```python
import torch

def _softmax(x, axis=-1):
    return torch.softmax(x, dim=axis)

def _gelu(x):
    return torch.nn.functional.gelu(x, approximate='tanh')

def _silu(x):
    return torch.nn.functional.silu(x)

def _sigmoid(x):
    return torch.sigmoid(x)

def _layernorm(x, axis=-1, eps=1e-05):
    m = x.mean(dim=axis, keepdim=True)
    v = x.var(dim=axis, keepdim=True, unbiased=False)
    return (x - m) / torch.sqrt(v + eps)

def _scatter_add(tgt, idx, src, axis=0):
    return tgt.clone().index_add_(axis, idx, src)

def _segment_sum(src, seg, n):
    out = torch.zeros((n,) + src.shape[1:], dtype=src.dtype)
    return out.index_add_(0, seg, src)

def _pad(x, pw):
    flat = tuple((v for pair in reversed(pw) for v in pair))
    return torch.nn.functional.pad(x, flat)
kernel_name = 'recurrent_scan__memory_aug_recurrent_mem_tr__mixer_s_mlp__prompt'

def setup_inputs():

    _w = lambda a: (lambda t: t.to(torch.bfloat16) if t.is_floating_point() else t)(torch.as_tensor(a))

    def _A_setup():
        B, S, Dm = (1, 2048, 1024)
        H, Dh = (32, 128)
        M, seg = (8, 32)
        seg = min(seg, S)
        S = S // seg * seg
        return {'x': _w((lambda *s: torch.randn(*s, dtype=torch.bfloat16) * 0.05)(B, S, Dm)), 'mem0': _w((lambda *s: torch.randn(*s, dtype=torch.bfloat16) * 0.2)(B, M, Dm)), 'Wq': _w((lambda *s: torch.randn(*s, dtype=torch.bfloat16) * 1.6)(Dm, H, Dh) * Dm ** (-0.5)), 'Wk': _w((lambda *s: torch.randn(*s, dtype=torch.bfloat16) * 1.6)(Dm, H, Dh) * Dm ** (-0.5)), 'Wv': _w((lambda *s: torch.randn(*s, dtype=torch.bfloat16) * 0.2)(Dm, H, Dh) * Dm ** (-0.5)), 'Wo': _w((lambda *s: torch.randn(*s, dtype=torch.bfloat16) * 0.2)(H, Dh, Dm) * (H * Dh) ** (-0.5)), 'seg_len': seg}
    _A_in = _A_setup()

    def _B_setup():
        B, S, D, F = (1, 2048, 1024, 3584)
        return {'x': _w((lambda *s: torch.randn(*s, dtype=torch.bfloat16) * 0.05)(B, S, D)), 'w1': _w((lambda *s: torch.randn(*s, dtype=torch.bfloat16) * 3.2)(D, D) * D ** (-0.5)), 'w2': _w((lambda *s: torch.randn(*s, dtype=torch.bfloat16) * 3.2)(D, D) * D ** (-0.5)), 'w3': _w((lambda *s: torch.randn(*s, dtype=torch.bfloat16) * 3.2)(D, F) * D ** (-0.5)), 'w4': _w((lambda *s: torch.randn(*s, dtype=torch.bfloat16) * 3.2)(F, D) * F ** (-0.5))}
    _B_in = _B_setup()
    return {'A_x': _A_in['x'], 'A_mem0': _A_in['mem0'], 'A_Wq': _A_in['Wq'], 'A_Wk': _A_in['Wk'], 'A_Wv': _A_in['Wv'], 'A_Wo': _A_in['Wo'], 'A_seg_len': _A_in['seg_len'], 'B_x': _B_in['x'], 'B_w1': _B_in['w1'], 'B_w2': _B_in['w2'], 'B_w3': _B_in['w3'], 'B_w4': _B_in['w4']}

def reference(A_x, A_mem0, A_Wq, A_Wk, A_Wv, A_Wo, A_seg_len, B_x, B_w1, B_w2, B_w3, B_w4):

    def _A_ref(x, mem0, Wq, Wk, Wv, Wo, seg_len):
        B, S, Dm = x.shape
        H, Dh = (Wq.shape[1], Wq.shape[2])
        M = mem0.shape[1]
        scale = Dh ** (-0.5)
        n_seg = S // seg_len
        L = M + seg_len
        idx = torch.arange(L)
        mask = (idx[:, None] < M) | (idx[:, None] >= idx[None, :])
        mem = mem0
        outs = []
        for s in range(n_seg):
            xs = x[:, s * seg_len:(s + 1) * seg_len, :].clone()
            h = torch.concatenate([mem, xs], axis=1)
            q = torch.einsum('btd,dhe->bhte', h, Wq)
            k = torch.einsum('btd,dhe->bhte', h, Wk)
            v = torch.einsum('btd,dhe->bhte', h, Wv)
            scores = torch.einsum('bhqe,bhke->bhqk', q, k) * scale
            scores = torch.where(mask[None, None], scores, -1000000000.0)
            p = _softmax(scores, axis=-1)
            o = torch.einsum('bhqk,bhke->bhqe', p, v)
            o = torch.einsum('bhte,hed->btd', o, Wo)
            mem = o[:, :M, :].clone()
            outs.append(o[:, M:, :])
        return torch.concatenate(outs, axis=1)

    def _B_ref(x, w1, w2, w3, w4):
        B, S, D = x.shape
        h = _gelu(_layernorm(x, axis=-1) @ w1)
        c = D // 4
        g0 = _pad(h[:, :, 0 * c:1 * c], ((0, 0), (1, 0), (0, 0)))[:, :S, :]
        g1 = _pad(h[:, :, 1 * c:2 * c], ((0, 0), (0, 1), (0, 0)))[:, 1:, :]
        g2 = _pad(h[:, :, 2 * c:3 * c], ((0, 0), (2, 0), (0, 0)))[:, :S, :]
        g3 = _pad(h[:, :, 3 * c:], ((0, 0), (0, 2), (0, 0)))[:, 2:, :]
        hs = torch.concatenate([g0, g1, g2, g3], axis=-1) @ w2
        x1 = x + hs
        h2 = _gelu(_layernorm(x1, axis=-1) @ w3) @ w4
        return x1 + h2
    x = A_x
    xn = _layernorm(x, axis=-1)
    s = _A_ref(xn, A_mem0, A_Wq, A_Wk, A_Wv, A_Wo, A_seg_len)
    g = _silu(_B_ref(xn, B_w1, B_w2, B_w3, B_w4))
    return x + s * g
```

```asm
; @launch kernel=main_kernel grid=(256,1,1) block=(256,1,1) lds=163840
.amdgcn_target "amdgcn-amd-amdhsa--gfx950"
.text
.text
.globl main_kernel
.p2align 8
.type main_kernel,@function
main_kernel:
s_load_dwordx4 s[20:23], s[0:1], 104
s_load_dwordx8 s[40:47], s[0:1], 16
s_load_dwordx8 s[64:71], s[0:1], 64
s_load_dwordx2 s[72:73], s[0:1], 0
s_load_dwordx2 s[74:75], s[0:1], 96
s_load_dwordx2 s[76:77], s[0:1], 8
s_cmp_ge_u32 s2, 256
s_cbranch_scc1 main_kernel_end
v_lshrrev_b32 v126, 6, v0
v_and_b32 v94, 63, v0
v_and_b32 v250, 63, v0
v_readfirstlane_b32 s14, v126
s_mov_b32 s29, 0x80000
s_waitcnt lgkmcnt(0)
s_mov_b32 s60, s20
s_and_b32 s61, s21, 0xffff
s_mov_b32 s62, 0x100
s_mov_b32 s63, 0x20000
s_mov_b32 s4, s22
s_and_b32 s5, s23, 0xffff
s_mov_b32 s6, 0x10000000
s_mov_b32 s7, 0x20000
s_cmp_lg_u32 s14, 0
s_cbranch_scc1 main_kernel_slot_wait
s_getreg_b32 s12, hwreg(HW_REG_XCC_ID, 0, 4)
s_and_b32 s12, s12, 7
s_lshl_b32 s32, s12, 5
v_mov_b32 v126, 0
v_mov_b32 v127, 1
s_mov_b64 exec, 1
buffer_atomic_add v127, v126, s[60:63], s32 offen sc0 sc1
s_waitcnt vmcnt(0)
s_mov_b64 exec, -1
v_readfirstlane_b32 s13, v127
s_nop 3
s_cmp_lt_u32 s13, 32
s_cbranch_scc1 main_kernel_slot_pub
v_and_b32 v126, 7, v94
v_lshlrev_b32 v126, 5, v126
main_kernel_ovf_cnt:
buffer_load_dword v127, v126, s[60:63], 0 offen sc1
s_waitcnt vmcnt(0)
v_readlane_b32 s48, v127, 0
v_readlane_b32 s49, v127, 1
v_readlane_b32 s50, v127, 2
v_readlane_b32 s51, v127, 3
v_readlane_b32 s52, v127, 4
v_readlane_b32 s53, v127, 5
v_readlane_b32 s54, v127, 6
v_readlane_b32 s55, v127, 7
s_nop 3
s_add_u32 s33, s48, s49
s_add_u32 s33, s33, s50
s_add_u32 s33, s33, s51
s_add_u32 s33, s33, s52
s_add_u32 s33, s33, s53
s_add_u32 s33, s33, s54
s_add_u32 s33, s33, s55
s_cmp_ge_u32 s33, 256
s_cbranch_scc1 main_kernel_ovf_cnt_ok
s_sub_u32 s29, s29, 1
s_cbranch_scc1 main_kernel_end
s_sleep 4
s_branch main_kernel_ovf_cnt
main_kernel_ovf_cnt_ok:
v_mov_b32 v126, 0
v_mov_b32 v127, 1
s_mov_b64 exec, 1
buffer_atomic_add v127, v126, s[60:63], 0 offen offset:8 sc0 sc1
s_waitcnt vmcnt(0)
s_mov_b64 exec, -1
v_readfirstlane_b32 s33, v127
s_nop 3
s_min_u32 s34, s48, 32
s_sub_u32 s35, 32, s34
s_mov_b32 s12, 0
s_add_u32 s13, s34, s33
s_cmp_lt_u32 s33, s35
s_cbranch_scc1 main_kernel_slot_pub
s_sub_u32 s33, s33, s35
s_min_u32 s34, s49, 32
s_sub_u32 s35, 32, s34
s_mov_b32 s12, 1
s_add_u32 s13, s34, s33
s_cmp_lt_u32 s33, s35
s_cbranch_scc1 main_kernel_slot_pub
s_sub_u32 s33, s33, s35
s_min_u32 s34, s50, 32
s_sub_u32 s35, 32, s34
s_mov_b32 s12, 2
s_add_u32 s13, s34, s33
s_cmp_lt_u32 s33, s35
s_cbranch_scc1 main_kernel_slot_pub
s_sub_u32 s33, s33, s35
s_min_u32 s34, s51, 32
s_sub_u32 s35, 32, s34
s_mov_b32 s12, 3
s_add_u32 s13, s34, s33
s_cmp_lt_u32 s33, s35
s_cbranch_scc1 main_kernel_slot_pub
s_sub_u32 s33, s33, s35
s_min_u32 s34, s52, 32
s_sub_u32 s35, 32, s34
s_mov_b32 s12, 4
s_add_u32 s13, s34, s33
s_cmp_lt_u32 s33, s35
s_cbranch_scc1 main_kernel_slot_pub
s_sub_u32 s33, s33, s35
s_min_u32 s34, s53, 32
s_sub_u32 s35, 32, s34
s_mov_b32 s12, 5
s_add_u32 s13, s34, s33
s_cmp_lt_u32 s33, s35
s_cbranch_scc1 main_kernel_slot_pub
s_sub_u32 s33, s33, s35
s_min_u32 s34, s54, 32
s_sub_u32 s35, 32, s34
s_mov_b32 s12, 6
s_add_u32 s13, s34, s33
s_cmp_lt_u32 s33, s35
s_cbranch_scc1 main_kernel_slot_pub
s_sub_u32 s33, s33, s35
s_min_u32 s34, s55, 32
s_sub_u32 s35, 32, s34
s_mov_b32 s12, 7
s_add_u32 s13, s34, s33
s_cmp_lt_u32 s33, s35
s_cbranch_scc1 main_kernel_slot_pub
s_sub_u32 s33, s33, s35
s_mov_b32 s12, 8
s_mov_b32 s13, 0
main_kernel_slot_pub:
v_mov_b32 v126, 0
v_mov_b32 v127, s12
v_mov_b32 v95, s13
ds_write_b32 v126, v127
ds_write_b32 v126, v95 offset:4
s_waitcnt lgkmcnt(0)
main_kernel_slot_wait:
s_barrier
v_mov_b32 v126, 0
ds_read_b32 v127, v126
ds_read_b32 v95, v126 offset:4
s_waitcnt lgkmcnt(0)
v_readfirstlane_b32 s12, v127
v_readfirstlane_b32 s13, v95
s_nop 3
s_barrier
s_cmp_ge_u32 s12, 8
s_cbranch_scc1 main_kernel_end
s_cmp_lt_u32 s12, 2
s_cbranch_scc1 main_kernel_chain
s_mov_b32 s96, s72
s_and_b32 s97, s73, 0xffff
s_mov_b32 s98, 0x400000
s_mov_b32 s99, 0x20000
s_mov_b32 s92, s74
s_and_b32 s93, s75, 0xffff
s_mov_b32 s94, 0x400000
s_mov_b32 s95, 0x20000
v_lshlrev_b32 v1, 4, v0
v_lshlrev_b32 v251, 4, v250
v_mov_b32 v4, 0
v_mov_b32 v8, -1
v_mov_b32 v5, 0
v_mov_b32 v9, -1
v_mov_b32 v6, 0
v_mov_b32 v10, -1
v_mov_b32 v7, 0
v_mov_b32 v11, -1
v_mul_u32_u24 v12, 128, v0
s_lshl_b32 s15, s12, 4
s_and_b32 s32, s12, 1
s_lshl_b32 s32, s32, 5
s_cmp_lt_u32 s12, 4
s_cselect_b32 s15, s32, s15
s_cselect_b32 s32, 32, 16
s_add_u32 s15, s15, s13
s_sub_u32 s16, s15, 80
s_sub_u32 s27, s12, 2
s_mov_b32 s52, 0
s_cmp_lt_u32 s13, s32
s_cbranch_scc1 main_kernel_s_ln
s_cmp_lg_u32 s13, 16
s_cbranch_scc1 main_kernel_s_fill
s_lshl_b32 s32, s16, 11
s_add_u32 s32, s32, 0x8400000
buffer_store_dwordx4 v[4:7], v1, s[4:7], s32 offen sc1
s_add_u32 s32, s32, 4096
buffer_store_dwordx4 v[4:7], v1, s[4:7], s32 offen sc1
s_add_u32 s32, s32, 4096
buffer_store_dwordx4 v[4:7], v1, s[4:7], s32 offen sc1
s_add_u32 s32, s32, 4096
buffer_store_dwordx4 v[4:7], v1, s[4:7], s32 offen sc1
s_add_u32 s32, s32, 4096
buffer_store_dwordx4 v[4:7], v1, s[4:7], s32 offen sc1
s_add_u32 s32, s32, 4096
buffer_store_dwordx4 v[4:7], v1, s[4:7], s32 offen sc1
s_add_u32 s32, s32, 4096
buffer_store_dwordx4 v[4:7], v1, s[4:7], s32 offen sc1
s_add_u32 s32, s32, 4096
buffer_store_dwordx4 v[4:7], v1, s[4:7], s32 offen sc1
s_add_u32 s32, s32, 4096
v_bfe_u32 v2, v0, 2, 1
s_lshr_b32 s32, s14, 1
v_and_b32 v2, s32, v2
s_bitcmp1_b32 s14, 0
s_cselect_b32 s32, 15, 0
s_cselect_b32 s33, 4161536, 0
v_xor_b32 v2, s32, v2
v_lshlrev_b32 v2, 4, v2
v_and_b32 v3, 3, v0
v_lshl_add_u32 v2, v3, 8, v2
v_lshrrev_b32 v3, 3, v0
v_lshl_add_u32 v2, v3, 10, v2
s_add_u32 s33, s33, 0x4808000
buffer_store_dwordx4 v[4:7], v2, s[4:7], s33 offen sc1
s_waitcnt vmcnt(0)
s_barrier
s_cmp_lg_u32 s14, 0
s_cbranch_scc1 main_kernel_s_fill
v_mov_b32 v2, 1
s_mov_b64 exec, 1
buffer_atomic_add v2, v4, s[60:63], 0 offen offset:12 sc1
s_mov_b64 exec, -1
s_branch main_kernel_s_fill
main_kernel_s_ln:
v_and_b32 v3, 15, v250
v_and_b32 v2, 48, v250
v_lshl_add_u32 v3, v3, 11, v2
s_lshl_b32 s34, s15, 15
s_lshl_b32 s32, s14, 9
s_add_u32 s32, s34, s32
buffer_load_dwordx4 v[32:35], v3, s[96:99], s32 offen offset:0
buffer_load_dwordx4 v[36:39], v3, s[96:99], s32 offen offset:64
buffer_load_dwordx4 v[40:43], v3, s[96:99], s32 offen offset:128
buffer_load_dwordx4 v[44:47], v3, s[96:99], s32 offen offset:192
buffer_load_dwordx4 v[48:51], v3, s[96:99], s32 offen offset:256
buffer_load_dwordx4 v[52:55], v3, s[96:99], s32 offen offset:320
buffer_load_dwordx4 v[56:59], v3, s[96:99], s32 offen offset:384
buffer_load_dwordx4 v[60:63], v3, s[96:99], s32 offen offset:448
v_and_b32 v255, 15, v250
v_lshlrev_b32 v254, 6, v255
v_add_u32 v254, 132096, v254
v_lshrrev_b32 v255, 4, v250
v_lshl_add_u32 v253, v255, 2, v254
v_lshl_add_u32 v253, s14, 4, v253
s_lshl_b32 s32, s14, 13
s_add_u32 s34, s34, s32
s_waitcnt vmcnt(0)
v_permlane16_swap_b32 v32, v34
v_permlane16_swap_b32 v33, v35
v_permlane16_swap_b32 v36, v38
v_permlane16_swap_b32 v37, v39
v_permlane16_swap_b32 v40, v42
v_permlane16_swap_b32 v41, v43
v_permlane16_swap_b32 v44, v46
v_permlane16_swap_b32 v45, v47
v_permlane16_swap_b32 v48, v50
v_permlane16_swap_b32 v49, v51
v_permlane16_swap_b32 v52, v54
v_permlane16_swap_b32 v53, v55
v_permlane16_swap_b32 v56, v58
v_permlane16_swap_b32 v57, v59
v_permlane16_swap_b32 v60, v62
v_permlane16_swap_b32 v61, v63
v_permlane32_swap_b32 v32, v34
v_permlane32_swap_b32 v33, v35
v_permlane32_swap_b32 v36, v38
v_permlane32_swap_b32 v37, v39
v_permlane32_swap_b32 v40, v42
v_permlane32_swap_b32 v41, v43
v_permlane32_swap_b32 v44, v46
v_permlane32_swap_b32 v45, v47
v_permlane32_swap_b32 v48, v50
v_permlane32_swap_b32 v49, v51
v_permlane32_swap_b32 v52, v54
v_permlane32_swap_b32 v53, v55
v_permlane32_swap_b32 v56, v58
v_permlane32_swap_b32 v57, v59
v_permlane32_swap_b32 v60, v62
v_permlane32_swap_b32 v61, v63
s_lshr_b32 s32, s15, 3
s_lshl_b32 s32, s32, 9
s_and_b32 s33, s15, 7
s_lshl_b32 s33, s33, 4
s_add_u32 s32, s32, s33
s_add_u32 s16, s32, 0x8416000
v_lshlrev_b32 v64, 16, v32
v_and_b32 v65, 0xffff0000, v32
v_lshlrev_b32 v66, 16, v33
v_and_b32 v67, 0xffff0000, v33
v_lshlrev_b32 v68, 16, v34
v_and_b32 v69, 0xffff0000, v34
v_lshlrev_b32 v70, 16, v35
v_and_b32 v71, 0xffff0000, v35
v_lshlrev_b32 v72, 16, v36
v_and_b32 v73, 0xffff0000, v36
v_lshlrev_b32 v74, 16, v37
v_and_b32 v75, 0xffff0000, v37
v_lshlrev_b32 v76, 16, v38
v_and_b32 v77, 0xffff0000, v38
v_lshlrev_b32 v78, 16, v39
v_and_b32 v79, 0xffff0000, v39
v_lshlrev_b32 v80, 16, v40
v_and_b32 v81, 0xffff0000, v40
v_lshlrev_b32 v82, 16, v41
v_and_b32 v83, 0xffff0000, v41
v_lshlrev_b32 v84, 16, v42
v_and_b32 v85, 0xffff0000, v42
v_lshlrev_b32 v86, 16, v43
v_and_b32 v87, 0xffff0000, v43
v_lshlrev_b32 v88, 16, v44
v_and_b32 v89, 0xffff0000, v44
v_lshlrev_b32 v90, 16, v45
v_and_b32 v91, 0xffff0000, v45
v_lshlrev_b32 v92, 16, v46
v_and_b32 v93, 0xffff0000, v46
v_lshlrev_b32 v94, 16, v47
v_and_b32 v95, 0xffff0000, v47
v_lshlrev_b32 v96, 16, v48
v_and_b32 v97, 0xffff0000, v48
v_lshlrev_b32 v98, 16, v49
v_and_b32 v99, 0xffff0000, v49
v_lshlrev_b32 v100, 16, v50
v_and_b32 v101, 0xffff0000, v50
v_lshlrev_b32 v102, 16, v51
v_and_b32 v103, 0xffff0000, v51
v_lshlrev_b32 v104, 16, v52
v_and_b32 v105, 0xffff0000, v52
v_lshlrev_b32 v106, 16, v53
v_and_b32 v107, 0xffff0000, v53
v_lshlrev_b32 v108, 16, v54
v_and_b32 v109, 0xffff0000, v54
v_lshlrev_b32 v110, 16, v55
v_and_b32 v111, 0xffff0000, v55
v_lshlrev_b32 v112, 16, v56
v_and_b32 v113, 0xffff0000, v56
v_lshlrev_b32 v114, 16, v57
v_and_b32 v115, 0xffff0000, v57
v_lshlrev_b32 v116, 16, v58
v_and_b32 v117, 0xffff0000, v58
v_lshlrev_b32 v118, 16, v59
v_and_b32 v119, 0xffff0000, v59
v_lshlrev_b32 v120, 16, v60
v_and_b32 v121, 0xffff0000, v60
v_lshlrev_b32 v122, 16, v61
v_and_b32 v123, 0xffff0000, v61
v_lshlrev_b32 v124, 16, v62
v_and_b32 v125, 0xffff0000, v62
v_lshlrev_b32 v126, 16, v63
v_and_b32 v127, 0xffff0000, v63
v_pk_add_f32 v[16:17], v[64:65], v[72:73]
v_pk_add_f32 v[18:19], v[66:67], v[74:75]
v_pk_add_f32 v[20:21], v[68:69], v[76:77]
v_pk_add_f32 v[22:23], v[70:71], v[78:79]
v_pk_add_f32 v[16:17], v[16:17], v[80:81]
v_pk_add_f32 v[18:19], v[18:19], v[82:83]
v_pk_add_f32 v[20:21], v[20:21], v[84:85]
v_pk_add_f32 v[22:23], v[22:23], v[86:87]
v_pk_add_f32 v[16:17], v[16:17], v[88:89]
v_pk_add_f32 v[18:19], v[18:19], v[90:91]
v_pk_add_f32 v[20:21], v[20:21], v[92:93]
v_pk_add_f32 v[22:23], v[22:23], v[94:95]
v_pk_add_f32 v[16:17], v[16:17], v[96:97]
v_pk_add_f32 v[18:19], v[18:19], v[98:99]
v_pk_add_f32 v[20:21], v[20:21], v[100:101]
v_pk_add_f32 v[22:23], v[22:23], v[102:103]
v_pk_add_f32 v[16:17], v[16:17], v[104:105]
v_pk_add_f32 v[18:19], v[18:19], v[106:107]
v_pk_add_f32 v[20:21], v[20:21], v[108:109]
v_pk_add_f32 v[22:23], v[22:23], v[110:111]
v_pk_add_f32 v[16:17], v[16:17], v[112:113]
v_pk_add_f32 v[18:19], v[18:19], v[114:115]
v_pk_add_f32 v[20:21], v[20:21], v[116:117]
v_pk_add_f32 v[22:23], v[22:23], v[118:119]
v_pk_add_f32 v[16:17], v[16:17], v[120:121]
v_pk_add_f32 v[18:19], v[18:19], v[122:123]
v_pk_add_f32 v[20:21], v[20:21], v[124:125]
v_pk_add_f32 v[22:23], v[22:23], v[126:127]
v_pk_add_f32 v[16:17], v[16:17], v[18:19]
v_pk_add_f32 v[20:21], v[20:21], v[22:23]
v_pk_add_f32 v[16:17], v[16:17], v[20:21]
v_add_f32 v16, v16, v17
ds_write_b32 v253, v16 offset:0
s_waitcnt lgkmcnt(0)
s_barrier
ds_read_b128 v[16:19], v254 offset:0
ds_read_b128 v[20:23], v254 offset:16
ds_read_b128 v[24:27], v254 offset:32
ds_read_b128 v[28:31], v254 offset:48
s_waitcnt lgkmcnt(2)
v_pk_add_f32 v[16:17], v[16:17], v[18:19]
v_pk_add_f32 v[20:21], v[20:21], v[22:23]
s_waitcnt lgkmcnt(0)
v_pk_add_f32 v[24:25], v[24:25], v[26:27]
v_pk_add_f32 v[28:29], v[28:29], v[30:31]
v_pk_add_f32 v[16:17], v[16:17], v[20:21]
v_pk_add_f32 v[24:25], v[24:25], v[28:29]
v_pk_add_f32 v[16:17], v[16:17], v[24:25]
v_add_f32 v16, v16, v17
v_mul_f32 v16, 0xba800000, v16
v_mov_b32 v17, v16
v_pk_add_f32 v[64:65], v[64:65], v[16:17]
v_pk_add_f32 v[66:67], v[66:67], v[16:17]
v_pk_add_f32 v[68:69], v[68:69], v[16:17]
v_pk_add_f32 v[70:71], v[70:71], v[16:17]
v_pk_add_f32 v[72:73], v[72:73], v[16:17]
v_pk_add_f32 v[74:75], v[74:75], v[16:17]
v_pk_add_f32 v[76:77], v[76:77], v[16:17]
v_pk_add_f32 v[78:79], v[78:79], v[16:17]
v_pk_add_f32 v[80:81], v[80:81], v[16:17]
v_pk_add_f32 v[82:83], v[82:83], v[16:17]
v_pk_add_f32 v[84:85], v[84:85], v[16:17]
v_pk_add_f32 v[86:87], v[86:87], v[16:17]
v_pk_add_f32 v[88:89], v[88:89], v[16:17]
v_pk_add_f32 v[90:91], v[90:91], v[16:17]
v_pk_add_f32 v[92:93], v[92:93], v[16:17]
v_pk_add_f32 v[94:95], v[94:95], v[16:17]
v_pk_add_f32 v[96:97], v[96:97], v[16:17]
v_pk_add_f32 v[98:99], v[98:99], v[16:17]
v_pk_add_f32 v[100:101], v[100:101], v[16:17]
v_pk_add_f32 v[102:103], v[102:103], v[16:17]
v_pk_add_f32 v[104:105], v[104:105], v[16:17]
v_pk_add_f32 v[106:107], v[106:107], v[16:17]
v_pk_add_f32 v[108:109], v[108:109], v[16:17]
v_pk_add_f32 v[110:111], v[110:111], v[16:17]
v_pk_add_f32 v[112:113], v[112:113], v[16:17]
v_pk_add_f32 v[114:115], v[114:115], v[16:17]
v_pk_add_f32 v[116:117], v[116:117], v[16:17]
v_pk_add_f32 v[118:119], v[118:119], v[16:17]
v_pk_add_f32 v[120:121], v[120:121], v[16:17]
v_pk_add_f32 v[122:123], v[122:123], v[16:17]
v_pk_add_f32 v[124:125], v[124:125], v[16:17]
v_pk_add_f32 v[126:127], v[126:127], v[16:17]
v_pk_mul_f32 v[16:17], v[64:65], v[64:65]
v_pk_mul_f32 v[18:19], v[66:67], v[66:67]
v_pk_mul_f32 v[20:21], v[68:69], v[68:69]
v_pk_mul_f32 v[22:23], v[70:71], v[70:71]
v_pk_fma_f32 v[16:17], v[72:73], v[72:73], v[16:17]
v_pk_fma_f32 v[18:19], v[74:75], v[74:75], v[18:19]
v_pk_fma_f32 v[20:21], v[76:77], v[76:77], v[20:21]
v_pk_fma_f32 v[22:23], v[78:79], v[78:79], v[22:23]
v_pk_fma_f32 v[16:17], v[80:81], v[80:81], v[16:17]
v_pk_fma_f32 v[18:19], v[82:83], v[82:83], v[18:19]
v_pk_fma_f32 v[20:21], v[84:85], v[84:85], v[20:21]
v_pk_fma_f32 v[22:23], v[86:87], v[86:87], v[22:23]
v_pk_fma_f32 v[16:17], v[88:89], v[88:89], v[16:17]
v_pk_fma_f32 v[18:19], v[90:91], v[90:91], v[18:19]
v_pk_fma_f32 v[20:21], v[92:93], v[92:93], v[20:21]
v_pk_fma_f32 v[22:23], v[94:95], v[94:95], v[22:23]
v_pk_fma_f32 v[16:17], v[96:97], v[96:97], v[16:17]
v_pk_fma_f32 v[18:19], v[98:99], v[98:99], v[18:19]
v_pk_fma_f32 v[20:21], v[100:101], v[100:101], v[20:21]
v_pk_fma_f32 v[22:23], v[102:103], v[102:103], v[22:23]
v_pk_fma_f32 v[16:17], v[104:105], v[104:105], v[16:17]
v_pk_fma_f32 v[18:19], v[106:107], v[106:107], v[18:19]
v_pk_fma_f32 v[20:21], v[108:109], v[108:109], v[20:21]
v_pk_fma_f32 v[22:23], v[110:111], v[110:111], v[22:23]
v_pk_fma_f32 v[16:17], v[112:113], v[112:113], v[16:17]
v_pk_fma_f32 v[18:19], v[114:115], v[114:115], v[18:19]
v_pk_fma_f32 v[20:21], v[116:117], v[116:117], v[20:21]
v_pk_fma_f32 v[22:23], v[118:119], v[118:119], v[22:23]
v_pk_fma_f32 v[16:17], v[120:121], v[120:121], v[16:17]
v_pk_fma_f32 v[18:19], v[122:123], v[122:123], v[18:19]
v_pk_fma_f32 v[20:21], v[124:125], v[124:125], v[20:21]
v_pk_fma_f32 v[22:23], v[126:127], v[126:127], v[22:23]
v_pk_add_f32 v[16:17], v[16:17], v[18:19]
v_pk_add_f32 v[20:21], v[20:21], v[22:23]
v_pk_add_f32 v[16:17], v[16:17], v[20:21]
v_add_f32 v16, v16, v17
ds_write_b32 v253, v16 offset:1024
s_waitcnt lgkmcnt(0)
s_barrier
ds_read_b128 v[16:19], v254 offset:1024
ds_read_b128 v[20:23], v254 offset:1040
ds_read_b128 v[24:27], v254 offset:1056
ds_read_b128 v[28:31], v254 offset:1072
s_waitcnt lgkmcnt(2)
v_pk_add_f32 v[16:17], v[16:17], v[18:19]
v_pk_add_f32 v[20:21], v[20:21], v[22:23]
s_waitcnt lgkmcnt(0)
v_pk_add_f32 v[24:25], v[24:25], v[26:27]
v_pk_add_f32 v[28:29], v[28:29], v[30:31]
v_pk_add_f32 v[16:17], v[16:17], v[20:21]
v_pk_add_f32 v[24:25], v[24:25], v[28:29]
v_pk_add_f32 v[16:17], v[16:17], v[24:25]
v_add_f32 v16, v16, v17
v_mov_b32 v17, 0x3727c5ac
v_fmac_f32 v17, 0x3a800000, v16
v_rsq_f32 v16, v17
s_nop 0
v_mov_b32 v17, v16
v_pk_mul_f32 v[64:65], v[64:65], v[16:17]
v_pk_mul_f32 v[66:67], v[66:67], v[16:17]
v_pk_mul_f32 v[68:69], v[68:69], v[16:17]
v_pk_mul_f32 v[70:71], v[70:71], v[16:17]
v_pk_mul_f32 v[72:73], v[72:73], v[16:17]
v_pk_mul_f32 v[74:75], v[74:75], v[16:17]
v_pk_mul_f32 v[76:77], v[76:77], v[16:17]
v_pk_mul_f32 v[78:79], v[78:79], v[16:17]
v_pk_mul_f32 v[80:81], v[80:81], v[16:17]
v_pk_mul_f32 v[82:83], v[82:83], v[16:17]
v_pk_mul_f32 v[84:85], v[84:85], v[16:17]
v_pk_mul_f32 v[86:87], v[86:87], v[16:17]
v_pk_mul_f32 v[88:89], v[88:89], v[16:17]
v_pk_mul_f32 v[90:91], v[90:91], v[16:17]
v_pk_mul_f32 v[92:93], v[92:93], v[16:17]
v_pk_mul_f32 v[94:95], v[94:95], v[16:17]
v_pk_mul_f32 v[96:97], v[96:97], v[16:17]
v_pk_mul_f32 v[98:99], v[98:99], v[16:17]
v_pk_mul_f32 v[100:101], v[100:101], v[16:17]
v_pk_mul_f32 v[102:103], v[102:103], v[16:17]
v_pk_mul_f32 v[104:105], v[104:105], v[16:17]
v_pk_mul_f32 v[106:107], v[106:107], v[16:17]
v_pk_mul_f32 v[108:109], v[108:109], v[16:17]
v_pk_mul_f32 v[110:111], v[110:111], v[16:17]
v_pk_mul_f32 v[112:113], v[112:113], v[16:17]
v_pk_mul_f32 v[114:115], v[114:115], v[16:17]
v_pk_mul_f32 v[116:117], v[116:117], v[16:17]
v_pk_mul_f32 v[118:119], v[118:119], v[16:17]
v_pk_mul_f32 v[120:121], v[120:121], v[16:17]
v_pk_mul_f32 v[122:123], v[122:123], v[16:17]
v_pk_mul_f32 v[124:125], v[124:125], v[16:17]
v_pk_mul_f32 v[126:127], v[126:127], v[16:17]
v_cvt_pk_bf16_f32 v128, v64, v65
v_cvt_pk_bf16_f32 v129, v66, v67
v_cvt_pk_bf16_f32 v130, v68, v69
v_cvt_pk_bf16_f32 v131, v70, v71
v_cvt_pk_bf16_f32 v132, v72, v73
v_cvt_pk_bf16_f32 v133, v74, v75
v_cvt_pk_bf16_f32 v134, v76, v77
v_cvt_pk_bf16_f32 v135, v78, v79
v_cvt_pk_bf16_f32 v136, v80, v81
v_cvt_pk_bf16_f32 v137, v82, v83
v_cvt_pk_bf16_f32 v138, v84, v85
v_cvt_pk_bf16_f32 v139, v86, v87
v_cvt_pk_bf16_f32 v140, v88, v89
v_cvt_pk_bf16_f32 v141, v90, v91
v_cvt_pk_bf16_f32 v142, v92, v93
v_cvt_pk_bf16_f32 v143, v94, v95
v_cvt_pk_bf16_f32 v144, v96, v97
v_cvt_pk_bf16_f32 v145, v98, v99
v_cvt_pk_bf16_f32 v146, v100, v101
v_cvt_pk_bf16_f32 v147, v102, v103
v_cvt_pk_bf16_f32 v148, v104, v105
v_cvt_pk_bf16_f32 v149, v106, v107
v_cvt_pk_bf16_f32 v150, v108, v109
v_cvt_pk_bf16_f32 v151, v110, v111
v_cvt_pk_bf16_f32 v152, v112, v113
v_cvt_pk_bf16_f32 v153, v114, v115
v_cvt_pk_bf16_f32 v154, v116, v117
v_cvt_pk_bf16_f32 v155, v118, v119
v_cvt_pk_bf16_f32 v156, v120, v121
v_cvt_pk_bf16_f32 v157, v122, v123
v_cvt_pk_bf16_f32 v158, v124, v125
v_cvt_pk_bf16_f32 v159, v126, v127
s_add_u32 s32, s34, 0x0
s_add_u32 s33, s32, 4096
buffer_store_dwordx4 v[128:131], v251, s[4:7], s32 offen offset:0 sc1
buffer_store_dwordx4 v[132:135], v251, s[4:7], s32 offen offset:1024 sc1
buffer_store_dwordx4 v[136:139], v251, s[4:7], s32 offen offset:2048 sc1
buffer_store_dwordx4 v[140:143], v251, s[4:7], s32 offen offset:3072 sc1
buffer_store_dwordx4 v[144:147], v251, s[4:7], s33 offen offset:0 sc1
buffer_store_dwordx4 v[148:151], v251, s[4:7], s33 offen offset:1024 sc1
buffer_store_dwordx4 v[152:155], v251, s[4:7], s33 offen offset:2048 sc1
buffer_store_dwordx4 v[156:159], v251, s[4:7], s33 offen offset:3072 sc1
buffer_load_dword v2, v4, s[60:63], 0 offen offset:12 sc1
v_lshlrev_b32 v64, 16, v128
v_and_b32 v65, 0xffff0000, v128
v_lshlrev_b32 v66, 16, v129
v_and_b32 v67, 0xffff0000, v129
v_lshlrev_b32 v68, 16, v130
v_and_b32 v69, 0xffff0000, v130
v_lshlrev_b32 v70, 16, v131
v_and_b32 v71, 0xffff0000, v131
v_lshlrev_b32 v72, 16, v132
v_and_b32 v73, 0xffff0000, v132
v_lshlrev_b32 v74, 16, v133
v_and_b32 v75, 0xffff0000, v133
v_lshlrev_b32 v76, 16, v134
v_and_b32 v77, 0xffff0000, v134
v_lshlrev_b32 v78, 16, v135
v_and_b32 v79, 0xffff0000, v135
v_lshlrev_b32 v80, 16, v136
v_and_b32 v81, 0xffff0000, v136
v_lshlrev_b32 v82, 16, v137
v_and_b32 v83, 0xffff0000, v137
v_lshlrev_b32 v84, 16, v138
v_and_b32 v85, 0xffff0000, v138
v_lshlrev_b32 v86, 16, v139
v_and_b32 v87, 0xffff0000, v139
v_lshlrev_b32 v88, 16, v140
v_and_b32 v89, 0xffff0000, v140
v_lshlrev_b32 v90, 16, v141
v_and_b32 v91, 0xffff0000, v141
v_lshlrev_b32 v92, 16, v142
v_and_b32 v93, 0xffff0000, v142
v_lshlrev_b32 v94, 16, v143
v_and_b32 v95, 0xffff0000, v143
v_lshlrev_b32 v96, 16, v144
v_and_b32 v97, 0xffff0000, v144
v_lshlrev_b32 v98, 16, v145
v_and_b32 v99, 0xffff0000, v145
v_lshlrev_b32 v100, 16, v146
v_and_b32 v101, 0xffff0000, v146
v_lshlrev_b32 v102, 16, v147
v_and_b32 v103, 0xffff0000, v147
v_lshlrev_b32 v104, 16, v148
v_and_b32 v105, 0xffff0000, v148
v_lshlrev_b32 v106, 16, v149
v_and_b32 v107, 0xffff0000, v149
v_lshlrev_b32 v108, 16, v150
v_and_b32 v109, 0xffff0000, v150
v_lshlrev_b32 v110, 16, v151
v_and_b32 v111, 0xffff0000, v151
v_lshlrev_b32 v112, 16, v152
v_and_b32 v113, 0xffff0000, v152
v_lshlrev_b32 v114, 16, v153
v_and_b32 v115, 0xffff0000, v153
v_lshlrev_b32 v116, 16, v154
v_and_b32 v117, 0xffff0000, v154
v_lshlrev_b32 v118, 16, v155
v_and_b32 v119, 0xffff0000, v155
v_lshlrev_b32 v120, 16, v156
v_and_b32 v121, 0xffff0000, v156
v_lshlrev_b32 v122, 16, v157
v_and_b32 v123, 0xffff0000, v157
v_lshlrev_b32 v124, 16, v158
v_and_b32 v125, 0xffff0000, v158
v_lshlrev_b32 v126, 16, v159
v_and_b32 v127, 0xffff0000, v159
v_pk_add_f32 v[16:17], v[64:65], v[72:73]
v_pk_add_f32 v[18:19], v[66:67], v[74:75]
v_pk_add_f32 v[20:21], v[68:69], v[76:77]
v_pk_add_f32 v[22:23], v[70:71], v[78:79]
v_pk_add_f32 v[16:17], v[16:17], v[80:81]
v_pk_add_f32 v[18:19], v[18:19], v[82:83]
v_pk_add_f32 v[20:21], v[20:21], v[84:85]
v_pk_add_f32 v[22:23], v[22:23], v[86:87]
v_pk_add_f32 v[16:17], v[16:17], v[88:89]
v_pk_add_f32 v[18:19], v[18:19], v[90:91]
v_pk_add_f32 v[20:21], v[20:21], v[92:93]
v_pk_add_f32 v[22:23], v[22:23], v[94:95]
v_pk_add_f32 v[16:17], v[16:17], v[96:97]
v_pk_add_f32 v[18:19], v[18:19], v[98:99]
v_pk_add_f32 v[20:21], v[20:21], v[100:101]
v_pk_add_f32 v[22:23], v[22:23], v[102:103]
v_pk_add_f32 v[16:17], v[16:17], v[104:105]
v_pk_add_f32 v[18:19], v[18:19], v[106:107]
v_pk_add_f32 v[20:21], v[20:21], v[108:109]
v_pk_add_f32 v[22:23], v[22:23], v[110:111]
v_pk_add_f32 v[16:17], v[16:17], v[112:113]
v_pk_add_f32 v[18:19], v[18:19], v[114:115]
v_pk_add_f32 v[20:21], v[20:21], v[116:117]
v_pk_add_f32 v[22:23], v[22:23], v[118:119]
v_pk_add_f32 v[16:17], v[16:17], v[120:121]
v_pk_add_f32 v[18:19], v[18:19], v[122:123]
v_pk_add_f32 v[20:21], v[20:21], v[124:125]
v_pk_add_f32 v[22:23], v[22:23], v[126:127]
v_pk_add_f32 v[16:17], v[16:17], v[18:19]
v_pk_add_f32 v[20:21], v[20:21], v[22:23]
v_pk_add_f32 v[16:17], v[16:17], v[20:21]
v_add_f32 v16, v16, v17
ds_write_b32 v253, v16 offset:0
s_waitcnt lgkmcnt(0)
s_barrier
ds_read_b128 v[16:19], v254 offset:0
ds_read_b128 v[20:23], v254 offset:16
ds_read_b128 v[24:27], v254 offset:32
ds_read_b128 v[28:31], v254 offset:48
s_waitcnt lgkmcnt(2)
v_pk_add_f32 v[16:17], v[16:17], v[18:19]
v_pk_add_f32 v[20:21], v[20:21], v[22:23]
s_waitcnt lgkmcnt(0)
v_pk_add_f32 v[24:25], v[24:25], v[26:27]
v_pk_add_f32 v[28:29], v[28:29], v[30:31]
v_pk_add_f32 v[16:17], v[16:17], v[20:21]
v_pk_add_f32 v[24:25], v[24:25], v[28:29]
v_pk_add_f32 v[16:17], v[16:17], v[24:25]
v_add_f32 v16, v16, v17
v_mul_f32 v16, 0xba800000, v16
v_mov_b32 v17, v16
v_pk_add_f32 v[64:65], v[64:65], v[16:17]
v_pk_add_f32 v[66:67], v[66:67], v[16:17]
v_pk_add_f32 v[68:69], v[68:69], v[16:17]
v_pk_add_f32 v[70:71], v[70:71], v[16:17]
v_pk_add_f32 v[72:73], v[72:73], v[16:17]
v_pk_add_f32 v[74:75], v[74:75], v[16:17]
v_pk_add_f32 v[76:77], v[76:77], v[16:17]
v_pk_add_f32 v[78:79], v[78:79], v[16:17]
v_pk_add_f32 v[80:81], v[80:81], v[16:17]
v_pk_add_f32 v[82:83], v[82:83], v[16:17]
v_pk_add_f32 v[84:85], v[84:85], v[16:17]
v_pk_add_f32 v[86:87], v[86:87], v[16:17]
v_pk_add_f32 v[88:89], v[88:89], v[16:17]
v_pk_add_f32 v[90:91], v[90:91], v[16:17]
v_pk_add_f32 v[92:93], v[92:93], v[16:17]
v_pk_add_f32 v[94:95], v[94:95], v[16:17]
v_pk_add_f32 v[96:97], v[96:97], v[16:17]
v_pk_add_f32 v[98:99], v[98:99], v[16:17]
v_pk_add_f32 v[100:101], v[100:101], v[16:17]
v_pk_add_f32 v[102:103], v[102:103], v[16:17]
v_pk_add_f32 v[104:105], v[104:105], v[16:17]
v_pk_add_f32 v[106:107], v[106:107], v[16:17]
v_pk_add_f32 v[108:109], v[108:109], v[16:17]
v_pk_add_f32 v[110:111], v[110:111], v[16:17]
v_pk_add_f32 v[112:113], v[112:113], v[16:17]
v_pk_add_f32 v[114:115], v[114:115], v[16:17]
v_pk_add_f32 v[116:117], v[116:117], v[16:17]
v_pk_add_f32 v[118:119], v[118:119], v[16:17]
v_pk_add_f32 v[120:121], v[120:121], v[16:17]
v_pk_add_f32 v[122:123], v[122:123], v[16:17]
v_pk_add_f32 v[124:125], v[124:125], v[16:17]
v_pk_add_f32 v[126:127], v[126:127], v[16:17]
v_pk_mul_f32 v[16:17], v[64:65], v[64:65]
v_pk_mul_f32 v[18:19], v[66:67], v[66:67]
v_pk_mul_f32 v[20:21], v[68:69], v[68:69]
v_pk_mul_f32 v[22:23], v[70:71], v[70:71]
v_pk_fma_f32 v[16:17], v[72:73], v[72:73], v[16:17]
v_pk_fma_f32 v[18:19], v[74:75], v[74:75], v[18:19]
v_pk_fma_f32 v[20:21], v[76:77], v[76:77], v[20:21]
v_pk_fma_f32 v[22:23], v[78:79], v[78:79], v[22:23]
v_pk_fma_f32 v[16:17], v[80:81], v[80:81], v[16:17]
v_pk_fma_f32 v[18:19], v[82:83], v[82:83], v[18:19]
v_pk_fma_f32 v[20:21], v[84:85], v[84:85], v[20:21]
v_pk_fma_f32 v[22:23], v[86:87], v[86:87], v[22:23]
v_pk_fma_f32 v[16:17], v[88:89], v[88:89], v[16:17]
v_pk_fma_f32 v[18:19], v[90:91], v[90:91], v[18:19]
v_pk_fma_f32 v[20:21], v[92:93], v[92:93], v[20:21]
v_pk_fma_f32 v[22:23], v[94:95], v[94:95], v[22:23]
v_pk_fma_f32 v[16:17], v[96:97], v[96:97], v[16:17]
v_pk_fma_f32 v[18:19], v[98:99], v[98:99], v[18:19]
v_pk_fma_f32 v[20:21], v[100:101], v[100:101], v[20:21]
v_pk_fma_f32 v[22:23], v[102:103], v[102:103], v[22:23]
v_pk_fma_f32 v[16:17], v[104:105], v[104:105], v[16:17]
v_pk_fma_f32 v[18:19], v[106:107], v[106:107], v[18:19]
v_pk_fma_f32 v[20:21], v[108:109], v[108:109], v[20:21]
v_pk_fma_f32 v[22:23], v[110:111], v[110:111], v[22:23]
v_pk_fma_f32 v[16:17], v[112:113], v[112:113], v[16:17]
v_pk_fma_f32 v[18:19], v[114:115], v[114:115], v[18:19]
v_pk_fma_f32 v[20:21], v[116:117], v[116:117], v[20:21]
v_pk_fma_f32 v[22:23], v[118:119], v[118:119], v[22:23]
v_pk_fma_f32 v[16:17], v[120:121], v[120:121], v[16:17]
v_pk_fma_f32 v[18:19], v[122:123], v[122:123], v[18:19]
v_pk_fma_f32 v[20:21], v[124:125], v[124:125], v[20:21]
v_pk_fma_f32 v[22:23], v[126:127], v[126:127], v[22:23]
v_pk_add_f32 v[16:17], v[16:17], v[18:19]
v_pk_add_f32 v[20:21], v[20:21], v[22:23]
v_pk_add_f32 v[16:17], v[16:17], v[20:21]
v_add_f32 v16, v16, v17
ds_write_b32 v253, v16 offset:1024
s_waitcnt lgkmcnt(0)
s_waitcnt vmcnt(0)
s_barrier
s_cmp_lg_u32 s14, 0
s_cbranch_scc1 main_kernel_s_nf
v_cmp_gt_u32 vcc, 4, v2
s_cbranch_vccz main_kernel_s_wa1_ok
v_mov_b32 v2, 0
main_kernel_s_wa1:
buffer_load_dword v3, v2, s[60:63], 0 offen offset:12 sc1
s_waitcnt vmcnt(0)
v_cmp_gt_u32 vcc, 4, v3
s_cbranch_vccz main_kernel_s_wa1_ok
s_sleep 4
s_sub_u32 s29, s29, 1
s_cbranch_scc0 main_kernel_s_wa1
s_branch main_kernel_end
main_kernel_s_wa1_ok:
s_mov_b64 exec, 1
buffer_store_dword v8, v4, s[4:7], s16 offen sc1
s_mov_b64 exec, -1
main_kernel_s_nf:
ds_read_b128 v[16:19], v254 offset:1024
ds_read_b128 v[20:23], v254 offset:1040
ds_read_b128 v[24:27], v254 offset:1056
ds_read_b128 v[28:31], v254 offset:1072
s_waitcnt lgkmcnt(2)
v_pk_add_f32 v[16:17], v[16:17], v[18:19]
v_pk_add_f32 v[20:21], v[20:21], v[22:23]
s_waitcnt lgkmcnt(0)
v_pk_add_f32 v[24:25], v[24:25], v[26:27]
v_pk_add_f32 v[28:29], v[28:29], v[30:31]
v_pk_add_f32 v[16:17], v[16:17], v[20:21]
v_pk_add_f32 v[24:25], v[24:25], v[28:29]
v_pk_add_f32 v[16:17], v[16:17], v[24:25]
v_add_f32 v16, v16, v17
v_mov_b32 v17, 0x3727c5ac
v_fmac_f32 v17, 0x3a800000, v16
v_rsq_f32 v16, v17
s_nop 0
v_mov_b32 v17, v16
v_pk_mul_f32 v[64:65], v[64:65], v[16:17]
v_pk_mul_f32 v[66:67], v[66:67], v[16:17]
v_pk_mul_f32 v[68:69], v[68:69], v[16:17]
v_pk_mul_f32 v[70:71], v[70:71], v[16:17]
v_pk_mul_f32 v[72:73], v[72:73], v[16:17]
v_pk_mul_f32 v[74:75], v[74:75], v[16:17]
v_pk_mul_f32 v[76:77], v[76:77], v[16:17]
v_pk_mul_f32 v[78:79], v[78:79], v[16:17]
v_pk_mul_f32 v[80:81], v[80:81], v[16:17]
v_pk_mul_f32 v[82:83], v[82:83], v[16:17]
v_pk_mul_f32 v[84:85], v[84:85], v[16:17]
v_pk_mul_f32 v[86:87], v[86:87], v[16:17]
v_pk_mul_f32 v[88:89], v[88:89], v[16:17]
v_pk_mul_f32 v[90:91], v[90:91], v[16:17]
v_pk_mul_f32 v[92:93], v[92:93], v[16:17]
v_pk_mul_f32 v[94:95], v[94:95], v[16:17]
v_pk_mul_f32 v[96:97], v[96:97], v[16:17]
v_pk_mul_f32 v[98:99], v[98:99], v[16:17]
v_pk_mul_f32 v[100:101], v[100:101], v[16:17]
v_pk_mul_f32 v[102:103], v[102:103], v[16:17]
v_pk_mul_f32 v[104:105], v[104:105], v[16:17]
v_pk_mul_f32 v[106:107], v[106:107], v[16:17]
v_pk_mul_f32 v[108:109], v[108:109], v[16:17]
v_pk_mul_f32 v[110:111], v[110:111], v[16:17]
v_pk_mul_f32 v[112:113], v[112:113], v[16:17]
v_pk_mul_f32 v[114:115], v[114:115], v[16:17]
v_pk_mul_f32 v[116:117], v[116:117], v[16:17]
v_pk_mul_f32 v[118:119], v[118:119], v[16:17]
v_pk_mul_f32 v[120:121], v[120:121], v[16:17]
v_pk_mul_f32 v[122:123], v[122:123], v[16:17]
v_pk_mul_f32 v[124:125], v[124:125], v[16:17]
v_pk_mul_f32 v[126:127], v[126:127], v[16:17]
v_cvt_pk_bf16_f32 v32, v64, v65
v_cvt_pk_bf16_f32 v33, v66, v67
v_cvt_pk_bf16_f32 v34, v68, v69
v_cvt_pk_bf16_f32 v35, v70, v71
v_cvt_pk_bf16_f32 v36, v72, v73
v_cvt_pk_bf16_f32 v37, v74, v75
v_cvt_pk_bf16_f32 v38, v76, v77
v_cvt_pk_bf16_f32 v39, v78, v79
v_cvt_pk_bf16_f32 v40, v80, v81
v_cvt_pk_bf16_f32 v41, v82, v83
v_cvt_pk_bf16_f32 v42, v84, v85
v_cvt_pk_bf16_f32 v43, v86, v87
v_cvt_pk_bf16_f32 v44, v88, v89
v_cvt_pk_bf16_f32 v45, v90, v91
v_cvt_pk_bf16_f32 v46, v92, v93
v_cvt_pk_bf16_f32 v47, v94, v95
v_cvt_pk_bf16_f32 v48, v96, v97
v_cvt_pk_bf16_f32 v49, v98, v99
v_cvt_pk_bf16_f32 v50, v100, v101
v_cvt_pk_bf16_f32 v51, v102, v103
v_cvt_pk_bf16_f32 v52, v104, v105
v_cvt_pk_bf16_f32 v53, v106, v107
v_cvt_pk_bf16_f32 v54, v108, v109
v_cvt_pk_bf16_f32 v55, v110, v111
v_cvt_pk_bf16_f32 v56, v112, v113
v_cvt_pk_bf16_f32 v57, v114, v115
v_cvt_pk_bf16_f32 v58, v116, v117
v_cvt_pk_bf16_f32 v59, v118, v119
v_cvt_pk_bf16_f32 v60, v120, v121
v_cvt_pk_bf16_f32 v61, v122, v123
v_cvt_pk_bf16_f32 v62, v124, v125
v_cvt_pk_bf16_f32 v63, v126, v127
s_add_u32 s32, s34, 0x400000
s_add_u32 s33, s32, 4096
buffer_store_dwordx4 v[32:35], v251, s[4:7], s32 offen offset:0 sc1
buffer_store_dwordx4 v[36:39], v251, s[4:7], s32 offen offset:1024 sc1
buffer_store_dwordx4 v[40:43], v251, s[4:7], s32 offen offset:2048 sc1
buffer_store_dwordx4 v[44:47], v251, s[4:7], s32 offen offset:3072 sc1
buffer_store_dwordx4 v[48:51], v251, s[4:7], s33 offen offset:0 sc1
buffer_store_dwordx4 v[52:55], v251, s[4:7], s33 offen offset:1024 sc1
buffer_store_dwordx4 v[56:59], v251, s[4:7], s33 offen offset:2048 sc1
buffer_store_dwordx4 v[60:63], v251, s[4:7], s33 offen offset:3072 sc1
s_add_u32 s16, s16, 4
s_branch main_kernel_s_wa2_ok
main_kernel_s_fill:
s_lshl_b32 s32, s16, 2
s_sub_u32 s33, s32, 48
s_lshl_b32 s34, s32, 12
s_add_u32 s34, s34, 0x6c00000
s_cmp_lt_u32 s33, 16
s_cselect_b32 s34, 0x7f000000, s34
buffer_store_dwordx4 v[8:11], v1, s[4:7], s34 offen sc1
s_sub_u32 s33, s32, 47
s_lshl_b32 s34, s32, 12
s_add_u32 s34, s34, 0x6c01000
s_cmp_lt_u32 s33, 16
s_cselect_b32 s34, 0x7f000000, s34
buffer_store_dwordx4 v[8:11], v1, s[4:7], s34 offen sc1
s_sub_u32 s33, s32, 46
s_lshl_b32 s34, s32, 12
s_add_u32 s34, s34, 0x6c02000
s_cmp_lt_u32 s33, 16
s_cselect_b32 s34, 0x7f000000, s34
buffer_store_dwordx4 v[8:11], v1, s[4:7], s34 offen sc1
s_sub_u32 s33, s32, 45
s_lshl_b32 s34, s32, 12
s_add_u32 s34, s34, 0x6c03000
s_cmp_lt_u32 s33, 16
s_cselect_b32 s34, 0x7f000000, s34
buffer_store_dwordx4 v[8:11], v1, s[4:7], s34 offen sc1
s_lshl_b32 s32, s16, 12
s_add_u32 s33, s32, 0x8c00000
s_add_u32 s34, s32, 0x6e00000
buffer_store_dwordx4 v[8:11], v1, s[4:7], s34 offen sc1
s_add_u32 s32, s32, 0x8000000
buffer_store_dwordx4 v[8:11], v1, s[4:7], s32 offen sc1
buffer_store_dwordx4 v[8:11], v1, s[4:7], s33 offen sc1
s_lshl_b32 s16, s16, 2
s_add_u32 s16, s16, 0x841f000
s_cmp_lg_u32 s16, 0x841f034
s_cbranch_scc1 main_kernel_s_fd
s_mov_b32 s8, s76
s_and_b32 s9, s77, 0xffff
s_mov_b32 s10, 0x4000
s_mov_b32 s11, 0x20000
v_and_b32 v2, 7, v0
v_lshlrev_b32 v2, 11, v2
v_lshrrev_b32 v3, 6, v0
v_lshl_add_u32 v2, v3, 7, v2
v_bfe_u32 v3, v0, 4, 2
v_lshl_add_u32 v2, v3, 5, v2
v_bfe_u32 v3, v0, 3, 1
v_lshl_add_u32 v2, v3, 4, v2
buffer_load_dwordx4 v[16:19], v2, s[8:11], 0 offen offset:0
buffer_load_dwordx4 v[20:23], v2, s[8:11], 0 offen offset:512
buffer_load_dwordx4 v[24:27], v2, s[8:11], 0 offen offset:1024
buffer_load_dwordx4 v[28:31], v2, s[8:11], 0 offen offset:1536
s_mov_b32 s32, 0x6c30000
s_waitcnt vmcnt(0)
s_cmp_lt_u32 s14, 0
s_cbranch_scc1 main_kernel_s_m0b
v_lshlrev_b32 v2, 16, v16
v_and_b32 v3, 0xffff0000, v16
v_cvt_pk_f16_f32 v16, v2, v3
v_lshlrev_b32 v2, 16, v17
v_and_b32 v3, 0xffff0000, v17
v_cvt_pk_f16_f32 v17, v2, v3
v_lshlrev_b32 v2, 16, v18
v_and_b32 v3, 0xffff0000, v18
v_cvt_pk_f16_f32 v18, v2, v3
v_lshlrev_b32 v2, 16, v19
v_and_b32 v3, 0xffff0000, v19
v_cvt_pk_f16_f32 v19, v2, v3
v_lshlrev_b32 v2, 16, v20
v_and_b32 v3, 0xffff0000, v20
v_cvt_pk_f16_f32 v20, v2, v3
v_lshlrev_b32 v2, 16, v21
v_and_b32 v3, 0xffff0000, v21
v_cvt_pk_f16_f32 v21, v2, v3
v_lshlrev_b32 v2, 16, v22
v_and_b32 v3, 0xffff0000, v22
v_cvt_pk_f16_f32 v22, v2, v3
v_lshlrev_b32 v2, 16, v23
v_and_b32 v3, 0xffff0000, v23
v_cvt_pk_f16_f32 v23, v2, v3
v_lshlrev_b32 v2, 16, v24
v_and_b32 v3, 0xffff0000, v24
v_cvt_pk_f16_f32 v24, v2, v3
v_lshlrev_b32 v2, 16, v25
v_and_b32 v3, 0xffff0000, v25
v_cvt_pk_f16_f32 v25, v2, v3
v_lshlrev_b32 v2, 16, v26
v_and_b32 v3, 0xffff0000, v26
v_cvt_pk_f16_f32 v26, v2, v3
v_lshlrev_b32 v2, 16, v27
v_and_b32 v3, 0xffff0000, v27
v_cvt_pk_f16_f32 v27, v2, v3
v_lshlrev_b32 v2, 16, v28
v_and_b32 v3, 0xffff0000, v28
v_cvt_pk_f16_f32 v28, v2, v3
v_lshlrev_b32 v2, 16, v29
v_and_b32 v3, 0xffff0000, v29
v_cvt_pk_f16_f32 v29, v2, v3
v_lshlrev_b32 v2, 16, v30
v_and_b32 v3, 0xffff0000, v30
v_cvt_pk_f16_f32 v30, v2, v3
v_lshlrev_b32 v2, 16, v31
v_and_b32 v3, 0xffff0000, v31
v_cvt_pk_f16_f32 v31, v2, v3
main_kernel_s_m0b:
v_xor_b32 v2, 0, v1
buffer_store_dwordx4 v[16:19], v1, s[4:7], s32 offen sc1
s_add_u32 s32, s32, 4096
buffer_store_dwordx4 v[20:23], v2, s[4:7], s32 offen sc1
s_add_u32 s32, s32, 4096
buffer_store_dwordx4 v[24:27], v1, s[4:7], s32 offen sc1
s_add_u32 s32, s32, 4096
buffer_store_dwordx4 v[28:31], v2, s[4:7], s32 offen sc1
s_add_u32 s32, s32, 4096
buffer_store_dwordx4 v[4:7], v1, s[4:7], s32 offen sc1
s_add_u32 s32, s32, 4096
buffer_store_dwordx4 v[4:7], v2, s[4:7], s32 offen sc1
s_add_u32 s32, s32, 4096
buffer_store_dwordx4 v[4:7], v1, s[4:7], s32 offen sc1
s_add_u32 s32, s32, 4096
buffer_store_dwordx4 v[4:7], v2, s[4:7], s32 offen sc1
s_add_u32 s32, s32, 4096
buffer_store_dwordx4 v[16:19], v1, s[4:7], s32 offen sc1
s_add_u32 s32, s32, 4096
buffer_store_dwordx4 v[20:23], v2, s[4:7], s32 offen sc1
s_add_u32 s32, s32, 4096
buffer_store_dwordx4 v[24:27], v1, s[4:7], s32 offen sc1
s_add_u32 s32, s32, 4096
buffer_store_dwordx4 v[28:31], v2, s[4:7], s32 offen sc1
s_add_u32 s32, s32, 4096
buffer_store_dwordx4 v[4:7], v1, s[4:7], s32 offen sc1
s_add_u32 s32, s32, 4096
buffer_store_dwordx4 v[4:7], v2, s[4:7], s32 offen sc1
s_add_u32 s32, s32, 4096
buffer_store_dwordx4 v[4:7], v1, s[4:7], s32 offen sc1
s_add_u32 s32, s32, 4096
buffer_store_dwordx4 v[4:7], v2, s[4:7], s32 offen sc1
s_add_u32 s32, s32, 4096
v_mov_b32 v2, 0
main_kernel_s_wa3:
buffer_load_dword v3, v2, s[60:63], 0 offen offset:12 sc1
s_waitcnt vmcnt(0)
v_cmp_gt_u32 vcc, 4, v3
s_cbranch_vccz main_kernel_s_wa3_ok
s_sleep 4
s_sub_u32 s29, s29, 1
s_cbranch_scc0 main_kernel_s_wa3
s_branch main_kernel_end
main_kernel_s_wa3_ok:
v_lshlrev_b32 v2, 7, v250
s_mov_b32 s32, 0x841a000
s_mov_b64 exec, 15
buffer_store_dwordx4 v[8:11], v2, s[4:7], s32 offen sc1
s_mov_b64 exec, -1
main_kernel_s_fd:
s_cmp_lg_u32 s14, 0
s_cbranch_scc1 main_kernel_s_wa2_ok
v_mov_b32 v2, 0
main_kernel_s_wa2:
buffer_load_dword v3, v2, s[60:63], 0 offen offset:12 sc1
s_waitcnt vmcnt(0)
v_cmp_gt_u32 vcc, 4, v3
s_cbranch_vccz main_kernel_s_wa2_ok
s_sleep 4
s_sub_u32 s29, s29, 1
s_cbranch_scc0 main_kernel_s_wa2
s_branch main_kernel_end
main_kernel_s_wa2_ok:
s_waitcnt vmcnt(0)
s_barrier
s_cmp_lg_u32 s14, 0
s_cbranch_scc1 main_kernel_s_end
s_mov_b64 exec, 1
buffer_store_dword v8, v4, s[4:7], s16 offen sc1
s_mov_b64 exec, -1
main_kernel_s_end:
s_lshl_b32 s32, s12, 5
s_add_u32 s32, s32, s13
s_sub_u32 s32, s32, 96
s_cmp_lt_u32 s32, 16
s_cbranch_scc1 main_kernel_att
s_branch main_kernel_worker
main_kernel_end:
s_endpgm
main_kernel_chain:
s_lshr_b32 s15, s13, 1
s_lshl_b32 s32, s12, 4
s_add_u32 s15, s15, s32
s_and_b32 s16, s13, 1
s_lshl_b32 s36, s14, 15
s_add_u32 s36, s36, 32768
v_lshrrev_b32 v126, 3, v94
v_and_b32 v127, 7, v94
v_lshlrev_b32 v126, 13, v126
v_lshl_add_u32 v64, v127, 4, v126
v_lshrrev_b32 v126, 2, v94
v_and_b32 v70, 3, v94
v_lshlrev_b32 v126, 11, v126
v_lshl_add_u32 v65, v70, 4, v126
v_lshrrev_b32 v126, 5, v94
v_lshlrev_b32 v69, 4, v126
v_bfe_u32 v126, v94, 4, 1
v_lshl_add_u32 v69, v126, 2, v69
v_bfe_u32 v126, v94, 2, 1
v_add_u32 v69, v69, v126
v_bfe_u32 v126, v94, 3, 1
v_lshl_add_u32 v69, v126, 3, v69
v_lshl_add_u32 v126, v69, 7, s36
v_lshl_add_u32 v67, v70, 3, v126
v_lshl_add_u32 v126, v69, 6, s36
v_lshl_add_u32 v68, v70, 3, v126
v_lshlrev_b32 v116, 4, v94
v_add_u32 v113, s36, v116
v_lshlrev_b32 v126, 7, v69
v_lshl_add_u32 v41, v70, 3, v126
v_lshl_add_u32 v41, s14, 5, v41
v_and_b32 v127, 1, v70
v_lshl_add_u32 v40, v127, 3, v126
v_lshrrev_b32 v127, 1, v70
v_lshl_add_u32 v40, v127, 5, v40
s_lshr_b32 s32, s14, 1
s_and_b32 s33, s14, 1
v_lshl_add_u32 v40, s32, 6, v40
v_lshl_add_u32 v40, s33, 4, v40
s_xor_b32 s32, s14, 0
s_lshl_b32 s32, s32, 15
s_add_u32 s32, s32, 32768
v_add_u32 v32, s32, v40
v_add_u32 v36, s32, v41
s_xor_b32 s32, s14, 1
s_lshl_b32 s32, s32, 15
s_add_u32 s32, s32, 32768
v_add_u32 v33, s32, v40
v_add_u32 v37, s32, v41
s_xor_b32 s32, s14, 2
s_lshl_b32 s32, s32, 15
s_add_u32 s32, s32, 32768
v_add_u32 v34, s32, v40
v_add_u32 v38, s32, v41
s_xor_b32 s32, s14, 3
s_lshl_b32 s32, s32, 15
s_add_u32 s32, s32, 32768
v_add_u32 v35, s32, v40
v_add_u32 v39, s32, v41
s_lshl_b32 s34, s14, 21
s_lshl_b32 s32, s15, 8
s_add_u32 s34, s34, s32
s_lshl_b32 s32, s16, 7
s_add_u32 s34, s34, s32
s_lshl_b32 s35, s12, 22
s_lshl_b32 s32, s14, 20
s_add_u32 s35, s35, s32
s_lshl_b32 s32, s13, 6
s_add_u32 s35, s35, s32
s_xor_b32 s32, s14, s13
s_and_b32 s32, s32, 3
s_lshl_b32 s32, s32, 19
s_add_u32 s34, s34, s32
s_xor_b32 s32, s14, s13
s_and_b32 s32, s32, 7
s_lshl_b32 s32, s32, 17
s_add_u32 s35, s35, s32
v_bfe_u32 v126, v94, 2, 1
v_lshl_add_u32 v126, s13, 1, v126
v_lshlrev_b32 v126, 13, v126
v_lshl_add_u32 v80, v70, 10, v126
v_and_b32 v126, 7, v94
v_lshl_add_u32 v126, s13, 3, v126
v_lshlrev_b32 v81, 10, v126
v_min_u32 v73, 8, v94
v_lshlrev_b32 v73, 5, v73
v_mov_b32 v126, 12
v_cmp_gt_u32 vcc, 8, v94
v_lshlrev_b32 v74, 2, v94
v_add_u32 v74, 0x841f000, v74
v_cndmask_b32 v73, v126, v73, vcc
v_and_b32 v75, 1, v94
s_lshl_b32 s32, s15, 2
s_add_u32 s32, s32, 0x8406000
v_lshl_add_u32 v75, v75, 13, s32
s_mov_b32 s8, s42
s_and_b32 s9, s43, 0xffff
s_mov_b32 s10, 0x800000
s_mov_b32 s11, 0x20000
s_sub_u32 s39, 511, s42
s_and_b32 s39, s39, 0x380
s_lshr_b32 s33, s39, 7
s_xor_b32 s33, s14, s33
s_and_b32 s33, s33, 3
s_lshl_b32 s33, s33, 19
s_add_u32 s39, s39, s33
s_andn2_b32 s32, s34, 0x180fff
s_add_u32 s39, s39, s32
s_xor_b32 s32, s39, 0x0
buffer_load_dword v82, v80, s[8:11], s32 offen
s_xor_b32 s32, s34, 0x0
s_add_u32 m0, s36, 0
s_nop 0
buffer_load_dwordx4 v64, s[8:11], s32 offen lds
s_xor_b32 s32, s34, 0x10000
s_add_u32 m0, s36, 1024
s_nop 0
buffer_load_dwordx4 v64, s[8:11], s32 offen lds
s_xor_b32 s32, s34, 0x20000
s_add_u32 m0, s36, 2048
s_nop 0
buffer_load_dwordx4 v64, s[8:11], s32 offen lds
s_xor_b32 s32, s34, 0x30000
s_add_u32 m0, s36, 3072
s_nop 0
buffer_load_dwordx4 v64, s[8:11], s32 offen lds
s_xor_b32 s32, s34, 0x40000
s_add_u32 m0, s36, 4096
s_nop 0
buffer_load_dwordx4 v64, s[8:11], s32 offen lds
s_xor_b32 s32, s34, 0x50000
s_add_u32 m0, s36, 5120
s_nop 0
buffer_load_dwordx4 v64, s[8:11], s32 offen lds
s_xor_b32 s32, s34, 0x60000
s_add_u32 m0, s36, 6144
s_nop 0
buffer_load_dwordx4 v64, s[8:11], s32 offen lds
s_xor_b32 s32, s34, 0x70000
s_add_u32 m0, s36, 7168
s_nop 0
buffer_load_dwordx4 v64, s[8:11], s32 offen lds
s_xor_b32 s32, s39, 0x80000
buffer_load_dword v82, v80, s[8:11], s32 offen
s_xor_b32 s32, s34, 0x80000
s_add_u32 m0, s36, 8192
s_nop 0
buffer_load_dwordx4 v64, s[8:11], s32 offen lds
s_xor_b32 s32, s34, 0x90000
s_add_u32 m0, s36, 9216
s_nop 0
buffer_load_dwordx4 v64, s[8:11], s32 offen lds
s_xor_b32 s32, s34, 0xa0000
s_add_u32 m0, s36, 10240
s_nop 0
buffer_load_dwordx4 v64, s[8:11], s32 offen lds
s_xor_b32 s32, s34, 0xb0000
s_add_u32 m0, s36, 11264
s_nop 0
buffer_load_dwordx4 v64, s[8:11], s32 offen lds
s_xor_b32 s32, s34, 0xc0000
s_add_u32 m0, s36, 12288
s_nop 0
buffer_load_dwordx4 v64, s[8:11], s32 offen lds
s_xor_b32 s32, s34, 0xd0000
s_add_u32 m0, s36, 13312
s_nop 0
buffer_load_dwordx4 v64, s[8:11], s32 offen lds
s_xor_b32 s32, s34, 0xe0000
s_add_u32 m0, s36, 14336
s_nop 0
buffer_load_dwordx4 v64, s[8:11], s32 offen lds
s_xor_b32 s32, s34, 0xf0000
s_add_u32 m0, s36, 15360
s_nop 0
buffer_load_dwordx4 v64, s[8:11], s32 offen lds
s_xor_b32 s32, s39, 0x100000
buffer_load_dword v82, v80, s[8:11], s32 offen
s_xor_b32 s32, s34, 0x100000
s_add_u32 m0, s36, 16384
s_nop 0
buffer_load_dwordx4 v64, s[8:11], s32 offen lds
s_xor_b32 s32, s34, 0x110000
s_add_u32 m0, s36, 17408
s_nop 0
buffer_load_dwordx4 v64, s[8:11], s32 offen lds
s_xor_b32 s32, s34, 0x120000
s_add_u32 m0, s36, 18432
s_nop 0
buffer_load_dwordx4 v64, s[8:11], s32 offen lds
s_xor_b32 s32, s34, 0x130000
s_add_u32 m0, s36, 19456
s_nop 0
buffer_load_dwordx4 v64, s[8:11], s32 offen lds
s_xor_b32 s32, s34, 0x140000
s_add_u32 m0, s36, 20480
s_nop 0
buffer_load_dwordx4 v64, s[8:11], s32 offen lds
s_xor_b32 s32, s34, 0x150000
s_add_u32 m0, s36, 21504
s_nop 0
buffer_load_dwordx4 v64, s[8:11], s32 offen lds
s_xor_b32 s32, s34, 0x160000
s_add_u32 m0, s36, 22528
s_nop 0
buffer_load_dwordx4 v64, s[8:11], s32 offen lds
s_xor_b32 s32, s34, 0x170000
s_add_u32 m0, s36, 23552
s_nop 0
buffer_load_dwordx4 v64, s[8:11], s32 offen lds
s_xor_b32 s32, s39, 0x180000
buffer_load_dword v82, v80, s[8:11], s32 offen
s_xor_b32 s32, s34, 0x180000
s_add_u32 m0, s36, 24576
s_nop 0
buffer_load_dwordx4 v64, s[8:11], s32 offen lds
s_xor_b32 s32, s34, 0x190000
s_add_u32 m0, s36, 25600
s_nop 0
buffer_load_dwordx4 v64, s[8:11], s32 offen lds
s_xor_b32 s32, s34, 0x1a0000
s_add_u32 m0, s36, 26624
s_nop 0
buffer_load_dwordx4 v64, s[8:11], s32 offen lds
s_xor_b32 s32, s34, 0x1b0000
s_add_u32 m0, s36, 27648
s_nop 0
buffer_load_dwordx4 v64, s[8:11], s32 offen lds
s_xor_b32 s32, s34, 0x1c0000
s_add_u32 m0, s36, 28672
s_nop 0
buffer_load_dwordx4 v64, s[8:11], s32 offen lds
s_xor_b32 s32, s34, 0x1d0000
s_add_u32 m0, s36, 29696
s_nop 0
buffer_load_dwordx4 v64, s[8:11], s32 offen lds
s_xor_b32 s32, s34, 0x1e0000
s_add_u32 m0, s36, 30720
s_nop 0
buffer_load_dwordx4 v64, s[8:11], s32 offen lds
s_xor_b32 s32, s34, 0x1f0000
s_add_u32 m0, s36, 31744
s_nop 0
buffer_load_dwordx4 v64, s[8:11], s32 offen lds
s_waitcnt vmcnt(27)
s_barrier
ds_read_b64_tr_b16 v[0:1], v32 offset:0
ds_read_b64_tr_b16 v[2:3], v32 offset:256
ds_read_b64_tr_b16 v[4:5], v32 offset:4096
ds_read_b64_tr_b16 v[6:7], v32 offset:4352
ds_read_b64_tr_b16 v[8:9], v33 offset:0
ds_read_b64_tr_b16 v[10:11], v33 offset:256
ds_read_b64_tr_b16 v[12:13], v33 offset:4096
ds_read_b64_tr_b16 v[14:15], v33 offset:4352
ds_read_b64_tr_b16 v[16:17], v34 offset:0
ds_read_b64_tr_b16 v[18:19], v34 offset:256
ds_read_b64_tr_b16 v[20:21], v34 offset:4096
ds_read_b64_tr_b16 v[22:23], v34 offset:4352
ds_read_b64_tr_b16 v[24:25], v35 offset:0
ds_read_b64_tr_b16 v[26:27], v35 offset:256
ds_read_b64_tr_b16 v[28:29], v35 offset:4096
ds_read_b64_tr_b16 v[30:31], v35 offset:4352
s_waitcnt lgkmcnt(0)
s_barrier
s_mov_b32 s8, s44
s_and_b32 s9, s45, 0xffff
s_mov_b32 s10, 0x800000
s_mov_b32 s11, 0x20000
s_sub_u32 s39, 511, s44
s_and_b32 s39, s39, 0x380
s_lshr_b32 s33, s39, 7
s_xor_b32 s33, s14, s33
s_and_b32 s33, s33, 3
s_lshl_b32 s33, s33, 19
s_add_u32 s39, s39, s33
s_andn2_b32 s32, s34, 0x180fff
s_add_u32 s39, s39, s32
s_xor_b32 s32, s39, 0x0
buffer_load_dword v82, v80, s[8:11], s32 offen
s_xor_b32 s32, s34, 0x0
s_add_u32 m0, s36, 0
s_nop 0
buffer_load_dwordx4 v64, s[8:11], s32 offen lds
s_xor_b32 s32, s34, 0x10000
s_add_u32 m0, s36, 1024
s_nop 0
buffer_load_dwordx4 v64, s[8:11], s32 offen lds
s_xor_b32 s32, s34, 0x20000
s_add_u32 m0, s36, 2048
s_nop 0
buffer_load_dwordx4 v64, s[8:11], s32 offen lds
s_xor_b32 s32, s34, 0x30000
s_add_u32 m0, s36, 3072
s_nop 0
buffer_load_dwordx4 v64, s[8:11], s32 offen lds
s_xor_b32 s32, s34, 0x40000
s_add_u32 m0, s36, 4096
s_nop 0
buffer_load_dwordx4 v64, s[8:11], s32 offen lds
s_xor_b32 s32, s34, 0x50000
s_add_u32 m0, s36, 5120
s_nop 0
buffer_load_dwordx4 v64, s[8:11], s32 offen lds
s_xor_b32 s32, s34, 0x60000
s_add_u32 m0, s36, 6144
s_nop 0
buffer_load_dwordx4 v64, s[8:11], s32 offen lds
s_xor_b32 s32, s34, 0x70000
s_add_u32 m0, s36, 7168
s_nop 0
buffer_load_dwordx4 v64, s[8:11], s32 offen lds
v_lshlrev_b32 v42, 16, v0
v_and_b32 v43, 0xffff0000, v0
v_cvt_pk_f16_f32 v0, v42, v43
v_lshlrev_b32 v44, 16, v1
v_and_b32 v45, 0xffff0000, v1
v_cvt_pk_f16_f32 v1, v44, v45
v_lshlrev_b32 v42, 16, v2
v_and_b32 v43, 0xffff0000, v2
v_cvt_pk_f16_f32 v2, v42, v43
v_lshlrev_b32 v44, 16, v3
v_and_b32 v45, 0xffff0000, v3
v_cvt_pk_f16_f32 v3, v44, v45
v_lshlrev_b32 v42, 16, v4
v_and_b32 v43, 0xffff0000, v4
v_cvt_pk_f16_f32 v4, v42, v43
v_lshlrev_b32 v44, 16, v5
v_and_b32 v45, 0xffff0000, v5
v_cvt_pk_f16_f32 v5, v44, v45
v_lshlrev_b32 v42, 16, v6
v_and_b32 v43, 0xffff0000, v6
v_cvt_pk_f16_f32 v6, v42, v43
v_lshlrev_b32 v44, 16, v7
v_and_b32 v45, 0xffff0000, v7
v_cvt_pk_f16_f32 v7, v44, v45
v_accvgpr_write_b32 a128, v0
v_accvgpr_write_b32 a129, v1
v_accvgpr_write_b32 a130, v2
v_accvgpr_write_b32 a131, v3
v_accvgpr_write_b32 a132, v4
v_accvgpr_write_b32 a133, v5
v_accvgpr_write_b32 a134, v6
v_accvgpr_write_b32 a135, v7
v_lshlrev_b32 v42, 16, v8
v_and_b32 v43, 0xffff0000, v8
v_cvt_pk_f16_f32 v8, v42, v43
v_lshlrev_b32 v44, 16, v9
v_and_b32 v45, 0xffff0000, v9
v_cvt_pk_f16_f32 v9, v44, v45
v_lshlrev_b32 v42, 16, v10
v_and_b32 v43, 0xffff0000, v10
v_cvt_pk_f16_f32 v10, v42, v43
v_lshlrev_b32 v44, 16, v11
v_and_b32 v45, 0xffff0000, v11
v_cvt_pk_f16_f32 v11, v44, v45
v_lshlrev_b32 v42, 16, v12
v_and_b32 v43, 0xffff0000, v12
v_cvt_pk_f16_f32 v12, v42, v43
v_lshlrev_b32 v44, 16, v13
v_and_b32 v45, 0xffff0000, v13
v_cvt_pk_f16_f32 v13, v44, v45
v_lshlrev_b32 v42, 16, v14
v_and_b32 v43, 0xffff0000, v14
v_cvt_pk_f16_f32 v14, v42, v43
v_lshlrev_b32 v44, 16, v15
v_and_b32 v45, 0xffff0000, v15
v_cvt_pk_f16_f32 v15, v44, v45
v_accvgpr_write_b32 a160, v8
v_accvgpr_write_b32 a161, v9
v_accvgpr_write_b32 a162, v10
v_accvgpr_write_b32 a163, v11
v_accvgpr_write_b32 a164, v12
v_accvgpr_write_b32 a165, v13
v_accvgpr_write_b32 a166, v14
v_accvgpr_write_b32 a167, v15
v_lshlrev_b32 v42, 16, v16
v_and_b32 v43, 0xffff0000, v16
v_cvt_pk_f16_f32 v16, v42, v43
v_lshlrev_b32 v44, 16, v17
v_and_b32 v45, 0xffff0000, v17
v_cvt_pk_f16_f32 v17, v44, v45
v_lshlrev_b32 v42, 16, v18
v_and_b32 v43, 0xffff0000, v18
v_cvt_pk_f16_f32 v18, v42, v43
v_lshlrev_b32 v44, 16, v19
v_and_b32 v45, 0xffff0000, v19
v_cvt_pk_f16_f32 v19, v44, v45
v_lshlrev_b32 v42, 16, v20
v_and_b32 v43, 0xffff0000, v20
v_cvt_pk_f16_f32 v20, v42, v43
v_lshlrev_b32 v44, 16, v21
v_and_b32 v45, 0xffff0000, v21
v_cvt_pk_f16_f32 v21, v44, v45
v_lshlrev_b32 v42, 16, v22
v_and_b32 v43, 0xffff0000, v22
v_cvt_pk_f16_f32 v22, v42, v43
v_lshlrev_b32 v44, 16, v23
v_and_b32 v45, 0xffff0000, v23
v_cvt_pk_f16_f32 v23, v44, v45
v_accvgpr_write_b32 a192, v16
v_accvgpr_write_b32 a193, v17
v_accvgpr_write_b32 a194, v18
v_accvgpr_write_b32 a195, v19
v_accvgpr_write_b32 a196, v20
v_accvgpr_write_b32 a197, v21
v_accvgpr_write_b32 a198, v22
v_accvgpr_write_b32 a199, v23
v_lshlrev_b32 v42, 16, v24
v_and_b32 v43, 0xffff0000, v24
v_cvt_pk_f16_f32 v24, v42, v43
v_lshlrev_b32 v44, 16, v25
v_and_b32 v45, 0xffff0000, v25
v_cvt_pk_f16_f32 v25, v44, v45
v_lshlrev_b32 v42, 16, v26
v_and_b32 v43, 0xffff0000, v26
v_cvt_pk_f16_f32 v26, v42, v43
v_lshlrev_b32 v44, 16, v27
v_and_b32 v45, 0xffff0000, v27
v_cvt_pk_f16_f32 v27, v44, v45
v_lshlrev_b32 v42, 16, v28
v_and_b32 v43, 0xffff0000, v28
v_cvt_pk_f16_f32 v28, v42, v43
v_lshlrev_b32 v44, 16, v29
v_and_b32 v45, 0xffff0000, v29
v_cvt_pk_f16_f32 v29, v44, v45
v_lshlrev_b32 v42, 16, v30
v_and_b32 v43, 0xffff0000, v30
v_cvt_pk_f16_f32 v30, v42, v43
v_lshlrev_b32 v44, 16, v31
v_and_b32 v45, 0xffff0000, v31
v_cvt_pk_f16_f32 v31, v44, v45
v_accvgpr_write_b32 a224, v24
v_accvgpr_write_b32 a225, v25
v_accvgpr_write_b32 a226, v26
v_accvgpr_write_b32 a227, v27
v_accvgpr_write_b32 a228, v28
v_accvgpr_write_b32 a229, v29
v_accvgpr_write_b32 a230, v30
v_accvgpr_write_b32 a231, v31
s_waitcnt vmcnt(27)
s_barrier
ds_read_b64_tr_b16 v[0:1], v32 offset:8192
ds_read_b64_tr_b16 v[2:3], v32 offset:8448
ds_read_b64_tr_b16 v[4:5], v32 offset:12288
ds_read_b64_tr_b16 v[6:7], v32 offset:12544
ds_read_b64_tr_b16 v[8:9], v33 offset:8192
ds_read_b64_tr_b16 v[10:11], v33 offset:8448
ds_read_b64_tr_b16 v[12:13], v33 offset:12288
ds_read_b64_tr_b16 v[14:15], v33 offset:12544
ds_read_b64_tr_b16 v[16:17], v34 offset:8192
ds_read_b64_tr_b16 v[18:19], v34 offset:8448
ds_read_b64_tr_b16 v[20:21], v34 offset:12288
ds_read_b64_tr_b16 v[22:23], v34 offset:12544
ds_read_b64_tr_b16 v[24:25], v35 offset:8192
ds_read_b64_tr_b16 v[26:27], v35 offset:8448
ds_read_b64_tr_b16 v[28:29], v35 offset:12288
ds_read_b64_tr_b16 v[30:31], v35 offset:12544
s_waitcnt lgkmcnt(0)
s_barrier
s_xor_b32 s32, s39, 0x80000
buffer_load_dword v82, v80, s[8:11], s32 offen
s_xor_b32 s32, s34, 0x80000
s_add_u32 m0, s36, 8192
s_nop 0
buffer_load_dwordx4 v64, s[8:11], s32 offen lds
s_xor_b32 s32, s34, 0x90000
s_add_u32 m0, s36, 9216
s_nop 0
buffer_load_dwordx4 v64, s[8:11], s32 offen lds
s_xor_b32 s32, s34, 0xa0000
s_add_u32 m0, s36, 10240
s_nop 0
buffer_load_dwordx4 v64, s[8:11], s32 offen lds
s_xor_b32 s32, s34, 0xb0000
s_add_u32 m0, s36, 11264
s_nop 0
buffer_load_dwordx4 v64, s[8:11], s32 offen lds
s_xor_b32 s32, s34, 0xc0000
s_add_u32 m0, s36, 12288
s_nop 0
buffer_load_dwordx4 v64, s[8:11], s32 offen lds
s_xor_b32 s32, s34, 0xd0000
s_add_u32 m0, s36, 13312
s_nop 0
buffer_load_dwordx4 v64, s[8:11], s32 offen lds
s_xor_b32 s32, s34, 0xe0000
s_add_u32 m0, s36, 14336
s_nop 0
buffer_load_dwordx4 v64, s[8:11], s32 offen lds
s_xor_b32 s32, s34, 0xf0000
s_add_u32 m0, s36, 15360
s_nop 0
buffer_load_dwordx4 v64, s[8:11], s32 offen lds
v_lshlrev_b32 v42, 16, v0
v_and_b32 v43, 0xffff0000, v0
v_cvt_pk_f16_f32 v0, v42, v43
v_lshlrev_b32 v44, 16, v1
v_and_b32 v45, 0xffff0000, v1
v_cvt_pk_f16_f32 v1, v44, v45
v_lshlrev_b32 v42, 16, v2
v_and_b32 v43, 0xffff0000, v2
v_cvt_pk_f16_f32 v2, v42, v43
v_lshlrev_b32 v44, 16, v3
v_and_b32 v45, 0xffff0000, v3
v_cvt_pk_f16_f32 v3, v44, v45
v_lshlrev_b32 v42, 16, v4
v_and_b32 v43, 0xffff0000, v4
v_cvt_pk_f16_f32 v4, v42, v43
v_lshlrev_b32 v44, 16, v5
v_and_b32 v45, 0xffff0000, v5
v_cvt_pk_f16_f32 v5, v44, v45
v_lshlrev_b32 v42, 16, v6
v_and_b32 v43, 0xffff0000, v6
v_cvt_pk_f16_f32 v6, v42, v43
v_lshlrev_b32 v44, 16, v7
v_and_b32 v45, 0xffff0000, v7
v_cvt_pk_f16_f32 v7, v44, v45
v_accvgpr_write_b32 a136, v0
v_accvgpr_write_b32 a137, v1
v_accvgpr_write_b32 a138, v2
v_accvgpr_write_b32 a139, v3
v_accvgpr_write_b32 a140, v4
v_accvgpr_write_b32 a141, v5
v_accvgpr_write_b32 a142, v6
v_accvgpr_write_b32 a143, v7
v_lshlrev_b32 v42, 16, v8
v_and_b32 v43, 0xffff0000, v8
v_cvt_pk_f16_f32 v8, v42, v43
v_lshlrev_b32 v44, 16, v9
v_and_b32 v45, 0xffff0000, v9
v_cvt_pk_f16_f32 v9, v44, v45
v_lshlrev_b32 v42, 16, v10
v_and_b32 v43, 0xffff0000, v10
v_cvt_pk_f16_f32 v10, v42, v43
v_lshlrev_b32 v44, 16, v11
v_and_b32 v45, 0xffff0000, v11
v_cvt_pk_f16_f32 v11, v44, v45
v_lshlrev_b32 v42, 16, v12
v_and_b32 v43, 0xffff0000, v12
v_cvt_pk_f16_f32 v12, v42, v43
v_lshlrev_b32 v44, 16, v13
v_and_b32 v45, 0xffff0000, v13
v_cvt_pk_f16_f32 v13, v44, v45
v_lshlrev_b32 v42, 16, v14
v_and_b32 v43, 0xffff0000, v14
v_cvt_pk_f16_f32 v14, v42, v43
v_lshlrev_b32 v44, 16, v15
v_and_b32 v45, 0xffff0000, v15
v_cvt_pk_f16_f32 v15, v44, v45
v_accvgpr_write_b32 a168, v8
v_accvgpr_write_b32 a169, v9
v_accvgpr_write_b32 a170, v10
v_accvgpr_write_b32 a171, v11
v_accvgpr_write_b32 a172, v12
v_accvgpr_write_b32 a173, v13
v_accvgpr_write_b32 a174, v14
v_accvgpr_write_b32 a175, v15
v_lshlrev_b32 v42, 16, v16
v_and_b32 v43, 0xffff0000, v16
v_cvt_pk_f16_f32 v16, v42, v43
v_lshlrev_b32 v44, 16, v17
v_and_b32 v45, 0xffff0000, v17
v_cvt_pk_f16_f32 v17, v44, v45
v_lshlrev_b32 v42, 16, v18
v_and_b32 v43, 0xffff0000, v18
v_cvt_pk_f16_f32 v18, v42, v43
v_lshlrev_b32 v44, 16, v19
v_and_b32 v45, 0xffff0000, v19
v_cvt_pk_f16_f32 v19, v44, v45
v_lshlrev_b32 v42, 16, v20
v_and_b32 v43, 0xffff0000, v20
v_cvt_pk_f16_f32 v20, v42, v43
v_lshlrev_b32 v44, 16, v21
v_and_b32 v45, 0xffff0000, v21
v_cvt_pk_f16_f32 v21, v44, v45
v_lshlrev_b32 v42, 16, v22
v_and_b32 v43, 0xffff0000, v22
v_cvt_pk_f16_f32 v22, v42, v43
v_lshlrev_b32 v44, 16, v23
v_and_b32 v45, 0xffff0000, v23
v_cvt_pk_f16_f32 v23, v44, v45
v_accvgpr_write_b32 a200, v16
v_accvgpr_write_b32 a201, v17
v_accvgpr_write_b32 a202, v18
v_accvgpr_write_b32 a203, v19
v_accvgpr_write_b32 a204, v20
v_accvgpr_write_b32 a205, v21
v_accvgpr_write_b32 a206, v22
v_accvgpr_write_b32 a207, v23
v_lshlrev_b32 v42, 16, v24
v_and_b32 v43, 0xffff0000, v24
v_cvt_pk_f16_f32 v24, v42, v43
v_lshlrev_b32 v44, 16, v25
v_and_b32 v45, 0xffff0000, v25
v_cvt_pk_f16_f32 v25, v44, v45
v_lshlrev_b32 v42, 16, v26
v_and_b32 v43, 0xffff0000, v26
v_cvt_pk_f16_f32 v26, v42, v43
v_lshlrev_b32 v44, 16, v27
v_and_b32 v45, 0xffff0000, v27
v_cvt_pk_f16_f32 v27, v44, v45
v_lshlrev_b32 v42, 16, v28
v_and_b32 v43, 0xffff0000, v28
v_cvt_pk_f16_f32 v28, v42, v43
v_lshlrev_b32 v44, 16, v29
v_and_b32 v45, 0xffff0000, v29
v_cvt_pk_f16_f32 v29, v44, v45
v_lshlrev_b32 v42, 16, v30
v_and_b32 v43, 0xffff0000, v30
v_cvt_pk_f16_f32 v30, v42, v43
v_lshlrev_b32 v44, 16, v31
v_and_b32 v45, 0xffff0000, v31
v_cvt_pk_f16_f32 v31, v44, v45
v_accvgpr_write_b32 a232, v24
v_accvgpr_write_b32 a233, v25
v_accvgpr_write_b32 a234, v26
v_accvgpr_write_b32 a235, v27
v_accvgpr_write_b32 a236, v28
v_accvgpr_write_b32 a237, v29
v_accvgpr_write_b32 a238, v30
v_accvgpr_write_b32 a239, v31
s_waitcnt vmcnt(27)
s_barrier
ds_read_b64_tr_b16 v[0:1], v32 offset:16384
ds_read_b64_tr_b16 v[2:3], v32 offset:16640
ds_read_b64_tr_b16 v[4:5], v32 offset:20480
ds_read_b64_tr_b16 v[6:7], v32 offset:20736
ds_read_b64_tr_b16 v[8:9], v33 offset:16384
ds_read_b64_tr_b16 v[10:11], v33 offset:16640
ds_read_b64_tr_b16 v[12:13], v33 offset:20480
ds_read_b64_tr_b16 v[14:15], v33 offset:20736
ds_read_b64_tr_b16 v[16:17], v34 offset:16384
ds_read_b64_tr_b16 v[18:19], v34 offset:16640
ds_read_b64_tr_b16 v[20:21], v34 offset:20480
ds_read_b64_tr_b16 v[22:23], v34 offset:20736
ds_read_b64_tr_b16 v[24:25], v35 offset:16384
ds_read_b64_tr_b16 v[26:27], v35 offset:16640
ds_read_b64_tr_b16 v[28:29], v35 offset:20480
ds_read_b64_tr_b16 v[30:31], v35 offset:20736
s_waitcnt lgkmcnt(0)
s_barrier
s_xor_b32 s32, s39, 0x100000
buffer_load_dword v82, v80, s[8:11], s32 offen
s_xor_b32 s32, s34, 0x100000
s_add_u32 m0, s36, 16384
s_nop 0
buffer_load_dwordx4 v64, s[8:11], s32 offen lds
s_xor_b32 s32, s34, 0x110000
s_add_u32 m0, s36, 17408
s_nop 0
buffer_load_dwordx4 v64, s[8:11], s32 offen lds
s_xor_b32 s32, s34, 0x120000
s_add_u32 m0, s36, 18432
s_nop 0
buffer_load_dwordx4 v64, s[8:11], s32 offen lds
s_xor_b32 s32, s34, 0x130000
s_add_u32 m0, s36, 19456
s_nop 0
buffer_load_dwordx4 v64, s[8:11], s32 offen lds
s_xor_b32 s32, s34, 0x140000
s_add_u32 m0, s36, 20480
s_nop 0
buffer_load_dwordx4 v64, s[8:11], s32 offen lds
s_xor_b32 s32, s34, 0x150000
s_add_u32 m0, s36, 21504
s_nop 0
buffer_load_dwordx4 v64, s[8:11], s32 offen lds
s_xor_b32 s32, s34, 0x160000
s_add_u32 m0, s36, 22528
s_nop 0
buffer_load_dwordx4 v64, s[8:11], s32 offen lds
s_xor_b32 s32, s34, 0x170000
s_add_u32 m0, s36, 23552
s_nop 0
buffer_load_dwordx4 v64, s[8:11], s32 offen lds
v_lshlrev_b32 v42, 16, v0
v_and_b32 v43, 0xffff0000, v0
v_cvt_pk_f16_f32 v0, v42, v43
v_lshlrev_b32 v44, 16, v1
v_and_b32 v45, 0xffff0000, v1
v_cvt_pk_f16_f32 v1, v44, v45
v_lshlrev_b32 v42, 16, v2
v_and_b32 v43, 0xffff0000, v2
v_cvt_pk_f16_f32 v2, v42, v43
v_lshlrev_b32 v44, 16, v3
v_and_b32 v45, 0xffff0000, v3
v_cvt_pk_f16_f32 v3, v44, v45
v_lshlrev_b32 v42, 16, v4
v_and_b32 v43, 0xffff0000, v4
v_cvt_pk_f16_f32 v4, v42, v43
v_lshlrev_b32 v44, 16, v5
v_and_b32 v45, 0xffff0000, v5
v_cvt_pk_f16_f32 v5, v44, v45
v_lshlrev_b32 v42, 16, v6
v_and_b32 v43, 0xffff0000, v6
v_cvt_pk_f16_f32 v6, v42, v43
v_lshlrev_b32 v44, 16, v7
v_and_b32 v45, 0xffff0000, v7
v_cvt_pk_f16_f32 v7, v44, v45
v_accvgpr_write_b32 a144, v0
v_accvgpr_write_b32 a145, v1
v_accvgpr_write_b32 a146, v2
v_accvgpr_write_b32 a147, v3
v_accvgpr_write_b32 a148, v4
v_accvgpr_write_b32 a149, v5
v_accvgpr_write_b32 a150, v6
v_accvgpr_write_b32 a151, v7
v_lshlrev_b32 v42, 16, v8
v_and_b32 v43, 0xffff0000, v8
v_cvt_pk_f16_f32 v8, v42, v43
v_lshlrev_b32 v44, 16, v9
v_and_b32 v45, 0xffff0000, v9
v_cvt_pk_f16_f32 v9, v44, v45
v_lshlrev_b32 v42, 16, v10
v_and_b32 v43, 0xffff0000, v10
v_cvt_pk_f16_f32 v10, v42, v43
v_lshlrev_b32 v44, 16, v11
v_and_b32 v45, 0xffff0000, v11
v_cvt_pk_f16_f32 v11, v44, v45
v_lshlrev_b32 v42, 16, v12
v_and_b32 v43, 0xffff0000, v12
v_cvt_pk_f16_f32 v12, v42, v43
v_lshlrev_b32 v44, 16, v13
v_and_b32 v45, 0xffff0000, v13
v_cvt_pk_f16_f32 v13, v44, v45
v_lshlrev_b32 v42, 16, v14
v_and_b32 v43, 0xffff0000, v14
v_cvt_pk_f16_f32 v14, v42, v43
v_lshlrev_b32 v44, 16, v15
v_and_b32 v45, 0xffff0000, v15
v_cvt_pk_f16_f32 v15, v44, v45
v_accvgpr_write_b32 a176, v8
v_accvgpr_write_b32 a177, v9
v_accvgpr_write_b32 a178, v10
v_accvgpr_write_b32 a179, v11
v_accvgpr_write_b32 a180, v12
v_accvgpr_write_b32 a181, v13
v_accvgpr_write_b32 a182, v14
v_accvgpr_write_b32 a183, v15
v_lshlrev_b32 v42, 16, v16
v_and_b32 v43, 0xffff0000, v16
v_cvt_pk_f16_f32 v16, v42, v43
v_lshlrev_b32 v44, 16, v17
v_and_b32 v45, 0xffff0000, v17
v_cvt_pk_f16_f32 v17, v44, v45
v_lshlrev_b32 v42, 16, v18
v_and_b32 v43, 0xffff0000, v18
v_cvt_pk_f16_f32 v18, v42, v43
v_lshlrev_b32 v44, 16, v19
v_and_b32 v45, 0xffff0000, v19
v_cvt_pk_f16_f32 v19, v44, v45
v_lshlrev_b32 v42, 16, v20
v_and_b32 v43, 0xffff0000, v20
v_cvt_pk_f16_f32 v20, v42, v43
v_lshlrev_b32 v44, 16, v21
v_and_b32 v45, 0xffff0000, v21
v_cvt_pk_f16_f32 v21, v44, v45
v_lshlrev_b32 v42, 16, v22
v_and_b32 v43, 0xffff0000, v22
v_cvt_pk_f16_f32 v22, v42, v43
v_lshlrev_b32 v44, 16, v23
v_and_b32 v45, 0xffff0000, v23
v_cvt_pk_f16_f32 v23, v44, v45
v_accvgpr_write_b32 a208, v16
v_accvgpr_write_b32 a209, v17
v_accvgpr_write_b32 a210, v18
v_accvgpr_write_b32 a211, v19
v_accvgpr_write_b32 a212, v20
v_accvgpr_write_b32 a213, v21
v_accvgpr_write_b32 a214, v22
v_accvgpr_write_b32 a215, v23
v_lshlrev_b32 v42, 16, v24
v_and_b32 v43, 0xffff0000, v24
v_cvt_pk_f16_f32 v24, v42, v43
v_lshlrev_b32 v44, 16, v25
v_and_b32 v45, 0xffff0000, v25
v_cvt_pk_f16_f32 v25, v44, v45
v_lshlrev_b32 v42, 16, v26
v_and_b32 v43, 0xffff0000, v26
v_cvt_pk_f16_f32 v26, v42, v43
v_lshlrev_b32 v44, 16, v27
v_and_b32 v45, 0xffff0000, v27
v_cvt_pk_f16_f32 v27, v44, v45
v_lshlrev_b32 v42, 16, v28
v_and_b32 v43, 0xffff0000, v28
v_cvt_pk_f16_f32 v28, v42, v43
v_lshlrev_b32 v44, 16, v29
v_and_b32 v45, 0xffff0000, v29
v_cvt_pk_f16_f32 v29, v44, v45
v_lshlrev_b32 v42, 16, v30
v_and_b32 v43, 0xffff0000, v30
v_cvt_pk_f16_f32 v30, v42, v43
v_lshlrev_b32 v44, 16, v31
v_and_b32 v45, 0xffff0000, v31
v_cvt_pk_f16_f32 v31, v44, v45
v_accvgpr_write_b32 a240, v24
v_accvgpr_write_b32 a241, v25
v_accvgpr_write_b32 a242, v26
v_accvgpr_write_b32 a243, v27
v_accvgpr_write_b32 a244, v28
v_accvgpr_write_b32 a245, v29
v_accvgpr_write_b32 a246, v30
v_accvgpr_write_b32 a247, v31
s_waitcnt vmcnt(27)
s_barrier
ds_read_b64_tr_b16 v[0:1], v32 offset:24576
ds_read_b64_tr_b16 v[2:3], v32 offset:24832
ds_read_b64_tr_b16 v[4:5], v32 offset:28672
ds_read_b64_tr_b16 v[6:7], v32 offset:28928
ds_read_b64_tr_b16 v[8:9], v33 offset:24576
ds_read_b64_tr_b16 v[10:11], v33 offset:24832
ds_read_b64_tr_b16 v[12:13], v33 offset:28672
ds_read_b64_tr_b16 v[14:15], v33 offset:28928
ds_read_b64_tr_b16 v[16:17], v34 offset:24576
ds_read_b64_tr_b16 v[18:19], v34 offset:24832
ds_read_b64_tr_b16 v[20:21], v34 offset:28672
ds_read_b64_tr_b16 v[22:23], v34 offset:28928
ds_read_b64_tr_b16 v[24:25], v35 offset:24576
ds_read_b64_tr_b16 v[26:27], v35 offset:24832
ds_read_b64_tr_b16 v[28:29], v35 offset:28672
ds_read_b64_tr_b16 v[30:31], v35 offset:28928
s_waitcnt lgkmcnt(0)
s_barrier
s_xor_b32 s32, s39, 0x180000
buffer_load_dword v82, v80, s[8:11], s32 offen
s_xor_b32 s32, s34, 0x180000
s_add_u32 m0, s36, 24576
s_nop 0
buffer_load_dwordx4 v64, s[8:11], s32 offen lds
s_xor_b32 s32, s34, 0x190000
s_add_u32 m0, s36, 25600
s_nop 0
buffer_load_dwordx4 v64, s[8:11], s32 offen lds
s_xor_b32 s32, s34, 0x1a0000
s_add_u32 m0, s36, 26624
s_nop 0
buffer_load_dwordx4 v64, s[8:11], s32 offen lds
s_xor_b32 s32, s34, 0x1b0000
s_add_u32 m0, s36, 27648
s_nop 0
buffer_load_dwordx4 v64, s[8:11], s32 offen lds
s_xor_b32 s32, s34, 0x1c0000
s_add_u32 m0, s36, 28672
s_nop 0
buffer_load_dwordx4 v64, s[8:11], s32 offen lds
s_xor_b32 s32, s34, 0x1d0000
s_add_u32 m0, s36, 29696
s_nop 0
buffer_load_dwordx4 v64, s[8:11], s32 offen lds
s_xor_b32 s32, s34, 0x1e0000
s_add_u32 m0, s36, 30720
s_nop 0
buffer_load_dwordx4 v64, s[8:11], s32 offen lds
s_xor_b32 s32, s34, 0x1f0000
s_add_u32 m0, s36, 31744
s_nop 0
buffer_load_dwordx4 v64, s[8:11], s32 offen lds
v_lshlrev_b32 v42, 16, v0
v_and_b32 v43, 0xffff0000, v0
v_cvt_pk_f16_f32 v0, v42, v43
v_lshlrev_b32 v44, 16, v1
v_and_b32 v45, 0xffff0000, v1
v_cvt_pk_f16_f32 v1, v44, v45
v_lshlrev_b32 v42, 16, v2
v_and_b32 v43, 0xffff0000, v2
v_cvt_pk_f16_f32 v2, v42, v43
v_lshlrev_b32 v44, 16, v3
v_and_b32 v45, 0xffff0000, v3
v_cvt_pk_f16_f32 v3, v44, v45
v_lshlrev_b32 v42, 16, v4
v_and_b32 v43, 0xffff0000, v4
v_cvt_pk_f16_f32 v4, v42, v43
v_lshlrev_b32 v44, 16, v5
v_and_b32 v45, 0xffff0000, v5
v_cvt_pk_f16_f32 v5, v44, v45
v_lshlrev_b32 v42, 16, v6
v_and_b32 v43, 0xffff0000, v6
v_cvt_pk_f16_f32 v6, v42, v43
v_lshlrev_b32 v44, 16, v7
v_and_b32 v45, 0xffff0000, v7
v_cvt_pk_f16_f32 v7, v44, v45
v_accvgpr_write_b32 a152, v0
v_accvgpr_write_b32 a153, v1
v_accvgpr_write_b32 a154, v2
v_accvgpr_write_b32 a155, v3
v_accvgpr_write_b32 a156, v4
v_accvgpr_write_b32 a157, v5
v_accvgpr_write_b32 a158, v6
v_accvgpr_write_b32 a159, v7
v_lshlrev_b32 v42, 16, v8
v_and_b32 v43, 0xffff0000, v8
v_cvt_pk_f16_f32 v8, v42, v43
v_lshlrev_b32 v44, 16, v9
v_and_b32 v45, 0xffff0000, v9
v_cvt_pk_f16_f32 v9, v44, v45
v_lshlrev_b32 v42, 16, v10
v_and_b32 v43, 0xffff0000, v10
v_cvt_pk_f16_f32 v10, v42, v43
v_lshlrev_b32 v44, 16, v11
v_and_b32 v45, 0xffff0000, v11
v_cvt_pk_f16_f32 v11, v44, v45
v_lshlrev_b32 v42, 16, v12
v_and_b32 v43, 0xffff0000, v12
v_cvt_pk_f16_f32 v12, v42, v43
v_lshlrev_b32 v44, 16, v13
v_and_b32 v45, 0xffff0000, v13
v_cvt_pk_f16_f32 v13, v44, v45
v_lshlrev_b32 v42, 16, v14
v_and_b32 v43, 0xffff0000, v14
v_cvt_pk_f16_f32 v14, v42, v43
v_lshlrev_b32 v44, 16, v15
v_and_b32 v45, 0xffff0000, v15
v_cvt_pk_f16_f32 v15, v44, v45
v_accvgpr_write_b32 a184, v8
v_accvgpr_write_b32 a185, v9
v_accvgpr_write_b32 a186, v10
v_accvgpr_write_b32 a187, v11
v_accvgpr_write_b32 a188, v12
v_accvgpr_write_b32 a189, v13
v_accvgpr_write_b32 a190, v14
v_accvgpr_write_b32 a191, v15
v_lshlrev_b32 v42, 16, v16
v_and_b32 v43, 0xffff0000, v16
v_cvt_pk_f16_f32 v16, v42, v43
v_lshlrev_b32 v44, 16, v17
v_and_b32 v45, 0xffff0000, v17
v_cvt_pk_f16_f32 v17, v44, v45
v_lshlrev_b32 v42, 16, v18
v_and_b32 v43, 0xffff0000, v18
v_cvt_pk_f16_f32 v18, v42, v43
v_lshlrev_b32 v44, 16, v19
v_and_b32 v45, 0xffff0000, v19
v_cvt_pk_f16_f32 v19, v44, v45
v_lshlrev_b32 v42, 16, v20
v_and_b32 v43, 0xffff0000, v20
v_cvt_pk_f16_f32 v20, v42, v43
v_lshlrev_b32 v44, 16, v21
v_and_b32 v45, 0xffff0000, v21
v_cvt_pk_f16_f32 v21, v44, v45
v_lshlrev_b32 v42, 16, v22
v_and_b32 v43, 0xffff0000, v22
v_cvt_pk_f16_f32 v22, v42, v43
v_lshlrev_b32 v44, 16, v23
v_and_b32 v45, 0xffff0000, v23
v_cvt_pk_f16_f32 v23, v44, v45
v_accvgpr_write_b32 a216, v16
v_accvgpr_write_b32 a217, v17
v_accvgpr_write_b32 a218, v18
v_accvgpr_write_b32 a219, v19
v_accvgpr_write_b32 a220, v20
v_accvgpr_write_b32 a221, v21
v_accvgpr_write_b32 a222, v22
v_accvgpr_write_b32 a223, v23
v_lshlrev_b32 v42, 16, v24
v_and_b32 v43, 0xffff0000, v24
v_cvt_pk_f16_f32 v24, v42, v43
v_lshlrev_b32 v44, 16, v25
v_and_b32 v45, 0xffff0000, v25
v_cvt_pk_f16_f32 v25, v44, v45
v_lshlrev_b32 v42, 16, v26
v_and_b32 v43, 0xffff0000, v26
v_cvt_pk_f16_f32 v26, v42, v43
v_lshlrev_b32 v44, 16, v27
v_and_b32 v45, 0xffff0000, v27
v_cvt_pk_f16_f32 v27, v44, v45
v_lshlrev_b32 v42, 16, v28
v_and_b32 v43, 0xffff0000, v28
v_cvt_pk_f16_f32 v28, v42, v43
v_lshlrev_b32 v44, 16, v29
v_and_b32 v45, 0xffff0000, v29
v_cvt_pk_f16_f32 v29, v44, v45
v_lshlrev_b32 v42, 16, v30
v_and_b32 v43, 0xffff0000, v30
v_cvt_pk_f16_f32 v30, v42, v43
v_lshlrev_b32 v44, 16, v31
v_and_b32 v45, 0xffff0000, v31
v_cvt_pk_f16_f32 v31, v44, v45
v_accvgpr_write_b32 a248, v24
v_accvgpr_write_b32 a249, v25
v_accvgpr_write_b32 a250, v26
v_accvgpr_write_b32 a251, v27
v_accvgpr_write_b32 a252, v28
v_accvgpr_write_b32 a253, v29
v_accvgpr_write_b32 a254, v30
v_accvgpr_write_b32 a255, v31
s_waitcnt vmcnt(27)
s_barrier
ds_read_b64_tr_b16 v[128:129], v36 offset:0
ds_read_b64_tr_b16 v[130:131], v36 offset:256
ds_read_b64_tr_b16 v[132:133], v36 offset:4096
ds_read_b64_tr_b16 v[134:135], v36 offset:4352
ds_read_b64_tr_b16 v[136:137], v37 offset:0
ds_read_b64_tr_b16 v[138:139], v37 offset:256
ds_read_b64_tr_b16 v[140:141], v37 offset:4096
ds_read_b64_tr_b16 v[142:143], v37 offset:4352
ds_read_b64_tr_b16 v[144:145], v38 offset:0
ds_read_b64_tr_b16 v[146:147], v38 offset:256
ds_read_b64_tr_b16 v[148:149], v38 offset:4096
ds_read_b64_tr_b16 v[150:151], v38 offset:4352
ds_read_b64_tr_b16 v[152:153], v39 offset:0
ds_read_b64_tr_b16 v[154:155], v39 offset:256
ds_read_b64_tr_b16 v[156:157], v39 offset:4096
ds_read_b64_tr_b16 v[158:159], v39 offset:4352
s_waitcnt lgkmcnt(0)
s_barrier
s_mov_b32 s8, s40
s_and_b32 s9, s41, 0xffff
s_mov_b32 s10, 0x800000
s_mov_b32 s11, 0x20000
s_sub_u32 s39, 511, s40
s_and_b32 s39, s39, 0x380
s_lshr_b32 s33, s39, 7
s_xor_b32 s33, s14, s33
s_and_b32 s33, s33, 3
s_lshl_b32 s33, s33, 19
s_add_u32 s39, s39, s33
s_andn2_b32 s32, s34, 0x180fff
s_add_u32 s39, s39, s32
s_xor_b32 s32, s39, 0x0
buffer_load_dword v82, v80, s[8:11], s32 offen
s_xor_b32 s32, s34, 0x0
s_add_u32 m0, s36, 0
s_nop 0
buffer_load_dwordx4 v64, s[8:11], s32 offen lds
s_xor_b32 s32, s34, 0x10000
s_add_u32 m0, s36, 1024
s_nop 0
buffer_load_dwordx4 v64, s[8:11], s32 offen lds
s_xor_b32 s32, s34, 0x20000
s_add_u32 m0, s36, 2048
s_nop 0
buffer_load_dwordx4 v64, s[8:11], s32 offen lds
s_xor_b32 s32, s34, 0x30000
s_add_u32 m0, s36, 3072
s_nop 0
buffer_load_dwordx4 v64, s[8:11], s32 offen lds
s_xor_b32 s32, s34, 0x40000
s_add_u32 m0, s36, 4096
s_nop 0
buffer_load_dwordx4 v64, s[8:11], s32 offen lds
s_xor_b32 s32, s34, 0x50000
s_add_u32 m0, s36, 5120
s_nop 0
buffer_load_dwordx4 v64, s[8:11], s32 offen lds
s_xor_b32 s32, s34, 0x60000
s_add_u32 m0, s36, 6144
s_nop 0
buffer_load_dwordx4 v64, s[8:11], s32 offen lds
s_xor_b32 s32, s34, 0x70000
s_add_u32 m0, s36, 7168
s_nop 0
buffer_load_dwordx4 v64, s[8:11], s32 offen lds
v_lshlrev_b32 v42, 16, v128
v_and_b32 v43, 0xffff0000, v128
v_cvt_pk_f16_f32 v128, v42, v43
v_lshlrev_b32 v44, 16, v129
v_and_b32 v45, 0xffff0000, v129
v_cvt_pk_f16_f32 v129, v44, v45
v_lshlrev_b32 v42, 16, v130
v_and_b32 v43, 0xffff0000, v130
v_cvt_pk_f16_f32 v130, v42, v43
v_lshlrev_b32 v44, 16, v131
v_and_b32 v45, 0xffff0000, v131
v_cvt_pk_f16_f32 v131, v44, v45
v_lshlrev_b32 v42, 16, v132
v_and_b32 v43, 0xffff0000, v132
v_cvt_pk_f16_f32 v132, v42, v43
v_lshlrev_b32 v44, 16, v133
v_and_b32 v45, 0xffff0000, v133
v_cvt_pk_f16_f32 v133, v44, v45
v_lshlrev_b32 v42, 16, v134
v_and_b32 v43, 0xffff0000, v134
v_cvt_pk_f16_f32 v134, v42, v43
v_lshlrev_b32 v44, 16, v135
v_and_b32 v45, 0xffff0000, v135
v_cvt_pk_f16_f32 v135, v44, v45
v_lshlrev_b32 v42, 16, v136
v_and_b32 v43, 0xffff0000, v136
v_cvt_pk_f16_f32 v136, v42, v43
v_lshlrev_b32 v44, 16, v137
v_and_b32 v45, 0xffff0000, v137
v_cvt_pk_f16_f32 v137, v44, v45
v_lshlrev_b32 v42, 16, v138
v_and_b32 v43, 0xffff0000, v138
v_cvt_pk_f16_f32 v138, v42, v43
v_lshlrev_b32 v44, 16, v139
v_and_b32 v45, 0xffff0000, v139
v_cvt_pk_f16_f32 v139, v44, v45
v_lshlrev_b32 v42, 16, v140
v_and_b32 v43, 0xffff0000, v140
v_cvt_pk_f16_f32 v140, v42, v43
v_lshlrev_b32 v44, 16, v141
v_and_b32 v45, 0xffff0000, v141
v_cvt_pk_f16_f32 v141, v44, v45
v_lshlrev_b32 v42, 16, v142
v_and_b32 v43, 0xffff0000, v142
v_cvt_pk_f16_f32 v142, v42, v43
v_lshlrev_b32 v44, 16, v143
v_and_b32 v45, 0xffff0000, v143
v_cvt_pk_f16_f32 v143, v44, v45
v_lshlrev_b32 v42, 16, v144
v_and_b32 v43, 0xffff0000, v144
v_cvt_pk_f16_f32 v144, v42, v43
v_lshlrev_b32 v44, 16, v145
v_and_b32 v45, 0xffff0000, v145
v_cvt_pk_f16_f32 v145, v44, v45
v_lshlrev_b32 v42, 16, v146
v_and_b32 v43, 0xffff0000, v146
v_cvt_pk_f16_f32 v146, v42, v43
v_lshlrev_b32 v44, 16, v147
v_and_b32 v45, 0xffff0000, v147
v_cvt_pk_f16_f32 v147, v44, v45
v_lshlrev_b32 v42, 16, v148
v_and_b32 v43, 0xffff0000, v148
v_cvt_pk_f16_f32 v148, v42, v43
v_lshlrev_b32 v44, 16, v149
v_and_b32 v45, 0xffff0000, v149
v_cvt_pk_f16_f32 v149, v44, v45
v_lshlrev_b32 v42, 16, v150
v_and_b32 v43, 0xffff0000, v150
v_cvt_pk_f16_f32 v150, v42, v43
v_lshlrev_b32 v44, 16, v151
v_and_b32 v45, 0xffff0000, v151
v_cvt_pk_f16_f32 v151, v44, v45
v_lshlrev_b32 v42, 16, v152
v_and_b32 v43, 0xffff0000, v152
v_cvt_pk_f16_f32 v152, v42, v43
v_lshlrev_b32 v44, 16, v153
v_and_b32 v45, 0xffff0000, v153
v_cvt_pk_f16_f32 v153, v44, v45
v_lshlrev_b32 v42, 16, v154
v_and_b32 v43, 0xffff0000, v154
v_cvt_pk_f16_f32 v154, v42, v43
v_lshlrev_b32 v44, 16, v155
v_and_b32 v45, 0xffff0000, v155
v_cvt_pk_f16_f32 v155, v44, v45
v_lshlrev_b32 v42, 16, v156
v_and_b32 v43, 0xffff0000, v156
v_cvt_pk_f16_f32 v156, v42, v43
v_lshlrev_b32 v44, 16, v157
v_and_b32 v45, 0xffff0000, v157
v_cvt_pk_f16_f32 v157, v44, v45
v_lshlrev_b32 v42, 16, v158
v_and_b32 v43, 0xffff0000, v158
v_cvt_pk_f16_f32 v158, v42, v43
v_lshlrev_b32 v44, 16, v159
v_and_b32 v45, 0xffff0000, v159
v_cvt_pk_f16_f32 v159, v44, v45
s_waitcnt vmcnt(27)
s_barrier
ds_read_b64_tr_b16 v[160:161], v36 offset:8192
ds_read_b64_tr_b16 v[162:163], v36 offset:8448
ds_read_b64_tr_b16 v[164:165], v36 offset:12288
ds_read_b64_tr_b16 v[166:167], v36 offset:12544
ds_read_b64_tr_b16 v[168:169], v37 offset:8192
ds_read_b64_tr_b16 v[170:171], v37 offset:8448
ds_read_b64_tr_b16 v[172:173], v37 offset:12288
ds_read_b64_tr_b16 v[174:175], v37 offset:12544
ds_read_b64_tr_b16 v[176:177], v38 offset:8192
ds_read_b64_tr_b16 v[178:179], v38 offset:8448
ds_read_b64_tr_b16 v[180:181], v38 offset:12288
ds_read_b64_tr_b16 v[182:183], v38 offset:12544
ds_read_b64_tr_b16 v[184:185], v39 offset:8192
ds_read_b64_tr_b16 v[186:187], v39 offset:8448
ds_read_b64_tr_b16 v[188:189], v39 offset:12288
ds_read_b64_tr_b16 v[190:191], v39 offset:12544
s_waitcnt lgkmcnt(0)
s_barrier
s_xor_b32 s32, s39, 0x80000
buffer_load_dword v82, v80, s[8:11], s32 offen
s_xor_b32 s32, s34, 0x80000
s_add_u32 m0, s36, 8192
s_nop 0
buffer_load_dwordx4 v64, s[8:11], s32 offen lds
s_xor_b32 s32, s34, 0x90000
s_add_u32 m0, s36, 9216
s_nop 0
buffer_load_dwordx4 v64, s[8:11], s32 offen lds
s_xor_b32 s32, s34, 0xa0000
s_add_u32 m0, s36, 10240
s_nop 0
buffer_load_dwordx4 v64, s[8:11], s32 offen lds
s_xor_b32 s32, s34, 0xb0000
s_add_u32 m0, s36, 11264
s_nop 0
buffer_load_dwordx4 v64, s[8:11], s32 offen lds
s_xor_b32 s32, s34, 0xc0000
s_add_u32 m0, s36, 12288
s_nop 0
buffer_load_dwordx4 v64, s[8:11], s32 offen lds
s_xor_b32 s32, s34, 0xd0000
s_add_u32 m0, s36, 13312
s_nop 0
buffer_load_dwordx4 v64, s[8:11], s32 offen lds
s_xor_b32 s32, s34, 0xe0000
s_add_u32 m0, s36, 14336
s_nop 0
buffer_load_dwordx4 v64, s[8:11], s32 offen lds
s_xor_b32 s32, s34, 0xf0000
s_add_u32 m0, s36, 15360
s_nop 0
buffer_load_dwordx4 v64, s[8:11], s32 offen lds
v_lshlrev_b32 v42, 16, v160
v_and_b32 v43, 0xffff0000, v160
v_cvt_pk_f16_f32 v160, v42, v43
v_lshlrev_b32 v44, 16, v161
v_and_b32 v45, 0xffff0000, v161
v_cvt_pk_f16_f32 v161, v44, v45
v_lshlrev_b32 v42, 16, v162
v_and_b32 v43, 0xffff0000, v162
v_cvt_pk_f16_f32 v162, v42, v43
v_lshlrev_b32 v44, 16, v163
v_and_b32 v45, 0xffff0000, v163
v_cvt_pk_f16_f32 v163, v44, v45
v_lshlrev_b32 v42, 16, v164
v_and_b32 v43, 0xffff0000, v164
v_cvt_pk_f16_f32 v164, v42, v43
v_lshlrev_b32 v44, 16, v165
v_and_b32 v45, 0xffff0000, v165
v_cvt_pk_f16_f32 v165, v44, v45
v_lshlrev_b32 v42, 16, v166
v_and_b32 v43, 0xffff0000, v166
v_cvt_pk_f16_f32 v166, v42, v43
v_lshlrev_b32 v44, 16, v167
v_and_b32 v45, 0xffff0000, v167
v_cvt_pk_f16_f32 v167, v44, v45
v_lshlrev_b32 v42, 16, v168
v_and_b32 v43, 0xffff0000, v168
v_cvt_pk_f16_f32 v168, v42, v43
v_lshlrev_b32 v44, 16, v169
v_and_b32 v45, 0xffff0000, v169
v_cvt_pk_f16_f32 v169, v44, v45
v_lshlrev_b32 v42, 16, v170
v_and_b32 v43, 0xffff0000, v170
v_cvt_pk_f16_f32 v170, v42, v43
v_lshlrev_b32 v44, 16, v171
v_and_b32 v45, 0xffff0000, v171
v_cvt_pk_f16_f32 v171, v44, v45
v_lshlrev_b32 v42, 16, v172
v_and_b32 v43, 0xffff0000, v172
v_cvt_pk_f16_f32 v172, v42, v43
v_lshlrev_b32 v44, 16, v173
v_and_b32 v45, 0xffff0000, v173
v_cvt_pk_f16_f32 v173, v44, v45
v_lshlrev_b32 v42, 16, v174
v_and_b32 v43, 0xffff0000, v174
v_cvt_pk_f16_f32 v174, v42, v43
v_lshlrev_b32 v44, 16, v175
v_and_b32 v45, 0xffff0000, v175
v_cvt_pk_f16_f32 v175, v44, v45
v_lshlrev_b32 v42, 16, v176
v_and_b32 v43, 0xffff0000, v176
v_cvt_pk_f16_f32 v176, v42, v43
v_lshlrev_b32 v44, 16, v177
v_and_b32 v45, 0xffff0000, v177
v_cvt_pk_f16_f32 v177, v44, v45
v_lshlrev_b32 v42, 16, v178
v_and_b32 v43, 0xffff0000, v178
v_cvt_pk_f16_f32 v178, v42, v43
v_lshlrev_b32 v44, 16, v179
v_and_b32 v45, 0xffff0000, v179
v_cvt_pk_f16_f32 v179, v44, v45
v_lshlrev_b32 v42, 16, v180
v_and_b32 v43, 0xffff0000, v180
v_cvt_pk_f16_f32 v180, v42, v43
v_lshlrev_b32 v44, 16, v181
v_and_b32 v45, 0xffff0000, v181
v_cvt_pk_f16_f32 v181, v44, v45
v_lshlrev_b32 v42, 16, v182
v_and_b32 v43, 0xffff0000, v182
v_cvt_pk_f16_f32 v182, v42, v43
v_lshlrev_b32 v44, 16, v183
v_and_b32 v45, 0xffff0000, v183
v_cvt_pk_f16_f32 v183, v44, v45
v_lshlrev_b32 v42, 16, v184
v_and_b32 v43, 0xffff0000, v184
v_cvt_pk_f16_f32 v184, v42, v43
v_lshlrev_b32 v44, 16, v185
v_and_b32 v45, 0xffff0000, v185
v_cvt_pk_f16_f32 v185, v44, v45
v_lshlrev_b32 v42, 16, v186
v_and_b32 v43, 0xffff0000, v186
v_cvt_pk_f16_f32 v186, v42, v43
v_lshlrev_b32 v44, 16, v187
v_and_b32 v45, 0xffff0000, v187
v_cvt_pk_f16_f32 v187, v44, v45
v_lshlrev_b32 v42, 16, v188
v_and_b32 v43, 0xffff0000, v188
v_cvt_pk_f16_f32 v188, v42, v43
v_lshlrev_b32 v44, 16, v189
v_and_b32 v45, 0xffff0000, v189
v_cvt_pk_f16_f32 v189, v44, v45
v_lshlrev_b32 v42, 16, v190
v_and_b32 v43, 0xffff0000, v190
v_cvt_pk_f16_f32 v190, v42, v43
v_lshlrev_b32 v44, 16, v191
v_and_b32 v45, 0xffff0000, v191
v_cvt_pk_f16_f32 v191, v44, v45
s_waitcnt vmcnt(27)
s_barrier
ds_read_b64_tr_b16 v[192:193], v36 offset:16384
ds_read_b64_tr_b16 v[194:195], v36 offset:16640
ds_read_b64_tr_b16 v[196:197], v36 offset:20480
ds_read_b64_tr_b16 v[198:199], v36 offset:20736
ds_read_b64_tr_b16 v[200:201], v37 offset:16384
ds_read_b64_tr_b16 v[202:203], v37 offset:16640
ds_read_b64_tr_b16 v[204:205], v37 offset:20480
ds_read_b64_tr_b16 v[206:207], v37 offset:20736
ds_read_b64_tr_b16 v[208:209], v38 offset:16384
ds_read_b64_tr_b16 v[210:211], v38 offset:16640
ds_read_b64_tr_b16 v[212:213], v38 offset:20480
ds_read_b64_tr_b16 v[214:215], v38 offset:20736
ds_read_b64_tr_b16 v[216:217], v39 offset:16384
ds_read_b64_tr_b16 v[218:219], v39 offset:16640
ds_read_b64_tr_b16 v[220:221], v39 offset:20480
ds_read_b64_tr_b16 v[222:223], v39 offset:20736
s_waitcnt lgkmcnt(0)
s_barrier
buffer_load_dword v72, v73, s[60:63], 0 offen sc1
buffer_load_dwordx2 v[84:85], off, s[60:63], 0 offset:16 sc1
s_xor_b32 s32, s39, 0x100000
buffer_load_dword v82, v80, s[8:11], s32 offen
s_xor_b32 s32, s34, 0x100000
s_add_u32 m0, s36, 16384
s_nop 0
buffer_load_dwordx4 v64, s[8:11], s32 offen lds
s_xor_b32 s32, s34, 0x110000
s_add_u32 m0, s36, 17408
s_nop 0
buffer_load_dwordx4 v64, s[8:11], s32 offen lds
s_xor_b32 s32, s34, 0x120000
s_add_u32 m0, s36, 18432
s_nop 0
buffer_load_dwordx4 v64, s[8:11], s32 offen lds
s_xor_b32 s32, s34, 0x130000
s_add_u32 m0, s36, 19456
s_nop 0
buffer_load_dwordx4 v64, s[8:11], s32 offen lds
s_xor_b32 s32, s34, 0x140000
s_add_u32 m0, s36, 20480
s_nop 0
buffer_load_dwordx4 v64, s[8:11], s32 offen lds
s_xor_b32 s32, s34, 0x150000
s_add_u32 m0, s36, 21504
s_nop 0
buffer_load_dwordx4 v64, s[8:11], s32 offen lds
s_xor_b32 s32, s34, 0x160000
s_add_u32 m0, s36, 22528
s_nop 0
buffer_load_dwordx4 v64, s[8:11], s32 offen lds
s_xor_b32 s32, s34, 0x170000
s_add_u32 m0, s36, 23552
s_nop 0
buffer_load_dwordx4 v64, s[8:11], s32 offen lds
v_lshlrev_b32 v42, 16, v192
v_and_b32 v43, 0xffff0000, v192
v_cvt_pk_f16_f32 v192, v42, v43
v_lshlrev_b32 v44, 16, v193
v_and_b32 v45, 0xffff0000, v193
v_cvt_pk_f16_f32 v193, v44, v45
v_lshlrev_b32 v42, 16, v194
v_and_b32 v43, 0xffff0000, v194
v_cvt_pk_f16_f32 v194, v42, v43
v_lshlrev_b32 v44, 16, v195
v_and_b32 v45, 0xffff0000, v195
v_cvt_pk_f16_f32 v195, v44, v45
v_lshlrev_b32 v42, 16, v196
v_and_b32 v43, 0xffff0000, v196
v_cvt_pk_f16_f32 v196, v42, v43
v_lshlrev_b32 v44, 16, v197
v_and_b32 v45, 0xffff0000, v197
v_cvt_pk_f16_f32 v197, v44, v45
v_lshlrev_b32 v42, 16, v198
v_and_b32 v43, 0xffff0000, v198
v_cvt_pk_f16_f32 v198, v42, v43
v_lshlrev_b32 v44, 16, v199
v_and_b32 v45, 0xffff0000, v199
v_cvt_pk_f16_f32 v199, v44, v45
v_lshlrev_b32 v42, 16, v200
v_and_b32 v43, 0xffff0000, v200
v_cvt_pk_f16_f32 v200, v42, v43
v_lshlrev_b32 v44, 16, v201
v_and_b32 v45, 0xffff0000, v201
v_cvt_pk_f16_f32 v201, v44, v45
v_lshlrev_b32 v42, 16, v202
v_and_b32 v43, 0xffff0000, v202
v_cvt_pk_f16_f32 v202, v42, v43
v_lshlrev_b32 v44, 16, v203
v_and_b32 v45, 0xffff0000, v203
v_cvt_pk_f16_f32 v203, v44, v45
v_lshlrev_b32 v42, 16, v204
v_and_b32 v43, 0xffff0000, v204
v_cvt_pk_f16_f32 v204, v42, v43
v_lshlrev_b32 v44, 16, v205
v_and_b32 v45, 0xffff0000, v205
v_cvt_pk_f16_f32 v205, v44, v45
v_lshlrev_b32 v42, 16, v206
v_and_b32 v43, 0xffff0000, v206
v_cvt_pk_f16_f32 v206, v42, v43
v_lshlrev_b32 v44, 16, v207
v_and_b32 v45, 0xffff0000, v207
v_cvt_pk_f16_f32 v207, v44, v45
v_lshlrev_b32 v42, 16, v208
v_and_b32 v43, 0xffff0000, v208
v_cvt_pk_f16_f32 v208, v42, v43
v_lshlrev_b32 v44, 16, v209
v_and_b32 v45, 0xffff0000, v209
v_cvt_pk_f16_f32 v209, v44, v45
v_lshlrev_b32 v42, 16, v210
v_and_b32 v43, 0xffff0000, v210
v_cvt_pk_f16_f32 v210, v42, v43
v_lshlrev_b32 v44, 16, v211
v_and_b32 v45, 0xffff0000, v211
v_cvt_pk_f16_f32 v211, v44, v45
v_lshlrev_b32 v42, 16, v212
v_and_b32 v43, 0xffff0000, v212
v_cvt_pk_f16_f32 v212, v42, v43
v_lshlrev_b32 v44, 16, v213
v_and_b32 v45, 0xffff0000, v213
v_cvt_pk_f16_f32 v213, v44, v45
v_lshlrev_b32 v42, 16, v214
v_and_b32 v43, 0xffff0000, v214
v_cvt_pk_f16_f32 v214, v42, v43
v_lshlrev_b32 v44, 16, v215
v_and_b32 v45, 0xffff0000, v215
v_cvt_pk_f16_f32 v215, v44, v45
v_lshlrev_b32 v42, 16, v216
v_and_b32 v43, 0xffff0000, v216
v_cvt_pk_f16_f32 v216, v42, v43
v_lshlrev_b32 v44, 16, v217
v_and_b32 v45, 0xffff0000, v217
v_cvt_pk_f16_f32 v217, v44, v45
v_lshlrev_b32 v42, 16, v218
v_and_b32 v43, 0xffff0000, v218
v_cvt_pk_f16_f32 v218, v42, v43
v_lshlrev_b32 v44, 16, v219
v_and_b32 v45, 0xffff0000, v219
v_cvt_pk_f16_f32 v219, v44, v45
v_lshlrev_b32 v42, 16, v220
v_and_b32 v43, 0xffff0000, v220
v_cvt_pk_f16_f32 v220, v42, v43
v_lshlrev_b32 v44, 16, v221
v_and_b32 v45, 0xffff0000, v221
v_cvt_pk_f16_f32 v221, v44, v45
v_lshlrev_b32 v42, 16, v222
v_and_b32 v43, 0xffff0000, v222
v_cvt_pk_f16_f32 v222, v42, v43
v_lshlrev_b32 v44, 16, v223
v_and_b32 v45, 0xffff0000, v223
v_cvt_pk_f16_f32 v223, v44, v45
s_waitcnt vmcnt(29)
s_barrier
ds_read_b64_tr_b16 v[224:225], v36 offset:24576
ds_read_b64_tr_b16 v[226:227], v36 offset:24832
ds_read_b64_tr_b16 v[228:229], v36 offset:28672
ds_read_b64_tr_b16 v[230:231], v36 offset:28928
ds_read_b64_tr_b16 v[232:233], v37 offset:24576
ds_read_b64_tr_b16 v[234:235], v37 offset:24832
ds_read_b64_tr_b16 v[236:237], v37 offset:28672
ds_read_b64_tr_b16 v[238:239], v37 offset:28928
ds_read_b64_tr_b16 v[240:241], v38 offset:24576
ds_read_b64_tr_b16 v[242:243], v38 offset:24832
ds_read_b64_tr_b16 v[244:245], v38 offset:28672
ds_read_b64_tr_b16 v[246:247], v38 offset:28928
ds_read_b64_tr_b16 v[248:249], v39 offset:24576
ds_read_b64_tr_b16 v[250:251], v39 offset:24832
ds_read_b64_tr_b16 v[252:253], v39 offset:28672
ds_read_b64_tr_b16 v[254:255], v39 offset:28928
s_waitcnt lgkmcnt(0)
s_barrier
s_xor_b32 s32, s39, 0x180000
buffer_load_dword v82, v80, s[8:11], s32 offen
s_xor_b32 s32, s34, 0x180000
s_add_u32 m0, s36, 24576
s_nop 0
buffer_load_dwordx4 v64, s[8:11], s32 offen lds
s_xor_b32 s32, s34, 0x190000
s_add_u32 m0, s36, 25600
s_nop 0
buffer_load_dwordx4 v64, s[8:11], s32 offen lds
s_xor_b32 s32, s34, 0x1a0000
s_add_u32 m0, s36, 26624
s_nop 0
buffer_load_dwordx4 v64, s[8:11], s32 offen lds
s_xor_b32 s32, s34, 0x1b0000
s_add_u32 m0, s36, 27648
s_nop 0
buffer_load_dwordx4 v64, s[8:11], s32 offen lds
s_xor_b32 s32, s34, 0x1c0000
s_add_u32 m0, s36, 28672
s_nop 0
buffer_load_dwordx4 v64, s[8:11], s32 offen lds
s_xor_b32 s32, s34, 0x1d0000
s_add_u32 m0, s36, 29696
s_nop 0
buffer_load_dwordx4 v64, s[8:11], s32 offen lds
s_xor_b32 s32, s34, 0x1e0000
s_add_u32 m0, s36, 30720
s_nop 0
buffer_load_dwordx4 v64, s[8:11], s32 offen lds
s_xor_b32 s32, s34, 0x1f0000
s_add_u32 m0, s36, 31744
s_nop 0
buffer_load_dwordx4 v64, s[8:11], s32 offen lds
v_lshlrev_b32 v42, 16, v224
v_and_b32 v43, 0xffff0000, v224
v_cvt_pk_f16_f32 v224, v42, v43
v_lshlrev_b32 v44, 16, v225
v_and_b32 v45, 0xffff0000, v225
v_cvt_pk_f16_f32 v225, v44, v45
v_lshlrev_b32 v42, 16, v226
v_and_b32 v43, 0xffff0000, v226
v_cvt_pk_f16_f32 v226, v42, v43
v_lshlrev_b32 v44, 16, v227
v_and_b32 v45, 0xffff0000, v227
v_cvt_pk_f16_f32 v227, v44, v45
v_lshlrev_b32 v42, 16, v228
v_and_b32 v43, 0xffff0000, v228
v_cvt_pk_f16_f32 v228, v42, v43
v_lshlrev_b32 v44, 16, v229
v_and_b32 v45, 0xffff0000, v229
v_cvt_pk_f16_f32 v229, v44, v45
v_lshlrev_b32 v42, 16, v230
v_and_b32 v43, 0xffff0000, v230
v_cvt_pk_f16_f32 v230, v42, v43
v_lshlrev_b32 v44, 16, v231
v_and_b32 v45, 0xffff0000, v231
v_cvt_pk_f16_f32 v231, v44, v45
v_lshlrev_b32 v42, 16, v232
v_and_b32 v43, 0xffff0000, v232
v_cvt_pk_f16_f32 v232, v42, v43
v_lshlrev_b32 v44, 16, v233
v_and_b32 v45, 0xffff0000, v233
v_cvt_pk_f16_f32 v233, v44, v45
v_lshlrev_b32 v42, 16, v234
v_and_b32 v43, 0xffff0000, v234
v_cvt_pk_f16_f32 v234, v42, v43
v_lshlrev_b32 v44, 16, v235
v_and_b32 v45, 0xffff0000, v235
v_cvt_pk_f16_f32 v235, v44, v45
v_lshlrev_b32 v42, 16, v236
v_and_b32 v43, 0xffff0000, v236
v_cvt_pk_f16_f32 v236, v42, v43
v_lshlrev_b32 v44, 16, v237
v_and_b32 v45, 0xffff0000, v237
v_cvt_pk_f16_f32 v237, v44, v45
v_lshlrev_b32 v42, 16, v238
v_and_b32 v43, 0xffff0000, v238
v_cvt_pk_f16_f32 v238, v42, v43
v_lshlrev_b32 v44, 16, v239
v_and_b32 v45, 0xffff0000, v239
v_cvt_pk_f16_f32 v239, v44, v45
v_lshlrev_b32 v42, 16, v240
v_and_b32 v43, 0xffff0000, v240
v_cvt_pk_f16_f32 v240, v42, v43
v_lshlrev_b32 v44, 16, v241
v_and_b32 v45, 0xffff0000, v241
v_cvt_pk_f16_f32 v241, v44, v45
v_lshlrev_b32 v42, 16, v242
v_and_b32 v43, 0xffff0000, v242
v_cvt_pk_f16_f32 v242, v42, v43
v_lshlrev_b32 v44, 16, v243
v_and_b32 v45, 0xffff0000, v243
v_cvt_pk_f16_f32 v243, v44, v45
v_lshlrev_b32 v42, 16, v244
v_and_b32 v43, 0xffff0000, v244
v_cvt_pk_f16_f32 v244, v42, v43
v_lshlrev_b32 v44, 16, v245
v_and_b32 v45, 0xffff0000, v245
v_cvt_pk_f16_f32 v245, v44, v45
v_lshlrev_b32 v42, 16, v246
v_and_b32 v43, 0xffff0000, v246
v_cvt_pk_f16_f32 v246, v42, v43
v_lshlrev_b32 v44, 16, v247
v_and_b32 v45, 0xffff0000, v247
v_cvt_pk_f16_f32 v247, v44, v45
v_lshlrev_b32 v42, 16, v248
v_and_b32 v43, 0xffff0000, v248
v_cvt_pk_f16_f32 v248, v42, v43
v_lshlrev_b32 v44, 16, v249
v_and_b32 v45, 0xffff0000, v249
v_cvt_pk_f16_f32 v249, v44, v45
v_lshlrev_b32 v42, 16, v250
v_and_b32 v43, 0xffff0000, v250
v_cvt_pk_f16_f32 v250, v42, v43
v_lshlrev_b32 v44, 16, v251
v_and_b32 v45, 0xffff0000, v251
v_cvt_pk_f16_f32 v251, v44, v45
v_lshlrev_b32 v42, 16, v252
v_and_b32 v43, 0xffff0000, v252
v_cvt_pk_f16_f32 v252, v42, v43
v_lshlrev_b32 v44, 16, v253
v_and_b32 v45, 0xffff0000, v253
v_cvt_pk_f16_f32 v253, v44, v45
v_lshlrev_b32 v42, 16, v254
v_and_b32 v43, 0xffff0000, v254
v_cvt_pk_f16_f32 v254, v42, v43
v_lshlrev_b32 v44, 16, v255
v_and_b32 v45, 0xffff0000, v255
v_cvt_pk_f16_f32 v255, v44, v45
s_waitcnt vmcnt(29)
s_barrier
ds_read_b64_tr_b16 v[0:1], v32 offset:0
ds_read_b64_tr_b16 v[2:3], v32 offset:256
ds_read_b64_tr_b16 v[4:5], v32 offset:4096
ds_read_b64_tr_b16 v[6:7], v32 offset:4352
ds_read_b64_tr_b16 v[8:9], v33 offset:0
ds_read_b64_tr_b16 v[10:11], v33 offset:256
ds_read_b64_tr_b16 v[12:13], v33 offset:4096
ds_read_b64_tr_b16 v[14:15], v33 offset:4352
ds_read_b64_tr_b16 v[16:17], v34 offset:0
ds_read_b64_tr_b16 v[18:19], v34 offset:256
ds_read_b64_tr_b16 v[20:21], v34 offset:4096
ds_read_b64_tr_b16 v[22:23], v34 offset:4352
ds_read_b64_tr_b16 v[24:25], v35 offset:0
ds_read_b64_tr_b16 v[26:27], v35 offset:256
ds_read_b64_tr_b16 v[28:29], v35 offset:4096
ds_read_b64_tr_b16 v[30:31], v35 offset:4352
s_waitcnt lgkmcnt(0)
s_barrier
s_mov_b32 s8, s46
s_and_b32 s9, s47, 0xffff
s_mov_b32 s10, 0x800000
s_mov_b32 s11, 0x20000
s_sub_u32 s39, 511, s46
s_and_b32 s39, s39, 0x380
s_lshr_b32 s33, s39, 6
s_xor_b32 s33, s14, s33
s_and_b32 s33, s33, 6
s_lshl_b32 s33, s33, 17
s_add_u32 s39, s39, s33
s_andn2_b32 s32, s35, 0xe0fff
s_add_u32 s39, s39, s32
s_xor_b32 s32, s39, 0x0
buffer_load_dword v82, v81, s[8:11], s32 offen
s_xor_b32 s32, s35, 0x0
s_add_u32 m0, s36, 0
s_nop 0
buffer_load_dwordx4 v65, s[8:11], s32 offen lds
s_xor_b32 s32, s35, 0x8000
s_add_u32 m0, s36, 1024
s_nop 0
buffer_load_dwordx4 v65, s[8:11], s32 offen lds
s_xor_b32 s32, s35, 0x10000
s_add_u32 m0, s36, 2048
s_nop 0
buffer_load_dwordx4 v65, s[8:11], s32 offen lds
s_xor_b32 s32, s35, 0x18000
s_add_u32 m0, s36, 3072
s_nop 0
buffer_load_dwordx4 v65, s[8:11], s32 offen lds
s_xor_b32 s32, s35, 0x20000
s_add_u32 m0, s36, 4096
s_nop 0
buffer_load_dwordx4 v65, s[8:11], s32 offen lds
s_xor_b32 s32, s35, 0x28000
s_add_u32 m0, s36, 5120
s_nop 0
buffer_load_dwordx4 v65, s[8:11], s32 offen lds
s_xor_b32 s32, s35, 0x30000
s_add_u32 m0, s36, 6144
s_nop 0
buffer_load_dwordx4 v65, s[8:11], s32 offen lds
s_xor_b32 s32, s35, 0x38000
s_add_u32 m0, s36, 7168
s_nop 0
buffer_load_dwordx4 v65, s[8:11], s32 offen lds
v_lshlrev_b32 v42, 16, v0
v_and_b32 v43, 0xffff0000, v0
v_cvt_pk_f16_f32 v0, v42, v43
v_lshlrev_b32 v44, 16, v1
v_and_b32 v45, 0xffff0000, v1
v_cvt_pk_f16_f32 v1, v44, v45
v_lshlrev_b32 v42, 16, v2
v_and_b32 v43, 0xffff0000, v2
v_cvt_pk_f16_f32 v2, v42, v43
v_lshlrev_b32 v44, 16, v3
v_and_b32 v45, 0xffff0000, v3
v_cvt_pk_f16_f32 v3, v44, v45
v_lshlrev_b32 v42, 16, v4
v_and_b32 v43, 0xffff0000, v4
v_cvt_pk_f16_f32 v4, v42, v43
v_lshlrev_b32 v44, 16, v5
v_and_b32 v45, 0xffff0000, v5
v_cvt_pk_f16_f32 v5, v44, v45
v_lshlrev_b32 v42, 16, v6
v_and_b32 v43, 0xffff0000, v6
v_cvt_pk_f16_f32 v6, v42, v43
v_lshlrev_b32 v44, 16, v7
v_and_b32 v45, 0xffff0000, v7
v_cvt_pk_f16_f32 v7, v44, v45
v_accvgpr_write_b32 a0, v0
v_accvgpr_write_b32 a1, v1
v_accvgpr_write_b32 a2, v2
v_accvgpr_write_b32 a3, v3
v_accvgpr_write_b32 a4, v4
v_accvgpr_write_b32 a5, v5
v_accvgpr_write_b32 a6, v6
v_accvgpr_write_b32 a7, v7
v_lshlrev_b32 v42, 16, v8
v_and_b32 v43, 0xffff0000, v8
v_cvt_pk_f16_f32 v8, v42, v43
v_lshlrev_b32 v44, 16, v9
v_and_b32 v45, 0xffff0000, v9
v_cvt_pk_f16_f32 v9, v44, v45
v_lshlrev_b32 v42, 16, v10
v_and_b32 v43, 0xffff0000, v10
v_cvt_pk_f16_f32 v10, v42, v43
v_lshlrev_b32 v44, 16, v11
v_and_b32 v45, 0xffff0000, v11
v_cvt_pk_f16_f32 v11, v44, v45
v_lshlrev_b32 v42, 16, v12
v_and_b32 v43, 0xffff0000, v12
v_cvt_pk_f16_f32 v12, v42, v43
v_lshlrev_b32 v44, 16, v13
v_and_b32 v45, 0xffff0000, v13
v_cvt_pk_f16_f32 v13, v44, v45
v_lshlrev_b32 v42, 16, v14
v_and_b32 v43, 0xffff0000, v14
v_cvt_pk_f16_f32 v14, v42, v43
v_lshlrev_b32 v44, 16, v15
v_and_b32 v45, 0xffff0000, v15
v_cvt_pk_f16_f32 v15, v44, v45
v_accvgpr_write_b32 a32, v8
v_accvgpr_write_b32 a33, v9
v_accvgpr_write_b32 a34, v10
v_accvgpr_write_b32 a35, v11
v_accvgpr_write_b32 a36, v12
v_accvgpr_write_b32 a37, v13
v_accvgpr_write_b32 a38, v14
v_accvgpr_write_b32 a39, v15
v_lshlrev_b32 v42, 16, v16
v_and_b32 v43, 0xffff0000, v16
v_cvt_pk_f16_f32 v16, v42, v43
v_lshlrev_b32 v44, 16, v17
v_and_b32 v45, 0xffff0000, v17
v_cvt_pk_f16_f32 v17, v44, v45
v_lshlrev_b32 v42, 16, v18
v_and_b32 v43, 0xffff0000, v18
v_cvt_pk_f16_f32 v18, v42, v43
v_lshlrev_b32 v44, 16, v19
v_and_b32 v45, 0xffff0000, v19
v_cvt_pk_f16_f32 v19, v44, v45
v_lshlrev_b32 v42, 16, v20
v_and_b32 v43, 0xffff0000, v20
v_cvt_pk_f16_f32 v20, v42, v43
v_lshlrev_b32 v44, 16, v21
v_and_b32 v45, 0xffff0000, v21
v_cvt_pk_f16_f32 v21, v44, v45
v_lshlrev_b32 v42, 16, v22
v_and_b32 v43, 0xffff0000, v22
v_cvt_pk_f16_f32 v22, v42, v43
v_lshlrev_b32 v44, 16, v23
v_and_b32 v45, 0xffff0000, v23
v_cvt_pk_f16_f32 v23, v44, v45
v_accvgpr_write_b32 a64, v16
v_accvgpr_write_b32 a65, v17
v_accvgpr_write_b32 a66, v18
v_accvgpr_write_b32 a67, v19
v_accvgpr_write_b32 a68, v20
v_accvgpr_write_b32 a69, v21
v_accvgpr_write_b32 a70, v22
v_accvgpr_write_b32 a71, v23
v_lshlrev_b32 v42, 16, v24
v_and_b32 v43, 0xffff0000, v24
v_cvt_pk_f16_f32 v24, v42, v43
v_lshlrev_b32 v44, 16, v25
v_and_b32 v45, 0xffff0000, v25
v_cvt_pk_f16_f32 v25, v44, v45
v_lshlrev_b32 v42, 16, v26
v_and_b32 v43, 0xffff0000, v26
v_cvt_pk_f16_f32 v26, v42, v43
v_lshlrev_b32 v44, 16, v27
v_and_b32 v45, 0xffff0000, v27
v_cvt_pk_f16_f32 v27, v44, v45
v_lshlrev_b32 v42, 16, v28
v_and_b32 v43, 0xffff0000, v28
v_cvt_pk_f16_f32 v28, v42, v43
v_lshlrev_b32 v44, 16, v29
v_and_b32 v45, 0xffff0000, v29
v_cvt_pk_f16_f32 v29, v44, v45
v_lshlrev_b32 v42, 16, v30
v_and_b32 v43, 0xffff0000, v30
v_cvt_pk_f16_f32 v30, v42, v43
v_lshlrev_b32 v44, 16, v31
v_and_b32 v45, 0xffff0000, v31
v_cvt_pk_f16_f32 v31, v44, v45
v_accvgpr_write_b32 a96, v24
v_accvgpr_write_b32 a97, v25
v_accvgpr_write_b32 a98, v26
v_accvgpr_write_b32 a99, v27
v_accvgpr_write_b32 a100, v28
v_accvgpr_write_b32 a101, v29
v_accvgpr_write_b32 a102, v30
v_accvgpr_write_b32 a103, v31
s_waitcnt vmcnt(29)
s_barrier
ds_read_b64_tr_b16 v[0:1], v32 offset:8192
ds_read_b64_tr_b16 v[2:3], v32 offset:8448
ds_read_b64_tr_b16 v[4:5], v32 offset:12288
ds_read_b64_tr_b16 v[6:7], v32 offset:12544
ds_read_b64_tr_b16 v[8:9], v33 offset:8192
ds_read_b64_tr_b16 v[10:11], v33 offset:8448
ds_read_b64_tr_b16 v[12:13], v33 offset:12288
ds_read_b64_tr_b16 v[14:15], v33 offset:12544
ds_read_b64_tr_b16 v[16:17], v34 offset:8192
ds_read_b64_tr_b16 v[18:19], v34 offset:8448
ds_read_b64_tr_b16 v[20:21], v34 offset:12288
ds_read_b64_tr_b16 v[22:23], v34 offset:12544
ds_read_b64_tr_b16 v[24:25], v35 offset:8192
ds_read_b64_tr_b16 v[26:27], v35 offset:8448
ds_read_b64_tr_b16 v[28:29], v35 offset:12288
ds_read_b64_tr_b16 v[30:31], v35 offset:12544
s_waitcnt lgkmcnt(0)
s_barrier
s_xor_b32 s32, s39, 0x40000
buffer_load_dword v82, v81, s[8:11], s32 offen
s_xor_b32 s32, s35, 0x40000
s_add_u32 m0, s36, 8192
s_nop 0
buffer_load_dwordx4 v65, s[8:11], s32 offen lds
s_xor_b32 s32, s35, 0x48000
s_add_u32 m0, s36, 9216
s_nop 0
buffer_load_dwordx4 v65, s[8:11], s32 offen lds
s_xor_b32 s32, s35, 0x50000
s_add_u32 m0, s36, 10240
s_nop 0
buffer_load_dwordx4 v65, s[8:11], s32 offen lds
s_xor_b32 s32, s35, 0x58000
s_add_u32 m0, s36, 11264
s_nop 0
buffer_load_dwordx4 v65, s[8:11], s32 offen lds
s_xor_b32 s32, s35, 0x60000
s_add_u32 m0, s36, 12288
s_nop 0
buffer_load_dwordx4 v65, s[8:11], s32 offen lds
s_xor_b32 s32, s35, 0x68000
s_add_u32 m0, s36, 13312
s_nop 0
buffer_load_dwordx4 v65, s[8:11], s32 offen lds
s_xor_b32 s32, s35, 0x70000
s_add_u32 m0, s36, 14336
s_nop 0
buffer_load_dwordx4 v65, s[8:11], s32 offen lds
s_xor_b32 s32, s35, 0x78000
s_add_u32 m0, s36, 15360
s_nop 0
buffer_load_dwordx4 v65, s[8:11], s32 offen lds
v_lshlrev_b32 v42, 16, v0
v_and_b32 v43, 0xffff0000, v0
v_cvt_pk_f16_f32 v0, v42, v43
v_lshlrev_b32 v44, 16, v1
v_and_b32 v45, 0xffff0000, v1
v_cvt_pk_f16_f32 v1, v44, v45
v_lshlrev_b32 v42, 16, v2
v_and_b32 v43, 0xffff0000, v2
v_cvt_pk_f16_f32 v2, v42, v43
v_lshlrev_b32 v44, 16, v3
v_and_b32 v45, 0xffff0000, v3
v_cvt_pk_f16_f32 v3, v44, v45
v_lshlrev_b32 v42, 16, v4
v_and_b32 v43, 0xffff0000, v4
v_cvt_pk_f16_f32 v4, v42, v43
v_lshlrev_b32 v44, 16, v5
v_and_b32 v45, 0xffff0000, v5
v_cvt_pk_f16_f32 v5, v44, v45
v_lshlrev_b32 v42, 16, v6
v_and_b32 v43, 0xffff0000, v6
v_cvt_pk_f16_f32 v6, v42, v43
v_lshlrev_b32 v44, 16, v7
v_and_b32 v45, 0xffff0000, v7
v_cvt_pk_f16_f32 v7, v44, v45
v_accvgpr_write_b32 a8, v0
v_accvgpr_write_b32 a9, v1
v_accvgpr_write_b32 a10, v2
v_accvgpr_write_b32 a11, v3
v_accvgpr_write_b32 a12, v4
v_accvgpr_write_b32 a13, v5
v_accvgpr_write_b32 a14, v6
v_accvgpr_write_b32 a15, v7
v_lshlrev_b32 v42, 16, v8
v_and_b32 v43, 0xffff0000, v8
v_cvt_pk_f16_f32 v8, v42, v43
v_lshlrev_b32 v44, 16, v9
v_and_b32 v45, 0xffff0000, v9
v_cvt_pk_f16_f32 v9, v44, v45
v_lshlrev_b32 v42, 16, v10
v_and_b32 v43, 0xffff0000, v10
v_cvt_pk_f16_f32 v10, v42, v43
v_lshlrev_b32 v44, 16, v11
v_and_b32 v45, 0xffff0000, v11
v_cvt_pk_f16_f32 v11, v44, v45
v_lshlrev_b32 v42, 16, v12
v_and_b32 v43, 0xffff0000, v12
v_cvt_pk_f16_f32 v12, v42, v43
v_lshlrev_b32 v44, 16, v13
v_and_b32 v45, 0xffff0000, v13
v_cvt_pk_f16_f32 v13, v44, v45
v_lshlrev_b32 v42, 16, v14
v_and_b32 v43, 0xffff0000, v14
v_cvt_pk_f16_f32 v14, v42, v43
v_lshlrev_b32 v44, 16, v15
v_and_b32 v45, 0xffff0000, v15
v_cvt_pk_f16_f32 v15, v44, v45
v_accvgpr_write_b32 a40, v8
v_accvgpr_write_b32 a41, v9
v_accvgpr_write_b32 a42, v10
v_accvgpr_write_b32 a43, v11
v_accvgpr_write_b32 a44, v12
v_accvgpr_write_b32 a45, v13
v_accvgpr_write_b32 a46, v14
v_accvgpr_write_b32 a47, v15
v_lshlrev_b32 v42, 16, v16
v_and_b32 v43, 0xffff0000, v16
v_cvt_pk_f16_f32 v16, v42, v43
v_lshlrev_b32 v44, 16, v17
v_and_b32 v45, 0xffff0000, v17
v_cvt_pk_f16_f32 v17, v44, v45
v_lshlrev_b32 v42, 16, v18
v_and_b32 v43, 0xffff0000, v18
v_cvt_pk_f16_f32 v18, v42, v43
v_lshlrev_b32 v44, 16, v19
v_and_b32 v45, 0xffff0000, v19
v_cvt_pk_f16_f32 v19, v44, v45
v_lshlrev_b32 v42, 16, v20
v_and_b32 v43, 0xffff0000, v20
v_cvt_pk_f16_f32 v20, v42, v43
v_lshlrev_b32 v44, 16, v21
v_and_b32 v45, 0xffff0000, v21
v_cvt_pk_f16_f32 v21, v44, v45
v_lshlrev_b32 v42, 16, v22
v_and_b32 v43, 0xffff0000, v22
v_cvt_pk_f16_f32 v22, v42, v43
v_lshlrev_b32 v44, 16, v23
v_and_b32 v45, 0xffff0000, v23
v_cvt_pk_f16_f32 v23, v44, v45
v_accvgpr_write_b32 a72, v16
v_accvgpr_write_b32 a73, v17
v_accvgpr_write_b32 a74, v18
v_accvgpr_write_b32 a75, v19
v_accvgpr_write_b32 a76, v20
v_accvgpr_write_b32 a77, v21
v_accvgpr_write_b32 a78, v22
v_accvgpr_write_b32 a79, v23
v_lshlrev_b32 v42, 16, v24
v_and_b32 v43, 0xffff0000, v24
v_cvt_pk_f16_f32 v24, v42, v43
v_lshlrev_b32 v44, 16, v25
v_and_b32 v45, 0xffff0000, v25
v_cvt_pk_f16_f32 v25, v44, v45
v_lshlrev_b32 v42, 16, v26
v_and_b32 v43, 0xffff0000, v26
v_cvt_pk_f16_f32 v26, v42, v43
v_lshlrev_b32 v44, 16, v27
v_and_b32 v45, 0xffff0000, v27
v_cvt_pk_f16_f32 v27, v44, v45
v_lshlrev_b32 v42, 16, v28
v_and_b32 v43, 0xffff0000, v28
v_cvt_pk_f16_f32 v28, v42, v43
v_lshlrev_b32 v44, 16, v29
v_and_b32 v45, 0xffff0000, v29
v_cvt_pk_f16_f32 v29, v44, v45
v_lshlrev_b32 v42, 16, v30
v_and_b32 v43, 0xffff0000, v30
v_cvt_pk_f16_f32 v30, v42, v43
v_lshlrev_b32 v44, 16, v31
v_and_b32 v45, 0xffff0000, v31
v_cvt_pk_f16_f32 v31, v44, v45
v_accvgpr_write_b32 a104, v24
v_accvgpr_write_b32 a105, v25
v_accvgpr_write_b32 a106, v26
v_accvgpr_write_b32 a107, v27
v_accvgpr_write_b32 a108, v28
v_accvgpr_write_b32 a109, v29
v_accvgpr_write_b32 a110, v30
v_accvgpr_write_b32 a111, v31
s_waitcnt vmcnt(27)
v_readlane_b32 s48, v72, 0
v_readlane_b32 s49, v72, 1
v_readlane_b32 s50, v72, 2
v_readlane_b32 s51, v72, 3
v_readlane_b32 s52, v72, 4
v_readlane_b32 s53, v72, 5
v_readlane_b32 s54, v72, 6
v_readlane_b32 s55, v72, 7
v_readlane_b32 s38, v72, 8
s_nop 3
s_add_u32 s33, s48, s49
s_add_u32 s33, s33, s50
s_add_u32 s33, s33, s51
s_add_u32 s33, s33, s52
s_add_u32 s33, s33, s53
s_add_u32 s33, s33, s54
s_add_u32 s33, s33, s55
s_cmp_ge_u32 s38, 4
s_cselect_b32 s33, s33, 0
s_cmp_ge_u32 s33, 256
s_cselect_b32 s38, 0, 1
s_barrier
ds_read_b64_tr_b16 v[0:1], v32 offset:16384
ds_read_b64_tr_b16 v[2:3], v32 offset:16640
ds_read_b64_tr_b16 v[4:5], v32 offset:20480
ds_read_b64_tr_b16 v[6:7], v32 offset:20736
ds_read_b64_tr_b16 v[8:9], v33 offset:16384
ds_read_b64_tr_b16 v[10:11], v33 offset:16640
ds_read_b64_tr_b16 v[12:13], v33 offset:20480
ds_read_b64_tr_b16 v[14:15], v33 offset:20736
ds_read_b64_tr_b16 v[16:17], v34 offset:16384
ds_read_b64_tr_b16 v[18:19], v34 offset:16640
ds_read_b64_tr_b16 v[20:21], v34 offset:20480
ds_read_b64_tr_b16 v[22:23], v34 offset:20736
ds_read_b64_tr_b16 v[24:25], v35 offset:16384
ds_read_b64_tr_b16 v[26:27], v35 offset:16640
ds_read_b64_tr_b16 v[28:29], v35 offset:20480
ds_read_b64_tr_b16 v[30:31], v35 offset:20736
s_waitcnt lgkmcnt(0)
s_barrier
s_xor_b32 s32, s39, 0x80000
buffer_load_dword v82, v81, s[8:11], s32 offen
s_xor_b32 s32, s35, 0x80000
s_add_u32 m0, s36, 16384
s_nop 0
buffer_load_dwordx4 v65, s[8:11], s32 offen lds
s_xor_b32 s32, s35, 0x88000
s_add_u32 m0, s36, 17408
s_nop 0
buffer_load_dwordx4 v65, s[8:11], s32 offen lds
s_xor_b32 s32, s35, 0x90000
s_add_u32 m0, s36, 18432
s_nop 0
buffer_load_dwordx4 v65, s[8:11], s32 offen lds
s_xor_b32 s32, s35, 0x98000
s_add_u32 m0, s36, 19456
s_nop 0
buffer_load_dwordx4 v65, s[8:11], s32 offen lds
s_xor_b32 s32, s35, 0xa0000
s_add_u32 m0, s36, 20480
s_nop 0
buffer_load_dwordx4 v65, s[8:11], s32 offen lds
s_xor_b32 s32, s35, 0xa8000
s_add_u32 m0, s36, 21504
s_nop 0
buffer_load_dwordx4 v65, s[8:11], s32 offen lds
s_xor_b32 s32, s35, 0xb0000
s_add_u32 m0, s36, 22528
s_nop 0
buffer_load_dwordx4 v65, s[8:11], s32 offen lds
s_xor_b32 s32, s35, 0xb8000
s_add_u32 m0, s36, 23552
s_nop 0
buffer_load_dwordx4 v65, s[8:11], s32 offen lds
v_lshlrev_b32 v42, 16, v0
v_and_b32 v43, 0xffff0000, v0
v_cvt_pk_f16_f32 v0, v42, v43
v_lshlrev_b32 v44, 16, v1
v_and_b32 v45, 0xffff0000, v1
v_cvt_pk_f16_f32 v1, v44, v45
v_lshlrev_b32 v42, 16, v2
v_and_b32 v43, 0xffff0000, v2
v_cvt_pk_f16_f32 v2, v42, v43
v_lshlrev_b32 v44, 16, v3
v_and_b32 v45, 0xffff0000, v3
v_cvt_pk_f16_f32 v3, v44, v45
v_lshlrev_b32 v42, 16, v4
v_and_b32 v43, 0xffff0000, v4
v_cvt_pk_f16_f32 v4, v42, v43
v_lshlrev_b32 v44, 16, v5
v_and_b32 v45, 0xffff0000, v5
v_cvt_pk_f16_f32 v5, v44, v45
v_lshlrev_b32 v42, 16, v6
v_and_b32 v43, 0xffff0000, v6
v_cvt_pk_f16_f32 v6, v42, v43
v_lshlrev_b32 v44, 16, v7
v_and_b32 v45, 0xffff0000, v7
v_cvt_pk_f16_f32 v7, v44, v45
v_accvgpr_write_b32 a16, v0
v_accvgpr_write_b32 a17, v1
v_accvgpr_write_b32 a18, v2
v_accvgpr_write_b32 a19, v3
v_accvgpr_write_b32 a20, v4
v_accvgpr_write_b32 a21, v5
v_accvgpr_write_b32 a22, v6
v_accvgpr_write_b32 a23, v7
v_lshlrev_b32 v42, 16, v8
v_and_b32 v43, 0xffff0000, v8
v_cvt_pk_f16_f32 v8, v42, v43
v_lshlrev_b32 v44, 16, v9
v_and_b32 v45, 0xffff0000, v9
v_cvt_pk_f16_f32 v9, v44, v45
v_lshlrev_b32 v42, 16, v10
v_and_b32 v43, 0xffff0000, v10
v_cvt_pk_f16_f32 v10, v42, v43
v_lshlrev_b32 v44, 16, v11
v_and_b32 v45, 0xffff0000, v11
v_cvt_pk_f16_f32 v11, v44, v45
v_lshlrev_b32 v42, 16, v12
v_and_b32 v43, 0xffff0000, v12
v_cvt_pk_f16_f32 v12, v42, v43
v_lshlrev_b32 v44, 16, v13
v_and_b32 v45, 0xffff0000, v13
v_cvt_pk_f16_f32 v13, v44, v45
v_lshlrev_b32 v42, 16, v14
v_and_b32 v43, 0xffff0000, v14
v_cvt_pk_f16_f32 v14, v42, v43
v_lshlrev_b32 v44, 16, v15
v_and_b32 v45, 0xffff0000, v15
v_cvt_pk_f16_f32 v15, v44, v45
v_accvgpr_write_b32 a48, v8
v_accvgpr_write_b32 a49, v9
v_accvgpr_write_b32 a50, v10
v_accvgpr_write_b32 a51, v11
v_accvgpr_write_b32 a52, v12
v_accvgpr_write_b32 a53, v13
v_accvgpr_write_b32 a54, v14
v_accvgpr_write_b32 a55, v15
v_lshlrev_b32 v42, 16, v16
v_and_b32 v43, 0xffff0000, v16
v_cvt_pk_f16_f32 v16, v42, v43
v_lshlrev_b32 v44, 16, v17
v_and_b32 v45, 0xffff0000, v17
v_cvt_pk_f16_f32 v17, v44, v45
v_lshlrev_b32 v42, 16, v18
v_and_b32 v43, 0xffff0000, v18
v_cvt_pk_f16_f32 v18, v42, v43
v_lshlrev_b32 v44, 16, v19
v_and_b32 v45, 0xffff0000, v19
v_cvt_pk_f16_f32 v19, v44, v45
v_lshlrev_b32 v42, 16, v20
v_and_b32 v43, 0xffff0000, v20
v_cvt_pk_f16_f32 v20, v42, v43
v_lshlrev_b32 v44, 16, v21
v_and_b32 v45, 0xffff0000, v21
v_cvt_pk_f16_f32 v21, v44, v45
v_lshlrev_b32 v42, 16, v22
v_and_b32 v43, 0xffff0000, v22
v_cvt_pk_f16_f32 v22, v42, v43
v_lshlrev_b32 v44, 16, v23
v_and_b32 v45, 0xffff0000, v23
v_cvt_pk_f16_f32 v23, v44, v45
v_accvgpr_write_b32 a80, v16
v_accvgpr_write_b32 a81, v17
v_accvgpr_write_b32 a82, v18
v_accvgpr_write_b32 a83, v19
v_accvgpr_write_b32 a84, v20
v_accvgpr_write_b32 a85, v21
v_accvgpr_write_b32 a86, v22
v_accvgpr_write_b32 a87, v23
v_lshlrev_b32 v42, 16, v24
v_and_b32 v43, 0xffff0000, v24
v_cvt_pk_f16_f32 v24, v42, v43
v_lshlrev_b32 v44, 16, v25
v_and_b32 v45, 0xffff0000, v25
v_cvt_pk_f16_f32 v25, v44, v45
v_lshlrev_b32 v42, 16, v26
v_and_b32 v43, 0xffff0000, v26
v_cvt_pk_f16_f32 v26, v42, v43
v_lshlrev_b32 v44, 16, v27
v_and_b32 v45, 0xffff0000, v27
v_cvt_pk_f16_f32 v27, v44, v45
v_lshlrev_b32 v42, 16, v28
v_and_b32 v43, 0xffff0000, v28
v_cvt_pk_f16_f32 v28, v42, v43
v_lshlrev_b32 v44, 16, v29
v_and_b32 v45, 0xffff0000, v29
v_cvt_pk_f16_f32 v29, v44, v45
v_lshlrev_b32 v42, 16, v30
v_and_b32 v43, 0xffff0000, v30
v_cvt_pk_f16_f32 v30, v42, v43
v_lshlrev_b32 v44, 16, v31
v_and_b32 v45, 0xffff0000, v31
v_cvt_pk_f16_f32 v31, v44, v45
v_accvgpr_write_b32 a112, v24
v_accvgpr_write_b32 a113, v25
v_accvgpr_write_b32 a114, v26
v_accvgpr_write_b32 a115, v27
v_accvgpr_write_b32 a116, v28
v_accvgpr_write_b32 a117, v29
v_accvgpr_write_b32 a118, v30
v_accvgpr_write_b32 a119, v31
s_waitcnt vmcnt(27)
s_barrier
ds_read_b64_tr_b16 v[0:1], v32 offset:24576
ds_read_b64_tr_b16 v[2:3], v32 offset:24832
ds_read_b64_tr_b16 v[4:5], v32 offset:28672
ds_read_b64_tr_b16 v[6:7], v32 offset:28928
ds_read_b64_tr_b16 v[8:9], v33 offset:24576
ds_read_b64_tr_b16 v[10:11], v33 offset:24832
ds_read_b64_tr_b16 v[12:13], v33 offset:28672
ds_read_b64_tr_b16 v[14:15], v33 offset:28928
ds_read_b64_tr_b16 v[16:17], v34 offset:24576
ds_read_b64_tr_b16 v[18:19], v34 offset:24832
ds_read_b64_tr_b16 v[20:21], v34 offset:28672
ds_read_b64_tr_b16 v[22:23], v34 offset:28928
ds_read_b64_tr_b16 v[24:25], v35 offset:24576
ds_read_b64_tr_b16 v[26:27], v35 offset:24832
ds_read_b64_tr_b16 v[28:29], v35 offset:28672
ds_read_b64_tr_b16 v[30:31], v35 offset:28928
s_waitcnt lgkmcnt(0)
s_barrier
s_xor_b32 s32, s39, 0xc0000
buffer_load_dword v82, v81, s[8:11], s32 offen
s_xor_b32 s32, s35, 0xc0000
s_add_u32 m0, s36, 24576
s_nop 0
buffer_load_dwordx4 v65, s[8:11], s32 offen lds
s_xor_b32 s32, s35, 0xc8000
s_add_u32 m0, s36, 25600
s_nop 0
buffer_load_dwordx4 v65, s[8:11], s32 offen lds
s_xor_b32 s32, s35, 0xd0000
s_add_u32 m0, s36, 26624
s_nop 0
buffer_load_dwordx4 v65, s[8:11], s32 offen lds
s_xor_b32 s32, s35, 0xd8000
s_add_u32 m0, s36, 27648
s_nop 0
buffer_load_dwordx4 v65, s[8:11], s32 offen lds
s_xor_b32 s32, s35, 0xe0000
s_add_u32 m0, s36, 28672
s_nop 0
buffer_load_dwordx4 v65, s[8:11], s32 offen lds
s_xor_b32 s32, s35, 0xe8000
s_add_u32 m0, s36, 29696
s_nop 0
buffer_load_dwordx4 v65, s[8:11], s32 offen lds
s_xor_b32 s32, s35, 0xf0000
s_add_u32 m0, s36, 30720
s_nop 0
buffer_load_dwordx4 v65, s[8:11], s32 offen lds
s_xor_b32 s32, s35, 0xf8000
s_add_u32 m0, s36, 31744
s_nop 0
buffer_load_dwordx4 v65, s[8:11], s32 offen lds
v_lshlrev_b32 v42, 16, v0
v_and_b32 v43, 0xffff0000, v0
v_cvt_pk_f16_f32 v0, v42, v43
v_lshlrev_b32 v44, 16, v1
v_and_b32 v45, 0xffff0000, v1
v_cvt_pk_f16_f32 v1, v44, v45
v_lshlrev_b32 v42, 16, v2
v_and_b32 v43, 0xffff0000, v2
v_cvt_pk_f16_f32 v2, v42, v43
v_lshlrev_b32 v44, 16, v3
v_and_b32 v45, 0xffff0000, v3
v_cvt_pk_f16_f32 v3, v44, v45
v_lshlrev_b32 v42, 16, v4
v_and_b32 v43, 0xffff0000, v4
v_cvt_pk_f16_f32 v4, v42, v43
v_lshlrev_b32 v44, 16, v5
v_and_b32 v45, 0xffff0000, v5
v_cvt_pk_f16_f32 v5, v44, v45
v_lshlrev_b32 v42, 16, v6
v_and_b32 v43, 0xffff0000, v6
v_cvt_pk_f16_f32 v6, v42, v43
v_lshlrev_b32 v44, 16, v7
v_and_b32 v45, 0xffff0000, v7
v_cvt_pk_f16_f32 v7, v44, v45
v_accvgpr_write_b32 a24, v0
v_accvgpr_write_b32 a25, v1
v_accvgpr_write_b32 a26, v2
v_accvgpr_write_b32 a27, v3
v_accvgpr_write_b32 a28, v4
v_accvgpr_write_b32 a29, v5
v_accvgpr_write_b32 a30, v6
v_accvgpr_write_b32 a31, v7
v_lshlrev_b32 v42, 16, v8
v_and_b32 v43, 0xffff0000, v8
v_cvt_pk_f16_f32 v8, v42, v43
v_lshlrev_b32 v44, 16, v9
v_and_b32 v45, 0xffff0000, v9
v_cvt_pk_f16_f32 v9, v44, v45
v_lshlrev_b32 v42, 16, v10
v_and_b32 v43, 0xffff0000, v10
v_cvt_pk_f16_f32 v10, v42, v43
v_lshlrev_b32 v44, 16, v11
v_and_b32 v45, 0xffff0000, v11
v_cvt_pk_f16_f32 v11, v44, v45
v_lshlrev_b32 v42, 16, v12
v_and_b32 v43, 0xffff0000, v12
v_cvt_pk_f16_f32 v12, v42, v43
v_lshlrev_b32 v44, 16, v13
v_and_b32 v45, 0xffff0000, v13
v_cvt_pk_f16_f32 v13, v44, v45
v_lshlrev_b32 v42, 16, v14
v_and_b32 v43, 0xffff0000, v14
v_cvt_pk_f16_f32 v14, v42, v43
v_lshlrev_b32 v44, 16, v15
v_and_b32 v45, 0xffff0000, v15
v_cvt_pk_f16_f32 v15, v44, v45
v_accvgpr_write_b32 a56, v8
v_accvgpr_write_b32 a57, v9
v_accvgpr_write_b32 a58, v10
v_accvgpr_write_b32 a59, v11
v_accvgpr_write_b32 a60, v12
v_accvgpr_write_b32 a61, v13
v_accvgpr_write_b32 a62, v14
v_accvgpr_write_b32 a63, v15
v_lshlrev_b32 v42, 16, v16
v_and_b32 v43, 0xffff0000, v16
v_cvt_pk_f16_f32 v16, v42, v43
v_lshlrev_b32 v44, 16, v17
v_and_b32 v45, 0xffff0000, v17
v_cvt_pk_f16_f32 v17, v44, v45
v_lshlrev_b32 v42, 16, v18
v_and_b32 v43, 0xffff0000, v18
v_cvt_pk_f16_f32 v18, v42, v43
v_lshlrev_b32 v44, 16, v19
v_and_b32 v45, 0xffff0000, v19
v_cvt_pk_f16_f32 v19, v44, v45
v_lshlrev_b32 v42, 16, v20
v_and_b32 v43, 0xffff0000, v20
v_cvt_pk_f16_f32 v20, v42, v43
v_lshlrev_b32 v44, 16, v21
v_and_b32 v45, 0xffff0000, v21
v_cvt_pk_f16_f32 v21, v44, v45
v_lshlrev_b32 v42, 16, v22
v_and_b32 v43, 0xffff0000, v22
v_cvt_pk_f16_f32 v22, v42, v43
v_lshlrev_b32 v44, 16, v23
v_and_b32 v45, 0xffff0000, v23
v_cvt_pk_f16_f32 v23, v44, v45
v_accvgpr_write_b32 a88, v16
v_accvgpr_write_b32 a89, v17
v_accvgpr_write_b32 a90, v18
v_accvgpr_write_b32 a91, v19
v_accvgpr_write_b32 a92, v20
v_accvgpr_write_b32 a93, v21
v_accvgpr_write_b32 a94, v22
v_accvgpr_write_b32 a95, v23
v_lshlrev_b32 v42, 16, v24
v_and_b32 v43, 0xffff0000, v24
v_cvt_pk_f16_f32 v24, v42, v43
v_lshlrev_b32 v44, 16, v25
v_and_b32 v45, 0xffff0000, v25
v_cvt_pk_f16_f32 v25, v44, v45
v_lshlrev_b32 v42, 16, v26
v_and_b32 v43, 0xffff0000, v26
v_cvt_pk_f16_f32 v26, v42, v43
v_lshlrev_b32 v44, 16, v27
v_and_b32 v45, 0xffff0000, v27
v_cvt_pk_f16_f32 v27, v44, v45
v_lshlrev_b32 v42, 16, v28
v_and_b32 v43, 0xffff0000, v28
v_cvt_pk_f16_f32 v28, v42, v43
v_lshlrev_b32 v44, 16, v29
v_and_b32 v45, 0xffff0000, v29
v_cvt_pk_f16_f32 v29, v44, v45
v_lshlrev_b32 v42, 16, v30
v_and_b32 v43, 0xffff0000, v30
v_cvt_pk_f16_f32 v30, v42, v43
v_lshlrev_b32 v44, 16, v31
v_and_b32 v45, 0xffff0000, v31
v_cvt_pk_f16_f32 v31, v44, v45
v_accvgpr_write_b32 a120, v24
v_accvgpr_write_b32 a121, v25
v_accvgpr_write_b32 a122, v26
v_accvgpr_write_b32 a123, v27
v_accvgpr_write_b32 a124, v28
v_accvgpr_write_b32 a125, v29
v_accvgpr_write_b32 a126, v30
v_accvgpr_write_b32 a127, v31
v_and_b32 v64, 15, v94
v_lshrrev_b32 v65, 4, v94
v_bfe_u32 v126, v94, 4, 1
v_lshlrev_b32 v126, 2, v126
v_sub_u32 v126, v64, v126
v_mov_b32 v66, 0x3f80
v_mov_b32 v67, 0x3f800000
s_and_b32 s33, s14, 1
s_lshl_b32 s32, s33, 3
v_subrev_u32 v71, s32, v126
v_lshrrev_b32 v70, 3, v64
v_and_b32 v69, 5, v64
v_lshl_add_u32 v69, v70, 1, v69
v_sub_u32 v126, v126, v64
v_add_u32 v126, v126, v69
v_and_b32 v70, 2, v64
v_lshl_add_u32 v126, v70, 4, v126
v_cmp_eq_u32 vcc, 32, v126
s_nop 1
v_cndmask_b32 v127, 0, v66, vcc
v_cmp_eq_u32 vcc, 33, v126
s_nop 1
v_cndmask_b32 v104, v127, v67, vcc
v_mov_b32 v106, v104
v_cmp_eq_u32 vcc, 34, v126
s_nop 1
v_cndmask_b32 v127, 0, v66, vcc
v_cmp_eq_u32 vcc, 35, v126
s_nop 1
v_cndmask_b32 v105, v127, v67, vcc
v_mov_b32 v107, v105
v_cmp_eq_u32 vcc, 0, v126
s_nop 1
v_cndmask_b32 v127, 0, v66, vcc
v_cmp_eq_u32 vcc, 1, v126
s_nop 1
v_cndmask_b32 v108, v127, v67, vcc
v_mov_b32 v110, v108
v_mov_b32 v106, v108
v_cmp_eq_u32 vcc, 2, v126
s_nop 1
v_cndmask_b32 v127, 0, v66, vcc
v_cmp_eq_u32 vcc, 3, v126
s_nop 1
v_cndmask_b32 v109, v127, v67, vcc
v_mov_b32 v111, v109
v_mov_b32 v107, v109
v_mov_b32 v127, 0x4444
v_mov_b32 v95, 0xeeee
v_cmp_gt_u32 vcc, 8, v64
s_nop 1
v_cndmask_b32 v112, v95, v127, vcc
v_lshrrev_b32 v126, 1, v65
v_lshlrev_b32 v126, 7, v126
v_lshl_add_u32 v126, v64, 4, v126
v_and_b32 v127, 1, v65
v_lshl_add_u32 v126, v127, 3, v126
v_mov_b32 v95, 0x7f000000
v_cndmask_b32 v118, v95, v126, vcc
v_lshlrev_b32 v126, 3, v64
v_lshl_add_u32 v126, v127, 7, v126
v_cmp_le_u32 vcc, 2, v65
s_nop 1
v_cndmask_b32 v120, v95, v126, vcc
v_mov_b32 v126, 0xf149f2ca
v_cndmask_b32 v124, v126, 0, vcc
v_lshrrev_b32 v126, 3, v64
v_cmp_eq_u32 vcc, s33, v126
v_and_b32 v126, 7, v64
v_lshlrev_b32 v126, 4, v126
v_lshl_add_u32 v126, v65, 7, v126
v_cndmask_b32 v117, v95, v116, vcc
v_cndmask_b32 v119, v95, v126, vcc
s_lshl_b32 s32, s14, 11
v_add_u32 v114, s32, v116
s_lshr_b32 s32, s14, 1
s_lshl_b32 s32, s32, 10
s_lshl_b32 s33, s33, 3
s_add_u32 s32, s32, s33
v_add_u32 v115, s32, v116
v_lshrrev_b32 v126, 3, v64
v_lshl_add_u32 v125, v126, 11, v116
v_lshrrev_b32 v71, 1, v65
v_cmp_ne_u32 vcc, 0, v70
v_lshlrev_b32 v126, 4, v64
v_lshl_add_u32 v126, v127, 8, v126
v_lshl_add_u32 v117, v71, 3, v126
v_lshrrev_b32 v120, 1, v117
v_lshlrev_b32 v69, 4, v69
v_lshl_add_u32 v126, v127, 7, v69
v_lshl_add_u32 v126, v71, 3, v126
v_cndmask_b32 v119, v126, v95, vcc
v_lshl_add_u32 v126, v71, 7, v69
v_lshl_add_u32 v126, v127, 3, v126
v_cndmask_b32 v125, v126, v95, vcc
v_cndmask_b32 v118, v95, v126, vcc
s_mov_b32 s17, 0
s_lshl_b32 s32, s12, 14
s_lshl_b32 s33, s14, 12
s_add_u32 s18, s32, s33
s_xor_b32 s33, s14, s13
s_and_b32 s33, s33, 3
s_lshl_b32 s33, s33, 10
s_add_u32 s18, s18, s33
s_xor_b32 s19, s18, 0x4000
s_add_u32 s18, s18, 0x6c30000
s_add_u32 s19, s19, 0x6c38000
s_lshl_b32 s20, s15, 12
s_add_u32 s20, s20, 0x6c00000
s_lshl_b32 s32, s16, 11
s_lshl_b32 s33, s14, 9
s_add_u32 s32, s32, s33
s_add_u32 s21, s20, s32
s_lshl_b32 s32, s16, 11
s_xor_b32 s32, s32, 2048
s_add_u32 s20, s20, s32
s_lshl_b32 s32, s12, 15
s_add_u32 s32, s32, 0x6c20000
s_lshl_b32 s33, s13, 10
s_add_u32 s22, s32, s33
s_lshl_b32 s33, s14, 8
s_add_u32 s22, s22, s33
s_lshl_b32 s33, s14, 13
s_add_u32 s23, s32, s33
s_add_u32 s24, s23, 4096
s_xor_b32 s33, s14, s13
s_and_b32 s33, s33, 7
s_lshl_b32 s33, s33, 10
s_add_u32 s23, s23, s33
s_lshl_b32 s32, s12, 14
s_lshl_b32 s33, s13, 9
s_add_u32 s32, s32, s33
s_bitcmp1_b32 s14, 0
s_cselect_b32 s33, 256, 0
s_add_u32 s32, s32, s33
s_add_u32 s25, s32, 0x6c30000
s_lshl_b32 s32, s16, 6
s_lshl_b32 s33, s14, 4
s_add_u32 s32, s32, s33
s_lshl_b32 s33, s15, 7
s_add_u32 s32, s32, s33
s_lshl_b32 s26, s32, 4
s_add_u32 s26, s26, 0x6e00000
s_lshl_b32 s37, s15, 2
s_lshl_b32 s33, s16, 1
s_add_u32 s37, s37, s33
s_lshr_b32 s33, s14, 1
s_add_u32 s37, s37, s33
s_lshl_b32 s37, s37, 9
s_add_u32 s37, s37, 0x8000000
s_bitcmp1_b32 s14, 0
s_cselect_b32 s33, 256, 0
s_add_u32 s37, s37, s33
s_lshl_b32 s28, s32, 6
s_add_u32 s28, s28, 0x2800000
s_lshl_b32 s27, s15, 12
s_lshl_b32 s36, s14, 11
s_and_b32 s33, s36, 2048
s_lshl_b32 s32, s16, 11
s_xor_b32 s33, s33, s32
s_add_u32 s27, s27, s33
s_lshr_b32 s33, s14, 1
s_lshl_b32 s33, s33, 17
s_add_u32 s27, s27, s33
s_add_u32 s27, s27, 0x1800000
s_add_u32 s36, s36, 24576
s_mov_b32 s30, 0x3e0293ee
s_mov_b32 s31, 0xbe0293ee
v_mov_b32 v100, 0x3f803f80
v_mov_b32 v101, 0x3f803f80
v_mov_b32 v102, 0x3f803f80
v_mov_b32 v103, 0x3f803f80
v_mov_b32 v121, 0x7f000000
v_mov_b32 v122, 0
v_and_b32 v127, 1, v94
v_mov_b32 v77, 0x7f000000
s_lshl_b32 s32, s16, 3
s_lshl_b64 exec, 0xff, s32
s_add_u32 s32, s27, 0x40000
v_lshl_add_u32 v121, v64, 7, s32
v_mov_b32 v122, 0x40000
s_mov_b32 exec_lo, 0xff0000
s_add_u32 s32, s28, 0x40000
v_lshl_add_u32 v121, v64, 7, s32
v_mov_b32 v122, 0x40000
s_mov_b32 exec_lo, 0x000f000f
s_mov_b32 exec_hi, 0x000f000f
s_and_b32 s33, s14, 1
s_lshl_b32 s33, s33, 7
s_add_u32 s32, s21, s33
v_lshl_add_u32 v77, v64, 7, s21
s_mov_b32 exec_lo, 0x00300030
s_mov_b32 exec_hi, 0x00300030
v_lshl_add_u32 v77, v127, 7, s22
s_mov_b32 exec_lo, 0x00400040
s_mov_b32 exec_hi, 0x00400040
s_lshl_b32 s32, s12, 14
s_lshl_b32 s33, s13, 9
s_add_u32 s33, s32, s33
s_add_u32 s33, s33, 0x6c30000
s_andn2_b32 s3, s33, 0x3ff
s_andn2_b32 s34, s22, 0x3ff
s_cmp_eq_u32 s14, 1
s_cselect_b32 s3, s34, s3
s_bitcmp0_b32 s14, 0
s_cselect_b32 s3, s21, s3
s_add_u32 s3, s3, 0x80000
s_lshl_b32 s34, s14, 7
s_add_u32 s33, s33, s34
v_mov_b32 v77, s33
s_mov_b32 exec_lo, 0x00800080
s_mov_b32 exec_hi, 0x00800080
s_add_u32 s32, s32, s34
s_add_u32 s32, s32, 0x6c38000
v_mov_b32 v77, s32
s_mov_b64 exec, -1
v_lshl_add_u32 v77, v65, 18, v77
s_mov_b32 exec_lo, 0
s_mov_b32 exec_hi, 0x300
s_lshl_b32 s32, s15, 2
s_add_u32 s32, s32, 0x8406000
v_lshl_add_u32 v121, v127, 13, s32
s_mov_b32 exec_hi, 0x3c00
s_mov_b32 s32, 0x8418158
v_lshl_add_u32 v121, v64, 2, s32
s_mov_b32 exec_hi, 0x3f00
v_mov_b32 v122, 128
s_mov_b64 exec, -1
s_lshl_b32 s32, s15, 3
s_lshl_b32 s33, s16, 2
s_add_u32 s32, s32, s33
s_add_u32 s32, s32, s14
s_mov_b32 s39, 0x7f000000
s_cmp_eq_u32 s32, 2
s_cselect_b32 s39, 0x841ec00, s39
s_waitcnt vmcnt(27)
ds_read_b64_tr_b16 v[0:1], v68 offset:0
ds_read_b64_tr_b16 v[2:3], v68 offset:128
ds_read_b64_tr_b16 v[4:5], v68 offset:2048
ds_read_b64_tr_b16 v[6:7], v68 offset:2176
ds_read_b64_tr_b16 v[8:9], v68 offset:32
ds_read_b64_tr_b16 v[10:11], v68 offset:160
ds_read_b64_tr_b16 v[12:13], v68 offset:2080
ds_read_b64_tr_b16 v[14:15], v68 offset:2208
ds_read_b64_tr_b16 v[16:17], v68 offset:4096
ds_read_b64_tr_b16 v[18:19], v68 offset:4224
ds_read_b64_tr_b16 v[20:21], v68 offset:6144
ds_read_b64_tr_b16 v[22:23], v68 offset:6272
ds_read_b64_tr_b16 v[24:25], v68 offset:4128
ds_read_b64_tr_b16 v[26:27], v68 offset:4256
ds_read_b64_tr_b16 v[28:29], v68 offset:6176
ds_read_b64_tr_b16 v[30:31], v68 offset:6304
s_waitcnt lgkmcnt(0)
ds_write_b128 v113, v[0:3] offset:0
ds_write_b128 v113, v[4:7] offset:1024
ds_write_b128 v113, v[8:11] offset:2048
ds_write_b128 v113, v[12:15] offset:3072
ds_write_b128 v113, v[16:19] offset:4096
ds_write_b128 v113, v[20:23] offset:5120
ds_write_b128 v113, v[24:27] offset:6144
ds_write_b128 v113, v[28:31] offset:7168
s_waitcnt lgkmcnt(0)
s_waitcnt vmcnt(18)
ds_read_b64_tr_b16 v[0:1], v68 offset:8192
ds_read_b64_tr_b16 v[2:3], v68 offset:8320
ds_read_b64_tr_b16 v[4:5], v68 offset:10240
ds_read_b64_tr_b16 v[6:7], v68 offset:10368
ds_read_b64_tr_b16 v[8:9], v68 offset:8224
ds_read_b64_tr_b16 v[10:11], v68 offset:8352
ds_read_b64_tr_b16 v[12:13], v68 offset:10272
ds_read_b64_tr_b16 v[14:15], v68 offset:10400
ds_read_b64_tr_b16 v[16:17], v68 offset:12288
ds_read_b64_tr_b16 v[18:19], v68 offset:12416
ds_read_b64_tr_b16 v[20:21], v68 offset:14336
ds_read_b64_tr_b16 v[22:23], v68 offset:14464
ds_read_b64_tr_b16 v[24:25], v68 offset:12320
ds_read_b64_tr_b16 v[26:27], v68 offset:12448
ds_read_b64_tr_b16 v[28:29], v68 offset:14368
ds_read_b64_tr_b16 v[30:31], v68 offset:14496
s_waitcnt lgkmcnt(0)
ds_write_b128 v113, v[0:3] offset:8192
ds_write_b128 v113, v[4:7] offset:9216
ds_write_b128 v113, v[8:11] offset:10240
ds_write_b128 v113, v[12:15] offset:11264
ds_write_b128 v113, v[16:19] offset:12288
ds_write_b128 v113, v[20:23] offset:13312
ds_write_b128 v113, v[24:27] offset:14336
ds_write_b128 v113, v[28:31] offset:15360
s_waitcnt lgkmcnt(0)
s_waitcnt vmcnt(9)
buffer_load_dword v76, v74, s[4:7], 0 offen sc1
buffer_load_dword v79, v75, s[4:7], 0 offen sc1
ds_read_b64_tr_b16 v[0:1], v68 offset:16384
ds_read_b64_tr_b16 v[2:3], v68 offset:16512
ds_read_b64_tr_b16 v[4:5], v68 offset:18432
ds_read_b64_tr_b16 v[6:7], v68 offset:18560
ds_read_b64_tr_b16 v[8:9], v68 offset:16416
ds_read_b64_tr_b16 v[10:11], v68 offset:16544
ds_read_b64_tr_b16 v[12:13], v68 offset:18464
ds_read_b64_tr_b16 v[14:15], v68 offset:18592
ds_read_b64_tr_b16 v[16:17], v68 offset:20480
ds_read_b64_tr_b16 v[18:19], v68 offset:20608
ds_read_b64_tr_b16 v[20:21], v68 offset:22528
ds_read_b64_tr_b16 v[22:23], v68 offset:22656
ds_read_b64_tr_b16 v[24:25], v68 offset:20512
ds_read_b64_tr_b16 v[26:27], v68 offset:20640
ds_read_b64_tr_b16 v[28:29], v68 offset:22560
ds_read_b64_tr_b16 v[30:31], v68 offset:22688
s_waitcnt lgkmcnt(0)
ds_write_b128 v113, v[0:3] offset:16384
ds_write_b128 v113, v[4:7] offset:17408
ds_write_b128 v113, v[8:11] offset:18432
ds_write_b128 v113, v[12:15] offset:19456
ds_write_b128 v113, v[16:19] offset:20480
ds_write_b128 v113, v[20:23] offset:21504
ds_write_b128 v113, v[24:27] offset:22528
ds_write_b128 v113, v[28:31] offset:23552
s_waitcnt lgkmcnt(0)
s_waitcnt vmcnt(2)
s_waitcnt vmcnt(0)
v_min_u32 v76, v76, v79
v_cmp_eq_u32 vcc, 0, v76
s_cmp_eq_u32 s38, 0
s_cbranch_scc0 main_kernel_c_sl0
s_cbranch_vccnz main_kernel_c_sl1
s_branch main_kernel_c_kv0_ok
main_kernel_c_sl0:
v_and_b32 v126, 7, v94
v_lshlrev_b32 v126, 5, v126
main_kernel_c_mode_cnt:
buffer_load_dword v127, v126, s[60:63], 0 offen sc1
s_waitcnt vmcnt(0)
v_readlane_b32 s48, v127, 0
v_readlane_b32 s49, v127, 1
v_readlane_b32 s50, v127, 2
v_readlane_b32 s51, v127, 3
v_readlane_b32 s52, v127, 4
v_readlane_b32 s53, v127, 5
v_readlane_b32 s54, v127, 6
v_readlane_b32 s55, v127, 7
s_nop 3
s_add_u32 s33, s48, s49
s_add_u32 s33, s33, s50
s_add_u32 s33, s33, s51
s_add_u32 s33, s33, s52
s_add_u32 s33, s33, s53
s_add_u32 s33, s33, s54
s_add_u32 s33, s33, s55
s_cmp_ge_u32 s33, 256
s_cbranch_scc1 main_kernel_c_mode_cnt_ok
s_sub_u32 s29, s29, 1
s_cbranch_scc1 main_kernel_end
s_sleep 4
s_branch main_kernel_c_mode_cnt
main_kernel_c_mode_cnt_ok:
v_mov_b32 v126, 0
main_kernel_c_wa:
buffer_load_dword v127, v126, s[60:63], 0 offen offset:12 sc1
s_waitcnt vmcnt(0)
v_cmp_gt_u32 vcc, 4, v127
s_cbranch_vccz main_kernel_c_wa_ok
s_sleep 4
s_sub_u32 s29, s29, 1
s_cbranch_scc0 main_kernel_c_wa
s_branch main_kernel_end
main_kernel_c_wa_ok:
main_kernel_c_sl1:
v_lshlrev_b32 v126, 2, v94
s_mov_b32 s32, 0x841f000
main_kernel_c_wf:
buffer_load_dword v0, v126, s[4:7], s32 offen sc1
s_waitcnt vmcnt(0)
v_cmp_eq_u32 vcc, 0, v0
s_cbranch_vccz main_kernel_c_wf_ok
s_sleep 4
s_sub_u32 s29, s29, 1
s_cbranch_scc0 main_kernel_c_wf
s_branch main_kernel_end
main_kernel_c_wf_ok:
s_mov_b32 exec_lo, 0
s_mov_b32 exec_hi, 0x300
v_subrev_u32 v127, 0, v121
main_kernel_c_kv0:
buffer_load_dword v126, v127, s[4:7], 0 offen sc1
s_waitcnt vmcnt(0)
v_cmp_eq_u32 vcc, 0, v126
s_cbranch_vccz main_kernel_c_kv0_ok
s_sleep 2
s_sub_u32 s29, s29, 1
s_cbranch_scc0 main_kernel_c_kv0
s_branch main_kernel_end
main_kernel_c_kv0_ok:
s_mov_b32 exec_lo, 0
s_mov_b32 exec_hi, 0x3f00
v_add_u32 v121, 128, v121
s_mov_b64 exec, -1
s_mov_b32 m0, s36
buffer_load_dwordx4 v[96:99], v116, s[4:7], s28 offen sc1
buffer_load_dwordx4 v116, s[4:7], s27 offen sc1 lds
buffer_load_dwordx4 v116, s[4:7], s27 offen offset:1024 sc1 lds
s_add_u32 s27, s27, 0x40000
buffer_load_dword v123, v77, s[4:7], 0 offen sc1
ds_read_b64_tr_b16 v[0:1], v68 offset:24576
ds_read_b64_tr_b16 v[2:3], v68 offset:24704
ds_read_b64_tr_b16 v[4:5], v68 offset:26624
ds_read_b64_tr_b16 v[6:7], v68 offset:26752
ds_read_b64_tr_b16 v[8:9], v68 offset:24608
ds_read_b64_tr_b16 v[10:11], v68 offset:24736
ds_read_b64_tr_b16 v[12:13], v68 offset:26656
ds_read_b64_tr_b16 v[14:15], v68 offset:26784
ds_read_b64_tr_b16 v[16:17], v68 offset:28672
ds_read_b64_tr_b16 v[18:19], v68 offset:28800
ds_read_b64_tr_b16 v[20:21], v68 offset:30720
ds_read_b64_tr_b16 v[22:23], v68 offset:30848
ds_read_b64_tr_b16 v[24:25], v68 offset:28704
ds_read_b64_tr_b16 v[26:27], v68 offset:28832
ds_read_b64_tr_b16 v[28:29], v68 offset:30752
ds_read_b64_tr_b16 v[30:31], v68 offset:30880
s_waitcnt lgkmcnt(0)
ds_write_b128 v113, v[0:3] offset:24576
ds_write_b128 v113, v[4:7] offset:25600
ds_write_b128 v113, v[8:11] offset:26624
ds_write_b128 v113, v[12:15] offset:27648
ds_write_b128 v113, v[16:19] offset:28672
ds_write_b128 v113, v[20:23] offset:29696
ds_write_b128 v113, v[24:27] offset:30720
ds_write_b128 v113, v[28:31] offset:31744
s_waitcnt lgkmcnt(0)
main_kernel_c_nb:
v_readfirstlane_b32 s33, v84
v_readfirstlane_b32 s32, v85
s_nop 3
s_and_b32 s34, s32, s33
s_cbranch_scc1 main_kernel_c_nb_ok
buffer_load_dwordx2 v[84:85], off, s[60:63], 0 offset:16 sc1
s_sub_u32 s29, s29, 1
s_cbranch_scc1 main_kernel_end
s_waitcnt vmcnt(0)
s_branch main_kernel_c_nb
main_kernel_c_nb_ok:
s_and_b32 s33, s33, 1
s_lshl_b32 s33, s33, 13
s_add_u32 s52, s33, 0x8c10000
s_and_b32 s32, s32, 1
s_lshl_b32 s32, s32, 13
s_sub_u32 s53, s32, s33
s_add_u32 s53, s53, 65536
s_and_b32 s59, s25, 0x7fff
s_and_b32 s33, s59, 0x6000
s_add_u32 s59, s59, s33
s_and_b32 s54, s19, 0x7fff
s_and_b32 s33, s54, 0x6000
s_add_u32 s54, s54, s33
s_xor_b32 s34, s52, 0x2000
s_lshl_b32 s32, s14, 14
s_lshl_b32 s33, s13, 8
s_add_u32 s33, s33, s34
s_add_u32 s55, s32, s33
v_writelane_b32 v121, s55, 39
s_lshl_b32 s32, s12, 15
s_add_u32 s44, s32, s33
s_xor_b32 s32, s32, 0x8000
s_add_u32 s45, s32, s34
s_lshl_b32 s32, s12, 14
s_add_u32 s32, s32, 0x6c78000
s_lshl_b32 s33, s13, 3
s_add_u32 s46, s32, s33
s_andn2_b32 s32, s25, 0x3ff
s_add_u32 s32, s32, 0x80000
s_cmp_eq_u32 s14, 1
s_cselect_b32 s46, s32, s46
s_add_u32 s20, s20, 0xc0000
s_add_u32 s21, s21, 0xc0000
s_add_u32 s22, s22, 0xc0000
s_add_u32 s23, s23, 0xc0000
s_sub_u32 s3, s3, 0x40000
s_sub_u32 s37, s37, 65536
s_sub_u32 s26, s26, 65536
s_cmp_eq_u32 s14, 3
s_cselect_b32 s39, 0, s39
s_mov_b32 s15, 0
s_mov_b32 s16, 0
s_cselect_b32 s27, 0, s27
s_mov_b32 s17, -1
s_memrealtime s[32:33]
s_memtime s[40:41]
s_waitcnt lgkmcnt(0)
s_mul_i32 s32, s32, 22
s_sub_u32 s11, s40, s32
s_sub_u32 s31, s32, 0x20000
s_sub_u32 s43, s31, 0x20000
s_min_u32 s32, s48, s49
s_cmp_ge_u32 s32, 32
s_waitcnt vmcnt(0)
s_cselect_b32 s32, 0, 4
s_add_u32 s32, s32, s14
s_cmp_eq_u32 s32, 1
s_cbranch_scc1 main_kernel_c1_top
s_cmp_eq_u32 s32, 2
s_cbranch_scc1 main_kernel_c2_top
s_cmp_eq_u32 s32, 3
s_cbranch_scc1 main_kernel_c3_top
s_cmp_eq_u32 s32, 4
s_cbranch_scc1 main_kernel_c4_top
s_cmp_eq_u32 s32, 5
s_cbranch_scc1 main_kernel_c5_top
s_cmp_eq_u32 s32, 6
s_cbranch_scc1 main_kernel_c6_top
s_cmp_eq_u32 s32, 7
s_cbranch_scc1 main_kernel_c7_top
s_branch main_kernel_c0_top
.p2align 6
main_kernel_c0_top:
s_barrier
buffer_load_dwordx4 v[0:3], v116, s[4:7], s18 offen sc1
s_add_u32 s20, s20, 0x40000
s_bitset0_b32 s20, 20
s_add_u32 s21, s21, 0x40000
s_bitset0_b32 s21, 20
s_add_u32 s22, s22, 0x40000
s_bitset0_b32 s22, 20
s_add_u32 s23, s23, 0x40000
s_bitset0_b32 s23, 20
s_xor_b32 s32, s18, 1024
buffer_load_dwordx4 v[16:19], v116, s[4:7], s32 offen sc1
s_add_u32 s3, s3, 0x40000
s_bitset0_b32 s3, 20
s_add_u32 s17, s17, 1
s_add_u32 s25, s52, s59
s_nop 3
buffer_load_dwordx4 v[64:67], v116, s[4:7], s19 offen sc1
v_mov_b32 v80, 0
v_mov_b32 v81, 0
s_nop 3
s_xor_b32 s32, s19, 1024
buffer_load_dwordx4 v[68:71], v116, s[4:7], s32 offen sc1
v_mov_b32 v82, 0
v_mov_b32 v83, 0
s_nop 3
s_xor_b32 s32, s18, 2048
buffer_load_dwordx4 v[32:35], v116, s[4:7], s32 offen sc1
v_mov_b32 v84, 0
v_mov_b32 v85, 0
s_nop 3
s_xor_b32 s32, s19, 2048
buffer_load_dwordx4 v[72:75], v116, s[4:7], s32 offen sc1
v_mov_b32 v86, 0
v_mov_b32 v87, 0
s_nop 3
s_xor_b32 s32, s18, 3072
buffer_load_dwordx4 v[48:51], v116, s[4:7], s32 offen sc1
v_mov_b32 v88, 0
v_mov_b32 v89, 0
s_nop 3
s_xor_b32 s32, s19, 3072
buffer_load_dwordx4 v[76:79], v116, s[4:7], s32 offen sc1
v_mov_b32 v90, 0
v_mov_b32 v91, 0
s_waitcnt vmcnt(5)
v_pk_add_f16 v0, v0, v64
v_pk_add_f16 v1, v1, v65
v_pk_add_f16 v2, v2, v66
v_pk_add_f16 v3, v3, v67
v_cmp_u_f16 vcc, v0, v2
s_cbranch_vccnz main_kernel_c0_m0_f
main_kernel_c0_m0:
v_smfmac_f32_16x16x64_f16 v[80:83], v[0:3], a[0:7], v112
ds_write_b128 v116, v[0:3] offset:0
v_smfmac_f32_16x16x64_f16 v[84:87], v[0:3], a[128:135], v112
buffer_load_dword v123, v121, s[4:7], 0 offen sc1
s_waitcnt vmcnt(5)
v_pk_add_f16 v16, v16, v68
v_pk_add_f16 v17, v17, v69
v_pk_add_f16 v18, v18, v70
v_pk_add_f16 v19, v19, v71
v_cmp_u_f16 vcc, v16, v18
s_waitcnt lgkmcnt(0)
s_barrier
ds_read_b128 v[4:7], v116 offset:1024
ds_write_b128 v116, v[16:19] offset:4096
s_cbranch_vccnz main_kernel_c0_m1_f
main_kernel_c0_m1:
v_smfmac_f32_16x16x64_f16 v[80:83], v[16:19], a[8:15], v112
v_smfmac_f32_16x16x64_f16 v[84:87], v[16:19], a[136:143], v112
ds_read_b128 v[8:11], v116 offset:2048
v_smfmac_f32_16x16x64_f16 v[88:91], v[0:3], v[128:135], v112
ds_read_b128 v[12:15], v116 offset:3072
s_waitcnt lgkmcnt(3)
v_smfmac_f32_16x16x64_f16 v[80:83], v[4:7], a[32:39], v112
v_smfmac_f32_16x16x64_f16 v[84:87], v[4:7], a[160:167], v112
v_smfmac_f32_16x16x64_f16 v[88:91], v[4:7], v[136:143], v112
s_waitcnt lgkmcnt(2)
s_barrier
s_waitcnt lgkmcnt(1)
v_smfmac_f32_16x16x64_f16 v[80:83], v[8:11], a[64:71], v112
s_waitcnt vmcnt(3)
ds_read_b128 v[20:23], v116 offset:5120
v_pk_add_f16 v32, v32, v72
v_smfmac_f32_16x16x64_f16 v[84:87], v[8:11], a[192:199], v112
ds_read_b128 v[24:27], v116 offset:6144
s_waitcnt lgkmcnt(2)
v_pk_add_f16 v33, v33, v73
v_smfmac_f32_16x16x64_f16 v[80:83], v[12:15], a[96:103], v112
ds_read_b128 v[28:31], v116 offset:7168
v_pk_add_f16 v34, v34, v74
v_smfmac_f32_16x16x64_f16 v[84:87], v[12:15], a[224:231], v112
s_waitcnt lgkmcnt(2)
v_pk_add_f16 v35, v35, v75
v_smfmac_f32_16x16x64_f16 v[80:83], v[20:23], a[40:47], v112
ds_write_b128 v116, v[32:35] offset:8192
v_cmp_u_f16 vcc, v32, v34
v_smfmac_f32_16x16x64_f16 v[84:87], v[20:23], a[168:175], v112
s_cbranch_vccnz main_kernel_c0_m2_f
main_kernel_c0_m2:
v_smfmac_f32_16x16x64_f16 v[80:83], v[32:35], a[16:23], v112
buffer_load_dwordx4 v[96:99], v116, s[4:7], s28 offen sc1
v_smfmac_f32_16x16x64_f16 v[84:87], v[32:35], a[144:151], v112
s_add_u32 s28, s28, 0x40000
s_waitcnt lgkmcnt(2)
v_smfmac_f32_16x16x64_f16 v[80:83], v[24:27], a[72:79], v112
s_waitcnt vmcnt(2)
v_pk_add_f16 v48, v48, v76
v_smfmac_f32_16x16x64_f16 v[84:87], v[24:27], a[200:207], v112
s_waitcnt lgkmcnt(0)
s_barrier
ds_read_b128 v[36:39], v116 offset:9216
v_pk_add_f16 v49, v49, v77
v_smfmac_f32_16x16x64_f16 v[80:83], v[28:31], a[104:111], v112
ds_read_b128 v[40:43], v116 offset:10240
v_pk_add_f16 v50, v50, v78
v_smfmac_f32_16x16x64_f16 v[84:87], v[28:31], a[232:239], v112
ds_read_b128 v[44:47], v116 offset:11264
v_pk_add_f16 v51, v51, v79
v_smfmac_f32_16x16x64_f16 v[88:91], v[8:11], v[144:151], v112
ds_write_b128 v116, v[48:51] offset:12288
s_waitcnt lgkmcnt(3)
v_cmp_u_f16 vcc, v48, v50
v_smfmac_f32_16x16x64_f16 v[80:83], v[36:39], a[48:55], v112
s_cbranch_vccnz main_kernel_c0_m3_f
main_kernel_c0_m3:
v_smfmac_f32_16x16x64_f16 v[80:83], v[48:51], a[24:31], v112
v_smfmac_f32_16x16x64_f16 v[84:87], v[48:51], a[152:159], v112
v_smfmac_f32_16x16x64_f16 v[84:87], v[36:39], a[176:183], v112
s_waitcnt lgkmcnt(2)
v_smfmac_f32_16x16x64_f16 v[80:83], v[40:43], a[80:87], v112
s_waitcnt lgkmcnt(0)
s_barrier
ds_read_b128 v[52:55], v116 offset:13312
v_smfmac_f32_16x16x64_f16 v[84:87], v[40:43], a[208:215], v112
s_add_u32 s19, s52, s54
ds_read_b128 v[56:59], v116 offset:14336
v_smfmac_f32_16x16x64_f16 v[80:83], v[44:47], a[112:119], v112
s_add_u32 s18, s18, 0x40000
ds_read_b128 v[60:63], v116 offset:15360
v_smfmac_f32_16x16x64_f16 v[84:87], v[44:47], a[240:247], v112
s_bitset0_b32 s18, 20
s_waitcnt lgkmcnt(2)
v_smfmac_f32_16x16x64_f16 v[80:83], v[52:55], a[56:63], v112
s_cmp_eq_u32 s17, 30
s_cselect_b32 s32, s53, 0x10000
s_waitcnt lgkmcnt(1)
v_smfmac_f32_16x16x64_f16 v[80:83], v[56:59], a[88:95], v112
s_add_u32 s52, s52, s32
s_waitcnt lgkmcnt(0)
v_smfmac_f32_16x16x64_f16 v[80:83], v[60:63], a[120:127], v112
s_sub_u32 s24, 0x20000, s32
ds_read_b128 v[64:67], v116 offset:24576
v_smfmac_f32_16x16x64_f16 v[84:87], v[52:55], a[184:191], v112
s_add_u32 s55, s55, s24
ds_read_b128 v[68:71], v116 offset:28672
v_smfmac_f32_16x16x64_f16 v[84:87], v[56:59], a[216:223], v112
ds_read_b128 v[72:75], v116 offset:25600
s_nop 0
v_cvt_pk_bf16_f32 v92, v80, v81
v_smfmac_f32_16x16x64_f16 v[84:87], v[60:63], a[248:255], v112
ds_read_b128 v[76:79], v116 offset:29696
s_nop 0
v_cvt_pk_bf16_f32 v93, v82, v83
v_smfmac_f32_16x16x64_f16 v[88:91], v[12:15], v[152:159], v112
s_nop 3
v_cvt_pk_bf16_f32 v94, v84, v85
v_cvt_pk_bf16_f32 v95, v86, v87
s_mov_b32 vcc_lo, 0xcccccccc
s_mov_b32 vcc_hi, 0xcccccccc
v_mfma_f32_16x16x32_bf16 v[84:87], v[92:95], v[104:107], 0
v_add_u32 v121, v121, v122
v_writelane_b32 v121, s55, 39
s_nop 0
v_smfmac_f32_16x16x64_f16 v[88:91], v[16:19], v[160:167], v112
s_nop 2
s_cmp_eq_u32 s17, 63
v_cvt_pk_bf16_f32 v114, v84, v85
v_cvt_pk_bf16_f32 v115, v86, v87
buffer_store_dwordx2 v[114:115], v117, s[4:7], s21 offen
s_cbranch_scc1 main_kernel_c0_last
ds_write_b64 v117, v[114:115] offset:16384
v_smfmac_f32_16x16x64_f16 v[88:91], v[20:23], v[168:175], v112
v_smfmac_f32_16x16x64_f16 v[88:91], v[24:27], v[176:183], v112
v_smfmac_f32_16x16x64_f16 v[88:91], v[28:31], v[184:191], v112
v_smfmac_f32_16x16x64_f16 v[88:91], v[32:35], v[192:199], v112
s_waitcnt lgkmcnt(0)
s_barrier
ds_read_b128 v[0:3], v116 offset:16384
v_smfmac_f32_16x16x64_f16 v[88:91], v[36:39], v[200:207], v112
ds_read_b128 v[4:7], v116 offset:17408
s_waitcnt vmcnt(2)
v_cmp_eq_u32 s[0:1], 0, v123
v_smfmac_f32_16x16x64_f16 v[88:91], v[40:43], v[208:215], v112
ds_read_b128 v[16:19], v116 offset:26624
s_and_b32 s10, s1, 0x3f00
v_smfmac_f32_16x16x64_f16 v[88:91], v[44:47], v[216:223], v112
ds_read_b128 v[20:23], v116 offset:30720
v_smfmac_f32_16x16x64_f16 v[88:91], v[48:51], v[224:231], v112
ds_read_b128 v[24:27], v116 offset:27648
v_smfmac_f32_16x16x64_f16 v[88:91], v[52:55], v[232:239], v112
ds_read_b128 v[28:31], v116 offset:31744
v_smfmac_f32_16x16x64_f16 v[88:91], v[56:59], v[240:247], v112
v_smfmac_f32_16x16x64_f16 v[88:91], v[60:63], v[248:255], v112
s_waitcnt lgkmcnt(5)
v_mfma_f32_16x16x32_bf16 v[80:83], v[64:67], v[0:3], 0
v_mfma_f32_16x16x32_bf16 v[84:87], v[68:71], v[0:3], 0
buffer_load_dwordx4 v[8:11], v116, s[4:7], s20 offen offset:0 sc1
v_mfma_f32_16x16x32_bf16 v[92:95], v[0:3], v[0:3], 0
buffer_load_dwordx4 v[12:15], v116, s[4:7], s20 offen offset:1024 sc1
v_permlane32_swap_b32 v88, v90
s_waitcnt lgkmcnt(4)
v_mfma_f32_16x16x32_bf16 v[80:83], v[72:75], v[4:7], v[80:83]
v_permlane32_swap_b32 v89, v91
v_mfma_f32_16x16x32_bf16 v[84:87], v[76:79], v[4:7], v[84:87]
v_pk_add_f32 v[88:89], v[88:89], v[90:91]
v_mfma_f32_16x16x32_bf16 v[92:95], v[4:7], v[4:7], v[92:95]
v_cvt_pk_bf16_f32 v124, v88, v89
v_mov_b32 v65, 0
s_waitcnt lgkmcnt(0)
s_waitcnt vmcnt(1)
v_mfma_f32_16x16x32_bf16 v[88:91], v[8:11], v[8:11], v[92:95]
v_mfma_f32_16x16x32_bf16 v[0:3], v[16:19], v[8:11], v[80:83]
v_cmp_u_f32 s[0:1], v8, v10
v_mfma_f32_16x16x32_bf16 v[4:7], v[20:23], v[8:11], v[84:87]
s_waitcnt vmcnt(0)
v_mfma_f32_16x16x32_bf16 v[88:91], v[12:15], v[12:15], v[88:91]
v_mfma_f32_16x16x32_bf16 v[0:3], v[24:27], v[12:15], v[0:3]
v_cmp_u_f32 s[32:33], v12, v14
v_mfma_f32_16x16x32_bf16 v[4:7], v[28:31], v[12:15], v[4:7]
s_or_b64 s[0:1], s[0:1], s[32:33]
s_cbranch_scc1 main_kernel_c0_z_f
main_kernel_c0_z:
v_mul_f32 v88, s30, v88
v_mul_f32 v89, s30, v89
v_exp_f32 v88, v88
v_exp_f32 v89, v89
v_cndmask_b32_dpp v0, v2, v0, vcc quad_perm:[2,3,2,3] row_mask:0xf bank_mask:0xf
v_cvt_pk_bf16_f32 v64, v88, v89
v_cndmask_b32_dpp v1, v3, v1, vcc quad_perm:[2,3,2,3] row_mask:0xf bank_mask:0xf
v_exp_f32 v0, v0
v_mfma_f32_16x16x16_bf16 v[16:19], v[100:101], v[64:65], 0
v_exp_f32 v1, v1
v_cndmask_b32_dpp v4, v6, v4, vcc quad_perm:[2,3,2,3] row_mask:0xf bank_mask:0xf
v_mfma_f32_16x16x16_bf16 v[8:11], v[124:125], v[64:65], 0
v_cndmask_b32_dpp v5, v7, v5, vcc quad_perm:[2,3,2,3] row_mask:0xf bank_mask:0xf
v_exp_f32 v4, v4
v_exp_f32 v5, v5
v_cvt_pk_bf16_f32 v92, v0, v1
v_cvt_pk_bf16_f32 v94, v4, v5
v_mov_b32 v80, 0
v_mov_b32_dpp v93, v92 quad_perm:[0,1,0,1] row_mask:0xf bank_mask:0xf
v_mov_b32_dpp v95, v94 quad_perm:[0,1,0,1] row_mask:0xf bank_mask:0xf
v_mov_b32 v81, 0
v_mov_b32 v82, 0
v_mfma_f32_16x16x32_bf16 v[16:19], v[100:103], v[92:95], v[16:19]
v_mov_b32 v83, 0
v_mov_b32 v84, 0
v_mfma_f32_16x16x32_bf16 v[8:11], v[96:99], v[92:95], v[8:11]
s_nop 1
v_mov_b32 v85, 0
v_mov_b32 v86, 0
v_mov_b32 v87, 0
v_rcp_f32 v126, v16
v_subrev_u32 v127, 0x21800000, v16
v_cmp_lt_u32 vcc, 0x3c000000, v127
v_pk_mul_f32 v[8:9], v[8:9], v[126:127] op_sel_hi:[1,0]
v_pk_mul_f32 v[10:11], v[10:11], v[126:127] op_sel_hi:[1,0]
s_and_b32 s32, vcc_lo, 0xcccc
v_cvt_pk_bf16_f32 v126, v8, v9
v_cvt_pk_bf16_f32 v127, v10, v11
s_cbranch_scc1 main_kernel_c0_sm_f
main_kernel_c0_ost:
buffer_store_dwordx2 v[126:127], v118, s[4:7], s22 offen
v_mov_b32 v24, -1
v_mov_b32 v25, -1
v_mov_b32 v26, -1
v_mov_b32 v27, -1
ds_read_b128 v[32:35], v113 offset:0
ds_read_b128 v[36:39], v113 offset:1024
ds_read_b128 v[40:43], v113 offset:2048
ds_read_b128 v[44:47], v113 offset:3072
ds_read_b128 v[48:51], v113 offset:4096
ds_read_b128 v[52:55], v113 offset:5120
buffer_store_dwordx4 v[24:27], v116, s[4:7], s3 offen
s_barrier
buffer_load_dwordx4 v[0:3], v116, s[4:7], s23 offen sc1
ds_read_b128 v[56:59], v113 offset:6144
ds_read_b128 v[60:63], v113 offset:7168
s_add_u32 s37, s37, 65536
s_add_u32 s26, s26, 65536
s_nop 1
s_xor_b32 s32, s23, 1024
buffer_load_dwordx4 v[4:7], v116, s[4:7], s32 offen sc1
ds_read_b128 v[64:67], v113 offset:8192
ds_read_b128 v[68:71], v113 offset:9216
s_nop 3
s_xor_b32 s32, s23, 2048
buffer_load_dwordx4 v[8:11], v116, s[4:7], s32 offen sc1
ds_read_b128 v[72:75], v113 offset:10240
ds_read_b128 v[76:79], v113 offset:11264
s_nop 3
s_xor_b32 s32, s23, 3072
buffer_load_dwordx4 v[12:15], v116, s[4:7], s32 offen sc1
ds_read_b128 v[88:91], v113 offset:12288
ds_read_b128 v[92:95], v113 offset:13312
s_nop 3
s_xor_b32 s32, s23, 4096
buffer_load_dwordx4 v[16:19], v116, s[4:7], s32 offen sc1
s_nop 7
s_xor_b32 s32, s23, 5120
buffer_load_dwordx4 v[20:23], v116, s[4:7], s32 offen sc1
s_nop 7
s_xor_b32 s32, s23, 6144
buffer_load_dwordx4 v[24:27], v116, s[4:7], s32 offen sc1
s_nop 7
s_xor_b32 s32, s23, 7168
buffer_load_dwordx4 v[28:31], v116, s[4:7], s32 offen sc1
s_waitcnt lgkmcnt(12)
s_waitcnt vmcnt(7)
v_cmp_u_f32 vcc, v0, v2
s_cbranch_vccnz main_kernel_c0_o0_f
main_kernel_c0_o0:
v_smfmac_f32_16x16x64_bf16 v[80:83], v[0:3], v[32:39], v112
ds_read_b128 v[32:35], v113 offset:14336
ds_read_b128 v[36:39], v113 offset:15360
s_waitcnt lgkmcnt(12)
s_waitcnt vmcnt(6)
v_cmp_u_f32 vcc, v4, v6
v_smfmac_f32_16x16x64_bf16 v[84:87], v[0:3], v[40:47], v112
ds_read_b128 v[40:43], v113 offset:16384
ds_read_b128 v[44:47], v113 offset:17408
buffer_store_dwordx2 v[114:115], v119, s[4:7], s37 offen sc1
s_cbranch_vccnz main_kernel_c0_o1_f
main_kernel_c0_o1:
s_waitcnt lgkmcnt(12)
v_smfmac_f32_16x16x64_bf16 v[80:83], v[4:7], v[48:55], v112
ds_read_b128 v[48:51], v113 offset:18432
ds_read_b128 v[52:55], v113 offset:19456
s_waitcnt lgkmcnt(12)
s_waitcnt vmcnt(6)
v_cmp_u_f32 vcc, v8, v10
v_smfmac_f32_16x16x64_bf16 v[84:87], v[4:7], v[56:63], v112
ds_read_b128 v[56:59], v113 offset:20480
ds_read_b128 v[60:63], v113 offset:21504
buffer_store_dword v124, v120, s[4:7], s26 offen sc1
s_cbranch_vccnz main_kernel_c0_o2_f
main_kernel_c0_o2:
s_waitcnt lgkmcnt(12)
v_smfmac_f32_16x16x64_bf16 v[80:83], v[8:11], v[64:71], v112
ds_read_b128 v[64:67], v113 offset:22528
ds_read_b128 v[68:71], v113 offset:23552
s_waitcnt lgkmcnt(12)
s_waitcnt vmcnt(6)
v_cmp_u_f32 vcc, v12, v14
v_smfmac_f32_16x16x64_bf16 v[84:87], v[8:11], v[72:79], v112
ds_read_b128 v[72:75], v113 offset:24576
ds_read_b128 v[76:79], v113 offset:25600
s_cbranch_vccnz main_kernel_c0_o3_f
main_kernel_c0_o3:
s_waitcnt lgkmcnt(12)
v_smfmac_f32_16x16x64_bf16 v[80:83], v[12:15], v[88:95], v112
ds_read_b128 v[88:91], v113 offset:26624
ds_read_b128 v[92:95], v113 offset:27648
s_waitcnt lgkmcnt(12)
s_waitcnt vmcnt(5)
v_cmp_u_f32 vcc, v16, v18
v_smfmac_f32_16x16x64_bf16 v[84:87], v[12:15], v[32:39], v112
ds_read_b128 v[32:35], v113 offset:28672
ds_read_b128 v[36:39], v113 offset:29696
s_cbranch_vccnz main_kernel_c0_o4_f
main_kernel_c0_o4:
s_waitcnt lgkmcnt(12)
v_smfmac_f32_16x16x64_bf16 v[80:83], v[16:19], v[40:47], v112
ds_read_b128 v[40:43], v113 offset:30720
ds_read_b128 v[44:47], v113 offset:31744
s_waitcnt lgkmcnt(12)
s_waitcnt vmcnt(4)
v_cmp_u_f32 vcc, v20, v22
v_smfmac_f32_16x16x64_bf16 v[84:87], v[16:19], v[48:55], v112
s_cbranch_vccnz main_kernel_c0_o5_f
main_kernel_c0_o5:
s_waitcnt lgkmcnt(10)
v_smfmac_f32_16x16x64_bf16 v[80:83], v[20:23], v[56:63], v112
s_waitcnt lgkmcnt(8)
s_waitcnt vmcnt(3)
v_cmp_u_f32 vcc, v24, v26
v_smfmac_f32_16x16x64_bf16 v[84:87], v[20:23], v[64:71], v112
s_cbranch_vccnz main_kernel_c0_o6_f
main_kernel_c0_o6:
s_waitcnt lgkmcnt(6)
v_smfmac_f32_16x16x64_bf16 v[80:83], v[24:27], v[72:79], v112
s_waitcnt lgkmcnt(4)
v_smfmac_f32_16x16x64_bf16 v[84:87], v[24:27], v[88:95], v112
s_waitcnt lgkmcnt(2)
s_waitcnt vmcnt(2)
v_cmp_u_f32 vcc, v28, v30
s_cbranch_vccnz main_kernel_c0_o7_f
main_kernel_c0_o7:
v_smfmac_f32_16x16x64_bf16 v[80:83], v[28:31], v[32:39], v112
s_waitcnt lgkmcnt(0)
v_smfmac_f32_16x16x64_bf16 v[84:87], v[28:31], v[40:47], v112
s_nop 4
v_cvt_pk_bf16_f32 v80, v80, v81
v_cvt_pk_bf16_f32 v81, v82, v83
ds_write_b64 v116, v[80:81] offset:20480
v_cvt_pk_bf16_f32 v82, v84, v85
v_cvt_pk_bf16_f32 v83, v86, v87
ds_write_b64 v116, v[82:83] offset:22528
s_waitcnt lgkmcnt(0)
s_barrier
ds_read_b128 v[72:75], v116 offset:20480
ds_read_b128 v[76:79], v116 offset:21504
s_mov_b32 m0, 24576
s_cmp_lg_u32 s10, 0
s_waitcnt lgkmcnt(1)
v_mfma_f32_16x16x32_bf16 v[64:67], v[72:75], v[108:111], 0
s_waitcnt lgkmcnt(0)
v_mfma_f32_16x16x32_bf16 v[64:67], v[76:79], v[108:111], v[64:67]
s_nop 7
v_cvt_pk_f16_f32 v68, v64, v65
v_cvt_pk_f16_f32 v69, v66, v67
buffer_store_dwordx2 v[68:69], v125, s[4:7], s25 offen sc1
s_cbranch_scc1 main_kernel_c0_kvw
main_kernel_c0_kvok:
s_nop 3
buffer_load_dwordx4 v116, s[4:7], s27 offen sc1 lds
buffer_load_dwordx4 v116, s[4:7], s27 offen offset:1024 sc1 lds
s_add_u32 s27, s27, 0x40000
s_branch main_kernel_c0_top
main_kernel_c0_kvw:
s_mov_b32 exec_lo, 0
s_mov_b32 exec_hi, 0x3f00
v_subrev_u32 v127, 128, v121
main_kernel_c0_kvp:
buffer_load_dword v126, v127, s[4:7], 0 offen sc1
s_waitcnt vmcnt(0)
v_cmp_eq_u32 vcc, 0, v126
s_cbranch_vccz main_kernel_c0_kvp_ok
s_sleep 2
s_sub_u32 s29, s29, 1
s_cbranch_scc0 main_kernel_c0_kvp
s_branch main_kernel_end
main_kernel_c0_kvp_ok:
s_mov_b64 exec, -1
s_branch main_kernel_c0_kvok
main_kernel_c0_last:
s_add_u32 s37, s37, 65536
s_add_u32 s26, s26, 65536
buffer_store_dwordx2 v[114:115], v119, s[4:7], s37 offen sc1
v_smfmac_f32_16x16x64_f16 v[88:91], v[20:23], v[168:175], v112
v_smfmac_f32_16x16x64_f16 v[88:91], v[24:27], v[176:183], v112
v_smfmac_f32_16x16x64_f16 v[88:91], v[28:31], v[184:191], v112
v_smfmac_f32_16x16x64_f16 v[88:91], v[32:35], v[192:199], v112
v_smfmac_f32_16x16x64_f16 v[88:91], v[36:39], v[200:207], v112
v_smfmac_f32_16x16x64_f16 v[88:91], v[40:43], v[208:215], v112
v_smfmac_f32_16x16x64_f16 v[88:91], v[44:47], v[216:223], v112
v_smfmac_f32_16x16x64_f16 v[88:91], v[48:51], v[224:231], v112
v_smfmac_f32_16x16x64_f16 v[88:91], v[52:55], v[232:239], v112
v_smfmac_f32_16x16x64_f16 v[88:91], v[56:59], v[240:247], v112
v_smfmac_f32_16x16x64_f16 v[88:91], v[60:63], v[248:255], v112
s_nop 7
v_permlane32_swap_b32 v88, v90
s_nop 1
v_permlane32_swap_b32 v89, v91
s_nop 1
v_pk_add_f32 v[88:89], v[88:89], v[90:91]
s_nop 1
v_cvt_pk_bf16_f32 v124, v88, v89
s_nop 1
buffer_store_dword v124, v120, s[4:7], s26 offen sc1
s_branch main_kernel_end
main_kernel_c0_m0_f:
s_waitcnt lgkmcnt(0)
buffer_load_dwordx4 v[0:3], v116, s[4:7], s18 offen sc1
buffer_load_dwordx4 v[64:67], v116, s[4:7], s19 offen sc1
s_xor_b32 s32, s18, 1024
buffer_load_dwordx4 v[16:19], v116, s[4:7], s32 offen sc1
s_xor_b32 s32, s19, 1024
buffer_load_dwordx4 v[68:71], v116, s[4:7], s32 offen sc1
s_xor_b32 s32, s18, 2048
buffer_load_dwordx4 v[32:35], v116, s[4:7], s32 offen sc1
s_xor_b32 s32, s19, 2048
buffer_load_dwordx4 v[72:75], v116, s[4:7], s32 offen sc1
s_xor_b32 s32, s18, 3072
buffer_load_dwordx4 v[48:51], v116, s[4:7], s32 offen sc1
s_xor_b32 s32, s19, 3072
buffer_load_dwordx4 v[76:79], v116, s[4:7], s32 offen sc1
s_sub_u32 s29, s29, 1
s_cbranch_scc1 main_kernel_end
s_waitcnt vmcnt(0)
v_max_u32 v126, v0, v2
v_max3_u32 v126, v126, v64, v66
v_cmp_eq_u32 vcc, -1, v126
s_cbranch_vccnz main_kernel_c0_m0_f
v_pk_add_f16 v0, v0, v64
v_pk_add_f16 v1, v1, v65
v_pk_add_f16 v2, v2, v66
v_pk_add_f16 v3, v3, v67
s_nop 0
s_branch main_kernel_c0_m0
main_kernel_c0_m1_f:
s_waitcnt lgkmcnt(0)
s_xor_b32 s32, s18, 1024
buffer_load_dwordx4 v[16:19], v116, s[4:7], s32 offen sc1
s_xor_b32 s32, s19, 1024
buffer_load_dwordx4 v[68:71], v116, s[4:7], s32 offen sc1
s_xor_b32 s32, s18, 2048
buffer_load_dwordx4 v[32:35], v116, s[4:7], s32 offen sc1
s_xor_b32 s32, s19, 2048
buffer_load_dwordx4 v[72:75], v116, s[4:7], s32 offen sc1
s_xor_b32 s32, s18, 3072
buffer_load_dwordx4 v[48:51], v116, s[4:7], s32 offen sc1
s_xor_b32 s32, s19, 3072
buffer_load_dwordx4 v[76:79], v116, s[4:7], s32 offen sc1
s_sub_u32 s29, s29, 1
s_cbranch_scc1 main_kernel_end
s_waitcnt vmcnt(0)
v_max_u32 v126, v16, v18
v_max3_u32 v126, v126, v68, v70
v_cmp_eq_u32 vcc, -1, v126
s_cbranch_vccnz main_kernel_c0_m1_f
v_pk_add_f16 v16, v16, v68
v_pk_add_f16 v17, v17, v69
v_pk_add_f16 v18, v18, v70
v_pk_add_f16 v19, v19, v71
ds_write_b128 v116, v[16:19] offset:4096
s_branch main_kernel_c0_m1
main_kernel_c0_m2_f:
s_waitcnt lgkmcnt(0)
s_xor_b32 s32, s18, 2048
buffer_load_dwordx4 v[32:35], v116, s[4:7], s32 offen sc1
s_xor_b32 s32, s19, 2048
buffer_load_dwordx4 v[72:75], v116, s[4:7], s32 offen sc1
s_xor_b32 s32, s18, 3072
buffer_load_dwordx4 v[48:51], v116, s[4:7], s32 offen sc1
s_xor_b32 s32, s19, 3072
buffer_load_dwordx4 v[76:79], v116, s[4:7], s32 offen sc1
s_sub_u32 s29, s29, 1
s_cbranch_scc1 main_kernel_end
s_waitcnt vmcnt(0)
v_max_u32 v126, v32, v34
v_max3_u32 v126, v126, v72, v74
v_cmp_eq_u32 vcc, -1, v126
s_cbranch_vccnz main_kernel_c0_m2_f
v_pk_add_f16 v32, v32, v72
v_pk_add_f16 v33, v33, v73
v_pk_add_f16 v34, v34, v74
v_pk_add_f16 v35, v35, v75
ds_write_b128 v116, v[32:35] offset:8192
s_branch main_kernel_c0_m2
main_kernel_c0_m3_f:
s_waitcnt lgkmcnt(0)
s_xor_b32 s32, s18, 3072
buffer_load_dwordx4 v[48:51], v116, s[4:7], s32 offen sc1
s_xor_b32 s32, s19, 3072
buffer_load_dwordx4 v[76:79], v116, s[4:7], s32 offen sc1
s_sub_u32 s29, s29, 1
s_cbranch_scc1 main_kernel_end
s_waitcnt vmcnt(0)
v_max_u32 v126, v48, v50
v_max3_u32 v126, v126, v76, v78
v_cmp_eq_u32 vcc, -1, v126
s_cbranch_vccnz main_kernel_c0_m3_f
v_pk_add_f16 v48, v48, v76
v_pk_add_f16 v49, v49, v77
v_pk_add_f16 v50, v50, v78
v_pk_add_f16 v51, v51, v79
ds_write_b128 v116, v[48:51] offset:12288
s_branch main_kernel_c0_m3
main_kernel_c0_z_f:
buffer_load_dwordx4 v[8:11], v116, s[4:7], s20 offen offset:0 sc1
buffer_load_dwordx4 v[12:15], v116, s[4:7], s20 offen offset:1024 sc1
s_memtime s[32:33]
ds_read_b32 v126, v116 offset:18432
s_sub_u32 s34, s19, s54
s_xor_b32 s34, s34, 0x2000
s_lshl_b32 s35, s12, 15
s_add_u32 s34, s34, s35
s_lshl_b32 s35, s13, 8
s_add_u32 s35, s35, s34
s_add_u32 s34, s34, 0x4000
s_waitcnt lgkmcnt(0)
s_sub_u32 s32, s32, 450
v_sub_u32 v127, s32, v126
buffer_store_dword v127, off, s[4:7], s34
s_sub_u32 s29, s29, 1
s_cbranch_scc1 main_kernel_end
s_waitcnt vmcnt(1)
main_kernel_c0_z_g:
v_max_u32 v126, v8, v10
v_max3_u32 v126, v126, v12, v14
v_cmp_eq_u32 vcc, -1, v126
s_cbranch_vccnz main_kernel_c0_z_h
v_mfma_f32_16x16x32_bf16 v[88:91], v[8:11], v[8:11], v[92:95]
v_mfma_f32_16x16x32_bf16 v[0:3], v[16:19], v[8:11], v[80:83]
v_mfma_f32_16x16x32_bf16 v[4:7], v[20:23], v[8:11], v[84:87]
v_mfma_f32_16x16x32_bf16 v[88:91], v[12:15], v[12:15], v[88:91]
v_mfma_f32_16x16x32_bf16 v[0:3], v[24:27], v[12:15], v[0:3]
v_mfma_f32_16x16x32_bf16 v[4:7], v[28:31], v[12:15], v[4:7]
buffer_store_dword v127, off, s[4:7], s35 offset:132 sc1
s_mov_b32 vcc_lo, 0xcccccccc
s_mov_b32 vcc_hi, 0xcccccccc
s_branch main_kernel_c0_z
main_kernel_c0_z_h:
buffer_load_dwordx4 v[8:11], v116, s[4:7], s20 offen offset:0 sc1
buffer_load_dwordx4 v[12:15], v116, s[4:7], s20 offen offset:1024 sc1
s_sub_u32 s29, s29, 1
s_cbranch_scc1 main_kernel_end
v_add_u32 v127, 300, v127
s_waitcnt vmcnt(0)
s_branch main_kernel_c0_z_g
main_kernel_c0_sm_f:
s_waitcnt vmcnt(0) lgkmcnt(0)
buffer_load_dwordx4 v[8:11], v116, s[4:7], s20 offen offset:0 sc1
buffer_load_dwordx4 v[12:15], v116, s[4:7], s20 offen offset:1024 sc1
ds_read_b128 v[0:3], v116 offset:16384
ds_read_b128 v[4:7], v116 offset:17408
ds_read_b128 v[64:67], v116 offset:24576
ds_read_b128 v[68:71], v116 offset:28672
ds_read_b128 v[72:75], v116 offset:25600
ds_read_b128 v[76:79], v116 offset:29696
ds_read_b128 v[16:19], v116 offset:26624
ds_read_b128 v[20:23], v116 offset:30720
ds_read_b128 v[24:27], v116 offset:27648
ds_read_b128 v[28:31], v116 offset:31744
s_waitcnt vmcnt(0)
s_waitcnt lgkmcnt(0)
v_mfma_f32_16x16x32_bf16 v[80:83], v[64:67], v[0:3], 0
v_mfma_f32_16x16x32_bf16 v[84:87], v[68:71], v[0:3], 0
v_mfma_f32_16x16x32_bf16 v[92:95], v[0:3], v[0:3], 0
v_mfma_f32_16x16x32_bf16 v[80:83], v[72:75], v[4:7], v[80:83]
v_mfma_f32_16x16x32_bf16 v[84:87], v[76:79], v[4:7], v[84:87]
v_mfma_f32_16x16x32_bf16 v[92:95], v[4:7], v[4:7], v[92:95]
v_mfma_f32_16x16x32_bf16 v[0:3], v[16:19], v[8:11], v[80:83]
v_mfma_f32_16x16x32_bf16 v[4:7], v[20:23], v[8:11], v[84:87]
v_mfma_f32_16x16x32_bf16 v[88:91], v[8:11], v[8:11], v[92:95]
v_mfma_f32_16x16x32_bf16 v[0:3], v[24:27], v[12:15], v[0:3]
v_mfma_f32_16x16x32_bf16 v[4:7], v[28:31], v[12:15], v[4:7]
v_mfma_f32_16x16x32_bf16 v[88:91], v[12:15], v[12:15], v[88:91]
s_nop 7
v_mov_b32 v65, 0
v_max_f32 v126, v88, v89
v_mul_f32 v126, s30, v126
v_max3_f32 v126, v126, v0, v1
v_max3_f32 v126, v126, v2, v3
v_max3_f32 v126, v126, v4, v5
v_max3_f32 v126, v126, v6, v7
v_mov_b32 v127, v126
s_nop 1
v_permlane32_swap_b32 v126, v127
v_max_f32 v126, v126, v127
v_mov_b32 v127, v126
s_nop 1
v_permlane16_swap_b32 v126, v127
v_max_f32 v126, v126, v127
v_mul_f32 v127, 0x40faf233, v126
s_mov_b32 vcc_lo, 0xcccccccc
s_mov_b32 vcc_hi, 0xcccccccc
v_sub_f32 v0, v0, v126
v_sub_f32 v1, v1, v126
v_sub_f32 v2, v2, v126
v_sub_f32 v3, v3, v126
v_sub_f32 v4, v4, v126
v_sub_f32 v5, v5, v126
v_sub_f32 v6, v6, v126
v_sub_f32 v7, v7, v126
v_sub_f32 v88, v88, v127
v_sub_f32 v89, v89, v127
s_waitcnt lgkmcnt(0)
s_nop 0
v_mul_f32 v88, s30, v88
v_mul_f32 v89, s30, v89
v_exp_f32 v88, v88
v_exp_f32 v89, v89
v_cndmask_b32_dpp v0, v2, v0, vcc quad_perm:[2,3,2,3] row_mask:0xf bank_mask:0xf
v_cvt_pk_bf16_f32 v64, v88, v89
v_cndmask_b32_dpp v1, v3, v1, vcc quad_perm:[2,3,2,3] row_mask:0xf bank_mask:0xf
v_exp_f32 v0, v0
v_mfma_f32_16x16x16_bf16 v[16:19], v[100:101], v[64:65], 0
v_exp_f32 v1, v1
v_cndmask_b32_dpp v4, v6, v4, vcc quad_perm:[2,3,2,3] row_mask:0xf bank_mask:0xf
v_mfma_f32_16x16x16_bf16 v[8:11], v[124:125], v[64:65], 0
v_cndmask_b32_dpp v5, v7, v5, vcc quad_perm:[2,3,2,3] row_mask:0xf bank_mask:0xf
v_exp_f32 v4, v4
v_exp_f32 v5, v5
v_cvt_pk_bf16_f32 v92, v0, v1
v_cvt_pk_bf16_f32 v94, v4, v5
v_mov_b32 v80, 0
v_mov_b32_dpp v93, v92 quad_perm:[0,1,0,1] row_mask:0xf bank_mask:0xf
v_mov_b32_dpp v95, v94 quad_perm:[0,1,0,1] row_mask:0xf bank_mask:0xf
v_mov_b32 v81, 0
v_mov_b32 v82, 0
v_mfma_f32_16x16x32_bf16 v[16:19], v[100:103], v[92:95], v[16:19]
v_mov_b32 v83, 0
v_mov_b32 v84, 0
v_mfma_f32_16x16x32_bf16 v[8:11], v[96:99], v[92:95], v[8:11]
s_nop 1
v_mov_b32 v85, 0
v_mov_b32 v86, 0
v_mov_b32 v87, 0
v_rcp_f32 v126, v16
v_subrev_u32 v127, 0x21800000, v16
v_cmp_lt_u32 vcc, 0x3c000000, v127
v_pk_mul_f32 v[8:9], v[8:9], v[126:127] op_sel_hi:[1,0]
v_pk_mul_f32 v[10:11], v[10:11], v[126:127] op_sel_hi:[1,0]
s_and_b32 s32, vcc_lo, 0xcccc
v_cvt_pk_bf16_f32 v126, v8, v9
v_cvt_pk_bf16_f32 v127, v10, v11
s_branch main_kernel_c0_ost
main_kernel_c0_o0_f:
s_nop 0
buffer_load_dwordx4 v[0:3], v116, s[4:7], s23 offen sc1
s_xor_b32 s32, s23, 1024
buffer_load_dwordx4 v[4:7], v116, s[4:7], s32 offen sc1
s_sub_u32 s29, s29, 1
s_cbranch_scc1 main_kernel_end
s_waitcnt vmcnt(0)
v_max_u32 v126, v0, v2
v_cmp_eq_u32 vcc, -1, v126
s_cbranch_vccnz main_kernel_c0_o0_f
s_branch main_kernel_c0_o0
main_kernel_c0_o1_f:
s_nop 0
s_xor_b32 s32, s23, 1024
buffer_load_dwordx4 v[4:7], v116, s[4:7], s32 offen sc1
s_xor_b32 s32, s23, 2048
buffer_load_dwordx4 v[8:11], v116, s[4:7], s32 offen sc1
s_sub_u32 s29, s29, 1
s_cbranch_scc1 main_kernel_end
s_waitcnt vmcnt(0)
v_max_u32 v126, v4, v6
v_cmp_eq_u32 vcc, -1, v126
s_cbranch_vccnz main_kernel_c0_o1_f
s_branch main_kernel_c0_o1
main_kernel_c0_o2_f:
s_nop 0
s_xor_b32 s32, s23, 2048
buffer_load_dwordx4 v[8:11], v116, s[4:7], s32 offen sc1
s_xor_b32 s32, s23, 3072
buffer_load_dwordx4 v[12:15], v116, s[4:7], s32 offen sc1
s_sub_u32 s29, s29, 1
s_cbranch_scc1 main_kernel_end
s_waitcnt vmcnt(0)
v_max_u32 v126, v8, v10
v_cmp_eq_u32 vcc, -1, v126
s_cbranch_vccnz main_kernel_c0_o2_f
s_branch main_kernel_c0_o2
main_kernel_c0_o3_f:
s_nop 0
s_xor_b32 s32, s23, 3072
buffer_load_dwordx4 v[12:15], v116, s[4:7], s32 offen sc1
s_xor_b32 s32, s23, 4096
buffer_load_dwordx4 v[16:19], v116, s[4:7], s32 offen sc1
s_sub_u32 s29, s29, 1
s_cbranch_scc1 main_kernel_end
s_waitcnt vmcnt(0)
v_max_u32 v126, v12, v14
v_cmp_eq_u32 vcc, -1, v126
s_cbranch_vccnz main_kernel_c0_o3_f
s_branch main_kernel_c0_o3
main_kernel_c0_o4_f:
s_nop 0
s_xor_b32 s32, s23, 4096
buffer_load_dwordx4 v[16:19], v116, s[4:7], s32 offen sc1
s_xor_b32 s32, s23, 5120
buffer_load_dwordx4 v[20:23], v116, s[4:7], s32 offen sc1
s_sub_u32 s29, s29, 1
s_cbranch_scc1 main_kernel_end
s_waitcnt vmcnt(0)
v_max_u32 v126, v16, v18
v_cmp_eq_u32 vcc, -1, v126
s_cbranch_vccnz main_kernel_c0_o4_f
s_branch main_kernel_c0_o4
main_kernel_c0_o5_f:
s_nop 0
s_xor_b32 s32, s23, 5120
buffer_load_dwordx4 v[20:23], v116, s[4:7], s32 offen sc1
s_xor_b32 s32, s23, 6144
buffer_load_dwordx4 v[24:27], v116, s[4:7], s32 offen sc1
s_sub_u32 s29, s29, 1
s_cbranch_scc1 main_kernel_end
s_waitcnt vmcnt(0)
v_max_u32 v126, v20, v22
v_cmp_eq_u32 vcc, -1, v126
s_cbranch_vccnz main_kernel_c0_o5_f
s_branch main_kernel_c0_o5
main_kernel_c0_o6_f:
s_nop 0
s_xor_b32 s32, s23, 6144
buffer_load_dwordx4 v[24:27], v116, s[4:7], s32 offen sc1
s_xor_b32 s32, s23, 7168
buffer_load_dwordx4 v[28:31], v116, s[4:7], s32 offen sc1
s_sub_u32 s29, s29, 1
s_cbranch_scc1 main_kernel_end
s_waitcnt vmcnt(0)
v_max_u32 v126, v24, v26
v_cmp_eq_u32 vcc, -1, v126
s_cbranch_vccnz main_kernel_c0_o6_f
s_branch main_kernel_c0_o6
main_kernel_c0_o7_f:
s_nop 0
s_xor_b32 s32, s23, 7168
buffer_load_dwordx4 v[28:31], v116, s[4:7], s32 offen sc1
s_sub_u32 s29, s29, 1
s_cbranch_scc1 main_kernel_end
s_waitcnt vmcnt(0)
v_max_u32 v126, v28, v30
v_cmp_eq_u32 vcc, -1, v126
s_cbranch_vccnz main_kernel_c0_o7_f
s_branch main_kernel_c0_o7
.p2align 6
main_kernel_c1_top:
s_barrier
buffer_load_dwordx4 v[0:3], v116, s[4:7], s18 offen sc1
s_add_u32 s20, s20, 0x40000
s_bitset0_b32 s20, 20
s_add_u32 s21, s21, 0x40000
s_bitset0_b32 s21, 20
s_add_u32 s22, s22, 0x40000
s_bitset0_b32 s22, 20
s_add_u32 s23, s23, 0x40000
s_bitset0_b32 s23, 20
s_xor_b32 s32, s18, 1024
buffer_load_dwordx4 v[16:19], v116, s[4:7], s32 offen sc1
s_add_u32 s3, s3, 0x40000
s_bitset0_b32 s3, 20
s_add_u32 s17, s17, 1
s_add_u32 s25, s52, s59
s_nop 3
buffer_load_dwordx4 v[64:67], v116, s[4:7], s19 offen sc1
v_mov_b32 v80, 0
v_mov_b32 v81, 0
s_nop 3
s_xor_b32 s32, s19, 1024
buffer_load_dwordx4 v[68:71], v116, s[4:7], s32 offen sc1
v_mov_b32 v82, 0
v_mov_b32 v83, 0
s_nop 3
s_xor_b32 s32, s18, 2048
buffer_load_dwordx4 v[32:35], v116, s[4:7], s32 offen sc1
v_mov_b32 v84, 0
v_mov_b32 v85, 0
s_nop 3
s_xor_b32 s32, s19, 2048
buffer_load_dwordx4 v[72:75], v116, s[4:7], s32 offen sc1
v_mov_b32 v86, 0
v_mov_b32 v87, 0
s_nop 3
s_xor_b32 s32, s18, 3072
buffer_load_dwordx4 v[48:51], v116, s[4:7], s32 offen sc1
v_mov_b32 v88, 0
v_mov_b32 v89, 0
s_nop 3
s_xor_b32 s32, s19, 3072
buffer_load_dwordx4 v[76:79], v116, s[4:7], s32 offen sc1
v_mov_b32 v90, 0
v_mov_b32 v91, 0
s_waitcnt vmcnt(5)
v_pk_add_f16 v0, v0, v64
v_pk_add_f16 v1, v1, v65
v_pk_add_f16 v2, v2, v66
v_pk_add_f16 v3, v3, v67
v_cmp_u_f16 vcc, v0, v2
s_cbranch_vccnz main_kernel_c1_m0_f
main_kernel_c1_m0:
v_smfmac_f32_16x16x64_f16 v[80:83], v[0:3], a[0:7], v112
ds_write_b128 v116, v[0:3] offset:1024
v_smfmac_f32_16x16x64_f16 v[84:87], v[0:3], a[128:135], v112
buffer_load_dword v123, v121, s[4:7], 0 offen sc1
s_waitcnt vmcnt(5)
v_pk_add_f16 v16, v16, v68
v_pk_add_f16 v17, v17, v69
v_pk_add_f16 v18, v18, v70
v_pk_add_f16 v19, v19, v71
v_cmp_u_f16 vcc, v16, v18
s_waitcnt lgkmcnt(0)
s_barrier
ds_read_b128 v[4:7], v116 offset:0
ds_write_b128 v116, v[16:19] offset:5120
s_cbranch_vccnz main_kernel_c1_m1_f
main_kernel_c1_m1:
v_smfmac_f32_16x16x64_f16 v[80:83], v[16:19], a[8:15], v112
v_smfmac_f32_16x16x64_f16 v[84:87], v[16:19], a[136:143], v112
ds_read_b128 v[8:11], v116 offset:3072
v_smfmac_f32_16x16x64_f16 v[88:91], v[0:3], v[128:135], v112
ds_read_b128 v[12:15], v116 offset:2048
s_waitcnt lgkmcnt(3)
v_smfmac_f32_16x16x64_f16 v[80:83], v[4:7], a[32:39], v112
v_smfmac_f32_16x16x64_f16 v[84:87], v[4:7], a[160:167], v112
v_smfmac_f32_16x16x64_f16 v[88:91], v[4:7], v[136:143], v112
s_waitcnt lgkmcnt(2)
s_barrier
s_waitcnt lgkmcnt(1)
v_smfmac_f32_16x16x64_f16 v[80:83], v[8:11], a[64:71], v112
s_waitcnt vmcnt(3)
ds_read_b128 v[20:23], v116 offset:4096
v_pk_add_f16 v32, v32, v72
v_smfmac_f32_16x16x64_f16 v[84:87], v[8:11], a[192:199], v112
ds_read_b128 v[24:27], v116 offset:7168
s_waitcnt lgkmcnt(2)
v_pk_add_f16 v33, v33, v73
v_smfmac_f32_16x16x64_f16 v[80:83], v[12:15], a[96:103], v112
ds_read_b128 v[28:31], v116 offset:6144
v_pk_add_f16 v34, v34, v74
v_smfmac_f32_16x16x64_f16 v[84:87], v[12:15], a[224:231], v112
s_waitcnt lgkmcnt(2)
v_pk_add_f16 v35, v35, v75
v_smfmac_f32_16x16x64_f16 v[80:83], v[20:23], a[40:47], v112
ds_write_b128 v116, v[32:35] offset:9216
v_cmp_u_f16 vcc, v32, v34
v_smfmac_f32_16x16x64_f16 v[84:87], v[20:23], a[168:175], v112
s_cbranch_vccnz main_kernel_c1_m2_f
main_kernel_c1_m2:
v_smfmac_f32_16x16x64_f16 v[80:83], v[32:35], a[16:23], v112
buffer_load_dwordx4 v[96:99], v116, s[4:7], s28 offen sc1
v_smfmac_f32_16x16x64_f16 v[84:87], v[32:35], a[144:151], v112
s_add_u32 s28, s28, 0x40000
s_waitcnt lgkmcnt(2)
v_smfmac_f32_16x16x64_f16 v[80:83], v[24:27], a[72:79], v112
s_waitcnt vmcnt(2)
v_pk_add_f16 v48, v48, v76
v_smfmac_f32_16x16x64_f16 v[84:87], v[24:27], a[200:207], v112
s_waitcnt lgkmcnt(0)
s_barrier
ds_read_b128 v[36:39], v116 offset:8192
v_pk_add_f16 v49, v49, v77
v_smfmac_f32_16x16x64_f16 v[80:83], v[28:31], a[104:111], v112
ds_read_b128 v[40:43], v116 offset:11264
v_pk_add_f16 v50, v50, v78
v_smfmac_f32_16x16x64_f16 v[84:87], v[28:31], a[232:239], v112
ds_read_b128 v[44:47], v116 offset:10240
v_pk_add_f16 v51, v51, v79
v_smfmac_f32_16x16x64_f16 v[88:91], v[8:11], v[144:151], v112
ds_write_b128 v116, v[48:51] offset:13312
s_waitcnt lgkmcnt(3)
v_cmp_u_f16 vcc, v48, v50
v_smfmac_f32_16x16x64_f16 v[80:83], v[36:39], a[48:55], v112
s_cbranch_vccnz main_kernel_c1_m3_f
main_kernel_c1_m3:
v_smfmac_f32_16x16x64_f16 v[80:83], v[48:51], a[24:31], v112
v_smfmac_f32_16x16x64_f16 v[84:87], v[48:51], a[152:159], v112
v_smfmac_f32_16x16x64_f16 v[84:87], v[36:39], a[176:183], v112
s_waitcnt lgkmcnt(2)
v_smfmac_f32_16x16x64_f16 v[80:83], v[40:43], a[80:87], v112
s_waitcnt lgkmcnt(0)
s_barrier
ds_read_b128 v[52:55], v116 offset:12288
v_smfmac_f32_16x16x64_f16 v[84:87], v[40:43], a[208:215], v112
s_add_u32 s19, s52, s54
ds_read_b128 v[56:59], v116 offset:15360
v_smfmac_f32_16x16x64_f16 v[80:83], v[44:47], a[112:119], v112
s_add_u32 s18, s18, 0x40000
ds_read_b128 v[60:63], v116 offset:14336
v_smfmac_f32_16x16x64_f16 v[84:87], v[44:47], a[240:247], v112
s_bitset0_b32 s18, 20
s_waitcnt lgkmcnt(2)
v_smfmac_f32_16x16x64_f16 v[80:83], v[52:55], a[56:63], v112
s_cmp_eq_u32 s17, 30
s_cselect_b32 s32, s53, 0x10000
s_waitcnt lgkmcnt(1)
v_smfmac_f32_16x16x64_f16 v[80:83], v[56:59], a[88:95], v112
s_add_u32 s52, s52, s32
s_waitcnt lgkmcnt(0)
v_smfmac_f32_16x16x64_f16 v[80:83], v[60:63], a[120:127], v112
s_sub_u32 s24, 0x20000, s32
ds_read_b128 v[64:67], v116 offset:24576
v_smfmac_f32_16x16x64_f16 v[84:87], v[52:55], a[184:191], v112
s_add_u32 s55, s55, s24
ds_read_b128 v[68:71], v116 offset:28672
v_smfmac_f32_16x16x64_f16 v[84:87], v[56:59], a[216:223], v112
ds_read_b128 v[72:75], v116 offset:25600
s_nop 0
v_cvt_pk_bf16_f32 v92, v80, v81
v_smfmac_f32_16x16x64_f16 v[84:87], v[60:63], a[248:255], v112
ds_read_b128 v[76:79], v116 offset:29696
s_nop 0
v_cvt_pk_bf16_f32 v93, v82, v83
v_smfmac_f32_16x16x64_f16 v[88:91], v[12:15], v[152:159], v112
s_nop 3
v_cvt_pk_bf16_f32 v94, v84, v85
v_cvt_pk_bf16_f32 v95, v86, v87
s_mov_b32 vcc_lo, 0xcccccccc
s_mov_b32 vcc_hi, 0xcccccccc
v_mfma_f32_16x16x32_bf16 v[84:87], v[92:95], v[104:107], 0
v_add_u32 v121, v121, v122
v_writelane_b32 v121, s55, 39
s_nop 0
v_smfmac_f32_16x16x64_f16 v[88:91], v[16:19], v[160:167], v112
s_nop 2
s_cmp_eq_u32 s17, 63
v_cvt_pk_bf16_f32 v114, v84, v85
v_cvt_pk_bf16_f32 v115, v86, v87
buffer_store_dwordx2 v[114:115], v117, s[4:7], s21 offen
s_cbranch_scc1 main_kernel_c1_last
ds_write_b64 v117, v[114:115] offset:16896
v_smfmac_f32_16x16x64_f16 v[88:91], v[20:23], v[168:175], v112
v_smfmac_f32_16x16x64_f16 v[88:91], v[24:27], v[176:183], v112
v_smfmac_f32_16x16x64_f16 v[88:91], v[28:31], v[184:191], v112
v_smfmac_f32_16x16x64_f16 v[88:91], v[32:35], v[192:199], v112
s_waitcnt lgkmcnt(0)
s_barrier
ds_read_b128 v[0:3], v116 offset:16384
v_smfmac_f32_16x16x64_f16 v[88:91], v[36:39], v[200:207], v112
ds_read_b128 v[4:7], v116 offset:17408
s_waitcnt vmcnt(2)
v_cmp_eq_u32 s[0:1], 0, v123
v_smfmac_f32_16x16x64_f16 v[88:91], v[40:43], v[208:215], v112
ds_read_b128 v[16:19], v116 offset:26624
s_and_b32 s10, s1, 0x3f00
v_smfmac_f32_16x16x64_f16 v[88:91], v[44:47], v[216:223], v112
ds_read_b128 v[20:23], v116 offset:30720
v_smfmac_f32_16x16x64_f16 v[88:91], v[48:51], v[224:231], v112
ds_read_b128 v[24:27], v116 offset:27648
v_smfmac_f32_16x16x64_f16 v[88:91], v[52:55], v[232:239], v112
ds_read_b128 v[28:31], v116 offset:31744
v_smfmac_f32_16x16x64_f16 v[88:91], v[56:59], v[240:247], v112
v_smfmac_f32_16x16x64_f16 v[88:91], v[60:63], v[248:255], v112
s_waitcnt lgkmcnt(5)
v_mfma_f32_16x16x32_bf16 v[80:83], v[64:67], v[0:3], 0
v_mfma_f32_16x16x32_bf16 v[84:87], v[68:71], v[0:3], 0
buffer_load_dwordx4 v[8:11], v116, s[4:7], s20 offen offset:0 sc1
v_mfma_f32_16x16x32_bf16 v[92:95], v[0:3], v[0:3], 0
buffer_load_dwordx4 v[12:15], v116, s[4:7], s20 offen offset:1024 sc1
v_permlane32_swap_b32 v88, v90
s_waitcnt lgkmcnt(4)
v_mfma_f32_16x16x32_bf16 v[80:83], v[72:75], v[4:7], v[80:83]
v_permlane32_swap_b32 v89, v91
v_mfma_f32_16x16x32_bf16 v[84:87], v[76:79], v[4:7], v[84:87]
v_pk_add_f32 v[88:89], v[88:89], v[90:91]
v_mfma_f32_16x16x32_bf16 v[92:95], v[4:7], v[4:7], v[92:95]
v_cvt_pk_bf16_f32 v124, v88, v89
v_mov_b32 v65, 0
s_waitcnt lgkmcnt(0)
s_waitcnt vmcnt(1)
v_mfma_f32_16x16x32_bf16 v[88:91], v[8:11], v[8:11], v[92:95]
v_mfma_f32_16x16x32_bf16 v[0:3], v[16:19], v[8:11], v[80:83]
v_cmp_u_f32 s[0:1], v8, v10
v_mfma_f32_16x16x32_bf16 v[4:7], v[20:23], v[8:11], v[84:87]
s_waitcnt vmcnt(0)
v_mfma_f32_16x16x32_bf16 v[88:91], v[12:15], v[12:15], v[88:91]
v_mfma_f32_16x16x32_bf16 v[0:3], v[24:27], v[12:15], v[0:3]
v_cmp_u_f32 s[32:33], v12, v14
v_mfma_f32_16x16x32_bf16 v[4:7], v[28:31], v[12:15], v[4:7]
s_or_b64 s[0:1], s[0:1], s[32:33]
s_cbranch_scc1 main_kernel_c1_z_f
main_kernel_c1_z:
v_mul_f32 v88, s30, v88
v_mul_f32 v89, s30, v89
v_exp_f32 v88, v88
v_exp_f32 v89, v89
v_cndmask_b32_dpp v0, v2, v0, vcc quad_perm:[2,3,2,3] row_mask:0xf bank_mask:0xf
v_cvt_pk_bf16_f32 v64, v88, v89
v_cndmask_b32_dpp v1, v3, v1, vcc quad_perm:[2,3,2,3] row_mask:0xf bank_mask:0xf
v_exp_f32 v0, v0
v_mfma_f32_16x16x16_bf16 v[16:19], v[100:101], v[64:65], 0
v_exp_f32 v1, v1
v_cndmask_b32_dpp v4, v6, v4, vcc quad_perm:[2,3,2,3] row_mask:0xf bank_mask:0xf
v_mfma_f32_16x16x16_bf16 v[8:11], v[124:125], v[64:65], 0
v_cndmask_b32_dpp v5, v7, v5, vcc quad_perm:[2,3,2,3] row_mask:0xf bank_mask:0xf
v_exp_f32 v4, v4
v_exp_f32 v5, v5
v_cvt_pk_bf16_f32 v92, v0, v1
v_cvt_pk_bf16_f32 v94, v4, v5
v_mov_b32 v80, 0
v_mov_b32_dpp v93, v92 quad_perm:[0,1,0,1] row_mask:0xf bank_mask:0xf
v_mov_b32_dpp v95, v94 quad_perm:[0,1,0,1] row_mask:0xf bank_mask:0xf
v_mov_b32 v81, 0
v_mov_b32 v82, 0
v_mfma_f32_16x16x32_bf16 v[16:19], v[100:103], v[92:95], v[16:19]
v_mov_b32 v83, 0
v_mov_b32 v84, 0
v_mfma_f32_16x16x32_bf16 v[8:11], v[96:99], v[92:95], v[8:11]
s_nop 1
v_mov_b32 v85, 0
v_mov_b32 v86, 0
v_mov_b32 v87, 0
v_rcp_f32 v126, v16
v_subrev_u32 v127, 0x21800000, v16
v_cmp_lt_u32 vcc, 0x3c000000, v127
v_pk_mul_f32 v[8:9], v[8:9], v[126:127] op_sel_hi:[1,0]
v_pk_mul_f32 v[10:11], v[10:11], v[126:127] op_sel_hi:[1,0]
s_and_b32 s32, vcc_lo, 0xcccc
v_cvt_pk_bf16_f32 v126, v8, v9
v_cvt_pk_bf16_f32 v127, v10, v11
s_cbranch_scc1 main_kernel_c1_sm_f
main_kernel_c1_ost:
buffer_store_dwordx2 v[126:127], v118, s[4:7], s22 offen
v_mov_b32 v24, -1
v_mov_b32 v25, -1
v_mov_b32 v26, -1
v_mov_b32 v27, -1
ds_read_b128 v[32:35], v113 offset:0
ds_read_b128 v[36:39], v113 offset:1024
ds_read_b128 v[40:43], v113 offset:2048
ds_read_b128 v[44:47], v113 offset:3072
ds_read_b128 v[48:51], v113 offset:4096
ds_read_b128 v[52:55], v113 offset:5120
buffer_store_dwordx4 v[24:27], v116, s[4:7], s3 offen
buffer_store_dwordx4 v[24:27], v116, s[4:7], s46 offen
s_barrier
buffer_load_dwordx4 v[0:3], v116, s[4:7], s23 offen sc1
ds_read_b128 v[56:59], v113 offset:6144
ds_read_b128 v[60:63], v113 offset:7168
s_add_u32 s46, s46, 0x40000
s_bitset0_b32 s46, 20
s_add_u32 s37, s37, 65536
s_add_u32 s26, s26, 65536
s_xor_b32 s32, s23, 1024
buffer_load_dwordx4 v[4:7], v116, s[4:7], s32 offen sc1
ds_read_b128 v[64:67], v113 offset:8192
ds_read_b128 v[68:71], v113 offset:9216
s_nop 3
s_xor_b32 s32, s23, 2048
buffer_load_dwordx4 v[8:11], v116, s[4:7], s32 offen sc1
ds_read_b128 v[72:75], v113 offset:10240
ds_read_b128 v[76:79], v113 offset:11264
s_nop 3
s_xor_b32 s32, s23, 3072
buffer_load_dwordx4 v[12:15], v116, s[4:7], s32 offen sc1
ds_read_b128 v[88:91], v113 offset:12288
ds_read_b128 v[92:95], v113 offset:13312
s_nop 3
s_xor_b32 s32, s23, 4096
buffer_load_dwordx4 v[16:19], v116, s[4:7], s32 offen sc1
s_nop 7
s_xor_b32 s32, s23, 5120
buffer_load_dwordx4 v[20:23], v116, s[4:7], s32 offen sc1
s_nop 7
s_xor_b32 s32, s23, 6144
buffer_load_dwordx4 v[24:27], v116, s[4:7], s32 offen sc1
s_nop 7
s_xor_b32 s32, s23, 7168
buffer_load_dwordx4 v[28:31], v116, s[4:7], s32 offen sc1
s_waitcnt lgkmcnt(12)
s_waitcnt vmcnt(7)
v_cmp_u_f32 vcc, v0, v2
s_cbranch_vccnz main_kernel_c1_o0_f
main_kernel_c1_o0:
v_smfmac_f32_16x16x64_bf16 v[80:83], v[0:3], v[32:39], v112
ds_read_b128 v[32:35], v113 offset:14336
ds_read_b128 v[36:39], v113 offset:15360
s_waitcnt lgkmcnt(12)
s_waitcnt vmcnt(6)
v_cmp_u_f32 vcc, v4, v6
v_smfmac_f32_16x16x64_bf16 v[84:87], v[0:3], v[40:47], v112
ds_read_b128 v[40:43], v113 offset:16384
ds_read_b128 v[44:47], v113 offset:17408
buffer_store_dwordx2 v[114:115], v119, s[4:7], s37 offen sc1
s_cbranch_vccnz main_kernel_c1_o1_f
main_kernel_c1_o1:
s_waitcnt lgkmcnt(12)
v_smfmac_f32_16x16x64_bf16 v[80:83], v[4:7], v[48:55], v112
ds_read_b128 v[48:51], v113 offset:18432
ds_read_b128 v[52:55], v113 offset:19456
s_waitcnt lgkmcnt(12)
s_waitcnt vmcnt(6)
v_cmp_u_f32 vcc, v8, v10
v_smfmac_f32_16x16x64_bf16 v[84:87], v[4:7], v[56:63], v112
ds_read_b128 v[56:59], v113 offset:20480
ds_read_b128 v[60:63], v113 offset:21504
buffer_store_dword v124, v120, s[4:7], s26 offen sc1
s_cbranch_vccnz main_kernel_c1_o2_f
main_kernel_c1_o2:
s_waitcnt lgkmcnt(12)
v_smfmac_f32_16x16x64_bf16 v[80:83], v[8:11], v[64:71], v112
ds_read_b128 v[64:67], v113 offset:22528
ds_read_b128 v[68:71], v113 offset:23552
s_waitcnt lgkmcnt(12)
s_waitcnt vmcnt(6)
v_cmp_u_f32 vcc, v12, v14
v_smfmac_f32_16x16x64_bf16 v[84:87], v[8:11], v[72:79], v112
ds_read_b128 v[72:75], v113 offset:24576
ds_read_b128 v[76:79], v113 offset:25600
s_cbranch_vccnz main_kernel_c1_o3_f
main_kernel_c1_o3:
s_waitcnt lgkmcnt(12)
v_smfmac_f32_16x16x64_bf16 v[80:83], v[12:15], v[88:95], v112
ds_read_b128 v[88:91], v113 offset:26624
ds_read_b128 v[92:95], v113 offset:27648
s_waitcnt lgkmcnt(12)
s_waitcnt vmcnt(5)
v_cmp_u_f32 vcc, v16, v18
v_smfmac_f32_16x16x64_bf16 v[84:87], v[12:15], v[32:39], v112
ds_read_b128 v[32:35], v113 offset:28672
ds_read_b128 v[36:39], v113 offset:29696
s_cbranch_vccnz main_kernel_c1_o4_f
main_kernel_c1_o4:
s_waitcnt lgkmcnt(12)
v_smfmac_f32_16x16x64_bf16 v[80:83], v[16:19], v[40:47], v112
ds_read_b128 v[40:43], v113 offset:30720
ds_read_b128 v[44:47], v113 offset:31744
s_waitcnt lgkmcnt(12)
s_waitcnt vmcnt(4)
v_cmp_u_f32 vcc, v20, v22
v_smfmac_f32_16x16x64_bf16 v[84:87], v[16:19], v[48:55], v112
s_cbranch_vccnz main_kernel_c1_o5_f
main_kernel_c1_o5:
s_waitcnt lgkmcnt(10)
v_smfmac_f32_16x16x64_bf16 v[80:83], v[20:23], v[56:63], v112
s_waitcnt lgkmcnt(8)
s_waitcnt vmcnt(3)
v_cmp_u_f32 vcc, v24, v26
v_smfmac_f32_16x16x64_bf16 v[84:87], v[20:23], v[64:71], v112
s_cbranch_vccnz main_kernel_c1_o6_f
main_kernel_c1_o6:
s_waitcnt lgkmcnt(6)
v_smfmac_f32_16x16x64_bf16 v[80:83], v[24:27], v[72:79], v112
s_waitcnt lgkmcnt(4)
v_smfmac_f32_16x16x64_bf16 v[84:87], v[24:27], v[88:95], v112
s_waitcnt lgkmcnt(2)
s_waitcnt vmcnt(2)
v_cmp_u_f32 vcc, v28, v30
s_cbranch_vccnz main_kernel_c1_o7_f
main_kernel_c1_o7:
v_smfmac_f32_16x16x64_bf16 v[80:83], v[28:31], v[32:39], v112
s_waitcnt lgkmcnt(0)
v_smfmac_f32_16x16x64_bf16 v[84:87], v[28:31], v[40:47], v112
s_nop 4
v_cvt_pk_bf16_f32 v80, v80, v81
v_cvt_pk_bf16_f32 v81, v82, v83
ds_write_b64 v116, v[80:81] offset:20488
v_cvt_pk_bf16_f32 v82, v84, v85
v_cvt_pk_bf16_f32 v83, v86, v87
ds_write_b64 v116, v[82:83] offset:22536
s_waitcnt lgkmcnt(0)
s_barrier
ds_read_b128 v[72:75], v116 offset:22528
ds_read_b128 v[76:79], v116 offset:23552
s_mov_b32 m0, 26624
s_cmp_lg_u32 s10, 0
s_waitcnt lgkmcnt(1)
v_mfma_f32_16x16x32_bf16 v[64:67], v[72:75], v[108:111], 0
s_waitcnt lgkmcnt(0)
v_mfma_f32_16x16x32_bf16 v[64:67], v[76:79], v[108:111], v[64:67]
s_nop 7
v_cvt_pk_f16_f32 v68, v64, v65
v_cvt_pk_f16_f32 v69, v66, v67
buffer_store_dwordx2 v[68:69], v125, s[4:7], s25 offen sc1
s_cbranch_scc1 main_kernel_c1_kvw
main_kernel_c1_kvok:
s_nop 3
buffer_load_dwordx4 v116, s[4:7], s27 offen sc1 lds
buffer_load_dwordx4 v116, s[4:7], s27 offen offset:1024 sc1 lds
s_mov_b32 m0, 30720
s_xor_b32 s32, s27, 131072
buffer_load_dwordx4 v116, s[4:7], s32 offen offset:0 sc1 lds
s_add_u32 s27, s27, 0x40000
s_branch main_kernel_c1_top
main_kernel_c1_kvw:
s_mov_b32 exec_lo, 0
s_mov_b32 exec_hi, 0x3f00
v_subrev_u32 v127, 128, v121
main_kernel_c1_kvp:
buffer_load_dword v126, v127, s[4:7], 0 offen sc1
s_waitcnt vmcnt(0)
v_cmp_eq_u32 vcc, 0, v126
s_cbranch_vccz main_kernel_c1_kvp_ok
s_sleep 2
s_sub_u32 s29, s29, 1
s_cbranch_scc0 main_kernel_c1_kvp
s_branch main_kernel_end
main_kernel_c1_kvp_ok:
s_mov_b64 exec, -1
s_branch main_kernel_c1_kvok
main_kernel_c1_last:
s_add_u32 s37, s37, 65536
s_add_u32 s26, s26, 65536
buffer_store_dwordx2 v[114:115], v119, s[4:7], s37 offen sc1
v_smfmac_f32_16x16x64_f16 v[88:91], v[20:23], v[168:175], v112
v_smfmac_f32_16x16x64_f16 v[88:91], v[24:27], v[176:183], v112
v_smfmac_f32_16x16x64_f16 v[88:91], v[28:31], v[184:191], v112
v_smfmac_f32_16x16x64_f16 v[88:91], v[32:35], v[192:199], v112
v_smfmac_f32_16x16x64_f16 v[88:91], v[36:39], v[200:207], v112
v_smfmac_f32_16x16x64_f16 v[88:91], v[40:43], v[208:215], v112
v_smfmac_f32_16x16x64_f16 v[88:91], v[44:47], v[216:223], v112
v_smfmac_f32_16x16x64_f16 v[88:91], v[48:51], v[224:231], v112
v_smfmac_f32_16x16x64_f16 v[88:91], v[52:55], v[232:239], v112
v_smfmac_f32_16x16x64_f16 v[88:91], v[56:59], v[240:247], v112
v_smfmac_f32_16x16x64_f16 v[88:91], v[60:63], v[248:255], v112
s_nop 7
v_permlane32_swap_b32 v88, v90
s_nop 1
v_permlane32_swap_b32 v89, v91
s_nop 1
v_pk_add_f32 v[88:89], v[88:89], v[90:91]
s_nop 1
v_cvt_pk_bf16_f32 v124, v88, v89
s_nop 1
buffer_store_dword v124, v120, s[4:7], s26 offen sc1
s_branch main_kernel_end
main_kernel_c1_m0_f:
s_waitcnt lgkmcnt(0)
buffer_load_dwordx4 v[0:3], v116, s[4:7], s18 offen sc1
buffer_load_dwordx4 v[64:67], v116, s[4:7], s19 offen sc1
s_xor_b32 s32, s18, 1024
buffer_load_dwordx4 v[16:19], v116, s[4:7], s32 offen sc1
s_xor_b32 s32, s19, 1024
buffer_load_dwordx4 v[68:71], v116, s[4:7], s32 offen sc1
s_xor_b32 s32, s18, 2048
buffer_load_dwordx4 v[32:35], v116, s[4:7], s32 offen sc1
s_xor_b32 s32, s19, 2048
buffer_load_dwordx4 v[72:75], v116, s[4:7], s32 offen sc1
s_xor_b32 s32, s18, 3072
buffer_load_dwordx4 v[48:51], v116, s[4:7], s32 offen sc1
s_xor_b32 s32, s19, 3072
buffer_load_dwordx4 v[76:79], v116, s[4:7], s32 offen sc1
s_sub_u32 s29, s29, 1
s_cbranch_scc1 main_kernel_end
s_waitcnt vmcnt(0)
v_max_u32 v126, v0, v2
v_max3_u32 v126, v126, v64, v66
v_cmp_eq_u32 vcc, -1, v126
s_cbranch_vccnz main_kernel_c1_m0_f
v_pk_add_f16 v0, v0, v64
v_pk_add_f16 v1, v1, v65
v_pk_add_f16 v2, v2, v66
v_pk_add_f16 v3, v3, v67
s_nop 0
s_branch main_kernel_c1_m0
main_kernel_c1_m1_f:
s_waitcnt lgkmcnt(0)
s_xor_b32 s32, s18, 1024
buffer_load_dwordx4 v[16:19], v116, s[4:7], s32 offen sc1
s_xor_b32 s32, s19, 1024
buffer_load_dwordx4 v[68:71], v116, s[4:7], s32 offen sc1
s_xor_b32 s32, s18, 2048
buffer_load_dwordx4 v[32:35], v116, s[4:7], s32 offen sc1
s_xor_b32 s32, s19, 2048
buffer_load_dwordx4 v[72:75], v116, s[4:7], s32 offen sc1
s_xor_b32 s32, s18, 3072
buffer_load_dwordx4 v[48:51], v116, s[4:7], s32 offen sc1
s_xor_b32 s32, s19, 3072
buffer_load_dwordx4 v[76:79], v116, s[4:7], s32 offen sc1
s_sub_u32 s29, s29, 1
s_cbranch_scc1 main_kernel_end
s_waitcnt vmcnt(0)
v_max_u32 v126, v16, v18
v_max3_u32 v126, v126, v68, v70
v_cmp_eq_u32 vcc, -1, v126
s_cbranch_vccnz main_kernel_c1_m1_f
v_pk_add_f16 v16, v16, v68
v_pk_add_f16 v17, v17, v69
v_pk_add_f16 v18, v18, v70
v_pk_add_f16 v19, v19, v71
ds_write_b128 v116, v[16:19] offset:5120
s_branch main_kernel_c1_m1
main_kernel_c1_m2_f:
s_waitcnt lgkmcnt(0)
s_xor_b32 s32, s18, 2048
buffer_load_dwordx4 v[32:35], v116, s[4:7], s32 offen sc1
s_xor_b32 s32, s19, 2048
buffer_load_dwordx4 v[72:75], v116, s[4:7], s32 offen sc1
s_xor_b32 s32, s18, 3072
buffer_load_dwordx4 v[48:51], v116, s[4:7], s32 offen sc1
s_xor_b32 s32, s19, 3072
buffer_load_dwordx4 v[76:79], v116, s[4:7], s32 offen sc1
s_sub_u32 s29, s29, 1
s_cbranch_scc1 main_kernel_end
s_waitcnt vmcnt(0)
v_max_u32 v126, v32, v34
v_max3_u32 v126, v126, v72, v74
v_cmp_eq_u32 vcc, -1, v126
s_cbranch_vccnz main_kernel_c1_m2_f
v_pk_add_f16 v32, v32, v72
v_pk_add_f16 v33, v33, v73
v_pk_add_f16 v34, v34, v74
v_pk_add_f16 v35, v35, v75
ds_write_b128 v116, v[32:35] offset:9216
s_branch main_kernel_c1_m2
main_kernel_c1_m3_f:
s_waitcnt lgkmcnt(0)
s_xor_b32 s32, s18, 3072
buffer_load_dwordx4 v[48:51], v116, s[4:7], s32 offen sc1
s_xor_b32 s32, s19, 3072
buffer_load_dwordx4 v[76:79], v116, s[4:7], s32 offen sc1
s_sub_u32 s29, s29, 1
s_cbranch_scc1 main_kernel_end
s_waitcnt vmcnt(0)
v_max_u32 v126, v48, v50
v_max3_u32 v126, v126, v76, v78
v_cmp_eq_u32 vcc, -1, v126
s_cbranch_vccnz main_kernel_c1_m3_f
v_pk_add_f16 v48, v48, v76
v_pk_add_f16 v49, v49, v77
v_pk_add_f16 v50, v50, v78
v_pk_add_f16 v51, v51, v79
ds_write_b128 v116, v[48:51] offset:13312
s_branch main_kernel_c1_m3
main_kernel_c1_z_f:
buffer_load_dwordx4 v[8:11], v116, s[4:7], s20 offen offset:0 sc1
buffer_load_dwordx4 v[12:15], v116, s[4:7], s20 offen offset:1024 sc1
s_memtime s[32:33]
ds_read_b32 v126, v116 offset:18432
s_sub_u32 s34, s19, s54
s_xor_b32 s34, s34, 0x2000
s_lshl_b32 s35, s12, 15
s_add_u32 s34, s34, s35
s_lshl_b32 s35, s13, 8
s_add_u32 s35, s35, s34
s_add_u32 s34, s34, 0x4000
s_waitcnt lgkmcnt(0)
s_sub_u32 s32, s32, 450
v_sub_u32 v127, s32, v126
buffer_store_dword v127, off, s[4:7], s34
s_sub_u32 s29, s29, 1
s_cbranch_scc1 main_kernel_end
s_waitcnt vmcnt(1)
main_kernel_c1_z_g:
v_max_u32 v126, v8, v10
v_max3_u32 v126, v126, v12, v14
v_cmp_eq_u32 vcc, -1, v126
s_cbranch_vccnz main_kernel_c1_z_h
v_mfma_f32_16x16x32_bf16 v[88:91], v[8:11], v[8:11], v[92:95]
v_mfma_f32_16x16x32_bf16 v[0:3], v[16:19], v[8:11], v[80:83]
v_mfma_f32_16x16x32_bf16 v[4:7], v[20:23], v[8:11], v[84:87]
v_mfma_f32_16x16x32_bf16 v[88:91], v[12:15], v[12:15], v[88:91]
v_mfma_f32_16x16x32_bf16 v[0:3], v[24:27], v[12:15], v[0:3]
v_mfma_f32_16x16x32_bf16 v[4:7], v[28:31], v[12:15], v[4:7]
buffer_store_dword v127, off, s[4:7], s35 offset:132 sc1
s_mov_b32 vcc_lo, 0xcccccccc
s_mov_b32 vcc_hi, 0xcccccccc
s_branch main_kernel_c1_z
main_kernel_c1_z_h:
buffer_load_dwordx4 v[8:11], v116, s[4:7], s20 offen offset:0 sc1
buffer_load_dwordx4 v[12:15], v116, s[4:7], s20 offen offset:1024 sc1
s_sub_u32 s29, s29, 1
s_cbranch_scc1 main_kernel_end
v_add_u32 v127, 300, v127
s_waitcnt vmcnt(0)
s_branch main_kernel_c1_z_g
main_kernel_c1_sm_f:
s_waitcnt vmcnt(0) lgkmcnt(0)
buffer_load_dwordx4 v[8:11], v116, s[4:7], s20 offen offset:0 sc1
buffer_load_dwordx4 v[12:15], v116, s[4:7], s20 offen offset:1024 sc1
ds_read_b128 v[0:3], v116 offset:16384
ds_read_b128 v[4:7], v116 offset:17408
ds_read_b128 v[64:67], v116 offset:24576
ds_read_b128 v[68:71], v116 offset:28672
ds_read_b128 v[72:75], v116 offset:25600
ds_read_b128 v[76:79], v116 offset:29696
ds_read_b128 v[16:19], v116 offset:26624
ds_read_b128 v[20:23], v116 offset:30720
ds_read_b128 v[24:27], v116 offset:27648
ds_read_b128 v[28:31], v116 offset:31744
s_waitcnt vmcnt(0)
s_waitcnt lgkmcnt(0)
v_mfma_f32_16x16x32_bf16 v[80:83], v[64:67], v[0:3], 0
v_mfma_f32_16x16x32_bf16 v[84:87], v[68:71], v[0:3], 0
v_mfma_f32_16x16x32_bf16 v[92:95], v[0:3], v[0:3], 0
v_mfma_f32_16x16x32_bf16 v[80:83], v[72:75], v[4:7], v[80:83]
v_mfma_f32_16x16x32_bf16 v[84:87], v[76:79], v[4:7], v[84:87]
v_mfma_f32_16x16x32_bf16 v[92:95], v[4:7], v[4:7], v[92:95]
v_mfma_f32_16x16x32_bf16 v[0:3], v[16:19], v[8:11], v[80:83]
v_mfma_f32_16x16x32_bf16 v[4:7], v[20:23], v[8:11], v[84:87]
v_mfma_f32_16x16x32_bf16 v[88:91], v[8:11], v[8:11], v[92:95]
v_mfma_f32_16x16x32_bf16 v[0:3], v[24:27], v[12:15], v[0:3]
v_mfma_f32_16x16x32_bf16 v[4:7], v[28:31], v[12:15], v[4:7]
v_mfma_f32_16x16x32_bf16 v[88:91], v[12:15], v[12:15], v[88:91]
s_nop 7
v_mov_b32 v65, 0
v_max_f32 v126, v88, v89
v_mul_f32 v126, s30, v126
v_max3_f32 v126, v126, v0, v1
v_max3_f32 v126, v126, v2, v3
v_max3_f32 v126, v126, v4, v5
v_max3_f32 v126, v126, v6, v7
v_mov_b32 v127, v126
s_nop 1
v_permlane32_swap_b32 v126, v127
v_max_f32 v126, v126, v127
v_mov_b32 v127, v126
s_nop 1
v_permlane16_swap_b32 v126, v127
v_max_f32 v126, v126, v127
v_mul_f32 v127, 0x40faf233, v126
s_mov_b32 vcc_lo, 0xcccccccc
s_mov_b32 vcc_hi, 0xcccccccc
v_sub_f32 v0, v0, v126
v_sub_f32 v1, v1, v126
v_sub_f32 v2, v2, v126
v_sub_f32 v3, v3, v126
v_sub_f32 v4, v4, v126
v_sub_f32 v5, v5, v126
v_sub_f32 v6, v6, v126
v_sub_f32 v7, v7, v126
v_sub_f32 v88, v88, v127
v_sub_f32 v89, v89, v127
s_waitcnt lgkmcnt(0)
s_nop 0
v_mul_f32 v88, s30, v88
v_mul_f32 v89, s30, v89
v_exp_f32 v88, v88
v_exp_f32 v89, v89
v_cndmask_b32_dpp v0, v2, v0, vcc quad_perm:[2,3,2,3] row_mask:0xf bank_mask:0xf
v_cvt_pk_bf16_f32 v64, v88, v89
v_cndmask_b32_dpp v1, v3, v1, vcc quad_perm:[2,3,2,3] row_mask:0xf bank_mask:0xf
v_exp_f32 v0, v0
v_mfma_f32_16x16x16_bf16 v[16:19], v[100:101], v[64:65], 0
v_exp_f32 v1, v1
v_cndmask_b32_dpp v4, v6, v4, vcc quad_perm:[2,3,2,3] row_mask:0xf bank_mask:0xf
v_mfma_f32_16x16x16_bf16 v[8:11], v[124:125], v[64:65], 0
v_cndmask_b32_dpp v5, v7, v5, vcc quad_perm:[2,3,2,3] row_mask:0xf bank_mask:0xf
v_exp_f32 v4, v4
v_exp_f32 v5, v5
v_cvt_pk_bf16_f32 v92, v0, v1
v_cvt_pk_bf16_f32 v94, v4, v5
v_mov_b32 v80, 0
v_mov_b32_dpp v93, v92 quad_perm:[0,1,0,1] row_mask:0xf bank_mask:0xf
v_mov_b32_dpp v95, v94 quad_perm:[0,1,0,1] row_mask:0xf bank_mask:0xf
v_mov_b32 v81, 0
v_mov_b32 v82, 0
v_mfma_f32_16x16x32_bf16 v[16:19], v[100:103], v[92:95], v[16:19]
v_mov_b32 v83, 0
v_mov_b32 v84, 0
v_mfma_f32_16x16x32_bf16 v[8:11], v[96:99], v[92:95], v[8:11]
s_nop 1
v_mov_b32 v85, 0
v_mov_b32 v86, 0
v_mov_b32 v87, 0
v_rcp_f32 v126, v16
v_subrev_u32 v127, 0x21800000, v16
v_cmp_lt_u32 vcc, 0x3c000000, v127
v_pk_mul_f32 v[8:9], v[8:9], v[126:127] op_sel_hi:[1,0]
v_pk_mul_f32 v[10:11], v[10:11], v[126:127] op_sel_hi:[1,0]
s_and_b32 s32, vcc_lo, 0xcccc
v_cvt_pk_bf16_f32 v126, v8, v9
v_cvt_pk_bf16_f32 v127, v10, v11
s_branch main_kernel_c1_ost
main_kernel_c1_o0_f:
s_nop 0
buffer_load_dwordx4 v[0:3], v116, s[4:7], s23 offen sc1
s_xor_b32 s32, s23, 1024
buffer_load_dwordx4 v[4:7], v116, s[4:7], s32 offen sc1
s_sub_u32 s29, s29, 1
s_cbranch_scc1 main_kernel_end
s_waitcnt vmcnt(0)
v_max_u32 v126, v0, v2
v_cmp_eq_u32 vcc, -1, v126
s_cbranch_vccnz main_kernel_c1_o0_f
s_branch main_kernel_c1_o0
main_kernel_c1_o1_f:
s_nop 0
s_xor_b32 s32, s23, 1024
buffer_load_dwordx4 v[4:7], v116, s[4:7], s32 offen sc1
s_xor_b32 s32, s23, 2048
buffer_load_dwordx4 v[8:11], v116, s[4:7], s32 offen sc1
s_sub_u32 s29, s29, 1
s_cbranch_scc1 main_kernel_end
s_waitcnt vmcnt(0)
v_max_u32 v126, v4, v6
v_cmp_eq_u32 vcc, -1, v126
s_cbranch_vccnz main_kernel_c1_o1_f
s_branch main_kernel_c1_o1
main_kernel_c1_o2_f:
s_nop 0
s_xor_b32 s32, s23, 2048
buffer_load_dwordx4 v[8:11], v116, s[4:7], s32 offen sc1
s_xor_b32 s32, s23, 3072
buffer_load_dwordx4 v[12:15], v116, s[4:7], s32 offen sc1
s_sub_u32 s29, s29, 1
s_cbranch_scc1 main_kernel_end
s_waitcnt vmcnt(0)
v_max_u32 v126, v8, v10
v_cmp_eq_u32 vcc, -1, v126
s_cbranch_vccnz main_kernel_c1_o2_f
s_branch main_kernel_c1_o2
main_kernel_c1_o3_f:
s_nop 0
s_xor_b32 s32, s23, 3072
buffer_load_dwordx4 v[12:15], v116, s[4:7], s32 offen sc1
s_xor_b32 s32, s23, 4096
buffer_load_dwordx4 v[16:19], v116, s[4:7], s32 offen sc1
s_sub_u32 s29, s29, 1
s_cbranch_scc1 main_kernel_end
s_waitcnt vmcnt(0)
v_max_u32 v126, v12, v14
v_cmp_eq_u32 vcc, -1, v126
s_cbranch_vccnz main_kernel_c1_o3_f
s_branch main_kernel_c1_o3
main_kernel_c1_o4_f:
s_nop 0
s_xor_b32 s32, s23, 4096
buffer_load_dwordx4 v[16:19], v116, s[4:7], s32 offen sc1
s_xor_b32 s32, s23, 5120
buffer_load_dwordx4 v[20:23], v116, s[4:7], s32 offen sc1
s_sub_u32 s29, s29, 1
s_cbranch_scc1 main_kernel_end
s_waitcnt vmcnt(0)
v_max_u32 v126, v16, v18
v_cmp_eq_u32 vcc, -1, v126
s_cbranch_vccnz main_kernel_c1_o4_f
s_branch main_kernel_c1_o4
main_kernel_c1_o5_f:
s_nop 0
s_xor_b32 s32, s23, 5120
buffer_load_dwordx4 v[20:23], v116, s[4:7], s32 offen sc1
s_xor_b32 s32, s23, 6144
buffer_load_dwordx4 v[24:27], v116, s[4:7], s32 offen sc1
s_sub_u32 s29, s29, 1
s_cbranch_scc1 main_kernel_end
s_waitcnt vmcnt(0)
v_max_u32 v126, v20, v22
v_cmp_eq_u32 vcc, -1, v126
s_cbranch_vccnz main_kernel_c1_o5_f
s_branch main_kernel_c1_o5
main_kernel_c1_o6_f:
s_nop 0
s_xor_b32 s32, s23, 6144
buffer_load_dwordx4 v[24:27], v116, s[4:7], s32 offen sc1
s_xor_b32 s32, s23, 7168
buffer_load_dwordx4 v[28:31], v116, s[4:7], s32 offen sc1
s_sub_u32 s29, s29, 1
s_cbranch_scc1 main_kernel_end
s_waitcnt vmcnt(0)
v_max_u32 v126, v24, v26
v_cmp_eq_u32 vcc, -1, v126
s_cbranch_vccnz main_kernel_c1_o6_f
s_branch main_kernel_c1_o6
main_kernel_c1_o7_f:
s_nop 0
s_xor_b32 s32, s23, 7168
buffer_load_dwordx4 v[28:31], v116, s[4:7], s32 offen sc1
s_sub_u32 s29, s29, 1
s_cbranch_scc1 main_kernel_end
s_waitcnt vmcnt(0)
v_max_u32 v126, v28, v30
v_cmp_eq_u32 vcc, -1, v126
s_cbranch_vccnz main_kernel_c1_o7_f
s_branch main_kernel_c1_o7
.p2align 6
main_kernel_c2_top:
s_barrier
buffer_load_dwordx4 v[0:3], v116, s[4:7], s18 offen sc1
s_add_u32 s20, s20, 0x40000
s_bitset0_b32 s20, 20
s_add_u32 s21, s21, 0x40000
s_bitset0_b32 s21, 20
s_add_u32 s22, s22, 0x40000
s_bitset0_b32 s22, 20
s_add_u32 s23, s23, 0x40000
s_bitset0_b32 s23, 20
s_xor_b32 s32, s18, 1024
buffer_load_dwordx4 v[16:19], v116, s[4:7], s32 offen sc1
s_add_u32 s3, s3, 0x40000
s_bitset0_b32 s3, 20
s_add_u32 s17, s17, 1
s_add_u32 s25, s25, 0x40000
s_bitset0_b32 s25, 20
s_nop 2
buffer_load_dwordx4 v[64:67], v116, s[4:7], s19 offen sc1
v_mov_b32 v80, 0
v_mov_b32 v81, 0
s_nop 3
s_xor_b32 s32, s19, 1024
buffer_load_dwordx4 v[68:71], v116, s[4:7], s32 offen sc1
v_mov_b32 v82, 0
v_mov_b32 v83, 0
s_nop 3
s_xor_b32 s32, s18, 2048
buffer_load_dwordx4 v[32:35], v116, s[4:7], s32 offen sc1
v_mov_b32 v84, 0
v_mov_b32 v85, 0
s_nop 3
s_xor_b32 s32, s19, 2048
buffer_load_dwordx4 v[72:75], v116, s[4:7], s32 offen sc1
v_mov_b32 v86, 0
v_mov_b32 v87, 0
s_nop 3
s_xor_b32 s32, s18, 3072
buffer_load_dwordx4 v[48:51], v116, s[4:7], s32 offen sc1
v_mov_b32 v88, 0
v_mov_b32 v89, 0
s_nop 3
s_xor_b32 s32, s19, 3072
buffer_load_dwordx4 v[76:79], v116, s[4:7], s32 offen sc1
v_mov_b32 v90, 0
v_mov_b32 v91, 0
s_waitcnt vmcnt(5)
v_pk_add_f16 v0, v0, v64
v_pk_add_f16 v1, v1, v65
v_pk_add_f16 v2, v2, v66
v_pk_add_f16 v3, v3, v67
v_cmp_u_f16 vcc, v0, v2
s_cbranch_vccnz main_kernel_c2_m0_f
main_kernel_c2_m0:
v_smfmac_f32_16x16x64_f16 v[80:83], v[0:3], a[0:7], v112
ds_write_b128 v116, v[0:3] offset:2048
v_smfmac_f32_16x16x64_f16 v[84:87], v[0:3], a[128:135], v112
buffer_load_dword v123, v121, s[4:7], 0 offen sc1
s_waitcnt vmcnt(5)
v_pk_add_f16 v16, v16, v68
v_pk_add_f16 v17, v17, v69
v_pk_add_f16 v18, v18, v70
v_pk_add_f16 v19, v19, v71
v_cmp_u_f16 vcc, v16, v18
s_waitcnt lgkmcnt(0)
s_barrier
ds_read_b128 v[4:7], v116 offset:3072
s_cbranch_vccnz main_kernel_c2_m1_f
main_kernel_c2_m1:
v_smfmac_f32_16x16x64_f16 v[80:83], v[16:19], a[8:15], v112
ds_write_b128 v116, v[16:19] offset:6144
v_smfmac_f32_16x16x64_f16 v[84:87], v[16:19], a[136:143], v112
ds_read_b128 v[8:11], v116 offset:0
v_smfmac_f32_16x16x64_f16 v[88:91], v[0:3], v[128:135], v112
ds_read_b128 v[12:15], v116 offset:1024
s_waitcnt lgkmcnt(3)
v_smfmac_f32_16x16x64_f16 v[80:83], v[4:7], a[32:39], v112
v_smfmac_f32_16x16x64_f16 v[84:87], v[4:7], a[160:167], v112
v_smfmac_f32_16x16x64_f16 v[88:91], v[4:7], v[136:143], v112
s_waitcnt lgkmcnt(2)
s_barrier
s_waitcnt lgkmcnt(1)
v_smfmac_f32_16x16x64_f16 v[80:83], v[8:11], a[64:71], v112
s_waitcnt vmcnt(3)
ds_read_b128 v[20:23], v116 offset:7168
v_pk_add_f16 v32, v32, v72
v_smfmac_f32_16x16x64_f16 v[84:87], v[8:11], a[192:199], v112
ds_read_b128 v[24:27], v116 offset:4096
s_waitcnt lgkmcnt(2)
v_pk_add_f16 v33, v33, v73
v_smfmac_f32_16x16x64_f16 v[80:83], v[12:15], a[96:103], v112
ds_read_b128 v[28:31], v116 offset:5120
v_pk_add_f16 v34, v34, v74
v_smfmac_f32_16x16x64_f16 v[84:87], v[12:15], a[224:231], v112
s_waitcnt lgkmcnt(2)
v_pk_add_f16 v35, v35, v75
v_smfmac_f32_16x16x64_f16 v[80:83], v[20:23], a[40:47], v112
v_cmp_u_f16 vcc, v32, v34
v_smfmac_f32_16x16x64_f16 v[84:87], v[20:23], a[168:175], v112
ds_write_b128 v116, v[32:35] offset:10240
s_cbranch_vccnz main_kernel_c2_m2_f
main_kernel_c2_m2:
v_smfmac_f32_16x16x64_f16 v[80:83], v[32:35], a[16:23], v112
buffer_load_dwordx4 v[96:99], v116, s[4:7], s28 offen sc1
v_smfmac_f32_16x16x64_f16 v[84:87], v[32:35], a[144:151], v112
s_add_u32 s28, s28, 0x40000
s_waitcnt lgkmcnt(2)
v_smfmac_f32_16x16x64_f16 v[80:83], v[24:27], a[72:79], v112
s_waitcnt vmcnt(2)
v_pk_add_f16 v48, v48, v76
v_smfmac_f32_16x16x64_f16 v[84:87], v[24:27], a[200:207], v112
s_waitcnt lgkmcnt(0)
s_barrier
ds_read_b128 v[36:39], v116 offset:11264
v_pk_add_f16 v49, v49, v77
v_smfmac_f32_16x16x64_f16 v[80:83], v[28:31], a[104:111], v112
ds_read_b128 v[40:43], v116 offset:8192
v_pk_add_f16 v50, v50, v78
v_smfmac_f32_16x16x64_f16 v[84:87], v[28:31], a[232:239], v112
ds_read_b128 v[44:47], v116 offset:9216
v_pk_add_f16 v51, v51, v79
v_smfmac_f32_16x16x64_f16 v[88:91], v[8:11], v[144:151], v112
s_waitcnt lgkmcnt(2)
v_cmp_u_f16 vcc, v48, v50
v_smfmac_f32_16x16x64_f16 v[80:83], v[36:39], a[48:55], v112
ds_write_b128 v116, v[48:51] offset:14336
s_cbranch_vccnz main_kernel_c2_m3_f
main_kernel_c2_m3:
v_smfmac_f32_16x16x64_f16 v[80:83], v[48:51], a[24:31], v112
v_smfmac_f32_16x16x64_f16 v[84:87], v[48:51], a[152:159], v112
v_smfmac_f32_16x16x64_f16 v[84:87], v[36:39], a[176:183], v112
s_waitcnt lgkmcnt(2)
v_smfmac_f32_16x16x64_f16 v[80:83], v[40:43], a[80:87], v112
s_waitcnt lgkmcnt(0)
s_barrier
ds_read_b128 v[52:55], v116 offset:15360
v_smfmac_f32_16x16x64_f16 v[84:87], v[40:43], a[208:215], v112
s_add_u32 s19, s52, s54
ds_read_b128 v[56:59], v116 offset:12288
v_smfmac_f32_16x16x64_f16 v[80:83], v[44:47], a[112:119], v112
s_add_u32 s18, s18, 0x40000
ds_read_b128 v[60:63], v116 offset:13312
v_smfmac_f32_16x16x64_f16 v[84:87], v[44:47], a[240:247], v112
s_bitset0_b32 s18, 20
s_waitcnt lgkmcnt(2)
v_smfmac_f32_16x16x64_f16 v[80:83], v[52:55], a[56:63], v112
s_cmp_eq_u32 s17, 30
s_cselect_b32 s32, s53, 0x10000
s_waitcnt lgkmcnt(1)
v_smfmac_f32_16x16x64_f16 v[80:83], v[56:59], a[88:95], v112
s_add_u32 s52, s52, s32
s_waitcnt lgkmcnt(0)
v_smfmac_f32_16x16x64_f16 v[80:83], v[60:63], a[120:127], v112
s_sub_u32 s24, 0x20000, s32
ds_read_b128 v[64:67], v116 offset:24576
v_smfmac_f32_16x16x64_f16 v[84:87], v[52:55], a[184:191], v112
s_add_u32 s55, s55, s24
ds_read_b128 v[68:71], v116 offset:28672
v_smfmac_f32_16x16x64_f16 v[84:87], v[56:59], a[216:223], v112
ds_read_b128 v[72:75], v116 offset:25600
s_nop 0
v_cvt_pk_bf16_f32 v92, v80, v81
v_smfmac_f32_16x16x64_f16 v[84:87], v[60:63], a[248:255], v112
ds_read_b128 v[76:79], v116 offset:29696
s_nop 0
v_cvt_pk_bf16_f32 v93, v82, v83
v_smfmac_f32_16x16x64_f16 v[88:91], v[12:15], v[152:159], v112
s_nop 3
v_cvt_pk_bf16_f32 v94, v84, v85
v_cvt_pk_bf16_f32 v95, v86, v87
s_mov_b32 vcc_lo, 0xcccccccc
s_mov_b32 vcc_hi, 0xcccccccc
v_mfma_f32_16x16x32_bf16 v[84:87], v[92:95], v[104:107], 0
v_add_u32 v121, v121, v122
v_writelane_b32 v121, s55, 39
s_nop 0
v_smfmac_f32_16x16x64_f16 v[88:91], v[16:19], v[160:167], v112
s_nop 2
s_cmp_eq_u32 s17, 63
v_cvt_pk_bf16_f32 v114, v84, v85
v_cvt_pk_bf16_f32 v115, v86, v87
buffer_store_dwordx2 v[114:115], v117, s[4:7], s21 offen
s_cbranch_scc1 main_kernel_c2_last
ds_write_b64 v117, v[114:115] offset:17408
v_smfmac_f32_16x16x64_f16 v[88:91], v[20:23], v[168:175], v112
v_smfmac_f32_16x16x64_f16 v[88:91], v[24:27], v[176:183], v112
v_smfmac_f32_16x16x64_f16 v[88:91], v[28:31], v[184:191], v112
v_smfmac_f32_16x16x64_f16 v[88:91], v[32:35], v[192:199], v112
s_waitcnt lgkmcnt(0)
s_barrier
ds_read_b128 v[0:3], v116 offset:16384
v_smfmac_f32_16x16x64_f16 v[88:91], v[36:39], v[200:207], v112
ds_read_b128 v[4:7], v116 offset:17408
s_waitcnt vmcnt(2)
v_cmp_eq_u32 s[0:1], 0, v123
v_smfmac_f32_16x16x64_f16 v[88:91], v[40:43], v[208:215], v112
ds_read_b128 v[16:19], v116 offset:26624
s_and_b32 s10, s1, 0x3f00
v_smfmac_f32_16x16x64_f16 v[88:91], v[44:47], v[216:223], v112
ds_read_b128 v[20:23], v116 offset:30720
v_smfmac_f32_16x16x64_f16 v[88:91], v[48:51], v[224:231], v112
ds_read_b128 v[24:27], v116 offset:27648
v_smfmac_f32_16x16x64_f16 v[88:91], v[52:55], v[232:239], v112
ds_read_b128 v[28:31], v116 offset:31744
v_smfmac_f32_16x16x64_f16 v[88:91], v[56:59], v[240:247], v112
v_smfmac_f32_16x16x64_f16 v[88:91], v[60:63], v[248:255], v112
s_waitcnt lgkmcnt(5)
v_mfma_f32_16x16x32_bf16 v[80:83], v[64:67], v[0:3], 0
v_mfma_f32_16x16x32_bf16 v[84:87], v[68:71], v[0:3], 0
buffer_load_dwordx4 v[8:11], v116, s[4:7], s20 offen offset:0 sc1
v_mfma_f32_16x16x32_bf16 v[92:95], v[0:3], v[0:3], 0
buffer_load_dwordx4 v[12:15], v116, s[4:7], s20 offen offset:1024 sc1
v_permlane32_swap_b32 v88, v90
s_waitcnt lgkmcnt(4)
v_mfma_f32_16x16x32_bf16 v[80:83], v[72:75], v[4:7], v[80:83]
v_permlane32_swap_b32 v89, v91
v_mfma_f32_16x16x32_bf16 v[84:87], v[76:79], v[4:7], v[84:87]
v_pk_add_f32 v[88:89], v[88:89], v[90:91]
v_mfma_f32_16x16x32_bf16 v[92:95], v[4:7], v[4:7], v[92:95]
v_cvt_pk_bf16_f32 v124, v88, v89
v_mov_b32 v65, 0
s_waitcnt lgkmcnt(0)
s_waitcnt vmcnt(1)
v_mfma_f32_16x16x32_bf16 v[88:91], v[8:11], v[8:11], v[92:95]
v_mfma_f32_16x16x32_bf16 v[0:3], v[16:19], v[8:11], v[80:83]
v_cmp_u_f32 s[0:1], v8, v10
v_mfma_f32_16x16x32_bf16 v[4:7], v[20:23], v[8:11], v[84:87]
s_waitcnt vmcnt(0)
v_mfma_f32_16x16x32_bf16 v[88:91], v[12:15], v[12:15], v[88:91]
v_mfma_f32_16x16x32_bf16 v[0:3], v[24:27], v[12:15], v[0:3]
v_cmp_u_f32 s[32:33], v12, v14
v_mfma_f32_16x16x32_bf16 v[4:7], v[28:31], v[12:15], v[4:7]
s_or_b64 s[0:1], s[0:1], s[32:33]
s_cbranch_scc1 main_kernel_c2_z_f
main_kernel_c2_z:
v_mul_f32 v88, s30, v88
v_mul_f32 v89, s30, v89
v_exp_f32 v88, v88
v_exp_f32 v89, v89
v_cndmask_b32_dpp v0, v2, v0, vcc quad_perm:[2,3,2,3] row_mask:0xf bank_mask:0xf
v_cvt_pk_bf16_f32 v64, v88, v89
v_cndmask_b32_dpp v1, v3, v1, vcc quad_perm:[2,3,2,3] row_mask:0xf bank_mask:0xf
v_exp_f32 v0, v0
v_mfma_f32_16x16x16_bf16 v[16:19], v[100:101], v[64:65], 0
v_exp_f32 v1, v1
v_cndmask_b32_dpp v4, v6, v4, vcc quad_perm:[2,3,2,3] row_mask:0xf bank_mask:0xf
v_mfma_f32_16x16x16_bf16 v[8:11], v[124:125], v[64:65], 0
v_cndmask_b32_dpp v5, v7, v5, vcc quad_perm:[2,3,2,3] row_mask:0xf bank_mask:0xf
v_exp_f32 v4, v4
v_exp_f32 v5, v5
v_cvt_pk_bf16_f32 v92, v0, v1
v_cvt_pk_bf16_f32 v94, v4, v5
v_mov_b32 v80, 0
v_mov_b32_dpp v93, v92 quad_perm:[0,1,0,1] row_mask:0xf bank_mask:0xf
v_mov_b32_dpp v95, v94 quad_perm:[0,1,0,1] row_mask:0xf bank_mask:0xf
v_mov_b32 v81, 0
v_mov_b32 v82, 0
v_mfma_f32_16x16x32_bf16 v[16:19], v[100:103], v[92:95], v[16:19]
v_mov_b32 v83, 0
v_mov_b32 v84, 0
v_mfma_f32_16x16x32_bf16 v[8:11], v[96:99], v[92:95], v[8:11]
s_nop 1
v_mov_b32 v85, 0
v_mov_b32 v86, 0
v_mov_b32 v87, 0
v_rcp_f32 v126, v16
v_subrev_u32 v127, 0x21800000, v16
v_cmp_lt_u32 vcc, 0x3c000000, v127
v_pk_mul_f32 v[8:9], v[8:9], v[126:127] op_sel_hi:[1,0]
v_pk_mul_f32 v[10:11], v[10:11], v[126:127] op_sel_hi:[1,0]
s_and_b32 s32, vcc_lo, 0xcccc
v_cvt_pk_bf16_f32 v126, v8, v9
v_cvt_pk_bf16_f32 v127, v10, v11
s_cbranch_scc1 main_kernel_c2_sm_f
main_kernel_c2_ost:
buffer_store_dwordx2 v[126:127], v118, s[4:7], s22 offen
v_mov_b32 v24, -1
v_mov_b32 v25, -1
v_mov_b32 v26, -1
v_mov_b32 v27, -1
ds_read_b128 v[32:35], v113 offset:0
ds_read_b128 v[36:39], v113 offset:1024
ds_read_b128 v[40:43], v113 offset:2048
ds_read_b128 v[44:47], v113 offset:3072
ds_read_b128 v[48:51], v113 offset:4096
ds_read_b128 v[52:55], v113 offset:5120
buffer_store_dwordx4 v[24:27], v116, s[4:7], s3 offen
s_barrier
buffer_load_dwordx4 v[0:3], v116, s[4:7], s23 offen sc1
ds_read_b128 v[56:59], v113 offset:6144
ds_read_b128 v[60:63], v113 offset:7168
s_add_u32 s37, s37, 65536
s_add_u32 s26, s26, 65536
s_nop 1
s_xor_b32 s32, s23, 1024
buffer_load_dwordx4 v[4:7], v116, s[4:7], s32 offen sc1
ds_read_b128 v[64:67], v113 offset:8192
ds_read_b128 v[68:71], v113 offset:9216
s_nop 3
s_xor_b32 s32, s23, 2048
buffer_load_dwordx4 v[8:11], v116, s[4:7], s32 offen sc1
ds_read_b128 v[72:75], v113 offset:10240
ds_read_b128 v[76:79], v113 offset:11264
s_nop 3
s_xor_b32 s32, s23, 3072
buffer_load_dwordx4 v[12:15], v116, s[4:7], s32 offen sc1
ds_read_b128 v[88:91], v113 offset:12288
ds_read_b128 v[92:95], v113 offset:13312
s_nop 3
s_xor_b32 s32, s23, 4096
buffer_load_dwordx4 v[16:19], v116, s[4:7], s32 offen sc1
s_nop 7
s_xor_b32 s32, s23, 5120
buffer_load_dwordx4 v[20:23], v116, s[4:7], s32 offen sc1
s_nop 7
s_xor_b32 s32, s23, 6144
buffer_load_dwordx4 v[24:27], v116, s[4:7], s32 offen sc1
s_nop 7
s_xor_b32 s32, s23, 7168
buffer_load_dwordx4 v[28:31], v116, s[4:7], s32 offen sc1
s_waitcnt lgkmcnt(12)
s_waitcnt vmcnt(7)
v_cmp_u_f32 vcc, v0, v2
s_cbranch_vccnz main_kernel_c2_o0_f
main_kernel_c2_o0:
v_smfmac_f32_16x16x64_bf16 v[80:83], v[0:3], v[32:39], v112
ds_read_b128 v[32:35], v113 offset:14336
ds_read_b128 v[36:39], v113 offset:15360
s_waitcnt lgkmcnt(12)
s_waitcnt vmcnt(6)
v_cmp_u_f32 vcc, v4, v6
v_smfmac_f32_16x16x64_bf16 v[84:87], v[0:3], v[40:47], v112
ds_read_b128 v[40:43], v113 offset:16384
ds_read_b128 v[44:47], v113 offset:17408
buffer_store_dwordx2 v[114:115], v119, s[4:7], s37 offen sc1
s_cbranch_vccnz main_kernel_c2_o1_f
main_kernel_c2_o1:
s_waitcnt lgkmcnt(12)
v_smfmac_f32_16x16x64_bf16 v[80:83], v[4:7], v[48:55], v112
ds_read_b128 v[48:51], v113 offset:18432
ds_read_b128 v[52:55], v113 offset:19456
s_waitcnt lgkmcnt(12)
s_waitcnt vmcnt(6)
v_cmp_u_f32 vcc, v8, v10
v_smfmac_f32_16x16x64_bf16 v[84:87], v[4:7], v[56:63], v112
ds_read_b128 v[56:59], v113 offset:20480
ds_read_b128 v[60:63], v113 offset:21504
buffer_store_dword v124, v120, s[4:7], s26 offen sc1
s_cbranch_vccnz main_kernel_c2_o2_f
main_kernel_c2_o2:
s_waitcnt lgkmcnt(12)
v_smfmac_f32_16x16x64_bf16 v[80:83], v[8:11], v[64:71], v112
ds_read_b128 v[64:67], v113 offset:22528
ds_read_b128 v[68:71], v113 offset:23552
s_waitcnt lgkmcnt(12)
s_waitcnt vmcnt(6)
v_cmp_u_f32 vcc, v12, v14
v_smfmac_f32_16x16x64_bf16 v[84:87], v[8:11], v[72:79], v112
ds_read_b128 v[72:75], v113 offset:24576
ds_read_b128 v[76:79], v113 offset:25600
s_cbranch_vccnz main_kernel_c2_o3_f
main_kernel_c2_o3:
s_waitcnt lgkmcnt(12)
v_smfmac_f32_16x16x64_bf16 v[80:83], v[12:15], v[88:95], v112
ds_read_b128 v[88:91], v113 offset:26624
ds_read_b128 v[92:95], v113 offset:27648
s_waitcnt lgkmcnt(12)
s_waitcnt vmcnt(5)
v_cmp_u_f32 vcc, v16, v18
v_smfmac_f32_16x16x64_bf16 v[84:87], v[12:15], v[32:39], v112
ds_read_b128 v[32:35], v113 offset:28672
ds_read_b128 v[36:39], v113 offset:29696
s_cbranch_vccnz main_kernel_c2_o4_f
main_kernel_c2_o4:
s_waitcnt lgkmcnt(12)
v_smfmac_f32_16x16x64_bf16 v[80:83], v[16:19], v[40:47], v112
ds_read_b128 v[40:43], v113 offset:30720
ds_read_b128 v[44:47], v113 offset:31744
s_waitcnt lgkmcnt(12)
s_waitcnt vmcnt(4)
v_cmp_u_f32 vcc, v20, v22
v_smfmac_f32_16x16x64_bf16 v[84:87], v[16:19], v[48:55], v112
s_cbranch_vccnz main_kernel_c2_o5_f
main_kernel_c2_o5:
s_waitcnt lgkmcnt(10)
v_smfmac_f32_16x16x64_bf16 v[80:83], v[20:23], v[56:63], v112
s_waitcnt lgkmcnt(8)
s_waitcnt vmcnt(3)
v_cmp_u_f32 vcc, v24, v26
v_smfmac_f32_16x16x64_bf16 v[84:87], v[20:23], v[64:71], v112
s_cbranch_vccnz main_kernel_c2_o6_f
main_kernel_c2_o6:
s_waitcnt lgkmcnt(6)
v_smfmac_f32_16x16x64_bf16 v[80:83], v[24:27], v[72:79], v112
s_waitcnt lgkmcnt(4)
v_smfmac_f32_16x16x64_bf16 v[84:87], v[24:27], v[88:95], v112
s_waitcnt lgkmcnt(2)
s_waitcnt vmcnt(2)
v_cmp_u_f32 vcc, v28, v30
s_cbranch_vccnz main_kernel_c2_o7_f
main_kernel_c2_o7:
v_smfmac_f32_16x16x64_bf16 v[80:83], v[28:31], v[32:39], v112
s_waitcnt lgkmcnt(0)
v_smfmac_f32_16x16x64_bf16 v[84:87], v[28:31], v[40:47], v112
s_nop 4
v_cvt_pk_bf16_f32 v80, v80, v81
v_cvt_pk_bf16_f32 v81, v82, v83
ds_write_b64 v116, v[80:81] offset:21504
v_cvt_pk_bf16_f32 v82, v84, v85
v_cvt_pk_bf16_f32 v83, v86, v87
ds_write_b64 v116, v[82:83] offset:23552
s_waitcnt lgkmcnt(0)
s_barrier
ds_read_b128 v[72:75], v116 offset:20480
ds_read_b128 v[76:79], v116 offset:21504
s_mov_b32 m0, 28672
s_cmp_lg_u32 s10, 0
s_waitcnt lgkmcnt(1)
v_mfma_f32_16x16x32_bf16 v[64:67], v[72:75], v[108:111], 0
s_waitcnt lgkmcnt(0)
v_mfma_f32_16x16x32_bf16 v[64:67], v[76:79], v[108:111], v[64:67]
s_nop 7
v_cvt_pk_f16_f32 v68, v64, v65
v_cvt_pk_f16_f32 v69, v66, v67
buffer_store_dwordx2 v[68:69], v125, s[4:7], s25 offen
s_cbranch_scc1 main_kernel_c2_kvw
main_kernel_c2_kvok:
s_nop 3
buffer_load_dwordx4 v116, s[4:7], s27 offen sc1 lds
buffer_load_dwordx4 v116, s[4:7], s27 offen offset:1024 sc1 lds
s_mov_b32 m0, 30720
s_xor_b32 s32, s27, 2048
buffer_load_dwordx4 v116, s[4:7], s32 offen offset:1024 sc1 lds
s_add_u32 s27, s27, 0x40000
s_branch main_kernel_c2_top
main_kernel_c2_kvw:
s_mov_b32 exec_lo, 0
s_mov_b32 exec_hi, 0x3f00
v_subrev_u32 v127, 128, v121
main_kernel_c2_kvp:
buffer_load_dword v126, v127, s[4:7], 0 offen sc1
s_waitcnt vmcnt(0)
v_cmp_eq_u32 vcc, 0, v126
s_cbranch_vccz main_kernel_c2_kvp_ok
s_sleep 2
s_sub_u32 s29, s29, 1
s_cbranch_scc0 main_kernel_c2_kvp
s_branch main_kernel_end
main_kernel_c2_kvp_ok:
s_mov_b64 exec, -1
s_branch main_kernel_c2_kvok
main_kernel_c2_last:
s_add_u32 s37, s37, 65536
s_add_u32 s26, s26, 65536
buffer_store_dwordx2 v[114:115], v119, s[4:7], s37 offen sc1
v_smfmac_f32_16x16x64_f16 v[88:91], v[20:23], v[168:175], v112
v_smfmac_f32_16x16x64_f16 v[88:91], v[24:27], v[176:183], v112
v_smfmac_f32_16x16x64_f16 v[88:91], v[28:31], v[184:191], v112
v_smfmac_f32_16x16x64_f16 v[88:91], v[32:35], v[192:199], v112
v_smfmac_f32_16x16x64_f16 v[88:91], v[36:39], v[200:207], v112
v_smfmac_f32_16x16x64_f16 v[88:91], v[40:43], v[208:215], v112
v_smfmac_f32_16x16x64_f16 v[88:91], v[44:47], v[216:223], v112
v_smfmac_f32_16x16x64_f16 v[88:91], v[48:51], v[224:231], v112
v_smfmac_f32_16x16x64_f16 v[88:91], v[52:55], v[232:239], v112
v_smfmac_f32_16x16x64_f16 v[88:91], v[56:59], v[240:247], v112
v_smfmac_f32_16x16x64_f16 v[88:91], v[60:63], v[248:255], v112
s_nop 7
v_permlane32_swap_b32 v88, v90
s_nop 1
v_permlane32_swap_b32 v89, v91
s_nop 1
v_pk_add_f32 v[88:89], v[88:89], v[90:91]
s_nop 1
v_cvt_pk_bf16_f32 v124, v88, v89
s_nop 1
buffer_store_dword v124, v120, s[4:7], s26 offen sc1
s_branch main_kernel_end
main_kernel_c2_m0_f:
s_waitcnt lgkmcnt(0)
buffer_load_dwordx4 v[0:3], v116, s[4:7], s18 offen sc1
buffer_load_dwordx4 v[64:67], v116, s[4:7], s19 offen sc1
s_xor_b32 s32, s18, 1024
buffer_load_dwordx4 v[16:19], v116, s[4:7], s32 offen sc1
s_xor_b32 s32, s19, 1024
buffer_load_dwordx4 v[68:71], v116, s[4:7], s32 offen sc1
s_xor_b32 s32, s18, 2048
buffer_load_dwordx4 v[32:35], v116, s[4:7], s32 offen sc1
s_xor_b32 s32, s19, 2048
buffer_load_dwordx4 v[72:75], v116, s[4:7], s32 offen sc1
s_xor_b32 s32, s18, 3072
buffer_load_dwordx4 v[48:51], v116, s[4:7], s32 offen sc1
s_xor_b32 s32, s19, 3072
buffer_load_dwordx4 v[76:79], v116, s[4:7], s32 offen sc1
s_sub_u32 s29, s29, 1
s_cbranch_scc1 main_kernel_end
s_waitcnt vmcnt(0)
v_max_u32 v126, v0, v2
v_max3_u32 v126, v126, v64, v66
v_cmp_eq_u32 vcc, -1, v126
s_cbranch_vccnz main_kernel_c2_m0_f
v_pk_add_f16 v0, v0, v64
v_pk_add_f16 v1, v1, v65
v_pk_add_f16 v2, v2, v66
v_pk_add_f16 v3, v3, v67
s_nop 0
s_branch main_kernel_c2_m0
main_kernel_c2_m1_f:
s_waitcnt lgkmcnt(0)
s_xor_b32 s32, s18, 1024
buffer_load_dwordx4 v[16:19], v116, s[4:7], s32 offen sc1
s_xor_b32 s32, s19, 1024
buffer_load_dwordx4 v[68:71], v116, s[4:7], s32 offen sc1
s_xor_b32 s32, s18, 2048
buffer_load_dwordx4 v[32:35], v116, s[4:7], s32 offen sc1
s_xor_b32 s32, s19, 2048
buffer_load_dwordx4 v[72:75], v116, s[4:7], s32 offen sc1
s_xor_b32 s32, s18, 3072
buffer_load_dwordx4 v[48:51], v116, s[4:7], s32 offen sc1
s_xor_b32 s32, s19, 3072
buffer_load_dwordx4 v[76:79], v116, s[4:7], s32 offen sc1
s_sub_u32 s29, s29, 1
s_cbranch_scc1 main_kernel_end
s_waitcnt vmcnt(0)
v_max_u32 v126, v16, v18
v_max3_u32 v126, v126, v68, v70
v_cmp_eq_u32 vcc, -1, v126
s_cbranch_vccnz main_kernel_c2_m1_f
v_pk_add_f16 v16, v16, v68
v_pk_add_f16 v17, v17, v69
v_pk_add_f16 v18, v18, v70
v_pk_add_f16 v19, v19, v71
s_nop 0
s_branch main_kernel_c2_m1
main_kernel_c2_m2_f:
s_waitcnt lgkmcnt(0)
s_xor_b32 s32, s18, 2048
buffer_load_dwordx4 v[32:35], v116, s[4:7], s32 offen sc1
s_xor_b32 s32, s19, 2048
buffer_load_dwordx4 v[72:75], v116, s[4:7], s32 offen sc1
s_xor_b32 s32, s18, 3072
buffer_load_dwordx4 v[48:51], v116, s[4:7], s32 offen sc1
s_xor_b32 s32, s19, 3072
buffer_load_dwordx4 v[76:79], v116, s[4:7], s32 offen sc1
s_sub_u32 s29, s29, 1
s_cbranch_scc1 main_kernel_end
s_waitcnt vmcnt(0)
v_max_u32 v126, v32, v34
v_max3_u32 v126, v126, v72, v74
v_cmp_eq_u32 vcc, -1, v126
s_cbranch_vccnz main_kernel_c2_m2_f
v_pk_add_f16 v32, v32, v72
v_pk_add_f16 v33, v33, v73
v_pk_add_f16 v34, v34, v74
v_pk_add_f16 v35, v35, v75
ds_write_b128 v116, v[32:35] offset:10240
s_branch main_kernel_c2_m2
main_kernel_c2_m3_f:
s_waitcnt lgkmcnt(0)
s_xor_b32 s32, s18, 3072
buffer_load_dwordx4 v[48:51], v116, s[4:7], s32 offen sc1
s_xor_b32 s32, s19, 3072
buffer_load_dwordx4 v[76:79], v116, s[4:7], s32 offen sc1
s_sub_u32 s29, s29, 1
s_cbranch_scc1 main_kernel_end
s_waitcnt vmcnt(0)
v_max_u32 v126, v48, v50
v_max3_u32 v126, v126, v76, v78
v_cmp_eq_u32 vcc, -1, v126
s_cbranch_vccnz main_kernel_c2_m3_f
v_pk_add_f16 v48, v48, v76
v_pk_add_f16 v49, v49, v77
v_pk_add_f16 v50, v50, v78
v_pk_add_f16 v51, v51, v79
ds_write_b128 v116, v[48:51] offset:14336
s_branch main_kernel_c2_m3
main_kernel_c2_z_f:
buffer_load_dwordx4 v[8:11], v116, s[4:7], s20 offen offset:0 sc1
buffer_load_dwordx4 v[12:15], v116, s[4:7], s20 offen offset:1024 sc1
s_memtime s[32:33]
ds_read_b32 v126, v116 offset:18432
s_sub_u32 s34, s19, s54
s_xor_b32 s34, s34, 0x2000
s_lshl_b32 s35, s12, 15
s_add_u32 s34, s34, s35
s_lshl_b32 s35, s13, 8
s_add_u32 s35, s35, s34
s_add_u32 s34, s34, 0x4000
s_waitcnt lgkmcnt(0)
s_sub_u32 s32, s32, 450
v_sub_u32 v127, s32, v126
buffer_store_dword v127, off, s[4:7], s34
s_sub_u32 s29, s29, 1
s_cbranch_scc1 main_kernel_end
s_waitcnt vmcnt(1)
main_kernel_c2_z_g:
v_max_u32 v126, v8, v10
v_max3_u32 v126, v126, v12, v14
v_cmp_eq_u32 vcc, -1, v126
s_cbranch_vccnz main_kernel_c2_z_h
v_mfma_f32_16x16x32_bf16 v[88:91], v[8:11], v[8:11], v[92:95]
v_mfma_f32_16x16x32_bf16 v[0:3], v[16:19], v[8:11], v[80:83]
v_mfma_f32_16x16x32_bf16 v[4:7], v[20:23], v[8:11], v[84:87]
v_mfma_f32_16x16x32_bf16 v[88:91], v[12:15], v[12:15], v[88:91]
v_mfma_f32_16x16x32_bf16 v[0:3], v[24:27], v[12:15], v[0:3]
v_mfma_f32_16x16x32_bf16 v[4:7], v[28:31], v[12:15], v[4:7]
buffer_store_dword v127, off, s[4:7], s35 offset:132 sc1
s_mov_b32 vcc_lo, 0xcccccccc
s_mov_b32 vcc_hi, 0xcccccccc
s_branch main_kernel_c2_z
main_kernel_c2_z_h:
buffer_load_dwordx4 v[8:11], v116, s[4:7], s20 offen offset:0 sc1
buffer_load_dwordx4 v[12:15], v116, s[4:7], s20 offen offset:1024 sc1
s_sub_u32 s29, s29, 1
s_cbranch_scc1 main_kernel_end
v_add_u32 v127, 300, v127
s_waitcnt vmcnt(0)
s_branch main_kernel_c2_z_g
main_kernel_c2_sm_f:
s_waitcnt vmcnt(0) lgkmcnt(0)
buffer_load_dwordx4 v[8:11], v116, s[4:7], s20 offen offset:0 sc1
buffer_load_dwordx4 v[12:15], v116, s[4:7], s20 offen offset:1024 sc1
ds_read_b128 v[0:3], v116 offset:16384
ds_read_b128 v[4:7], v116 offset:17408
ds_read_b128 v[64:67], v116 offset:24576
ds_read_b128 v[68:71], v116 offset:28672
ds_read_b128 v[72:75], v116 offset:25600
ds_read_b128 v[76:79], v116 offset:29696
ds_read_b128 v[16:19], v116 offset:26624
ds_read_b128 v[20:23], v116 offset:30720
ds_read_b128 v[24:27], v116 offset:27648
ds_read_b128 v[28:31], v116 offset:31744
s_waitcnt vmcnt(0)
s_waitcnt lgkmcnt(0)
v_mfma_f32_16x16x32_bf16 v[80:83], v[64:67], v[0:3], 0
v_mfma_f32_16x16x32_bf16 v[84:87], v[68:71], v[0:3], 0
v_mfma_f32_16x16x32_bf16 v[92:95], v[0:3], v[0:3], 0
v_mfma_f32_16x16x32_bf16 v[80:83], v[72:75], v[4:7], v[80:83]
v_mfma_f32_16x16x32_bf16 v[84:87], v[76:79], v[4:7], v[84:87]
v_mfma_f32_16x16x32_bf16 v[92:95], v[4:7], v[4:7], v[92:95]
v_mfma_f32_16x16x32_bf16 v[0:3], v[16:19], v[8:11], v[80:83]
v_mfma_f32_16x16x32_bf16 v[4:7], v[20:23], v[8:11], v[84:87]
v_mfma_f32_16x16x32_bf16 v[88:91], v[8:11], v[8:11], v[92:95]
v_mfma_f32_16x16x32_bf16 v[0:3], v[24:27], v[12:15], v[0:3]
v_mfma_f32_16x16x32_bf16 v[4:7], v[28:31], v[12:15], v[4:7]
v_mfma_f32_16x16x32_bf16 v[88:91], v[12:15], v[12:15], v[88:91]
s_nop 7
v_mov_b32 v65, 0
v_max_f32 v126, v88, v89
v_mul_f32 v126, s30, v126
v_max3_f32 v126, v126, v0, v1
v_max3_f32 v126, v126, v2, v3
v_max3_f32 v126, v126, v4, v5
v_max3_f32 v126, v126, v6, v7
v_mov_b32 v127, v126
s_nop 1
v_permlane32_swap_b32 v126, v127
v_max_f32 v126, v126, v127
v_mov_b32 v127, v126
s_nop 1
v_permlane16_swap_b32 v126, v127
v_max_f32 v126, v126, v127
v_mul_f32 v127, 0x40faf233, v126
s_mov_b32 vcc_lo, 0xcccccccc
s_mov_b32 vcc_hi, 0xcccccccc
v_sub_f32 v0, v0, v126
v_sub_f32 v1, v1, v126
v_sub_f32 v2, v2, v126
v_sub_f32 v3, v3, v126
v_sub_f32 v4, v4, v126
v_sub_f32 v5, v5, v126
v_sub_f32 v6, v6, v126
v_sub_f32 v7, v7, v126
v_sub_f32 v88, v88, v127
v_sub_f32 v89, v89, v127
s_waitcnt lgkmcnt(0)
s_nop 0
v_mul_f32 v88, s30, v88
v_mul_f32 v89, s30, v89
v_exp_f32 v88, v88
v_exp_f32 v89, v89
v_cndmask_b32_dpp v0, v2, v0, vcc quad_perm:[2,3,2,3] row_mask:0xf bank_mask:0xf
v_cvt_pk_bf16_f32 v64, v88, v89
v_cndmask_b32_dpp v1, v3, v1, vcc quad_perm:[2,3,2,3] row_mask:0xf bank_mask:0xf
v_exp_f32 v0, v0
v_mfma_f32_16x16x16_bf16 v[16:19], v[100:101], v[64:65], 0
v_exp_f32 v1, v1
v_cndmask_b32_dpp v4, v6, v4, vcc quad_perm:[2,3,2,3] row_mask:0xf bank_mask:0xf
v_mfma_f32_16x16x16_bf16 v[8:11], v[124:125], v[64:65], 0
v_cndmask_b32_dpp v5, v7, v5, vcc quad_perm:[2,3,2,3] row_mask:0xf bank_mask:0xf
v_exp_f32 v4, v4
v_exp_f32 v5, v5
v_cvt_pk_bf16_f32 v92, v0, v1
v_cvt_pk_bf16_f32 v94, v4, v5
v_mov_b32 v80, 0
v_mov_b32_dpp v93, v92 quad_perm:[0,1,0,1] row_mask:0xf bank_mask:0xf
v_mov_b32_dpp v95, v94 quad_perm:[0,1,0,1] row_mask:0xf bank_mask:0xf
v_mov_b32 v81, 0
v_mov_b32 v82, 0
v_mfma_f32_16x16x32_bf16 v[16:19], v[100:103], v[92:95], v[16:19]
v_mov_b32 v83, 0
v_mov_b32 v84, 0
v_mfma_f32_16x16x32_bf16 v[8:11], v[96:99], v[92:95], v[8:11]
s_nop 1
v_mov_b32 v85, 0
v_mov_b32 v86, 0
v_mov_b32 v87, 0
v_rcp_f32 v126, v16
v_subrev_u32 v127, 0x21800000, v16
v_cmp_lt_u32 vcc, 0x3c000000, v127
v_pk_mul_f32 v[8:9], v[8:9], v[126:127] op_sel_hi:[1,0]
v_pk_mul_f32 v[10:11], v[10:11], v[126:127] op_sel_hi:[1,0]
s_and_b32 s32, vcc_lo, 0xcccc
v_cvt_pk_bf16_f32 v126, v8, v9
v_cvt_pk_bf16_f32 v127, v10, v11
s_branch main_kernel_c2_ost
main_kernel_c2_o0_f:
s_nop 0
buffer_load_dwordx4 v[0:3], v116, s[4:7], s23 offen sc1
s_xor_b32 s32, s23, 1024
buffer_load_dwordx4 v[4:7], v116, s[4:7], s32 offen sc1
s_sub_u32 s29, s29, 1
s_cbranch_scc1 main_kernel_end
s_waitcnt vmcnt(0)
v_max_u32 v126, v0, v2
v_cmp_eq_u32 vcc, -1, v126
s_cbranch_vccnz main_kernel_c2_o0_f
s_branch main_kernel_c2_o0
main_kernel_c2_o1_f:
s_nop 0
s_xor_b32 s32, s23, 1024
buffer_load_dwordx4 v[4:7], v116, s[4:7], s32 offen sc1
s_xor_b32 s32, s23, 2048
buffer_load_dwordx4 v[8:11], v116, s[4:7], s32 offen sc1
s_sub_u32 s29, s29, 1
s_cbranch_scc1 main_kernel_end
s_waitcnt vmcnt(0)
v_max_u32 v126, v4, v6
v_cmp_eq_u32 vcc, -1, v126
s_cbranch_vccnz main_kernel_c2_o1_f
s_branch main_kernel_c2_o1
main_kernel_c2_o2_f:
s_nop 0
s_xor_b32 s32, s23, 2048
buffer_load_dwordx4 v[8:11], v116, s[4:7], s32 offen sc1
s_xor_b32 s32, s23, 3072
buffer_load_dwordx4 v[12:15], v116, s[4:7], s32 offen sc1
s_sub_u32 s29, s29, 1
s_cbranch_scc1 main_kernel_end
s_waitcnt vmcnt(0)
v_max_u32 v126, v8, v10
v_cmp_eq_u32 vcc, -1, v126
s_cbranch_vccnz main_kernel_c2_o2_f
s_branch main_kernel_c2_o2
main_kernel_c2_o3_f:
s_nop 0
s_xor_b32 s32, s23, 3072
buffer_load_dwordx4 v[12:15], v116, s[4:7], s32 offen sc1
s_xor_b32 s32, s23, 4096
buffer_load_dwordx4 v[16:19], v116, s[4:7], s32 offen sc1
s_sub_u32 s29, s29, 1
s_cbranch_scc1 main_kernel_end
s_waitcnt vmcnt(0)
v_max_u32 v126, v12, v14
v_cmp_eq_u32 vcc, -1, v126
s_cbranch_vccnz main_kernel_c2_o3_f
s_branch main_kernel_c2_o3
main_kernel_c2_o4_f:
s_nop 0
s_xor_b32 s32, s23, 4096
buffer_load_dwordx4 v[16:19], v116, s[4:7], s32 offen sc1
s_xor_b32 s32, s23, 5120
buffer_load_dwordx4 v[20:23], v116, s[4:7], s32 offen sc1
s_sub_u32 s29, s29, 1
s_cbranch_scc1 main_kernel_end
s_waitcnt vmcnt(0)
v_max_u32 v126, v16, v18
v_cmp_eq_u32 vcc, -1, v126
s_cbranch_vccnz main_kernel_c2_o4_f
s_branch main_kernel_c2_o4
main_kernel_c2_o5_f:
s_nop 0
s_xor_b32 s32, s23, 5120
buffer_load_dwordx4 v[20:23], v116, s[4:7], s32 offen sc1
s_xor_b32 s32, s23, 6144
buffer_load_dwordx4 v[24:27], v116, s[4:7], s32 offen sc1
s_sub_u32 s29, s29, 1
s_cbranch_scc1 main_kernel_end
s_waitcnt vmcnt(0)
v_max_u32 v126, v20, v22
v_cmp_eq_u32 vcc, -1, v126
s_cbranch_vccnz main_kernel_c2_o5_f
s_branch main_kernel_c2_o5
main_kernel_c2_o6_f:
s_nop 0
s_xor_b32 s32, s23, 6144
buffer_load_dwordx4 v[24:27], v116, s[4:7], s32 offen sc1
s_xor_b32 s32, s23, 7168
buffer_load_dwordx4 v[28:31], v116, s[4:7], s32 offen sc1
s_sub_u32 s29, s29, 1
s_cbranch_scc1 main_kernel_end
s_waitcnt vmcnt(0)
v_max_u32 v126, v24, v26
v_cmp_eq_u32 vcc, -1, v126
s_cbranch_vccnz main_kernel_c2_o6_f
s_branch main_kernel_c2_o6
main_kernel_c2_o7_f:
s_nop 0
s_xor_b32 s32, s23, 7168
buffer_load_dwordx4 v[28:31], v116, s[4:7], s32 offen sc1
s_sub_u32 s29, s29, 1
s_cbranch_scc1 main_kernel_end
s_waitcnt vmcnt(0)
v_max_u32 v126, v28, v30
v_cmp_eq_u32 vcc, -1, v126
s_cbranch_vccnz main_kernel_c2_o7_f
s_branch main_kernel_c2_o7
.p2align 6
main_kernel_c3_top:
s_barrier
buffer_load_dwordx4 v[0:3], v116, s[4:7], s18 offen sc1
s_add_u32 s20, s20, 0x40000
s_bitset0_b32 s20, 20
s_add_u32 s21, s21, 0x40000
s_bitset0_b32 s21, 20
s_add_u32 s22, s22, 0x40000
s_bitset0_b32 s22, 20
s_add_u32 s23, s23, 0x40000
s_bitset0_b32 s23, 20
s_xor_b32 s32, s18, 1024
buffer_load_dwordx4 v[16:19], v116, s[4:7], s32 offen sc1
s_add_u32 s3, s3, 0x40000
s_bitset0_b32 s3, 20
s_add_u32 s17, s17, 1
s_add_u32 s25, s25, 0x40000
s_bitset0_b32 s25, 20
s_nop 2
buffer_load_dwordx4 v[64:67], v116, s[4:7], s19 offen sc1
v_mov_b32 v80, 0
v_mov_b32 v81, 0
s_nop 3
s_xor_b32 s32, s19, 1024
buffer_load_dwordx4 v[68:71], v116, s[4:7], s32 offen sc1
v_mov_b32 v82, 0
v_mov_b32 v83, 0
s_nop 3
s_xor_b32 s32, s18, 2048
buffer_load_dwordx4 v[32:35], v116, s[4:7], s32 offen sc1
v_mov_b32 v84, 0
v_mov_b32 v85, 0
s_nop 3
s_xor_b32 s32, s19, 2048
buffer_load_dwordx4 v[72:75], v116, s[4:7], s32 offen sc1
v_mov_b32 v86, 0
v_mov_b32 v87, 0
s_nop 3
s_xor_b32 s32, s18, 3072
buffer_load_dwordx4 v[48:51], v116, s[4:7], s32 offen sc1
v_mov_b32 v88, 0
v_mov_b32 v89, 0
s_nop 3
s_xor_b32 s32, s19, 3072
buffer_load_dwordx4 v[76:79], v116, s[4:7], s32 offen sc1
s_memtime s[40:41]
s_memrealtime s[80:81]
s_memrealtime s[82:83]
s_memrealtime s[84:85]
s_memrealtime s[86:87]
s_memrealtime s[88:89]
s_memrealtime s[90:91]
s_memrealtime s[92:93]
s_memrealtime s[94:95]
s_memrealtime s[96:97]
s_memrealtime s[98:99]
s_memrealtime s[100:101]
s_sub_u32 s32, s15, s16
s_lshr_b32 s33, s17, 1
s_min_u32 s33, s33, 3
s_ashr_i32 s32, s32, s33
s_add_u32 s11, s11, s32
s_sub_u32 s32, s16, s27
s_sub_u32 s32, s32, s39
s_ashr_i32 s32, s32, 2
s_add_u32 s39, s39, s32
s_mov_b32 s27, s16
s_mov_b32 s2, s31
v_mov_b32 v126, s11
s_add_u32 s32, s43, 1590
v_mov_b32 v127, s32
s_waitcnt lgkmcnt(0)
ds_write_b32 v116, v126 offset:18432
s_add_u32 s80, s80, s82
s_add_u32 s80, s80, s84
s_add_u32 s80, s80, s86
s_add_u32 s80, s80, s88
s_add_u32 s80, s80, s90
s_add_u32 s80, s80, s92
s_add_u32 s80, s80, s94
s_add_u32 s80, s80, s96
s_add_u32 s80, s80, s98
s_add_u32 s80, s80, s100
s_lshl1_add_u32 s80, s80, s11
s_sub_u32 s15, s40, s80
s_add_u32 s32, s15, s39
v_mov_b32 v126, s32
buffer_store_dwordx2 v[126:127], off, s[4:7], s44 offset:128 sc1
v_mov_b32 v90, 0
v_mov_b32 v91, 0
s_waitcnt vmcnt(6)
v_pk_add_f16 v0, v0, v64
v_pk_add_f16 v1, v1, v65
v_pk_add_f16 v2, v2, v66
v_pk_add_f16 v3, v3, v67
v_cmp_u_f16 vcc, v0, v2
s_cbranch_vccnz main_kernel_c3_m0_f
main_kernel_c3_m0:
v_smfmac_f32_16x16x64_f16 v[80:83], v[0:3], a[0:7], v112
ds_write_b128 v116, v[0:3] offset:3072
v_smfmac_f32_16x16x64_f16 v[84:87], v[0:3], a[128:135], v112
buffer_load_dword v123, v121, s[4:7], 0 offen sc1
s_waitcnt vmcnt(6)
v_pk_add_f16 v16, v16, v68
v_pk_add_f16 v17, v17, v69
v_pk_add_f16 v18, v18, v70
v_pk_add_f16 v19, v19, v71
v_cmp_u_f16 vcc, v16, v18
s_waitcnt lgkmcnt(0)
s_barrier
ds_read_b128 v[4:7], v116 offset:2048
s_cbranch_vccnz main_kernel_c3_m1_f
main_kernel_c3_m1:
v_smfmac_f32_16x16x64_f16 v[80:83], v[16:19], a[8:15], v112
ds_write_b128 v116, v[16:19] offset:7168
v_smfmac_f32_16x16x64_f16 v[84:87], v[16:19], a[136:143], v112
ds_read_b128 v[8:11], v116 offset:1024
v_smfmac_f32_16x16x64_f16 v[88:91], v[0:3], v[128:135], v112
ds_read_b128 v[12:15], v116 offset:0
s_waitcnt lgkmcnt(3)
v_smfmac_f32_16x16x64_f16 v[80:83], v[4:7], a[32:39], v112
v_smfmac_f32_16x16x64_f16 v[84:87], v[4:7], a[160:167], v112
v_smfmac_f32_16x16x64_f16 v[88:91], v[4:7], v[136:143], v112
s_waitcnt lgkmcnt(2)
s_barrier
s_waitcnt lgkmcnt(1)
v_smfmac_f32_16x16x64_f16 v[80:83], v[8:11], a[64:71], v112
s_waitcnt vmcnt(4)
ds_read_b128 v[20:23], v116 offset:6144
v_pk_add_f16 v32, v32, v72
v_smfmac_f32_16x16x64_f16 v[84:87], v[8:11], a[192:199], v112
ds_read_b128 v[24:27], v116 offset:5120
s_waitcnt lgkmcnt(2)
v_pk_add_f16 v33, v33, v73
v_smfmac_f32_16x16x64_f16 v[80:83], v[12:15], a[96:103], v112
ds_read_b128 v[28:31], v116 offset:4096
v_pk_add_f16 v34, v34, v74
v_smfmac_f32_16x16x64_f16 v[84:87], v[12:15], a[224:231], v112
s_waitcnt lgkmcnt(2)
v_pk_add_f16 v35, v35, v75
v_smfmac_f32_16x16x64_f16 v[80:83], v[20:23], a[40:47], v112
v_cmp_u_f16 vcc, v32, v34
v_smfmac_f32_16x16x64_f16 v[84:87], v[20:23], a[168:175], v112
ds_write_b128 v116, v[32:35] offset:11264
s_cbranch_vccnz main_kernel_c3_m2_f
main_kernel_c3_m2:
v_smfmac_f32_16x16x64_f16 v[80:83], v[32:35], a[16:23], v112
buffer_load_dwordx4 v[96:99], v116, s[4:7], s28 offen sc1
v_smfmac_f32_16x16x64_f16 v[84:87], v[32:35], a[144:151], v112
s_add_u32 s28, s28, 0x40000
s_waitcnt lgkmcnt(2)
v_smfmac_f32_16x16x64_f16 v[80:83], v[24:27], a[72:79], v112
s_waitcnt vmcnt(3)
v_pk_add_f16 v48, v48, v76
v_smfmac_f32_16x16x64_f16 v[84:87], v[24:27], a[200:207], v112
s_waitcnt lgkmcnt(0)
s_barrier
ds_read_b128 v[36:39], v116 offset:10240
v_pk_add_f16 v49, v49, v77
v_smfmac_f32_16x16x64_f16 v[80:83], v[28:31], a[104:111], v112
ds_read_b128 v[40:43], v116 offset:9216
v_pk_add_f16 v50, v50, v78
v_smfmac_f32_16x16x64_f16 v[84:87], v[28:31], a[232:239], v112
ds_read_b128 v[44:47], v116 offset:8192
v_pk_add_f16 v51, v51, v79
v_smfmac_f32_16x16x64_f16 v[88:91], v[8:11], v[144:151], v112
s_waitcnt lgkmcnt(2)
v_cmp_u_f16 vcc, v48, v50
v_smfmac_f32_16x16x64_f16 v[80:83], v[36:39], a[48:55], v112
ds_write_b128 v116, v[48:51] offset:15360
s_cbranch_vccnz main_kernel_c3_m3_f
main_kernel_c3_m3:
v_smfmac_f32_16x16x64_f16 v[80:83], v[48:51], a[24:31], v112
v_smfmac_f32_16x16x64_f16 v[84:87], v[48:51], a[152:159], v112
v_smfmac_f32_16x16x64_f16 v[84:87], v[36:39], a[176:183], v112
s_waitcnt lgkmcnt(2)
v_smfmac_f32_16x16x64_f16 v[80:83], v[40:43], a[80:87], v112
s_waitcnt lgkmcnt(0)
s_barrier
ds_read_b128 v[52:55], v116 offset:14336
v_smfmac_f32_16x16x64_f16 v[84:87], v[40:43], a[208:215], v112
s_memtime s[40:41]
ds_read_b128 v[56:59], v116 offset:13312
v_smfmac_f32_16x16x64_f16 v[80:83], v[44:47], a[112:119], v112
s_add_u32 s19, s52, s54
ds_read_b128 v[60:63], v116 offset:12288
v_smfmac_f32_16x16x64_f16 v[84:87], v[44:47], a[240:247], v112
s_add_u32 s18, s18, 0x40000
s_waitcnt lgkmcnt(2)
v_smfmac_f32_16x16x64_f16 v[80:83], v[52:55], a[56:63], v112
s_bitset0_b32 s18, 20
s_waitcnt lgkmcnt(1)
v_smfmac_f32_16x16x64_f16 v[80:83], v[56:59], a[88:95], v112
s_cmp_eq_u32 s17, 30
s_cselect_b32 s32, s53, 0x10000
s_waitcnt lgkmcnt(0)
v_smfmac_f32_16x16x64_f16 v[80:83], v[60:63], a[120:127], v112
s_add_u32 s52, s52, s32
ds_read_b128 v[64:67], v116 offset:24576
v_smfmac_f32_16x16x64_f16 v[84:87], v[52:55], a[184:191], v112
s_sub_u32 s24, 0x20000, s32
ds_read_b128 v[68:71], v116 offset:28672
v_smfmac_f32_16x16x64_f16 v[84:87], v[56:59], a[216:223], v112
ds_read_b128 v[72:75], v116 offset:25600
s_add_u32 s55, s55, s24
v_cvt_pk_bf16_f32 v92, v80, v81
v_smfmac_f32_16x16x64_f16 v[84:87], v[60:63], a[248:255], v112
ds_read_b128 v[76:79], v116 offset:29696
s_nop 0
v_cvt_pk_bf16_f32 v93, v82, v83
v_smfmac_f32_16x16x64_f16 v[88:91], v[12:15], v[152:159], v112
s_nop 3
v_cvt_pk_bf16_f32 v94, v84, v85
v_cvt_pk_bf16_f32 v95, v86, v87
s_mov_b32 vcc_lo, 0xcccccccc
s_mov_b32 vcc_hi, 0xcccccccc
v_mfma_f32_16x16x32_bf16 v[84:87], v[92:95], v[104:107], 0
v_add_u32 v121, v121, v122
s_waitcnt lgkmcnt(0)
s_sub_u32 s31, s40, s11
v_smfmac_f32_16x16x64_f16 v[88:91], v[16:19], v[160:167], v112
s_sub_u32 s32, s31, s43
s_sub_u32 s47, 1590, s32
s_max_i32 s47, s47, 0
s_cmp_eq_u32 s17, 63
v_cvt_pk_bf16_f32 v114, v84, v85
v_cvt_pk_bf16_f32 v115, v86, v87
buffer_store_dwordx2 v[114:115], v117, s[4:7], s21 offen
s_cbranch_scc1 main_kernel_c3_last
ds_write_b64 v117, v[114:115] offset:17920
v_smfmac_f32_16x16x64_f16 v[88:91], v[20:23], v[168:175], v112
s_cmp_gt_u32 s32, 1690
s_cselect_b32 s33, 900, s47
v_smfmac_f32_16x16x64_f16 v[88:91], v[24:27], v[176:183], v112
s_add_u32 s10, s33, s31
s_andn2_b32 s42, s44, 0x1f00
v_mov_b32 v126, s15
v_smfmac_f32_16x16x64_f16 v[88:91], v[28:31], v[184:191], v112
s_add_u32 s42, s42, 0x4000
v_mov_b32 v127, s10
v_smfmac_f32_16x16x64_f16 v[88:91], v[32:35], v[192:199], v112
.p2align 3
main_kernel_c3_b21:
s_sub_u32 s47, s47, 28
s_cbranch_scc0 main_kernel_c3_b21
s_waitcnt lgkmcnt(0)
s_barrier
ds_read_b128 v[0:3], v116 offset:16384
v_smfmac_f32_16x16x64_f16 v[88:91], v[36:39], v[200:207], v112
ds_read_b128 v[4:7], v116 offset:17408
buffer_store_dwordx2 v[126:127], off, s[4:7], s46
v_smfmac_f32_16x16x64_f16 v[88:91], v[40:43], v[208:215], v112
ds_read_b128 v[16:19], v116 offset:26624
s_cmp_gt_u32 s32, 1690
s_cbranch_scc1 main_kernel_c3_rp
main_kernel_c3_rq:
v_smfmac_f32_16x16x64_f16 v[88:91], v[44:47], v[216:223], v112
ds_read_b128 v[20:23], v116 offset:30720
v_writelane_b32 v121, s55, 39
v_smfmac_f32_16x16x64_f16 v[88:91], v[48:51], v[224:231], v112
ds_read_b128 v[24:27], v116 offset:27648
s_waitcnt vmcnt(3)
s_andn2_b32 s35, s46, 0xff
v_bfe_u32 v123, v116, 1, 8
v_smfmac_f32_16x16x64_f16 v[88:91], v[52:55], v[232:239], v112
ds_read_b128 v[28:31], v116 offset:31744
v_smfmac_f32_16x16x64_f16 v[88:91], v[56:59], v[240:247], v112
v_smfmac_f32_16x16x64_f16 v[88:91], v[60:63], v[248:255], v112
s_waitcnt lgkmcnt(5)
v_mfma_f32_16x16x32_bf16 v[80:83], v[64:67], v[0:3], 0
v_mfma_f32_16x16x32_bf16 v[84:87], v[68:71], v[0:3], 0
buffer_load_dwordx4 v[8:11], v116, s[4:7], s20 offen offset:0 sc1
v_mfma_f32_16x16x32_bf16 v[92:95], v[0:3], v[0:3], 0
buffer_load_dwordx4 v[12:15], v116, s[4:7], s20 offen offset:1024 sc1
v_permlane32_swap_b32 v88, v90
s_waitcnt lgkmcnt(4)
v_mfma_f32_16x16x32_bf16 v[80:83], v[72:75], v[4:7], v[80:83]
v_permlane32_swap_b32 v89, v91
v_mfma_f32_16x16x32_bf16 v[84:87], v[76:79], v[4:7], v[84:87]
v_pk_add_f32 v[88:89], v[88:89], v[90:91]
v_mfma_f32_16x16x32_bf16 v[92:95], v[4:7], v[4:7], v[92:95]
v_cvt_pk_bf16_f32 v124, v88, v89
v_mov_b32 v65, 0
buffer_load_dwordx2 v[66:67], v123, s[4:7], s35 offen sc1
s_waitcnt lgkmcnt(0)
s_waitcnt vmcnt(2)
v_mfma_f32_16x16x32_bf16 v[88:91], v[8:11], v[8:11], v[92:95]
v_mfma_f32_16x16x32_bf16 v[0:3], v[16:19], v[8:11], v[80:83]
v_cmp_u_f32 s[0:1], v8, v10
v_mfma_f32_16x16x32_bf16 v[4:7], v[20:23], v[8:11], v[84:87]
s_waitcnt vmcnt(1)
v_mfma_f32_16x16x32_bf16 v[88:91], v[12:15], v[12:15], v[88:91]
v_mfma_f32_16x16x32_bf16 v[0:3], v[24:27], v[12:15], v[0:3]
v_cmp_u_f32 s[32:33], v12, v14
v_mfma_f32_16x16x32_bf16 v[4:7], v[28:31], v[12:15], v[4:7]
s_or_b64 s[0:1], s[0:1], s[32:33]
s_cbranch_scc1 main_kernel_c3_z_f
main_kernel_c3_z:
v_mul_f32 v88, s30, v88
v_mul_f32 v89, s30, v89
v_exp_f32 v88, v88
v_exp_f32 v89, v89
v_cndmask_b32_dpp v0, v2, v0, vcc quad_perm:[2,3,2,3] row_mask:0xf bank_mask:0xf
v_cvt_pk_bf16_f32 v64, v88, v89
v_cndmask_b32_dpp v1, v3, v1, vcc quad_perm:[2,3,2,3] row_mask:0xf bank_mask:0xf
v_exp_f32 v0, v0
v_mfma_f32_16x16x16_bf16 v[16:19], v[100:101], v[64:65], 0
v_exp_f32 v1, v1
v_cndmask_b32_dpp v4, v6, v4, vcc quad_perm:[2,3,2,3] row_mask:0xf bank_mask:0xf
v_mfma_f32_16x16x16_bf16 v[8:11], v[124:125], v[64:65], 0
v_cndmask_b32_dpp v5, v7, v5, vcc quad_perm:[2,3,2,3] row_mask:0xf bank_mask:0xf
v_exp_f32 v4, v4
v_exp_f32 v5, v5
v_cvt_pk_bf16_f32 v92, v0, v1
v_cvt_pk_bf16_f32 v94, v4, v5
v_mov_b32 v80, 0
v_mov_b32_dpp v93, v92 quad_perm:[0,1,0,1] row_mask:0xf bank_mask:0xf
v_mov_b32_dpp v95, v94 quad_perm:[0,1,0,1] row_mask:0xf bank_mask:0xf
v_mov_b32 v81, 0
v_mov_b32 v82, 0
v_mfma_f32_16x16x32_bf16 v[16:19], v[100:103], v[92:95], v[16:19]
v_mov_b32 v83, 0
v_mov_b32 v84, 0
v_mfma_f32_16x16x32_bf16 v[8:11], v[96:99], v[92:95], v[8:11]
s_buffer_load_dword s42, s[4:7], s42
s_nop 1
v_mov_b32 v85, 0
v_mov_b32 v86, 0
v_mov_b32 v87, 0
v_rcp_f32 v126, v16
v_subrev_u32 v127, 0x21800000, v16
v_cmp_lt_u32 vcc, 0x3c000000, v127
v_pk_mul_f32 v[8:9], v[8:9], v[126:127] op_sel_hi:[1,0]
v_pk_mul_f32 v[10:11], v[10:11], v[126:127] op_sel_hi:[1,0]
s_and_b32 s32, vcc_lo, 0xcccc
v_cvt_pk_bf16_f32 v126, v8, v9
v_cvt_pk_bf16_f32 v127, v10, v11
s_cbranch_scc1 main_kernel_c3_sm_f
main_kernel_c3_ost:
buffer_store_dwordx2 v[126:127], v118, s[4:7], s22 offen
s_waitcnt vmcnt(1)
main_kernel_c3_to0:
s_memtime s[40:41]
v_readlane_b32 s16, v66, 0
v_subrev_u32 v67, s2, v67
s_add_u32 s34, s11, s2
s_nop 0
v_max_u32_dpp v67, v67, v67 row_ror:8 row_mask:0xf bank_mask:0xf
s_nop 1
v_max_u32_dpp v67, v67, v67 row_ror:4 row_mask:0xf bank_mask:0xf
s_nop 1
v_max_u32_dpp v67, v67, v67 row_ror:2 row_mask:0xf bank_mask:0xf
s_nop 1
v_max_u32_dpp v67, v67, v67 row_ror:1 row_mask:0xf bank_mask:0xf
s_waitcnt lgkmcnt(0)
v_readlane_b32 s32, v67, 0
v_readlane_b32 s33, v67, 16
s_sub_u32 s34, s40, s34
s_max_u32 s32, s32, s33
s_add_u32 s35, s34, 1536
s_cmp_gt_u32 s32, s35
s_cbranch_scc1 main_kernel_c3_to2
main_kernel_c3_to3:
s_sub_u32 s33, s42, s2
s_cmp_le_u32 s33, s35
s_cselect_b32 s33, s33, 0
s_max_u32 s32, s32, s33
s_add_u32 s36, s32, 2850
s_add_u32 s32, s32, 1270
s_sub_u32 s47, s32, s34
s_max_i32 s47, s47, 0
.p2align 3
main_kernel_c3_to1:
s_sub_u32 s47, s47, 28
s_cbranch_scc0 main_kernel_c3_to1
s_barrier
buffer_load_dwordx4 v[0:3], v116, s[4:7], s23 offen sc1
ds_read_b128 v[32:35], v113 offset:0
ds_read_b128 v[36:39], v113 offset:1024
s_add_u32 s46, s46, 0x40000
s_bitset0_b32 s46, 20
s_add_u32 s37, s37, 65536
s_add_u32 s26, s26, 65536
s_xor_b32 s32, s23, 1024
buffer_load_dwordx4 v[4:7], v116, s[4:7], s32 offen sc1
ds_read_b128 v[40:43], v113 offset:2048
ds_read_b128 v[44:47], v113 offset:3072
s_add_u32 s44, s44, s24
s_nop 2
s_xor_b32 s32, s23, 2048
buffer_load_dwordx4 v[8:11], v116, s[4:7], s32 offen sc1
ds_read_b128 v[48:51], v113 offset:4096
ds_read_b128 v[52:55], v113 offset:5120
s_nop 3
s_xor_b32 s32, s23, 3072
buffer_load_dwordx4 v[12:15], v116, s[4:7], s32 offen sc1
ds_read_b128 v[56:59], v113 offset:6144
ds_read_b128 v[60:63], v113 offset:7168
s_nop 3
s_xor_b32 s32, s23, 4096
buffer_load_dwordx4 v[16:19], v116, s[4:7], s32 offen sc1
ds_read_b128 v[64:67], v113 offset:8192
ds_read_b128 v[68:71], v113 offset:9216
s_nop 3
s_xor_b32 s32, s23, 5120
buffer_load_dwordx4 v[20:23], v116, s[4:7], s32 offen sc1
ds_read_b128 v[72:75], v113 offset:10240
ds_read_b128 v[76:79], v113 offset:11264
s_nop 3
s_xor_b32 s32, s23, 6144
buffer_load_dwordx4 v[24:27], v116, s[4:7], s32 offen sc1
ds_read_b128 v[88:91], v113 offset:12288
ds_read_b128 v[92:95], v113 offset:13312
s_nop 3
s_xor_b32 s32, s23, 7168
buffer_load_dwordx4 v[28:31], v116, s[4:7], s32 offen sc1
v_and_b32 v127, 0x1f0, v116
v_lshlrev_b32 v127, 4, v127
s_waitcnt lgkmcnt(12)
s_waitcnt vmcnt(7)
v_cmp_u_f32 vcc, v0, v2
s_cbranch_vccnz main_kernel_c3_o0_f
main_kernel_c3_o0:
v_smfmac_f32_16x16x64_bf16 v[80:83], v[0:3], v[32:39], v112
ds_read_b128 v[32:35], v113 offset:14336
ds_read_b128 v[36:39], v113 offset:15360
buffer_load_dwordx2 v[96:97], v127, s[4:7], s45 offen offset:128 sc1
s_waitcnt lgkmcnt(12)
s_waitcnt vmcnt(7)
v_cmp_u_f32 vcc, v4, v6
v_smfmac_f32_16x16x64_bf16 v[84:87], v[0:3], v[40:47], v112
ds_read_b128 v[40:43], v113 offset:16384
ds_read_b128 v[44:47], v113 offset:17408
buffer_store_dwordx2 v[114:115], v119, s[4:7], s37 offen sc1
s_cbranch_vccnz main_kernel_c3_o1_f
main_kernel_c3_o1:
s_waitcnt lgkmcnt(12)
v_smfmac_f32_16x16x64_bf16 v[80:83], v[4:7], v[48:55], v112
ds_read_b128 v[48:51], v113 offset:18432
ds_read_b128 v[52:55], v113 offset:19456
s_waitcnt lgkmcnt(12)
s_waitcnt vmcnt(7)
v_cmp_u_f32 vcc, v8, v10
v_smfmac_f32_16x16x64_bf16 v[84:87], v[4:7], v[56:63], v112
ds_read_b128 v[56:59], v113 offset:20480
ds_read_b128 v[60:63], v113 offset:21504
buffer_store_dword v124, v120, s[4:7], s26 offen sc1
s_cbranch_vccnz main_kernel_c3_o2_f
main_kernel_c3_o2:
s_waitcnt lgkmcnt(12)
v_smfmac_f32_16x16x64_bf16 v[80:83], v[8:11], v[64:71], v112
ds_read_b128 v[64:67], v113 offset:22528
ds_read_b128 v[68:71], v113 offset:23552
s_waitcnt lgkmcnt(12)
s_waitcnt vmcnt(7)
v_cmp_u_f32 vcc, v12, v14
v_smfmac_f32_16x16x64_bf16 v[84:87], v[8:11], v[72:79], v112
ds_read_b128 v[72:75], v113 offset:24576
ds_read_b128 v[76:79], v113 offset:25600
s_cbranch_vccnz main_kernel_c3_o3_f
main_kernel_c3_o3:
s_waitcnt lgkmcnt(12)
v_smfmac_f32_16x16x64_bf16 v[80:83], v[12:15], v[88:95], v112
ds_read_b128 v[88:91], v113 offset:26624
ds_read_b128 v[92:95], v113 offset:27648
s_waitcnt lgkmcnt(12)
s_waitcnt vmcnt(6)
v_cmp_u_f32 vcc, v16, v18
v_smfmac_f32_16x16x64_bf16 v[84:87], v[12:15], v[32:39], v112
ds_read_b128 v[32:35], v113 offset:28672
ds_read_b128 v[36:39], v113 offset:29696
s_cbranch_vccnz main_kernel_c3_o4_f
main_kernel_c3_o4:
s_waitcnt lgkmcnt(12)
v_smfmac_f32_16x16x64_bf16 v[80:83], v[16:19], v[40:47], v112
ds_read_b128 v[40:43], v113 offset:30720
ds_read_b128 v[44:47], v113 offset:31744
s_waitcnt lgkmcnt(12)
s_waitcnt vmcnt(5)
v_cmp_u_f32 vcc, v20, v22
v_smfmac_f32_16x16x64_bf16 v[84:87], v[16:19], v[48:55], v112
s_cbranch_vccnz main_kernel_c3_o5_f
main_kernel_c3_o5:
s_waitcnt lgkmcnt(10)
v_smfmac_f32_16x16x64_bf16 v[80:83], v[20:23], v[56:63], v112
s_waitcnt lgkmcnt(8)
s_waitcnt vmcnt(4)
v_cmp_u_f32 vcc, v24, v26
v_smfmac_f32_16x16x64_bf16 v[84:87], v[20:23], v[64:71], v112
s_cbranch_vccnz main_kernel_c3_o6_f
main_kernel_c3_o6:
s_waitcnt lgkmcnt(6)
v_smfmac_f32_16x16x64_bf16 v[80:83], v[24:27], v[72:79], v112
s_waitcnt lgkmcnt(4)
v_smfmac_f32_16x16x64_bf16 v[84:87], v[24:27], v[88:95], v112
s_waitcnt lgkmcnt(2)
s_waitcnt vmcnt(3)
v_cmp_u_f32 vcc, v28, v30
s_cbranch_vccnz main_kernel_c3_o7_f
main_kernel_c3_o7:
v_smfmac_f32_16x16x64_bf16 v[80:83], v[28:31], v[32:39], v112
s_waitcnt lgkmcnt(0)
v_smfmac_f32_16x16x64_bf16 v[84:87], v[28:31], v[40:47], v112
s_nop 4
v_cvt_pk_bf16_f32 v80, v80, v81
v_cvt_pk_bf16_f32 v81, v82, v83
ds_write_b64 v116, v[80:81] offset:21512
v_cvt_pk_bf16_f32 v82, v84, v85
v_cvt_pk_bf16_f32 v83, v86, v87
ds_write_b64 v116, v[82:83] offset:23560
s_waitcnt lgkmcnt(0)
s_barrier
ds_read_b128 v[72:75], v116 offset:22528
ds_read_b128 v[76:79], v116 offset:23552
s_waitcnt lgkmcnt(1)
v_mfma_f32_16x16x32_bf16 v[64:67], v[72:75], v[108:111], 0
s_waitcnt lgkmcnt(0)
v_mfma_f32_16x16x32_bf16 v[64:67], v[76:79], v[108:111], v[64:67]
s_nop 7
v_cvt_pk_f16_f32 v68, v64, v65
v_cvt_pk_f16_f32 v69, v66, v67
buffer_store_dwordx2 v[68:69], v125, s[4:7], s25 offen
s_sub_u32 s0, s2, s16
s_sub_u32 s0, s0, s39
s_waitcnt vmcnt(3)
main_kernel_c3_tm0:
s_memtime s[40:41]
v_sub_u32 v97, v97, v96
v_subrev_u32 v97, s0, v97
s_add_u32 s34, s11, s2
s_nop 0
v_max_u32_dpp v97, v97, v97 row_ror:8 row_mask:0xf bank_mask:0xf
s_nop 1
v_max_u32_dpp v97, v97, v97 row_ror:4 row_mask:0xf bank_mask:0xf
s_nop 1
v_max_u32_dpp v97, v97, v97 row_ror:2 row_mask:0xf bank_mask:0xf
s_nop 1
v_max_u32_dpp v97, v97, v97 row_ror:1 row_mask:0xf bank_mask:0xf
s_waitcnt lgkmcnt(0)
v_readlane_b32 s32, v97, 0
v_readlane_b32 s33, v97, 16
s_sub_u32 s34, s40, s34
s_max_u32 s32, s32, s33
s_add_u32 s35, s34, 1536
s_cmp_gt_u32 s32, s35
s_cbranch_scc1 main_kernel_c3_tm2
main_kernel_c3_tm3:
s_add_u32 s32, s32, 2850
s_max_u32 s32, s32, s36
s_add_u32 s43, s32, s2
s_sub_u32 s47, s32, s34
s_max_i32 s47, s47, 0
.p2align 3
main_kernel_c3_tm1:
s_sub_u32 s47, s47, 28
s_cbranch_scc0 main_kernel_c3_tm1
s_add_u32 s45, s45, s24
s_branch main_kernel_c3_top
main_kernel_c3_to2:
s_mov_b32 s32, s34
s_mov_b32 s16, s15
s_cmp_gt_u32 s34, 0x40000
s_cbranch_scc1 main_kernel_c3_to3
s_andn2_b32 s35, s46, 0xff
v_bfe_u32 v123, v116, 1, 8
buffer_load_dwordx2 v[66:67], v123, s[4:7], s35 offen sc1
s_sub_u32 s29, s29, 1
s_cbranch_scc1 main_kernel_end
s_waitcnt vmcnt(0)
s_branch main_kernel_c3_to0
main_kernel_c3_tm2:
s_mov_b32 s32, s34
s_cmp_gt_u32 s34, 0x40000
s_cbranch_scc1 main_kernel_c3_tm3
v_and_b32 v127, 0x1f0, v116
v_lshlrev_b32 v127, 4, v127
buffer_load_dwordx2 v[96:97], v127, s[4:7], s45 offen offset:128 sc1
s_sub_u32 s29, s29, 1
s_cbranch_scc1 main_kernel_end
s_waitcnt vmcnt(0)
s_branch main_kernel_c3_tm0
main_kernel_c3_rp:
buffer_store_dword v127, off, s[4:7], s44 offset:132 sc1
s_branch main_kernel_c3_rq
main_kernel_c3_last:
s_add_u32 s37, s37, 65536
s_add_u32 s26, s26, 65536
buffer_store_dwordx2 v[114:115], v119, s[4:7], s37 offen sc1
v_smfmac_f32_16x16x64_f16 v[88:91], v[20:23], v[168:175], v112
v_smfmac_f32_16x16x64_f16 v[88:91], v[24:27], v[176:183], v112
v_smfmac_f32_16x16x64_f16 v[88:91], v[28:31], v[184:191], v112
v_smfmac_f32_16x16x64_f16 v[88:91], v[32:35], v[192:199], v112
v_smfmac_f32_16x16x64_f16 v[88:91], v[36:39], v[200:207], v112
v_smfmac_f32_16x16x64_f16 v[88:91], v[40:43], v[208:215], v112
v_smfmac_f32_16x16x64_f16 v[88:91], v[44:47], v[216:223], v112
v_smfmac_f32_16x16x64_f16 v[88:91], v[48:51], v[224:231], v112
v_smfmac_f32_16x16x64_f16 v[88:91], v[52:55], v[232:239], v112
v_smfmac_f32_16x16x64_f16 v[88:91], v[56:59], v[240:247], v112
v_smfmac_f32_16x16x64_f16 v[88:91], v[60:63], v[248:255], v112
s_nop 7
v_permlane32_swap_b32 v88, v90
s_nop 1
v_permlane32_swap_b32 v89, v91
s_nop 1
v_pk_add_f32 v[88:89], v[88:89], v[90:91]
s_nop 1
v_cvt_pk_bf16_f32 v124, v88, v89
s_nop 1
buffer_store_dword v124, v120, s[4:7], s26 offen sc1
s_branch main_kernel_end
main_kernel_c3_m0_f:
s_waitcnt lgkmcnt(0)
buffer_load_dwordx4 v[0:3], v116, s[4:7], s18 offen sc1
buffer_load_dwordx4 v[64:67], v116, s[4:7], s19 offen sc1
s_xor_b32 s32, s18, 1024
buffer_load_dwordx4 v[16:19], v116, s[4:7], s32 offen sc1
s_xor_b32 s32, s19, 1024
buffer_load_dwordx4 v[68:71], v116, s[4:7], s32 offen sc1
s_xor_b32 s32, s18, 2048
buffer_load_dwordx4 v[32:35], v116, s[4:7], s32 offen sc1
s_xor_b32 s32, s19, 2048
buffer_load_dwordx4 v[72:75], v116, s[4:7], s32 offen sc1
s_xor_b32 s32, s18, 3072
buffer_load_dwordx4 v[48:51], v116, s[4:7], s32 offen sc1
s_xor_b32 s32, s19, 3072
buffer_load_dwordx4 v[76:79], v116, s[4:7], s32 offen sc1
s_sub_u32 s29, s29, 1
s_cbranch_scc1 main_kernel_end
s_waitcnt vmcnt(0)
v_max_u32 v126, v0, v2
v_max3_u32 v126, v126, v64, v66
v_cmp_eq_u32 vcc, -1, v126
s_cbranch_vccnz main_kernel_c3_m0_f
v_pk_add_f16 v0, v0, v64
v_pk_add_f16 v1, v1, v65
v_pk_add_f16 v2, v2, v66
v_pk_add_f16 v3, v3, v67
s_nop 0
s_branch main_kernel_c3_m0
main_kernel_c3_m1_f:
s_waitcnt lgkmcnt(0)
s_xor_b32 s32, s18, 1024
buffer_load_dwordx4 v[16:19], v116, s[4:7], s32 offen sc1
s_xor_b32 s32, s19, 1024
buffer_load_dwordx4 v[68:71], v116, s[4:7], s32 offen sc1
s_xor_b32 s32, s18, 2048
buffer_load_dwordx4 v[32:35], v116, s[4:7], s32 offen sc1
s_xor_b32 s32, s19, 2048
buffer_load_dwordx4 v[72:75], v116, s[4:7], s32 offen sc1
s_xor_b32 s32, s18, 3072
buffer_load_dwordx4 v[48:51], v116, s[4:7], s32 offen sc1
s_xor_b32 s32, s19, 3072
buffer_load_dwordx4 v[76:79], v116, s[4:7], s32 offen sc1
s_sub_u32 s29, s29, 1
s_cbranch_scc1 main_kernel_end
s_waitcnt vmcnt(0)
v_max_u32 v126, v16, v18
v_max3_u32 v126, v126, v68, v70
v_cmp_eq_u32 vcc, -1, v126
s_cbranch_vccnz main_kernel_c3_m1_f
v_pk_add_f16 v16, v16, v68
v_pk_add_f16 v17, v17, v69
v_pk_add_f16 v18, v18, v70
v_pk_add_f16 v19, v19, v71
s_nop 0
s_branch main_kernel_c3_m1
main_kernel_c3_m2_f:
s_waitcnt lgkmcnt(0)
s_xor_b32 s32, s18, 2048
buffer_load_dwordx4 v[32:35], v116, s[4:7], s32 offen sc1
s_xor_b32 s32, s19, 2048
buffer_load_dwordx4 v[72:75], v116, s[4:7], s32 offen sc1
s_xor_b32 s32, s18, 3072
buffer_load_dwordx4 v[48:51], v116, s[4:7], s32 offen sc1
s_xor_b32 s32, s19, 3072
buffer_load_dwordx4 v[76:79], v116, s[4:7], s32 offen sc1
s_sub_u32 s29, s29, 1
s_cbranch_scc1 main_kernel_end
s_waitcnt vmcnt(0)
v_max_u32 v126, v32, v34
v_max3_u32 v126, v126, v72, v74
v_cmp_eq_u32 vcc, -1, v126
s_cbranch_vccnz main_kernel_c3_m2_f
v_pk_add_f16 v32, v32, v72
v_pk_add_f16 v33, v33, v73
v_pk_add_f16 v34, v34, v74
v_pk_add_f16 v35, v35, v75
ds_write_b128 v116, v[32:35] offset:11264
s_branch main_kernel_c3_m2
main_kernel_c3_m3_f:
s_waitcnt lgkmcnt(0)
s_xor_b32 s32, s18, 3072
buffer_load_dwordx4 v[48:51], v116, s[4:7], s32 offen sc1
s_xor_b32 s32, s19, 3072
buffer_load_dwordx4 v[76:79], v116, s[4:7], s32 offen sc1
s_sub_u32 s29, s29, 1
s_cbranch_scc1 main_kernel_end
s_waitcnt vmcnt(0)
v_max_u32 v126, v48, v50
v_max3_u32 v126, v126, v76, v78
v_cmp_eq_u32 vcc, -1, v126
s_cbranch_vccnz main_kernel_c3_m3_f
v_pk_add_f16 v48, v48, v76
v_pk_add_f16 v49, v49, v77
v_pk_add_f16 v50, v50, v78
v_pk_add_f16 v51, v51, v79
ds_write_b128 v116, v[48:51] offset:15360
s_branch main_kernel_c3_m3
main_kernel_c3_z_f:
buffer_load_dwordx4 v[8:11], v116, s[4:7], s20 offen offset:0 sc1
buffer_load_dwordx4 v[12:15], v116, s[4:7], s20 offen offset:1024 sc1
s_memtime s[32:33]
ds_read_b32 v126, v116 offset:18432
s_sub_u32 s34, s19, s54
s_xor_b32 s34, s34, 0x2000
s_lshl_b32 s35, s12, 15
s_add_u32 s34, s34, s35
s_lshl_b32 s35, s13, 8
s_add_u32 s35, s35, s34
s_add_u32 s34, s34, 0x4000
s_waitcnt lgkmcnt(0)
s_sub_u32 s32, s32, 450
v_sub_u32 v126, s32, v126
v_max_u32 v127, v126, v127
buffer_store_dword v127, off, s[4:7], s34
s_sub_u32 s29, s29, 1
s_cbranch_scc1 main_kernel_end
s_waitcnt vmcnt(1)
main_kernel_c3_z_g:
v_max_u32 v126, v8, v10
v_max3_u32 v126, v126, v12, v14
v_cmp_eq_u32 vcc, -1, v126
s_cbranch_vccnz main_kernel_c3_z_h
v_mfma_f32_16x16x32_bf16 v[88:91], v[8:11], v[8:11], v[92:95]
v_mfma_f32_16x16x32_bf16 v[0:3], v[16:19], v[8:11], v[80:83]
v_mfma_f32_16x16x32_bf16 v[4:7], v[20:23], v[8:11], v[84:87]
v_mfma_f32_16x16x32_bf16 v[88:91], v[12:15], v[12:15], v[88:91]
v_mfma_f32_16x16x32_bf16 v[0:3], v[24:27], v[12:15], v[0:3]
v_mfma_f32_16x16x32_bf16 v[4:7], v[28:31], v[12:15], v[4:7]
buffer_store_dword v127, off, s[4:7], s35 offset:132 sc1
s_mov_b32 vcc_lo, 0xcccccccc
s_mov_b32 vcc_hi, 0xcccccccc
s_branch main_kernel_c3_z
main_kernel_c3_z_h:
buffer_load_dwordx4 v[8:11], v116, s[4:7], s20 offen offset:0 sc1
buffer_load_dwordx4 v[12:15], v116, s[4:7], s20 offen offset:1024 sc1
s_sub_u32 s29, s29, 1
s_cbranch_scc1 main_kernel_end
v_add_u32 v127, 300, v127
s_waitcnt vmcnt(0)
s_branch main_kernel_c3_z_g
main_kernel_c3_sm_f:
s_waitcnt vmcnt(0) lgkmcnt(0)
buffer_load_dwordx4 v[8:11], v116, s[4:7], s20 offen offset:0 sc1
buffer_load_dwordx4 v[12:15], v116, s[4:7], s20 offen offset:1024 sc1
ds_read_b128 v[0:3], v116 offset:16384
ds_read_b128 v[4:7], v116 offset:17408
ds_read_b128 v[64:67], v116 offset:24576
ds_read_b128 v[68:71], v116 offset:28672
ds_read_b128 v[72:75], v116 offset:25600
ds_read_b128 v[76:79], v116 offset:29696
ds_read_b128 v[16:19], v116 offset:26624
ds_read_b128 v[20:23], v116 offset:30720
ds_read_b128 v[24:27], v116 offset:27648
ds_read_b128 v[28:31], v116 offset:31744
s_waitcnt vmcnt(0)
s_waitcnt lgkmcnt(0)
v_mfma_f32_16x16x32_bf16 v[80:83], v[64:67], v[0:3], 0
v_mfma_f32_16x16x32_bf16 v[84:87], v[68:71], v[0:3], 0
v_mfma_f32_16x16x32_bf16 v[92:95], v[0:3], v[0:3], 0
v_mfma_f32_16x16x32_bf16 v[80:83], v[72:75], v[4:7], v[80:83]
v_mfma_f32_16x16x32_bf16 v[84:87], v[76:79], v[4:7], v[84:87]
v_mfma_f32_16x16x32_bf16 v[92:95], v[4:7], v[4:7], v[92:95]
v_mfma_f32_16x16x32_bf16 v[0:3], v[16:19], v[8:11], v[80:83]
v_mfma_f32_16x16x32_bf16 v[4:7], v[20:23], v[8:11], v[84:87]
v_mfma_f32_16x16x32_bf16 v[88:91], v[8:11], v[8:11], v[92:95]
v_mfma_f32_16x16x32_bf16 v[0:3], v[24:27], v[12:15], v[0:3]
v_mfma_f32_16x16x32_bf16 v[4:7], v[28:31], v[12:15], v[4:7]
v_mfma_f32_16x16x32_bf16 v[88:91], v[12:15], v[12:15], v[88:91]
s_nop 7
v_mov_b32 v65, 0
v_max_f32 v126, v88, v89
v_mul_f32 v126, s30, v126
v_max3_f32 v126, v126, v0, v1
v_max3_f32 v126, v126, v2, v3
v_max3_f32 v126, v126, v4, v5
v_max3_f32 v126, v126, v6, v7
v_mov_b32 v127, v126
s_nop 1
v_permlane32_swap_b32 v126, v127
v_max_f32 v126, v126, v127
v_mov_b32 v127, v126
s_nop 1
v_permlane16_swap_b32 v126, v127
v_max_f32 v126, v126, v127
v_mul_f32 v127, 0x40faf233, v126
s_mov_b32 vcc_lo, 0xcccccccc
s_mov_b32 vcc_hi, 0xcccccccc
v_sub_f32 v0, v0, v126
v_sub_f32 v1, v1, v126
v_sub_f32 v2, v2, v126
v_sub_f32 v3, v3, v126
v_sub_f32 v4, v4, v126
v_sub_f32 v5, v5, v126
v_sub_f32 v6, v6, v126
v_sub_f32 v7, v7, v126
v_sub_f32 v88, v88, v127
v_sub_f32 v89, v89, v127
s_waitcnt lgkmcnt(0)
s_nop 0
v_mul_f32 v88, s30, v88
v_mul_f32 v89, s30, v89
v_exp_f32 v88, v88
v_exp_f32 v89, v89
v_cndmask_b32_dpp v0, v2, v0, vcc quad_perm:[2,3,2,3] row_mask:0xf bank_mask:0xf
v_cvt_pk_bf16_f32 v64, v88, v89
v_cndmask_b32_dpp v1, v3, v1, vcc quad_perm:[2,3,2,3] row_mask:0xf bank_mask:0xf
v_exp_f32 v0, v0
v_mfma_f32_16x16x16_bf16 v[16:19], v[100:101], v[64:65], 0
v_exp_f32 v1, v1
v_cndmask_b32_dpp v4, v6, v4, vcc quad_perm:[2,3,2,3] row_mask:0xf bank_mask:0xf
v_mfma_f32_16x16x16_bf16 v[8:11], v[124:125], v[64:65], 0
v_cndmask_b32_dpp v5, v7, v5, vcc quad_perm:[2,3,2,3] row_mask:0xf bank_mask:0xf
v_exp_f32 v4, v4
v_exp_f32 v5, v5
v_cvt_pk_bf16_f32 v92, v0, v1
v_cvt_pk_bf16_f32 v94, v4, v5
v_mov_b32 v80, 0
v_mov_b32_dpp v93, v92 quad_perm:[0,1,0,1] row_mask:0xf bank_mask:0xf
v_mov_b32_dpp v95, v94 quad_perm:[0,1,0,1] row_mask:0xf bank_mask:0xf
v_mov_b32 v81, 0
v_mov_b32 v82, 0
v_mfma_f32_16x16x32_bf16 v[16:19], v[100:103], v[92:95], v[16:19]
v_mov_b32 v83, 0
v_mov_b32 v84, 0
v_mfma_f32_16x16x32_bf16 v[8:11], v[96:99], v[92:95], v[8:11]
s_nop 1
v_mov_b32 v85, 0
v_mov_b32 v86, 0
v_mov_b32 v87, 0
v_rcp_f32 v126, v16
v_subrev_u32 v127, 0x21800000, v16
v_cmp_lt_u32 vcc, 0x3c000000, v127
v_pk_mul_f32 v[8:9], v[8:9], v[126:127] op_sel_hi:[1,0]
v_pk_mul_f32 v[10:11], v[10:11], v[126:127] op_sel_hi:[1,0]
s_and_b32 s32, vcc_lo, 0xcccc
v_cvt_pk_bf16_f32 v126, v8, v9
v_cvt_pk_bf16_f32 v127, v10, v11
s_andn2_b32 s35, s46, 0xff
v_bfe_u32 v123, v116, 1, 8
buffer_load_dwordx2 v[66:67], v123, s[4:7], s35 offen sc1
s_branch main_kernel_c3_ost
main_kernel_c3_o0_f:
s_nop 0
buffer_load_dwordx4 v[0:3], v116, s[4:7], s23 offen sc1
s_xor_b32 s32, s23, 1024
buffer_load_dwordx4 v[4:7], v116, s[4:7], s32 offen sc1
s_sub_u32 s29, s29, 1
s_cbranch_scc1 main_kernel_end
s_waitcnt vmcnt(0)
v_max_u32 v126, v0, v2
v_cmp_eq_u32 vcc, -1, v126
s_cbranch_vccnz main_kernel_c3_o0_f
s_branch main_kernel_c3_o0
main_kernel_c3_o1_f:
s_nop 0
s_xor_b32 s32, s23, 1024
buffer_load_dwordx4 v[4:7], v116, s[4:7], s32 offen sc1
s_xor_b32 s32, s23, 2048
buffer_load_dwordx4 v[8:11], v116, s[4:7], s32 offen sc1
s_sub_u32 s29, s29, 1
s_cbranch_scc1 main_kernel_end
s_waitcnt vmcnt(0)
v_max_u32 v126, v4, v6
v_cmp_eq_u32 vcc, -1, v126
s_cbranch_vccnz main_kernel_c3_o1_f
s_branch main_kernel_c3_o1
main_kernel_c3_o2_f:
s_nop 0
s_xor_b32 s32, s23, 2048
buffer_load_dwordx4 v[8:11], v116, s[4:7], s32 offen sc1
s_xor_b32 s32, s23, 3072
buffer_load_dwordx4 v[12:15], v116, s[4:7], s32 offen sc1
s_sub_u32 s29, s29, 1
s_cbranch_scc1 main_kernel_end
s_waitcnt vmcnt(0)
v_max_u32 v126, v8, v10
v_cmp_eq_u32 vcc, -1, v126
s_cbranch_vccnz main_kernel_c3_o2_f
s_branch main_kernel_c3_o2
main_kernel_c3_o3_f:
s_nop 0
s_xor_b32 s32, s23, 3072
buffer_load_dwordx4 v[12:15], v116, s[4:7], s32 offen sc1
s_xor_b32 s32, s23, 4096
buffer_load_dwordx4 v[16:19], v116, s[4:7], s32 offen sc1
s_sub_u32 s29, s29, 1
s_cbranch_scc1 main_kernel_end
s_waitcnt vmcnt(0)
v_max_u32 v126, v12, v14
v_cmp_eq_u32 vcc, -1, v126
s_cbranch_vccnz main_kernel_c3_o3_f
s_branch main_kernel_c3_o3
main_kernel_c3_o4_f:
s_nop 0
s_xor_b32 s32, s23, 4096
buffer_load_dwordx4 v[16:19], v116, s[4:7], s32 offen sc1
s_xor_b32 s32, s23, 5120
buffer_load_dwordx4 v[20:23], v116, s[4:7], s32 offen sc1
s_sub_u32 s29, s29, 1
s_cbranch_scc1 main_kernel_end
s_waitcnt vmcnt(0)
v_max_u32 v126, v16, v18
v_cmp_eq_u32 vcc, -1, v126
s_cbranch_vccnz main_kernel_c3_o4_f
s_branch main_kernel_c3_o4
main_kernel_c3_o5_f:
s_nop 0
s_xor_b32 s32, s23, 5120
buffer_load_dwordx4 v[20:23], v116, s[4:7], s32 offen sc1
s_xor_b32 s32, s23, 6144
buffer_load_dwordx4 v[24:27], v116, s[4:7], s32 offen sc1
s_sub_u32 s29, s29, 1
s_cbranch_scc1 main_kernel_end
s_waitcnt vmcnt(0)
v_max_u32 v126, v20, v22
v_cmp_eq_u32 vcc, -1, v126
s_cbranch_vccnz main_kernel_c3_o5_f
s_branch main_kernel_c3_o5
main_kernel_c3_o6_f:
s_nop 0
s_xor_b32 s32, s23, 6144
buffer_load_dwordx4 v[24:27], v116, s[4:7], s32 offen sc1
s_xor_b32 s32, s23, 7168
buffer_load_dwordx4 v[28:31], v116, s[4:7], s32 offen sc1
s_sub_u32 s29, s29, 1
s_cbranch_scc1 main_kernel_end
s_waitcnt vmcnt(0)
v_max_u32 v126, v24, v26
v_cmp_eq_u32 vcc, -1, v126
s_cbranch_vccnz main_kernel_c3_o6_f
s_branch main_kernel_c3_o6
main_kernel_c3_o7_f:
s_nop 0
s_xor_b32 s32, s23, 7168
buffer_load_dwordx4 v[28:31], v116, s[4:7], s32 offen sc1
s_sub_u32 s29, s29, 1
s_cbranch_scc1 main_kernel_end
s_waitcnt vmcnt(0)
v_max_u32 v126, v28, v30
v_cmp_eq_u32 vcc, -1, v126
s_cbranch_vccnz main_kernel_c3_o7_f
s_branch main_kernel_c3_o7
.p2align 6
main_kernel_c4_top:
s_barrier
buffer_load_dwordx4 v[0:3], v116, s[4:7], s18 offen sc1
s_add_u32 s20, s20, 0x40000
s_bitset0_b32 s20, 20
s_add_u32 s21, s21, 0x40000
s_bitset0_b32 s21, 20
s_add_u32 s22, s22, 0x40000
s_bitset0_b32 s22, 20
s_add_u32 s23, s23, 0x40000
s_bitset0_b32 s23, 20
s_xor_b32 s32, s18, 1024
buffer_load_dwordx4 v[16:19], v116, s[4:7], s32 offen sc1
s_add_u32 s3, s3, 0x40000
s_bitset0_b32 s3, 20
s_add_u32 s17, s17, 1
s_add_u32 s25, s52, s59
s_nop 3
buffer_load_dwordx4 v[64:67], v116, s[4:7], s19 offen sc1
v_mov_b32 v80, 0
v_mov_b32 v81, 0
s_nop 3
s_xor_b32 s32, s19, 1024
buffer_load_dwordx4 v[68:71], v116, s[4:7], s32 offen sc1
v_mov_b32 v82, 0
v_mov_b32 v83, 0
s_nop 3
s_xor_b32 s32, s18, 2048
buffer_load_dwordx4 v[32:35], v116, s[4:7], s32 offen sc1
v_mov_b32 v84, 0
v_mov_b32 v85, 0
s_nop 3
s_xor_b32 s32, s19, 2048
buffer_load_dwordx4 v[72:75], v116, s[4:7], s32 offen sc1
v_mov_b32 v86, 0
v_mov_b32 v87, 0
s_nop 3
s_xor_b32 s32, s18, 3072
buffer_load_dwordx4 v[48:51], v116, s[4:7], s32 offen sc1
v_mov_b32 v88, 0
v_mov_b32 v89, 0
s_nop 3
s_xor_b32 s32, s19, 3072
buffer_load_dwordx4 v[76:79], v116, s[4:7], s32 offen sc1
v_mov_b32 v90, 0
v_mov_b32 v91, 0
s_waitcnt vmcnt(5)
v_pk_add_f16 v0, v0, v64
v_pk_add_f16 v1, v1, v65
v_pk_add_f16 v2, v2, v66
v_pk_add_f16 v3, v3, v67
v_cmp_u_f16 vcc, v0, v2
s_cbranch_vccnz main_kernel_c4_m0_f
main_kernel_c4_m0:
v_smfmac_f32_16x16x64_f16 v[80:83], v[0:3], a[0:7], v112
ds_write_b128 v116, v[0:3] offset:0
v_smfmac_f32_16x16x64_f16 v[84:87], v[0:3], a[128:135], v112
buffer_load_dword v123, v121, s[4:7], 0 offen sc1
s_waitcnt vmcnt(5)
v_pk_add_f16 v16, v16, v68
v_pk_add_f16 v17, v17, v69
v_pk_add_f16 v18, v18, v70
v_pk_add_f16 v19, v19, v71
v_cmp_u_f16 vcc, v16, v18
s_waitcnt lgkmcnt(0)
s_barrier
ds_read_b128 v[4:7], v116 offset:1024
ds_write_b128 v116, v[16:19] offset:4096
s_cbranch_vccnz main_kernel_c4_m1_f
main_kernel_c4_m1:
v_smfmac_f32_16x16x64_f16 v[80:83], v[16:19], a[8:15], v112
v_smfmac_f32_16x16x64_f16 v[84:87], v[16:19], a[136:143], v112
ds_read_b128 v[8:11], v116 offset:2048
v_smfmac_f32_16x16x64_f16 v[88:91], v[0:3], v[128:135], v112
ds_read_b128 v[12:15], v116 offset:3072
s_waitcnt lgkmcnt(3)
v_smfmac_f32_16x16x64_f16 v[80:83], v[4:7], a[32:39], v112
v_smfmac_f32_16x16x64_f16 v[84:87], v[4:7], a[160:167], v112
v_smfmac_f32_16x16x64_f16 v[88:91], v[4:7], v[136:143], v112
s_waitcnt lgkmcnt(2)
s_barrier
s_waitcnt lgkmcnt(1)
v_smfmac_f32_16x16x64_f16 v[80:83], v[8:11], a[64:71], v112
s_waitcnt vmcnt(3)
ds_read_b128 v[20:23], v116 offset:5120
v_pk_add_f16 v32, v32, v72
v_smfmac_f32_16x16x64_f16 v[84:87], v[8:11], a[192:199], v112
ds_read_b128 v[24:27], v116 offset:6144
s_waitcnt lgkmcnt(2)
v_pk_add_f16 v33, v33, v73
v_smfmac_f32_16x16x64_f16 v[80:83], v[12:15], a[96:103], v112
ds_read_b128 v[28:31], v116 offset:7168
v_pk_add_f16 v34, v34, v74
v_smfmac_f32_16x16x64_f16 v[84:87], v[12:15], a[224:231], v112
s_waitcnt lgkmcnt(2)
v_pk_add_f16 v35, v35, v75
v_smfmac_f32_16x16x64_f16 v[80:83], v[20:23], a[40:47], v112
ds_write_b128 v116, v[32:35] offset:8192
v_cmp_u_f16 vcc, v32, v34
v_smfmac_f32_16x16x64_f16 v[84:87], v[20:23], a[168:175], v112
s_cbranch_vccnz main_kernel_c4_m2_f
main_kernel_c4_m2:
v_smfmac_f32_16x16x64_f16 v[80:83], v[32:35], a[16:23], v112
buffer_load_dwordx4 v[96:99], v116, s[4:7], s28 offen sc1
v_smfmac_f32_16x16x64_f16 v[84:87], v[32:35], a[144:151], v112
s_add_u32 s28, s28, 0x40000
s_waitcnt lgkmcnt(2)
v_smfmac_f32_16x16x64_f16 v[80:83], v[24:27], a[72:79], v112
s_waitcnt vmcnt(2)
v_pk_add_f16 v48, v48, v76
v_smfmac_f32_16x16x64_f16 v[84:87], v[24:27], a[200:207], v112
s_waitcnt lgkmcnt(0)
s_barrier
ds_read_b128 v[36:39], v116 offset:9216
v_pk_add_f16 v49, v49, v77
v_smfmac_f32_16x16x64_f16 v[80:83], v[28:31], a[104:111], v112
ds_read_b128 v[40:43], v116 offset:10240
v_pk_add_f16 v50, v50, v78
v_smfmac_f32_16x16x64_f16 v[84:87], v[28:31], a[232:239], v112
ds_read_b128 v[44:47], v116 offset:11264
v_pk_add_f16 v51, v51, v79
v_smfmac_f32_16x16x64_f16 v[88:91], v[8:11], v[144:151], v112
ds_write_b128 v116, v[48:51] offset:12288
s_waitcnt lgkmcnt(3)
v_cmp_u_f16 vcc, v48, v50
v_smfmac_f32_16x16x64_f16 v[80:83], v[36:39], a[48:55], v112
s_cbranch_vccnz main_kernel_c4_m3_f
main_kernel_c4_m3:
v_smfmac_f32_16x16x64_f16 v[80:83], v[48:51], a[24:31], v112
v_smfmac_f32_16x16x64_f16 v[84:87], v[48:51], a[152:159], v112
v_smfmac_f32_16x16x64_f16 v[84:87], v[36:39], a[176:183], v112
s_waitcnt lgkmcnt(2)
v_smfmac_f32_16x16x64_f16 v[80:83], v[40:43], a[80:87], v112
s_waitcnt lgkmcnt(0)
s_barrier
ds_read_b128 v[52:55], v116 offset:13312
v_smfmac_f32_16x16x64_f16 v[84:87], v[40:43], a[208:215], v112
s_add_u32 s19, s52, s54
ds_read_b128 v[56:59], v116 offset:14336
v_smfmac_f32_16x16x64_f16 v[80:83], v[44:47], a[112:119], v112
s_add_u32 s18, s18, 0x40000
ds_read_b128 v[60:63], v116 offset:15360
v_smfmac_f32_16x16x64_f16 v[84:87], v[44:47], a[240:247], v112
s_bitset0_b32 s18, 20
s_waitcnt lgkmcnt(2)
v_smfmac_f32_16x16x64_f16 v[80:83], v[52:55], a[56:63], v112
s_cmp_eq_u32 s17, 30
s_cselect_b32 s32, s53, 0x10000
s_waitcnt lgkmcnt(1)
v_smfmac_f32_16x16x64_f16 v[80:83], v[56:59], a[88:95], v112
s_add_u32 s52, s52, s32
s_waitcnt lgkmcnt(0)
v_smfmac_f32_16x16x64_f16 v[80:83], v[60:63], a[120:127], v112
s_sub_u32 s24, 0x20000, s32
ds_read_b128 v[64:67], v116 offset:24576
v_smfmac_f32_16x16x64_f16 v[84:87], v[52:55], a[184:191], v112
s_add_u32 s55, s55, s24
ds_read_b128 v[68:71], v116 offset:28672
v_smfmac_f32_16x16x64_f16 v[84:87], v[56:59], a[216:223], v112
ds_read_b128 v[72:75], v116 offset:25600
s_nop 0
v_cvt_pk_bf16_f32 v92, v80, v81
v_smfmac_f32_16x16x64_f16 v[84:87], v[60:63], a[248:255], v112
ds_read_b128 v[76:79], v116 offset:29696
s_nop 0
v_cvt_pk_bf16_f32 v93, v82, v83
v_smfmac_f32_16x16x64_f16 v[88:91], v[12:15], v[152:159], v112
s_nop 3
v_cvt_pk_bf16_f32 v94, v84, v85
v_cvt_pk_bf16_f32 v95, v86, v87
s_mov_b32 vcc_lo, 0xcccccccc
s_mov_b32 vcc_hi, 0xcccccccc
v_mfma_f32_16x16x32_bf16 v[84:87], v[92:95], v[104:107], 0
v_add_u32 v121, v121, v122
v_writelane_b32 v121, s55, 39
s_nop 0
v_smfmac_f32_16x16x64_f16 v[88:91], v[16:19], v[160:167], v112
s_nop 2
s_cmp_eq_u32 s17, 63
v_cvt_pk_bf16_f32 v114, v84, v85
v_cvt_pk_bf16_f32 v115, v86, v87
buffer_store_dwordx2 v[114:115], v117, s[4:7], s21 offen sc1
s_cbranch_scc1 main_kernel_c4_last
ds_write_b64 v117, v[114:115] offset:16384
v_smfmac_f32_16x16x64_f16 v[88:91], v[20:23], v[168:175], v112
v_smfmac_f32_16x16x64_f16 v[88:91], v[24:27], v[176:183], v112
v_smfmac_f32_16x16x64_f16 v[88:91], v[28:31], v[184:191], v112
v_smfmac_f32_16x16x64_f16 v[88:91], v[32:35], v[192:199], v112
s_waitcnt lgkmcnt(0)
s_barrier
ds_read_b128 v[0:3], v116 offset:16384
v_smfmac_f32_16x16x64_f16 v[88:91], v[36:39], v[200:207], v112
ds_read_b128 v[4:7], v116 offset:17408
s_waitcnt vmcnt(2)
v_cmp_eq_u32 s[0:1], 0, v123
v_smfmac_f32_16x16x64_f16 v[88:91], v[40:43], v[208:215], v112
ds_read_b128 v[16:19], v116 offset:26624
s_and_b32 s10, s1, 0x3f00
v_smfmac_f32_16x16x64_f16 v[88:91], v[44:47], v[216:223], v112
ds_read_b128 v[20:23], v116 offset:30720
v_smfmac_f32_16x16x64_f16 v[88:91], v[48:51], v[224:231], v112
ds_read_b128 v[24:27], v116 offset:27648
v_smfmac_f32_16x16x64_f16 v[88:91], v[52:55], v[232:239], v112
ds_read_b128 v[28:31], v116 offset:31744
v_smfmac_f32_16x16x64_f16 v[88:91], v[56:59], v[240:247], v112
v_smfmac_f32_16x16x64_f16 v[88:91], v[60:63], v[248:255], v112
s_waitcnt lgkmcnt(5)
v_mfma_f32_16x16x32_bf16 v[80:83], v[64:67], v[0:3], 0
v_mfma_f32_16x16x32_bf16 v[84:87], v[68:71], v[0:3], 0
buffer_load_dwordx4 v[8:11], v116, s[4:7], s20 offen offset:0 sc1
v_mfma_f32_16x16x32_bf16 v[92:95], v[0:3], v[0:3], 0
buffer_load_dwordx4 v[12:15], v116, s[4:7], s20 offen offset:1024 sc1
v_permlane32_swap_b32 v88, v90
s_waitcnt lgkmcnt(4)
v_mfma_f32_16x16x32_bf16 v[80:83], v[72:75], v[4:7], v[80:83]
v_permlane32_swap_b32 v89, v91
v_mfma_f32_16x16x32_bf16 v[84:87], v[76:79], v[4:7], v[84:87]
v_pk_add_f32 v[88:89], v[88:89], v[90:91]
v_mfma_f32_16x16x32_bf16 v[92:95], v[4:7], v[4:7], v[92:95]
v_cvt_pk_bf16_f32 v124, v88, v89
v_mov_b32 v65, 0
s_waitcnt lgkmcnt(0)
s_waitcnt vmcnt(1)
v_mfma_f32_16x16x32_bf16 v[88:91], v[8:11], v[8:11], v[92:95]
v_mfma_f32_16x16x32_bf16 v[0:3], v[16:19], v[8:11], v[80:83]
v_cmp_u_f32 s[0:1], v8, v10
v_mfma_f32_16x16x32_bf16 v[4:7], v[20:23], v[8:11], v[84:87]
s_waitcnt vmcnt(0)
v_mfma_f32_16x16x32_bf16 v[88:91], v[12:15], v[12:15], v[88:91]
v_mfma_f32_16x16x32_bf16 v[0:3], v[24:27], v[12:15], v[0:3]
v_cmp_u_f32 s[32:33], v12, v14
v_mfma_f32_16x16x32_bf16 v[4:7], v[28:31], v[12:15], v[4:7]
s_or_b64 s[0:1], s[0:1], s[32:33]
s_cbranch_scc1 main_kernel_c4_z_f
main_kernel_c4_z:
v_mul_f32 v88, s30, v88
v_mul_f32 v89, s30, v89
v_exp_f32 v88, v88
v_exp_f32 v89, v89
v_cndmask_b32_dpp v0, v2, v0, vcc quad_perm:[2,3,2,3] row_mask:0xf bank_mask:0xf
v_cvt_pk_bf16_f32 v64, v88, v89
v_cndmask_b32_dpp v1, v3, v1, vcc quad_perm:[2,3,2,3] row_mask:0xf bank_mask:0xf
v_exp_f32 v0, v0
v_mfma_f32_16x16x16_bf16 v[16:19], v[100:101], v[64:65], 0
v_exp_f32 v1, v1
v_cndmask_b32_dpp v4, v6, v4, vcc quad_perm:[2,3,2,3] row_mask:0xf bank_mask:0xf
v_mfma_f32_16x16x16_bf16 v[8:11], v[124:125], v[64:65], 0
v_cndmask_b32_dpp v5, v7, v5, vcc quad_perm:[2,3,2,3] row_mask:0xf bank_mask:0xf
v_exp_f32 v4, v4
v_exp_f32 v5, v5
v_cvt_pk_bf16_f32 v92, v0, v1
v_cvt_pk_bf16_f32 v94, v4, v5
v_mov_b32 v80, 0
v_mov_b32_dpp v93, v92 quad_perm:[0,1,0,1] row_mask:0xf bank_mask:0xf
v_mov_b32_dpp v95, v94 quad_perm:[0,1,0,1] row_mask:0xf bank_mask:0xf
v_mov_b32 v81, 0
v_mov_b32 v82, 0
v_mfma_f32_16x16x32_bf16 v[16:19], v[100:103], v[92:95], v[16:19]
v_mov_b32 v83, 0
v_mov_b32 v84, 0
v_mfma_f32_16x16x32_bf16 v[8:11], v[96:99], v[92:95], v[8:11]
s_nop 1
v_mov_b32 v85, 0
v_mov_b32 v86, 0
v_mov_b32 v87, 0
v_rcp_f32 v126, v16
v_subrev_u32 v127, 0x21800000, v16
v_cmp_lt_u32 vcc, 0x3c000000, v127
v_pk_mul_f32 v[8:9], v[8:9], v[126:127] op_sel_hi:[1,0]
v_pk_mul_f32 v[10:11], v[10:11], v[126:127] op_sel_hi:[1,0]
s_and_b32 s32, vcc_lo, 0xcccc
v_cvt_pk_bf16_f32 v126, v8, v9
v_cvt_pk_bf16_f32 v127, v10, v11
s_cbranch_scc1 main_kernel_c4_sm_f
main_kernel_c4_ost:
buffer_store_dwordx2 v[126:127], v118, s[4:7], s22 offen sc1
v_mov_b32 v24, -1
v_mov_b32 v25, -1
v_mov_b32 v26, -1
v_mov_b32 v27, -1
ds_read_b128 v[32:35], v113 offset:0
ds_read_b128 v[36:39], v113 offset:1024
ds_read_b128 v[40:43], v113 offset:2048
ds_read_b128 v[44:47], v113 offset:3072
ds_read_b128 v[48:51], v113 offset:4096
ds_read_b128 v[52:55], v113 offset:5120
buffer_store_dwordx4 v[24:27], v116, s[4:7], s3 offen sc1
s_barrier
buffer_load_dwordx4 v[0:3], v116, s[4:7], s23 offen sc1
ds_read_b128 v[56:59], v113 offset:6144
ds_read_b128 v[60:63], v113 offset:7168
s_add_u32 s37, s37, 65536
s_add_u32 s26, s26, 65536
s_nop 1
s_xor_b32 s32, s23, 1024
buffer_load_dwordx4 v[4:7], v116, s[4:7], s32 offen sc1
ds_read_b128 v[64:67], v113 offset:8192
ds_read_b128 v[68:71], v113 offset:9216
s_nop 3
s_xor_b32 s32, s23, 2048
buffer_load_dwordx4 v[8:11], v116, s[4:7], s32 offen sc1
ds_read_b128 v[72:75], v113 offset:10240
ds_read_b128 v[76:79], v113 offset:11264
s_nop 3
s_xor_b32 s32, s23, 3072
buffer_load_dwordx4 v[12:15], v116, s[4:7], s32 offen sc1
ds_read_b128 v[88:91], v113 offset:12288
ds_read_b128 v[92:95], v113 offset:13312
s_nop 3
s_xor_b32 s32, s23, 4096
buffer_load_dwordx4 v[16:19], v116, s[4:7], s32 offen sc1
s_nop 7
s_xor_b32 s32, s23, 5120
buffer_load_dwordx4 v[20:23], v116, s[4:7], s32 offen sc1
s_nop 7
s_xor_b32 s32, s23, 6144
buffer_load_dwordx4 v[24:27], v116, s[4:7], s32 offen sc1
s_nop 7
s_xor_b32 s32, s23, 7168
buffer_load_dwordx4 v[28:31], v116, s[4:7], s32 offen sc1
s_waitcnt lgkmcnt(12)
s_waitcnt vmcnt(7)
v_cmp_u_f32 vcc, v0, v2
s_cbranch_vccnz main_kernel_c4_o0_f
main_kernel_c4_o0:
v_smfmac_f32_16x16x64_bf16 v[80:83], v[0:3], v[32:39], v112
ds_read_b128 v[32:35], v113 offset:14336
ds_read_b128 v[36:39], v113 offset:15360
s_waitcnt lgkmcnt(12)
s_waitcnt vmcnt(6)
v_cmp_u_f32 vcc, v4, v6
v_smfmac_f32_16x16x64_bf16 v[84:87], v[0:3], v[40:47], v112
ds_read_b128 v[40:43], v113 offset:16384
ds_read_b128 v[44:47], v113 offset:17408
buffer_store_dwordx2 v[114:115], v119, s[4:7], s37 offen sc1
s_cbranch_vccnz main_kernel_c4_o1_f
main_kernel_c4_o1:
s_waitcnt lgkmcnt(12)
v_smfmac_f32_16x16x64_bf16 v[80:83], v[4:7], v[48:55], v112
ds_read_b128 v[48:51], v113 offset:18432
ds_read_b128 v[52:55], v113 offset:19456
s_waitcnt lgkmcnt(12)
s_waitcnt vmcnt(6)
v_cmp_u_f32 vcc, v8, v10
v_smfmac_f32_16x16x64_bf16 v[84:87], v[4:7], v[56:63], v112
ds_read_b128 v[56:59], v113 offset:20480
ds_read_b128 v[60:63], v113 offset:21504
buffer_store_dword v124, v120, s[4:7], s26 offen sc1
s_cbranch_vccnz main_kernel_c4_o2_f
main_kernel_c4_o2:
s_waitcnt lgkmcnt(12)
v_smfmac_f32_16x16x64_bf16 v[80:83], v[8:11], v[64:71], v112
ds_read_b128 v[64:67], v113 offset:22528
ds_read_b128 v[68:71], v113 offset:23552
s_waitcnt lgkmcnt(12)
s_waitcnt vmcnt(6)
v_cmp_u_f32 vcc, v12, v14
v_smfmac_f32_16x16x64_bf16 v[84:87], v[8:11], v[72:79], v112
ds_read_b128 v[72:75], v113 offset:24576
ds_read_b128 v[76:79], v113 offset:25600
s_cbranch_vccnz main_kernel_c4_o3_f
main_kernel_c4_o3:
s_waitcnt lgkmcnt(12)
v_smfmac_f32_16x16x64_bf16 v[80:83], v[12:15], v[88:95], v112
ds_read_b128 v[88:91], v113 offset:26624
ds_read_b128 v[92:95], v113 offset:27648
s_waitcnt lgkmcnt(12)
s_waitcnt vmcnt(5)
v_cmp_u_f32 vcc, v16, v18
v_smfmac_f32_16x16x64_bf16 v[84:87], v[12:15], v[32:39], v112
ds_read_b128 v[32:35], v113 offset:28672
ds_read_b128 v[36:39], v113 offset:29696
s_cbranch_vccnz main_kernel_c4_o4_f
main_kernel_c4_o4:
s_waitcnt lgkmcnt(12)
v_smfmac_f32_16x16x64_bf16 v[80:83], v[16:19], v[40:47], v112
ds_read_b128 v[40:43], v113 offset:30720
ds_read_b128 v[44:47], v113 offset:31744
s_waitcnt lgkmcnt(12)
s_waitcnt vmcnt(4)
v_cmp_u_f32 vcc, v20, v22
v_smfmac_f32_16x16x64_bf16 v[84:87], v[16:19], v[48:55], v112
s_cbranch_vccnz main_kernel_c4_o5_f
main_kernel_c4_o5:
s_waitcnt lgkmcnt(10)
v_smfmac_f32_16x16x64_bf16 v[80:83], v[20:23], v[56:63], v112
s_waitcnt lgkmcnt(8)
s_waitcnt vmcnt(3)
v_cmp_u_f32 vcc, v24, v26
v_smfmac_f32_16x16x64_bf16 v[84:87], v[20:23], v[64:71], v112
s_cbranch_vccnz main_kernel_c4_o6_f
main_kernel_c4_o6:
s_waitcnt lgkmcnt(6)
v_smfmac_f32_16x16x64_bf16 v[80:83], v[24:27], v[72:79], v112
s_waitcnt lgkmcnt(4)
v_smfmac_f32_16x16x64_bf16 v[84:87], v[24:27], v[88:95], v112
s_waitcnt lgkmcnt(2)
s_waitcnt vmcnt(2)
v_cmp_u_f32 vcc, v28, v30
s_cbranch_vccnz main_kernel_c4_o7_f
main_kernel_c4_o7:
v_smfmac_f32_16x16x64_bf16 v[80:83], v[28:31], v[32:39], v112
s_waitcnt lgkmcnt(0)
v_smfmac_f32_16x16x64_bf16 v[84:87], v[28:31], v[40:47], v112
s_nop 4
v_cvt_pk_bf16_f32 v80, v80, v81
v_cvt_pk_bf16_f32 v81, v82, v83
ds_write_b64 v116, v[80:81] offset:20480
v_cvt_pk_bf16_f32 v82, v84, v85
v_cvt_pk_bf16_f32 v83, v86, v87
ds_write_b64 v116, v[82:83] offset:22528
s_waitcnt lgkmcnt(0)
s_barrier
ds_read_b128 v[72:75], v116 offset:20480
ds_read_b128 v[76:79], v116 offset:21504
s_mov_b32 m0, 24576
s_cmp_lg_u32 s10, 0
s_waitcnt lgkmcnt(1)
v_mfma_f32_16x16x32_bf16 v[64:67], v[72:75], v[108:111], 0
s_waitcnt lgkmcnt(0)
v_mfma_f32_16x16x32_bf16 v[64:67], v[76:79], v[108:111], v[64:67]
s_nop 7
v_cvt_pk_f16_f32 v68, v64, v65
v_cvt_pk_f16_f32 v69, v66, v67
buffer_store_dwordx2 v[68:69], v125, s[4:7], s25 offen sc1
s_cbranch_scc1 main_kernel_c4_kvw
main_kernel_c4_kvok:
s_nop 3
buffer_load_dwordx4 v116, s[4:7], s27 offen sc1 lds
buffer_load_dwordx4 v116, s[4:7], s27 offen offset:1024 sc1 lds
s_add_u32 s27, s27, 0x40000
s_branch main_kernel_c4_top
main_kernel_c4_kvw:
s_mov_b32 exec_lo, 0
s_mov_b32 exec_hi, 0x3f00
v_subrev_u32 v127, 128, v121
main_kernel_c4_kvp:
buffer_load_dword v126, v127, s[4:7], 0 offen sc1
s_waitcnt vmcnt(0)
v_cmp_eq_u32 vcc, 0, v126
s_cbranch_vccz main_kernel_c4_kvp_ok
s_sleep 2
s_sub_u32 s29, s29, 1
s_cbranch_scc0 main_kernel_c4_kvp
s_branch main_kernel_end
main_kernel_c4_kvp_ok:
s_mov_b64 exec, -1
s_branch main_kernel_c4_kvok
main_kernel_c4_last:
s_add_u32 s37, s37, 65536
s_add_u32 s26, s26, 65536
buffer_store_dwordx2 v[114:115], v119, s[4:7], s37 offen sc1
v_smfmac_f32_16x16x64_f16 v[88:91], v[20:23], v[168:175], v112
v_smfmac_f32_16x16x64_f16 v[88:91], v[24:27], v[176:183], v112
v_smfmac_f32_16x16x64_f16 v[88:91], v[28:31], v[184:191], v112
v_smfmac_f32_16x16x64_f16 v[88:91], v[32:35], v[192:199], v112
v_smfmac_f32_16x16x64_f16 v[88:91], v[36:39], v[200:207], v112
v_smfmac_f32_16x16x64_f16 v[88:91], v[40:43], v[208:215], v112
v_smfmac_f32_16x16x64_f16 v[88:91], v[44:47], v[216:223], v112
v_smfmac_f32_16x16x64_f16 v[88:91], v[48:51], v[224:231], v112
v_smfmac_f32_16x16x64_f16 v[88:91], v[52:55], v[232:239], v112
v_smfmac_f32_16x16x64_f16 v[88:91], v[56:59], v[240:247], v112
v_smfmac_f32_16x16x64_f16 v[88:91], v[60:63], v[248:255], v112
s_nop 7
v_permlane32_swap_b32 v88, v90
s_nop 1
v_permlane32_swap_b32 v89, v91
s_nop 1
v_pk_add_f32 v[88:89], v[88:89], v[90:91]
s_nop 1
v_cvt_pk_bf16_f32 v124, v88, v89
s_nop 1
buffer_store_dword v124, v120, s[4:7], s26 offen sc1
s_branch main_kernel_end
main_kernel_c4_m0_f:
s_waitcnt lgkmcnt(0)
buffer_load_dwordx4 v[0:3], v116, s[4:7], s18 offen sc1
buffer_load_dwordx4 v[64:67], v116, s[4:7], s19 offen sc1
s_xor_b32 s32, s18, 1024
buffer_load_dwordx4 v[16:19], v116, s[4:7], s32 offen sc1
s_xor_b32 s32, s19, 1024
buffer_load_dwordx4 v[68:71], v116, s[4:7], s32 offen sc1
s_xor_b32 s32, s18, 2048
buffer_load_dwordx4 v[32:35], v116, s[4:7], s32 offen sc1
s_xor_b32 s32, s19, 2048
buffer_load_dwordx4 v[72:75], v116, s[4:7], s32 offen sc1
s_xor_b32 s32, s18, 3072
buffer_load_dwordx4 v[48:51], v116, s[4:7], s32 offen sc1
s_xor_b32 s32, s19, 3072
buffer_load_dwordx4 v[76:79], v116, s[4:7], s32 offen sc1
s_sub_u32 s29, s29, 1
s_cbranch_scc1 main_kernel_end
s_waitcnt vmcnt(0)
v_max_u32 v126, v0, v2
v_max3_u32 v126, v126, v64, v66
v_cmp_eq_u32 vcc, -1, v126
s_cbranch_vccnz main_kernel_c4_m0_f
v_pk_add_f16 v0, v0, v64
v_pk_add_f16 v1, v1, v65
v_pk_add_f16 v2, v2, v66
v_pk_add_f16 v3, v3, v67
s_nop 0
s_branch main_kernel_c4_m0
main_kernel_c4_m1_f:
s_waitcnt lgkmcnt(0)
s_xor_b32 s32, s18, 1024
buffer_load_dwordx4 v[16:19], v116, s[4:7], s32 offen sc1
s_xor_b32 s32, s19, 1024
buffer_load_dwordx4 v[68:71], v116, s[4:7], s32 offen sc1
s_xor_b32 s32, s18, 2048
buffer_load_dwordx4 v[32:35], v116, s[4:7], s32 offen sc1
s_xor_b32 s32, s19, 2048
buffer_load_dwordx4 v[72:75], v116, s[4:7], s32 offen sc1
s_xor_b32 s32, s18, 3072
buffer_load_dwordx4 v[48:51], v116, s[4:7], s32 offen sc1
s_xor_b32 s32, s19, 3072
buffer_load_dwordx4 v[76:79], v116, s[4:7], s32 offen sc1
s_sub_u32 s29, s29, 1
s_cbranch_scc1 main_kernel_end
s_waitcnt vmcnt(0)
v_max_u32 v126, v16, v18
v_max3_u32 v126, v126, v68, v70
v_cmp_eq_u32 vcc, -1, v126
s_cbranch_vccnz main_kernel_c4_m1_f
v_pk_add_f16 v16, v16, v68
v_pk_add_f16 v17, v17, v69
v_pk_add_f16 v18, v18, v70
v_pk_add_f16 v19, v19, v71
ds_write_b128 v116, v[16:19] offset:4096
s_branch main_kernel_c4_m1
main_kernel_c4_m2_f:
s_waitcnt lgkmcnt(0)
s_xor_b32 s32, s18, 2048
buffer_load_dwordx4 v[32:35], v116, s[4:7], s32 offen sc1
s_xor_b32 s32, s19, 2048
buffer_load_dwordx4 v[72:75], v116, s[4:7], s32 offen sc1
s_xor_b32 s32, s18, 3072
buffer_load_dwordx4 v[48:51], v116, s[4:7], s32 offen sc1
s_xor_b32 s32, s19, 3072
buffer_load_dwordx4 v[76:79], v116, s[4:7], s32 offen sc1
s_sub_u32 s29, s29, 1
s_cbranch_scc1 main_kernel_end
s_waitcnt vmcnt(0)
v_max_u32 v126, v32, v34
v_max3_u32 v126, v126, v72, v74
v_cmp_eq_u32 vcc, -1, v126
s_cbranch_vccnz main_kernel_c4_m2_f
v_pk_add_f16 v32, v32, v72
v_pk_add_f16 v33, v33, v73
v_pk_add_f16 v34, v34, v74
v_pk_add_f16 v35, v35, v75
ds_write_b128 v116, v[32:35] offset:8192
s_branch main_kernel_c4_m2
main_kernel_c4_m3_f:
s_waitcnt lgkmcnt(0)
s_xor_b32 s32, s18, 3072
buffer_load_dwordx4 v[48:51], v116, s[4:7], s32 offen sc1
s_xor_b32 s32, s19, 3072
buffer_load_dwordx4 v[76:79], v116, s[4:7], s32 offen sc1
s_sub_u32 s29, s29, 1
s_cbranch_scc1 main_kernel_end
s_waitcnt vmcnt(0)
v_max_u32 v126, v48, v50
v_max3_u32 v126, v126, v76, v78
v_cmp_eq_u32 vcc, -1, v126
s_cbranch_vccnz main_kernel_c4_m3_f
v_pk_add_f16 v48, v48, v76
v_pk_add_f16 v49, v49, v77
v_pk_add_f16 v50, v50, v78
v_pk_add_f16 v51, v51, v79
ds_write_b128 v116, v[48:51] offset:12288
s_branch main_kernel_c4_m3
main_kernel_c4_z_f:
buffer_load_dwordx4 v[8:11], v116, s[4:7], s20 offen offset:0 sc1
buffer_load_dwordx4 v[12:15], v116, s[4:7], s20 offen offset:1024 sc1
s_memtime s[32:33]
ds_read_b32 v126, v116 offset:18432
s_sub_u32 s34, s19, s54
s_xor_b32 s34, s34, 0x2000
s_lshl_b32 s35, s12, 15
s_add_u32 s34, s34, s35
s_lshl_b32 s35, s13, 8
s_add_u32 s35, s35, s34
s_add_u32 s34, s34, 0x4000
s_waitcnt lgkmcnt(0)
s_sub_u32 s32, s32, 450
v_sub_u32 v127, s32, v126
buffer_store_dword v127, off, s[4:7], s34 sc1
s_sub_u32 s29, s29, 1
s_cbranch_scc1 main_kernel_end
s_waitcnt vmcnt(1)
main_kernel_c4_z_g:
v_max_u32 v126, v8, v10
v_max3_u32 v126, v126, v12, v14
v_cmp_eq_u32 vcc, -1, v126
s_cbranch_vccnz main_kernel_c4_z_h
v_mfma_f32_16x16x32_bf16 v[88:91], v[8:11], v[8:11], v[92:95]
v_mfma_f32_16x16x32_bf16 v[0:3], v[16:19], v[8:11], v[80:83]
v_mfma_f32_16x16x32_bf16 v[4:7], v[20:23], v[8:11], v[84:87]
v_mfma_f32_16x16x32_bf16 v[88:91], v[12:15], v[12:15], v[88:91]
v_mfma_f32_16x16x32_bf16 v[0:3], v[24:27], v[12:15], v[0:3]
v_mfma_f32_16x16x32_bf16 v[4:7], v[28:31], v[12:15], v[4:7]
buffer_store_dword v127, off, s[4:7], s35 offset:132 sc1
s_mov_b32 vcc_lo, 0xcccccccc
s_mov_b32 vcc_hi, 0xcccccccc
s_branch main_kernel_c4_z
main_kernel_c4_z_h:
buffer_load_dwordx4 v[8:11], v116, s[4:7], s20 offen offset:0 sc1
buffer_load_dwordx4 v[12:15], v116, s[4:7], s20 offen offset:1024 sc1
s_sub_u32 s29, s29, 1
s_cbranch_scc1 main_kernel_end
v_add_u32 v127, 300, v127
s_waitcnt vmcnt(0)
s_branch main_kernel_c4_z_g
main_kernel_c4_sm_f:
s_waitcnt vmcnt(0) lgkmcnt(0)
buffer_load_dwordx4 v[8:11], v116, s[4:7], s20 offen offset:0 sc1
buffer_load_dwordx4 v[12:15], v116, s[4:7], s20 offen offset:1024 sc1
ds_read_b128 v[0:3], v116 offset:16384
ds_read_b128 v[4:7], v116 offset:17408
ds_read_b128 v[64:67], v116 offset:24576
ds_read_b128 v[68:71], v116 offset:28672
ds_read_b128 v[72:75], v116 offset:25600
ds_read_b128 v[76:79], v116 offset:29696
ds_read_b128 v[16:19], v116 offset:26624
ds_read_b128 v[20:23], v116 offset:30720
ds_read_b128 v[24:27], v116 offset:27648
ds_read_b128 v[28:31], v116 offset:31744
s_waitcnt vmcnt(0)
s_waitcnt lgkmcnt(0)
v_mfma_f32_16x16x32_bf16 v[80:83], v[64:67], v[0:3], 0
v_mfma_f32_16x16x32_bf16 v[84:87], v[68:71], v[0:3], 0
v_mfma_f32_16x16x32_bf16 v[92:95], v[0:3], v[0:3], 0
v_mfma_f32_16x16x32_bf16 v[80:83], v[72:75], v[4:7], v[80:83]
v_mfma_f32_16x16x32_bf16 v[84:87], v[76:79], v[4:7], v[84:87]
v_mfma_f32_16x16x32_bf16 v[92:95], v[4:7], v[4:7], v[92:95]
v_mfma_f32_16x16x32_bf16 v[0:3], v[16:19], v[8:11], v[80:83]
v_mfma_f32_16x16x32_bf16 v[4:7], v[20:23], v[8:11], v[84:87]
v_mfma_f32_16x16x32_bf16 v[88:91], v[8:11], v[8:11], v[92:95]
v_mfma_f32_16x16x32_bf16 v[0:3], v[24:27], v[12:15], v[0:3]
v_mfma_f32_16x16x32_bf16 v[4:7], v[28:31], v[12:15], v[4:7]
v_mfma_f32_16x16x32_bf16 v[88:91], v[12:15], v[12:15], v[88:91]
s_nop 7
v_mov_b32 v65, 0
v_max_f32 v126, v88, v89
v_mul_f32 v126, s30, v126
v_max3_f32 v126, v126, v0, v1
v_max3_f32 v126, v126, v2, v3
v_max3_f32 v126, v126, v4, v5
v_max3_f32 v126, v126, v6, v7
v_mov_b32 v127, v126
s_nop 1
v_permlane32_swap_b32 v126, v127
v_max_f32 v126, v126, v127
v_mov_b32 v127, v126
s_nop 1
v_permlane16_swap_b32 v126, v127
v_max_f32 v126, v126, v127
v_mul_f32 v127, 0x40faf233, v126
s_mov_b32 vcc_lo, 0xcccccccc
s_mov_b32 vcc_hi, 0xcccccccc
v_sub_f32 v0, v0, v126
v_sub_f32 v1, v1, v126
v_sub_f32 v2, v2, v126
v_sub_f32 v3, v3, v126
v_sub_f32 v4, v4, v126
v_sub_f32 v5, v5, v126
v_sub_f32 v6, v6, v126
v_sub_f32 v7, v7, v126
v_sub_f32 v88, v88, v127
v_sub_f32 v89, v89, v127
s_waitcnt lgkmcnt(0)
s_nop 0
v_mul_f32 v88, s30, v88
v_mul_f32 v89, s30, v89
v_exp_f32 v88, v88
v_exp_f32 v89, v89
v_cndmask_b32_dpp v0, v2, v0, vcc quad_perm:[2,3,2,3] row_mask:0xf bank_mask:0xf
v_cvt_pk_bf16_f32 v64, v88, v89
v_cndmask_b32_dpp v1, v3, v1, vcc quad_perm:[2,3,2,3] row_mask:0xf bank_mask:0xf
v_exp_f32 v0, v0
v_mfma_f32_16x16x16_bf16 v[16:19], v[100:101], v[64:65], 0
v_exp_f32 v1, v1
v_cndmask_b32_dpp v4, v6, v4, vcc quad_perm:[2,3,2,3] row_mask:0xf bank_mask:0xf
v_mfma_f32_16x16x16_bf16 v[8:11], v[124:125], v[64:65], 0
v_cndmask_b32_dpp v5, v7, v5, vcc quad_perm:[2,3,2,3] row_mask:0xf bank_mask:0xf
v_exp_f32 v4, v4
v_exp_f32 v5, v5
v_cvt_pk_bf16_f32 v92, v0, v1
v_cvt_pk_bf16_f32 v94, v4, v5
v_mov_b32 v80, 0
v_mov_b32_dpp v93, v92 quad_perm:[0,1,0,1] row_mask:0xf bank_mask:0xf
v_mov_b32_dpp v95, v94 quad_perm:[0,1,0,1] row_mask:0xf bank_mask:0xf
v_mov_b32 v81, 0
v_mov_b32 v82, 0
v_mfma_f32_16x16x32_bf16 v[16:19], v[100:103], v[92:95], v[16:19]
v_mov_b32 v83, 0
v_mov_b32 v84, 0
v_mfma_f32_16x16x32_bf16 v[8:11], v[96:99], v[92:95], v[8:11]
s_nop 1
v_mov_b32 v85, 0
v_mov_b32 v86, 0
v_mov_b32 v87, 0
v_rcp_f32 v126, v16
v_subrev_u32 v127, 0x21800000, v16
v_cmp_lt_u32 vcc, 0x3c000000, v127
v_pk_mul_f32 v[8:9], v[8:9], v[126:127] op_sel_hi:[1,0]
v_pk_mul_f32 v[10:11], v[10:11], v[126:127] op_sel_hi:[1,0]
s_and_b32 s32, vcc_lo, 0xcccc
v_cvt_pk_bf16_f32 v126, v8, v9
v_cvt_pk_bf16_f32 v127, v10, v11
s_branch main_kernel_c4_ost
main_kernel_c4_o0_f:
s_nop 0
buffer_load_dwordx4 v[0:3], v116, s[4:7], s23 offen sc1
s_xor_b32 s32, s23, 1024
buffer_load_dwordx4 v[4:7], v116, s[4:7], s32 offen sc1
s_sub_u32 s29, s29, 1
s_cbranch_scc1 main_kernel_end
s_waitcnt vmcnt(0)
v_max_u32 v126, v0, v2
v_cmp_eq_u32 vcc, -1, v126
s_cbranch_vccnz main_kernel_c4_o0_f
s_branch main_kernel_c4_o0
main_kernel_c4_o1_f:
s_nop 0
s_xor_b32 s32, s23, 1024
buffer_load_dwordx4 v[4:7], v116, s[4:7], s32 offen sc1
s_xor_b32 s32, s23, 2048
buffer_load_dwordx4 v[8:11], v116, s[4:7], s32 offen sc1
s_sub_u32 s29, s29, 1
s_cbranch_scc1 main_kernel_end
s_waitcnt vmcnt(0)
v_max_u32 v126, v4, v6
v_cmp_eq_u32 vcc, -1, v126
s_cbranch_vccnz main_kernel_c4_o1_f
s_branch main_kernel_c4_o1
main_kernel_c4_o2_f:
s_nop 0
s_xor_b32 s32, s23, 2048
buffer_load_dwordx4 v[8:11], v116, s[4:7], s32 offen sc1
s_xor_b32 s32, s23, 3072
buffer_load_dwordx4 v[12:15], v116, s[4:7], s32 offen sc1
s_sub_u32 s29, s29, 1
s_cbranch_scc1 main_kernel_end
s_waitcnt vmcnt(0)
v_max_u32 v126, v8, v10
v_cmp_eq_u32 vcc, -1, v126
s_cbranch_vccnz main_kernel_c4_o2_f
s_branch main_kernel_c4_o2
main_kernel_c4_o3_f:
s_nop 0
s_xor_b32 s32, s23, 3072
buffer_load_dwordx4 v[12:15], v116, s[4:7], s32 offen sc1
s_xor_b32 s32, s23, 4096
buffer_load_dwordx4 v[16:19], v116, s[4:7], s32 offen sc1
s_sub_u32 s29, s29, 1
s_cbranch_scc1 main_kernel_end
s_waitcnt vmcnt(0)
v_max_u32 v126, v12, v14
v_cmp_eq_u32 vcc, -1, v126
s_cbranch_vccnz main_kernel_c4_o3_f
s_branch main_kernel_c4_o3
main_kernel_c4_o4_f:
s_nop 0
s_xor_b32 s32, s23, 4096
buffer_load_dwordx4 v[16:19], v116, s[4:7], s32 offen sc1
s_xor_b32 s32, s23, 5120
buffer_load_dwordx4 v[20:23], v116, s[4:7], s32 offen sc1
s_sub_u32 s29, s29, 1
s_cbranch_scc1 main_kernel_end
s_waitcnt vmcnt(0)
v_max_u32 v126, v16, v18
v_cmp_eq_u32 vcc, -1, v126
s_cbranch_vccnz main_kernel_c4_o4_f
s_branch main_kernel_c4_o4
main_kernel_c4_o5_f:
s_nop 0
s_xor_b32 s32, s23, 5120
buffer_load_dwordx4 v[20:23], v116, s[4:7], s32 offen sc1
s_xor_b32 s32, s23, 6144
buffer_load_dwordx4 v[24:27], v116, s[4:7], s32 offen sc1
s_sub_u32 s29, s29, 1
s_cbranch_scc1 main_kernel_end
s_waitcnt vmcnt(0)
v_max_u32 v126, v20, v22
v_cmp_eq_u32 vcc, -1, v126
s_cbranch_vccnz main_kernel_c4_o5_f
s_branch main_kernel_c4_o5
main_kernel_c4_o6_f:
s_nop 0
s_xor_b32 s32, s23, 6144
buffer_load_dwordx4 v[24:27], v116, s[4:7], s32 offen sc1
s_xor_b32 s32, s23, 7168
buffer_load_dwordx4 v[28:31], v116, s[4:7], s32 offen sc1
s_sub_u32 s29, s29, 1
s_cbranch_scc1 main_kernel_end
s_waitcnt vmcnt(0)
v_max_u32 v126, v24, v26
v_cmp_eq_u32 vcc, -1, v126
s_cbranch_vccnz main_kernel_c4_o6_f
s_branch main_kernel_c4_o6
main_kernel_c4_o7_f:
s_nop 0
s_xor_b32 s32, s23, 7168
buffer_load_dwordx4 v[28:31], v116, s[4:7], s32 offen sc1
s_sub_u32 s29, s29, 1
s_cbranch_scc1 main_kernel_end
s_waitcnt vmcnt(0)
v_max_u32 v126, v28, v30
v_cmp_eq_u32 vcc, -1, v126
s_cbranch_vccnz main_kernel_c4_o7_f
s_branch main_kernel_c4_o7
.p2align 6
main_kernel_c5_top:
s_barrier
buffer_load_dwordx4 v[0:3], v116, s[4:7], s18 offen sc1
s_add_u32 s20, s20, 0x40000
s_bitset0_b32 s20, 20
s_add_u32 s21, s21, 0x40000
s_bitset0_b32 s21, 20
s_add_u32 s22, s22, 0x40000
s_bitset0_b32 s22, 20
s_add_u32 s23, s23, 0x40000
s_bitset0_b32 s23, 20
s_xor_b32 s32, s18, 1024
buffer_load_dwordx4 v[16:19], v116, s[4:7], s32 offen sc1
s_add_u32 s3, s3, 0x40000
s_bitset0_b32 s3, 20
s_add_u32 s17, s17, 1
s_add_u32 s25, s52, s59
s_nop 3
buffer_load_dwordx4 v[64:67], v116, s[4:7], s19 offen sc1
v_mov_b32 v80, 0
v_mov_b32 v81, 0
s_nop 3
s_xor_b32 s32, s19, 1024
buffer_load_dwordx4 v[68:71], v116, s[4:7], s32 offen sc1
v_mov_b32 v82, 0
v_mov_b32 v83, 0
s_nop 3
s_xor_b32 s32, s18, 2048
buffer_load_dwordx4 v[32:35], v116, s[4:7], s32 offen sc1
v_mov_b32 v84, 0
v_mov_b32 v85, 0
s_nop 3
s_xor_b32 s32, s19, 2048
buffer_load_dwordx4 v[72:75], v116, s[4:7], s32 offen sc1
v_mov_b32 v86, 0
v_mov_b32 v87, 0
s_nop 3
s_xor_b32 s32, s18, 3072
buffer_load_dwordx4 v[48:51], v116, s[4:7], s32 offen sc1
v_mov_b32 v88, 0
v_mov_b32 v89, 0
s_nop 3
s_xor_b32 s32, s19, 3072
buffer_load_dwordx4 v[76:79], v116, s[4:7], s32 offen sc1
v_mov_b32 v90, 0
v_mov_b32 v91, 0
s_waitcnt vmcnt(5)
v_pk_add_f16 v0, v0, v64
v_pk_add_f16 v1, v1, v65
v_pk_add_f16 v2, v2, v66
v_pk_add_f16 v3, v3, v67
v_cmp_u_f16 vcc, v0, v2
s_cbranch_vccnz main_kernel_c5_m0_f
main_kernel_c5_m0:
v_smfmac_f32_16x16x64_f16 v[80:83], v[0:3], a[0:7], v112
ds_write_b128 v116, v[0:3] offset:1024
v_smfmac_f32_16x16x64_f16 v[84:87], v[0:3], a[128:135], v112
buffer_load_dword v123, v121, s[4:7], 0 offen sc1
s_waitcnt vmcnt(5)
v_pk_add_f16 v16, v16, v68
v_pk_add_f16 v17, v17, v69
v_pk_add_f16 v18, v18, v70
v_pk_add_f16 v19, v19, v71
v_cmp_u_f16 vcc, v16, v18
s_waitcnt lgkmcnt(0)
s_barrier
ds_read_b128 v[4:7], v116 offset:0
ds_write_b128 v116, v[16:19] offset:5120
s_cbranch_vccnz main_kernel_c5_m1_f
main_kernel_c5_m1:
v_smfmac_f32_16x16x64_f16 v[80:83], v[16:19], a[8:15], v112
v_smfmac_f32_16x16x64_f16 v[84:87], v[16:19], a[136:143], v112
ds_read_b128 v[8:11], v116 offset:3072
v_smfmac_f32_16x16x64_f16 v[88:91], v[0:3], v[128:135], v112
ds_read_b128 v[12:15], v116 offset:2048
s_waitcnt lgkmcnt(3)
v_smfmac_f32_16x16x64_f16 v[80:83], v[4:7], a[32:39], v112
v_smfmac_f32_16x16x64_f16 v[84:87], v[4:7], a[160:167], v112
v_smfmac_f32_16x16x64_f16 v[88:91], v[4:7], v[136:143], v112
s_waitcnt lgkmcnt(2)
s_barrier
s_waitcnt lgkmcnt(1)
v_smfmac_f32_16x16x64_f16 v[80:83], v[8:11], a[64:71], v112
s_waitcnt vmcnt(3)
ds_read_b128 v[20:23], v116 offset:4096
v_pk_add_f16 v32, v32, v72
v_smfmac_f32_16x16x64_f16 v[84:87], v[8:11], a[192:199], v112
ds_read_b128 v[24:27], v116 offset:7168
s_waitcnt lgkmcnt(2)
v_pk_add_f16 v33, v33, v73
v_smfmac_f32_16x16x64_f16 v[80:83], v[12:15], a[96:103], v112
ds_read_b128 v[28:31], v116 offset:6144
v_pk_add_f16 v34, v34, v74
v_smfmac_f32_16x16x64_f16 v[84:87], v[12:15], a[224:231], v112
s_waitcnt lgkmcnt(2)
v_pk_add_f16 v35, v35, v75
v_smfmac_f32_16x16x64_f16 v[80:83], v[20:23], a[40:47], v112
ds_write_b128 v116, v[32:35] offset:9216
v_cmp_u_f16 vcc, v32, v34
v_smfmac_f32_16x16x64_f16 v[84:87], v[20:23], a[168:175], v112
s_cbranch_vccnz main_kernel_c5_m2_f
main_kernel_c5_m2:
v_smfmac_f32_16x16x64_f16 v[80:83], v[32:35], a[16:23], v112
buffer_load_dwordx4 v[96:99], v116, s[4:7], s28 offen sc1
v_smfmac_f32_16x16x64_f16 v[84:87], v[32:35], a[144:151], v112
s_add_u32 s28, s28, 0x40000
s_waitcnt lgkmcnt(2)
v_smfmac_f32_16x16x64_f16 v[80:83], v[24:27], a[72:79], v112
s_waitcnt vmcnt(2)
v_pk_add_f16 v48, v48, v76
v_smfmac_f32_16x16x64_f16 v[84:87], v[24:27], a[200:207], v112
s_waitcnt lgkmcnt(0)
s_barrier
ds_read_b128 v[36:39], v116 offset:8192
v_pk_add_f16 v49, v49, v77
v_smfmac_f32_16x16x64_f16 v[80:83], v[28:31], a[104:111], v112
ds_read_b128 v[40:43], v116 offset:11264
v_pk_add_f16 v50, v50, v78
v_smfmac_f32_16x16x64_f16 v[84:87], v[28:31], a[232:239], v112
ds_read_b128 v[44:47], v116 offset:10240
v_pk_add_f16 v51, v51, v79
v_smfmac_f32_16x16x64_f16 v[88:91], v[8:11], v[144:151], v112
ds_write_b128 v116, v[48:51] offset:13312
s_waitcnt lgkmcnt(3)
v_cmp_u_f16 vcc, v48, v50
v_smfmac_f32_16x16x64_f16 v[80:83], v[36:39], a[48:55], v112
s_cbranch_vccnz main_kernel_c5_m3_f
main_kernel_c5_m3:
v_smfmac_f32_16x16x64_f16 v[80:83], v[48:51], a[24:31], v112
v_smfmac_f32_16x16x64_f16 v[84:87], v[48:51], a[152:159], v112
v_smfmac_f32_16x16x64_f16 v[84:87], v[36:39], a[176:183], v112
s_waitcnt lgkmcnt(2)
v_smfmac_f32_16x16x64_f16 v[80:83], v[40:43], a[80:87], v112
s_waitcnt lgkmcnt(0)
s_barrier
ds_read_b128 v[52:55], v116 offset:12288
v_smfmac_f32_16x16x64_f16 v[84:87], v[40:43], a[208:215], v112
s_add_u32 s19, s52, s54
ds_read_b128 v[56:59], v116 offset:15360
v_smfmac_f32_16x16x64_f16 v[80:83], v[44:47], a[112:119], v112
s_add_u32 s18, s18, 0x40000
ds_read_b128 v[60:63], v116 offset:14336
v_smfmac_f32_16x16x64_f16 v[84:87], v[44:47], a[240:247], v112
s_bitset0_b32 s18, 20
s_waitcnt lgkmcnt(2)
v_smfmac_f32_16x16x64_f16 v[80:83], v[52:55], a[56:63], v112
s_cmp_eq_u32 s17, 30
s_cselect_b32 s32, s53, 0x10000
s_waitcnt lgkmcnt(1)
v_smfmac_f32_16x16x64_f16 v[80:83], v[56:59], a[88:95], v112
s_add_u32 s52, s52, s32
s_waitcnt lgkmcnt(0)
v_smfmac_f32_16x16x64_f16 v[80:83], v[60:63], a[120:127], v112
s_sub_u32 s24, 0x20000, s32
ds_read_b128 v[64:67], v116 offset:24576
v_smfmac_f32_16x16x64_f16 v[84:87], v[52:55], a[184:191], v112
s_add_u32 s55, s55, s24
ds_read_b128 v[68:71], v116 offset:28672
v_smfmac_f32_16x16x64_f16 v[84:87], v[56:59], a[216:223], v112
ds_read_b128 v[72:75], v116 offset:25600
s_nop 0
v_cvt_pk_bf16_f32 v92, v80, v81
v_smfmac_f32_16x16x64_f16 v[84:87], v[60:63], a[248:255], v112
ds_read_b128 v[76:79], v116 offset:29696
s_nop 0
v_cvt_pk_bf16_f32 v93, v82, v83
v_smfmac_f32_16x16x64_f16 v[88:91], v[12:15], v[152:159], v112
s_nop 3
v_cvt_pk_bf16_f32 v94, v84, v85
v_cvt_pk_bf16_f32 v95, v86, v87
s_mov_b32 vcc_lo, 0xcccccccc
s_mov_b32 vcc_hi, 0xcccccccc
v_mfma_f32_16x16x32_bf16 v[84:87], v[92:95], v[104:107], 0
v_add_u32 v121, v121, v122
v_writelane_b32 v121, s55, 39
s_nop 0
v_smfmac_f32_16x16x64_f16 v[88:91], v[16:19], v[160:167], v112
s_nop 2
s_cmp_eq_u32 s17, 63
v_cvt_pk_bf16_f32 v114, v84, v85
v_cvt_pk_bf16_f32 v115, v86, v87
buffer_store_dwordx2 v[114:115], v117, s[4:7], s21 offen sc1
s_cbranch_scc1 main_kernel_c5_last
ds_write_b64 v117, v[114:115] offset:16896
v_smfmac_f32_16x16x64_f16 v[88:91], v[20:23], v[168:175], v112
v_smfmac_f32_16x16x64_f16 v[88:91], v[24:27], v[176:183], v112
v_smfmac_f32_16x16x64_f16 v[88:91], v[28:31], v[184:191], v112
v_smfmac_f32_16x16x64_f16 v[88:91], v[32:35], v[192:199], v112
s_waitcnt lgkmcnt(0)
s_barrier
ds_read_b128 v[0:3], v116 offset:16384
v_smfmac_f32_16x16x64_f16 v[88:91], v[36:39], v[200:207], v112
ds_read_b128 v[4:7], v116 offset:17408
s_waitcnt vmcnt(2)
v_cmp_eq_u32 s[0:1], 0, v123
v_smfmac_f32_16x16x64_f16 v[88:91], v[40:43], v[208:215], v112
ds_read_b128 v[16:19], v116 offset:26624
s_and_b32 s10, s1, 0x3f00
v_smfmac_f32_16x16x64_f16 v[88:91], v[44:47], v[216:223], v112
ds_read_b128 v[20:23], v116 offset:30720
v_smfmac_f32_16x16x64_f16 v[88:91], v[48:51], v[224:231], v112
ds_read_b128 v[24:27], v116 offset:27648
v_smfmac_f32_16x16x64_f16 v[88:91], v[52:55], v[232:239], v112
ds_read_b128 v[28:31], v116 offset:31744
v_smfmac_f32_16x16x64_f16 v[88:91], v[56:59], v[240:247], v112
v_smfmac_f32_16x16x64_f16 v[88:91], v[60:63], v[248:255], v112
s_waitcnt lgkmcnt(5)
v_mfma_f32_16x16x32_bf16 v[80:83], v[64:67], v[0:3], 0
v_mfma_f32_16x16x32_bf16 v[84:87], v[68:71], v[0:3], 0
buffer_load_dwordx4 v[8:11], v116, s[4:7], s20 offen offset:0 sc1
v_mfma_f32_16x16x32_bf16 v[92:95], v[0:3], v[0:3], 0
buffer_load_dwordx4 v[12:15], v116, s[4:7], s20 offen offset:1024 sc1
v_permlane32_swap_b32 v88, v90
s_waitcnt lgkmcnt(4)
v_mfma_f32_16x16x32_bf16 v[80:83], v[72:75], v[4:7], v[80:83]
v_permlane32_swap_b32 v89, v91
v_mfma_f32_16x16x32_bf16 v[84:87], v[76:79], v[4:7], v[84:87]
v_pk_add_f32 v[88:89], v[88:89], v[90:91]
v_mfma_f32_16x16x32_bf16 v[92:95], v[4:7], v[4:7], v[92:95]
v_cvt_pk_bf16_f32 v124, v88, v89
v_mov_b32 v65, 0
s_waitcnt lgkmcnt(0)
s_waitcnt vmcnt(1)
v_mfma_f32_16x16x32_bf16 v[88:91], v[8:11], v[8:11], v[92:95]
v_mfma_f32_16x16x32_bf16 v[0:3], v[16:19], v[8:11], v[80:83]
v_cmp_u_f32 s[0:1], v8, v10
v_mfma_f32_16x16x32_bf16 v[4:7], v[20:23], v[8:11], v[84:87]
s_waitcnt vmcnt(0)
v_mfma_f32_16x16x32_bf16 v[88:91], v[12:15], v[12:15], v[88:91]
v_mfma_f32_16x16x32_bf16 v[0:3], v[24:27], v[12:15], v[0:3]
v_cmp_u_f32 s[32:33], v12, v14
v_mfma_f32_16x16x32_bf16 v[4:7], v[28:31], v[12:15], v[4:7]
s_or_b64 s[0:1], s[0:1], s[32:33]
s_cbranch_scc1 main_kernel_c5_z_f
main_kernel_c5_z:
v_mul_f32 v88, s30, v88
v_mul_f32 v89, s30, v89
v_exp_f32 v88, v88
v_exp_f32 v89, v89
v_cndmask_b32_dpp v0, v2, v0, vcc quad_perm:[2,3,2,3] row_mask:0xf bank_mask:0xf
v_cvt_pk_bf16_f32 v64, v88, v89
v_cndmask_b32_dpp v1, v3, v1, vcc quad_perm:[2,3,2,3] row_mask:0xf bank_mask:0xf
v_exp_f32 v0, v0
v_mfma_f32_16x16x16_bf16 v[16:19], v[100:101], v[64:65], 0
v_exp_f32 v1, v1
v_cndmask_b32_dpp v4, v6, v4, vcc quad_perm:[2,3,2,3] row_mask:0xf bank_mask:0xf
v_mfma_f32_16x16x16_bf16 v[8:11], v[124:125], v[64:65], 0
v_cndmask_b32_dpp v5, v7, v5, vcc quad_perm:[2,3,2,3] row_mask:0xf bank_mask:0xf
v_exp_f32 v4, v4
v_exp_f32 v5, v5
v_cvt_pk_bf16_f32 v92, v0, v1
v_cvt_pk_bf16_f32 v94, v4, v5
v_mov_b32 v80, 0
v_mov_b32_dpp v93, v92 quad_perm:[0,1,0,1] row_mask:0xf bank_mask:0xf
v_mov_b32_dpp v95, v94 quad_perm:[0,1,0,1] row_mask:0xf bank_mask:0xf
v_mov_b32 v81, 0
v_mov_b32 v82, 0
v_mfma_f32_16x16x32_bf16 v[16:19], v[100:103], v[92:95], v[16:19]
v_mov_b32 v83, 0
v_mov_b32 v84, 0
v_mfma_f32_16x16x32_bf16 v[8:11], v[96:99], v[92:95], v[8:11]
s_nop 1
v_mov_b32 v85, 0
v_mov_b32 v86, 0
v_mov_b32 v87, 0
v_rcp_f32 v126, v16
v_subrev_u32 v127, 0x21800000, v16
v_cmp_lt_u32 vcc, 0x3c000000, v127
v_pk_mul_f32 v[8:9], v[8:9], v[126:127] op_sel_hi:[1,0]
v_pk_mul_f32 v[10:11], v[10:11], v[126:127] op_sel_hi:[1,0]
s_and_b32 s32, vcc_lo, 0xcccc
v_cvt_pk_bf16_f32 v126, v8, v9
v_cvt_pk_bf16_f32 v127, v10, v11
s_cbranch_scc1 main_kernel_c5_sm_f
main_kernel_c5_ost:
buffer_store_dwordx2 v[126:127], v118, s[4:7], s22 offen sc1
v_mov_b32 v24, -1
v_mov_b32 v25, -1
v_mov_b32 v26, -1
v_mov_b32 v27, -1
ds_read_b128 v[32:35], v113 offset:0
ds_read_b128 v[36:39], v113 offset:1024
ds_read_b128 v[40:43], v113 offset:2048
ds_read_b128 v[44:47], v113 offset:3072
ds_read_b128 v[48:51], v113 offset:4096
ds_read_b128 v[52:55], v113 offset:5120
buffer_store_dwordx4 v[24:27], v116, s[4:7], s3 offen sc1
buffer_store_dwordx4 v[24:27], v116, s[4:7], s46 offen sc1
s_barrier
buffer_load_dwordx4 v[0:3], v116, s[4:7], s23 offen sc1
ds_read_b128 v[56:59], v113 offset:6144
ds_read_b128 v[60:63], v113 offset:7168
s_add_u32 s46, s46, 0x40000
s_bitset0_b32 s46, 20
s_add_u32 s37, s37, 65536
s_add_u32 s26, s26, 65536
s_xor_b32 s32, s23, 1024
buffer_load_dwordx4 v[4:7], v116, s[4:7], s32 offen sc1
ds_read_b128 v[64:67], v113 offset:8192
ds_read_b128 v[68:71], v113 offset:9216
s_nop 3
s_xor_b32 s32, s23, 2048
buffer_load_dwordx4 v[8:11], v116, s[4:7], s32 offen sc1
ds_read_b128 v[72:75], v113 offset:10240
ds_read_b128 v[76:79], v113 offset:11264
s_nop 3
s_xor_b32 s32, s23, 3072
buffer_load_dwordx4 v[12:15], v116, s[4:7], s32 offen sc1
ds_read_b128 v[88:91], v113 offset:12288
ds_read_b128 v[92:95], v113 offset:13312
s_nop 3
s_xor_b32 s32, s23, 4096
buffer_load_dwordx4 v[16:19], v116, s[4:7], s32 offen sc1
s_nop 7
s_xor_b32 s32, s23, 5120
buffer_load_dwordx4 v[20:23], v116, s[4:7], s32 offen sc1
s_nop 7
s_xor_b32 s32, s23, 6144
buffer_load_dwordx4 v[24:27], v116, s[4:7], s32 offen sc1
s_nop 7
s_xor_b32 s32, s23, 7168
buffer_load_dwordx4 v[28:31], v116, s[4:7], s32 offen sc1
s_waitcnt lgkmcnt(12)
s_waitcnt vmcnt(7)
v_cmp_u_f32 vcc, v0, v2
s_cbranch_vccnz main_kernel_c5_o0_f
main_kernel_c5_o0:
v_smfmac_f32_16x16x64_bf16 v[80:83], v[0:3], v[32:39], v112
ds_read_b128 v[32:35], v113 offset:14336
ds_read_b128 v[36:39], v113 offset:15360
s_waitcnt lgkmcnt(12)
s_waitcnt vmcnt(6)
v_cmp_u_f32 vcc, v4, v6
v_smfmac_f32_16x16x64_bf16 v[84:87], v[0:3], v[40:47], v112
ds_read_b128 v[40:43], v113 offset:16384
ds_read_b128 v[44:47], v113 offset:17408
buffer_store_dwordx2 v[114:115], v119, s[4:7], s37 offen sc1
s_cbranch_vccnz main_kernel_c5_o1_f
main_kernel_c5_o1:
s_waitcnt lgkmcnt(12)
v_smfmac_f32_16x16x64_bf16 v[80:83], v[4:7], v[48:55], v112
ds_read_b128 v[48:51], v113 offset:18432
ds_read_b128 v[52:55], v113 offset:19456
s_waitcnt lgkmcnt(12)
s_waitcnt vmcnt(6)
v_cmp_u_f32 vcc, v8, v10
v_smfmac_f32_16x16x64_bf16 v[84:87], v[4:7], v[56:63], v112
ds_read_b128 v[56:59], v113 offset:20480
ds_read_b128 v[60:63], v113 offset:21504
buffer_store_dword v124, v120, s[4:7], s26 offen sc1
s_cbranch_vccnz main_kernel_c5_o2_f
main_kernel_c5_o2:
s_waitcnt lgkmcnt(12)
v_smfmac_f32_16x16x64_bf16 v[80:83], v[8:11], v[64:71], v112
ds_read_b128 v[64:67], v113 offset:22528
ds_read_b128 v[68:71], v113 offset:23552
s_waitcnt lgkmcnt(12)
s_waitcnt vmcnt(6)
v_cmp_u_f32 vcc, v12, v14
v_smfmac_f32_16x16x64_bf16 v[84:87], v[8:11], v[72:79], v112
ds_read_b128 v[72:75], v113 offset:24576
ds_read_b128 v[76:79], v113 offset:25600
s_cbranch_vccnz main_kernel_c5_o3_f
main_kernel_c5_o3:
s_waitcnt lgkmcnt(12)
v_smfmac_f32_16x16x64_bf16 v[80:83], v[12:15], v[88:95], v112
ds_read_b128 v[88:91], v113 offset:26624
ds_read_b128 v[92:95], v113 offset:27648
s_waitcnt lgkmcnt(12)
s_waitcnt vmcnt(5)
v_cmp_u_f32 vcc, v16, v18
v_smfmac_f32_16x16x64_bf16 v[84:87], v[12:15], v[32:39], v112
ds_read_b128 v[32:35], v113 offset:28672
ds_read_b128 v[36:39], v113 offset:29696
s_cbranch_vccnz main_kernel_c5_o4_f
main_kernel_c5_o4:
s_waitcnt lgkmcnt(12)
v_smfmac_f32_16x16x64_bf16 v[80:83], v[16:19], v[40:47], v112
ds_read_b128 v[40:43], v113 offset:30720
ds_read_b128 v[44:47], v113 offset:31744
s_waitcnt lgkmcnt(12)
s_waitcnt vmcnt(4)
v_cmp_u_f32 vcc, v20, v22
v_smfmac_f32_16x16x64_bf16 v[84:87], v[16:19], v[48:55], v112
s_cbranch_vccnz main_kernel_c5_o5_f
main_kernel_c5_o5:
s_waitcnt lgkmcnt(10)
v_smfmac_f32_16x16x64_bf16 v[80:83], v[20:23], v[56:63], v112
s_waitcnt lgkmcnt(8)
s_waitcnt vmcnt(3)
v_cmp_u_f32 vcc, v24, v26
v_smfmac_f32_16x16x64_bf16 v[84:87], v[20:23], v[64:71], v112
s_cbranch_vccnz main_kernel_c5_o6_f
main_kernel_c5_o6:
s_waitcnt lgkmcnt(6)
v_smfmac_f32_16x16x64_bf16 v[80:83], v[24:27], v[72:79], v112
s_waitcnt lgkmcnt(4)
v_smfmac_f32_16x16x64_bf16 v[84:87], v[24:27], v[88:95], v112
s_waitcnt lgkmcnt(2)
s_waitcnt vmcnt(2)
v_cmp_u_f32 vcc, v28, v30
s_cbranch_vccnz main_kernel_c5_o7_f
main_kernel_c5_o7:
v_smfmac_f32_16x16x64_bf16 v[80:83], v[28:31], v[32:39], v112
s_waitcnt lgkmcnt(0)
v_smfmac_f32_16x16x64_bf16 v[84:87], v[28:31], v[40:47], v112
s_nop 4
v_cvt_pk_bf16_f32 v80, v80, v81
v_cvt_pk_bf16_f32 v81, v82, v83
ds_write_b64 v116, v[80:81] offset:20488
v_cvt_pk_bf16_f32 v82, v84, v85
v_cvt_pk_bf16_f32 v83, v86, v87
ds_write_b64 v116, v[82:83] offset:22536
s_waitcnt lgkmcnt(0)
s_barrier
ds_read_b128 v[72:75], v116 offset:22528
ds_read_b128 v[76:79], v116 offset:23552
s_mov_b32 m0, 26624
s_cmp_lg_u32 s10, 0
s_waitcnt lgkmcnt(1)
v_mfma_f32_16x16x32_bf16 v[64:67], v[72:75], v[108:111], 0
s_waitcnt lgkmcnt(0)
v_mfma_f32_16x16x32_bf16 v[64:67], v[76:79], v[108:111], v[64:67]
s_nop 7
v_cvt_pk_f16_f32 v68, v64, v65
v_cvt_pk_f16_f32 v69, v66, v67
buffer_store_dwordx2 v[68:69], v125, s[4:7], s25 offen sc1
s_cbranch_scc1 main_kernel_c5_kvw
main_kernel_c5_kvok:
s_nop 3
buffer_load_dwordx4 v116, s[4:7], s27 offen sc1 lds
buffer_load_dwordx4 v116, s[4:7], s27 offen offset:1024 sc1 lds
s_mov_b32 m0, 30720
s_xor_b32 s32, s27, 131072
buffer_load_dwordx4 v116, s[4:7], s32 offen offset:0 sc1 lds
s_add_u32 s27, s27, 0x40000
s_branch main_kernel_c5_top
main_kernel_c5_kvw:
s_mov_b32 exec_lo, 0
s_mov_b32 exec_hi, 0x3f00
v_subrev_u32 v127, 128, v121
main_kernel_c5_kvp:
buffer_load_dword v126, v127, s[4:7], 0 offen sc1
s_waitcnt vmcnt(0)
v_cmp_eq_u32 vcc, 0, v126
s_cbranch_vccz main_kernel_c5_kvp_ok
s_sleep 2
s_sub_u32 s29, s29, 1
s_cbranch_scc0 main_kernel_c5_kvp
s_branch main_kernel_end
main_kernel_c5_kvp_ok:
s_mov_b64 exec, -1
s_branch main_kernel_c5_kvok
main_kernel_c5_last:
s_add_u32 s37, s37, 65536
s_add_u32 s26, s26, 65536
buffer_store_dwordx2 v[114:115], v119, s[4:7], s37 offen sc1
v_smfmac_f32_16x16x64_f16 v[88:91], v[20:23], v[168:175], v112
v_smfmac_f32_16x16x64_f16 v[88:91], v[24:27], v[176:183], v112
v_smfmac_f32_16x16x64_f16 v[88:91], v[28:31], v[184:191], v112
v_smfmac_f32_16x16x64_f16 v[88:91], v[32:35], v[192:199], v112
v_smfmac_f32_16x16x64_f16 v[88:91], v[36:39], v[200:207], v112
v_smfmac_f32_16x16x64_f16 v[88:91], v[40:43], v[208:215], v112
v_smfmac_f32_16x16x64_f16 v[88:91], v[44:47], v[216:223], v112
v_smfmac_f32_16x16x64_f16 v[88:91], v[48:51], v[224:231], v112
v_smfmac_f32_16x16x64_f16 v[88:91], v[52:55], v[232:239], v112
v_smfmac_f32_16x16x64_f16 v[88:91], v[56:59], v[240:247], v112
v_smfmac_f32_16x16x64_f16 v[88:91], v[60:63], v[248:255], v112
s_nop 7
v_permlane32_swap_b32 v88, v90
s_nop 1
v_permlane32_swap_b32 v89, v91
s_nop 1
v_pk_add_f32 v[88:89], v[88:89], v[90:91]
s_nop 1
v_cvt_pk_bf16_f32 v124, v88, v89
s_nop 1
buffer_store_dword v124, v120, s[4:7], s26 offen sc1
s_branch main_kernel_end
main_kernel_c5_m0_f:
s_waitcnt lgkmcnt(0)
buffer_load_dwordx4 v[0:3], v116, s[4:7], s18 offen sc1
buffer_load_dwordx4 v[64:67], v116, s[4:7], s19 offen sc1
s_xor_b32 s32, s18, 1024
buffer_load_dwordx4 v[16:19], v116, s[4:7], s32 offen sc1
s_xor_b32 s32, s19, 1024
buffer_load_dwordx4 v[68:71], v116, s[4:7], s32 offen sc1
s_xor_b32 s32, s18, 2048
buffer_load_dwordx4 v[32:35], v116, s[4:7], s32 offen sc1
s_xor_b32 s32, s19, 2048
buffer_load_dwordx4 v[72:75], v116, s[4:7], s32 offen sc1
s_xor_b32 s32, s18, 3072
buffer_load_dwordx4 v[48:51], v116, s[4:7], s32 offen sc1
s_xor_b32 s32, s19, 3072
buffer_load_dwordx4 v[76:79], v116, s[4:7], s32 offen sc1
s_sub_u32 s29, s29, 1
s_cbranch_scc1 main_kernel_end
s_waitcnt vmcnt(0)
v_max_u32 v126, v0, v2
v_max3_u32 v126, v126, v64, v66
v_cmp_eq_u32 vcc, -1, v126
s_cbranch_vccnz main_kernel_c5_m0_f
v_pk_add_f16 v0, v0, v64
v_pk_add_f16 v1, v1, v65
v_pk_add_f16 v2, v2, v66
v_pk_add_f16 v3, v3, v67
s_nop 0
s_branch main_kernel_c5_m0
main_kernel_c5_m1_f:
s_waitcnt lgkmcnt(0)
s_xor_b32 s32, s18, 1024
buffer_load_dwordx4 v[16:19], v116, s[4:7], s32 offen sc1
s_xor_b32 s32, s19, 1024
buffer_load_dwordx4 v[68:71], v116, s[4:7], s32 offen sc1
s_xor_b32 s32, s18, 2048
buffer_load_dwordx4 v[32:35], v116, s[4:7], s32 offen sc1
s_xor_b32 s32, s19, 2048
buffer_load_dwordx4 v[72:75], v116, s[4:7], s32 offen sc1
s_xor_b32 s32, s18, 3072
buffer_load_dwordx4 v[48:51], v116, s[4:7], s32 offen sc1
s_xor_b32 s32, s19, 3072
buffer_load_dwordx4 v[76:79], v116, s[4:7], s32 offen sc1
s_sub_u32 s29, s29, 1
s_cbranch_scc1 main_kernel_end
s_waitcnt vmcnt(0)
v_max_u32 v126, v16, v18
v_max3_u32 v126, v126, v68, v70
v_cmp_eq_u32 vcc, -1, v126
s_cbranch_vccnz main_kernel_c5_m1_f
v_pk_add_f16 v16, v16, v68
v_pk_add_f16 v17, v17, v69
v_pk_add_f16 v18, v18, v70
v_pk_add_f16 v19, v19, v71
ds_write_b128 v116, v[16:19] offset:5120
s_branch main_kernel_c5_m1
main_kernel_c5_m2_f:
s_waitcnt lgkmcnt(0)
s_xor_b32 s32, s18, 2048
buffer_load_dwordx4 v[32:35], v116, s[4:7], s32 offen sc1
s_xor_b32 s32, s19, 2048
buffer_load_dwordx4 v[72:75], v116, s[4:7], s32 offen sc1
s_xor_b32 s32, s18, 3072
buffer_load_dwordx4 v[48:51], v116, s[4:7], s32 offen sc1
s_xor_b32 s32, s19, 3072
buffer_load_dwordx4 v[76:79], v116, s[4:7], s32 offen sc1
s_sub_u32 s29, s29, 1
s_cbranch_scc1 main_kernel_end
s_waitcnt vmcnt(0)
v_max_u32 v126, v32, v34
v_max3_u32 v126, v126, v72, v74
v_cmp_eq_u32 vcc, -1, v126
s_cbranch_vccnz main_kernel_c5_m2_f
v_pk_add_f16 v32, v32, v72
v_pk_add_f16 v33, v33, v73
v_pk_add_f16 v34, v34, v74
v_pk_add_f16 v35, v35, v75
ds_write_b128 v116, v[32:35] offset:9216
s_branch main_kernel_c5_m2
main_kernel_c5_m3_f:
s_waitcnt lgkmcnt(0)
s_xor_b32 s32, s18, 3072
buffer_load_dwordx4 v[48:51], v116, s[4:7], s32 offen sc1
s_xor_b32 s32, s19, 3072
buffer_load_dwordx4 v[76:79], v116, s[4:7], s32 offen sc1
s_sub_u32 s29, s29, 1
s_cbranch_scc1 main_kernel_end
s_waitcnt vmcnt(0)
v_max_u32 v126, v48, v50
v_max3_u32 v126, v126, v76, v78
v_cmp_eq_u32 vcc, -1, v126
s_cbranch_vccnz main_kernel_c5_m3_f
v_pk_add_f16 v48, v48, v76
v_pk_add_f16 v49, v49, v77
v_pk_add_f16 v50, v50, v78
v_pk_add_f16 v51, v51, v79
ds_write_b128 v116, v[48:51] offset:13312
s_branch main_kernel_c5_m3
main_kernel_c5_z_f:
buffer_load_dwordx4 v[8:11], v116, s[4:7], s20 offen offset:0 sc1
buffer_load_dwordx4 v[12:15], v116, s[4:7], s20 offen offset:1024 sc1
s_memtime s[32:33]
ds_read_b32 v126, v116 offset:18432
s_sub_u32 s34, s19, s54
s_xor_b32 s34, s34, 0x2000
s_lshl_b32 s35, s12, 15
s_add_u32 s34, s34, s35
s_lshl_b32 s35, s13, 8
s_add_u32 s35, s35, s34
s_add_u32 s34, s34, 0x4000
s_waitcnt lgkmcnt(0)
s_sub_u32 s32, s32, 450
v_sub_u32 v127, s32, v126
buffer_store_dword v127, off, s[4:7], s34 sc1
s_sub_u32 s29, s29, 1
s_cbranch_scc1 main_kernel_end
s_waitcnt vmcnt(1)
main_kernel_c5_z_g:
v_max_u32 v126, v8, v10
v_max3_u32 v126, v126, v12, v14
v_cmp_eq_u32 vcc, -1, v126
s_cbranch_vccnz main_kernel_c5_z_h
v_mfma_f32_16x16x32_bf16 v[88:91], v[8:11], v[8:11], v[92:95]
v_mfma_f32_16x16x32_bf16 v[0:3], v[16:19], v[8:11], v[80:83]
v_mfma_f32_16x16x32_bf16 v[4:7], v[20:23], v[8:11], v[84:87]
v_mfma_f32_16x16x32_bf16 v[88:91], v[12:15], v[12:15], v[88:91]
v_mfma_f32_16x16x32_bf16 v[0:3], v[24:27], v[12:15], v[0:3]
v_mfma_f32_16x16x32_bf16 v[4:7], v[28:31], v[12:15], v[4:7]
buffer_store_dword v127, off, s[4:7], s35 offset:132 sc1
s_mov_b32 vcc_lo, 0xcccccccc
s_mov_b32 vcc_hi, 0xcccccccc
s_branch main_kernel_c5_z
main_kernel_c5_z_h:
buffer_load_dwordx4 v[8:11], v116, s[4:7], s20 offen offset:0 sc1
buffer_load_dwordx4 v[12:15], v116, s[4:7], s20 offen offset:1024 sc1
s_sub_u32 s29, s29, 1
s_cbranch_scc1 main_kernel_end
v_add_u32 v127, 300, v127
s_waitcnt vmcnt(0)
s_branch main_kernel_c5_z_g
main_kernel_c5_sm_f:
s_waitcnt vmcnt(0) lgkmcnt(0)
buffer_load_dwordx4 v[8:11], v116, s[4:7], s20 offen offset:0 sc1
buffer_load_dwordx4 v[12:15], v116, s[4:7], s20 offen offset:1024 sc1
ds_read_b128 v[0:3], v116 offset:16384
ds_read_b128 v[4:7], v116 offset:17408
ds_read_b128 v[64:67], v116 offset:24576
ds_read_b128 v[68:71], v116 offset:28672
ds_read_b128 v[72:75], v116 offset:25600
ds_read_b128 v[76:79], v116 offset:29696
ds_read_b128 v[16:19], v116 offset:26624
ds_read_b128 v[20:23], v116 offset:30720
ds_read_b128 v[24:27], v116 offset:27648
ds_read_b128 v[28:31], v116 offset:31744
s_waitcnt vmcnt(0)
s_waitcnt lgkmcnt(0)
v_mfma_f32_16x16x32_bf16 v[80:83], v[64:67], v[0:3], 0
v_mfma_f32_16x16x32_bf16 v[84:87], v[68:71], v[0:3], 0
v_mfma_f32_16x16x32_bf16 v[92:95], v[0:3], v[0:3], 0
v_mfma_f32_16x16x32_bf16 v[80:83], v[72:75], v[4:7], v[80:83]
v_mfma_f32_16x16x32_bf16 v[84:87], v[76:79], v[4:7], v[84:87]
v_mfma_f32_16x16x32_bf16 v[92:95], v[4:7], v[4:7], v[92:95]
v_mfma_f32_16x16x32_bf16 v[0:3], v[16:19], v[8:11], v[80:83]
v_mfma_f32_16x16x32_bf16 v[4:7], v[20:23], v[8:11], v[84:87]
v_mfma_f32_16x16x32_bf16 v[88:91], v[8:11], v[8:11], v[92:95]
v_mfma_f32_16x16x32_bf16 v[0:3], v[24:27], v[12:15], v[0:3]
v_mfma_f32_16x16x32_bf16 v[4:7], v[28:31], v[12:15], v[4:7]
v_mfma_f32_16x16x32_bf16 v[88:91], v[12:15], v[12:15], v[88:91]
s_nop 7
v_mov_b32 v65, 0
v_max_f32 v126, v88, v89
v_mul_f32 v126, s30, v126
v_max3_f32 v126, v126, v0, v1
v_max3_f32 v126, v126, v2, v3
v_max3_f32 v126, v126, v4, v5
v_max3_f32 v126, v126, v6, v7
v_mov_b32 v127, v126
s_nop 1
v_permlane32_swap_b32 v126, v127
v_max_f32 v126, v126, v127
v_mov_b32 v127, v126
s_nop 1
v_permlane16_swap_b32 v126, v127
v_max_f32 v126, v126, v127
v_mul_f32 v127, 0x40faf233, v126
s_mov_b32 vcc_lo, 0xcccccccc
s_mov_b32 vcc_hi, 0xcccccccc
v_sub_f32 v0, v0, v126
v_sub_f32 v1, v1, v126
v_sub_f32 v2, v2, v126
v_sub_f32 v3, v3, v126
v_sub_f32 v4, v4, v126
v_sub_f32 v5, v5, v126
v_sub_f32 v6, v6, v126
v_sub_f32 v7, v7, v126
v_sub_f32 v88, v88, v127
v_sub_f32 v89, v89, v127
s_waitcnt lgkmcnt(0)
s_nop 0
v_mul_f32 v88, s30, v88
v_mul_f32 v89, s30, v89
v_exp_f32 v88, v88
v_exp_f32 v89, v89
v_cndmask_b32_dpp v0, v2, v0, vcc quad_perm:[2,3,2,3] row_mask:0xf bank_mask:0xf
v_cvt_pk_bf16_f32 v64, v88, v89
v_cndmask_b32_dpp v1, v3, v1, vcc quad_perm:[2,3,2,3] row_mask:0xf bank_mask:0xf
v_exp_f32 v0, v0
v_mfma_f32_16x16x16_bf16 v[16:19], v[100:101], v[64:65], 0
v_exp_f32 v1, v1
v_cndmask_b32_dpp v4, v6, v4, vcc quad_perm:[2,3,2,3] row_mask:0xf bank_mask:0xf
v_mfma_f32_16x16x16_bf16 v[8:11], v[124:125], v[64:65], 0
v_cndmask_b32_dpp v5, v7, v5, vcc quad_perm:[2,3,2,3] row_mask:0xf bank_mask:0xf
v_exp_f32 v4, v4
v_exp_f32 v5, v5
v_cvt_pk_bf16_f32 v92, v0, v1
v_cvt_pk_bf16_f32 v94, v4, v5
v_mov_b32 v80, 0
v_mov_b32_dpp v93, v92 quad_perm:[0,1,0,1] row_mask:0xf bank_mask:0xf
v_mov_b32_dpp v95, v94 quad_perm:[0,1,0,1] row_mask:0xf bank_mask:0xf
v_mov_b32 v81, 0
v_mov_b32 v82, 0
v_mfma_f32_16x16x32_bf16 v[16:19], v[100:103], v[92:95], v[16:19]
v_mov_b32 v83, 0
v_mov_b32 v84, 0
v_mfma_f32_16x16x32_bf16 v[8:11], v[96:99], v[92:95], v[8:11]
s_nop 1
v_mov_b32 v85, 0
v_mov_b32 v86, 0
v_mov_b32 v87, 0
v_rcp_f32 v126, v16
v_subrev_u32 v127, 0x21800000, v16
v_cmp_lt_u32 vcc, 0x3c000000, v127
v_pk_mul_f32 v[8:9], v[8:9], v[126:127] op_sel_hi:[1,0]
v_pk_mul_f32 v[10:11], v[10:11], v[126:127] op_sel_hi:[1,0]
s_and_b32 s32, vcc_lo, 0xcccc
v_cvt_pk_bf16_f32 v126, v8, v9
v_cvt_pk_bf16_f32 v127, v10, v11
s_branch main_kernel_c5_ost
main_kernel_c5_o0_f:
s_nop 0
buffer_load_dwordx4 v[0:3], v116, s[4:7], s23 offen sc1
s_xor_b32 s32, s23, 1024
buffer_load_dwordx4 v[4:7], v116, s[4:7], s32 offen sc1
s_sub_u32 s29, s29, 1
s_cbranch_scc1 main_kernel_end
s_waitcnt vmcnt(0)
v_max_u32 v126, v0, v2
v_cmp_eq_u32 vcc, -1, v126
s_cbranch_vccnz main_kernel_c5_o0_f
s_branch main_kernel_c5_o0
main_kernel_c5_o1_f:
s_nop 0
s_xor_b32 s32, s23, 1024
buffer_load_dwordx4 v[4:7], v116, s[4:7], s32 offen sc1
s_xor_b32 s32, s23, 2048
buffer_load_dwordx4 v[8:11], v116, s[4:7], s32 offen sc1
s_sub_u32 s29, s29, 1
s_cbranch_scc1 main_kernel_end
s_waitcnt vmcnt(0)
v_max_u32 v126, v4, v6
v_cmp_eq_u32 vcc, -1, v126
s_cbranch_vccnz main_kernel_c5_o1_f
s_branch main_kernel_c5_o1
main_kernel_c5_o2_f:
s_nop 0
s_xor_b32 s32, s23, 2048
buffer_load_dwordx4 v[8:11], v116, s[4:7], s32 offen sc1
s_xor_b32 s32, s23, 3072
buffer_load_dwordx4 v[12:15], v116, s[4:7], s32 offen sc1
s_sub_u32 s29, s29, 1
s_cbranch_scc1 main_kernel_end
s_waitcnt vmcnt(0)
v_max_u32 v126, v8, v10
v_cmp_eq_u32 vcc, -1, v126
s_cbranch_vccnz main_kernel_c5_o2_f
s_branch main_kernel_c5_o2
main_kernel_c5_o3_f:
s_nop 0
s_xor_b32 s32, s23, 3072
buffer_load_dwordx4 v[12:15], v116, s[4:7], s32 offen sc1
s_xor_b32 s32, s23, 4096
buffer_load_dwordx4 v[16:19], v116, s[4:7], s32 offen sc1
s_sub_u32 s29, s29, 1
s_cbranch_scc1 main_kernel_end
s_waitcnt vmcnt(0)
v_max_u32 v126, v12, v14
v_cmp_eq_u32 vcc, -1, v126
s_cbranch_vccnz main_kernel_c5_o3_f
s_branch main_kernel_c5_o3
main_kernel_c5_o4_f:
s_nop 0
s_xor_b32 s32, s23, 4096
buffer_load_dwordx4 v[16:19], v116, s[4:7], s32 offen sc1
s_xor_b32 s32, s23, 5120
buffer_load_dwordx4 v[20:23], v116, s[4:7], s32 offen sc1
s_sub_u32 s29, s29, 1
s_cbranch_scc1 main_kernel_end
s_waitcnt vmcnt(0)
v_max_u32 v126, v16, v18
v_cmp_eq_u32 vcc, -1, v126
s_cbranch_vccnz main_kernel_c5_o4_f
s_branch main_kernel_c5_o4
main_kernel_c5_o5_f:
s_nop 0
s_xor_b32 s32, s23, 5120
buffer_load_dwordx4 v[20:23], v116, s[4:7], s32 offen sc1
s_xor_b32 s32, s23, 6144
buffer_load_dwordx4 v[24:27], v116, s[4:7], s32 offen sc1
s_sub_u32 s29, s29, 1
s_cbranch_scc1 main_kernel_end
s_waitcnt vmcnt(0)
v_max_u32 v126, v20, v22
v_cmp_eq_u32 vcc, -1, v126
s_cbranch_vccnz main_kernel_c5_o5_f
s_branch main_kernel_c5_o5
main_kernel_c5_o6_f:
s_nop 0
s_xor_b32 s32, s23, 6144
buffer_load_dwordx4 v[24:27], v116, s[4:7], s32 offen sc1
s_xor_b32 s32, s23, 7168
buffer_load_dwordx4 v[28:31], v116, s[4:7], s32 offen sc1
s_sub_u32 s29, s29, 1
s_cbranch_scc1 main_kernel_end
s_waitcnt vmcnt(0)
v_max_u32 v126, v24, v26
v_cmp_eq_u32 vcc, -1, v126
s_cbranch_vccnz main_kernel_c5_o6_f
s_branch main_kernel_c5_o6
main_kernel_c5_o7_f:
s_nop 0
s_xor_b32 s32, s23, 7168
buffer_load_dwordx4 v[28:31], v116, s[4:7], s32 offen sc1
s_sub_u32 s29, s29, 1
s_cbranch_scc1 main_kernel_end
s_waitcnt vmcnt(0)
v_max_u32 v126, v28, v30
v_cmp_eq_u32 vcc, -1, v126
s_cbranch_vccnz main_kernel_c5_o7_f
s_branch main_kernel_c5_o7
.p2align 6
main_kernel_c6_top:
s_barrier
buffer_load_dwordx4 v[0:3], v116, s[4:7], s18 offen sc1
s_add_u32 s20, s20, 0x40000
s_bitset0_b32 s20, 20
s_add_u32 s21, s21, 0x40000
s_bitset0_b32 s21, 20
s_add_u32 s22, s22, 0x40000
s_bitset0_b32 s22, 20
s_add_u32 s23, s23, 0x40000
s_bitset0_b32 s23, 20
s_xor_b32 s32, s18, 1024
buffer_load_dwordx4 v[16:19], v116, s[4:7], s32 offen sc1
s_add_u32 s3, s3, 0x40000
s_bitset0_b32 s3, 20
s_add_u32 s17, s17, 1
s_add_u32 s25, s25, 0x40000
s_bitset0_b32 s25, 20
s_nop 2
buffer_load_dwordx4 v[64:67], v116, s[4:7], s19 offen sc1
v_mov_b32 v80, 0
v_mov_b32 v81, 0
s_nop 3
s_xor_b32 s32, s19, 1024
buffer_load_dwordx4 v[68:71], v116, s[4:7], s32 offen sc1
v_mov_b32 v82, 0
v_mov_b32 v83, 0
s_nop 3
s_xor_b32 s32, s18, 2048
buffer_load_dwordx4 v[32:35], v116, s[4:7], s32 offen sc1
v_mov_b32 v84, 0
v_mov_b32 v85, 0
s_nop 3
s_xor_b32 s32, s19, 2048
buffer_load_dwordx4 v[72:75], v116, s[4:7], s32 offen sc1
v_mov_b32 v86, 0
v_mov_b32 v87, 0
s_nop 3
s_xor_b32 s32, s18, 3072
buffer_load_dwordx4 v[48:51], v116, s[4:7], s32 offen sc1
v_mov_b32 v88, 0
v_mov_b32 v89, 0
s_nop 3
s_xor_b32 s32, s19, 3072
buffer_load_dwordx4 v[76:79], v116, s[4:7], s32 offen sc1
v_mov_b32 v90, 0
v_mov_b32 v91, 0
s_waitcnt vmcnt(5)
v_pk_add_f16 v0, v0, v64
v_pk_add_f16 v1, v1, v65
v_pk_add_f16 v2, v2, v66
v_pk_add_f16 v3, v3, v67
v_cmp_u_f16 vcc, v0, v2
s_cbranch_vccnz main_kernel_c6_m0_f
main_kernel_c6_m0:
v_smfmac_f32_16x16x64_f16 v[80:83], v[0:3], a[0:7], v112
ds_write_b128 v116, v[0:3] offset:2048
v_smfmac_f32_16x16x64_f16 v[84:87], v[0:3], a[128:135], v112
buffer_load_dword v123, v121, s[4:7], 0 offen sc1
s_waitcnt vmcnt(5)
v_pk_add_f16 v16, v16, v68
v_pk_add_f16 v17, v17, v69
v_pk_add_f16 v18, v18, v70
v_pk_add_f16 v19, v19, v71
v_cmp_u_f16 vcc, v16, v18
s_waitcnt lgkmcnt(0)
s_barrier
ds_read_b128 v[4:7], v116 offset:3072
s_cbranch_vccnz main_kernel_c6_m1_f
main_kernel_c6_m1:
v_smfmac_f32_16x16x64_f16 v[80:83], v[16:19], a[8:15], v112
ds_write_b128 v116, v[16:19] offset:6144
v_smfmac_f32_16x16x64_f16 v[84:87], v[16:19], a[136:143], v112
ds_read_b128 v[8:11], v116 offset:0
v_smfmac_f32_16x16x64_f16 v[88:91], v[0:3], v[128:135], v112
ds_read_b128 v[12:15], v116 offset:1024
s_waitcnt lgkmcnt(3)
v_smfmac_f32_16x16x64_f16 v[80:83], v[4:7], a[32:39], v112
v_smfmac_f32_16x16x64_f16 v[84:87], v[4:7], a[160:167], v112
v_smfmac_f32_16x16x64_f16 v[88:91], v[4:7], v[136:143], v112
s_waitcnt lgkmcnt(2)
s_barrier
s_waitcnt lgkmcnt(1)
v_smfmac_f32_16x16x64_f16 v[80:83], v[8:11], a[64:71], v112
s_waitcnt vmcnt(3)
ds_read_b128 v[20:23], v116 offset:7168
v_pk_add_f16 v32, v32, v72
v_smfmac_f32_16x16x64_f16 v[84:87], v[8:11], a[192:199], v112
ds_read_b128 v[24:27], v116 offset:4096
s_waitcnt lgkmcnt(2)
v_pk_add_f16 v33, v33, v73
v_smfmac_f32_16x16x64_f16 v[80:83], v[12:15], a[96:103], v112
ds_read_b128 v[28:31], v116 offset:5120
v_pk_add_f16 v34, v34, v74
v_smfmac_f32_16x16x64_f16 v[84:87], v[12:15], a[224:231], v112
s_waitcnt lgkmcnt(2)
v_pk_add_f16 v35, v35, v75
v_smfmac_f32_16x16x64_f16 v[80:83], v[20:23], a[40:47], v112
v_cmp_u_f16 vcc, v32, v34
v_smfmac_f32_16x16x64_f16 v[84:87], v[20:23], a[168:175], v112
ds_write_b128 v116, v[32:35] offset:10240
s_cbranch_vccnz main_kernel_c6_m2_f
main_kernel_c6_m2:
v_smfmac_f32_16x16x64_f16 v[80:83], v[32:35], a[16:23], v112
buffer_load_dwordx4 v[96:99], v116, s[4:7], s28 offen sc1
v_smfmac_f32_16x16x64_f16 v[84:87], v[32:35], a[144:151], v112
s_add_u32 s28, s28, 0x40000
s_waitcnt lgkmcnt(2)
v_smfmac_f32_16x16x64_f16 v[80:83], v[24:27], a[72:79], v112
s_waitcnt vmcnt(2)
v_pk_add_f16 v48, v48, v76
v_smfmac_f32_16x16x64_f16 v[84:87], v[24:27], a[200:207], v112
s_waitcnt lgkmcnt(0)
s_barrier
ds_read_b128 v[36:39], v116 offset:11264
v_pk_add_f16 v49, v49, v77
v_smfmac_f32_16x16x64_f16 v[80:83], v[28:31], a[104:111], v112
ds_read_b128 v[40:43], v116 offset:8192
v_pk_add_f16 v50, v50, v78
v_smfmac_f32_16x16x64_f16 v[84:87], v[28:31], a[232:239], v112
ds_read_b128 v[44:47], v116 offset:9216
v_pk_add_f16 v51, v51, v79
v_smfmac_f32_16x16x64_f16 v[88:91], v[8:11], v[144:151], v112
s_waitcnt lgkmcnt(2)
v_cmp_u_f16 vcc, v48, v50
v_smfmac_f32_16x16x64_f16 v[80:83], v[36:39], a[48:55], v112
ds_write_b128 v116, v[48:51] offset:14336
s_cbranch_vccnz main_kernel_c6_m3_f
main_kernel_c6_m3:
v_smfmac_f32_16x16x64_f16 v[80:83], v[48:51], a[24:31], v112
v_smfmac_f32_16x16x64_f16 v[84:87], v[48:51], a[152:159], v112
v_smfmac_f32_16x16x64_f16 v[84:87], v[36:39], a[176:183], v112
s_waitcnt lgkmcnt(2)
v_smfmac_f32_16x16x64_f16 v[80:83], v[40:43], a[80:87], v112
s_waitcnt lgkmcnt(0)
s_barrier
ds_read_b128 v[52:55], v116 offset:15360
v_smfmac_f32_16x16x64_f16 v[84:87], v[40:43], a[208:215], v112
s_add_u32 s19, s52, s54
ds_read_b128 v[56:59], v116 offset:12288
v_smfmac_f32_16x16x64_f16 v[80:83], v[44:47], a[112:119], v112
s_add_u32 s18, s18, 0x40000
ds_read_b128 v[60:63], v116 offset:13312
v_smfmac_f32_16x16x64_f16 v[84:87], v[44:47], a[240:247], v112
s_bitset0_b32 s18, 20
s_waitcnt lgkmcnt(2)
v_smfmac_f32_16x16x64_f16 v[80:83], v[52:55], a[56:63], v112
s_cmp_eq_u32 s17, 30
s_cselect_b32 s32, s53, 0x10000
s_waitcnt lgkmcnt(1)
v_smfmac_f32_16x16x64_f16 v[80:83], v[56:59], a[88:95], v112
s_add_u32 s52, s52, s32
s_waitcnt lgkmcnt(0)
v_smfmac_f32_16x16x64_f16 v[80:83], v[60:63], a[120:127], v112
s_sub_u32 s24, 0x20000, s32
ds_read_b128 v[64:67], v116 offset:24576
v_smfmac_f32_16x16x64_f16 v[84:87], v[52:55], a[184:191], v112
s_add_u32 s55, s55, s24
ds_read_b128 v[68:71], v116 offset:28672
v_smfmac_f32_16x16x64_f16 v[84:87], v[56:59], a[216:223], v112
ds_read_b128 v[72:75], v116 offset:25600
s_nop 0
v_cvt_pk_bf16_f32 v92, v80, v81
v_smfmac_f32_16x16x64_f16 v[84:87], v[60:63], a[248:255], v112
ds_read_b128 v[76:79], v116 offset:29696
s_nop 0
v_cvt_pk_bf16_f32 v93, v82, v83
v_smfmac_f32_16x16x64_f16 v[88:91], v[12:15], v[152:159], v112
s_nop 3
v_cvt_pk_bf16_f32 v94, v84, v85
v_cvt_pk_bf16_f32 v95, v86, v87
s_mov_b32 vcc_lo, 0xcccccccc
s_mov_b32 vcc_hi, 0xcccccccc
v_mfma_f32_16x16x32_bf16 v[84:87], v[92:95], v[104:107], 0
v_add_u32 v121, v121, v122
v_writelane_b32 v121, s55, 39
s_nop 0
v_smfmac_f32_16x16x64_f16 v[88:91], v[16:19], v[160:167], v112
s_nop 2
s_cmp_eq_u32 s17, 63
v_cvt_pk_bf16_f32 v114, v84, v85
v_cvt_pk_bf16_f32 v115, v86, v87
buffer_store_dwordx2 v[114:115], v117, s[4:7], s21 offen sc1
s_cbranch_scc1 main_kernel_c6_last
ds_write_b64 v117, v[114:115] offset:17408
v_smfmac_f32_16x16x64_f16 v[88:91], v[20:23], v[168:175], v112
v_smfmac_f32_16x16x64_f16 v[88:91], v[24:27], v[176:183], v112
v_smfmac_f32_16x16x64_f16 v[88:91], v[28:31], v[184:191], v112
v_smfmac_f32_16x16x64_f16 v[88:91], v[32:35], v[192:199], v112
s_waitcnt lgkmcnt(0)
s_barrier
ds_read_b128 v[0:3], v116 offset:16384
v_smfmac_f32_16x16x64_f16 v[88:91], v[36:39], v[200:207], v112
ds_read_b128 v[4:7], v116 offset:17408
s_waitcnt vmcnt(2)
v_cmp_eq_u32 s[0:1], 0, v123
v_smfmac_f32_16x16x64_f16 v[88:91], v[40:43], v[208:215], v112
ds_read_b128 v[16:19], v116 offset:26624
s_and_b32 s10, s1, 0x3f00
v_smfmac_f32_16x16x64_f16 v[88:91], v[44:47], v[216:223], v112
ds_read_b128 v[20:23], v116 offset:30720
v_smfmac_f32_16x16x64_f16 v[88:91], v[48:51], v[224:231], v112
ds_read_b128 v[24:27], v116 offset:27648
v_smfmac_f32_16x16x64_f16 v[88:91], v[52:55], v[232:239], v112
ds_read_b128 v[28:31], v116 offset:31744
v_smfmac_f32_16x16x64_f16 v[88:91], v[56:59], v[240:247], v112
v_smfmac_f32_16x16x64_f16 v[88:91], v[60:63], v[248:255], v112
s_waitcnt lgkmcnt(5)
v_mfma_f32_16x16x32_bf16 v[80:83], v[64:67], v[0:3], 0
v_mfma_f32_16x16x32_bf16 v[84:87], v[68:71], v[0:3], 0
buffer_load_dwordx4 v[8:11], v116, s[4:7], s20 offen offset:0 sc1
v_mfma_f32_16x16x32_bf16 v[92:95], v[0:3], v[0:3], 0
buffer_load_dwordx4 v[12:15], v116, s[4:7], s20 offen offset:1024 sc1
v_permlane32_swap_b32 v88, v90
s_waitcnt lgkmcnt(4)
v_mfma_f32_16x16x32_bf16 v[80:83], v[72:75], v[4:7], v[80:83]
v_permlane32_swap_b32 v89, v91
v_mfma_f32_16x16x32_bf16 v[84:87], v[76:79], v[4:7], v[84:87]
v_pk_add_f32 v[88:89], v[88:89], v[90:91]
v_mfma_f32_16x16x32_bf16 v[92:95], v[4:7], v[4:7], v[92:95]
v_cvt_pk_bf16_f32 v124, v88, v89
v_mov_b32 v65, 0
s_waitcnt lgkmcnt(0)
s_waitcnt vmcnt(1)
v_mfma_f32_16x16x32_bf16 v[88:91], v[8:11], v[8:11], v[92:95]
v_mfma_f32_16x16x32_bf16 v[0:3], v[16:19], v[8:11], v[80:83]
v_cmp_u_f32 s[0:1], v8, v10
v_mfma_f32_16x16x32_bf16 v[4:7], v[20:23], v[8:11], v[84:87]
s_waitcnt vmcnt(0)
v_mfma_f32_16x16x32_bf16 v[88:91], v[12:15], v[12:15], v[88:91]
v_mfma_f32_16x16x32_bf16 v[0:3], v[24:27], v[12:15], v[0:3]
v_cmp_u_f32 s[32:33], v12, v14
v_mfma_f32_16x16x32_bf16 v[4:7], v[28:31], v[12:15], v[4:7]
s_or_b64 s[0:1], s[0:1], s[32:33]
s_cbranch_scc1 main_kernel_c6_z_f
main_kernel_c6_z:
v_mul_f32 v88, s30, v88
v_mul_f32 v89, s30, v89
v_exp_f32 v88, v88
v_exp_f32 v89, v89
v_cndmask_b32_dpp v0, v2, v0, vcc quad_perm:[2,3,2,3] row_mask:0xf bank_mask:0xf
v_cvt_pk_bf16_f32 v64, v88, v89
v_cndmask_b32_dpp v1, v3, v1, vcc quad_perm:[2,3,2,3] row_mask:0xf bank_mask:0xf
v_exp_f32 v0, v0
v_mfma_f32_16x16x16_bf16 v[16:19], v[100:101], v[64:65], 0
v_exp_f32 v1, v1
v_cndmask_b32_dpp v4, v6, v4, vcc quad_perm:[2,3,2,3] row_mask:0xf bank_mask:0xf
v_mfma_f32_16x16x16_bf16 v[8:11], v[124:125], v[64:65], 0
v_cndmask_b32_dpp v5, v7, v5, vcc quad_perm:[2,3,2,3] row_mask:0xf bank_mask:0xf
v_exp_f32 v4, v4
v_exp_f32 v5, v5
v_cvt_pk_bf16_f32 v92, v0, v1
v_cvt_pk_bf16_f32 v94, v4, v5
v_mov_b32 v80, 0
v_mov_b32_dpp v93, v92 quad_perm:[0,1,0,1] row_mask:0xf bank_mask:0xf
v_mov_b32_dpp v95, v94 quad_perm:[0,1,0,1] row_mask:0xf bank_mask:0xf
v_mov_b32 v81, 0
v_mov_b32 v82, 0
v_mfma_f32_16x16x32_bf16 v[16:19], v[100:103], v[92:95], v[16:19]
v_mov_b32 v83, 0
v_mov_b32 v84, 0
v_mfma_f32_16x16x32_bf16 v[8:11], v[96:99], v[92:95], v[8:11]
s_nop 1
v_mov_b32 v85, 0
v_mov_b32 v86, 0
v_mov_b32 v87, 0
v_rcp_f32 v126, v16
v_subrev_u32 v127, 0x21800000, v16
v_cmp_lt_u32 vcc, 0x3c000000, v127
v_pk_mul_f32 v[8:9], v[8:9], v[126:127] op_sel_hi:[1,0]
v_pk_mul_f32 v[10:11], v[10:11], v[126:127] op_sel_hi:[1,0]
s_and_b32 s32, vcc_lo, 0xcccc
v_cvt_pk_bf16_f32 v126, v8, v9
v_cvt_pk_bf16_f32 v127, v10, v11
s_cbranch_scc1 main_kernel_c6_sm_f
main_kernel_c6_ost:
buffer_store_dwordx2 v[126:127], v118, s[4:7], s22 offen sc1
v_mov_b32 v24, -1
v_mov_b32 v25, -1
v_mov_b32 v26, -1
v_mov_b32 v27, -1
ds_read_b128 v[32:35], v113 offset:0
ds_read_b128 v[36:39], v113 offset:1024
ds_read_b128 v[40:43], v113 offset:2048
ds_read_b128 v[44:47], v113 offset:3072
ds_read_b128 v[48:51], v113 offset:4096
ds_read_b128 v[52:55], v113 offset:5120
buffer_store_dwordx4 v[24:27], v116, s[4:7], s3 offen sc1
s_barrier
buffer_load_dwordx4 v[0:3], v116, s[4:7], s23 offen sc1
ds_read_b128 v[56:59], v113 offset:6144
ds_read_b128 v[60:63], v113 offset:7168
s_add_u32 s37, s37, 65536
s_add_u32 s26, s26, 65536
s_nop 1
s_xor_b32 s32, s23, 1024
buffer_load_dwordx4 v[4:7], v116, s[4:7], s32 offen sc1
ds_read_b128 v[64:67], v113 offset:8192
ds_read_b128 v[68:71], v113 offset:9216
s_nop 3
s_xor_b32 s32, s23, 2048
buffer_load_dwordx4 v[8:11], v116, s[4:7], s32 offen sc1
ds_read_b128 v[72:75], v113 offset:10240
ds_read_b128 v[76:79], v113 offset:11264
s_nop 3
s_xor_b32 s32, s23, 3072
buffer_load_dwordx4 v[12:15], v116, s[4:7], s32 offen sc1
ds_read_b128 v[88:91], v113 offset:12288
ds_read_b128 v[92:95], v113 offset:13312
s_nop 3
s_xor_b32 s32, s23, 4096
buffer_load_dwordx4 v[16:19], v116, s[4:7], s32 offen sc1
s_nop 7
s_xor_b32 s32, s23, 5120
buffer_load_dwordx4 v[20:23], v116, s[4:7], s32 offen sc1
s_nop 7
s_xor_b32 s32, s23, 6144
buffer_load_dwordx4 v[24:27], v116, s[4:7], s32 offen sc1
s_nop 7
s_xor_b32 s32, s23, 7168
buffer_load_dwordx4 v[28:31], v116, s[4:7], s32 offen sc1
s_waitcnt lgkmcnt(12)
s_waitcnt vmcnt(7)
v_cmp_u_f32 vcc, v0, v2
s_cbranch_vccnz main_kernel_c6_o0_f
main_kernel_c6_o0:
v_smfmac_f32_16x16x64_bf16 v[80:83], v[0:3], v[32:39], v112
ds_read_b128 v[32:35], v113 offset:14336
ds_read_b128 v[36:39], v113 offset:15360
s_waitcnt lgkmcnt(12)
s_waitcnt vmcnt(6)
v_cmp_u_f32 vcc, v4, v6
v_smfmac_f32_16x16x64_bf16 v[84:87], v[0:3], v[40:47], v112
ds_read_b128 v[40:43], v113 offset:16384
ds_read_b128 v[44:47], v113 offset:17408
buffer_store_dwordx2 v[114:115], v119, s[4:7], s37 offen sc1
s_cbranch_vccnz main_kernel_c6_o1_f
main_kernel_c6_o1:
s_waitcnt lgkmcnt(12)
v_smfmac_f32_16x16x64_bf16 v[80:83], v[4:7], v[48:55], v112
ds_read_b128 v[48:51], v113 offset:18432
ds_read_b128 v[52:55], v113 offset:19456
s_waitcnt lgkmcnt(12)
s_waitcnt vmcnt(6)
v_cmp_u_f32 vcc, v8, v10
v_smfmac_f32_16x16x64_bf16 v[84:87], v[4:7], v[56:63], v112
ds_read_b128 v[56:59], v113 offset:20480
ds_read_b128 v[60:63], v113 offset:21504
buffer_store_dword v124, v120, s[4:7], s26 offen sc1
s_cbranch_vccnz main_kernel_c6_o2_f
main_kernel_c6_o2:
s_waitcnt lgkmcnt(12)
v_smfmac_f32_16x16x64_bf16 v[80:83], v[8:11], v[64:71], v112
ds_read_b128 v[64:67], v113 offset:22528
ds_read_b128 v[68:71], v113 offset:23552
s_waitcnt lgkmcnt(12)
s_waitcnt vmcnt(6)
v_cmp_u_f32 vcc, v12, v14
v_smfmac_f32_16x16x64_bf16 v[84:87], v[8:11], v[72:79], v112
ds_read_b128 v[72:75], v113 offset:24576
ds_read_b128 v[76:79], v113 offset:25600
s_cbranch_vccnz main_kernel_c6_o3_f
main_kernel_c6_o3:
s_waitcnt lgkmcnt(12)
v_smfmac_f32_16x16x64_bf16 v[80:83], v[12:15], v[88:95], v112
ds_read_b128 v[88:91], v113 offset:26624
ds_read_b128 v[92:95], v113 offset:27648
s_waitcnt lgkmcnt(12)
s_waitcnt vmcnt(5)
v_cmp_u_f32 vcc, v16, v18
v_smfmac_f32_16x16x64_bf16 v[84:87], v[12:15], v[32:39], v112
ds_read_b128 v[32:35], v113 offset:28672
ds_read_b128 v[36:39], v113 offset:29696
s_cbranch_vccnz main_kernel_c6_o4_f
main_kernel_c6_o4:
s_waitcnt lgkmcnt(12)
v_smfmac_f32_16x16x64_bf16 v[80:83], v[16:19], v[40:47], v112
ds_read_b128 v[40:43], v113 offset:30720
ds_read_b128 v[44:47], v113 offset:31744
s_waitcnt lgkmcnt(12)
s_waitcnt vmcnt(4)
v_cmp_u_f32 vcc, v20, v22
v_smfmac_f32_16x16x64_bf16 v[84:87], v[16:19], v[48:55], v112
s_cbranch_vccnz main_kernel_c6_o5_f
main_kernel_c6_o5:
s_waitcnt lgkmcnt(10)
v_smfmac_f32_16x16x64_bf16 v[80:83], v[20:23], v[56:63], v112
s_waitcnt lgkmcnt(8)
s_waitcnt vmcnt(3)
v_cmp_u_f32 vcc, v24, v26
v_smfmac_f32_16x16x64_bf16 v[84:87], v[20:23], v[64:71], v112
s_cbranch_vccnz main_kernel_c6_o6_f
main_kernel_c6_o6:
s_waitcnt lgkmcnt(6)
v_smfmac_f32_16x16x64_bf16 v[80:83], v[24:27], v[72:79], v112
s_waitcnt lgkmcnt(4)
v_smfmac_f32_16x16x64_bf16 v[84:87], v[24:27], v[88:95], v112
s_waitcnt lgkmcnt(2)
s_waitcnt vmcnt(2)
v_cmp_u_f32 vcc, v28, v30
s_cbranch_vccnz main_kernel_c6_o7_f
main_kernel_c6_o7:
v_smfmac_f32_16x16x64_bf16 v[80:83], v[28:31], v[32:39], v112
s_waitcnt lgkmcnt(0)
v_smfmac_f32_16x16x64_bf16 v[84:87], v[28:31], v[40:47], v112
s_nop 4
v_cvt_pk_bf16_f32 v80, v80, v81
v_cvt_pk_bf16_f32 v81, v82, v83
ds_write_b64 v116, v[80:81] offset:21504
v_cvt_pk_bf16_f32 v82, v84, v85
v_cvt_pk_bf16_f32 v83, v86, v87
ds_write_b64 v116, v[82:83] offset:23552
s_waitcnt lgkmcnt(0)
s_barrier
ds_read_b128 v[72:75], v116 offset:20480
ds_read_b128 v[76:79], v116 offset:21504
s_mov_b32 m0, 28672
s_cmp_lg_u32 s10, 0
s_waitcnt lgkmcnt(1)
v_mfma_f32_16x16x32_bf16 v[64:67], v[72:75], v[108:111], 0
s_waitcnt lgkmcnt(0)
v_mfma_f32_16x16x32_bf16 v[64:67], v[76:79], v[108:111], v[64:67]
s_nop 7
v_cvt_pk_f16_f32 v68, v64, v65
v_cvt_pk_f16_f32 v69, v66, v67
buffer_store_dwordx2 v[68:69], v125, s[4:7], s25 offen sc1
s_cbranch_scc1 main_kernel_c6_kvw
main_kernel_c6_kvok:
s_nop 3
buffer_load_dwordx4 v116, s[4:7], s27 offen sc1 lds
buffer_load_dwordx4 v116, s[4:7], s27 offen offset:1024 sc1 lds
s_mov_b32 m0, 30720
s_xor_b32 s32, s27, 2048
buffer_load_dwordx4 v116, s[4:7], s32 offen offset:1024 sc1 lds
s_add_u32 s27, s27, 0x40000
s_branch main_kernel_c6_top
main_kernel_c6_kvw:
s_mov_b32 exec_lo, 0
s_mov_b32 exec_hi, 0x3f00
v_subrev_u32 v127, 128, v121
main_kernel_c6_kvp:
buffer_load_dword v126, v127, s[4:7], 0 offen sc1
s_waitcnt vmcnt(0)
v_cmp_eq_u32 vcc, 0, v126
s_cbranch_vccz main_kernel_c6_kvp_ok
s_sleep 2
s_sub_u32 s29, s29, 1
s_cbranch_scc0 main_kernel_c6_kvp
s_branch main_kernel_end
main_kernel_c6_kvp_ok:
s_mov_b64 exec, -1
s_branch main_kernel_c6_kvok
main_kernel_c6_last:
s_add_u32 s37, s37, 65536
s_add_u32 s26, s26, 65536
buffer_store_dwordx2 v[114:115], v119, s[4:7], s37 offen sc1
v_smfmac_f32_16x16x64_f16 v[88:91], v[20:23], v[168:175], v112
v_smfmac_f32_16x16x64_f16 v[88:91], v[24:27], v[176:183], v112
v_smfmac_f32_16x16x64_f16 v[88:91], v[28:31], v[184:191], v112
v_smfmac_f32_16x16x64_f16 v[88:91], v[32:35], v[192:199], v112
v_smfmac_f32_16x16x64_f16 v[88:91], v[36:39], v[200:207], v112
v_smfmac_f32_16x16x64_f16 v[88:91], v[40:43], v[208:215], v112
v_smfmac_f32_16x16x64_f16 v[88:91], v[44:47], v[216:223], v112
v_smfmac_f32_16x16x64_f16 v[88:91], v[48:51], v[224:231], v112
v_smfmac_f32_16x16x64_f16 v[88:91], v[52:55], v[232:239], v112
v_smfmac_f32_16x16x64_f16 v[88:91], v[56:59], v[240:247], v112
v_smfmac_f32_16x16x64_f16 v[88:91], v[60:63], v[248:255], v112
s_nop 7
v_permlane32_swap_b32 v88, v90
s_nop 1
v_permlane32_swap_b32 v89, v91
s_nop 1
v_pk_add_f32 v[88:89], v[88:89], v[90:91]
s_nop 1
v_cvt_pk_bf16_f32 v124, v88, v89
s_nop 1
buffer_store_dword v124, v120, s[4:7], s26 offen sc1
s_branch main_kernel_end
main_kernel_c6_m0_f:
s_waitcnt lgkmcnt(0)
buffer_load_dwordx4 v[0:3], v116, s[4:7], s18 offen sc1
buffer_load_dwordx4 v[64:67], v116, s[4:7], s19 offen sc1
s_xor_b32 s32, s18, 1024
buffer_load_dwordx4 v[16:19], v116, s[4:7], s32 offen sc1
s_xor_b32 s32, s19, 1024
buffer_load_dwordx4 v[68:71], v116, s[4:7], s32 offen sc1
s_xor_b32 s32, s18, 2048
buffer_load_dwordx4 v[32:35], v116, s[4:7], s32 offen sc1
s_xor_b32 s32, s19, 2048
buffer_load_dwordx4 v[72:75], v116, s[4:7], s32 offen sc1
s_xor_b32 s32, s18, 3072
buffer_load_dwordx4 v[48:51], v116, s[4:7], s32 offen sc1
s_xor_b32 s32, s19, 3072
buffer_load_dwordx4 v[76:79], v116, s[4:7], s32 offen sc1
s_sub_u32 s29, s29, 1
s_cbranch_scc1 main_kernel_end
s_waitcnt vmcnt(0)
v_max_u32 v126, v0, v2
v_max3_u32 v126, v126, v64, v66
v_cmp_eq_u32 vcc, -1, v126
s_cbranch_vccnz main_kernel_c6_m0_f
v_pk_add_f16 v0, v0, v64
v_pk_add_f16 v1, v1, v65
v_pk_add_f16 v2, v2, v66
v_pk_add_f16 v3, v3, v67
s_nop 0
s_branch main_kernel_c6_m0
main_kernel_c6_m1_f:
s_waitcnt lgkmcnt(0)
s_xor_b32 s32, s18, 1024
buffer_load_dwordx4 v[16:19], v116, s[4:7], s32 offen sc1
s_xor_b32 s32, s19, 1024
buffer_load_dwordx4 v[68:71], v116, s[4:7], s32 offen sc1
s_xor_b32 s32, s18, 2048
buffer_load_dwordx4 v[32:35], v116, s[4:7], s32 offen sc1
s_xor_b32 s32, s19, 2048
buffer_load_dwordx4 v[72:75], v116, s[4:7], s32 offen sc1
s_xor_b32 s32, s18, 3072
buffer_load_dwordx4 v[48:51], v116, s[4:7], s32 offen sc1
s_xor_b32 s32, s19, 3072
buffer_load_dwordx4 v[76:79], v116, s[4:7], s32 offen sc1
s_sub_u32 s29, s29, 1
s_cbranch_scc1 main_kernel_end
s_waitcnt vmcnt(0)
v_max_u32 v126, v16, v18
v_max3_u32 v126, v126, v68, v70
v_cmp_eq_u32 vcc, -1, v126
s_cbranch_vccnz main_kernel_c6_m1_f
v_pk_add_f16 v16, v16, v68
v_pk_add_f16 v17, v17, v69
v_pk_add_f16 v18, v18, v70
v_pk_add_f16 v19, v19, v71
s_nop 0
s_branch main_kernel_c6_m1
main_kernel_c6_m2_f:
s_waitcnt lgkmcnt(0)
s_xor_b32 s32, s18, 2048
buffer_load_dwordx4 v[32:35], v116, s[4:7], s32 offen sc1
s_xor_b32 s32, s19, 2048
buffer_load_dwordx4 v[72:75], v116, s[4:7], s32 offen sc1
s_xor_b32 s32, s18, 3072
buffer_load_dwordx4 v[48:51], v116, s[4:7], s32 offen sc1
s_xor_b32 s32, s19, 3072
buffer_load_dwordx4 v[76:79], v116, s[4:7], s32 offen sc1
s_sub_u32 s29, s29, 1
s_cbranch_scc1 main_kernel_end
s_waitcnt vmcnt(0)
v_max_u32 v126, v32, v34
v_max3_u32 v126, v126, v72, v74
v_cmp_eq_u32 vcc, -1, v126
s_cbranch_vccnz main_kernel_c6_m2_f
v_pk_add_f16 v32, v32, v72
v_pk_add_f16 v33, v33, v73
v_pk_add_f16 v34, v34, v74
v_pk_add_f16 v35, v35, v75
ds_write_b128 v116, v[32:35] offset:10240
s_branch main_kernel_c6_m2
main_kernel_c6_m3_f:
s_waitcnt lgkmcnt(0)
s_xor_b32 s32, s18, 3072
buffer_load_dwordx4 v[48:51], v116, s[4:7], s32 offen sc1
s_xor_b32 s32, s19, 3072
buffer_load_dwordx4 v[76:79], v116, s[4:7], s32 offen sc1
s_sub_u32 s29, s29, 1
s_cbranch_scc1 main_kernel_end
s_waitcnt vmcnt(0)
v_max_u32 v126, v48, v50
v_max3_u32 v126, v126, v76, v78
v_cmp_eq_u32 vcc, -1, v126
s_cbranch_vccnz main_kernel_c6_m3_f
v_pk_add_f16 v48, v48, v76
v_pk_add_f16 v49, v49, v77
v_pk_add_f16 v50, v50, v78
v_pk_add_f16 v51, v51, v79
ds_write_b128 v116, v[48:51] offset:14336
s_branch main_kernel_c6_m3
main_kernel_c6_z_f:
buffer_load_dwordx4 v[8:11], v116, s[4:7], s20 offen offset:0 sc1
buffer_load_dwordx4 v[12:15], v116, s[4:7], s20 offen offset:1024 sc1
s_memtime s[32:33]
ds_read_b32 v126, v116 offset:18432
s_sub_u32 s34, s19, s54
s_xor_b32 s34, s34, 0x2000
s_lshl_b32 s35, s12, 15
s_add_u32 s34, s34, s35
s_lshl_b32 s35, s13, 8
s_add_u32 s35, s35, s34
s_add_u32 s34, s34, 0x4000
s_waitcnt lgkmcnt(0)
s_sub_u32 s32, s32, 450
v_sub_u32 v127, s32, v126
buffer_store_dword v127, off, s[4:7], s34 sc1
s_sub_u32 s29, s29, 1
s_cbranch_scc1 main_kernel_end
s_waitcnt vmcnt(1)
main_kernel_c6_z_g:
v_max_u32 v126, v8, v10
v_max3_u32 v126, v126, v12, v14
v_cmp_eq_u32 vcc, -1, v126
s_cbranch_vccnz main_kernel_c6_z_h
v_mfma_f32_16x16x32_bf16 v[88:91], v[8:11], v[8:11], v[92:95]
v_mfma_f32_16x16x32_bf16 v[0:3], v[16:19], v[8:11], v[80:83]
v_mfma_f32_16x16x32_bf16 v[4:7], v[20:23], v[8:11], v[84:87]
v_mfma_f32_16x16x32_bf16 v[88:91], v[12:15], v[12:15], v[88:91]
v_mfma_f32_16x16x32_bf16 v[0:3], v[24:27], v[12:15], v[0:3]
v_mfma_f32_16x16x32_bf16 v[4:7], v[28:31], v[12:15], v[4:7]
buffer_store_dword v127, off, s[4:7], s35 offset:132 sc1
s_mov_b32 vcc_lo, 0xcccccccc
s_mov_b32 vcc_hi, 0xcccccccc
s_branch main_kernel_c6_z
main_kernel_c6_z_h:
buffer_load_dwordx4 v[8:11], v116, s[4:7], s20 offen offset:0 sc1
buffer_load_dwordx4 v[12:15], v116, s[4:7], s20 offen offset:1024 sc1
s_sub_u32 s29, s29, 1
s_cbranch_scc1 main_kernel_end
v_add_u32 v127, 300, v127
s_waitcnt vmcnt(0)
s_branch main_kernel_c6_z_g
main_kernel_c6_sm_f:
s_waitcnt vmcnt(0) lgkmcnt(0)
buffer_load_dwordx4 v[8:11], v116, s[4:7], s20 offen offset:0 sc1
buffer_load_dwordx4 v[12:15], v116, s[4:7], s20 offen offset:1024 sc1
ds_read_b128 v[0:3], v116 offset:16384
ds_read_b128 v[4:7], v116 offset:17408
ds_read_b128 v[64:67], v116 offset:24576
ds_read_b128 v[68:71], v116 offset:28672
ds_read_b128 v[72:75], v116 offset:25600
ds_read_b128 v[76:79], v116 offset:29696
ds_read_b128 v[16:19], v116 offset:26624
ds_read_b128 v[20:23], v116 offset:30720
ds_read_b128 v[24:27], v116 offset:27648
ds_read_b128 v[28:31], v116 offset:31744
s_waitcnt vmcnt(0)
s_waitcnt lgkmcnt(0)
v_mfma_f32_16x16x32_bf16 v[80:83], v[64:67], v[0:3], 0
v_mfma_f32_16x16x32_bf16 v[84:87], v[68:71], v[0:3], 0
v_mfma_f32_16x16x32_bf16 v[92:95], v[0:3], v[0:3], 0
v_mfma_f32_16x16x32_bf16 v[80:83], v[72:75], v[4:7], v[80:83]
v_mfma_f32_16x16x32_bf16 v[84:87], v[76:79], v[4:7], v[84:87]
v_mfma_f32_16x16x32_bf16 v[92:95], v[4:7], v[4:7], v[92:95]
v_mfma_f32_16x16x32_bf16 v[0:3], v[16:19], v[8:11], v[80:83]
v_mfma_f32_16x16x32_bf16 v[4:7], v[20:23], v[8:11], v[84:87]
v_mfma_f32_16x16x32_bf16 v[88:91], v[8:11], v[8:11], v[92:95]
v_mfma_f32_16x16x32_bf16 v[0:3], v[24:27], v[12:15], v[0:3]
v_mfma_f32_16x16x32_bf16 v[4:7], v[28:31], v[12:15], v[4:7]
v_mfma_f32_16x16x32_bf16 v[88:91], v[12:15], v[12:15], v[88:91]
s_nop 7
v_mov_b32 v65, 0
v_max_f32 v126, v88, v89
v_mul_f32 v126, s30, v126
v_max3_f32 v126, v126, v0, v1
v_max3_f32 v126, v126, v2, v3
v_max3_f32 v126, v126, v4, v5
v_max3_f32 v126, v126, v6, v7
v_mov_b32 v127, v126
s_nop 1
v_permlane32_swap_b32 v126, v127
v_max_f32 v126, v126, v127
v_mov_b32 v127, v126
s_nop 1
v_permlane16_swap_b32 v126, v127
v_max_f32 v126, v126, v127
v_mul_f32 v127, 0x40faf233, v126
s_mov_b32 vcc_lo, 0xcccccccc
s_mov_b32 vcc_hi, 0xcccccccc
v_sub_f32 v0, v0, v126
v_sub_f32 v1, v1, v126
v_sub_f32 v2, v2, v126
v_sub_f32 v3, v3, v126
v_sub_f32 v4, v4, v126
v_sub_f32 v5, v5, v126
v_sub_f32 v6, v6, v126
v_sub_f32 v7, v7, v126
v_sub_f32 v88, v88, v127
v_sub_f32 v89, v89, v127
s_waitcnt lgkmcnt(0)
s_nop 0
v_mul_f32 v88, s30, v88
v_mul_f32 v89, s30, v89
v_exp_f32 v88, v88
v_exp_f32 v89, v89
v_cndmask_b32_dpp v0, v2, v0, vcc quad_perm:[2,3,2,3] row_mask:0xf bank_mask:0xf
v_cvt_pk_bf16_f32 v64, v88, v89
v_cndmask_b32_dpp v1, v3, v1, vcc quad_perm:[2,3,2,3] row_mask:0xf bank_mask:0xf
v_exp_f32 v0, v0
v_mfma_f32_16x16x16_bf16 v[16:19], v[100:101], v[64:65], 0
v_exp_f32 v1, v1
v_cndmask_b32_dpp v4, v6, v4, vcc quad_perm:[2,3,2,3] row_mask:0xf bank_mask:0xf
v_mfma_f32_16x16x16_bf16 v[8:11], v[124:125], v[64:65], 0
v_cndmask_b32_dpp v5, v7, v5, vcc quad_perm:[2,3,2,3] row_mask:0xf bank_mask:0xf
v_exp_f32 v4, v4
v_exp_f32 v5, v5
v_cvt_pk_bf16_f32 v92, v0, v1
v_cvt_pk_bf16_f32 v94, v4, v5
v_mov_b32 v80, 0
v_mov_b32_dpp v93, v92 quad_perm:[0,1,0,1] row_mask:0xf bank_mask:0xf
v_mov_b32_dpp v95, v94 quad_perm:[0,1,0,1] row_mask:0xf bank_mask:0xf
v_mov_b32 v81, 0
v_mov_b32 v82, 0
v_mfma_f32_16x16x32_bf16 v[16:19], v[100:103], v[92:95], v[16:19]
v_mov_b32 v83, 0
v_mov_b32 v84, 0
v_mfma_f32_16x16x32_bf16 v[8:11], v[96:99], v[92:95], v[8:11]
s_nop 1
v_mov_b32 v85, 0
v_mov_b32 v86, 0
v_mov_b32 v87, 0
v_rcp_f32 v126, v16
v_subrev_u32 v127, 0x21800000, v16
v_cmp_lt_u32 vcc, 0x3c000000, v127
v_pk_mul_f32 v[8:9], v[8:9], v[126:127] op_sel_hi:[1,0]
v_pk_mul_f32 v[10:11], v[10:11], v[126:127] op_sel_hi:[1,0]
s_and_b32 s32, vcc_lo, 0xcccc
v_cvt_pk_bf16_f32 v126, v8, v9
v_cvt_pk_bf16_f32 v127, v10, v11
s_branch main_kernel_c6_ost
main_kernel_c6_o0_f:
s_nop 0
buffer_load_dwordx4 v[0:3], v116, s[4:7], s23 offen sc1
s_xor_b32 s32, s23, 1024
buffer_load_dwordx4 v[4:7], v116, s[4:7], s32 offen sc1
s_sub_u32 s29, s29, 1
s_cbranch_scc1 main_kernel_end
s_waitcnt vmcnt(0)
v_max_u32 v126, v0, v2
v_cmp_eq_u32 vcc, -1, v126
s_cbranch_vccnz main_kernel_c6_o0_f
s_branch main_kernel_c6_o0
main_kernel_c6_o1_f:
s_nop 0
s_xor_b32 s32, s23, 1024
buffer_load_dwordx4 v[4:7], v116, s[4:7], s32 offen sc1
s_xor_b32 s32, s23, 2048
buffer_load_dwordx4 v[8:11], v116, s[4:7], s32 offen sc1
s_sub_u32 s29, s29, 1
s_cbranch_scc1 main_kernel_end
s_waitcnt vmcnt(0)
v_max_u32 v126, v4, v6
v_cmp_eq_u32 vcc, -1, v126
s_cbranch_vccnz main_kernel_c6_o1_f
s_branch main_kernel_c6_o1
main_kernel_c6_o2_f:
s_nop 0
s_xor_b32 s32, s23, 2048
buffer_load_dwordx4 v[8:11], v116, s[4:7], s32 offen sc1
s_xor_b32 s32, s23, 3072
buffer_load_dwordx4 v[12:15], v116, s[4:7], s32 offen sc1
s_sub_u32 s29, s29, 1
s_cbranch_scc1 main_kernel_end
s_waitcnt vmcnt(0)
v_max_u32 v126, v8, v10
v_cmp_eq_u32 vcc, -1, v126
s_cbranch_vccnz main_kernel_c6_o2_f
s_branch main_kernel_c6_o2
main_kernel_c6_o3_f:
s_nop 0
s_xor_b32 s32, s23, 3072
buffer_load_dwordx4 v[12:15], v116, s[4:7], s32 offen sc1
s_xor_b32 s32, s23, 4096
buffer_load_dwordx4 v[16:19], v116, s[4:7], s32 offen sc1
s_sub_u32 s29, s29, 1
s_cbranch_scc1 main_kernel_end
s_waitcnt vmcnt(0)
v_max_u32 v126, v12, v14
v_cmp_eq_u32 vcc, -1, v126
s_cbranch_vccnz main_kernel_c6_o3_f
s_branch main_kernel_c6_o3
main_kernel_c6_o4_f:
s_nop 0
s_xor_b32 s32, s23, 4096
buffer_load_dwordx4 v[16:19], v116, s[4:7], s32 offen sc1
s_xor_b32 s32, s23, 5120
buffer_load_dwordx4 v[20:23], v116, s[4:7], s32 offen sc1
s_sub_u32 s29, s29, 1
s_cbranch_scc1 main_kernel_end
s_waitcnt vmcnt(0)
v_max_u32 v126, v16, v18
v_cmp_eq_u32 vcc, -1, v126
s_cbranch_vccnz main_kernel_c6_o4_f
s_branch main_kernel_c6_o4
main_kernel_c6_o5_f:
s_nop 0
s_xor_b32 s32, s23, 5120
buffer_load_dwordx4 v[20:23], v116, s[4:7], s32 offen sc1
s_xor_b32 s32, s23, 6144
buffer_load_dwordx4 v[24:27], v116, s[4:7], s32 offen sc1
s_sub_u32 s29, s29, 1
s_cbranch_scc1 main_kernel_end
s_waitcnt vmcnt(0)
v_max_u32 v126, v20, v22
v_cmp_eq_u32 vcc, -1, v126
s_cbranch_vccnz main_kernel_c6_o5_f
s_branch main_kernel_c6_o5
main_kernel_c6_o6_f:
s_nop 0
s_xor_b32 s32, s23, 6144
buffer_load_dwordx4 v[24:27], v116, s[4:7], s32 offen sc1
s_xor_b32 s32, s23, 7168
buffer_load_dwordx4 v[28:31], v116, s[4:7], s32 offen sc1
s_sub_u32 s29, s29, 1
s_cbranch_scc1 main_kernel_end
s_waitcnt vmcnt(0)
v_max_u32 v126, v24, v26
v_cmp_eq_u32 vcc, -1, v126
s_cbranch_vccnz main_kernel_c6_o6_f
s_branch main_kernel_c6_o6
main_kernel_c6_o7_f:
s_nop 0
s_xor_b32 s32, s23, 7168
buffer_load_dwordx4 v[28:31], v116, s[4:7], s32 offen sc1
s_sub_u32 s29, s29, 1
s_cbranch_scc1 main_kernel_end
s_waitcnt vmcnt(0)
v_max_u32 v126, v28, v30
v_cmp_eq_u32 vcc, -1, v126
s_cbranch_vccnz main_kernel_c6_o7_f
s_branch main_kernel_c6_o7
.p2align 6
main_kernel_c7_top:
s_barrier
buffer_load_dwordx4 v[0:3], v116, s[4:7], s18 offen sc1
s_add_u32 s20, s20, 0x40000
s_bitset0_b32 s20, 20
s_add_u32 s21, s21, 0x40000
s_bitset0_b32 s21, 20
s_add_u32 s22, s22, 0x40000
s_bitset0_b32 s22, 20
s_add_u32 s23, s23, 0x40000
s_bitset0_b32 s23, 20
s_xor_b32 s32, s18, 1024
buffer_load_dwordx4 v[16:19], v116, s[4:7], s32 offen sc1
s_add_u32 s3, s3, 0x40000
s_bitset0_b32 s3, 20
s_add_u32 s17, s17, 1
s_add_u32 s25, s25, 0x40000
s_bitset0_b32 s25, 20
s_nop 2
buffer_load_dwordx4 v[64:67], v116, s[4:7], s19 offen sc1
v_mov_b32 v80, 0
v_mov_b32 v81, 0
s_nop 3
s_xor_b32 s32, s19, 1024
buffer_load_dwordx4 v[68:71], v116, s[4:7], s32 offen sc1
v_mov_b32 v82, 0
v_mov_b32 v83, 0
s_nop 3
s_xor_b32 s32, s18, 2048
buffer_load_dwordx4 v[32:35], v116, s[4:7], s32 offen sc1
v_mov_b32 v84, 0
v_mov_b32 v85, 0
s_nop 3
s_xor_b32 s32, s19, 2048
buffer_load_dwordx4 v[72:75], v116, s[4:7], s32 offen sc1
v_mov_b32 v86, 0
v_mov_b32 v87, 0
s_nop 3
s_xor_b32 s32, s18, 3072
buffer_load_dwordx4 v[48:51], v116, s[4:7], s32 offen sc1
v_mov_b32 v88, 0
v_mov_b32 v89, 0
s_nop 3
s_xor_b32 s32, s19, 3072
buffer_load_dwordx4 v[76:79], v116, s[4:7], s32 offen sc1
s_memtime s[40:41]
s_memrealtime s[80:81]
s_memrealtime s[82:83]
s_memrealtime s[84:85]
s_memrealtime s[86:87]
s_memrealtime s[88:89]
s_memrealtime s[90:91]
s_memrealtime s[92:93]
s_memrealtime s[94:95]
s_memrealtime s[96:97]
s_memrealtime s[98:99]
s_memrealtime s[100:101]
s_sub_u32 s32, s15, s16
s_lshr_b32 s33, s17, 1
s_min_u32 s33, s33, 3
s_ashr_i32 s32, s32, s33
s_add_u32 s11, s11, s32
s_sub_u32 s32, s16, s27
s_sub_u32 s32, s32, s39
s_ashr_i32 s32, s32, 2
s_add_u32 s39, s39, s32
s_mov_b32 s27, s16
s_mov_b32 s2, s31
v_mov_b32 v126, s11
s_add_u32 s32, s43, 1590
v_mov_b32 v127, s32
s_waitcnt lgkmcnt(0)
ds_write_b32 v116, v126 offset:18432
s_add_u32 s80, s80, s82
s_add_u32 s80, s80, s84
s_add_u32 s80, s80, s86
s_add_u32 s80, s80, s88
s_add_u32 s80, s80, s90
s_add_u32 s80, s80, s92
s_add_u32 s80, s80, s94
s_add_u32 s80, s80, s96
s_add_u32 s80, s80, s98
s_add_u32 s80, s80, s100
s_lshl1_add_u32 s80, s80, s11
s_sub_u32 s15, s40, s80
s_add_u32 s32, s15, s39
v_mov_b32 v126, s32
buffer_store_dwordx2 v[126:127], off, s[4:7], s44 offset:128 sc1
v_mov_b32 v90, 0
v_mov_b32 v91, 0
s_waitcnt vmcnt(6)
v_pk_add_f16 v0, v0, v64
v_pk_add_f16 v1, v1, v65
v_pk_add_f16 v2, v2, v66
v_pk_add_f16 v3, v3, v67
v_cmp_u_f16 vcc, v0, v2
s_cbranch_vccnz main_kernel_c7_m0_f
main_kernel_c7_m0:
v_smfmac_f32_16x16x64_f16 v[80:83], v[0:3], a[0:7], v112
ds_write_b128 v116, v[0:3] offset:3072
v_smfmac_f32_16x16x64_f16 v[84:87], v[0:3], a[128:135], v112
buffer_load_dword v123, v121, s[4:7], 0 offen sc1
s_waitcnt vmcnt(6)
v_pk_add_f16 v16, v16, v68
v_pk_add_f16 v17, v17, v69
v_pk_add_f16 v18, v18, v70
v_pk_add_f16 v19, v19, v71
v_cmp_u_f16 vcc, v16, v18
s_waitcnt lgkmcnt(0)
s_barrier
ds_read_b128 v[4:7], v116 offset:2048
s_cbranch_vccnz main_kernel_c7_m1_f
main_kernel_c7_m1:
v_smfmac_f32_16x16x64_f16 v[80:83], v[16:19], a[8:15], v112
ds_write_b128 v116, v[16:19] offset:7168
v_smfmac_f32_16x16x64_f16 v[84:87], v[16:19], a[136:143], v112
ds_read_b128 v[8:11], v116 offset:1024
v_smfmac_f32_16x16x64_f16 v[88:91], v[0:3], v[128:135], v112
ds_read_b128 v[12:15], v116 offset:0
s_waitcnt lgkmcnt(3)
v_smfmac_f32_16x16x64_f16 v[80:83], v[4:7], a[32:39], v112
v_smfmac_f32_16x16x64_f16 v[84:87], v[4:7], a[160:167], v112
v_smfmac_f32_16x16x64_f16 v[88:91], v[4:7], v[136:143], v112
s_waitcnt lgkmcnt(2)
s_barrier
s_waitcnt lgkmcnt(1)
v_smfmac_f32_16x16x64_f16 v[80:83], v[8:11], a[64:71], v112
s_waitcnt vmcnt(4)
ds_read_b128 v[20:23], v116 offset:6144
v_pk_add_f16 v32, v32, v72
v_smfmac_f32_16x16x64_f16 v[84:87], v[8:11], a[192:199], v112
ds_read_b128 v[24:27], v116 offset:5120
s_waitcnt lgkmcnt(2)
v_pk_add_f16 v33, v33, v73
v_smfmac_f32_16x16x64_f16 v[80:83], v[12:15], a[96:103], v112
ds_read_b128 v[28:31], v116 offset:4096
v_pk_add_f16 v34, v34, v74
v_smfmac_f32_16x16x64_f16 v[84:87], v[12:15], a[224:231], v112
s_waitcnt lgkmcnt(2)
v_pk_add_f16 v35, v35, v75
v_smfmac_f32_16x16x64_f16 v[80:83], v[20:23], a[40:47], v112
v_cmp_u_f16 vcc, v32, v34
v_smfmac_f32_16x16x64_f16 v[84:87], v[20:23], a[168:175], v112
ds_write_b128 v116, v[32:35] offset:11264
s_cbranch_vccnz main_kernel_c7_m2_f
main_kernel_c7_m2:
v_smfmac_f32_16x16x64_f16 v[80:83], v[32:35], a[16:23], v112
buffer_load_dwordx4 v[96:99], v116, s[4:7], s28 offen sc1
v_smfmac_f32_16x16x64_f16 v[84:87], v[32:35], a[144:151], v112
s_add_u32 s28, s28, 0x40000
s_waitcnt lgkmcnt(2)
v_smfmac_f32_16x16x64_f16 v[80:83], v[24:27], a[72:79], v112
s_waitcnt vmcnt(3)
v_pk_add_f16 v48, v48, v76
v_smfmac_f32_16x16x64_f16 v[84:87], v[24:27], a[200:207], v112
s_waitcnt lgkmcnt(0)
s_barrier
ds_read_b128 v[36:39], v116 offset:10240
v_pk_add_f16 v49, v49, v77
v_smfmac_f32_16x16x64_f16 v[80:83], v[28:31], a[104:111], v112
ds_read_b128 v[40:43], v116 offset:9216
v_pk_add_f16 v50, v50, v78
v_smfmac_f32_16x16x64_f16 v[84:87], v[28:31], a[232:239], v112
ds_read_b128 v[44:47], v116 offset:8192
v_pk_add_f16 v51, v51, v79
v_smfmac_f32_16x16x64_f16 v[88:91], v[8:11], v[144:151], v112
s_waitcnt lgkmcnt(2)
v_cmp_u_f16 vcc, v48, v50
v_smfmac_f32_16x16x64_f16 v[80:83], v[36:39], a[48:55], v112
ds_write_b128 v116, v[48:51] offset:15360
s_cbranch_vccnz main_kernel_c7_m3_f
main_kernel_c7_m3:
v_smfmac_f32_16x16x64_f16 v[80:83], v[48:51], a[24:31], v112
v_smfmac_f32_16x16x64_f16 v[84:87], v[48:51], a[152:159], v112
v_smfmac_f32_16x16x64_f16 v[84:87], v[36:39], a[176:183], v112
s_waitcnt lgkmcnt(2)
v_smfmac_f32_16x16x64_f16 v[80:83], v[40:43], a[80:87], v112
s_waitcnt lgkmcnt(0)
s_barrier
ds_read_b128 v[52:55], v116 offset:14336
v_smfmac_f32_16x16x64_f16 v[84:87], v[40:43], a[208:215], v112
s_memtime s[40:41]
ds_read_b128 v[56:59], v116 offset:13312
v_smfmac_f32_16x16x64_f16 v[80:83], v[44:47], a[112:119], v112
s_add_u32 s19, s52, s54
ds_read_b128 v[60:63], v116 offset:12288
v_smfmac_f32_16x16x64_f16 v[84:87], v[44:47], a[240:247], v112
s_add_u32 s18, s18, 0x40000
s_waitcnt lgkmcnt(2)
v_smfmac_f32_16x16x64_f16 v[80:83], v[52:55], a[56:63], v112
s_bitset0_b32 s18, 20
s_waitcnt lgkmcnt(1)
v_smfmac_f32_16x16x64_f16 v[80:83], v[56:59], a[88:95], v112
s_cmp_eq_u32 s17, 30
s_cselect_b32 s32, s53, 0x10000
s_waitcnt lgkmcnt(0)
v_smfmac_f32_16x16x64_f16 v[80:83], v[60:63], a[120:127], v112
s_add_u32 s52, s52, s32
ds_read_b128 v[64:67], v116 offset:24576
v_smfmac_f32_16x16x64_f16 v[84:87], v[52:55], a[184:191], v112
s_sub_u32 s24, 0x20000, s32
ds_read_b128 v[68:71], v116 offset:28672
v_smfmac_f32_16x16x64_f16 v[84:87], v[56:59], a[216:223], v112
ds_read_b128 v[72:75], v116 offset:25600
s_add_u32 s55, s55, s24
v_cvt_pk_bf16_f32 v92, v80, v81
v_smfmac_f32_16x16x64_f16 v[84:87], v[60:63], a[248:255], v112
ds_read_b128 v[76:79], v116 offset:29696
s_nop 0
v_cvt_pk_bf16_f32 v93, v82, v83
v_smfmac_f32_16x16x64_f16 v[88:91], v[12:15], v[152:159], v112
s_nop 3
v_cvt_pk_bf16_f32 v94, v84, v85
v_cvt_pk_bf16_f32 v95, v86, v87
s_mov_b32 vcc_lo, 0xcccccccc
s_mov_b32 vcc_hi, 0xcccccccc
v_mfma_f32_16x16x32_bf16 v[84:87], v[92:95], v[104:107], 0
v_add_u32 v121, v121, v122
s_waitcnt lgkmcnt(0)
s_sub_u32 s31, s40, s11
v_smfmac_f32_16x16x64_f16 v[88:91], v[16:19], v[160:167], v112
s_sub_u32 s32, s31, s43
s_sub_u32 s47, 1590, s32
s_max_i32 s47, s47, 0
s_cmp_eq_u32 s17, 63
v_cvt_pk_bf16_f32 v114, v84, v85
v_cvt_pk_bf16_f32 v115, v86, v87
buffer_store_dwordx2 v[114:115], v117, s[4:7], s21 offen sc1
s_cbranch_scc1 main_kernel_c7_last
ds_write_b64 v117, v[114:115] offset:17920
v_smfmac_f32_16x16x64_f16 v[88:91], v[20:23], v[168:175], v112
s_cmp_gt_u32 s32, 1690
s_cselect_b32 s33, 900, s47
v_smfmac_f32_16x16x64_f16 v[88:91], v[24:27], v[176:183], v112
s_add_u32 s10, s33, s31
s_andn2_b32 s42, s44, 0x1f00
v_mov_b32 v126, s15
v_smfmac_f32_16x16x64_f16 v[88:91], v[28:31], v[184:191], v112
s_add_u32 s42, s42, 0x4000
v_mov_b32 v127, s10
v_smfmac_f32_16x16x64_f16 v[88:91], v[32:35], v[192:199], v112
.p2align 3
main_kernel_c7_b21:
s_sub_u32 s47, s47, 28
s_cbranch_scc0 main_kernel_c7_b21
s_waitcnt lgkmcnt(0)
s_barrier
ds_read_b128 v[0:3], v116 offset:16384
v_smfmac_f32_16x16x64_f16 v[88:91], v[36:39], v[200:207], v112
ds_read_b128 v[4:7], v116 offset:17408
buffer_store_dwordx2 v[126:127], off, s[4:7], s46 sc1
v_smfmac_f32_16x16x64_f16 v[88:91], v[40:43], v[208:215], v112
ds_read_b128 v[16:19], v116 offset:26624
s_cmp_gt_u32 s32, 1690
s_cbranch_scc1 main_kernel_c7_rp
main_kernel_c7_rq:
v_smfmac_f32_16x16x64_f16 v[88:91], v[44:47], v[216:223], v112
ds_read_b128 v[20:23], v116 offset:30720
v_writelane_b32 v121, s55, 39
v_smfmac_f32_16x16x64_f16 v[88:91], v[48:51], v[224:231], v112
ds_read_b128 v[24:27], v116 offset:27648
s_waitcnt vmcnt(3)
s_andn2_b32 s35, s46, 0xff
v_bfe_u32 v123, v116, 1, 8
v_smfmac_f32_16x16x64_f16 v[88:91], v[52:55], v[232:239], v112
ds_read_b128 v[28:31], v116 offset:31744
v_smfmac_f32_16x16x64_f16 v[88:91], v[56:59], v[240:247], v112
v_smfmac_f32_16x16x64_f16 v[88:91], v[60:63], v[248:255], v112
s_waitcnt lgkmcnt(5)
v_mfma_f32_16x16x32_bf16 v[80:83], v[64:67], v[0:3], 0
v_mfma_f32_16x16x32_bf16 v[84:87], v[68:71], v[0:3], 0
buffer_load_dwordx4 v[8:11], v116, s[4:7], s20 offen offset:0 sc1
v_mfma_f32_16x16x32_bf16 v[92:95], v[0:3], v[0:3], 0
buffer_load_dwordx4 v[12:15], v116, s[4:7], s20 offen offset:1024 sc1
v_permlane32_swap_b32 v88, v90
s_waitcnt lgkmcnt(4)
v_mfma_f32_16x16x32_bf16 v[80:83], v[72:75], v[4:7], v[80:83]
v_permlane32_swap_b32 v89, v91
v_mfma_f32_16x16x32_bf16 v[84:87], v[76:79], v[4:7], v[84:87]
v_pk_add_f32 v[88:89], v[88:89], v[90:91]
v_mfma_f32_16x16x32_bf16 v[92:95], v[4:7], v[4:7], v[92:95]
v_cvt_pk_bf16_f32 v124, v88, v89
v_mov_b32 v65, 0
buffer_load_dwordx2 v[66:67], v123, s[4:7], s35 offen sc1
s_waitcnt lgkmcnt(0)
s_waitcnt vmcnt(2)
v_mfma_f32_16x16x32_bf16 v[88:91], v[8:11], v[8:11], v[92:95]
v_mfma_f32_16x16x32_bf16 v[0:3], v[16:19], v[8:11], v[80:83]
v_cmp_u_f32 s[0:1], v8, v10
v_mfma_f32_16x16x32_bf16 v[4:7], v[20:23], v[8:11], v[84:87]
s_waitcnt vmcnt(1)
v_mfma_f32_16x16x32_bf16 v[88:91], v[12:15], v[12:15], v[88:91]
v_mfma_f32_16x16x32_bf16 v[0:3], v[24:27], v[12:15], v[0:3]
v_cmp_u_f32 s[32:33], v12, v14
v_mfma_f32_16x16x32_bf16 v[4:7], v[28:31], v[12:15], v[4:7]
s_or_b64 s[0:1], s[0:1], s[32:33]
s_cbranch_scc1 main_kernel_c7_z_f
main_kernel_c7_z:
v_mul_f32 v88, s30, v88
v_mul_f32 v89, s30, v89
v_exp_f32 v88, v88
v_exp_f32 v89, v89
v_cndmask_b32_dpp v0, v2, v0, vcc quad_perm:[2,3,2,3] row_mask:0xf bank_mask:0xf
v_cvt_pk_bf16_f32 v64, v88, v89
v_cndmask_b32_dpp v1, v3, v1, vcc quad_perm:[2,3,2,3] row_mask:0xf bank_mask:0xf
v_exp_f32 v0, v0
v_mfma_f32_16x16x16_bf16 v[16:19], v[100:101], v[64:65], 0
v_exp_f32 v1, v1
v_cndmask_b32_dpp v4, v6, v4, vcc quad_perm:[2,3,2,3] row_mask:0xf bank_mask:0xf
v_mfma_f32_16x16x16_bf16 v[8:11], v[124:125], v[64:65], 0
v_cndmask_b32_dpp v5, v7, v5, vcc quad_perm:[2,3,2,3] row_mask:0xf bank_mask:0xf
v_exp_f32 v4, v4
v_exp_f32 v5, v5
v_cvt_pk_bf16_f32 v92, v0, v1
v_cvt_pk_bf16_f32 v94, v4, v5
v_mov_b32 v80, 0
v_mov_b32_dpp v93, v92 quad_perm:[0,1,0,1] row_mask:0xf bank_mask:0xf
v_mov_b32_dpp v95, v94 quad_perm:[0,1,0,1] row_mask:0xf bank_mask:0xf
v_mov_b32 v81, 0
v_mov_b32 v82, 0
v_mfma_f32_16x16x32_bf16 v[16:19], v[100:103], v[92:95], v[16:19]
v_mov_b32 v83, 0
v_mov_b32 v84, 0
v_mfma_f32_16x16x32_bf16 v[8:11], v[96:99], v[92:95], v[8:11]
s_buffer_load_dword s42, s[4:7], s42
s_nop 1
v_mov_b32 v85, 0
v_mov_b32 v86, 0
v_mov_b32 v87, 0
v_rcp_f32 v126, v16
v_subrev_u32 v127, 0x21800000, v16
v_cmp_lt_u32 vcc, 0x3c000000, v127
v_pk_mul_f32 v[8:9], v[8:9], v[126:127] op_sel_hi:[1,0]
v_pk_mul_f32 v[10:11], v[10:11], v[126:127] op_sel_hi:[1,0]
s_and_b32 s32, vcc_lo, 0xcccc
v_cvt_pk_bf16_f32 v126, v8, v9
v_cvt_pk_bf16_f32 v127, v10, v11
s_cbranch_scc1 main_kernel_c7_sm_f
main_kernel_c7_ost:
buffer_store_dwordx2 v[126:127], v118, s[4:7], s22 offen sc1
s_waitcnt vmcnt(1)
main_kernel_c7_to0:
s_memtime s[40:41]
v_readlane_b32 s16, v66, 0
v_subrev_u32 v67, s2, v67
s_add_u32 s34, s11, s2
s_nop 0
v_max_u32_dpp v67, v67, v67 row_ror:8 row_mask:0xf bank_mask:0xf
s_nop 1
v_max_u32_dpp v67, v67, v67 row_ror:4 row_mask:0xf bank_mask:0xf
s_nop 1
v_max_u32_dpp v67, v67, v67 row_ror:2 row_mask:0xf bank_mask:0xf
s_nop 1
v_max_u32_dpp v67, v67, v67 row_ror:1 row_mask:0xf bank_mask:0xf
s_waitcnt lgkmcnt(0)
v_readlane_b32 s32, v67, 0
v_readlane_b32 s33, v67, 16
s_sub_u32 s34, s40, s34
s_max_u32 s32, s32, s33
s_add_u32 s35, s34, 1536
s_cmp_gt_u32 s32, s35
s_cbranch_scc1 main_kernel_c7_to2
main_kernel_c7_to3:
s_sub_u32 s33, s42, s2
s_cmp_le_u32 s33, s35
s_cselect_b32 s33, s33, 0
s_max_u32 s32, s32, s33
s_add_u32 s36, s32, 2850
s_add_u32 s32, s32, 1270
s_sub_u32 s47, s32, s34
s_max_i32 s47, s47, 0
.p2align 3
main_kernel_c7_to1:
s_sub_u32 s47, s47, 28
s_cbranch_scc0 main_kernel_c7_to1
s_barrier
buffer_load_dwordx4 v[0:3], v116, s[4:7], s23 offen sc1
ds_read_b128 v[32:35], v113 offset:0
ds_read_b128 v[36:39], v113 offset:1024
s_add_u32 s46, s46, 0x40000
s_bitset0_b32 s46, 20
s_add_u32 s37, s37, 65536
s_add_u32 s26, s26, 65536
s_xor_b32 s32, s23, 1024
buffer_load_dwordx4 v[4:7], v116, s[4:7], s32 offen sc1
ds_read_b128 v[40:43], v113 offset:2048
ds_read_b128 v[44:47], v113 offset:3072
s_add_u32 s44, s44, s24
s_nop 2
s_xor_b32 s32, s23, 2048
buffer_load_dwordx4 v[8:11], v116, s[4:7], s32 offen sc1
ds_read_b128 v[48:51], v113 offset:4096
ds_read_b128 v[52:55], v113 offset:5120
s_nop 3
s_xor_b32 s32, s23, 3072
buffer_load_dwordx4 v[12:15], v116, s[4:7], s32 offen sc1
ds_read_b128 v[56:59], v113 offset:6144
ds_read_b128 v[60:63], v113 offset:7168
s_nop 3
s_xor_b32 s32, s23, 4096
buffer_load_dwordx4 v[16:19], v116, s[4:7], s32 offen sc1
ds_read_b128 v[64:67], v113 offset:8192
ds_read_b128 v[68:71], v113 offset:9216
s_nop 3
s_xor_b32 s32, s23, 5120
buffer_load_dwordx4 v[20:23], v116, s[4:7], s32 offen sc1
ds_read_b128 v[72:75], v113 offset:10240
ds_read_b128 v[76:79], v113 offset:11264
s_nop 3
s_xor_b32 s32, s23, 6144
buffer_load_dwordx4 v[24:27], v116, s[4:7], s32 offen sc1
ds_read_b128 v[88:91], v113 offset:12288
ds_read_b128 v[92:95], v113 offset:13312
s_nop 3
s_xor_b32 s32, s23, 7168
buffer_load_dwordx4 v[28:31], v116, s[4:7], s32 offen sc1
v_and_b32 v127, 0x1f0, v116
v_lshlrev_b32 v127, 4, v127
s_waitcnt lgkmcnt(12)
s_waitcnt vmcnt(7)
v_cmp_u_f32 vcc, v0, v2
s_cbranch_vccnz main_kernel_c7_o0_f
main_kernel_c7_o0:
v_smfmac_f32_16x16x64_bf16 v[80:83], v[0:3], v[32:39], v112
ds_read_b128 v[32:35], v113 offset:14336
ds_read_b128 v[36:39], v113 offset:15360
buffer_load_dwordx2 v[96:97], v127, s[4:7], s45 offen offset:128 sc1
s_waitcnt lgkmcnt(12)
s_waitcnt vmcnt(7)
v_cmp_u_f32 vcc, v4, v6
v_smfmac_f32_16x16x64_bf16 v[84:87], v[0:3], v[40:47], v112
ds_read_b128 v[40:43], v113 offset:16384
ds_read_b128 v[44:47], v113 offset:17408
buffer_store_dwordx2 v[114:115], v119, s[4:7], s37 offen sc1
s_cbranch_vccnz main_kernel_c7_o1_f
main_kernel_c7_o1:
s_waitcnt lgkmcnt(12)
v_smfmac_f32_16x16x64_bf16 v[80:83], v[4:7], v[48:55], v112
ds_read_b128 v[48:51], v113 offset:18432
ds_read_b128 v[52:55], v113 offset:19456
s_waitcnt lgkmcnt(12)
s_waitcnt vmcnt(7)
v_cmp_u_f32 vcc, v8, v10
v_smfmac_f32_16x16x64_bf16 v[84:87], v[4:7], v[56:63], v112
ds_read_b128 v[56:59], v113 offset:20480
ds_read_b128 v[60:63], v113 offset:21504
buffer_store_dword v124, v120, s[4:7], s26 offen sc1
s_cbranch_vccnz main_kernel_c7_o2_f
main_kernel_c7_o2:
s_waitcnt lgkmcnt(12)
v_smfmac_f32_16x16x64_bf16 v[80:83], v[8:11], v[64:71], v112
ds_read_b128 v[64:67], v113 offset:22528
ds_read_b128 v[68:71], v113 offset:23552
s_waitcnt lgkmcnt(12)
s_waitcnt vmcnt(7)
v_cmp_u_f32 vcc, v12, v14
v_smfmac_f32_16x16x64_bf16 v[84:87], v[8:11], v[72:79], v112
ds_read_b128 v[72:75], v113 offset:24576
ds_read_b128 v[76:79], v113 offset:25600
s_cbranch_vccnz main_kernel_c7_o3_f
main_kernel_c7_o3:
s_waitcnt lgkmcnt(12)
v_smfmac_f32_16x16x64_bf16 v[80:83], v[12:15], v[88:95], v112
ds_read_b128 v[88:91], v113 offset:26624
ds_read_b128 v[92:95], v113 offset:27648
s_waitcnt lgkmcnt(12)
s_waitcnt vmcnt(6)
v_cmp_u_f32 vcc, v16, v18
v_smfmac_f32_16x16x64_bf16 v[84:87], v[12:15], v[32:39], v112
ds_read_b128 v[32:35], v113 offset:28672
ds_read_b128 v[36:39], v113 offset:29696
s_cbranch_vccnz main_kernel_c7_o4_f
main_kernel_c7_o4:
s_waitcnt lgkmcnt(12)
v_smfmac_f32_16x16x64_bf16 v[80:83], v[16:19], v[40:47], v112
ds_read_b128 v[40:43], v113 offset:30720
ds_read_b128 v[44:47], v113 offset:31744
s_waitcnt lgkmcnt(12)
s_waitcnt vmcnt(5)
v_cmp_u_f32 vcc, v20, v22
v_smfmac_f32_16x16x64_bf16 v[84:87], v[16:19], v[48:55], v112
s_cbranch_vccnz main_kernel_c7_o5_f
main_kernel_c7_o5:
s_waitcnt lgkmcnt(10)
v_smfmac_f32_16x16x64_bf16 v[80:83], v[20:23], v[56:63], v112
s_waitcnt lgkmcnt(8)
s_waitcnt vmcnt(4)
v_cmp_u_f32 vcc, v24, v26
v_smfmac_f32_16x16x64_bf16 v[84:87], v[20:23], v[64:71], v112
s_cbranch_vccnz main_kernel_c7_o6_f
main_kernel_c7_o6:
s_waitcnt lgkmcnt(6)
v_smfmac_f32_16x16x64_bf16 v[80:83], v[24:27], v[72:79], v112
s_waitcnt lgkmcnt(4)
v_smfmac_f32_16x16x64_bf16 v[84:87], v[24:27], v[88:95], v112
s_waitcnt lgkmcnt(2)
s_waitcnt vmcnt(3)
v_cmp_u_f32 vcc, v28, v30
s_cbranch_vccnz main_kernel_c7_o7_f
main_kernel_c7_o7:
v_smfmac_f32_16x16x64_bf16 v[80:83], v[28:31], v[32:39], v112
s_waitcnt lgkmcnt(0)
v_smfmac_f32_16x16x64_bf16 v[84:87], v[28:31], v[40:47], v112
s_nop 4
v_cvt_pk_bf16_f32 v80, v80, v81
v_cvt_pk_bf16_f32 v81, v82, v83
ds_write_b64 v116, v[80:81] offset:21512
v_cvt_pk_bf16_f32 v82, v84, v85
v_cvt_pk_bf16_f32 v83, v86, v87
ds_write_b64 v116, v[82:83] offset:23560
s_waitcnt lgkmcnt(0)
s_barrier
ds_read_b128 v[72:75], v116 offset:22528
ds_read_b128 v[76:79], v116 offset:23552
s_waitcnt lgkmcnt(1)
v_mfma_f32_16x16x32_bf16 v[64:67], v[72:75], v[108:111], 0
s_waitcnt lgkmcnt(0)
v_mfma_f32_16x16x32_bf16 v[64:67], v[76:79], v[108:111], v[64:67]
s_nop 7
v_cvt_pk_f16_f32 v68, v64, v65
v_cvt_pk_f16_f32 v69, v66, v67
buffer_store_dwordx2 v[68:69], v125, s[4:7], s25 offen sc1
s_sub_u32 s0, s2, s16
s_sub_u32 s0, s0, s39
s_waitcnt vmcnt(3)
main_kernel_c7_tm0:
s_memtime s[40:41]
v_sub_u32 v97, v97, v96
v_subrev_u32 v97, s0, v97
s_add_u32 s34, s11, s2
s_nop 0
v_max_u32_dpp v97, v97, v97 row_ror:8 row_mask:0xf bank_mask:0xf
s_nop 1
v_max_u32_dpp v97, v97, v97 row_ror:4 row_mask:0xf bank_mask:0xf
s_nop 1
v_max_u32_dpp v97, v97, v97 row_ror:2 row_mask:0xf bank_mask:0xf
s_nop 1
v_max_u32_dpp v97, v97, v97 row_ror:1 row_mask:0xf bank_mask:0xf
s_waitcnt lgkmcnt(0)
v_readlane_b32 s32, v97, 0
v_readlane_b32 s33, v97, 16
s_sub_u32 s34, s40, s34
s_max_u32 s32, s32, s33
s_add_u32 s35, s34, 1536
s_cmp_gt_u32 s32, s35
s_cbranch_scc1 main_kernel_c7_tm2
main_kernel_c7_tm3:
s_add_u32 s32, s32, 2850
s_max_u32 s32, s32, s36
s_add_u32 s43, s32, s2
s_sub_u32 s47, s32, s34
s_max_i32 s47, s47, 0
.p2align 3
main_kernel_c7_tm1:
s_sub_u32 s47, s47, 28
s_cbranch_scc0 main_kernel_c7_tm1
s_add_u32 s45, s45, s24
s_branch main_kernel_c7_top
main_kernel_c7_to2:
s_mov_b32 s32, s34
s_mov_b32 s16, s15
s_cmp_gt_u32 s34, 0x40000
s_cbranch_scc1 main_kernel_c7_to3
s_andn2_b32 s35, s46, 0xff
v_bfe_u32 v123, v116, 1, 8
buffer_load_dwordx2 v[66:67], v123, s[4:7], s35 offen sc1
s_sub_u32 s29, s29, 1
s_cbranch_scc1 main_kernel_end
s_waitcnt vmcnt(0)
s_branch main_kernel_c7_to0
main_kernel_c7_tm2:
s_mov_b32 s32, s34
s_cmp_gt_u32 s34, 0x40000
s_cbranch_scc1 main_kernel_c7_tm3
v_and_b32 v127, 0x1f0, v116
v_lshlrev_b32 v127, 4, v127
buffer_load_dwordx2 v[96:97], v127, s[4:7], s45 offen offset:128 sc1
s_sub_u32 s29, s29, 1
s_cbranch_scc1 main_kernel_end
s_waitcnt vmcnt(0)
s_branch main_kernel_c7_tm0
main_kernel_c7_rp:
buffer_store_dword v127, off, s[4:7], s44 offset:132 sc1
s_branch main_kernel_c7_rq
main_kernel_c7_last:
s_add_u32 s37, s37, 65536
s_add_u32 s26, s26, 65536
buffer_store_dwordx2 v[114:115], v119, s[4:7], s37 offen sc1
v_smfmac_f32_16x16x64_f16 v[88:91], v[20:23], v[168:175], v112
v_smfmac_f32_16x16x64_f16 v[88:91], v[24:27], v[176:183], v112
v_smfmac_f32_16x16x64_f16 v[88:91], v[28:31], v[184:191], v112
v_smfmac_f32_16x16x64_f16 v[88:91], v[32:35], v[192:199], v112
v_smfmac_f32_16x16x64_f16 v[88:91], v[36:39], v[200:207], v112
v_smfmac_f32_16x16x64_f16 v[88:91], v[40:43], v[208:215], v112
v_smfmac_f32_16x16x64_f16 v[88:91], v[44:47], v[216:223], v112
v_smfmac_f32_16x16x64_f16 v[88:91], v[48:51], v[224:231], v112
v_smfmac_f32_16x16x64_f16 v[88:91], v[52:55], v[232:239], v112
v_smfmac_f32_16x16x64_f16 v[88:91], v[56:59], v[240:247], v112
v_smfmac_f32_16x16x64_f16 v[88:91], v[60:63], v[248:255], v112
s_nop 7
v_permlane32_swap_b32 v88, v90
s_nop 1
v_permlane32_swap_b32 v89, v91
s_nop 1
v_pk_add_f32 v[88:89], v[88:89], v[90:91]
s_nop 1
v_cvt_pk_bf16_f32 v124, v88, v89
s_nop 1
buffer_store_dword v124, v120, s[4:7], s26 offen sc1
s_branch main_kernel_end
main_kernel_c7_m0_f:
s_waitcnt lgkmcnt(0)
buffer_load_dwordx4 v[0:3], v116, s[4:7], s18 offen sc1
buffer_load_dwordx4 v[64:67], v116, s[4:7], s19 offen sc1
s_xor_b32 s32, s18, 1024
buffer_load_dwordx4 v[16:19], v116, s[4:7], s32 offen sc1
s_xor_b32 s32, s19, 1024
buffer_load_dwordx4 v[68:71], v116, s[4:7], s32 offen sc1
s_xor_b32 s32, s18, 2048
buffer_load_dwordx4 v[32:35], v116, s[4:7], s32 offen sc1
s_xor_b32 s32, s19, 2048
buffer_load_dwordx4 v[72:75], v116, s[4:7], s32 offen sc1
s_xor_b32 s32, s18, 3072
buffer_load_dwordx4 v[48:51], v116, s[4:7], s32 offen sc1
s_xor_b32 s32, s19, 3072
buffer_load_dwordx4 v[76:79], v116, s[4:7], s32 offen sc1
s_sub_u32 s29, s29, 1
s_cbranch_scc1 main_kernel_end
s_waitcnt vmcnt(0)
v_max_u32 v126, v0, v2
v_max3_u32 v126, v126, v64, v66
v_cmp_eq_u32 vcc, -1, v126
s_cbranch_vccnz main_kernel_c7_m0_f
v_pk_add_f16 v0, v0, v64
v_pk_add_f16 v1, v1, v65
v_pk_add_f16 v2, v2, v66
v_pk_add_f16 v3, v3, v67
s_nop 0
s_branch main_kernel_c7_m0
main_kernel_c7_m1_f:
s_waitcnt lgkmcnt(0)
s_xor_b32 s32, s18, 1024
buffer_load_dwordx4 v[16:19], v116, s[4:7], s32 offen sc1
s_xor_b32 s32, s19, 1024
buffer_load_dwordx4 v[68:71], v116, s[4:7], s32 offen sc1
s_xor_b32 s32, s18, 2048
buffer_load_dwordx4 v[32:35], v116, s[4:7], s32 offen sc1
s_xor_b32 s32, s19, 2048
buffer_load_dwordx4 v[72:75], v116, s[4:7], s32 offen sc1
s_xor_b32 s32, s18, 3072
buffer_load_dwordx4 v[48:51], v116, s[4:7], s32 offen sc1
s_xor_b32 s32, s19, 3072
buffer_load_dwordx4 v[76:79], v116, s[4:7], s32 offen sc1
s_sub_u32 s29, s29, 1
s_cbranch_scc1 main_kernel_end
s_waitcnt vmcnt(0)
v_max_u32 v126, v16, v18
v_max3_u32 v126, v126, v68, v70
v_cmp_eq_u32 vcc, -1, v126
s_cbranch_vccnz main_kernel_c7_m1_f
v_pk_add_f16 v16, v16, v68
v_pk_add_f16 v17, v17, v69
v_pk_add_f16 v18, v18, v70
v_pk_add_f16 v19, v19, v71
s_nop 0
s_branch main_kernel_c7_m1
main_kernel_c7_m2_f:
s_waitcnt lgkmcnt(0)
s_xor_b32 s32, s18, 2048
buffer_load_dwordx4 v[32:35], v116, s[4:7], s32 offen sc1
s_xor_b32 s32, s19, 2048
buffer_load_dwordx4 v[72:75], v116, s[4:7], s32 offen sc1
s_xor_b32 s32, s18, 3072
buffer_load_dwordx4 v[48:51], v116, s[4:7], s32 offen sc1
s_xor_b32 s32, s19, 3072
buffer_load_dwordx4 v[76:79], v116, s[4:7], s32 offen sc1
s_sub_u32 s29, s29, 1
s_cbranch_scc1 main_kernel_end
s_waitcnt vmcnt(0)
v_max_u32 v126, v32, v34
v_max3_u32 v126, v126, v72, v74
v_cmp_eq_u32 vcc, -1, v126
s_cbranch_vccnz main_kernel_c7_m2_f
v_pk_add_f16 v32, v32, v72
v_pk_add_f16 v33, v33, v73
v_pk_add_f16 v34, v34, v74
v_pk_add_f16 v35, v35, v75
ds_write_b128 v116, v[32:35] offset:11264
s_branch main_kernel_c7_m2
main_kernel_c7_m3_f:
s_waitcnt lgkmcnt(0)
s_xor_b32 s32, s18, 3072
buffer_load_dwordx4 v[48:51], v116, s[4:7], s32 offen sc1
s_xor_b32 s32, s19, 3072
buffer_load_dwordx4 v[76:79], v116, s[4:7], s32 offen sc1
s_sub_u32 s29, s29, 1
s_cbranch_scc1 main_kernel_end
s_waitcnt vmcnt(0)
v_max_u32 v126, v48, v50
v_max3_u32 v126, v126, v76, v78
v_cmp_eq_u32 vcc, -1, v126
s_cbranch_vccnz main_kernel_c7_m3_f
v_pk_add_f16 v48, v48, v76
v_pk_add_f16 v49, v49, v77
v_pk_add_f16 v50, v50, v78
v_pk_add_f16 v51, v51, v79
ds_write_b128 v116, v[48:51] offset:15360
s_branch main_kernel_c7_m3
main_kernel_c7_z_f:
buffer_load_dwordx4 v[8:11], v116, s[4:7], s20 offen offset:0 sc1
buffer_load_dwordx4 v[12:15], v116, s[4:7], s20 offen offset:1024 sc1
s_memtime s[32:33]
ds_read_b32 v126, v116 offset:18432
s_sub_u32 s34, s19, s54
s_xor_b32 s34, s34, 0x2000
s_lshl_b32 s35, s12, 15
s_add_u32 s34, s34, s35
s_lshl_b32 s35, s13, 8
s_add_u32 s35, s35, s34
s_add_u32 s34, s34, 0x4000
s_waitcnt lgkmcnt(0)
s_sub_u32 s32, s32, 450
v_sub_u32 v126, s32, v126
v_max_u32 v127, v126, v127
buffer_store_dword v127, off, s[4:7], s34 sc1
s_sub_u32 s29, s29, 1
s_cbranch_scc1 main_kernel_end
s_waitcnt vmcnt(1)
main_kernel_c7_z_g:
v_max_u32 v126, v8, v10
v_max3_u32 v126, v126, v12, v14
v_cmp_eq_u32 vcc, -1, v126
s_cbranch_vccnz main_kernel_c7_z_h
v_mfma_f32_16x16x32_bf16 v[88:91], v[8:11], v[8:11], v[92:95]
v_mfma_f32_16x16x32_bf16 v[0:3], v[16:19], v[8:11], v[80:83]
v_mfma_f32_16x16x32_bf16 v[4:7], v[20:23], v[8:11], v[84:87]
v_mfma_f32_16x16x32_bf16 v[88:91], v[12:15], v[12:15], v[88:91]
v_mfma_f32_16x16x32_bf16 v[0:3], v[24:27], v[12:15], v[0:3]
v_mfma_f32_16x16x32_bf16 v[4:7], v[28:31], v[12:15], v[4:7]
buffer_store_dword v127, off, s[4:7], s35 offset:132 sc1
s_mov_b32 vcc_lo, 0xcccccccc
s_mov_b32 vcc_hi, 0xcccccccc
s_branch main_kernel_c7_z
main_kernel_c7_z_h:
buffer_load_dwordx4 v[8:11], v116, s[4:7], s20 offen offset:0 sc1
buffer_load_dwordx4 v[12:15], v116, s[4:7], s20 offen offset:1024 sc1
s_sub_u32 s29, s29, 1
s_cbranch_scc1 main_kernel_end
v_add_u32 v127, 300, v127
s_waitcnt vmcnt(0)
s_branch main_kernel_c7_z_g
main_kernel_c7_sm_f:
s_waitcnt vmcnt(0) lgkmcnt(0)
buffer_load_dwordx4 v[8:11], v116, s[4:7], s20 offen offset:0 sc1
buffer_load_dwordx4 v[12:15], v116, s[4:7], s20 offen offset:1024 sc1
ds_read_b128 v[0:3], v116 offset:16384
ds_read_b128 v[4:7], v116 offset:17408
ds_read_b128 v[64:67], v116 offset:24576
ds_read_b128 v[68:71], v116 offset:28672
ds_read_b128 v[72:75], v116 offset:25600
ds_read_b128 v[76:79], v116 offset:29696
ds_read_b128 v[16:19], v116 offset:26624
ds_read_b128 v[20:23], v116 offset:30720
ds_read_b128 v[24:27], v116 offset:27648
ds_read_b128 v[28:31], v116 offset:31744
s_waitcnt vmcnt(0)
s_waitcnt lgkmcnt(0)
v_mfma_f32_16x16x32_bf16 v[80:83], v[64:67], v[0:3], 0
v_mfma_f32_16x16x32_bf16 v[84:87], v[68:71], v[0:3], 0
v_mfma_f32_16x16x32_bf16 v[92:95], v[0:3], v[0:3], 0
v_mfma_f32_16x16x32_bf16 v[80:83], v[72:75], v[4:7], v[80:83]
v_mfma_f32_16x16x32_bf16 v[84:87], v[76:79], v[4:7], v[84:87]
v_mfma_f32_16x16x32_bf16 v[92:95], v[4:7], v[4:7], v[92:95]
v_mfma_f32_16x16x32_bf16 v[0:3], v[16:19], v[8:11], v[80:83]
v_mfma_f32_16x16x32_bf16 v[4:7], v[20:23], v[8:11], v[84:87]
v_mfma_f32_16x16x32_bf16 v[88:91], v[8:11], v[8:11], v[92:95]
v_mfma_f32_16x16x32_bf16 v[0:3], v[24:27], v[12:15], v[0:3]
v_mfma_f32_16x16x32_bf16 v[4:7], v[28:31], v[12:15], v[4:7]
v_mfma_f32_16x16x32_bf16 v[88:91], v[12:15], v[12:15], v[88:91]
s_nop 7
v_mov_b32 v65, 0
v_max_f32 v126, v88, v89
v_mul_f32 v126, s30, v126
v_max3_f32 v126, v126, v0, v1
v_max3_f32 v126, v126, v2, v3
v_max3_f32 v126, v126, v4, v5
v_max3_f32 v126, v126, v6, v7
v_mov_b32 v127, v126
s_nop 1
v_permlane32_swap_b32 v126, v127
v_max_f32 v126, v126, v127
v_mov_b32 v127, v126
s_nop 1
v_permlane16_swap_b32 v126, v127
v_max_f32 v126, v126, v127
v_mul_f32 v127, 0x40faf233, v126
s_mov_b32 vcc_lo, 0xcccccccc
s_mov_b32 vcc_hi, 0xcccccccc
v_sub_f32 v0, v0, v126
v_sub_f32 v1, v1, v126
v_sub_f32 v2, v2, v126
v_sub_f32 v3, v3, v126
v_sub_f32 v4, v4, v126
v_sub_f32 v5, v5, v126
v_sub_f32 v6, v6, v126
v_sub_f32 v7, v7, v126
v_sub_f32 v88, v88, v127
v_sub_f32 v89, v89, v127
s_waitcnt lgkmcnt(0)
s_nop 0
v_mul_f32 v88, s30, v88
v_mul_f32 v89, s30, v89
v_exp_f32 v88, v88
v_exp_f32 v89, v89
v_cndmask_b32_dpp v0, v2, v0, vcc quad_perm:[2,3,2,3] row_mask:0xf bank_mask:0xf
v_cvt_pk_bf16_f32 v64, v88, v89
v_cndmask_b32_dpp v1, v3, v1, vcc quad_perm:[2,3,2,3] row_mask:0xf bank_mask:0xf
v_exp_f32 v0, v0
v_mfma_f32_16x16x16_bf16 v[16:19], v[100:101], v[64:65], 0
v_exp_f32 v1, v1
v_cndmask_b32_dpp v4, v6, v4, vcc quad_perm:[2,3,2,3] row_mask:0xf bank_mask:0xf
v_mfma_f32_16x16x16_bf16 v[8:11], v[124:125], v[64:65], 0
v_cndmask_b32_dpp v5, v7, v5, vcc quad_perm:[2,3,2,3] row_mask:0xf bank_mask:0xf
v_exp_f32 v4, v4
v_exp_f32 v5, v5
v_cvt_pk_bf16_f32 v92, v0, v1
v_cvt_pk_bf16_f32 v94, v4, v5
v_mov_b32 v80, 0
v_mov_b32_dpp v93, v92 quad_perm:[0,1,0,1] row_mask:0xf bank_mask:0xf
v_mov_b32_dpp v95, v94 quad_perm:[0,1,0,1] row_mask:0xf bank_mask:0xf
v_mov_b32 v81, 0
v_mov_b32 v82, 0
v_mfma_f32_16x16x32_bf16 v[16:19], v[100:103], v[92:95], v[16:19]
v_mov_b32 v83, 0
v_mov_b32 v84, 0
v_mfma_f32_16x16x32_bf16 v[8:11], v[96:99], v[92:95], v[8:11]
s_nop 1
v_mov_b32 v85, 0
v_mov_b32 v86, 0
v_mov_b32 v87, 0
v_rcp_f32 v126, v16
v_subrev_u32 v127, 0x21800000, v16
v_cmp_lt_u32 vcc, 0x3c000000, v127
v_pk_mul_f32 v[8:9], v[8:9], v[126:127] op_sel_hi:[1,0]
v_pk_mul_f32 v[10:11], v[10:11], v[126:127] op_sel_hi:[1,0]
s_and_b32 s32, vcc_lo, 0xcccc
v_cvt_pk_bf16_f32 v126, v8, v9
v_cvt_pk_bf16_f32 v127, v10, v11
s_andn2_b32 s35, s46, 0xff
v_bfe_u32 v123, v116, 1, 8
buffer_load_dwordx2 v[66:67], v123, s[4:7], s35 offen sc1
s_branch main_kernel_c7_ost
main_kernel_c7_o0_f:
s_nop 0
buffer_load_dwordx4 v[0:3], v116, s[4:7], s23 offen sc1
s_xor_b32 s32, s23, 1024
buffer_load_dwordx4 v[4:7], v116, s[4:7], s32 offen sc1
s_sub_u32 s29, s29, 1
s_cbranch_scc1 main_kernel_end
s_waitcnt vmcnt(0)
v_max_u32 v126, v0, v2
v_cmp_eq_u32 vcc, -1, v126
s_cbranch_vccnz main_kernel_c7_o0_f
s_branch main_kernel_c7_o0
main_kernel_c7_o1_f:
s_nop 0
s_xor_b32 s32, s23, 1024
buffer_load_dwordx4 v[4:7], v116, s[4:7], s32 offen sc1
s_xor_b32 s32, s23, 2048
buffer_load_dwordx4 v[8:11], v116, s[4:7], s32 offen sc1
s_sub_u32 s29, s29, 1
s_cbranch_scc1 main_kernel_end
s_waitcnt vmcnt(0)
v_max_u32 v126, v4, v6
v_cmp_eq_u32 vcc, -1, v126
s_cbranch_vccnz main_kernel_c7_o1_f
s_branch main_kernel_c7_o1
main_kernel_c7_o2_f:
s_nop 0
s_xor_b32 s32, s23, 2048
buffer_load_dwordx4 v[8:11], v116, s[4:7], s32 offen sc1
s_xor_b32 s32, s23, 3072
buffer_load_dwordx4 v[12:15], v116, s[4:7], s32 offen sc1
s_sub_u32 s29, s29, 1
s_cbranch_scc1 main_kernel_end
s_waitcnt vmcnt(0)
v_max_u32 v126, v8, v10
v_cmp_eq_u32 vcc, -1, v126
s_cbranch_vccnz main_kernel_c7_o2_f
s_branch main_kernel_c7_o2
main_kernel_c7_o3_f:
s_nop 0
s_xor_b32 s32, s23, 3072
buffer_load_dwordx4 v[12:15], v116, s[4:7], s32 offen sc1
s_xor_b32 s32, s23, 4096
buffer_load_dwordx4 v[16:19], v116, s[4:7], s32 offen sc1
s_sub_u32 s29, s29, 1
s_cbranch_scc1 main_kernel_end
s_waitcnt vmcnt(0)
v_max_u32 v126, v12, v14
v_cmp_eq_u32 vcc, -1, v126
s_cbranch_vccnz main_kernel_c7_o3_f
s_branch main_kernel_c7_o3
main_kernel_c7_o4_f:
s_nop 0
s_xor_b32 s32, s23, 4096
buffer_load_dwordx4 v[16:19], v116, s[4:7], s32 offen sc1
s_xor_b32 s32, s23, 5120
buffer_load_dwordx4 v[20:23], v116, s[4:7], s32 offen sc1
s_sub_u32 s29, s29, 1
s_cbranch_scc1 main_kernel_end
s_waitcnt vmcnt(0)
v_max_u32 v126, v16, v18
v_cmp_eq_u32 vcc, -1, v126
s_cbranch_vccnz main_kernel_c7_o4_f
s_branch main_kernel_c7_o4
main_kernel_c7_o5_f:
s_nop 0
s_xor_b32 s32, s23, 5120
buffer_load_dwordx4 v[20:23], v116, s[4:7], s32 offen sc1
s_xor_b32 s32, s23, 6144
buffer_load_dwordx4 v[24:27], v116, s[4:7], s32 offen sc1
s_sub_u32 s29, s29, 1
s_cbranch_scc1 main_kernel_end
s_waitcnt vmcnt(0)
v_max_u32 v126, v20, v22
v_cmp_eq_u32 vcc, -1, v126
s_cbranch_vccnz main_kernel_c7_o5_f
s_branch main_kernel_c7_o5
main_kernel_c7_o6_f:
s_nop 0
s_xor_b32 s32, s23, 6144
buffer_load_dwordx4 v[24:27], v116, s[4:7], s32 offen sc1
s_xor_b32 s32, s23, 7168
buffer_load_dwordx4 v[28:31], v116, s[4:7], s32 offen sc1
s_sub_u32 s29, s29, 1
s_cbranch_scc1 main_kernel_end
s_waitcnt vmcnt(0)
v_max_u32 v126, v24, v26
v_cmp_eq_u32 vcc, -1, v126
s_cbranch_vccnz main_kernel_c7_o6_f
s_branch main_kernel_c7_o6
main_kernel_c7_o7_f:
s_nop 0
s_xor_b32 s32, s23, 7168
buffer_load_dwordx4 v[28:31], v116, s[4:7], s32 offen sc1
s_sub_u32 s29, s29, 1
s_cbranch_scc1 main_kernel_end
s_waitcnt vmcnt(0)
v_max_u32 v126, v28, v30
v_cmp_eq_u32 vcc, -1, v126
s_cbranch_vccnz main_kernel_c7_o7_f
s_branch main_kernel_c7_o7
main_kernel_att:
s_cmp_gt_u32 s13, 1
s_cbranch_scc1 main_kernel_p_end
s_cmp_lg_u32 s14, 0
s_cbranch_scc1 main_kernel_p_bar
s_lshl_b32 s32, s13, 21
s_add_u32 s32, s32, 0x8c00000
v_lshlrev_b32 v2, 2, v250
v_mov_b32 v3, -1
s_mov_b64 s[20:21], -1
s_mov_b32 s34, 12
s_mov_b32 exec_hi, 0
s_waitcnt vmcnt(0)
main_kernel_p_lp:
s_memtime s[16:17]
s_waitcnt lgkmcnt(0)
buffer_store_dword v3, v2, s[4:7], s32 offen sc1
s_waitcnt vmcnt(0)
s_memtime s[18:19]
s_xor_b32 s32, s32, 0x2000
s_waitcnt lgkmcnt(0)
s_sub_u32 s33, s18, s16
s_min_u32 s20, s20, s33
s_memtime s[16:17]
s_waitcnt lgkmcnt(0)
buffer_store_dword v3, v2, s[4:7], s32 offen sc1
s_waitcnt vmcnt(0)
s_memtime s[18:19]
s_xor_b32 s32, s32, 0x2000
s_waitcnt lgkmcnt(0)
s_sub_u32 s33, s18, s16
s_min_u32 s21, s21, s33
s_add_u32 s32, s32, 128
s_sub_u32 s34, s34, 1
s_cmp_lg_u32 s34, 0
s_cbranch_scc1 main_kernel_p_lp
s_cmp_lt_u32 s21, s20
s_cselect_b32 s32, 3, 2
s_lshl_b32 s33, s13, 2
v_mov_b32 v3, s32
s_mov_b64 exec, 1
buffer_store_dword v3, off, s[60:63], s33 offset:16 sc1
s_mov_b64 exec, -1
main_kernel_p_bar:
s_barrier
main_kernel_p_end:
s_mov_b32 s8, s64
s_and_b32 s9, s65, 0xffff
s_mov_b32 s10, 0x200000
s_mov_b32 s11, 0x20000
s_mul_i32 s35, s13, 131072
buffer_load_dword v14, v12, s[8:11], s35 offen
s_add_u32 s35, s35, 32768
buffer_load_dword v14, v12, s[8:11], s35 offen
s_add_u32 s35, s35, 32768
buffer_load_dword v14, v12, s[8:11], s35 offen
s_add_u32 s35, s35, 32768
buffer_load_dword v14, v12, s[8:11], s35 offen
s_add_u32 s35, s35, 32768
s_mov_b32 s8, s66
s_and_b32 s9, s67, 0xffff
s_mov_b32 s10, 0x200000
s_mov_b32 s11, 0x20000
s_mul_i32 s35, s13, 131072
buffer_load_dword v14, v12, s[8:11], s35 offen
s_add_u32 s35, s35, 32768
buffer_load_dword v14, v12, s[8:11], s35 offen
s_add_u32 s35, s35, 32768
buffer_load_dword v14, v12, s[8:11], s35 offen
s_add_u32 s35, s35, 32768
buffer_load_dword v14, v12, s[8:11], s35 offen
s_add_u32 s35, s35, 32768
v_lshlrev_b32 v0, 2, v250
s_mov_b32 s32, 0x841f000
main_kernel_awf:
buffer_load_dword v2, v0, s[4:7], s32 offen sc1
s_waitcnt vmcnt(0)
v_cmp_eq_u32 vcc, 0, v2
s_cbranch_vccz main_kernel_awf_ok
s_sleep 4
s_sub_u32 s29, s29, 1
s_cbranch_scc0 main_kernel_awf
s_branch main_kernel_end
main_kernel_awf_ok:
main_kernel_att2:
s_lshl_b32 s28, s13, 1
s_lshr_b32 s31, s14, 1
s_add_u32 s28, s28, s31
s_and_b32 s30, s14, 1
v_lshlrev_b32 v204, 4, v250
v_and_b32 v200, 15, v250
v_lshrrev_b32 v201, 4, v250
v_and_b32 v202, 7, v250
v_lshl_add_u32 v202, v201, 3, v202
v_lshlrev_b32 v205, 4, v202
v_bfe_u32 v206, v204, 1, 8
v_min_u32 v207, 2, v250
v_lshlrev_b32 v207, 13, v207
s_lshl_b32 s31, s28, 2
s_sub_u32 s31, 82416, s31
s_cmp_eq_u32 s12, 7
s_cselect_b32 s25, 61, 0
s_cselect_b32 s32, 512, 0
s_sub_u32 s31, s31, s32
s_mov_b64 exec, 0xf0
v_lshl_add_u32 v207, v250, 2, s31
s_mov_b64 exec, -1
v_mov_b32 v208, 1
v_mov_b32 v209, 0
s_lshl_b32 s31, s30, 4
v_add_u32 v200, s31, v200
v_lshlrev_b32 v202, 2, v201
v_sub_u32 v200, v200, v202
v_mov_b32 v202, 0xf149f2ca
v_cmp_le_i32 vcc, 0, v200
s_nop 1
v_cndmask_b32 v124, v202, 0, vcc
v_cmp_le_i32 vcc, 1, v200
s_nop 1
v_cndmask_b32 v125, v202, 0, vcc
v_cmp_le_i32 vcc, 2, v200
s_nop 1
v_cndmask_b32 v126, v202, 0, vcc
v_cmp_le_i32 vcc, 3, v200
s_nop 1
v_cndmask_b32 v127, v202, 0, vcc
v_cmp_le_i32 vcc, 16, v200
s_nop 1
v_cndmask_b32 v128, v202, 0, vcc
v_cmp_le_i32 vcc, 17, v200
s_nop 1
v_cndmask_b32 v129, v202, 0, vcc
v_cmp_le_i32 vcc, 18, v200
s_nop 1
v_cndmask_b32 v130, v202, 0, vcc
v_cmp_le_i32 vcc, 19, v200
s_nop 1
v_cndmask_b32 v131, v202, 0, vcc
v_cmp_le_u32 vcc, 2, v201
s_nop 1
v_cndmask_b32 v132, v202, 0, vcc
v_mov_b32 v180, 0x3f803f80
v_cndmask_b32 v133, v202, 0, vcc
v_mov_b32 v181, 0x3f803f80
v_cndmask_b32 v134, v202, 0, vcc
v_mov_b32 v182, 0x3f803f80
v_cndmask_b32 v135, v202, 0, vcc
v_mov_b32 v183, 0x3f803f80
s_mov_b32 s26, 0x3e0293ee
s_mov_b32 s27, 0xbe0293ee
s_lshl_b32 s31, s28, 12
s_add_u32 s16, s31, 0x1800000
s_add_u32 s17, s16, 131072
s_lshl_b32 s32, s30, 17
s_add_u32 s31, s31, s32
s_add_u32 s15, s31, 0x800000
s_add_u32 s22, s31, 0x3800000
s_lshl_b32 s31, s28, 13
s_add_u32 s18, s31, 0x2800000
s_add_u32 s19, s18, 4096
s_lshl_b32 s31, s28, 11
s_add_u32 s20, s31, 0x8000000
s_add_u32 s21, s31, 0x6e00000
s_lshl_b32 s31, s28, 2
s_add_u32 s23, s31, 0x8404000
s_lshl_b32 s31, s28, 3
s_lshl_b32 s32, s30, 2
s_add_u32 s31, s31, s32
s_add_u32 s24, s31, 0x8400000
s_lshl_b32 s31, s30, 7
v_and_b32 v210, 7, v250
v_lshl_add_u32 v210, v210, 8, s31
s_mov_b32 s33, 0x841ec00
s_lshl_b32 s31, s25, 18
s_add_u32 s15, s15, s31
s_add_u32 s16, s16, s31
s_add_u32 s17, s17, s31
s_add_u32 s18, s18, s31
s_add_u32 s19, s19, s31
s_add_u32 s22, s22, s31
s_lshl_b32 s31, s25, 16
s_add_u32 s20, s20, s31
s_add_u32 s21, s21, s31
s_lshl_b32 s31, s25, 8
s_add_u32 s24, s24, s31
s_lshl_b32 s31, s25, 2
s_add_u32 s33, s33, s31
s_lshl_b32 s31, s25, 7
s_add_u32 s23, s23, s31
s_cmp_eq_u32 s25, 0
s_cbranch_scc1 main_kernel_a_fp
s_sub_u32 s32, s24, 1280
main_kernel_a_gp:
buffer_load_dword v200, v209, s[4:7], s32 offen sc1
s_waitcnt vmcnt(0)
v_cmp_eq_u32 vcc, 0, v200
s_and_b32 s31, vcc_lo, 1
s_cbranch_scc0 main_kernel_a_fp
s_sleep 32
s_sub_u32 s29, s29, 1
s_cbranch_scc0 main_kernel_a_gp
s_branch main_kernel_end
main_kernel_a_fp:
buffer_load_dword v200, v207, s[4:7], s23 offen sc1
s_waitcnt vmcnt(0)
v_cmp_eq_u32 vcc, 0, v200
s_and_b32 s31, vcc_lo, -1
s_cbranch_scc0 main_kernel_a_fok
s_sleep 8
s_sub_u32 s29, s29, 1
s_cbranch_scc0 main_kernel_a_fp
s_branch main_kernel_end
main_kernel_a_fok:
buffer_load_dwordx4 v[0:3], v204, s[4:7], s15 offen offset:0 sc1
buffer_load_dwordx4 v[16:19], v204, s[4:7], s16 offen offset:0 sc1
buffer_load_dwordx4 v[32:35], v204, s[4:7], s17 offen offset:0 sc1
buffer_load_dwordx4 v[4:7], v204, s[4:7], s15 offen offset:1024 sc1
buffer_load_dwordx4 v[20:23], v204, s[4:7], s16 offen offset:1024 sc1
buffer_load_dwordx4 v[36:39], v204, s[4:7], s17 offen offset:1024 sc1
buffer_load_dwordx4 v[8:11], v204, s[4:7], s15 offen offset:2048 sc1
buffer_load_dwordx4 v[24:27], v204, s[4:7], s16 offen offset:2048 sc1
buffer_load_dwordx4 v[40:43], v204, s[4:7], s17 offen offset:2048 sc1
buffer_load_dwordx4 v[12:15], v204, s[4:7], s15 offen offset:3072 sc1
buffer_load_dwordx4 v[28:31], v204, s[4:7], s16 offen offset:3072 sc1
buffer_load_dwordx4 v[44:47], v204, s[4:7], s17 offen offset:3072 sc1
v_mov_b32 v211, 0
s_mov_b64 exec, 255
buffer_atomic_add v211, v210, s[4:7], s21 offen sc0 sc1
s_mov_b64 exec, -1
buffer_load_dwordx4 v[48:51], v204, s[4:7], s18 offen offset:0 sc1
buffer_load_dwordx4 v[52:55], v204, s[4:7], s18 offen offset:1024 sc1
buffer_load_dwordx4 v[56:59], v204, s[4:7], s18 offen offset:2048 sc1
buffer_load_dwordx4 v[60:63], v204, s[4:7], s18 offen offset:3072 sc1
buffer_load_dwordx4 v[64:67], v204, s[4:7], s19 offen offset:0 sc1
buffer_load_dwordx4 v[68:71], v204, s[4:7], s19 offen offset:1024 sc1
buffer_load_dwordx4 v[72:75], v204, s[4:7], s19 offen offset:2048 sc1
buffer_load_dwordx4 v[76:79], v204, s[4:7], s19 offen offset:3072 sc1
s_waitcnt vmcnt(0)
main_kernel_a_top:
s_cmp_ge_u32 s25, 60
s_cselect_b32 s38, 2, 1
s_lshl_b32 s34, s38, 18
s_lshl_b32 s35, s38, 16
s_lshl_b32 s36, s38, 8
s_lshl_b32 s37, s38, 2
s_lshl_b32 s39, s38, 7
s_waitcnt vmcnt(19)
v_mfma_f32_16x16x32_bf16 v[112:115], v[16:19], v[0:3], v[124:127]
v_mfma_f32_16x16x32_bf16 v[116:119], v[32:35], v[0:3], v[128:131]
s_waitcnt vmcnt(16)
v_mfma_f32_16x16x32_bf16 v[112:115], v[20:23], v[4:7], v[112:115]
v_mfma_f32_16x16x32_bf16 v[116:119], v[36:39], v[4:7], v[116:119]
s_waitcnt vmcnt(13)
v_mfma_f32_16x16x32_bf16 v[112:115], v[24:27], v[8:11], v[112:115]
v_mfma_f32_16x16x32_bf16 v[116:119], v[40:43], v[8:11], v[116:119]
s_waitcnt vmcnt(10)
v_mfma_f32_16x16x32_bf16 v[112:115], v[28:31], v[12:15], v[112:115]
v_mfma_f32_16x16x32_bf16 v[116:119], v[44:47], v[12:15], v[116:119]
s_add_u32 s15, s15, s34
s_add_u32 s16, s16, s34
s_add_u32 s17, s17, s34
s_add_u32 s18, s18, s34
s_add_u32 s19, s19, s34
s_add_u32 s23, s23, s39
s_waitcnt vmcnt(9)
v_cmp_eq_u32 vcc, -1, v211
s_nop 0
v_max3_f32 v202, v112, v113, v114
s_nop 1
v_max3_f32 v202, v202, v115, v116
v_max3_f32 v202, v202, v117, v118
v_max_f32 v202, v202, v119
s_cbranch_vccz main_kernel_a_mp
s_cmp_eq_u32 s25, 99
s_cbranch_scc1 main_kernel_a_mp
main_kernel_a_pp:
v_mov_b32 v211, 0
s_mov_b64 exec, 255
buffer_atomic_add v211, v210, s[4:7], s21 offen sc0 sc1
s_mov_b64 exec, -1
s_sub_u32 s29, s29, 1
s_cbranch_scc1 main_kernel_end
s_waitcnt vmcnt(0)
v_cmp_eq_u32 vcc, -1, v211
s_cbranch_vccnz main_kernel_a_pp
main_kernel_a_mp:
buffer_load_dwordx4 v[80:83], v205, s[4:7], s20 offen offset:0 sc1
buffer_load_dwordx4 v[84:87], v205, s[4:7], s20 offen offset:512 sc1
buffer_load_dwordx4 v[88:91], v205, s[4:7], s20 offen offset:1024 sc1
buffer_load_dwordx4 v[92:95], v205, s[4:7], s20 offen offset:1536 sc1
buffer_load_dwordx2 v[96:97], v206, s[4:7], s21 offen offset:0 sc1
buffer_load_dwordx2 v[98:99], v206, s[4:7], s21 offen offset:256 sc1
buffer_load_dwordx2 v[100:101], v206, s[4:7], s21 offen offset:512 sc1
buffer_load_dwordx2 v[102:103], v206, s[4:7], s21 offen offset:768 sc1
buffer_load_dwordx2 v[104:105], v206, s[4:7], s21 offen offset:1024 sc1
buffer_load_dwordx2 v[106:107], v206, s[4:7], s21 offen offset:1280 sc1
buffer_load_dwordx2 v[108:109], v206, s[4:7], s21 offen offset:1536 sc1
buffer_load_dwordx2 v[110:111], v206, s[4:7], s21 offen offset:1792 sc1
buffer_load_dword v211, v207, s[4:7], s23 offen sc1
s_waitcnt vmcnt(12)
v_mfma_f32_16x16x32_bf16 v[120:123], v[80:83], v[0:3], v[132:135]
v_max3_u32 v200, v80, v81, v82
v_max_u32 v200, v200, v83
s_waitcnt vmcnt(11)
v_mfma_f32_16x16x32_bf16 v[120:123], v[84:87], v[4:7], v[120:123]
v_max3_u32 v200, v200, v84, v85
v_max3_u32 v200, v200, v86, v87
s_waitcnt vmcnt(10)
v_mfma_f32_16x16x32_bf16 v[120:123], v[88:91], v[8:11], v[120:123]
v_max3_u32 v200, v200, v88, v89
v_max3_u32 v200, v200, v90, v91
s_waitcnt vmcnt(9)
v_mfma_f32_16x16x32_bf16 v[120:123], v[92:95], v[12:15], v[120:123]
v_max3_u32 v200, v200, v92, v93
v_max3_u32 v200, v200, v94, v95
s_waitcnt vmcnt(7)
v_max3_u32 v200, v200, v96, v97
v_max3_u32 v200, v200, v98, v99
s_waitcnt vmcnt(5)
v_max3_u32 v200, v200, v100, v101
v_max3_u32 v200, v200, v102, v103
s_waitcnt vmcnt(3)
v_max3_u32 v200, v200, v104, v105
v_max3_u32 v200, v200, v106, v107
s_waitcnt vmcnt(1)
v_max3_u32 v200, v200, v108, v109
v_max3_u32 v200, v200, v110, v111
v_cmp_eq_u32 vcc, -1, v200
s_cbranch_vccz main_kernel_a_mok
s_sleep 1
s_sub_u32 s29, s29, 1
s_cbranch_scc0 main_kernel_a_mp
s_branch main_kernel_end
main_kernel_a_mok:
v_mul_f32 v120, s26, v120
v_mul_f32 v121, s26, v121
v_mul_f32 v122, s26, v122
v_mul_f32 v123, s26, v123
v_max3_f32 v200, v202, v120, v121
v_max3_f32 v200, v200, v122, v123
v_mov_b32 v201, v200
s_add_u32 s20, s20, s35
s_add_u32 s21, s21, s35
v_permlane32_swap_b32 v200, v201
v_max_f32 v200, v200, v201
v_mov_b32 v201, v200
s_nop 1
v_permlane16_swap_b32 v200, v201
v_max_f32 v200, v200, v201
v_sub_f32 v112, v112, v200
v_sub_f32 v113, v113, v200
v_sub_f32 v114, v114, v200
v_sub_f32 v115, v115, v200
v_sub_f32 v116, v116, v200
v_sub_f32 v117, v117, v200
v_sub_f32 v118, v118, v200
v_sub_f32 v119, v119, v200
v_sub_f32 v120, v120, v200
v_sub_f32 v121, v121, v200
v_sub_f32 v122, v122, v200
v_sub_f32 v123, v123, v200
v_exp_f32 v112, v112
v_exp_f32 v113, v113
v_exp_f32 v114, v114
v_cvt_pk_bf16_f32 v136, v112, v113
v_exp_f32 v115, v115
v_exp_f32 v116, v116
v_cvt_pk_bf16_f32 v137, v114, v115
v_exp_f32 v117, v117
v_exp_f32 v118, v118
v_cvt_pk_bf16_f32 v138, v116, v117
v_exp_f32 v119, v119
v_exp_f32 v120, v120
v_cvt_pk_bf16_f32 v139, v118, v119
v_exp_f32 v121, v121
v_exp_f32 v122, v122
v_cvt_pk_bf16_f32 v140, v120, v121
v_exp_f32 v123, v123
s_nop 0
v_cvt_pk_bf16_f32 v141, v122, v123
v_mfma_f32_16x16x32_bf16 v[144:147], v[180:183], v[136:139], 0
v_mfma_f32_16x16x32_bf16 v[148:151], v[48:51], v[136:139], 0
v_mfma_f32_16x16x16_bf16 v[144:147], v[180:181], v[140:141], v[144:147]
v_mfma_f32_16x16x32_bf16 v[152:155], v[52:55], v[136:139], 0
v_mfma_f32_16x16x32_bf16 v[156:159], v[56:59], v[136:139], 0
v_mfma_f32_16x16x32_bf16 v[160:163], v[60:63], v[136:139], 0
v_mfma_f32_16x16x32_bf16 v[164:167], v[64:67], v[136:139], 0
v_mfma_f32_16x16x32_bf16 v[168:171], v[68:71], v[136:139], 0
v_mfma_f32_16x16x32_bf16 v[172:175], v[72:75], v[136:139], 0
v_mfma_f32_16x16x32_bf16 v[176:179], v[76:79], v[136:139], 0
v_rcp_f32 v200, v144
v_mfma_f32_16x16x16_bf16 v[148:151], v[96:97], v[140:141], v[148:151]
v_mfma_f32_16x16x16_bf16 v[152:155], v[98:99], v[140:141], v[152:155]
v_mfma_f32_16x16x16_bf16 v[156:159], v[100:101], v[140:141], v[156:159]
v_mfma_f32_16x16x16_bf16 v[160:163], v[102:103], v[140:141], v[160:163]
v_mfma_f32_16x16x16_bf16 v[164:167], v[104:105], v[140:141], v[164:167]
v_mfma_f32_16x16x16_bf16 v[168:171], v[106:107], v[140:141], v[168:171]
v_mfma_f32_16x16x16_bf16 v[172:175], v[108:109], v[140:141], v[172:175]
v_mfma_f32_16x16x16_bf16 v[176:179], v[110:111], v[140:141], v[176:179]
v_mov_b32 v201, v200
s_waitcnt vmcnt(0)
v_cmp_eq_u32 vcc, 0, v211
v_pk_mul_f32 v[148:149], v[148:149], v[200:201]
v_pk_mul_f32 v[150:151], v[150:151], v[200:201]
v_pk_mul_f32 v[152:153], v[152:153], v[200:201]
v_pk_mul_f32 v[154:155], v[154:155], v[200:201]
v_cvt_pk_bf16_f32 v184, v148, v149
v_cvt_pk_bf16_f32 v185, v150, v151
v_cvt_pk_bf16_f32 v186, v152, v153
v_cvt_pk_bf16_f32 v187, v154, v155
buffer_store_dwordx4 v[184:187], v204, s[4:7], s22 offen offset:0 sc1
v_pk_mul_f32 v[156:157], v[156:157], v[200:201]
v_pk_mul_f32 v[158:159], v[158:159], v[200:201]
v_pk_mul_f32 v[160:161], v[160:161], v[200:201]
v_pk_mul_f32 v[162:163], v[162:163], v[200:201]
v_cvt_pk_bf16_f32 v188, v156, v157
v_cvt_pk_bf16_f32 v189, v158, v159
v_cvt_pk_bf16_f32 v190, v160, v161
v_cvt_pk_bf16_f32 v191, v162, v163
buffer_store_dwordx4 v[188:191], v204, s[4:7], s22 offen offset:1024 sc1
v_pk_mul_f32 v[164:165], v[164:165], v[200:201]
v_pk_mul_f32 v[166:167], v[166:167], v[200:201]
v_pk_mul_f32 v[168:169], v[168:169], v[200:201]
v_pk_mul_f32 v[170:171], v[170:171], v[200:201]
v_cvt_pk_bf16_f32 v192, v164, v165
v_cvt_pk_bf16_f32 v193, v166, v167
v_cvt_pk_bf16_f32 v194, v168, v169
v_cvt_pk_bf16_f32 v195, v170, v171
buffer_store_dwordx4 v[192:195], v204, s[4:7], s22 offen offset:2048 sc1
s_nop 0
v_pk_mul_f32 v[172:173], v[172:173], v[200:201]
v_pk_mul_f32 v[174:175], v[174:175], v[200:201]
v_pk_mul_f32 v[176:177], v[176:177], v[200:201]
v_pk_mul_f32 v[178:179], v[178:179], v[200:201]
v_cvt_pk_bf16_f32 v196, v172, v173
v_cvt_pk_bf16_f32 v197, v174, v175
v_cvt_pk_bf16_f32 v198, v176, v177
v_cvt_pk_bf16_f32 v199, v178, v179
buffer_store_dwordx4 v[196:199], v204, s[4:7], s22 offen offset:3072 sc1
s_add_u32 s22, s22, s34
s_add_u32 s33, s33, s37
s_add_u32 s25, s25, s38
s_cmp_ge_u32 s25, 64
s_cbranch_scc1 main_kernel_a_last
s_cbranch_vccnz main_kernel_a_slow
s_cmp_gt_u32 s25, 60
s_cbranch_scc1 main_kernel_a_slow
buffer_load_dwordx4 v[0:3], v204, s[4:7], s15 offen offset:0 sc1
buffer_load_dwordx4 v[16:19], v204, s[4:7], s16 offen offset:0 sc1
buffer_load_dwordx4 v[32:35], v204, s[4:7], s17 offen offset:0 sc1
buffer_load_dwordx4 v[4:7], v204, s[4:7], s15 offen offset:1024 sc1
buffer_load_dwordx4 v[20:23], v204, s[4:7], s16 offen offset:1024 sc1
buffer_load_dwordx4 v[36:39], v204, s[4:7], s17 offen offset:1024 sc1
buffer_load_dwordx4 v[8:11], v204, s[4:7], s15 offen offset:2048 sc1
buffer_load_dwordx4 v[24:27], v204, s[4:7], s16 offen offset:2048 sc1
buffer_load_dwordx4 v[40:43], v204, s[4:7], s17 offen offset:2048 sc1
buffer_load_dwordx4 v[12:15], v204, s[4:7], s15 offen offset:3072 sc1
buffer_load_dwordx4 v[28:31], v204, s[4:7], s16 offen offset:3072 sc1
buffer_load_dwordx4 v[44:47], v204, s[4:7], s17 offen offset:3072 sc1
v_mov_b32 v211, 0
s_mov_b64 exec, 255
buffer_atomic_add v211, v210, s[4:7], s21 offen sc0 sc1
s_mov_b64 exec, -1
buffer_load_dwordx4 v[48:51], v204, s[4:7], s18 offen offset:0 sc1
buffer_load_dwordx4 v[52:55], v204, s[4:7], s18 offen offset:1024 sc1
buffer_load_dwordx4 v[56:59], v204, s[4:7], s18 offen offset:2048 sc1
buffer_load_dwordx4 v[60:63], v204, s[4:7], s18 offen offset:3072 sc1
buffer_load_dwordx4 v[64:67], v204, s[4:7], s19 offen offset:0 sc1
buffer_load_dwordx4 v[68:71], v204, s[4:7], s19 offen offset:1024 sc1
buffer_load_dwordx4 v[72:75], v204, s[4:7], s19 offen offset:2048 sc1
buffer_load_dwordx4 v[76:79], v204, s[4:7], s19 offen offset:3072 sc1
s_waitcnt vmcnt(21)
s_mov_b64 exec, 1
buffer_store_dword v208, v209, s[4:7], s24 offen sc1
s_mov_b64 exec, -1
s_add_u32 s24, s24, s36
s_branch main_kernel_a_top
main_kernel_a_slow:
s_waitcnt vmcnt(0)
s_mov_b64 exec, 1
buffer_store_dword v208, v209, s[4:7], s24 offen sc1
s_mov_b64 exec, -1
s_add_u32 s24, s24, s36
s_branch main_kernel_a_fp
main_kernel_a_last:
s_waitcnt vmcnt(0)
s_mov_b64 exec, 1
buffer_store_dword v208, v209, s[4:7], s24 offen sc1
s_mov_b64 exec, -1
s_add_u32 s24, s24, s36
s_branch main_kernel_end
main_kernel_wo:
s_mov_b32 s8, s46
s_and_b32 s9, s47, 0xffff
s_mov_b32 s10, 0x800000
s_mov_b32 s11, 0x20000
v_lshlrev_b32 v170, 4, v250
s_lshr_b32 s23, s12, 2
s_sub_u32 s21, s12, 5
s_cselect_b32 s23, s23, s21
s_cselect_b32 s18, 44, 63
v_lshrrev_b32 v178, 2, v250
v_and_b32 v179, 3, v250
v_lshlrev_b32 v0, 11, v178
v_lshl_add_u32 v0, v179, 4, v0
s_lshl_b32 s19, s14, 15
v_lshl_add_u32 v1, v178, 6, s19
v_lshl_add_u32 v1, v179, 3, v1
s_lshl_b32 s20, s14, 21
s_lshl_b32 s21, s13, 6
s_add_u32 s20, s20, s21
s_add_u32 s21, s20, 0x0
s_add_u32 m0, s19, 0
s_nop 0
buffer_load_dwordx4 v0, s[8:11], s21 offen lds
s_add_u32 s21, s20, 0x8000
s_add_u32 m0, s19, 1024
s_nop 0
buffer_load_dwordx4 v0, s[8:11], s21 offen lds
s_add_u32 s21, s20, 0x10000
s_add_u32 m0, s19, 2048
s_nop 0
buffer_load_dwordx4 v0, s[8:11], s21 offen lds
s_add_u32 s21, s20, 0x18000
s_add_u32 m0, s19, 3072
s_nop 0
buffer_load_dwordx4 v0, s[8:11], s21 offen lds
s_add_u32 s21, s20, 0x20000
s_add_u32 m0, s19, 4096
s_nop 0
buffer_load_dwordx4 v0, s[8:11], s21 offen lds
s_add_u32 s21, s20, 0x28000
s_add_u32 m0, s19, 5120
s_nop 0
buffer_load_dwordx4 v0, s[8:11], s21 offen lds
s_add_u32 s21, s20, 0x30000
s_add_u32 m0, s19, 6144
s_nop 0
buffer_load_dwordx4 v0, s[8:11], s21 offen lds
s_add_u32 s21, s20, 0x38000
s_add_u32 m0, s19, 7168
s_nop 0
buffer_load_dwordx4 v0, s[8:11], s21 offen lds
s_add_u32 s21, s20, 0x40000
s_add_u32 m0, s19, 8192
s_nop 0
buffer_load_dwordx4 v0, s[8:11], s21 offen lds
s_add_u32 s21, s20, 0x48000
s_add_u32 m0, s19, 9216
s_nop 0
buffer_load_dwordx4 v0, s[8:11], s21 offen lds
s_add_u32 s21, s20, 0x50000
s_add_u32 m0, s19, 10240
s_nop 0
buffer_load_dwordx4 v0, s[8:11], s21 offen lds
s_add_u32 s21, s20, 0x58000
s_add_u32 m0, s19, 11264
s_nop 0
buffer_load_dwordx4 v0, s[8:11], s21 offen lds
s_add_u32 s21, s20, 0x60000
s_add_u32 m0, s19, 12288
s_nop 0
buffer_load_dwordx4 v0, s[8:11], s21 offen lds
s_add_u32 s21, s20, 0x68000
s_add_u32 m0, s19, 13312
s_nop 0
buffer_load_dwordx4 v0, s[8:11], s21 offen lds
s_add_u32 s21, s20, 0x70000
s_add_u32 m0, s19, 14336
s_nop 0
buffer_load_dwordx4 v0, s[8:11], s21 offen lds
s_add_u32 s21, s20, 0x78000
s_add_u32 m0, s19, 15360
s_nop 0
buffer_load_dwordx4 v0, s[8:11], s21 offen lds
s_add_u32 s21, s20, 0x80000
s_add_u32 m0, s19, 16384
s_nop 0
buffer_load_dwordx4 v0, s[8:11], s21 offen lds
s_add_u32 s21, s20, 0x88000
s_add_u32 m0, s19, 17408
s_nop 0
buffer_load_dwordx4 v0, s[8:11], s21 offen lds
s_add_u32 s21, s20, 0x90000
s_add_u32 m0, s19, 18432
s_nop 0
buffer_load_dwordx4 v0, s[8:11], s21 offen lds
s_add_u32 s21, s20, 0x98000
s_add_u32 m0, s19, 19456
s_nop 0
buffer_load_dwordx4 v0, s[8:11], s21 offen lds
s_add_u32 s21, s20, 0xa0000
s_add_u32 m0, s19, 20480
s_nop 0
buffer_load_dwordx4 v0, s[8:11], s21 offen lds
s_add_u32 s21, s20, 0xa8000
s_add_u32 m0, s19, 21504
s_nop 0
buffer_load_dwordx4 v0, s[8:11], s21 offen lds
s_add_u32 s21, s20, 0xb0000
s_add_u32 m0, s19, 22528
s_nop 0
buffer_load_dwordx4 v0, s[8:11], s21 offen lds
s_add_u32 s21, s20, 0xb8000
s_add_u32 m0, s19, 23552
s_nop 0
buffer_load_dwordx4 v0, s[8:11], s21 offen lds
s_add_u32 s21, s20, 0xc0000
s_add_u32 m0, s19, 24576
s_nop 0
buffer_load_dwordx4 v0, s[8:11], s21 offen lds
s_add_u32 s21, s20, 0xc8000
s_add_u32 m0, s19, 25600
s_nop 0
buffer_load_dwordx4 v0, s[8:11], s21 offen lds
s_add_u32 s21, s20, 0xd0000
s_add_u32 m0, s19, 26624
s_nop 0
buffer_load_dwordx4 v0, s[8:11], s21 offen lds
s_add_u32 s21, s20, 0xd8000
s_add_u32 m0, s19, 27648
s_nop 0
buffer_load_dwordx4 v0, s[8:11], s21 offen lds
s_add_u32 s21, s20, 0xe0000
s_add_u32 m0, s19, 28672
s_nop 0
buffer_load_dwordx4 v0, s[8:11], s21 offen lds
s_add_u32 s21, s20, 0xe8000
s_add_u32 m0, s19, 29696
s_nop 0
buffer_load_dwordx4 v0, s[8:11], s21 offen lds
s_add_u32 s21, s20, 0xf0000
s_add_u32 m0, s19, 30720
s_nop 0
buffer_load_dwordx4 v0, s[8:11], s21 offen lds
s_add_u32 s21, s20, 0xf8000
s_add_u32 m0, s19, 31744
s_nop 0
buffer_load_dwordx4 v0, s[8:11], s21 offen lds
v_and_b32 v178, 15, v250
v_lshrrev_b32 v179, 4, v250
v_lshlrev_b32 v175, 11, v178
v_lshl_add_u32 v175, v179, 3, v175
s_lshl_b32 s21, s14, 11
s_add_u32 s21, s21, 131072
v_add_u32 v176, s21, v170
s_lshl_b32 s21, s14, 10
s_add_u32 s21, s21, 131072
v_add_u32 v177, s21, v170
s_lshr_b32 s21, s13, 2
s_lshl_b32 s21, s21, 2
s_add_u32 s21, s21, 0x8412000
s_lshl_b32 s22, s18, 7
s_add_u32 s21, s22, s21
v_mov_b32 v172, s21
v_mov_b32 v173, 128
s_lshl_b32 s21, s14, 4
s_add_u32 s21, s21, s23
s_lshl_b32 s21, s21, 2
s_add_u32 s21, s21, 0x8400000
s_lshl_b32 s22, s18, 8
s_add_u32 s21, s21, s22
s_mov_b64 exec, 0xff
v_lshl_add_u32 v172, v250, 3, s21
v_mov_b32 v173, 0x100
s_mov_b64 exec, -1
s_lshl_b32 s15, s14, 15
s_lshl_b32 s21, s23, 17
s_add_u32 s15, s15, s21
s_add_u32 s15, s15, 0x3800000
s_lshl_b32 s21, s18, 18
s_add_u32 s15, s15, s21
s_lshl_b32 s21, s23, 15
s_lshl_b32 s22, s18, 16
s_add_u32 s21, s21, s22
s_and_b32 s22, s14, 1
s_lshl_b32 s16, s13, 1
s_add_u32 s16, s16, s22
s_lshl_b32 s16, s16, 5
s_add_u32 s16, s16, s21
s_lshl_b32 s17, s13, 7
s_add_u32 s17, s17, s22
s_lshl_b32 s17, s17, 3
s_add_u32 s17, s17, s21
s_add_u32 s17, s17, 0x6400000
s_waitcnt vmcnt(24)
ds_read_b64_tr_b16 a[0:1], v1 offset:0
ds_read_b64_tr_b16 a[2:3], v1 offset:1024
ds_read_b64_tr_b16 a[128:129], v1 offset:32
ds_read_b64_tr_b16 a[130:131], v1 offset:1056
ds_read_b64_tr_b16 a[4:5], v1 offset:2048
ds_read_b64_tr_b16 a[6:7], v1 offset:3072
ds_read_b64_tr_b16 a[132:133], v1 offset:2080
ds_read_b64_tr_b16 a[134:135], v1 offset:3104
ds_read_b64_tr_b16 a[8:9], v1 offset:4096
ds_read_b64_tr_b16 a[10:11], v1 offset:5120
ds_read_b64_tr_b16 a[136:137], v1 offset:4128
ds_read_b64_tr_b16 a[138:139], v1 offset:5152
ds_read_b64_tr_b16 a[12:13], v1 offset:6144
ds_read_b64_tr_b16 a[14:15], v1 offset:7168
ds_read_b64_tr_b16 a[140:141], v1 offset:6176
ds_read_b64_tr_b16 a[142:143], v1 offset:7200
s_waitcnt lgkmcnt(0)
s_add_u32 s21, s20, 0x100000
s_add_u32 m0, s19, 0
s_nop 0
buffer_load_dwordx4 v0, s[8:11], s21 offen lds
s_add_u32 s21, s20, 0x108000
s_add_u32 m0, s19, 1024
s_nop 0
buffer_load_dwordx4 v0, s[8:11], s21 offen lds
s_add_u32 s21, s20, 0x110000
s_add_u32 m0, s19, 2048
s_nop 0
buffer_load_dwordx4 v0, s[8:11], s21 offen lds
s_add_u32 s21, s20, 0x118000
s_add_u32 m0, s19, 3072
s_nop 0
buffer_load_dwordx4 v0, s[8:11], s21 offen lds
s_add_u32 s21, s20, 0x120000
s_add_u32 m0, s19, 4096
s_nop 0
buffer_load_dwordx4 v0, s[8:11], s21 offen lds
s_add_u32 s21, s20, 0x128000
s_add_u32 m0, s19, 5120
s_nop 0
buffer_load_dwordx4 v0, s[8:11], s21 offen lds
s_add_u32 s21, s20, 0x130000
s_add_u32 m0, s19, 6144
s_nop 0
buffer_load_dwordx4 v0, s[8:11], s21 offen lds
s_add_u32 s21, s20, 0x138000
s_add_u32 m0, s19, 7168
s_nop 0
buffer_load_dwordx4 v0, s[8:11], s21 offen lds
s_waitcnt vmcnt(24)
ds_read_b64_tr_b16 a[16:17], v1 offset:8192
ds_read_b64_tr_b16 a[18:19], v1 offset:9216
ds_read_b64_tr_b16 a[144:145], v1 offset:8224
ds_read_b64_tr_b16 a[146:147], v1 offset:9248
ds_read_b64_tr_b16 a[20:21], v1 offset:10240
ds_read_b64_tr_b16 a[22:23], v1 offset:11264
ds_read_b64_tr_b16 a[148:149], v1 offset:10272
ds_read_b64_tr_b16 a[150:151], v1 offset:11296
ds_read_b64_tr_b16 a[24:25], v1 offset:12288
ds_read_b64_tr_b16 a[26:27], v1 offset:13312
ds_read_b64_tr_b16 a[152:153], v1 offset:12320
ds_read_b64_tr_b16 a[154:155], v1 offset:13344
ds_read_b64_tr_b16 a[28:29], v1 offset:14336
ds_read_b64_tr_b16 a[30:31], v1 offset:15360
ds_read_b64_tr_b16 a[156:157], v1 offset:14368
ds_read_b64_tr_b16 a[158:159], v1 offset:15392
s_waitcnt lgkmcnt(0)
s_add_u32 s21, s20, 0x140000
s_add_u32 m0, s19, 8192
s_nop 0
buffer_load_dwordx4 v0, s[8:11], s21 offen lds
s_add_u32 s21, s20, 0x148000
s_add_u32 m0, s19, 9216
s_nop 0
buffer_load_dwordx4 v0, s[8:11], s21 offen lds
s_add_u32 s21, s20, 0x150000
s_add_u32 m0, s19, 10240
s_nop 0
buffer_load_dwordx4 v0, s[8:11], s21 offen lds
s_add_u32 s21, s20, 0x158000
s_add_u32 m0, s19, 11264
s_nop 0
buffer_load_dwordx4 v0, s[8:11], s21 offen lds
s_add_u32 s21, s20, 0x160000
s_add_u32 m0, s19, 12288
s_nop 0
buffer_load_dwordx4 v0, s[8:11], s21 offen lds
s_add_u32 s21, s20, 0x168000
s_add_u32 m0, s19, 13312
s_nop 0
buffer_load_dwordx4 v0, s[8:11], s21 offen lds
s_add_u32 s21, s20, 0x170000
s_add_u32 m0, s19, 14336
s_nop 0
buffer_load_dwordx4 v0, s[8:11], s21 offen lds
s_add_u32 s21, s20, 0x178000
s_add_u32 m0, s19, 15360
s_nop 0
buffer_load_dwordx4 v0, s[8:11], s21 offen lds
s_waitcnt vmcnt(24)
ds_read_b64_tr_b16 a[32:33], v1 offset:16384
ds_read_b64_tr_b16 a[34:35], v1 offset:17408
ds_read_b64_tr_b16 a[160:161], v1 offset:16416
ds_read_b64_tr_b16 a[162:163], v1 offset:17440
ds_read_b64_tr_b16 a[36:37], v1 offset:18432
ds_read_b64_tr_b16 a[38:39], v1 offset:19456
ds_read_b64_tr_b16 a[164:165], v1 offset:18464
ds_read_b64_tr_b16 a[166:167], v1 offset:19488
ds_read_b64_tr_b16 a[40:41], v1 offset:20480
ds_read_b64_tr_b16 a[42:43], v1 offset:21504
ds_read_b64_tr_b16 a[168:169], v1 offset:20512
ds_read_b64_tr_b16 a[170:171], v1 offset:21536
ds_read_b64_tr_b16 a[44:45], v1 offset:22528
ds_read_b64_tr_b16 a[46:47], v1 offset:23552
ds_read_b64_tr_b16 a[172:173], v1 offset:22560
ds_read_b64_tr_b16 a[174:175], v1 offset:23584
s_waitcnt lgkmcnt(0)
s_add_u32 s21, s20, 0x180000
s_add_u32 m0, s19, 16384
s_nop 0
buffer_load_dwordx4 v0, s[8:11], s21 offen lds
s_add_u32 s21, s20, 0x188000
s_add_u32 m0, s19, 17408
s_nop 0
buffer_load_dwordx4 v0, s[8:11], s21 offen lds
s_add_u32 s21, s20, 0x190000
s_add_u32 m0, s19, 18432
s_nop 0
buffer_load_dwordx4 v0, s[8:11], s21 offen lds
s_add_u32 s21, s20, 0x198000
s_add_u32 m0, s19, 19456
s_nop 0
buffer_load_dwordx4 v0, s[8:11], s21 offen lds
s_add_u32 s21, s20, 0x1a0000
s_add_u32 m0, s19, 20480
s_nop 0
buffer_load_dwordx4 v0, s[8:11], s21 offen lds
s_add_u32 s21, s20, 0x1a8000
s_add_u32 m0, s19, 21504
s_nop 0
buffer_load_dwordx4 v0, s[8:11], s21 offen lds
s_add_u32 s21, s20, 0x1b0000
s_add_u32 m0, s19, 22528
s_nop 0
buffer_load_dwordx4 v0, s[8:11], s21 offen lds
s_add_u32 s21, s20, 0x1b8000
s_add_u32 m0, s19, 23552
s_nop 0
buffer_load_dwordx4 v0, s[8:11], s21 offen lds
s_waitcnt vmcnt(24)
ds_read_b64_tr_b16 a[48:49], v1 offset:24576
ds_read_b64_tr_b16 a[50:51], v1 offset:25600
ds_read_b64_tr_b16 a[176:177], v1 offset:24608
ds_read_b64_tr_b16 a[178:179], v1 offset:25632
ds_read_b64_tr_b16 a[52:53], v1 offset:26624
ds_read_b64_tr_b16 a[54:55], v1 offset:27648
ds_read_b64_tr_b16 a[180:181], v1 offset:26656
ds_read_b64_tr_b16 a[182:183], v1 offset:27680
ds_read_b64_tr_b16 a[56:57], v1 offset:28672
ds_read_b64_tr_b16 a[58:59], v1 offset:29696
ds_read_b64_tr_b16 a[184:185], v1 offset:28704
ds_read_b64_tr_b16 a[186:187], v1 offset:29728
ds_read_b64_tr_b16 a[60:61], v1 offset:30720
ds_read_b64_tr_b16 a[62:63], v1 offset:31744
ds_read_b64_tr_b16 a[188:189], v1 offset:30752
ds_read_b64_tr_b16 a[190:191], v1 offset:31776
s_waitcnt lgkmcnt(0)
s_add_u32 s21, s20, 0x1c0000
s_add_u32 m0, s19, 24576
s_nop 0
buffer_load_dwordx4 v0, s[8:11], s21 offen lds
s_add_u32 s21, s20, 0x1c8000
s_add_u32 m0, s19, 25600
s_nop 0
buffer_load_dwordx4 v0, s[8:11], s21 offen lds
s_add_u32 s21, s20, 0x1d0000
s_add_u32 m0, s19, 26624
s_nop 0
buffer_load_dwordx4 v0, s[8:11], s21 offen lds
s_add_u32 s21, s20, 0x1d8000
s_add_u32 m0, s19, 27648
s_nop 0
buffer_load_dwordx4 v0, s[8:11], s21 offen lds
s_add_u32 s21, s20, 0x1e0000
s_add_u32 m0, s19, 28672
s_nop 0
buffer_load_dwordx4 v0, s[8:11], s21 offen lds
s_add_u32 s21, s20, 0x1e8000
s_add_u32 m0, s19, 29696
s_nop 0
buffer_load_dwordx4 v0, s[8:11], s21 offen lds
s_add_u32 s21, s20, 0x1f0000
s_add_u32 m0, s19, 30720
s_nop 0
buffer_load_dwordx4 v0, s[8:11], s21 offen lds
s_add_u32 s21, s20, 0x1f8000
s_add_u32 m0, s19, 31744
s_nop 0
buffer_load_dwordx4 v0, s[8:11], s21 offen lds
s_waitcnt vmcnt(24)
ds_read_b64_tr_b16 a[64:65], v1 offset:0
ds_read_b64_tr_b16 a[66:67], v1 offset:1024
ds_read_b64_tr_b16 a[192:193], v1 offset:32
ds_read_b64_tr_b16 a[194:195], v1 offset:1056
ds_read_b64_tr_b16 a[68:69], v1 offset:2048
ds_read_b64_tr_b16 a[70:71], v1 offset:3072
ds_read_b64_tr_b16 a[196:197], v1 offset:2080
ds_read_b64_tr_b16 a[198:199], v1 offset:3104
ds_read_b64_tr_b16 a[72:73], v1 offset:4096
ds_read_b64_tr_b16 a[74:75], v1 offset:5120
ds_read_b64_tr_b16 a[200:201], v1 offset:4128
ds_read_b64_tr_b16 a[202:203], v1 offset:5152
ds_read_b64_tr_b16 a[76:77], v1 offset:6144
ds_read_b64_tr_b16 a[78:79], v1 offset:7168
ds_read_b64_tr_b16 a[204:205], v1 offset:6176
ds_read_b64_tr_b16 a[206:207], v1 offset:7200
s_waitcnt lgkmcnt(0)
s_waitcnt vmcnt(16)
ds_read_b64_tr_b16 a[80:81], v1 offset:8192
ds_read_b64_tr_b16 a[82:83], v1 offset:9216
ds_read_b64_tr_b16 a[208:209], v1 offset:8224
ds_read_b64_tr_b16 a[210:211], v1 offset:9248
ds_read_b64_tr_b16 a[84:85], v1 offset:10240
ds_read_b64_tr_b16 a[86:87], v1 offset:11264
ds_read_b64_tr_b16 a[212:213], v1 offset:10272
ds_read_b64_tr_b16 a[214:215], v1 offset:11296
ds_read_b64_tr_b16 a[88:89], v1 offset:12288
ds_read_b64_tr_b16 a[90:91], v1 offset:13312
ds_read_b64_tr_b16 a[216:217], v1 offset:12320
ds_read_b64_tr_b16 a[218:219], v1 offset:13344
ds_read_b64_tr_b16 a[92:93], v1 offset:14336
ds_read_b64_tr_b16 a[94:95], v1 offset:15360
ds_read_b64_tr_b16 a[220:221], v1 offset:14368
ds_read_b64_tr_b16 a[222:223], v1 offset:15392
s_waitcnt lgkmcnt(0)
s_waitcnt vmcnt(8)
ds_read_b64_tr_b16 a[96:97], v1 offset:16384
ds_read_b64_tr_b16 a[98:99], v1 offset:17408
ds_read_b64_tr_b16 a[224:225], v1 offset:16416
ds_read_b64_tr_b16 a[226:227], v1 offset:17440
ds_read_b64_tr_b16 a[100:101], v1 offset:18432
ds_read_b64_tr_b16 a[102:103], v1 offset:19456
ds_read_b64_tr_b16 a[228:229], v1 offset:18464
ds_read_b64_tr_b16 a[230:231], v1 offset:19488
ds_read_b64_tr_b16 a[104:105], v1 offset:20480
ds_read_b64_tr_b16 a[106:107], v1 offset:21504
ds_read_b64_tr_b16 a[232:233], v1 offset:20512
ds_read_b64_tr_b16 a[234:235], v1 offset:21536
ds_read_b64_tr_b16 a[108:109], v1 offset:22528
ds_read_b64_tr_b16 a[110:111], v1 offset:23552
ds_read_b64_tr_b16 a[236:237], v1 offset:22560
ds_read_b64_tr_b16 a[238:239], v1 offset:23584
s_waitcnt lgkmcnt(0)
s_waitcnt vmcnt(0)
ds_read_b64_tr_b16 a[112:113], v1 offset:24576
ds_read_b64_tr_b16 a[114:115], v1 offset:25600
ds_read_b64_tr_b16 a[240:241], v1 offset:24608
ds_read_b64_tr_b16 a[242:243], v1 offset:25632
ds_read_b64_tr_b16 a[116:117], v1 offset:26624
ds_read_b64_tr_b16 a[118:119], v1 offset:27648
ds_read_b64_tr_b16 a[244:245], v1 offset:26656
ds_read_b64_tr_b16 a[246:247], v1 offset:27680
ds_read_b64_tr_b16 a[120:121], v1 offset:28672
ds_read_b64_tr_b16 a[122:123], v1 offset:29696
ds_read_b64_tr_b16 a[248:249], v1 offset:28704
ds_read_b64_tr_b16 a[250:251], v1 offset:29728
ds_read_b64_tr_b16 a[124:125], v1 offset:30720
ds_read_b64_tr_b16 a[126:127], v1 offset:31744
ds_read_b64_tr_b16 a[252:253], v1 offset:30752
ds_read_b64_tr_b16 a[254:255], v1 offset:31776
s_waitcnt lgkmcnt(0)
s_cmp_lt_u32 s12, 5
s_cbranch_scc1 main_kernel_o_top
v_mul_u32_u24 v178, 2, v173
v_sub_u32 v171, v172, v178
main_kernel_o_gp:
buffer_load_dword v174, v171, s[4:7], 0 offen sc1
s_waitcnt vmcnt(0)
v_cmp_eq_u32 vcc, 0, v174
s_cbranch_vccz main_kernel_o_top
s_sleep 32
s_sub_u32 s29, s29, 1
s_cbranch_scc0 main_kernel_o_gp
s_branch main_kernel_end
main_kernel_o_top:
buffer_load_dword v174, v172, s[4:7], 0 offen sc1
s_waitcnt vmcnt(0)
v_cmp_eq_u32 vcc, 0, v174
s_cbranch_vccz main_kernel_o_go
s_sleep 1
s_sub_u32 s29, s29, 1
s_cbranch_scc0 main_kernel_o_top
s_branch main_kernel_end
main_kernel_o_go:
buffer_load_dwordx4 v[0:3], v170, s[4:7], s15 offen offset:0 sc1
buffer_load_dwordx4 v[4:7], v170, s[4:7], s15 offen offset:1024 sc1
buffer_load_dwordx4 v[8:11], v170, s[4:7], s15 offen offset:2048 sc1
buffer_load_dwordx4 v[12:15], v170, s[4:7], s15 offen offset:3072 sc1
s_add_u32 s15, s15, 4096
buffer_load_dwordx4 v[16:19], v170, s[4:7], s15 offen offset:0 sc1
buffer_load_dwordx4 v[20:23], v170, s[4:7], s15 offen offset:1024 sc1
buffer_load_dwordx4 v[24:27], v170, s[4:7], s15 offen offset:2048 sc1
buffer_load_dwordx4 v[28:31], v170, s[4:7], s15 offen offset:3072 sc1
s_add_u32 s15, s15, 4096
buffer_load_dwordx4 v[32:35], v170, s[4:7], s15 offen offset:0 sc1
buffer_load_dwordx4 v[36:39], v170, s[4:7], s15 offen offset:1024 sc1
buffer_load_dwordx4 v[40:43], v170, s[4:7], s15 offen offset:2048 sc1
buffer_load_dwordx4 v[44:47], v170, s[4:7], s15 offen offset:3072 sc1
s_add_u32 s15, s15, 4096
buffer_load_dwordx4 v[48:51], v170, s[4:7], s15 offen offset:0 sc1
buffer_load_dwordx4 v[52:55], v170, s[4:7], s15 offen offset:1024 sc1
buffer_load_dwordx4 v[56:59], v170, s[4:7], s15 offen offset:2048 sc1
buffer_load_dwordx4 v[60:63], v170, s[4:7], s15 offen offset:3072 sc1
s_add_u32 s15, s15, 4096
buffer_load_dwordx2 v[160:161], v175, s[96:99], s16 offen
buffer_load_dwordx2 v[162:163], v170, s[4:7], s17 offen sc1
buffer_load_dwordx4 v[64:67], v170, s[4:7], s15 offen offset:0 sc1
buffer_load_dwordx4 v[68:71], v170, s[4:7], s15 offen offset:1024 sc1
buffer_load_dwordx4 v[72:75], v170, s[4:7], s15 offen offset:2048 sc1
buffer_load_dwordx4 v[76:79], v170, s[4:7], s15 offen offset:3072 sc1
s_add_u32 s15, s15, 4096
buffer_load_dwordx4 v[80:83], v170, s[4:7], s15 offen offset:0 sc1
buffer_load_dwordx4 v[84:87], v170, s[4:7], s15 offen offset:1024 sc1
buffer_load_dwordx4 v[88:91], v170, s[4:7], s15 offen offset:2048 sc1
buffer_load_dwordx4 v[92:95], v170, s[4:7], s15 offen offset:3072 sc1
s_add_u32 s15, s15, 4096
buffer_load_dwordx4 v[96:99], v170, s[4:7], s15 offen offset:0 sc1
buffer_load_dwordx4 v[100:103], v170, s[4:7], s15 offen offset:1024 sc1
buffer_load_dwordx4 v[104:107], v170, s[4:7], s15 offen offset:2048 sc1
buffer_load_dwordx4 v[108:111], v170, s[4:7], s15 offen offset:3072 sc1
s_add_u32 s15, s15, 4096
buffer_load_dwordx4 v[112:115], v170, s[4:7], s15 offen offset:0 sc1
buffer_load_dwordx4 v[116:119], v170, s[4:7], s15 offen offset:1024 sc1
buffer_load_dwordx4 v[120:123], v170, s[4:7], s15 offen offset:2048 sc1
buffer_load_dwordx4 v[124:127], v170, s[4:7], s15 offen offset:3072 sc1
s_add_u32 s15, s15, 233472
v_add_u32 v172, v172, v173
s_add_u32 s17, s17, 65536
s_add_u32 s18, s18, 1
s_waitcnt vmcnt(33)
v_mfma_f32_16x16x32_bf16 v[128:131], a[0:3], v[0:3], 0
v_mfma_f32_16x16x32_bf16 v[132:135], a[128:131], v[0:3], 0
s_waitcnt vmcnt(32)
v_mfma_f32_16x16x32_bf16 v[128:131], a[4:7], v[4:7], v[128:131]
v_mfma_f32_16x16x32_bf16 v[132:135], a[132:135], v[4:7], v[132:135]
s_waitcnt vmcnt(31)
v_mfma_f32_16x16x32_bf16 v[128:131], a[8:11], v[8:11], v[128:131]
v_mfma_f32_16x16x32_bf16 v[132:135], a[136:139], v[8:11], v[132:135]
s_waitcnt vmcnt(30)
v_mfma_f32_16x16x32_bf16 v[128:131], a[12:15], v[12:15], v[128:131]
v_mfma_f32_16x16x32_bf16 v[132:135], a[140:143], v[12:15], v[132:135]
s_waitcnt vmcnt(29)
v_mfma_f32_16x16x32_bf16 v[128:131], a[16:19], v[16:19], v[128:131]
v_mfma_f32_16x16x32_bf16 v[132:135], a[144:147], v[16:19], v[132:135]
s_waitcnt vmcnt(28)
v_mfma_f32_16x16x32_bf16 v[128:131], a[20:23], v[20:23], v[128:131]
v_mfma_f32_16x16x32_bf16 v[132:135], a[148:151], v[20:23], v[132:135]
s_waitcnt vmcnt(27)
v_mfma_f32_16x16x32_bf16 v[128:131], a[24:27], v[24:27], v[128:131]
v_mfma_f32_16x16x32_bf16 v[132:135], a[152:155], v[24:27], v[132:135]
s_waitcnt vmcnt(26)
v_mfma_f32_16x16x32_bf16 v[128:131], a[28:31], v[28:31], v[128:131]
v_mfma_f32_16x16x32_bf16 v[132:135], a[156:159], v[28:31], v[132:135]
s_waitcnt vmcnt(25)
v_mfma_f32_16x16x32_bf16 v[128:131], a[32:35], v[32:35], v[128:131]
v_mfma_f32_16x16x32_bf16 v[132:135], a[160:163], v[32:35], v[132:135]
s_waitcnt vmcnt(24)
v_mfma_f32_16x16x32_bf16 v[128:131], a[36:39], v[36:39], v[128:131]
v_mfma_f32_16x16x32_bf16 v[132:135], a[164:167], v[36:39], v[132:135]
s_waitcnt vmcnt(23)
v_mfma_f32_16x16x32_bf16 v[128:131], a[40:43], v[40:43], v[128:131]
v_mfma_f32_16x16x32_bf16 v[132:135], a[168:171], v[40:43], v[132:135]
s_waitcnt vmcnt(22)
v_mfma_f32_16x16x32_bf16 v[128:131], a[44:47], v[44:47], v[128:131]
v_mfma_f32_16x16x32_bf16 v[132:135], a[172:175], v[44:47], v[132:135]
s_waitcnt vmcnt(21)
v_mfma_f32_16x16x32_bf16 v[128:131], a[48:51], v[48:51], v[128:131]
v_mfma_f32_16x16x32_bf16 v[132:135], a[176:179], v[48:51], v[132:135]
s_waitcnt vmcnt(20)
v_mfma_f32_16x16x32_bf16 v[128:131], a[52:55], v[52:55], v[128:131]
v_mfma_f32_16x16x32_bf16 v[132:135], a[180:183], v[52:55], v[132:135]
s_waitcnt vmcnt(19)
v_mfma_f32_16x16x32_bf16 v[128:131], a[56:59], v[56:59], v[128:131]
v_mfma_f32_16x16x32_bf16 v[132:135], a[184:187], v[56:59], v[132:135]
s_waitcnt vmcnt(18)
v_mfma_f32_16x16x32_bf16 v[128:131], a[60:63], v[60:63], v[128:131]
v_mfma_f32_16x16x32_bf16 v[132:135], a[188:191], v[60:63], v[132:135]
s_waitcnt vmcnt(15)
v_mfma_f32_16x16x32_bf16 v[128:131], a[64:67], v[64:67], v[128:131]
v_mfma_f32_16x16x32_bf16 v[132:135], a[192:195], v[64:67], v[132:135]
s_waitcnt vmcnt(14)
v_mfma_f32_16x16x32_bf16 v[128:131], a[68:71], v[68:71], v[128:131]
v_mfma_f32_16x16x32_bf16 v[132:135], a[196:199], v[68:71], v[132:135]
s_waitcnt vmcnt(13)
v_mfma_f32_16x16x32_bf16 v[128:131], a[72:75], v[72:75], v[128:131]
v_mfma_f32_16x16x32_bf16 v[132:135], a[200:203], v[72:75], v[132:135]
s_waitcnt vmcnt(12)
v_mfma_f32_16x16x32_bf16 v[128:131], a[76:79], v[76:79], v[128:131]
v_mfma_f32_16x16x32_bf16 v[132:135], a[204:207], v[76:79], v[132:135]
s_waitcnt vmcnt(11)
v_mfma_f32_16x16x32_bf16 v[128:131], a[80:83], v[80:83], v[128:131]
v_mfma_f32_16x16x32_bf16 v[132:135], a[208:211], v[80:83], v[132:135]
v_lshlrev_b32 v164, 16, v160
v_and_b32 v165, 0xffff0000, v160
v_lshlrev_b32 v166, 16, v161
v_and_b32 v167, 0xffff0000, v161
v_lshlrev_b32 v160, 16, v162
v_and_b32 v161, 0xffff0000, v162
v_lshlrev_b32 v162, 16, v163
v_and_b32 v163, 0xffff0000, v163
s_waitcnt vmcnt(10)
v_mfma_f32_16x16x32_bf16 v[128:131], a[84:87], v[84:87], v[128:131]
v_mfma_f32_16x16x32_bf16 v[132:135], a[212:215], v[84:87], v[132:135]
s_waitcnt vmcnt(9)
v_mfma_f32_16x16x32_bf16 v[128:131], a[88:91], v[88:91], v[128:131]
v_mfma_f32_16x16x32_bf16 v[132:135], a[216:219], v[88:91], v[132:135]
s_waitcnt vmcnt(8)
v_mfma_f32_16x16x32_bf16 v[128:131], a[92:95], v[92:95], v[128:131]
v_mfma_f32_16x16x32_bf16 v[132:135], a[220:223], v[92:95], v[132:135]
s_waitcnt vmcnt(7)
v_mfma_f32_16x16x32_bf16 v[128:131], a[96:99], v[96:99], v[128:131]
v_mfma_f32_16x16x32_bf16 v[132:135], a[224:227], v[96:99], v[132:135]
s_waitcnt vmcnt(6)
v_mfma_f32_16x16x32_bf16 v[128:131], a[100:103], v[100:103], v[128:131]
v_mfma_f32_16x16x32_bf16 v[132:135], a[228:231], v[100:103], v[132:135]
s_waitcnt vmcnt(5)
v_mfma_f32_16x16x32_bf16 v[128:131], a[104:107], v[104:107], v[128:131]
v_mfma_f32_16x16x32_bf16 v[132:135], a[232:235], v[104:107], v[132:135]
s_waitcnt vmcnt(4)
v_mfma_f32_16x16x32_bf16 v[128:131], a[108:111], v[108:111], v[128:131]
v_mfma_f32_16x16x32_bf16 v[132:135], a[236:239], v[108:111], v[132:135]
s_waitcnt vmcnt(3)
v_mfma_f32_16x16x32_bf16 v[128:131], a[112:115], v[112:115], v[128:131]
v_mfma_f32_16x16x32_bf16 v[132:135], a[240:243], v[112:115], v[132:135]
s_waitcnt vmcnt(2)
v_mfma_f32_16x16x32_bf16 v[128:131], a[116:119], v[116:119], v[128:131]
v_mfma_f32_16x16x32_bf16 v[132:135], a[244:247], v[116:119], v[132:135]
s_waitcnt vmcnt(1)
v_mfma_f32_16x16x32_bf16 v[128:131], a[120:123], v[120:123], v[128:131]
v_mfma_f32_16x16x32_bf16 v[132:135], a[248:251], v[120:123], v[132:135]
s_waitcnt vmcnt(0)
v_mfma_f32_16x16x32_bf16 v[128:131], a[124:127], v[124:127], v[128:131]
v_mfma_f32_16x16x32_bf16 v[132:135], a[252:255], v[124:127], v[132:135]
s_cmp_ge_u32 s14, 2
s_nop 5
ds_write_b128 v176, v[128:131] offset:0
ds_write_b128 v176, v[132:135] offset:1024
v_xor_b32 v176, 0x4000, v176
s_waitcnt lgkmcnt(0)
s_barrier
s_cbranch_scc1 main_kernel_o_nx
ds_read_b128 v[144:147], v177 offset:0
ds_read_b128 v[148:151], v177 offset:2048
ds_read_b128 v[152:155], v177 offset:4096
ds_read_b128 v[156:159], v177 offset:6144
v_xor_b32 v177, 0x4000, v177
s_waitcnt lgkmcnt(2)
v_pk_add_f32 v[144:145], v[144:145], v[148:149]
v_pk_add_f32 v[146:147], v[146:147], v[150:151]
s_waitcnt lgkmcnt(0)
v_pk_add_f32 v[152:153], v[152:153], v[156:157]
v_pk_add_f32 v[154:155], v[154:155], v[158:159]
v_pk_add_f32 v[144:145], v[144:145], v[152:153]
v_pk_add_f32 v[146:147], v[146:147], v[154:155]
v_pk_fma_f32 v[144:145], v[144:145], v[160:161], v[164:165]
v_pk_fma_f32 v[146:147], v[146:147], v[162:163], v[166:167]
v_cvt_pk_bf16_f32 v148, v144, v145
v_cvt_pk_bf16_f32 v149, v146, v147
buffer_store_dwordx2 v[148:149], v175, s[92:95], s16 offen
main_kernel_o_nx:
s_add_u32 s16, s16, 65536
s_cmp_le_u32 s18, 62
s_cbranch_scc1 main_kernel_o_top
v_add_u32 v172, v172, v173
s_add_u32 s17, s17, 65536
s_add_u32 s16, s16, 65536
s_add_u32 s15, s15, 262144
s_add_u32 s18, s18, 1
s_cmp_lt_u32 s18, 64
s_cbranch_scc1 main_kernel_o_top
s_branch main_kernel_end
main_kernel_end2:
s_endpgm
main_kernel_worker:
v_lshlrev_b32 v251, 4, v250
v_mov_b32 v240, 0xc0135761
v_mov_b32 v241, 0xc0135761
v_mov_b32 v242, 0xbdd2d3e8
v_mov_b32 v243, 0xbdd2d3e8
v_mov_b32 v244, 0x3f800000
v_mov_b32 v245, 0x3f800000
v_mov_b32 v246, 0xbfb8aa3b
v_mov_b32 v247, 0xbfb8aa3b
s_lshr_b32 s37, s14, 1
s_and_b32 s38, s14, 1
v_mov_b32 v252, 0
v_mov_b32 v224, 0
v_mov_b32 v225, 0
v_mov_b32 v226, 0
v_mov_b32 v227, 0
v_mov_b32 v228, 0
v_mov_b32 v229, 0
v_mov_b32 v230, 0
v_mov_b32 v231, 0
v_mov_b32 v232, 0
v_mov_b32 v233, 0
v_mov_b32 v234, 0
v_mov_b32 v235, 0
v_mov_b32 v249, 0
v_mov_b32 v248, 0
v_mov_b32 v128, 0
v_mov_b32 v129, 0
v_mov_b32 v130, 0
v_mov_b32 v131, 0
v_mov_b32 v132, 0
v_mov_b32 v133, 0
v_mov_b32 v134, 0
v_mov_b32 v135, 0
v_mov_b32 v136, 0
v_mov_b32 v137, 0
v_mov_b32 v138, 0
v_mov_b32 v139, 0
v_mov_b32 v140, 0
v_mov_b32 v141, 0
v_mov_b32 v142, 0
v_mov_b32 v143, 0
v_mov_b32 v144, 0
v_mov_b32 v145, 0
v_mov_b32 v146, 0
v_mov_b32 v147, 0
v_mov_b32 v148, 0
v_mov_b32 v149, 0
v_mov_b32 v150, 0
v_mov_b32 v151, 0
v_mov_b32 v152, 0
v_mov_b32 v153, 0
v_mov_b32 v154, 0
s_cmp_eq_u32 s14, 0
s_cselect_b64 s[100:101], -1, 0
s_mov_b32 s21, 0
s_mov_b32 s22, 0
s_mov_b32 s26, 0
s_mov_b32 s0, 0
s_mov_b32 s1, 0
s_mov_b32 s2, 0
s_mov_b32 s3, 0
s_mov_b32 s59, 0
s_mov_b32 s60, 0
s_mov_b32 s39, 0
s_mov_b32 s8, s40
s_and_b32 s9, s41, 0xffff
s_mov_b32 s10, 0x0
s_mov_b32 s11, 0x20000
s_cmp_lg_u32 s14, 0
s_cbranch_scc1 main_kernel_w_bar
main_kernel_w_selq:
s_lshl_b32 s32, s27, 8
s_add_u32 s32, s32, 0x841e000
s_mov_b64 exec, 1
v_mov_b32 v249, 1
buffer_atomic_add v249, off, s[4:7], s32 sc0 sc1
s_mov_b64 exec, -1
v_mov_b32 v230, 0x7fff
s_cmp_lg_u32 s27, 0
s_cbranch_scc1 main_kernel_w_q1
s_mov_b32 s32, 0x45800
v_writelane_b32 v230, s32, 0
s_mov_b32 s32, 0x6580e
v_writelane_b32 v230, s32, 1
s_mov_b32 s32, 0x404501c
v_writelane_b32 v230, s32, 2
s_mov_b32 s32, 0x49088024
v_writelane_b32 v230, s32, 3
s_mov_b32 s32, 0x49088834
v_writelane_b32 v230, s32, 4
s_mov_b32 s32, 0x48088044
v_writelane_b32 v230, s32, 5
s_mov_b32 s32, 0x40c2054
v_writelane_b32 v230, s32, 6
s_mov_b32 s32, 0x4102064
v_writelane_b32 v230, s32, 7
s_mov_b32 s32, 0x4182074
v_writelane_b32 v230, s32, 8
s_mov_b32 s32, 0x8082884
v_writelane_b32 v230, s32, 9
s_mov_b32 s32, 0x49108094
v_writelane_b32 v230, s32, 10
s_mov_b32 s32, 0x4a00b0a4
v_writelane_b32 v230, s32, 11
s_mov_b32 s32, 0x4a08b0b0
v_writelane_b32 v230, s32, 12
s_mov_b32 s32, 0x4800b0bc
v_writelane_b32 v230, s32, 13
s_mov_b32 s32, 0x4918b0cc
v_writelane_b32 v230, s32, 14
s_mov_b32 s32, 0x4a1888dc
v_writelane_b32 v230, s32, 15
s_mov_b32 s32, 0x81850ec
v_writelane_b32 v230, s32, 16
s_mov_b32 s32, 0x40838fc
v_writelane_b32 v230, s32, 17
s_mov_b32 s32, 0x4918910c
v_writelane_b32 v230, s32, 18
s_mov_b32 s32, 0x410391c
v_writelane_b32 v230, s32, 19
s_mov_b32 s32, 0x414392c
v_writelane_b32 v230, s32, 20
s_mov_b32 s32, 0x4b18813c
v_writelane_b32 v230, s32, 21
s_mov_b32 s32, 0x41c394c
v_writelane_b32 v230, s32, 22
s_mov_b32 s32, 0x795c
v_writelane_b32 v230, s32, 23
s_branch main_kernel_w_qe
main_kernel_w_q1:
s_cmp_lg_u32 s27, 1
s_cbranch_scc1 main_kernel_w_q2
s_mov_b32 s32, 0x25000
v_writelane_b32 v230, s32, 0
s_mov_b32 s32, 0x40069004
v_writelane_b32 v230, s32, 1
s_mov_b32 s32, 0x4206880c
v_writelane_b32 v230, s32, 2
s_mov_b32 s32, 0x7814
v_writelane_b32 v230, s32, 3
s_branch main_kernel_w_qe
main_kernel_w_q2:
s_cmp_lg_u32 s27, 2
s_cbranch_scc1 main_kernel_w_q3
s_mov_b32 s32, 0x800
v_writelane_b32 v230, s32, 0
s_mov_b32 s32, 0x1008
v_writelane_b32 v230, s32, 1
s_mov_b32 s32, 0x44028810
v_writelane_b32 v230, s32, 2
s_mov_b32 s32, 0x44029018
v_writelane_b32 v230, s32, 3
s_mov_b32 s32, 0x48109820
v_writelane_b32 v230, s32, 4
s_mov_b32 s32, 0x46008030
v_writelane_b32 v230, s32, 5
s_mov_b32 s32, 0x46048040
v_writelane_b32 v230, s32, 6
s_mov_b32 s32, 0x4a088850
v_writelane_b32 v230, s32, 7
s_mov_b32 s32, 0x48088860
v_writelane_b32 v230, s32, 8
s_mov_b32 s32, 0x4b109070
v_writelane_b32 v230, s32, 9
s_mov_b32 s32, 0x41c2080
v_writelane_b32 v230, s32, 10
s_mov_b32 s32, 0x4b108890
v_writelane_b32 v230, s32, 11
s_mov_b32 s32, 0x81050a0
v_writelane_b32 v230, s32, 12
s_mov_b32 s32, 0x4a1088b0
v_writelane_b32 v230, s32, 13
s_mov_b32 s32, 0x491088c0
v_writelane_b32 v230, s32, 14
s_mov_b32 s32, 0x481088d0
v_writelane_b32 v230, s32, 15
s_mov_b32 s32, 0x4908b0e0
v_writelane_b32 v230, s32, 16
s_mov_b32 s32, 0x4a1080f0
v_writelane_b32 v230, s32, 17
s_mov_b32 s32, 0x4ac0b100
v_writelane_b32 v230, s32, 18
s_mov_b32 s32, 0x4810b10c
v_writelane_b32 v230, s32, 19
s_mov_b32 s32, 0x4818b11c
v_writelane_b32 v230, s32, 20
s_mov_b32 s32, 0x4818892c
v_writelane_b32 v230, s32, 21
s_mov_b32 s32, 0x40c393c
v_writelane_b32 v230, s32, 22
s_mov_b32 s32, 0x404394c
v_writelane_b32 v230, s32, 23
s_mov_b32 s32, 0x4b18895c
v_writelane_b32 v230, s32, 24
s_mov_b32 s32, 0x796c
v_writelane_b32 v230, s32, 25
s_branch main_kernel_w_qe
main_kernel_w_q3:
s_cmp_lg_u32 s27, 3
s_cbranch_scc1 main_kernel_w_q4
s_mov_b32 s32, 0x1000800
v_writelane_b32 v230, s32, 0
s_mov_b32 s32, 0x1001008
v_writelane_b32 v230, s32, 1
s_mov_b32 s32, 0x45028810
v_writelane_b32 v230, s32, 2
s_mov_b32 s32, 0x45029018
v_writelane_b32 v230, s32, 3
s_mov_b32 s32, 0x48009820
v_writelane_b32 v230, s32, 4
s_mov_b32 s32, 0x44048030
v_writelane_b32 v230, s32, 5
s_mov_b32 s32, 0x4a089040
v_writelane_b32 v230, s32, 6
s_mov_b32 s32, 0x4b089050
v_writelane_b32 v230, s32, 7
s_mov_b32 s32, 0x4142060
v_writelane_b32 v230, s32, 8
s_mov_b32 s32, 0x4002070
v_writelane_b32 v230, s32, 9
s_mov_b32 s32, 0x4a109080
v_writelane_b32 v230, s32, 10
s_mov_b32 s32, 0x8102890
v_writelane_b32 v230, s32, 11
s_mov_b32 s32, 0x81828a0
v_writelane_b32 v230, s32, 12
s_mov_b32 s32, 0x4ac8b0b0
v_writelane_b32 v230, s32, 13
s_mov_b32 s32, 0x4910b0bc
v_writelane_b32 v230, s32, 14
s_mov_b32 s32, 0x4a10b0cc
v_writelane_b32 v230, s32, 15
s_mov_b32 s32, 0x4ad0b0d8
v_writelane_b32 v230, s32, 16
s_mov_b32 s32, 0x4ad8b0e4
v_writelane_b32 v230, s32, 17
s_mov_b32 s32, 0x4b1890f0
v_writelane_b32 v230, s32, 18
s_mov_b32 s32, 0x4a189100
v_writelane_b32 v230, s32, 19
s_mov_b32 s32, 0x48188110
v_writelane_b32 v230, s32, 20
s_mov_b32 s32, 0x4a188120
v_writelane_b32 v230, s32, 21
s_mov_b32 s32, 0x64130
v_writelane_b32 v230, s32, 22
s_mov_b32 s32, 0xe4138
v_writelane_b32 v230, s32, 23
s_mov_b32 s32, 0x44140
v_writelane_b32 v230, s32, 24
s_mov_b32 s32, 0x4148
v_writelane_b32 v230, s32, 25
s_mov_b32 s32, 0xa4150
v_writelane_b32 v230, s32, 26
s_mov_b32 s32, 0x84158
v_writelane_b32 v230, s32, 27
s_mov_b32 s32, 0x7960
v_writelane_b32 v230, s32, 28
s_branch main_kernel_w_qe
main_kernel_w_q4:
s_cmp_lg_u32 s27, 4
s_cbranch_scc1 main_kernel_w_q5
s_mov_b32 s32, 0x2000800
v_writelane_b32 v230, s32, 0
s_mov_b32 s32, 0x2001008
v_writelane_b32 v230, s32, 1
s_mov_b32 s32, 0x46028810
v_writelane_b32 v230, s32, 2
s_mov_b32 s32, 0x46029018
v_writelane_b32 v230, s32, 3
s_mov_b32 s32, 0x48089820
v_writelane_b32 v230, s32, 4
s_mov_b32 s32, 0x40068830
v_writelane_b32 v230, s32, 5
s_mov_b32 s32, 0x42069038
v_writelane_b32 v230, s32, 6
s_mov_b32 s32, 0x4b088840
v_writelane_b32 v230, s32, 7
s_mov_b32 s32, 0x49089050
v_writelane_b32 v230, s32, 8
s_mov_b32 s32, 0x4b088060
v_writelane_b32 v230, s32, 9
s_mov_b32 s32, 0x4a088070
v_writelane_b32 v230, s32, 10
s_mov_b32 s32, 0x49188880
v_writelane_b32 v230, s32, 11
s_mov_b32 s32, 0x8002890
v_writelane_b32 v230, s32, 12
s_mov_b32 s32, 0x4808b0a0
v_writelane_b32 v230, s32, 13
s_mov_b32 s32, 0x4900b0b0
v_writelane_b32 v230, s32, 14
s_mov_b32 s32, 0x481890c0
v_writelane_b32 v230, s32, 15
s_mov_b32 s32, 0x491880d0
v_writelane_b32 v230, s32, 16
s_mov_b32 s32, 0x40038e0
v_writelane_b32 v230, s32, 17
s_mov_b32 s32, 0x41838f0
v_writelane_b32 v230, s32, 18
s_mov_b32 s32, 0x124100
v_writelane_b32 v230, s32, 19
s_mov_b32 s32, 0x104108
v_writelane_b32 v230, s32, 20
s_mov_b32 s32, 0x24110
v_writelane_b32 v230, s32, 21
s_mov_b32 s32, 0xc4118
v_writelane_b32 v230, s32, 22
s_mov_b32 s32, 0x144120
v_writelane_b32 v230, s32, 23
s_mov_b32 s32, 0x7928
v_writelane_b32 v230, s32, 24
s_branch main_kernel_w_qe
main_kernel_w_q5:
s_mov_b32 s32, 0x3000800
v_writelane_b32 v230, s32, 0
s_mov_b32 s32, 0x3001008
v_writelane_b32 v230, s32, 1
s_mov_b32 s32, 0x47028810
v_writelane_b32 v230, s32, 2
s_mov_b32 s32, 0x47029018
v_writelane_b32 v230, s32, 3
s_mov_b32 s32, 0x8085020
v_writelane_b32 v230, s32, 4
s_mov_b32 s32, 0x48189830
v_writelane_b32 v230, s32, 5
s_mov_b32 s32, 0x44008040
v_writelane_b32 v230, s32, 6
s_mov_b32 s32, 0x48089050
v_writelane_b32 v230, s32, 7
s_mov_b32 s32, 0x4082060
v_writelane_b32 v230, s32, 8
s_mov_b32 s32, 0x4042070
v_writelane_b32 v230, s32, 9
s_mov_b32 s32, 0x48108080
v_writelane_b32 v230, s32, 10
s_mov_b32 s32, 0x49109090
v_writelane_b32 v230, s32, 11
s_mov_b32 s32, 0x481090a0
v_writelane_b32 v230, s32, 12
s_mov_b32 s32, 0x4b1080b0
v_writelane_b32 v230, s32, 13
s_mov_b32 s32, 0x4a18b0c0
v_writelane_b32 v230, s32, 14
s_mov_b32 s32, 0x78cc
v_writelane_b32 v230, s32, 15
main_kernel_w_qe:
v_and_b32 v229, 0x7ff, v230
main_kernel_w_dec:
s_waitcnt vmcnt(0)
v_readfirstlane_b32 s28, v249
s_nop 1
v_cmp_ge_u32 vcc, s28, v229
s_nop 1
s_bcnt1_i32_b64 s32, vcc
s_sub_u32 s32, s32, 1
v_readlane_b32 s36, v230, s32
s_nop 1
s_and_b32 s32, s36, 0x7ff
s_sub_u32 s28, s28, s32
s_bfe_u32 s32, s36, 0x3001a
s_lshr_b32 s25, s28, s32
s_lshl_b32 s33, s25, s32
s_sub_u32 s24, s28, s33
s_bfe_u32 s34, s36, 0x1001d
s_lshl_b32 s24, s24, s34
s_bfe_u32 s35, s36, 0x1001e
s_lshl_b32 s25, s25, s35
s_bfe_u32 s32, s36, 0x40011
s_add_u32 s24, s24, s32
s_bfe_u32 s32, s36, 0x50015
s_add_u32 s25, s25, s32
s_bfe_u32 s23, s36, 0x4000b
s_bfe_u32 s36, s36, 0x6000b
s_lshl_b32 s32, s24, 8
s_or_b32 s36, s36, s32
s_lshl_b32 s32, s25, 16
s_or_b32 s36, s36, s32
s_cmp_eq_u32 s23, 4
s_cselect_b32 s32, 1, 0
s_sub_u32 s48, s24, s32
s_max_i32 s48, s48, 0
s_add_u32 s49, s24, s34
s_add_u32 s49, s49, s32
s_min_u32 s49, s49, 15
s_cmp_eq_u32 s23, 6
s_cselect_b32 s51, 3, 7
s_cmp_eq_u32 s23, 7
s_cselect_b32 s51, 27, s51
s_cselect_b32 s50, 5, 4
s_add_u32 s33, s25, s35
s_lshl_b32 s34, s24, 9
s_cmp_eq_u32 s23, 8
s_cselect_b32 s51, 0, s51
s_cselect_b32 s48, s25, s48
s_cselect_b32 s49, s33, s49
s_cmp_eq_u32 s23, 8
s_cselect_b32 s63, 2, 9
s_cselect_b32 s61, 0, 0x7f000000
s_cselect_b32 s34, s34, 0
v_lshrrev_b32 v228, s50, v250
v_lshlrev_b32 v254, s50, v228
v_sub_u32 v254, v250, v254
s_cmp_lt_u32 s23, 4
s_cselect_b32 s39, 10, s23
v_min_u32 v254, s51, v254
s_lshl_b32 s39, s39, 13
s_cmp_eq_u32 s23, 3
s_cselect_b32 s34, 4, s34
v_add_u32 v228, s48, v228
s_add_u32 s39, s39, s34
s_add_u32 s39, s39, 0x8402000
v_min_u32 v228, s49, v228
s_lshl_b32 s60, s24, 10
s_add_u32 s60, s60, 0x8400000
v_lshlrev_b32 v228, s63, v228
v_lshl_add_u32 v228, v254, 4, v228
v_or_b32 v146, s61, v251
main_kernel_w_chk:
s_and_b32 s23, s36, 15
s_cmp_lg_u32 s23, 15
s_cbranch_scc1 main_kernel_w_got
s_add_u32 s27, s27, 1
s_cmp_ge_u32 s27, 6
s_cselect_b32 s27, 0, s27
s_add_u32 s52, s52, 1
s_mov_b32 s36, -1
s_lshl_b32 s32, 1, s12
s_and_b32 s32, s32, 116
s_cselect_b32 s36, -2, -1
s_cbranch_scc1 main_kernel_w_pub
s_cmp_lt_u32 s52, 6
s_cbranch_scc1 main_kernel_w_selq
s_lshl_b32 s32, s12, 5
s_add_u32 s32, s32, s13
s_sub_u32 s32, s32, 160
s_cmp_lt_u32 s32, 80
s_cselect_b32 s36, -3, -1
s_cmp_lt_u32 s32, 64
s_cselect_b32 s36, -2, s36
s_branch main_kernel_w_pub
main_kernel_w_got:
s_cmp_ge_u32 s23, 10
s_cbranch_scc1 main_kernel_w_pub
main_kernel_w_poll:
buffer_load_dword v231, v228, s[4:7], s39 offen sc1
buffer_load_dwordx4 v[232:235], v146, s[4:7], s60 offen sc1
s_waitcnt vmcnt(0)
v_min3_u32 v253, v232, v233, v234
v_min_u32 v253, v253, v235
v_or_b32 v253, s61, v253
v_min_u32 v253, v253, v231
v_cmp_eq_u32 vcc, 0, v253
s_cbranch_vccz main_kernel_w_pub
s_sleep 8
s_sub_u32 s29, s29, 1
s_cbranch_scc0 main_kernel_w_poll
s_mov_b32 s36, -1
main_kernel_w_pub:
v_mov_b32 v253, 131072
v_mov_b32 v254, s36
ds_write_b32 v253, v254
s_waitcnt lgkmcnt(0)
main_kernel_w_bar:
s_barrier
v_mov_b32 v253, 131072
ds_read_b32 v254, v253
s_mov_b32 s56, 0
s_mov_b32 s73, -1
s_mov_b32 s58, -2
s_waitcnt lgkmcnt(0)
v_readfirstlane_b32 s62, v254
s_nop 3
s_cmp_eq_u32 s62, -1
s_cbranch_scc1 main_kernel_end2
s_cmp_eq_u32 s62, -2
s_cbranch_scc1 main_kernel_wo
s_cmp_eq_u32 s62, -3
s_cbranch_scc1 main_kernel_att2
s_and_b32 s23, s62, 15
s_bfe_u32 s54, s62, 0x20004
s_bfe_u32 s24, s62, 0x80008
s_lshr_b32 s25, s62, 16
s_cmp_eq_u32 s23, 5
s_cbranch_scc1 main_kernel_w_ln2
s_cmp_eq_u32 s23, 10
s_cbranch_scc1 main_kernel_w_fill
s_cmp_eq_u32 s23, 11
s_cbranch_scc1 main_kernel_w_pref
main_kernel_w_gemm:
s_cmp_eq_u32 s54, 1
s_cbranch_scc1 main_kernel_w_c1_task
main_kernel_w_c0_task:
s_cmp_eq_u32 s23, 1
s_cbranch_scc1 main_kernel_w_c0_set1
s_cmp_eq_u32 s23, 2
s_cbranch_scc1 main_kernel_w_c0_set2
s_cmp_eq_u32 s23, 4
s_cbranch_scc1 main_kernel_w_c0_set4
s_cmp_eq_u32 s23, 7
s_cbranch_scc1 main_kernel_w_c0_set7
s_cmp_eq_u32 s23, 8
s_cbranch_scc1 main_kernel_w_c0_set8
s_branch main_kernel_end2
main_kernel_w_c0_set1:
s_mov_b32 s57, 1
s_lshl_b32 s32, s25, 8
s_add_u32 s8, s42, s32
s_addc_u32 s9, s43, 0
s_and_b32 s9, s9, 0xffff
s_sub_u32 s10, 0x800000, s32
s_mov_b32 s11, 0x20000
s_mov_b32 s30, 8192
s_mov_b32 s31, 32768
s_mul_i32 s16, s24, 262144
s_add_u32 s16, s16, 0x0
s_mov_b32 s18, 3
s_lshl_b32 s32, s24, 3
s_mul_i32 s33, s38, 4
s_add_u32 s32, s32, s33
s_mul_i32 s32, s32, 131072
s_lshl_b32 s33, s25, 12
s_add_u32 s32, s32, s33
s_mul_i32 s33, s37, 2048
s_add_u32 s32, s32, s33
s_add_u32 s21, s32, 0x1800000
s_mov_b32 s22, 131072
s_mov_b32 s26, 0x7f000000
s_branch main_kernel_w_c0_go
main_kernel_w_c0_set2:
s_mov_b32 s57, 2
s_lshl_b32 s32, s25, 8
s_add_u32 s8, s44, s32
s_addc_u32 s9, s45, 0
s_and_b32 s9, s9, 0xffff
s_sub_u32 s10, 0x800000, s32
s_mov_b32 s11, 0x20000
s_mov_b32 s30, 8192
s_mov_b32 s31, 32768
s_mul_i32 s16, s24, 262144
s_add_u32 s16, s16, 0x0
s_mov_b32 s18, 3
s_lshl_b32 s32, s24, 2
s_mul_i32 s33, s38, 2
s_add_u32 s32, s32, s33
s_lshl_b32 s32, s32, 18
s_lshl_b32 s33, s25, 13
s_add_u32 s32, s32, s33
s_mul_i32 s33, s37, 4096
s_add_u32 s32, s32, s33
s_add_u32 s21, s32, 0x2800000
s_branch main_kernel_w_c0_gov
main_kernel_w_c0_set4:
s_mov_b32 s57, 3
s_lshl_b32 s32, s25, 8
s_add_u32 s8, s66, s32
s_addc_u32 s9, s67, 0
s_and_b32 s9, s9, 0xffff
s_sub_u32 s10, 0x200000, s32
s_mov_b32 s11, 0x20000
s_mov_b32 s30, 2048
s_mov_b32 s31, 32768
s_mul_i32 s16, s24, 262144
s_add_u32 s16, s16, 0x4808000
s_mov_b32 s18, 3
s_lshl_b32 s32, s24, 3
s_mul_i32 s33, s38, 4
s_add_u32 s32, s32, s33
s_mul_i32 s32, s32, 32768
s_lshl_b32 s33, s25, 12
s_add_u32 s32, s32, s33
s_mul_i32 s33, s37, 2048
s_add_u32 s32, s32, s33
s_add_u32 s21, s32, 0x5000000
s_mov_b32 s22, 32768
s_add_u32 s26, s32, 0x0
s_branch main_kernel_w_c0_go
main_kernel_w_c0_set7:
s_mov_b32 s57, 4
s_lshl_b32 s32, s25, 8
s_add_u32 s8, s70, s32
s_addc_u32 s9, s71, 0
s_and_b32 s9, s9, 0xffff
s_sub_u32 s10, 0x700000, s32
s_mov_b32 s11, 0x20000
s_mov_b32 s30, 2048
s_mov_b32 s31, 114688
s_mul_i32 s16, s24, 917504
s_add_u32 s16, s16, 0x5400000
s_mov_b32 s18, 13
s_lshl_b32 s32, s24, 3
s_mul_i32 s33, s38, 4
s_add_u32 s32, s32, s33
s_mul_i32 s32, s32, 32768
s_lshl_b32 s33, s25, 12
s_add_u32 s32, s32, s33
s_mul_i32 s33, s37, 2048
s_add_u32 s32, s32, s33
s_add_u32 s21, s32, 0x6400000
s_mov_b32 s22, 32768
s_add_u32 s26, s32, 0x5000000
s_branch main_kernel_w_c0_go
main_kernel_w_c0_set8:
s_mov_b32 s57, 5
s_lshl_b32 s32, s25, 8
s_add_u32 s8, s46, s32
s_addc_u32 s9, s47, 0
s_and_b32 s9, s9, 0xffff
s_sub_u32 s10, 0x800000, s32
s_mov_b32 s11, 0x20000
s_mov_b32 s30, 2048
s_mov_b32 s31, 131072
s_mul_i32 s16, s24, 1048576
s_add_u32 s16, s16, 0x3800000
s_mov_b32 s18, 15
s_lshl_b32 s32, s24, 3
s_mul_i32 s33, s38, 4
s_add_u32 s32, s32, s33
s_mul_i32 s32, s32, 32768
s_lshl_b32 s33, s25, 8
s_add_u32 s34, s32, s33
s_mul_i32 s33, s37, 128
s_add_u32 s34, s34, s33
s_lshl_b32 s33, s25, 12
s_add_u32 s32, s32, s33
s_mul_i32 s33, s37, 2048
s_add_u32 s32, s32, s33
s_add_u32 s21, s32, 0x0
s_mov_b32 s22, 32768
s_add_u32 s26, s32, 0x6400000
s_mov_b32 s21, s34
v_and_b32 v253, 15, v250
v_and_b32 v254, 48, v250
v_lshl_add_u32 v252, v253, 11, v254
s_branch main_kernel_w_c0_go
main_kernel_w_c0_str:
s_mul_i32 s32, s14, 2
s_mul_i32 s32, s32, s31
v_mad_u32_u24 v137, v147, s30, v151
v_mad_u32_u24 v138, v148, s30, v152
v_mad_u32_u24 v139, v149, s30, v153
v_mad_u32_u24 v140, v150, s30, v154
v_add_u32 v141, s32, v251
s_add_u32 s32, s32, s31
s_sub_u32 s32, s32, 2048
v_add_u32 v142, s32, v251
s_mul_i32 s17, s30, 64
s_mov_b32 s15, 0
s_mov_b32 s18, 1
s_cmp_eq_u32 s73, 0
s_cbranch_scc1 main_kernel_w_c0_n_mid
s_branch main_kernel_w_c0_v_mid
main_kernel_w_c0_go:
s_mov_b32 s58, 0
s_mov_b32 s72, s18
s_cmp_lg_u32 s73, -1
s_cbranch_scc1 main_kernel_w_c0_str
s_waitcnt lgkmcnt(0)
v_lshrrev_b32 v0, 4, v250
v_bfe_u32 v1, v250, 2, 2
v_lshl_add_u32 v4, v0, 2, v1
v_and_b32 v5, 7, v4
v_mul_u32_u24 v4, 256, v4
v_and_b32 v6, 3, v250
v_lshl_add_u32 v4, v6, 3, v4
s_mul_i32 s32, s37, 4
v_xor_b32 v5, s32, v5
v_lshl_add_u32 v128, v5, 5, v4
v_xor_b32 v129, 32, v128
v_xor_b32 v130, 64, v128
v_xor_b32 v131, 96, v128
s_mul_i32 s32, s38, 8192
s_add_u32 s32, s32, 65536
v_add_u32 v136, s32, v251
v_lshrrev_b32 v2, 4, v250
v_and_b32 v3, 15, v250
s_mul_i32 s32, s14, 16
v_add_u32 v147, s32, v2
v_and_b32 v6, 7, v147
v_lshlrev_b32 v6, 1, v6
v_xor_b32 v6, v6, v3
v_lshlrev_b32 v151, 4, v6
v_add_u32 v148, 4, v147
v_and_b32 v6, 7, v148
v_lshlrev_b32 v6, 1, v6
v_xor_b32 v6, v6, v3
v_lshlrev_b32 v152, 4, v6
v_subrev_u32 v152, 1024, v152
v_add_u32 v149, 8, v147
v_and_b32 v6, 7, v149
v_lshlrev_b32 v6, 1, v6
v_xor_b32 v6, v6, v3
v_lshlrev_b32 v153, 4, v6
v_subrev_u32 v153, 2048, v153
v_add_u32 v150, 12, v147
v_and_b32 v6, 7, v150
v_lshlrev_b32 v6, 1, v6
v_xor_b32 v6, v6, v3
v_lshlrev_b32 v154, 4, v6
v_subrev_u32 v154, 3072, v154
s_mul_i32 s19, s14, 4096
s_mul_i32 s20, s14, 4096
s_add_u32 s20, s20, 65536
s_mul_i32 s32, s14, 2
s_mul_i32 s32, s32, s31
v_mad_u32_u24 v137, v147, s30, v151
v_mad_u32_u24 v138, v148, s30, v152
v_mad_u32_u24 v139, v149, s30, v153
v_mad_u32_u24 v140, v150, s30, v154
v_add_u32 v141, s32, v251
s_add_u32 s32, s32, s31
s_sub_u32 s32, s32, 2048
v_add_u32 v142, s32, v251
s_mul_i32 s17, s30, 64
s_mov_b32 s15, 0
s_waitcnt vmcnt(0)
s_add_u32 m0, s20, 0
s_nop 0
buffer_load_dwordx4 v141, s[4:7], s16 offen offset:0 sc1 lds
buffer_load_dwordx4 v141, s[4:7], s16 offen offset:1024 sc1 lds
buffer_load_dwordx4 v142, s[4:7], s16 offen offset:2048 sc1 lds
buffer_load_dwordx4 v142, s[4:7], s16 offen offset:3072 sc1 lds
s_add_u32 s16, s16, 2048
s_add_u32 m0, s19, 0
s_nop 0
buffer_load_dwordx4 v137, s[8:11], s15 offen offset:0 lds
buffer_load_dwordx4 v138, s[8:11], s15 offen offset:1024 lds
buffer_load_dwordx4 v139, s[8:11], s15 offen offset:2048 lds
buffer_load_dwordx4 v140, s[8:11], s15 offen offset:3072 lds
s_add_u32 s15, s15, s17
s_add_u32 m0, s20, 16384
s_nop 0
buffer_load_dwordx4 v141, s[4:7], s16 offen offset:0 sc1 lds
buffer_load_dwordx4 v141, s[4:7], s16 offen offset:1024 sc1 lds
buffer_load_dwordx4 v142, s[4:7], s16 offen offset:2048 sc1 lds
buffer_load_dwordx4 v142, s[4:7], s16 offen offset:3072 sc1 lds
s_add_u32 s16, s16, 2048
s_add_u32 m0, s19, 16384
s_nop 0
buffer_load_dwordx4 v137, s[8:11], s15 offen offset:0 lds
buffer_load_dwordx4 v138, s[8:11], s15 offen offset:1024 lds
buffer_load_dwordx4 v139, s[8:11], s15 offen offset:2048 lds
buffer_load_dwordx4 v140, s[8:11], s15 offen offset:3072 lds
s_add_u32 s15, s15, s17
s_add_u32 m0, s20, 32768
s_nop 0
buffer_load_dwordx4 v141, s[4:7], s16 offen offset:0 sc1 lds
buffer_load_dwordx4 v141, s[4:7], s16 offen offset:1024 sc1 lds
buffer_load_dwordx4 v142, s[4:7], s16 offen offset:2048 sc1 lds
buffer_load_dwordx4 v142, s[4:7], s16 offen offset:3072 sc1 lds
s_add_u32 s16, s16, 2048
s_add_u32 m0, s19, 32768
s_nop 0
buffer_load_dwordx4 v137, s[8:11], s15 offen offset:0 lds
buffer_load_dwordx4 v138, s[8:11], s15 offen offset:1024 lds
buffer_load_dwordx4 v139, s[8:11], s15 offen offset:2048 lds
buffer_load_dwordx4 v140, s[8:11], s15 offen offset:3072 lds
s_add_u32 s15, s15, s17
s_add_u32 m0, s20, 49152
s_nop 0
buffer_load_dwordx4 v141, s[4:7], s16 offen offset:0 sc1 lds
buffer_load_dwordx4 v141, s[4:7], s16 offen offset:1024 sc1 lds
buffer_load_dwordx4 v142, s[4:7], s16 offen offset:2048 sc1 lds
buffer_load_dwordx4 v142, s[4:7], s16 offen offset:3072 sc1 lds
s_add_u32 s16, s16, 2048
s_cmp_lg_u32 s56, 0
s_cbranch_scc1 main_kernel_w_epi
main_kernel_w_c0_n_ent:
v_mfma_f32_32x32x16_bf16 v[64:79], v[224:227], v[224:227], 0
s_waitcnt vmcnt(20)
s_barrier
ds_read_b128 v[16:19], v136 offset:0
ds_read_b64_tr_b16 v[0:1], v128 offset:0
ds_read_b64_tr_b16 v[2:3], v128 offset:4096
v_mfma_f32_32x32x16_bf16 v[80:95], v[224:227], v[224:227], 0
ds_read_b64_tr_b16 v[4:5], v129 offset:0
ds_read_b64_tr_b16 v[6:7], v129 offset:4096
ds_read_b64_tr_b16 v[8:9], v130 offset:0
v_mfma_f32_32x32x16_bf16 v[96:111], v[224:227], v[224:227], 0
ds_read_b64_tr_b16 v[10:11], v130 offset:4096
ds_read_b64_tr_b16 v[12:13], v131 offset:0
ds_read_b64_tr_b16 v[14:15], v131 offset:4096
v_mfma_f32_32x32x16_bf16 v[112:127], v[224:227], v[224:227], 0
ds_read_b128 v[20:23], v136 offset:2048
ds_read_b128 v[24:27], v136 offset:4096
ds_read_b128 v[28:31], v136 offset:6144
s_sub_u32 s18, s72, 1
s_sub_u32 s55, s72, 2
s_orn2_b32 s55, s55, s100
s_mov_b32 s73, -1
s_nop 0
main_kernel_w_c0_n_loop:
s_waitcnt lgkmcnt(0)
ds_read_b128 v[48:51], v136 offset:1024
s_add_u32 m0, s19, 49152
s_nop 0
v_mfma_f32_16x16x32_bf16 v[64:67], v[0:3], v[16:19], v[64:67]
ds_read_b64_tr_b16 v[32:33], v128 offset:8192
v_mfma_f32_16x16x32_bf16 v[68:71], v[4:7], v[16:19], v[68:71]
ds_read_b64_tr_b16 v[34:35], v128 offset:12288
buffer_load_dwordx4 v137, s[8:11], s15 offen offset:0 lds
v_mfma_f32_16x16x32_bf16 v[72:75], v[8:11], v[16:19], v[72:75]
ds_read_b64_tr_b16 v[36:37], v129 offset:8192
v_mfma_f32_16x16x32_bf16 v[76:79], v[12:15], v[16:19], v[76:79]
ds_read_b64_tr_b16 v[38:39], v129 offset:12288
v_mfma_f32_16x16x32_bf16 v[80:83], v[0:3], v[20:23], v[80:83]
ds_read_b64_tr_b16 v[40:41], v130 offset:8192
buffer_load_dwordx4 v138, s[8:11], s15 offen offset:1024 lds
v_mfma_f32_16x16x32_bf16 v[84:87], v[4:7], v[20:23], v[84:87]
ds_read_b64_tr_b16 v[42:43], v130 offset:12288
v_mfma_f32_16x16x32_bf16 v[88:91], v[8:11], v[20:23], v[88:91]
ds_read_b64_tr_b16 v[44:45], v131 offset:8192
v_mfma_f32_16x16x32_bf16 v[92:95], v[12:15], v[20:23], v[92:95]
ds_read_b64_tr_b16 v[46:47], v131 offset:12288
buffer_load_dwordx4 v139, s[8:11], s15 offen offset:2048 lds
v_mfma_f32_16x16x32_bf16 v[96:99], v[0:3], v[24:27], v[96:99]
ds_read_b128 v[52:55], v136 offset:3072
v_mfma_f32_16x16x32_bf16 v[100:103], v[4:7], v[24:27], v[100:103]
ds_read_b128 v[56:59], v136 offset:5120
buffer_load_dwordx4 v140, s[8:11], s15 offen offset:3072 lds
v_mfma_f32_16x16x32_bf16 v[104:107], v[8:11], v[24:27], v[104:107]
ds_read_b128 v[60:63], v136 offset:7168
v_mfma_f32_16x16x32_bf16 v[108:111], v[12:15], v[24:27], v[108:111]
v_mfma_f32_16x16x32_bf16 v[112:115], v[0:3], v[28:31], v[112:115]
s_add_u32 s15, s15, s17
v_mfma_f32_16x16x32_bf16 v[116:119], v[4:7], v[28:31], v[116:119]
v_mfma_f32_16x16x32_bf16 v[120:123], v[8:11], v[28:31], v[120:123]
v_mfma_f32_16x16x32_bf16 v[124:127], v[12:15], v[28:31], v[124:127]
main_kernel_w_c0_n_mid:
s_waitcnt lgkmcnt(0)
v_mfma_f32_16x16x32_bf16 v[64:67], v[32:35], v[48:51], v[64:67]
s_waitcnt vmcnt(16)
s_barrier
ds_read_b128 v[16:19], v136 offset:16384
s_add_u32 m0, s20, 0
s_nop 0
v_mfma_f32_16x16x32_bf16 v[68:71], v[36:39], v[48:51], v[68:71]
ds_read_b64_tr_b16 v[0:1], v128 offset:16384
v_mfma_f32_16x16x32_bf16 v[72:75], v[40:43], v[48:51], v[72:75]
ds_read_b64_tr_b16 v[2:3], v128 offset:20480
buffer_load_dwordx4 v141, s[4:7], s16 offen offset:0 sc1 lds
v_mfma_f32_16x16x32_bf16 v[76:79], v[44:47], v[48:51], v[76:79]
ds_read_b64_tr_b16 v[4:5], v129 offset:16384
v_mfma_f32_16x16x32_bf16 v[80:83], v[32:35], v[52:55], v[80:83]
ds_read_b64_tr_b16 v[6:7], v129 offset:20480
v_mfma_f32_16x16x32_bf16 v[84:87], v[36:39], v[52:55], v[84:87]
ds_read_b64_tr_b16 v[8:9], v130 offset:16384
buffer_load_dwordx4 v141, s[4:7], s16 offen offset:1024 sc1 lds
v_mfma_f32_16x16x32_bf16 v[88:91], v[40:43], v[52:55], v[88:91]
ds_read_b64_tr_b16 v[10:11], v130 offset:20480
v_mfma_f32_16x16x32_bf16 v[92:95], v[44:47], v[52:55], v[92:95]
ds_read_b64_tr_b16 v[12:13], v131 offset:16384
buffer_load_dwordx4 v142, s[4:7], s16 offen offset:2048 sc1 lds
v_mfma_f32_16x16x32_bf16 v[96:99], v[32:35], v[56:59], v[96:99]
ds_read_b64_tr_b16 v[14:15], v131 offset:20480
v_mfma_f32_16x16x32_bf16 v[100:103], v[36:39], v[56:59], v[100:103]
ds_read_b128 v[20:23], v136 offset:18432
v_mfma_f32_16x16x32_bf16 v[104:107], v[40:43], v[56:59], v[104:107]
ds_read_b128 v[24:27], v136 offset:20480
buffer_load_dwordx4 v142, s[4:7], s16 offen offset:3072 sc1 lds
v_mfma_f32_16x16x32_bf16 v[108:111], v[44:47], v[56:59], v[108:111]
ds_read_b128 v[28:31], v136 offset:22528
v_mfma_f32_16x16x32_bf16 v[112:115], v[32:35], v[60:63], v[112:115]
s_add_u32 s16, s16, 2048
v_mfma_f32_16x16x32_bf16 v[116:119], v[36:39], v[60:63], v[116:119]
v_mfma_f32_16x16x32_bf16 v[120:123], v[40:43], v[60:63], v[120:123]
v_mfma_f32_16x16x32_bf16 v[124:127], v[44:47], v[60:63], v[124:127]
s_waitcnt lgkmcnt(0)
ds_read_b128 v[48:51], v136 offset:17408
s_add_u32 m0, s19, 0
s_nop 0
v_mfma_f32_16x16x32_bf16 v[64:67], v[0:3], v[16:19], v[64:67]
ds_read_b64_tr_b16 v[32:33], v128 offset:24576
v_mfma_f32_16x16x32_bf16 v[68:71], v[4:7], v[16:19], v[68:71]
ds_read_b64_tr_b16 v[34:35], v128 offset:28672
buffer_load_dwordx4 v137, s[8:11], s15 offen offset:0 lds
v_mfma_f32_16x16x32_bf16 v[72:75], v[8:11], v[16:19], v[72:75]
ds_read_b64_tr_b16 v[36:37], v129 offset:24576
v_mfma_f32_16x16x32_bf16 v[76:79], v[12:15], v[16:19], v[76:79]
ds_read_b64_tr_b16 v[38:39], v129 offset:28672
v_mfma_f32_16x16x32_bf16 v[80:83], v[0:3], v[20:23], v[80:83]
ds_read_b64_tr_b16 v[40:41], v130 offset:24576
buffer_load_dwordx4 v138, s[8:11], s15 offen offset:1024 lds
v_mfma_f32_16x16x32_bf16 v[84:87], v[4:7], v[20:23], v[84:87]
ds_read_b64_tr_b16 v[42:43], v130 offset:28672
v_mfma_f32_16x16x32_bf16 v[88:91], v[8:11], v[20:23], v[88:91]
ds_read_b64_tr_b16 v[44:45], v131 offset:24576
v_mfma_f32_16x16x32_bf16 v[92:95], v[12:15], v[20:23], v[92:95]
ds_read_b64_tr_b16 v[46:47], v131 offset:28672
buffer_load_dwordx4 v139, s[8:11], s15 offen offset:2048 lds
v_mfma_f32_16x16x32_bf16 v[96:99], v[0:3], v[24:27], v[96:99]
ds_read_b128 v[52:55], v136 offset:19456
v_mfma_f32_16x16x32_bf16 v[100:103], v[4:7], v[24:27], v[100:103]
ds_read_b128 v[56:59], v136 offset:21504
buffer_load_dwordx4 v140, s[8:11], s15 offen offset:3072 lds
v_mfma_f32_16x16x32_bf16 v[104:107], v[8:11], v[24:27], v[104:107]
ds_read_b128 v[60:63], v136 offset:23552
v_mfma_f32_16x16x32_bf16 v[108:111], v[12:15], v[24:27], v[108:111]
v_mfma_f32_16x16x32_bf16 v[112:115], v[0:3], v[28:31], v[112:115]
s_add_u32 s15, s15, s17
v_mfma_f32_16x16x32_bf16 v[116:119], v[4:7], v[28:31], v[116:119]
v_mfma_f32_16x16x32_bf16 v[120:123], v[8:11], v[28:31], v[120:123]
v_mfma_f32_16x16x32_bf16 v[124:127], v[12:15], v[28:31], v[124:127]
s_waitcnt lgkmcnt(0)
v_mfma_f32_16x16x32_bf16 v[64:67], v[32:35], v[48:51], v[64:67]
s_waitcnt vmcnt(16)
s_barrier
ds_read_b128 v[16:19], v136 offset:32768
s_add_u32 m0, s20, 16384
s_nop 0
v_mfma_f32_16x16x32_bf16 v[68:71], v[36:39], v[48:51], v[68:71]
ds_read_b64_tr_b16 v[0:1], v128 offset:32768
v_mfma_f32_16x16x32_bf16 v[72:75], v[40:43], v[48:51], v[72:75]
ds_read_b64_tr_b16 v[2:3], v128 offset:36864
buffer_load_dwordx4 v141, s[4:7], s16 offen offset:0 sc1 lds
v_mfma_f32_16x16x32_bf16 v[76:79], v[44:47], v[48:51], v[76:79]
ds_read_b64_tr_b16 v[4:5], v129 offset:32768
v_mfma_f32_16x16x32_bf16 v[80:83], v[32:35], v[52:55], v[80:83]
ds_read_b64_tr_b16 v[6:7], v129 offset:36864
v_mfma_f32_16x16x32_bf16 v[84:87], v[36:39], v[52:55], v[84:87]
ds_read_b64_tr_b16 v[8:9], v130 offset:32768
buffer_load_dwordx4 v141, s[4:7], s16 offen offset:1024 sc1 lds
v_mfma_f32_16x16x32_bf16 v[88:91], v[40:43], v[52:55], v[88:91]
ds_read_b64_tr_b16 v[10:11], v130 offset:36864
v_mfma_f32_16x16x32_bf16 v[92:95], v[44:47], v[52:55], v[92:95]
ds_read_b64_tr_b16 v[12:13], v131 offset:32768
buffer_load_dwordx4 v142, s[4:7], s16 offen offset:2048 sc1 lds
v_mfma_f32_16x16x32_bf16 v[96:99], v[32:35], v[56:59], v[96:99]
ds_read_b64_tr_b16 v[14:15], v131 offset:36864
v_mfma_f32_16x16x32_bf16 v[100:103], v[36:39], v[56:59], v[100:103]
ds_read_b128 v[20:23], v136 offset:34816
v_mfma_f32_16x16x32_bf16 v[104:107], v[40:43], v[56:59], v[104:107]
ds_read_b128 v[24:27], v136 offset:36864
buffer_load_dwordx4 v142, s[4:7], s16 offen offset:3072 sc1 lds
v_mfma_f32_16x16x32_bf16 v[108:111], v[44:47], v[56:59], v[108:111]
ds_read_b128 v[28:31], v136 offset:38912
v_mfma_f32_16x16x32_bf16 v[112:115], v[32:35], v[60:63], v[112:115]
s_add_u32 s16, s16, 2048
v_mfma_f32_16x16x32_bf16 v[116:119], v[36:39], v[60:63], v[116:119]
v_mfma_f32_16x16x32_bf16 v[120:123], v[40:43], v[60:63], v[120:123]
v_mfma_f32_16x16x32_bf16 v[124:127], v[44:47], v[60:63], v[124:127]
s_waitcnt lgkmcnt(0)
ds_read_b128 v[48:51], v136 offset:33792
s_add_u32 m0, s19, 16384
s_nop 0
v_mfma_f32_16x16x32_bf16 v[64:67], v[0:3], v[16:19], v[64:67]
ds_read_b64_tr_b16 v[32:33], v128 offset:40960
v_mfma_f32_16x16x32_bf16 v[68:71], v[4:7], v[16:19], v[68:71]
ds_read_b64_tr_b16 v[34:35], v128 offset:45056
buffer_load_dwordx4 v137, s[8:11], s15 offen offset:0 lds
v_mfma_f32_16x16x32_bf16 v[72:75], v[8:11], v[16:19], v[72:75]
ds_read_b64_tr_b16 v[36:37], v129 offset:40960
v_mfma_f32_16x16x32_bf16 v[76:79], v[12:15], v[16:19], v[76:79]
ds_read_b64_tr_b16 v[38:39], v129 offset:45056
v_mfma_f32_16x16x32_bf16 v[80:83], v[0:3], v[20:23], v[80:83]
ds_read_b64_tr_b16 v[40:41], v130 offset:40960
buffer_load_dwordx4 v138, s[8:11], s15 offen offset:1024 lds
v_mfma_f32_16x16x32_bf16 v[84:87], v[4:7], v[20:23], v[84:87]
ds_read_b64_tr_b16 v[42:43], v130 offset:45056
v_mfma_f32_16x16x32_bf16 v[88:91], v[8:11], v[20:23], v[88:91]
ds_read_b64_tr_b16 v[44:45], v131 offset:40960
v_mfma_f32_16x16x32_bf16 v[92:95], v[12:15], v[20:23], v[92:95]
ds_read_b64_tr_b16 v[46:47], v131 offset:45056
buffer_load_dwordx4 v139, s[8:11], s15 offen offset:2048 lds
v_mfma_f32_16x16x32_bf16 v[96:99], v[0:3], v[24:27], v[96:99]
ds_read_b128 v[52:55], v136 offset:35840
v_mfma_f32_16x16x32_bf16 v[100:103], v[4:7], v[24:27], v[100:103]
ds_read_b128 v[56:59], v136 offset:37888
buffer_load_dwordx4 v140, s[8:11], s15 offen offset:3072 lds
v_mfma_f32_16x16x32_bf16 v[104:107], v[8:11], v[24:27], v[104:107]
ds_read_b128 v[60:63], v136 offset:39936
v_mfma_f32_16x16x32_bf16 v[108:111], v[12:15], v[24:27], v[108:111]
v_mfma_f32_16x16x32_bf16 v[112:115], v[0:3], v[28:31], v[112:115]
s_add_u32 s15, s15, s17
v_mfma_f32_16x16x32_bf16 v[116:119], v[4:7], v[28:31], v[116:119]
v_mfma_f32_16x16x32_bf16 v[120:123], v[8:11], v[28:31], v[120:123]
v_mfma_f32_16x16x32_bf16 v[124:127], v[12:15], v[28:31], v[124:127]
s_waitcnt lgkmcnt(0)
v_mfma_f32_16x16x32_bf16 v[64:67], v[32:35], v[48:51], v[64:67]
s_waitcnt vmcnt(16)
s_barrier
ds_read_b128 v[16:19], v136 offset:49152
s_add_u32 m0, s20, 32768
s_nop 0
v_mfma_f32_16x16x32_bf16 v[68:71], v[36:39], v[48:51], v[68:71]
ds_read_b64_tr_b16 v[0:1], v128 offset:49152
v_mfma_f32_16x16x32_bf16 v[72:75], v[40:43], v[48:51], v[72:75]
ds_read_b64_tr_b16 v[2:3], v128 offset:53248
buffer_load_dwordx4 v141, s[4:7], s16 offen offset:0 sc1 lds
v_mfma_f32_16x16x32_bf16 v[76:79], v[44:47], v[48:51], v[76:79]
ds_read_b64_tr_b16 v[4:5], v129 offset:49152
v_mfma_f32_16x16x32_bf16 v[80:83], v[32:35], v[52:55], v[80:83]
ds_read_b64_tr_b16 v[6:7], v129 offset:53248
v_mfma_f32_16x16x32_bf16 v[84:87], v[36:39], v[52:55], v[84:87]
ds_read_b64_tr_b16 v[8:9], v130 offset:49152
buffer_load_dwordx4 v141, s[4:7], s16 offen offset:1024 sc1 lds
v_mfma_f32_16x16x32_bf16 v[88:91], v[40:43], v[52:55], v[88:91]
ds_read_b64_tr_b16 v[10:11], v130 offset:53248
v_mfma_f32_16x16x32_bf16 v[92:95], v[44:47], v[52:55], v[92:95]
ds_read_b64_tr_b16 v[12:13], v131 offset:49152
buffer_load_dwordx4 v142, s[4:7], s16 offen offset:2048 sc1 lds
v_mfma_f32_16x16x32_bf16 v[96:99], v[32:35], v[56:59], v[96:99]
ds_read_b64_tr_b16 v[14:15], v131 offset:53248
v_mfma_f32_16x16x32_bf16 v[100:103], v[36:39], v[56:59], v[100:103]
ds_read_b128 v[20:23], v136 offset:51200
v_mfma_f32_16x16x32_bf16 v[104:107], v[40:43], v[56:59], v[104:107]
ds_read_b128 v[24:27], v136 offset:53248
buffer_load_dwordx4 v142, s[4:7], s16 offen offset:3072 sc1 lds
v_mfma_f32_16x16x32_bf16 v[108:111], v[44:47], v[56:59], v[108:111]
ds_read_b128 v[28:31], v136 offset:55296
v_mfma_f32_16x16x32_bf16 v[112:115], v[32:35], v[60:63], v[112:115]
s_add_u32 s16, s16, 2048
v_mfma_f32_16x16x32_bf16 v[116:119], v[36:39], v[60:63], v[116:119]
v_mfma_f32_16x16x32_bf16 v[120:123], v[40:43], v[60:63], v[120:123]
v_mfma_f32_16x16x32_bf16 v[124:127], v[44:47], v[60:63], v[124:127]
s_waitcnt lgkmcnt(0)
ds_read_b128 v[48:51], v136 offset:50176
s_add_u32 m0, s19, 32768
s_nop 0
v_mfma_f32_16x16x32_bf16 v[64:67], v[0:3], v[16:19], v[64:67]
ds_read_b64_tr_b16 v[32:33], v128 offset:57344
v_mfma_f32_16x16x32_bf16 v[68:71], v[4:7], v[16:19], v[68:71]
ds_read_b64_tr_b16 v[34:35], v128 offset:61440
buffer_load_dwordx4 v137, s[8:11], s15 offen offset:0 lds
v_mfma_f32_16x16x32_bf16 v[72:75], v[8:11], v[16:19], v[72:75]
ds_read_b64_tr_b16 v[36:37], v129 offset:57344
v_mfma_f32_16x16x32_bf16 v[76:79], v[12:15], v[16:19], v[76:79]
ds_read_b64_tr_b16 v[38:39], v129 offset:61440
v_mfma_f32_16x16x32_bf16 v[80:83], v[0:3], v[20:23], v[80:83]
ds_read_b64_tr_b16 v[40:41], v130 offset:57344
buffer_load_dwordx4 v138, s[8:11], s15 offen offset:1024 lds
v_mfma_f32_16x16x32_bf16 v[84:87], v[4:7], v[20:23], v[84:87]
ds_read_b64_tr_b16 v[42:43], v130 offset:61440
v_mfma_f32_16x16x32_bf16 v[88:91], v[8:11], v[20:23], v[88:91]
ds_read_b64_tr_b16 v[44:45], v131 offset:57344
v_mfma_f32_16x16x32_bf16 v[92:95], v[12:15], v[20:23], v[92:95]
ds_read_b64_tr_b16 v[46:47], v131 offset:61440
buffer_load_dwordx4 v139, s[8:11], s15 offen offset:2048 lds
v_mfma_f32_16x16x32_bf16 v[96:99], v[0:3], v[24:27], v[96:99]
ds_read_b128 v[52:55], v136 offset:52224
v_mfma_f32_16x16x32_bf16 v[100:103], v[4:7], v[24:27], v[100:103]
ds_read_b128 v[56:59], v136 offset:54272
buffer_load_dwordx4 v140, s[8:11], s15 offen offset:3072 lds
v_mfma_f32_16x16x32_bf16 v[104:107], v[8:11], v[24:27], v[104:107]
ds_read_b128 v[60:63], v136 offset:56320
v_mfma_f32_16x16x32_bf16 v[108:111], v[12:15], v[24:27], v[108:111]
v_mfma_f32_16x16x32_bf16 v[112:115], v[0:3], v[28:31], v[112:115]
s_add_u32 s15, s15, s17
v_mfma_f32_16x16x32_bf16 v[116:119], v[4:7], v[28:31], v[116:119]
v_mfma_f32_16x16x32_bf16 v[120:123], v[8:11], v[28:31], v[120:123]
v_mfma_f32_16x16x32_bf16 v[124:127], v[12:15], v[28:31], v[124:127]
s_waitcnt lgkmcnt(0)
v_mfma_f32_16x16x32_bf16 v[64:67], v[32:35], v[48:51], v[64:67]
s_waitcnt vmcnt(16)
s_barrier
ds_read_b128 v[16:19], v136 offset:0
s_add_u32 m0, s20, 49152
s_nop 0
v_mfma_f32_16x16x32_bf16 v[68:71], v[36:39], v[48:51], v[68:71]
ds_read_b64_tr_b16 v[0:1], v128 offset:0
v_mfma_f32_16x16x32_bf16 v[72:75], v[40:43], v[48:51], v[72:75]
ds_read_b64_tr_b16 v[2:3], v128 offset:4096
buffer_load_dwordx4 v141, s[4:7], s16 offen offset:0 sc1 lds
v_mfma_f32_16x16x32_bf16 v[76:79], v[44:47], v[48:51], v[76:79]
ds_read_b64_tr_b16 v[4:5], v129 offset:0
v_mfma_f32_16x16x32_bf16 v[80:83], v[32:35], v[52:55], v[80:83]
ds_read_b64_tr_b16 v[6:7], v129 offset:4096
v_mfma_f32_16x16x32_bf16 v[84:87], v[36:39], v[52:55], v[84:87]
ds_read_b64_tr_b16 v[8:9], v130 offset:0
buffer_load_dwordx4 v141, s[4:7], s16 offen offset:1024 sc1 lds
v_mfma_f32_16x16x32_bf16 v[88:91], v[40:43], v[52:55], v[88:91]
ds_read_b64_tr_b16 v[10:11], v130 offset:4096
v_mfma_f32_16x16x32_bf16 v[92:95], v[44:47], v[52:55], v[92:95]
ds_read_b64_tr_b16 v[12:13], v131 offset:0
buffer_load_dwordx4 v142, s[4:7], s16 offen offset:2048 sc1 lds
v_mfma_f32_16x16x32_bf16 v[96:99], v[32:35], v[56:59], v[96:99]
ds_read_b64_tr_b16 v[14:15], v131 offset:4096
v_mfma_f32_16x16x32_bf16 v[100:103], v[36:39], v[56:59], v[100:103]
ds_read_b128 v[20:23], v136 offset:2048
v_mfma_f32_16x16x32_bf16 v[104:107], v[40:43], v[56:59], v[104:107]
ds_read_b128 v[24:27], v136 offset:4096
buffer_load_dwordx4 v142, s[4:7], s16 offen offset:3072 sc1 lds
v_mfma_f32_16x16x32_bf16 v[108:111], v[44:47], v[56:59], v[108:111]
ds_read_b128 v[28:31], v136 offset:6144
v_mfma_f32_16x16x32_bf16 v[112:115], v[32:35], v[60:63], v[112:115]
s_add_u32 s16, s16, 2048
v_mfma_f32_16x16x32_bf16 v[116:119], v[36:39], v[60:63], v[116:119]
v_mfma_f32_16x16x32_bf16 v[120:123], v[40:43], v[60:63], v[120:123]
v_mfma_f32_16x16x32_bf16 v[124:127], v[44:47], v[60:63], v[124:127]
s_sub_u32 s18, s18, 1
s_cmp_eq_u32 s18, s55
s_cbranch_scc1 main_kernel_w_c0_n_ev
s_cmp_lg_u32 s18, 0
s_cbranch_scc1 main_kernel_w_c0_n_loop
s_cmp_lg_u32 s73, -1
s_cbranch_scc1 main_kernel_w_epn
s_waitcnt lgkmcnt(0)
ds_read_b128 v[48:51], v136 offset:1024
s_add_u32 m0, s19, 49152
s_nop 0
v_mfma_f32_16x16x32_bf16 v[64:67], v[0:3], v[16:19], v[64:67]
ds_read_b64_tr_b16 v[32:33], v128 offset:8192
s_add_u32 s32, s23, 1
s_bitcmp0_b32 s32, 2
s_cselect_b32 s34, 7, 2
s_cselect_b32 s35, 2, 4
s_lshl_b32 s59, s23, 13
s_add_u32 s59, s59, 0x8404000
v_mfma_f32_16x16x32_bf16 v[68:71], v[4:7], v[16:19], v[68:71]
ds_read_b64_tr_b16 v[34:35], v128 offset:12288
buffer_load_dwordx4 v137, s[8:11], s15 offen offset:0 lds
v_lshrrev_b32 v253, 3, v250
v_add_lshl_u32 v253, s24, v253, 9
v_mfma_f32_16x16x32_bf16 v[72:75], v[8:11], v[16:19], v[72:75]
ds_read_b64_tr_b16 v[36:37], v129 offset:8192
v_and_b32 v254, 3, v250
v_lshl_add_u32 v253, v254, s34, v253
v_mfma_f32_16x16x32_bf16 v[76:79], v[12:15], v[16:19], v[76:79]
ds_read_b64_tr_b16 v[38:39], v129 offset:12288
v_bfe_u32 v254, v250, 2, 1
v_add_u32 v254, s25, v254
v_lshl_add_u32 v248, v254, s35, v253
v_mfma_f32_16x16x32_bf16 v[80:83], v[0:3], v[20:23], v[80:83]
ds_read_b64_tr_b16 v[40:41], v130 offset:8192
buffer_load_dwordx4 v138, s[8:11], s15 offen offset:1024 lds
s_lshl_b32 s0, 4, s54
v_readfirstlane_b32 s28, v249
v_mfma_f32_16x16x32_bf16 v[84:87], v[4:7], v[20:23], v[84:87]
ds_read_b64_tr_b16 v[42:43], v130 offset:12288
s_nop 1
v_cmp_ge_u32 vcc, s28, v229
v_mfma_f32_16x16x32_bf16 v[88:91], v[8:11], v[20:23], v[88:91]
ds_read_b64_tr_b16 v[44:45], v131 offset:8192
s_nop 1
s_bcnt1_i32_b64 s32, vcc
v_mfma_f32_16x16x32_bf16 v[92:95], v[12:15], v[20:23], v[92:95]
ds_read_b64_tr_b16 v[46:47], v131 offset:12288
buffer_load_dwordx4 v139, s[8:11], s15 offen offset:2048 lds
s_sub_u32 s32, s32, 1
v_readlane_b32 s36, v230, s32
s_nop 1
v_mfma_f32_16x16x32_bf16 v[96:99], v[0:3], v[24:27], v[96:99]
ds_read_b128 v[52:55], v136 offset:3072
s_and_b32 s32, s36, 0x7ff
s_sub_u32 s28, s28, s32
v_mfma_f32_16x16x32_bf16 v[100:103], v[4:7], v[24:27], v[100:103]
ds_read_b128 v[56:59], v136 offset:5120
buffer_load_dwordx4 v140, s[8:11], s15 offen offset:3072 lds
s_bfe_u32 s32, s36, 0x3001a
s_lshr_b32 s25, s28, s32
v_mfma_f32_16x16x32_bf16 v[104:107], v[8:11], v[24:27], v[104:107]
ds_read_b128 v[60:63], v136 offset:7168
s_lshl_b32 s33, s25, s32
s_sub_u32 s24, s28, s33
v_mfma_f32_16x16x32_bf16 v[108:111], v[12:15], v[24:27], v[108:111]
s_bfe_u32 s34, s36, 0x1001d
s_lshl_b32 s24, s24, s34
s_bfe_u32 s35, s36, 0x1001e
v_mfma_f32_16x16x32_bf16 v[112:115], v[0:3], v[28:31], v[112:115]
s_add_u32 s15, s15, s17
s_lshl_b32 s25, s25, s35
s_bfe_u32 s32, s36, 0x40011
v_mfma_f32_16x16x32_bf16 v[116:119], v[4:7], v[28:31], v[116:119]
s_add_u32 s24, s24, s32
s_bfe_u32 s32, s36, 0x50015
v_mfma_f32_16x16x32_bf16 v[120:123], v[8:11], v[28:31], v[120:123]
s_add_u32 s25, s25, s32
s_bfe_u32 s23, s36, 0x4000b
v_mfma_f32_16x16x32_bf16 v[124:127], v[12:15], v[28:31], v[124:127]
s_waitcnt lgkmcnt(0)
v_mfma_f32_16x16x32_bf16 v[64:67], v[32:35], v[48:51], v[64:67]
s_waitcnt vmcnt(16)
s_barrier
ds_read_b128 v[16:19], v136 offset:16384
s_add_u32 m0, s20, 0
s_nop 0
s_bfe_u32 s36, s36, 0x6000b
s_lshl_b32 s32, s24, 8
s_or_b32 s36, s36, s32
v_mfma_f32_16x16x32_bf16 v[68:71], v[36:39], v[48:51], v[68:71]
ds_read_b64_tr_b16 v[0:1], v128 offset:16384
s_lshl_b32 s32, s25, 16
s_or_b32 s36, s36, s32
v_mfma_f32_16x16x32_bf16 v[72:75], v[40:43], v[48:51], v[72:75]
ds_read_b64_tr_b16 v[2:3], v128 offset:20480
buffer_load_dwordx4 v141, s[4:7], s16 offen offset:0 sc1 lds
s_cmp_eq_u32 s23, 4
s_cselect_b32 s32, 1, 0
s_sub_u32 s48, s24, s32
v_mfma_f32_16x16x32_bf16 v[76:79], v[44:47], v[48:51], v[76:79]
ds_read_b64_tr_b16 v[4:5], v129 offset:16384
s_max_i32 s48, s48, 0
s_add_u32 s49, s24, s34
s_add_u32 s49, s49, s32
v_mfma_f32_16x16x32_bf16 v[80:83], v[32:35], v[52:55], v[80:83]
ds_read_b64_tr_b16 v[6:7], v129 offset:20480
s_min_u32 s49, s49, 15
s_cmp_eq_u32 s23, 6
s_cselect_b32 s51, 3, 7
v_mfma_f32_16x16x32_bf16 v[84:87], v[36:39], v[52:55], v[84:87]
ds_read_b64_tr_b16 v[8:9], v130 offset:16384
buffer_load_dwordx4 v141, s[4:7], s16 offen offset:1024 sc1 lds
s_cmp_eq_u32 s23, 7
s_cselect_b32 s51, 27, s51
s_cselect_b32 s50, 5, 4
s_add_u32 s33, s25, s35
v_mfma_f32_16x16x32_bf16 v[88:91], v[40:43], v[52:55], v[88:91]
ds_read_b64_tr_b16 v[10:11], v130 offset:20480
s_lshl_b32 s34, s24, 9
s_cmp_eq_u32 s23, 8
s_cselect_b32 s51, 0, s51
s_cselect_b32 s48, s25, s48
s_cselect_b32 s49, s33, s49
v_mfma_f32_16x16x32_bf16 v[92:95], v[44:47], v[52:55], v[92:95]
ds_read_b64_tr_b16 v[12:13], v131 offset:16384
buffer_load_dwordx4 v142, s[4:7], s16 offen offset:2048 sc1 lds
s_cmp_eq_u32 s23, 8
s_cselect_b32 s63, 2, 9
s_cselect_b32 s61, 0, 0x7f000000
s_cselect_b32 s34, s34, 0
v_lshrrev_b32 v228, s50, v250
v_lshlrev_b32 v254, s50, v228
v_mfma_f32_16x16x32_bf16 v[96:99], v[32:35], v[56:59], v[96:99]
ds_read_b64_tr_b16 v[14:15], v131 offset:20480
v_sub_u32 v254, v250, v254
s_cmp_lt_u32 s23, 4
s_cselect_b32 s39, 10, s23
v_mfma_f32_16x16x32_bf16 v[100:103], v[36:39], v[56:59], v[100:103]
ds_read_b128 v[20:23], v136 offset:18432
v_min_u32 v254, s51, v254
s_lshl_b32 s39, s39, 13
v_mfma_f32_16x16x32_bf16 v[104:107], v[40:43], v[56:59], v[104:107]
ds_read_b128 v[24:27], v136 offset:20480
buffer_load_dwordx4 v142, s[4:7], s16 offen offset:3072 sc1 lds
s_cmp_eq_u32 s23, 3
s_cselect_b32 s34, 4, s34
v_add_u32 v228, s48, v228
v_mfma_f32_16x16x32_bf16 v[108:111], v[44:47], v[56:59], v[108:111]
ds_read_b128 v[28:31], v136 offset:22528
s_add_u32 s39, s39, s34
s_add_u32 s39, s39, 0x8402000
v_min_u32 v228, s49, v228
v_mfma_f32_16x16x32_bf16 v[112:115], v[32:35], v[60:63], v[112:115]
s_add_u32 s16, s16, 2048
s_lshl_b32 s60, s24, 10
s_add_u32 s60, s60, 0x8400000
v_mfma_f32_16x16x32_bf16 v[116:119], v[36:39], v[60:63], v[116:119]
v_lshlrev_b32 v228, s63, v228
v_lshl_add_u32 v228, v254, 4, v228
v_mfma_f32_16x16x32_bf16 v[120:123], v[40:43], v[60:63], v[120:123]
v_or_b32 v146, s61, v251
s_mov_b64 exec, s[100:101]
buffer_load_dword v231, v228, s[4:7], s39 offen sc1
buffer_load_dwordx4 v[232:235], v146, s[4:7], s60 offen sc1
s_mov_b64 exec, -1
v_mfma_f32_16x16x32_bf16 v[124:127], v[44:47], v[60:63], v[124:127]
s_waitcnt lgkmcnt(0)
ds_read_b128 v[48:51], v136 offset:17408
s_add_u32 m0, s19, 0
s_nop 0
v_mfma_f32_16x16x32_bf16 v[64:67], v[0:3], v[16:19], v[64:67]
ds_read_b64_tr_b16 v[32:33], v128 offset:24576
s_mov_b32 s1, s21
v_mfma_f32_16x16x32_bf16 v[68:71], v[4:7], v[16:19], v[68:71]
ds_read_b64_tr_b16 v[34:35], v128 offset:28672
buffer_load_dwordx4 v137, s[8:11], s15 offen offset:0 lds
s_mov_b32 s2, s22
v_mfma_f32_16x16x32_bf16 v[72:75], v[8:11], v[16:19], v[72:75]
ds_read_b64_tr_b16 v[36:37], v129 offset:24576
s_mov_b32 s3, s26
v_mfma_f32_16x16x32_bf16 v[76:79], v[12:15], v[16:19], v[76:79]
ds_read_b64_tr_b16 v[38:39], v129 offset:28672
s_mov_b32 s56, s57
v_mfma_f32_16x16x32_bf16 v[80:83], v[0:3], v[20:23], v[80:83]
ds_read_b64_tr_b16 v[40:41], v130 offset:24576
buffer_load_dwordx4 v138, s[8:11], s15 offen offset:1024 lds
v_mfma_f32_16x16x32_bf16 v[84:87], v[4:7], v[20:23], v[84:87]
ds_read_b64_tr_b16 v[42:43], v130 offset:28672
v_mov_b32 v145, v252
v_mfma_f32_16x16x32_bf16 v[88:91], v[8:11], v[20:23], v[88:91]
ds_read_b64_tr_b16 v[44:45], v131 offset:24576
v_mov_b32 v255, 131072
v_mfma_f32_16x16x32_bf16 v[92:95], v[12:15], v[20:23], v[92:95]
ds_read_b64_tr_b16 v[46:47], v131 offset:28672
buffer_load_dwordx4 v139, s[8:11], s15 offen offset:2048 lds
s_add_u32 s32, s3, 0
v_mfma_f32_16x16x32_bf16 v[96:99], v[0:3], v[24:27], v[96:99]
ds_read_b128 v[52:55], v136 offset:19456
buffer_load_dwordx4 v[192:195], v251, s[4:7], s32 offen offset:0 sc1
v_mfma_f32_16x16x32_bf16 v[100:103], v[4:7], v[24:27], v[100:103]
ds_read_b128 v[56:59], v136 offset:21504
buffer_load_dwordx4 v140, s[8:11], s15 offen offset:3072 lds
v_mfma_f32_16x16x32_bf16 v[104:107], v[8:11], v[24:27], v[104:107]
ds_read_b128 v[60:63], v136 offset:23552
buffer_load_dwordx4 v[196:199], v251, s[4:7], s32 offen offset:1024 sc1
v_mfma_f32_16x16x32_bf16 v[108:111], v[12:15], v[24:27], v[108:111]
s_add_u32 s32, s3, 32768
v_mfma_f32_16x16x32_bf16 v[112:115], v[0:3], v[28:31], v[112:115]
s_add_u32 s15, s15, s17
buffer_load_dwordx4 v[200:203], v251, s[4:7], s32 offen offset:0 sc1
v_mfma_f32_16x16x32_bf16 v[116:119], v[4:7], v[28:31], v[116:119]
buffer_load_dwordx4 v[204:207], v251, s[4:7], s32 offen offset:1024 sc1
v_mfma_f32_16x16x32_bf16 v[120:123], v[8:11], v[28:31], v[120:123]
v_mfma_f32_16x16x32_bf16 v[124:127], v[12:15], v[28:31], v[124:127]
s_waitcnt lgkmcnt(0)
v_mfma_f32_16x16x32_bf16 v[64:67], v[32:35], v[48:51], v[64:67]
s_waitcnt vmcnt(20)
s_barrier
ds_read_b128 v[16:19], v136 offset:32768
s_add_u32 m0, s20, 16384
s_nop 0
s_add_u32 s32, s3, 65536
v_mfma_f32_16x16x32_bf16 v[68:71], v[36:39], v[48:51], v[68:71]
ds_read_b64_tr_b16 v[0:1], v128 offset:32768
v_mfma_f32_16x16x32_bf16 v[72:75], v[40:43], v[48:51], v[72:75]
ds_read_b64_tr_b16 v[2:3], v128 offset:36864
buffer_load_dwordx4 v141, s[4:7], s16 offen offset:0 sc1 lds
buffer_load_dwordx4 v[208:211], v251, s[4:7], s32 offen offset:0 sc1
v_mfma_f32_16x16x32_bf16 v[76:79], v[44:47], v[48:51], v[76:79]
ds_read_b64_tr_b16 v[4:5], v129 offset:32768
v_mfma_f32_16x16x32_bf16 v[80:83], v[32:35], v[52:55], v[80:83]
ds_read_b64_tr_b16 v[6:7], v129 offset:36864
v_mfma_f32_16x16x32_bf16 v[84:87], v[36:39], v[52:55], v[84:87]
ds_read_b64_tr_b16 v[8:9], v130 offset:32768
buffer_load_dwordx4 v141, s[4:7], s16 offen offset:1024 sc1 lds
buffer_load_dwordx4 v[212:215], v251, s[4:7], s32 offen offset:1024 sc1
v_mfma_f32_16x16x32_bf16 v[88:91], v[40:43], v[52:55], v[88:91]
ds_read_b64_tr_b16 v[10:11], v130 offset:36864
v_mfma_f32_16x16x32_bf16 v[92:95], v[44:47], v[52:55], v[92:95]
ds_read_b64_tr_b16 v[12:13], v131 offset:32768
buffer_load_dwordx4 v142, s[4:7], s16 offen offset:2048 sc1 lds
s_add_u32 s32, s3, 98304
v_mfma_f32_16x16x32_bf16 v[96:99], v[32:35], v[56:59], v[96:99]
ds_read_b64_tr_b16 v[14:15], v131 offset:36864
v_mfma_f32_16x16x32_bf16 v[100:103], v[36:39], v[56:59], v[100:103]
ds_read_b128 v[20:23], v136 offset:34816
v_mfma_f32_16x16x32_bf16 v[104:107], v[40:43], v[56:59], v[104:107]
ds_read_b128 v[24:27], v136 offset:36864
buffer_load_dwordx4 v142, s[4:7], s16 offen offset:3072 sc1 lds
buffer_load_dwordx4 v[216:219], v251, s[4:7], s32 offen offset:0 sc1
v_mfma_f32_16x16x32_bf16 v[108:111], v[44:47], v[56:59], v[108:111]
ds_read_b128 v[28:31], v136 offset:38912
v_mfma_f32_16x16x32_bf16 v[112:115], v[32:35], v[60:63], v[112:115]
s_add_u32 s16, s16, 2048
buffer_load_dwordx4 v[220:223], v251, s[4:7], s32 offen offset:1024 sc1
v_mfma_f32_16x16x32_bf16 v[116:119], v[36:39], v[60:63], v[116:119]
v_mfma_f32_16x16x32_bf16 v[120:123], v[40:43], v[60:63], v[120:123]
v_mfma_f32_16x16x32_bf16 v[124:127], v[44:47], v[60:63], v[124:127]
s_cmp_lg_u32 s56, 5
s_cbranch_scc1 main_kernel_w_c0_n_nox
s_add_u32 s32, s1, 0
buffer_load_dwordx4 v[160:163], v145, s[96:99], s32 offen offset:0
buffer_load_dwordx4 v[164:167], v145, s[96:99], s32 offen offset:64
s_add_u32 s32, s1, 32768
buffer_load_dwordx4 v[168:171], v145, s[96:99], s32 offen offset:0
buffer_load_dwordx4 v[172:175], v145, s[96:99], s32 offen offset:64
s_add_u32 s32, s1, 65536
buffer_load_dwordx4 v[176:179], v145, s[96:99], s32 offen offset:0
buffer_load_dwordx4 v[180:183], v145, s[96:99], s32 offen offset:64
s_add_u32 s32, s1, 98304
buffer_load_dwordx4 v[184:187], v145, s[96:99], s32 offen offset:0
buffer_load_dwordx4 v[188:191], v145, s[96:99], s32 offen offset:64
main_kernel_w_c0_n_nox:
s_waitcnt lgkmcnt(0)
ds_read_b128 v[48:51], v136 offset:33792
s_add_u32 m0, s19, 16384
s_nop 0
v_mfma_f32_16x16x32_bf16 v[64:67], v[0:3], v[16:19], v[64:67]
ds_read_b64_tr_b16 v[32:33], v128 offset:40960
v_mfma_f32_16x16x32_bf16 v[68:71], v[4:7], v[16:19], v[68:71]
ds_read_b64_tr_b16 v[34:35], v128 offset:45056
buffer_load_dwordx4 v137, s[8:11], s15 offen offset:0 lds
v_mfma_f32_16x16x32_bf16 v[72:75], v[8:11], v[16:19], v[72:75]
ds_read_b64_tr_b16 v[36:37], v129 offset:40960
v_mfma_f32_16x16x32_bf16 v[76:79], v[12:15], v[16:19], v[76:79]
ds_read_b64_tr_b16 v[38:39], v129 offset:45056
v_mfma_f32_16x16x32_bf16 v[80:83], v[0:3], v[20:23], v[80:83]
ds_read_b64_tr_b16 v[40:41], v130 offset:40960
buffer_load_dwordx4 v138, s[8:11], s15 offen offset:1024 lds
v_mfma_f32_16x16x32_bf16 v[84:87], v[4:7], v[20:23], v[84:87]
ds_read_b64_tr_b16 v[42:43], v130 offset:45056
v_mfma_f32_16x16x32_bf16 v[88:91], v[8:11], v[20:23], v[88:91]
ds_read_b64_tr_b16 v[44:45], v131 offset:40960
v_mfma_f32_16x16x32_bf16 v[92:95], v[12:15], v[20:23], v[92:95]
ds_read_b64_tr_b16 v[46:47], v131 offset:45056
buffer_load_dwordx4 v139, s[8:11], s15 offen offset:2048 lds
v_mfma_f32_16x16x32_bf16 v[96:99], v[0:3], v[24:27], v[96:99]
ds_read_b128 v[52:55], v136 offset:35840
v_mfma_f32_16x16x32_bf16 v[100:103], v[4:7], v[24:27], v[100:103]
ds_read_b128 v[56:59], v136 offset:37888
buffer_load_dwordx4 v140, s[8:11], s15 offen offset:3072 lds
v_mfma_f32_16x16x32_bf16 v[104:107], v[8:11], v[24:27], v[104:107]
ds_read_b128 v[60:63], v136 offset:39936
v_mfma_f32_16x16x32_bf16 v[108:111], v[12:15], v[24:27], v[108:111]
v_mfma_f32_16x16x32_bf16 v[112:115], v[0:3], v[28:31], v[112:115]
s_add_u32 s15, s15, s17
v_mfma_f32_16x16x32_bf16 v[116:119], v[4:7], v[28:31], v[116:119]
v_mfma_f32_16x16x32_bf16 v[120:123], v[8:11], v[28:31], v[120:123]
v_mfma_f32_16x16x32_bf16 v[124:127], v[12:15], v[28:31], v[124:127]
s_waitcnt lgkmcnt(0)
v_mfma_f32_16x16x32_bf16 v[64:67], v[32:35], v[48:51], v[64:67]
s_waitcnt vmcnt(24)
s_barrier
ds_read_b128 v[16:19], v136 offset:49152
s_add_u32 m0, s20, 32768
s_nop 0
v_mfma_f32_16x16x32_bf16 v[68:71], v[36:39], v[48:51], v[68:71]
ds_read_b64_tr_b16 v[0:1], v128 offset:49152
v_mfma_f32_16x16x32_bf16 v[72:75], v[40:43], v[48:51], v[72:75]
ds_read_b64_tr_b16 v[2:3], v128 offset:53248
buffer_load_dwordx4 v141, s[4:7], s16 offen offset:0 sc1 lds
v_mfma_f32_16x16x32_bf16 v[76:79], v[44:47], v[48:51], v[76:79]
ds_read_b64_tr_b16 v[4:5], v129 offset:49152
v_mfma_f32_16x16x32_bf16 v[80:83], v[32:35], v[52:55], v[80:83]
ds_read_b64_tr_b16 v[6:7], v129 offset:53248
s_waitcnt vmcnt(21)
v_mfma_f32_16x16x32_bf16 v[84:87], v[36:39], v[52:55], v[84:87]
ds_read_b64_tr_b16 v[8:9], v130 offset:49152
buffer_load_dwordx4 v141, s[4:7], s16 offen offset:1024 sc1 lds
v_min3_u32 v253, v232, v233, v234
v_mfma_f32_16x16x32_bf16 v[88:91], v[40:43], v[52:55], v[88:91]
ds_read_b64_tr_b16 v[10:11], v130 offset:53248
v_min_u32 v253, v253, v235
v_mfma_f32_16x16x32_bf16 v[92:95], v[44:47], v[52:55], v[92:95]
ds_read_b64_tr_b16 v[12:13], v131 offset:49152
buffer_load_dwordx4 v142, s[4:7], s16 offen offset:2048 sc1 lds
v_or_b32 v253, s61, v253
v_mfma_f32_16x16x32_bf16 v[96:99], v[32:35], v[56:59], v[96:99]
ds_read_b64_tr_b16 v[14:15], v131 offset:53248
v_min_u32 v253, v253, v231
v_mfma_f32_16x16x32_bf16 v[100:103], v[36:39], v[56:59], v[100:103]
ds_read_b128 v[20:23], v136 offset:51200
v_cmp_eq_u32 vcc, 0, v253
v_mfma_f32_16x16x32_bf16 v[104:107], v[40:43], v[56:59], v[104:107]
ds_read_b128 v[24:27], v136 offset:53248
buffer_load_dwordx4 v142, s[4:7], s16 offen offset:3072 sc1 lds
s_nop 1
v_mfma_f32_16x16x32_bf16 v[108:111], v[44:47], v[56:59], v[108:111]
ds_read_b128 v[28:31], v136 offset:55296
s_cmp_eq_u64 vcc, 0
s_cselect_b32 s32, s36, -4
v_mfma_f32_16x16x32_bf16 v[112:115], v[32:35], v[60:63], v[112:115]
s_add_u32 s16, s16, 2048
s_bitcmp1_b32 0x1df, s23
s_cselect_b32 s32, s32, -4
v_mfma_f32_16x16x32_bf16 v[116:119], v[36:39], v[60:63], v[116:119]
v_mov_b32 v254, s32
v_mfma_f32_16x16x32_bf16 v[120:123], v[40:43], v[60:63], v[120:123]
s_mov_b64 exec, s[100:101]
ds_write_b32 v255, v254
s_mov_b64 exec, -1
v_mfma_f32_16x16x32_bf16 v[124:127], v[44:47], v[60:63], v[124:127]
s_waitcnt lgkmcnt(0)
ds_read_b128 v[48:51], v136 offset:50176
s_add_u32 m0, s19, 32768
s_nop 0
v_mfma_f32_16x16x32_bf16 v[64:67], v[0:3], v[16:19], v[64:67]
ds_read_b64_tr_b16 v[32:33], v128 offset:57344
v_mfma_f32_16x16x32_bf16 v[68:71], v[4:7], v[16:19], v[68:71]
ds_read_b64_tr_b16 v[34:35], v128 offset:61440
buffer_load_dwordx4 v137, s[8:11], s15 offen offset:0 lds
v_mfma_f32_16x16x32_bf16 v[72:75], v[8:11], v[16:19], v[72:75]
ds_read_b64_tr_b16 v[36:37], v129 offset:57344
v_mfma_f32_16x16x32_bf16 v[76:79], v[12:15], v[16:19], v[76:79]
ds_read_b64_tr_b16 v[38:39], v129 offset:61440
v_mfma_f32_16x16x32_bf16 v[80:83], v[0:3], v[20:23], v[80:83]
ds_read_b64_tr_b16 v[40:41], v130 offset:57344
buffer_load_dwordx4 v138, s[8:11], s15 offen offset:1024 lds
v_mfma_f32_16x16x32_bf16 v[84:87], v[4:7], v[20:23], v[84:87]
ds_read_b64_tr_b16 v[42:43], v130 offset:61440
v_mfma_f32_16x16x32_bf16 v[88:91], v[8:11], v[20:23], v[88:91]
ds_read_b64_tr_b16 v[44:45], v131 offset:57344
v_mfma_f32_16x16x32_bf16 v[92:95], v[12:15], v[20:23], v[92:95]
ds_read_b64_tr_b16 v[46:47], v131 offset:61440
buffer_load_dwordx4 v139, s[8:11], s15 offen offset:2048 lds
v_mfma_f32_16x16x32_bf16 v[96:99], v[0:3], v[24:27], v[96:99]
ds_read_b128 v[52:55], v136 offset:52224
v_mfma_f32_16x16x32_bf16 v[100:103], v[4:7], v[24:27], v[100:103]
ds_read_b128 v[56:59], v136 offset:54272
buffer_load_dwordx4 v140, s[8:11], s15 offen offset:3072 lds
v_mfma_f32_16x16x32_bf16 v[104:107], v[8:11], v[24:27], v[104:107]
ds_read_b128 v[60:63], v136 offset:56320
v_mfma_f32_16x16x32_bf16 v[108:111], v[12:15], v[24:27], v[108:111]
v_mfma_f32_16x16x32_bf16 v[112:115], v[0:3], v[28:31], v[112:115]
s_add_u32 s15, s15, s17
v_mfma_f32_16x16x32_bf16 v[116:119], v[4:7], v[28:31], v[116:119]
v_mfma_f32_16x16x32_bf16 v[120:123], v[8:11], v[28:31], v[120:123]
v_mfma_f32_16x16x32_bf16 v[124:127], v[12:15], v[28:31], v[124:127]
s_waitcnt lgkmcnt(0)
v_mfma_f32_16x16x32_bf16 v[64:67], v[32:35], v[48:51], v[64:67]
s_waitcnt vmcnt(23)
s_barrier
ds_read_b128 v[16:19], v136 offset:0
s_add_u32 m0, s20, 49152
s_nop 0
ds_read_b32 v254, v255
v_mfma_f32_16x16x32_bf16 v[68:71], v[36:39], v[48:51], v[68:71]
ds_read_b64_tr_b16 v[0:1], v128 offset:0
v_mfma_f32_16x16x32_bf16 v[72:75], v[40:43], v[48:51], v[72:75]
ds_read_b64_tr_b16 v[2:3], v128 offset:4096
buffer_load_dwordx4 v141, s[4:7], s16 offen offset:0 sc1 lds
v_mfma_f32_16x16x32_bf16 v[76:79], v[44:47], v[48:51], v[76:79]
ds_read_b64_tr_b16 v[4:5], v129 offset:0
v_mfma_f32_16x16x32_bf16 v[80:83], v[32:35], v[52:55], v[80:83]
ds_read_b64_tr_b16 v[6:7], v129 offset:4096
v_mfma_f32_16x16x32_bf16 v[84:87], v[36:39], v[52:55], v[84:87]
ds_read_b64_tr_b16 v[8:9], v130 offset:0
buffer_load_dwordx4 v141, s[4:7], s16 offen offset:1024 sc1 lds
v_mfma_f32_16x16x32_bf16 v[88:91], v[40:43], v[52:55], v[88:91]
ds_read_b64_tr_b16 v[10:11], v130 offset:4096
v_mfma_f32_16x16x32_bf16 v[92:95], v[44:47], v[52:55], v[92:95]
ds_read_b64_tr_b16 v[12:13], v131 offset:0
buffer_load_dwordx4 v142, s[4:7], s16 offen offset:2048 sc1 lds
v_mfma_f32_16x16x32_bf16 v[96:99], v[32:35], v[56:59], v[96:99]
ds_read_b64_tr_b16 v[14:15], v131 offset:4096
v_mfma_f32_16x16x32_bf16 v[100:103], v[36:39], v[56:59], v[100:103]
ds_read_b128 v[20:23], v136 offset:2048
v_mfma_f32_16x16x32_bf16 v[104:107], v[40:43], v[56:59], v[104:107]
ds_read_b128 v[24:27], v136 offset:4096
buffer_load_dwordx4 v142, s[4:7], s16 offen offset:3072 sc1 lds
v_mfma_f32_16x16x32_bf16 v[108:111], v[44:47], v[56:59], v[108:111]
ds_read_b128 v[28:31], v136 offset:6144
v_mfma_f32_16x16x32_bf16 v[112:115], v[32:35], v[60:63], v[112:115]
s_add_u32 s16, s16, 2048
v_mfma_f32_16x16x32_bf16 v[116:119], v[36:39], v[60:63], v[116:119]
v_mfma_f32_16x16x32_bf16 v[120:123], v[40:43], v[60:63], v[120:123]
v_mfma_f32_16x16x32_bf16 v[124:127], v[44:47], v[60:63], v[124:127]
s_waitcnt lgkmcnt(0)
ds_read_b128 v[48:51], v136 offset:1024
s_add_u32 m0, s19, 49152
s_nop 0
v_mfma_f32_16x16x32_bf16 v[64:67], v[0:3], v[16:19], v[64:67]
ds_read_b64_tr_b16 v[32:33], v128 offset:8192
v_readfirstlane_b32 s62, v254
v_mfma_f32_16x16x32_bf16 v[68:71], v[4:7], v[16:19], v[68:71]
ds_read_b64_tr_b16 v[34:35], v128 offset:12288
buffer_load_dwordx4 v137, s[8:11], s15 offen offset:0 lds
v_mfma_f32_16x16x32_bf16 v[72:75], v[8:11], v[16:19], v[72:75]
ds_read_b64_tr_b16 v[36:37], v129 offset:8192
s_nop 1
v_mfma_f32_16x16x32_bf16 v[76:79], v[12:15], v[16:19], v[76:79]
ds_read_b64_tr_b16 v[38:39], v129 offset:12288
v_mfma_f32_16x16x32_bf16 v[80:83], v[0:3], v[20:23], v[80:83]
ds_read_b64_tr_b16 v[40:41], v130 offset:8192
buffer_load_dwordx4 v138, s[8:11], s15 offen offset:1024 lds
v_mfma_f32_16x16x32_bf16 v[84:87], v[4:7], v[20:23], v[84:87]
ds_read_b64_tr_b16 v[42:43], v130 offset:12288
s_and_b32 s23, s62, 15
v_mfma_f32_16x16x32_bf16 v[88:91], v[8:11], v[20:23], v[88:91]
ds_read_b64_tr_b16 v[44:45], v131 offset:8192
v_mfma_f32_16x16x32_bf16 v[92:95], v[12:15], v[20:23], v[92:95]
ds_read_b64_tr_b16 v[46:47], v131 offset:12288
buffer_load_dwordx4 v139, s[8:11], s15 offen offset:2048 lds
s_bfe_u32 s54, s62, 0x20004
v_mfma_f32_16x16x32_bf16 v[96:99], v[0:3], v[24:27], v[96:99]
ds_read_b128 v[52:55], v136 offset:3072
v_mfma_f32_16x16x32_bf16 v[100:103], v[4:7], v[24:27], v[100:103]
ds_read_b128 v[56:59], v136 offset:5120
buffer_load_dwordx4 v140, s[8:11], s15 offen offset:3072 lds
v_mfma_f32_16x16x32_bf16 v[104:107], v[8:11], v[24:27], v[104:107]
ds_read_b128 v[60:63], v136 offset:7168
s_bfe_u32 s24, s62, 0x80008
v_mfma_f32_16x16x32_bf16 v[108:111], v[12:15], v[24:27], v[108:111]
v_mfma_f32_16x16x32_bf16 v[112:115], v[0:3], v[28:31], v[112:115]
s_add_u32 s15, s15, s17
s_lshr_b32 s25, s62, 16
v_mfma_f32_16x16x32_bf16 v[116:119], v[4:7], v[28:31], v[116:119]
v_mfma_f32_16x16x32_bf16 v[120:123], v[8:11], v[28:31], v[120:123]
v_mfma_f32_16x16x32_bf16 v[124:127], v[12:15], v[28:31], v[124:127]
s_cmp_eq_u32 s54, 0
s_cselect_b32 s73, 0, -1
s_cbranch_scc1 main_kernel_w_c0_task
s_waitcnt lgkmcnt(0)
v_mfma_f32_16x16x32_bf16 v[64:67], v[32:35], v[48:51], v[64:67]
s_waitcnt vmcnt(16)
s_barrier
ds_read_b128 v[16:19], v136 offset:16384
v_mfma_f32_16x16x32_bf16 v[68:71], v[36:39], v[48:51], v[68:71]
ds_read_b64_tr_b16 v[0:1], v128 offset:16384
v_mfma_f32_16x16x32_bf16 v[72:75], v[40:43], v[48:51], v[72:75]
ds_read_b64_tr_b16 v[2:3], v128 offset:20480
v_mfma_f32_16x16x32_bf16 v[76:79], v[44:47], v[48:51], v[76:79]
ds_read_b64_tr_b16 v[4:5], v129 offset:16384
v_mfma_f32_16x16x32_bf16 v[80:83], v[32:35], v[52:55], v[80:83]
ds_read_b64_tr_b16 v[6:7], v129 offset:20480
v_mfma_f32_16x16x32_bf16 v[84:87], v[36:39], v[52:55], v[84:87]
ds_read_b64_tr_b16 v[8:9], v130 offset:16384
v_mfma_f32_16x16x32_bf16 v[88:91], v[40:43], v[52:55], v[88:91]
ds_read_b64_tr_b16 v[10:11], v130 offset:20480
v_mfma_f32_16x16x32_bf16 v[92:95], v[44:47], v[52:55], v[92:95]
ds_read_b64_tr_b16 v[12:13], v131 offset:16384
v_mfma_f32_16x16x32_bf16 v[96:99], v[32:35], v[56:59], v[96:99]
ds_read_b64_tr_b16 v[14:15], v131 offset:20480
v_mfma_f32_16x16x32_bf16 v[100:103], v[36:39], v[56:59], v[100:103]
ds_read_b128 v[20:23], v136 offset:18432
v_mfma_f32_16x16x32_bf16 v[104:107], v[40:43], v[56:59], v[104:107]
ds_read_b128 v[24:27], v136 offset:20480
v_mfma_f32_16x16x32_bf16 v[108:111], v[44:47], v[56:59], v[108:111]
ds_read_b128 v[28:31], v136 offset:22528
v_mfma_f32_16x16x32_bf16 v[112:115], v[32:35], v[60:63], v[112:115]
v_mfma_f32_16x16x32_bf16 v[116:119], v[36:39], v[60:63], v[116:119]
v_mfma_f32_16x16x32_bf16 v[120:123], v[40:43], v[60:63], v[120:123]
v_mfma_f32_16x16x32_bf16 v[124:127], v[44:47], v[60:63], v[124:127]
s_waitcnt lgkmcnt(0)
ds_read_b128 v[48:51], v136 offset:17408
v_mfma_f32_16x16x32_bf16 v[64:67], v[0:3], v[16:19], v[64:67]
ds_read_b64_tr_b16 v[32:33], v128 offset:24576
v_mfma_f32_16x16x32_bf16 v[68:71], v[4:7], v[16:19], v[68:71]
ds_read_b64_tr_b16 v[34:35], v128 offset:28672
v_mfma_f32_16x16x32_bf16 v[72:75], v[8:11], v[16:19], v[72:75]
ds_read_b64_tr_b16 v[36:37], v129 offset:24576
v_mfma_f32_16x16x32_bf16 v[76:79], v[12:15], v[16:19], v[76:79]
ds_read_b64_tr_b16 v[38:39], v129 offset:28672
v_mfma_f32_16x16x32_bf16 v[80:83], v[0:3], v[20:23], v[80:83]
ds_read_b64_tr_b16 v[40:41], v130 offset:24576
v_mfma_f32_16x16x32_bf16 v[84:87], v[4:7], v[20:23], v[84:87]
ds_read_b64_tr_b16 v[42:43], v130 offset:28672
v_mfma_f32_16x16x32_bf16 v[88:91], v[8:11], v[20:23], v[88:91]
ds_read_b64_tr_b16 v[44:45], v131 offset:24576
v_mfma_f32_16x16x32_bf16 v[92:95], v[12:15], v[20:23], v[92:95]
ds_read_b64_tr_b16 v[46:47], v131 offset:28672
v_mfma_f32_16x16x32_bf16 v[96:99], v[0:3], v[24:27], v[96:99]
ds_read_b128 v[52:55], v136 offset:19456
v_mfma_f32_16x16x32_bf16 v[100:103], v[4:7], v[24:27], v[100:103]
ds_read_b128 v[56:59], v136 offset:21504
v_mfma_f32_16x16x32_bf16 v[104:107], v[8:11], v[24:27], v[104:107]
ds_read_b128 v[60:63], v136 offset:23552
v_mfma_f32_16x16x32_bf16 v[108:111], v[12:15], v[24:27], v[108:111]
v_mfma_f32_16x16x32_bf16 v[112:115], v[0:3], v[28:31], v[112:115]
v_mfma_f32_16x16x32_bf16 v[116:119], v[4:7], v[28:31], v[116:119]
v_mfma_f32_16x16x32_bf16 v[120:123], v[8:11], v[28:31], v[120:123]
v_mfma_f32_16x16x32_bf16 v[124:127], v[12:15], v[28:31], v[124:127]
s_waitcnt lgkmcnt(0)
v_mfma_f32_16x16x32_bf16 v[64:67], v[32:35], v[48:51], v[64:67]
s_waitcnt vmcnt(8)
s_barrier
ds_read_b128 v[16:19], v136 offset:32768
v_mfma_f32_16x16x32_bf16 v[68:71], v[36:39], v[48:51], v[68:71]
ds_read_b64_tr_b16 v[0:1], v128 offset:32768
v_mfma_f32_16x16x32_bf16 v[72:75], v[40:43], v[48:51], v[72:75]
ds_read_b64_tr_b16 v[2:3], v128 offset:36864
v_mfma_f32_16x16x32_bf16 v[76:79], v[44:47], v[48:51], v[76:79]
ds_read_b64_tr_b16 v[4:5], v129 offset:32768
v_mfma_f32_16x16x32_bf16 v[80:83], v[32:35], v[52:55], v[80:83]
ds_read_b64_tr_b16 v[6:7], v129 offset:36864
v_mfma_f32_16x16x32_bf16 v[84:87], v[36:39], v[52:55], v[84:87]
ds_read_b64_tr_b16 v[8:9], v130 offset:32768
v_mfma_f32_16x16x32_bf16 v[88:91], v[40:43], v[52:55], v[88:91]
ds_read_b64_tr_b16 v[10:11], v130 offset:36864
v_mfma_f32_16x16x32_bf16 v[92:95], v[44:47], v[52:55], v[92:95]
ds_read_b64_tr_b16 v[12:13], v131 offset:32768
v_mfma_f32_16x16x32_bf16 v[96:99], v[32:35], v[56:59], v[96:99]
ds_read_b64_tr_b16 v[14:15], v131 offset:36864
v_mfma_f32_16x16x32_bf16 v[100:103], v[36:39], v[56:59], v[100:103]
ds_read_b128 v[20:23], v136 offset:34816
v_mfma_f32_16x16x32_bf16 v[104:107], v[40:43], v[56:59], v[104:107]
ds_read_b128 v[24:27], v136 offset:36864
v_mfma_f32_16x16x32_bf16 v[108:111], v[44:47], v[56:59], v[108:111]
ds_read_b128 v[28:31], v136 offset:38912
v_mfma_f32_16x16x32_bf16 v[112:115], v[32:35], v[60:63], v[112:115]
v_mfma_f32_16x16x32_bf16 v[116:119], v[36:39], v[60:63], v[116:119]
v_mfma_f32_16x16x32_bf16 v[120:123], v[40:43], v[60:63], v[120:123]
v_mfma_f32_16x16x32_bf16 v[124:127], v[44:47], v[60:63], v[124:127]
s_waitcnt lgkmcnt(0)
ds_read_b128 v[48:51], v136 offset:33792
v_mfma_f32_16x16x32_bf16 v[64:67], v[0:3], v[16:19], v[64:67]
ds_read_b64_tr_b16 v[32:33], v128 offset:40960
v_mfma_f32_16x16x32_bf16 v[68:71], v[4:7], v[16:19], v[68:71]
ds_read_b64_tr_b16 v[34:35], v128 offset:45056
v_mfma_f32_16x16x32_bf16 v[72:75], v[8:11], v[16:19], v[72:75]
ds_read_b64_tr_b16 v[36:37], v129 offset:40960
v_mfma_f32_16x16x32_bf16 v[76:79], v[12:15], v[16:19], v[76:79]
ds_read_b64_tr_b16 v[38:39], v129 offset:45056
v_mfma_f32_16x16x32_bf16 v[80:83], v[0:3], v[20:23], v[80:83]
ds_read_b64_tr_b16 v[40:41], v130 offset:40960
v_mfma_f32_16x16x32_bf16 v[84:87], v[4:7], v[20:23], v[84:87]
ds_read_b64_tr_b16 v[42:43], v130 offset:45056
v_mfma_f32_16x16x32_bf16 v[88:91], v[8:11], v[20:23], v[88:91]
ds_read_b64_tr_b16 v[44:45], v131 offset:40960
v_mfma_f32_16x16x32_bf16 v[92:95], v[12:15], v[20:23], v[92:95]
ds_read_b64_tr_b16 v[46:47], v131 offset:45056
v_mfma_f32_16x16x32_bf16 v[96:99], v[0:3], v[24:27], v[96:99]
ds_read_b128 v[52:55], v136 offset:35840
v_mfma_f32_16x16x32_bf16 v[100:103], v[4:7], v[24:27], v[100:103]
ds_read_b128 v[56:59], v136 offset:37888
v_mfma_f32_16x16x32_bf16 v[104:107], v[8:11], v[24:27], v[104:107]
ds_read_b128 v[60:63], v136 offset:39936
v_mfma_f32_16x16x32_bf16 v[108:111], v[12:15], v[24:27], v[108:111]
v_mfma_f32_16x16x32_bf16 v[112:115], v[0:3], v[28:31], v[112:115]
v_mfma_f32_16x16x32_bf16 v[116:119], v[4:7], v[28:31], v[116:119]
v_mfma_f32_16x16x32_bf16 v[120:123], v[8:11], v[28:31], v[120:123]
v_mfma_f32_16x16x32_bf16 v[124:127], v[12:15], v[28:31], v[124:127]
s_waitcnt lgkmcnt(0)
v_mfma_f32_16x16x32_bf16 v[64:67], v[32:35], v[48:51], v[64:67]
s_waitcnt vmcnt(0)
s_barrier
ds_read_b128 v[16:19], v136 offset:49152
v_mfma_f32_16x16x32_bf16 v[68:71], v[36:39], v[48:51], v[68:71]
ds_read_b64_tr_b16 v[0:1], v128 offset:49152
v_mfma_f32_16x16x32_bf16 v[72:75], v[40:43], v[48:51], v[72:75]
ds_read_b64_tr_b16 v[2:3], v128 offset:53248
v_mfma_f32_16x16x32_bf16 v[76:79], v[44:47], v[48:51], v[76:79]
ds_read_b64_tr_b16 v[4:5], v129 offset:49152
v_mfma_f32_16x16x32_bf16 v[80:83], v[32:35], v[52:55], v[80:83]
ds_read_b64_tr_b16 v[6:7], v129 offset:53248
v_mfma_f32_16x16x32_bf16 v[84:87], v[36:39], v[52:55], v[84:87]
ds_read_b64_tr_b16 v[8:9], v130 offset:49152
v_mfma_f32_16x16x32_bf16 v[88:91], v[40:43], v[52:55], v[88:91]
ds_read_b64_tr_b16 v[10:11], v130 offset:53248
v_mfma_f32_16x16x32_bf16 v[92:95], v[44:47], v[52:55], v[92:95]
ds_read_b64_tr_b16 v[12:13], v131 offset:49152
v_mfma_f32_16x16x32_bf16 v[96:99], v[32:35], v[56:59], v[96:99]
ds_read_b64_tr_b16 v[14:15], v131 offset:53248
v_mfma_f32_16x16x32_bf16 v[100:103], v[36:39], v[56:59], v[100:103]
ds_read_b128 v[20:23], v136 offset:51200
v_mfma_f32_16x16x32_bf16 v[104:107], v[40:43], v[56:59], v[104:107]
ds_read_b128 v[24:27], v136 offset:53248
v_mfma_f32_16x16x32_bf16 v[108:111], v[44:47], v[56:59], v[108:111]
ds_read_b128 v[28:31], v136 offset:55296
v_mfma_f32_16x16x32_bf16 v[112:115], v[32:35], v[60:63], v[112:115]
v_mfma_f32_16x16x32_bf16 v[116:119], v[36:39], v[60:63], v[116:119]
v_mfma_f32_16x16x32_bf16 v[120:123], v[40:43], v[60:63], v[120:123]
v_mfma_f32_16x16x32_bf16 v[124:127], v[44:47], v[60:63], v[124:127]
s_waitcnt lgkmcnt(0)
ds_read_b128 v[48:51], v136 offset:50176
v_mfma_f32_16x16x32_bf16 v[64:67], v[0:3], v[16:19], v[64:67]
ds_read_b64_tr_b16 v[32:33], v128 offset:57344
v_mfma_f32_16x16x32_bf16 v[68:71], v[4:7], v[16:19], v[68:71]
ds_read_b64_tr_b16 v[34:35], v128 offset:61440
v_mfma_f32_16x16x32_bf16 v[72:75], v[8:11], v[16:19], v[72:75]
ds_read_b64_tr_b16 v[36:37], v129 offset:57344
v_mfma_f32_16x16x32_bf16 v[76:79], v[12:15], v[16:19], v[76:79]
ds_read_b64_tr_b16 v[38:39], v129 offset:61440
v_mfma_f32_16x16x32_bf16 v[80:83], v[0:3], v[20:23], v[80:83]
ds_read_b64_tr_b16 v[40:41], v130 offset:57344
v_mfma_f32_16x16x32_bf16 v[84:87], v[4:7], v[20:23], v[84:87]
ds_read_b64_tr_b16 v[42:43], v130 offset:61440
v_mfma_f32_16x16x32_bf16 v[88:91], v[8:11], v[20:23], v[88:91]
ds_read_b64_tr_b16 v[44:45], v131 offset:57344
v_mfma_f32_16x16x32_bf16 v[92:95], v[12:15], v[20:23], v[92:95]
ds_read_b64_tr_b16 v[46:47], v131 offset:61440
v_mfma_f32_16x16x32_bf16 v[96:99], v[0:3], v[24:27], v[96:99]
ds_read_b128 v[52:55], v136 offset:52224
v_mfma_f32_16x16x32_bf16 v[100:103], v[4:7], v[24:27], v[100:103]
ds_read_b128 v[56:59], v136 offset:54272
v_mfma_f32_16x16x32_bf16 v[104:107], v[8:11], v[24:27], v[104:107]
ds_read_b128 v[60:63], v136 offset:56320
v_mfma_f32_16x16x32_bf16 v[108:111], v[12:15], v[24:27], v[108:111]
v_mfma_f32_16x16x32_bf16 v[112:115], v[0:3], v[28:31], v[112:115]
v_mfma_f32_16x16x32_bf16 v[116:119], v[4:7], v[28:31], v[116:119]
v_mfma_f32_16x16x32_bf16 v[120:123], v[8:11], v[28:31], v[120:123]
v_mfma_f32_16x16x32_bf16 v[124:127], v[12:15], v[28:31], v[124:127]
s_waitcnt lgkmcnt(0)
v_mfma_f32_16x16x32_bf16 v[64:67], v[32:35], v[48:51], v[64:67]
s_barrier
v_mfma_f32_16x16x32_bf16 v[68:71], v[36:39], v[48:51], v[68:71]
v_mfma_f32_16x16x32_bf16 v[72:75], v[40:43], v[48:51], v[72:75]
v_mfma_f32_16x16x32_bf16 v[76:79], v[44:47], v[48:51], v[76:79]
v_mfma_f32_16x16x32_bf16 v[80:83], v[32:35], v[52:55], v[80:83]
v_mfma_f32_16x16x32_bf16 v[84:87], v[36:39], v[52:55], v[84:87]
v_mfma_f32_16x16x32_bf16 v[88:91], v[40:43], v[52:55], v[88:91]
v_mfma_f32_16x16x32_bf16 v[92:95], v[44:47], v[52:55], v[92:95]
v_mfma_f32_16x16x32_bf16 v[96:99], v[32:35], v[56:59], v[96:99]
v_mfma_f32_16x16x32_bf16 v[100:103], v[36:39], v[56:59], v[100:103]
v_mfma_f32_16x16x32_bf16 v[104:107], v[40:43], v[56:59], v[104:107]
v_mfma_f32_16x16x32_bf16 v[108:111], v[44:47], v[56:59], v[108:111]
v_mfma_f32_16x16x32_bf16 v[112:115], v[32:35], v[60:63], v[112:115]
v_mfma_f32_16x16x32_bf16 v[116:119], v[36:39], v[60:63], v[116:119]
v_mfma_f32_16x16x32_bf16 v[120:123], v[40:43], v[60:63], v[120:123]
v_mfma_f32_16x16x32_bf16 v[124:127], v[44:47], v[60:63], v[124:127]
s_cmp_lg_u32 s62, -4
s_cbranch_scc1 main_kernel_w_gemm
s_branch main_kernel_w_slow
main_kernel_w_c0_n_ev:
s_mov_b32 s55, 1
s_cmp_eq_u32 s56, 0
s_cbranch_scc1 main_kernel_w_c0_n_et
s_bfm_b64 exec, s0, 0
buffer_store_dword v244, v248, s[4:7], s59 offen sc1
s_mov_b64 exec, -1
s_mov_b32 s56, 0
main_kernel_w_c0_n_et:
s_cmp_lg_u32 s18, 1
s_cbranch_scc1 main_kernel_w_c0_n_loop
s_lshl_b32 s32, s27, 8
s_add_u32 s32, s32, 0x841e000
s_mov_b64 exec, 1
v_mov_b32 v249, 1
buffer_atomic_add v249, off, s[4:7], s32 sc0 sc1
s_mov_b64 exec, -1
s_branch main_kernel_w_c0_n_loop
main_kernel_w_c0_gov:
s_mov_b32 s58, 1
s_mov_b32 s72, s18
s_cmp_lg_u32 s73, -1
s_cbranch_scc1 main_kernel_w_c0_str
s_waitcnt lgkmcnt(0)
v_lshrrev_b32 v0, 4, v250
v_bfe_u32 v1, v250, 2, 2
v_lshl_add_u32 v4, v0, 2, v1
v_and_b32 v5, 7, v4
v_mul_u32_u24 v4, 256, v4
v_and_b32 v6, 3, v250
v_lshl_add_u32 v4, v6, 3, v4
s_mul_i32 s32, s37, 4
v_xor_b32 v5, s32, v5
v_lshl_add_u32 v128, v5, 5, v4
v_xor_b32 v129, 32, v128
v_xor_b32 v130, 64, v128
v_xor_b32 v131, 96, v128
s_mul_i32 s32, s38, 8192
s_add_u32 s32, s32, 65536
v_add_u32 v136, s32, v251
v_lshrrev_b32 v2, 4, v250
v_and_b32 v3, 15, v250
s_mul_i32 s32, s14, 16
v_add_u32 v147, s32, v2
v_and_b32 v6, 7, v147
v_lshlrev_b32 v6, 1, v6
v_xor_b32 v6, v6, v3
v_lshlrev_b32 v151, 4, v6
v_add_u32 v148, 4, v147
v_and_b32 v6, 7, v148
v_lshlrev_b32 v6, 1, v6
v_xor_b32 v6, v6, v3
v_lshlrev_b32 v152, 4, v6
v_subrev_u32 v152, 1024, v152
v_add_u32 v149, 8, v147
v_and_b32 v6, 7, v149
v_lshlrev_b32 v6, 1, v6
v_xor_b32 v6, v6, v3
v_lshlrev_b32 v153, 4, v6
v_subrev_u32 v153, 2048, v153
v_add_u32 v150, 12, v147
v_and_b32 v6, 7, v150
v_lshlrev_b32 v6, 1, v6
v_xor_b32 v6, v6, v3
v_lshlrev_b32 v154, 4, v6
v_subrev_u32 v154, 3072, v154
s_mul_i32 s19, s14, 4096
s_mul_i32 s20, s14, 4096
s_add_u32 s20, s20, 65536
s_mul_i32 s32, s14, 2
s_mul_i32 s32, s32, s31
v_mad_u32_u24 v137, v147, s30, v151
v_mad_u32_u24 v138, v148, s30, v152
v_mad_u32_u24 v139, v149, s30, v153
v_mad_u32_u24 v140, v150, s30, v154
v_add_u32 v141, s32, v251
s_add_u32 s32, s32, s31
s_sub_u32 s32, s32, 2048
v_add_u32 v142, s32, v251
s_mul_i32 s17, s30, 64
s_mov_b32 s15, 0
s_waitcnt vmcnt(0)
s_add_u32 m0, s20, 0
s_nop 0
buffer_load_dwordx4 v141, s[4:7], s16 offen offset:0 sc1 lds
buffer_load_dwordx4 v141, s[4:7], s16 offen offset:1024 sc1 lds
buffer_load_dwordx4 v142, s[4:7], s16 offen offset:2048 sc1 lds
buffer_load_dwordx4 v142, s[4:7], s16 offen offset:3072 sc1 lds
s_add_u32 s16, s16, 2048
s_add_u32 m0, s19, 0
s_nop 0
buffer_load_dwordx4 v137, s[8:11], s15 offen offset:0 lds
buffer_load_dwordx4 v138, s[8:11], s15 offen offset:1024 lds
buffer_load_dwordx4 v139, s[8:11], s15 offen offset:2048 lds
buffer_load_dwordx4 v140, s[8:11], s15 offen offset:3072 lds
s_add_u32 s15, s15, s17
s_add_u32 m0, s20, 16384
s_nop 0
buffer_load_dwordx4 v141, s[4:7], s16 offen offset:0 sc1 lds
buffer_load_dwordx4 v141, s[4:7], s16 offen offset:1024 sc1 lds
buffer_load_dwordx4 v142, s[4:7], s16 offen offset:2048 sc1 lds
buffer_load_dwordx4 v142, s[4:7], s16 offen offset:3072 sc1 lds
s_add_u32 s16, s16, 2048
s_add_u32 m0, s19, 16384
s_nop 0
buffer_load_dwordx4 v137, s[8:11], s15 offen offset:0 lds
buffer_load_dwordx4 v138, s[8:11], s15 offen offset:1024 lds
buffer_load_dwordx4 v139, s[8:11], s15 offen offset:2048 lds
buffer_load_dwordx4 v140, s[8:11], s15 offen offset:3072 lds
s_add_u32 s15, s15, s17
s_add_u32 m0, s20, 32768
s_nop 0
buffer_load_dwordx4 v141, s[4:7], s16 offen offset:0 sc1 lds
buffer_load_dwordx4 v141, s[4:7], s16 offen offset:1024 sc1 lds
buffer_load_dwordx4 v142, s[4:7], s16 offen offset:2048 sc1 lds
buffer_load_dwordx4 v142, s[4:7], s16 offen offset:3072 sc1 lds
s_add_u32 s16, s16, 2048
s_add_u32 m0, s19, 32768
s_nop 0
buffer_load_dwordx4 v137, s[8:11], s15 offen offset:0 lds
buffer_load_dwordx4 v138, s[8:11], s15 offen offset:1024 lds
buffer_load_dwordx4 v139, s[8:11], s15 offen offset:2048 lds
buffer_load_dwordx4 v140, s[8:11], s15 offen offset:3072 lds
s_add_u32 s15, s15, s17
s_add_u32 m0, s20, 49152
s_nop 0
buffer_load_dwordx4 v141, s[4:7], s16 offen offset:0 sc1 lds
buffer_load_dwordx4 v141, s[4:7], s16 offen offset:1024 sc1 lds
buffer_load_dwordx4 v142, s[4:7], s16 offen offset:2048 sc1 lds
buffer_load_dwordx4 v142, s[4:7], s16 offen offset:3072 sc1 lds
s_add_u32 s16, s16, 2048
s_cmp_lg_u32 s56, 0
s_cbranch_scc1 main_kernel_w_epi
main_kernel_w_c0_v_ent:
v_mfma_f32_32x32x16_bf16 v[64:79], v[224:227], v[224:227], 0
s_waitcnt vmcnt(20)
s_barrier
ds_read_b128 v[16:19], v136 offset:0
ds_read_b64_tr_b16 v[0:1], v128 offset:0
ds_read_b64_tr_b16 v[2:3], v128 offset:4096
v_mfma_f32_32x32x16_bf16 v[80:95], v[224:227], v[224:227], 0
ds_read_b64_tr_b16 v[4:5], v129 offset:0
ds_read_b64_tr_b16 v[6:7], v129 offset:4096
ds_read_b64_tr_b16 v[8:9], v130 offset:0
v_mfma_f32_32x32x16_bf16 v[96:111], v[224:227], v[224:227], 0
ds_read_b64_tr_b16 v[10:11], v130 offset:4096
ds_read_b64_tr_b16 v[12:13], v131 offset:0
ds_read_b64_tr_b16 v[14:15], v131 offset:4096
v_mfma_f32_32x32x16_bf16 v[112:127], v[224:227], v[224:227], 0
ds_read_b128 v[20:23], v136 offset:2048
ds_read_b128 v[24:27], v136 offset:4096
ds_read_b128 v[28:31], v136 offset:6144
s_sub_u32 s18, s72, 1
s_sub_u32 s55, s72, 2
s_orn2_b32 s55, s55, s100
s_mov_b32 s73, -1
s_nop 0
main_kernel_w_c0_v_loop:
s_waitcnt lgkmcnt(0)
ds_read_b128 v[48:51], v136 offset:1024
s_add_u32 m0, s19, 49152
s_nop 0
v_mfma_f32_16x16x32_bf16 v[64:67], v[16:19], v[0:3], v[64:67]
ds_read_b64_tr_b16 v[32:33], v128 offset:8192
v_mfma_f32_16x16x32_bf16 v[68:71], v[16:19], v[4:7], v[68:71]
ds_read_b64_tr_b16 v[34:35], v128 offset:12288
buffer_load_dwordx4 v137, s[8:11], s15 offen offset:0 lds
v_mfma_f32_16x16x32_bf16 v[72:75], v[16:19], v[8:11], v[72:75]
ds_read_b64_tr_b16 v[36:37], v129 offset:8192
v_mfma_f32_16x16x32_bf16 v[76:79], v[16:19], v[12:15], v[76:79]
ds_read_b64_tr_b16 v[38:39], v129 offset:12288
v_mfma_f32_16x16x32_bf16 v[80:83], v[20:23], v[0:3], v[80:83]
ds_read_b64_tr_b16 v[40:41], v130 offset:8192
buffer_load_dwordx4 v138, s[8:11], s15 offen offset:1024 lds
v_mfma_f32_16x16x32_bf16 v[84:87], v[20:23], v[4:7], v[84:87]
ds_read_b64_tr_b16 v[42:43], v130 offset:12288
v_mfma_f32_16x16x32_bf16 v[88:91], v[20:23], v[8:11], v[88:91]
ds_read_b64_tr_b16 v[44:45], v131 offset:8192
v_mfma_f32_16x16x32_bf16 v[92:95], v[20:23], v[12:15], v[92:95]
ds_read_b64_tr_b16 v[46:47], v131 offset:12288
buffer_load_dwordx4 v139, s[8:11], s15 offen offset:2048 lds
v_mfma_f32_16x16x32_bf16 v[96:99], v[24:27], v[0:3], v[96:99]
ds_read_b128 v[52:55], v136 offset:3072
v_mfma_f32_16x16x32_bf16 v[100:103], v[24:27], v[4:7], v[100:103]
ds_read_b128 v[56:59], v136 offset:5120
buffer_load_dwordx4 v140, s[8:11], s15 offen offset:3072 lds
v_mfma_f32_16x16x32_bf16 v[104:107], v[24:27], v[8:11], v[104:107]
ds_read_b128 v[60:63], v136 offset:7168
v_mfma_f32_16x16x32_bf16 v[108:111], v[24:27], v[12:15], v[108:111]
v_mfma_f32_16x16x32_bf16 v[112:115], v[28:31], v[0:3], v[112:115]
s_add_u32 s15, s15, s17
v_mfma_f32_16x16x32_bf16 v[116:119], v[28:31], v[4:7], v[116:119]
v_mfma_f32_16x16x32_bf16 v[120:123], v[28:31], v[8:11], v[120:123]
v_mfma_f32_16x16x32_bf16 v[124:127], v[28:31], v[12:15], v[124:127]
main_kernel_w_c0_v_mid:
s_waitcnt lgkmcnt(0)
v_mfma_f32_16x16x32_bf16 v[64:67], v[48:51], v[32:35], v[64:67]
s_waitcnt vmcnt(16)
s_barrier
ds_read_b128 v[16:19], v136 offset:16384
s_add_u32 m0, s20, 0
s_nop 0
v_mfma_f32_16x16x32_bf16 v[68:71], v[48:51], v[36:39], v[68:71]
ds_read_b64_tr_b16 v[0:1], v128 offset:16384
v_mfma_f32_16x16x32_bf16 v[72:75], v[48:51], v[40:43], v[72:75]
ds_read_b64_tr_b16 v[2:3], v128 offset:20480
buffer_load_dwordx4 v141, s[4:7], s16 offen offset:0 sc1 lds
v_mfma_f32_16x16x32_bf16 v[76:79], v[48:51], v[44:47], v[76:79]
ds_read_b64_tr_b16 v[4:5], v129 offset:16384
v_mfma_f32_16x16x32_bf16 v[80:83], v[52:55], v[32:35], v[80:83]
ds_read_b64_tr_b16 v[6:7], v129 offset:20480
v_mfma_f32_16x16x32_bf16 v[84:87], v[52:55], v[36:39], v[84:87]
ds_read_b64_tr_b16 v[8:9], v130 offset:16384
buffer_load_dwordx4 v141, s[4:7], s16 offen offset:1024 sc1 lds
v_mfma_f32_16x16x32_bf16 v[88:91], v[52:55], v[40:43], v[88:91]
ds_read_b64_tr_b16 v[10:11], v130 offset:20480
v_mfma_f32_16x16x32_bf16 v[92:95], v[52:55], v[44:47], v[92:95]
ds_read_b64_tr_b16 v[12:13], v131 offset:16384
buffer_load_dwordx4 v142, s[4:7], s16 offen offset:2048 sc1 lds
v_mfma_f32_16x16x32_bf16 v[96:99], v[56:59], v[32:35], v[96:99]
ds_read_b64_tr_b16 v[14:15], v131 offset:20480
v_mfma_f32_16x16x32_bf16 v[100:103], v[56:59], v[36:39], v[100:103]
ds_read_b128 v[20:23], v136 offset:18432
v_mfma_f32_16x16x32_bf16 v[104:107], v[56:59], v[40:43], v[104:107]
ds_read_b128 v[24:27], v136 offset:20480
buffer_load_dwordx4 v142, s[4:7], s16 offen offset:3072 sc1 lds
v_mfma_f32_16x16x32_bf16 v[108:111], v[56:59], v[44:47], v[108:111]
ds_read_b128 v[28:31], v136 offset:22528
v_mfma_f32_16x16x32_bf16 v[112:115], v[60:63], v[32:35], v[112:115]
s_add_u32 s16, s16, 2048
v_mfma_f32_16x16x32_bf16 v[116:119], v[60:63], v[36:39], v[116:119]
v_mfma_f32_16x16x32_bf16 v[120:123], v[60:63], v[40:43], v[120:123]
v_mfma_f32_16x16x32_bf16 v[124:127], v[60:63], v[44:47], v[124:127]
s_waitcnt lgkmcnt(0)
ds_read_b128 v[48:51], v136 offset:17408
s_add_u32 m0, s19, 0
s_nop 0
v_mfma_f32_16x16x32_bf16 v[64:67], v[16:19], v[0:3], v[64:67]
ds_read_b64_tr_b16 v[32:33], v128 offset:24576
v_mfma_f32_16x16x32_bf16 v[68:71], v[16:19], v[4:7], v[68:71]
ds_read_b64_tr_b16 v[34:35], v128 offset:28672
buffer_load_dwordx4 v137, s[8:11], s15 offen offset:0 lds
v_mfma_f32_16x16x32_bf16 v[72:75], v[16:19], v[8:11], v[72:75]
ds_read_b64_tr_b16 v[36:37], v129 offset:24576
v_mfma_f32_16x16x32_bf16 v[76:79], v[16:19], v[12:15], v[76:79]
ds_read_b64_tr_b16 v[38:39], v129 offset:28672
v_mfma_f32_16x16x32_bf16 v[80:83], v[20:23], v[0:3], v[80:83]
ds_read_b64_tr_b16 v[40:41], v130 offset:24576
buffer_load_dwordx4 v138, s[8:11], s15 offen offset:1024 lds
v_mfma_f32_16x16x32_bf16 v[84:87], v[20:23], v[4:7], v[84:87]
ds_read_b64_tr_b16 v[42:43], v130 offset:28672
v_mfma_f32_16x16x32_bf16 v[88:91], v[20:23], v[8:11], v[88:91]
ds_read_b64_tr_b16 v[44:45], v131 offset:24576
v_mfma_f32_16x16x32_bf16 v[92:95], v[20:23], v[12:15], v[92:95]
ds_read_b64_tr_b16 v[46:47], v131 offset:28672
buffer_load_dwordx4 v139, s[8:11], s15 offen offset:2048 lds
v_mfma_f32_16x16x32_bf16 v[96:99], v[24:27], v[0:3], v[96:99]
ds_read_b128 v[52:55], v136 offset:19456
v_mfma_f32_16x16x32_bf16 v[100:103], v[24:27], v[4:7], v[100:103]
ds_read_b128 v[56:59], v136 offset:21504
buffer_load_dwordx4 v140, s[8:11], s15 offen offset:3072 lds
v_mfma_f32_16x16x32_bf16 v[104:107], v[24:27], v[8:11], v[104:107]
ds_read_b128 v[60:63], v136 offset:23552
v_mfma_f32_16x16x32_bf16 v[108:111], v[24:27], v[12:15], v[108:111]
v_mfma_f32_16x16x32_bf16 v[112:115], v[28:31], v[0:3], v[112:115]
s_add_u32 s15, s15, s17
v_mfma_f32_16x16x32_bf16 v[116:119], v[28:31], v[4:7], v[116:119]
v_mfma_f32_16x16x32_bf16 v[120:123], v[28:31], v[8:11], v[120:123]
v_mfma_f32_16x16x32_bf16 v[124:127], v[28:31], v[12:15], v[124:127]
s_waitcnt lgkmcnt(0)
v_mfma_f32_16x16x32_bf16 v[64:67], v[48:51], v[32:35], v[64:67]
s_waitcnt vmcnt(16)
s_barrier
ds_read_b128 v[16:19], v136 offset:32768
s_add_u32 m0, s20, 16384
s_nop 0
v_mfma_f32_16x16x32_bf16 v[68:71], v[48:51], v[36:39], v[68:71]
ds_read_b64_tr_b16 v[0:1], v128 offset:32768
v_mfma_f32_16x16x32_bf16 v[72:75], v[48:51], v[40:43], v[72:75]
ds_read_b64_tr_b16 v[2:3], v128 offset:36864
buffer_load_dwordx4 v141, s[4:7], s16 offen offset:0 sc1 lds
v_mfma_f32_16x16x32_bf16 v[76:79], v[48:51], v[44:47], v[76:79]
ds_read_b64_tr_b16 v[4:5], v129 offset:32768
v_mfma_f32_16x16x32_bf16 v[80:83], v[52:55], v[32:35], v[80:83]
ds_read_b64_tr_b16 v[6:7], v129 offset:36864
v_mfma_f32_16x16x32_bf16 v[84:87], v[52:55], v[36:39], v[84:87]
ds_read_b64_tr_b16 v[8:9], v130 offset:32768
buffer_load_dwordx4 v141, s[4:7], s16 offen offset:1024 sc1 lds
v_mfma_f32_16x16x32_bf16 v[88:91], v[52:55], v[40:43], v[88:91]
ds_read_b64_tr_b16 v[10:11], v130 offset:36864
v_mfma_f32_16x16x32_bf16 v[92:95], v[52:55], v[44:47], v[92:95]
ds_read_b64_tr_b16 v[12:13], v131 offset:32768
buffer_load_dwordx4 v142, s[4:7], s16 offen offset:2048 sc1 lds
v_mfma_f32_16x16x32_bf16 v[96:99], v[56:59], v[32:35], v[96:99]
ds_read_b64_tr_b16 v[14:15], v131 offset:36864
v_mfma_f32_16x16x32_bf16 v[100:103], v[56:59], v[36:39], v[100:103]
ds_read_b128 v[20:23], v136 offset:34816
v_mfma_f32_16x16x32_bf16 v[104:107], v[56:59], v[40:43], v[104:107]
ds_read_b128 v[24:27], v136 offset:36864
buffer_load_dwordx4 v142, s[4:7], s16 offen offset:3072 sc1 lds
v_mfma_f32_16x16x32_bf16 v[108:111], v[56:59], v[44:47], v[108:111]
ds_read_b128 v[28:31], v136 offset:38912
v_mfma_f32_16x16x32_bf16 v[112:115], v[60:63], v[32:35], v[112:115]
s_add_u32 s16, s16, 2048
v_mfma_f32_16x16x32_bf16 v[116:119], v[60:63], v[36:39], v[116:119]
v_mfma_f32_16x16x32_bf16 v[120:123], v[60:63], v[40:43], v[120:123]
v_mfma_f32_16x16x32_bf16 v[124:127], v[60:63], v[44:47], v[124:127]
s_waitcnt lgkmcnt(0)
ds_read_b128 v[48:51], v136 offset:33792
s_add_u32 m0, s19, 16384
s_nop 0
v_mfma_f32_16x16x32_bf16 v[64:67], v[16:19], v[0:3], v[64:67]
ds_read_b64_tr_b16 v[32:33], v128 offset:40960
v_mfma_f32_16x16x32_bf16 v[68:71], v[16:19], v[4:7], v[68:71]
ds_read_b64_tr_b16 v[34:35], v128 offset:45056
buffer_load_dwordx4 v137, s[8:11], s15 offen offset:0 lds
v_mfma_f32_16x16x32_bf16 v[72:75], v[16:19], v[8:11], v[72:75]
ds_read_b64_tr_b16 v[36:37], v129 offset:40960
v_mfma_f32_16x16x32_bf16 v[76:79], v[16:19], v[12:15], v[76:79]
ds_read_b64_tr_b16 v[38:39], v129 offset:45056
v_mfma_f32_16x16x32_bf16 v[80:83], v[20:23], v[0:3], v[80:83]
ds_read_b64_tr_b16 v[40:41], v130 offset:40960
buffer_load_dwordx4 v138, s[8:11], s15 offen offset:1024 lds
v_mfma_f32_16x16x32_bf16 v[84:87], v[20:23], v[4:7], v[84:87]
ds_read_b64_tr_b16 v[42:43], v130 offset:45056
v_mfma_f32_16x16x32_bf16 v[88:91], v[20:23], v[8:11], v[88:91]
ds_read_b64_tr_b16 v[44:45], v131 offset:40960
v_mfma_f32_16x16x32_bf16 v[92:95], v[20:23], v[12:15], v[92:95]
ds_read_b64_tr_b16 v[46:47], v131 offset:45056
buffer_load_dwordx4 v139, s[8:11], s15 offen offset:2048 lds
v_mfma_f32_16x16x32_bf16 v[96:99], v[24:27], v[0:3], v[96:99]
ds_read_b128 v[52:55], v136 offset:35840
v_mfma_f32_16x16x32_bf16 v[100:103], v[24:27], v[4:7], v[100:103]
ds_read_b128 v[56:59], v136 offset:37888
buffer_load_dwordx4 v140, s[8:11], s15 offen offset:3072 lds
v_mfma_f32_16x16x32_bf16 v[104:107], v[24:27], v[8:11], v[104:107]
ds_read_b128 v[60:63], v136 offset:39936
v_mfma_f32_16x16x32_bf16 v[108:111], v[24:27], v[12:15], v[108:111]
v_mfma_f32_16x16x32_bf16 v[112:115], v[28:31], v[0:3], v[112:115]
s_add_u32 s15, s15, s17
v_mfma_f32_16x16x32_bf16 v[116:119], v[28:31], v[4:7], v[116:119]
v_mfma_f32_16x16x32_bf16 v[120:123], v[28:31], v[8:11], v[120:123]
v_mfma_f32_16x16x32_bf16 v[124:127], v[28:31], v[12:15], v[124:127]
s_waitcnt lgkmcnt(0)
v_mfma_f32_16x16x32_bf16 v[64:67], v[48:51], v[32:35], v[64:67]
s_waitcnt vmcnt(16)
s_barrier
ds_read_b128 v[16:19], v136 offset:49152
s_add_u32 m0, s20, 32768
s_nop 0
v_mfma_f32_16x16x32_bf16 v[68:71], v[48:51], v[36:39], v[68:71]
ds_read_b64_tr_b16 v[0:1], v128 offset:49152
v_mfma_f32_16x16x32_bf16 v[72:75], v[48:51], v[40:43], v[72:75]
ds_read_b64_tr_b16 v[2:3], v128 offset:53248
buffer_load_dwordx4 v141, s[4:7], s16 offen offset:0 sc1 lds
v_mfma_f32_16x16x32_bf16 v[76:79], v[48:51], v[44:47], v[76:79]
ds_read_b64_tr_b16 v[4:5], v129 offset:49152
v_mfma_f32_16x16x32_bf16 v[80:83], v[52:55], v[32:35], v[80:83]
ds_read_b64_tr_b16 v[6:7], v129 offset:53248
v_mfma_f32_16x16x32_bf16 v[84:87], v[52:55], v[36:39], v[84:87]
ds_read_b64_tr_b16 v[8:9], v130 offset:49152
buffer_load_dwordx4 v141, s[4:7], s16 offen offset:1024 sc1 lds
v_mfma_f32_16x16x32_bf16 v[88:91], v[52:55], v[40:43], v[88:91]
ds_read_b64_tr_b16 v[10:11], v130 offset:53248
v_mfma_f32_16x16x32_bf16 v[92:95], v[52:55], v[44:47], v[92:95]
ds_read_b64_tr_b16 v[12:13], v131 offset:49152
buffer_load_dwordx4 v142, s[4:7], s16 offen offset:2048 sc1 lds
v_mfma_f32_16x16x32_bf16 v[96:99], v[56:59], v[32:35], v[96:99]
ds_read_b64_tr_b16 v[14:15], v131 offset:53248
v_mfma_f32_16x16x32_bf16 v[100:103], v[56:59], v[36:39], v[100:103]
ds_read_b128 v[20:23], v136 offset:51200
v_mfma_f32_16x16x32_bf16 v[104:107], v[56:59], v[40:43], v[104:107]
ds_read_b128 v[24:27], v136 offset:53248
buffer_load_dwordx4 v142, s[4:7], s16 offen offset:3072 sc1 lds
v_mfma_f32_16x16x32_bf16 v[108:111], v[56:59], v[44:47], v[108:111]
ds_read_b128 v[28:31], v136 offset:55296
v_mfma_f32_16x16x32_bf16 v[112:115], v[60:63], v[32:35], v[112:115]
s_add_u32 s16, s16, 2048
v_mfma_f32_16x16x32_bf16 v[116:119], v[60:63], v[36:39], v[116:119]
v_mfma_f32_16x16x32_bf16 v[120:123], v[60:63], v[40:43], v[120:123]
v_mfma_f32_16x16x32_bf16 v[124:127], v[60:63], v[44:47], v[124:127]
s_waitcnt lgkmcnt(0)
ds_read_b128 v[48:51], v136 offset:50176
s_add_u32 m0, s19, 32768
s_nop 0
v_mfma_f32_16x16x32_bf16 v[64:67], v[16:19], v[0:3], v[64:67]
ds_read_b64_tr_b16 v[32:33], v128 offset:57344
v_mfma_f32_16x16x32_bf16 v[68:71], v[16:19], v[4:7], v[68:71]
ds_read_b64_tr_b16 v[34:35], v128 offset:61440
buffer_load_dwordx4 v137, s[8:11], s15 offen offset:0 lds
v_mfma_f32_16x16x32_bf16 v[72:75], v[16:19], v[8:11], v[72:75]
ds_read_b64_tr_b16 v[36:37], v129 offset:57344
v_mfma_f32_16x16x32_bf16 v[76:79], v[16:19], v[12:15], v[76:79]
ds_read_b64_tr_b16 v[38:39], v129 offset:61440
v_mfma_f32_16x16x32_bf16 v[80:83], v[20:23], v[0:3], v[80:83]
ds_read_b64_tr_b16 v[40:41], v130 offset:57344
buffer_load_dwordx4 v138, s[8:11], s15 offen offset:1024 lds
v_mfma_f32_16x16x32_bf16 v[84:87], v[20:23], v[4:7], v[84:87]
ds_read_b64_tr_b16 v[42:43], v130 offset:61440
v_mfma_f32_16x16x32_bf16 v[88:91], v[20:23], v[8:11], v[88:91]
ds_read_b64_tr_b16 v[44:45], v131 offset:57344
v_mfma_f32_16x16x32_bf16 v[92:95], v[20:23], v[12:15], v[92:95]
ds_read_b64_tr_b16 v[46:47], v131 offset:61440
buffer_load_dwordx4 v139, s[8:11], s15 offen offset:2048 lds
v_mfma_f32_16x16x32_bf16 v[96:99], v[24:27], v[0:3], v[96:99]
ds_read_b128 v[52:55], v136 offset:52224
v_mfma_f32_16x16x32_bf16 v[100:103], v[24:27], v[4:7], v[100:103]
ds_read_b128 v[56:59], v136 offset:54272
buffer_load_dwordx4 v140, s[8:11], s15 offen offset:3072 lds
v_mfma_f32_16x16x32_bf16 v[104:107], v[24:27], v[8:11], v[104:107]
ds_read_b128 v[60:63], v136 offset:56320
v_mfma_f32_16x16x32_bf16 v[108:111], v[24:27], v[12:15], v[108:111]
v_mfma_f32_16x16x32_bf16 v[112:115], v[28:31], v[0:3], v[112:115]
s_add_u32 s15, s15, s17
v_mfma_f32_16x16x32_bf16 v[116:119], v[28:31], v[4:7], v[116:119]
v_mfma_f32_16x16x32_bf16 v[120:123], v[28:31], v[8:11], v[120:123]
v_mfma_f32_16x16x32_bf16 v[124:127], v[28:31], v[12:15], v[124:127]
s_waitcnt lgkmcnt(0)
v_mfma_f32_16x16x32_bf16 v[64:67], v[48:51], v[32:35], v[64:67]
s_waitcnt vmcnt(16)
s_barrier
ds_read_b128 v[16:19], v136 offset:0
s_add_u32 m0, s20, 49152
s_nop 0
v_mfma_f32_16x16x32_bf16 v[68:71], v[48:51], v[36:39], v[68:71]
ds_read_b64_tr_b16 v[0:1], v128 offset:0
v_mfma_f32_16x16x32_bf16 v[72:75], v[48:51], v[40:43], v[72:75]
ds_read_b64_tr_b16 v[2:3], v128 offset:4096
buffer_load_dwordx4 v141, s[4:7], s16 offen offset:0 sc1 lds
v_mfma_f32_16x16x32_bf16 v[76:79], v[48:51], v[44:47], v[76:79]
ds_read_b64_tr_b16 v[4:5], v129 offset:0
v_mfma_f32_16x16x32_bf16 v[80:83], v[52:55], v[32:35], v[80:83]
ds_read_b64_tr_b16 v[6:7], v129 offset:4096
v_mfma_f32_16x16x32_bf16 v[84:87], v[52:55], v[36:39], v[84:87]
ds_read_b64_tr_b16 v[8:9], v130 offset:0
buffer_load_dwordx4 v141, s[4:7], s16 offen offset:1024 sc1 lds
v_mfma_f32_16x16x32_bf16 v[88:91], v[52:55], v[40:43], v[88:91]
ds_read_b64_tr_b16 v[10:11], v130 offset:4096
v_mfma_f32_16x16x32_bf16 v[92:95], v[52:55], v[44:47], v[92:95]
ds_read_b64_tr_b16 v[12:13], v131 offset:0
buffer_load_dwordx4 v142, s[4:7], s16 offen offset:2048 sc1 lds
v_mfma_f32_16x16x32_bf16 v[96:99], v[56:59], v[32:35], v[96:99]
ds_read_b64_tr_b16 v[14:15], v131 offset:4096
v_mfma_f32_16x16x32_bf16 v[100:103], v[56:59], v[36:39], v[100:103]
ds_read_b128 v[20:23], v136 offset:2048
v_mfma_f32_16x16x32_bf16 v[104:107], v[56:59], v[40:43], v[104:107]
ds_read_b128 v[24:27], v136 offset:4096
buffer_load_dwordx4 v142, s[4:7], s16 offen offset:3072 sc1 lds
v_mfma_f32_16x16x32_bf16 v[108:111], v[56:59], v[44:47], v[108:111]
ds_read_b128 v[28:31], v136 offset:6144
v_mfma_f32_16x16x32_bf16 v[112:115], v[60:63], v[32:35], v[112:115]
s_add_u32 s16, s16, 2048
v_mfma_f32_16x16x32_bf16 v[116:119], v[60:63], v[36:39], v[116:119]
v_mfma_f32_16x16x32_bf16 v[120:123], v[60:63], v[40:43], v[120:123]
v_mfma_f32_16x16x32_bf16 v[124:127], v[60:63], v[44:47], v[124:127]
s_sub_u32 s18, s18, 1
s_cmp_eq_u32 s18, s55
s_cbranch_scc1 main_kernel_w_c0_v_ev
s_cmp_lg_u32 s18, 0
s_cbranch_scc1 main_kernel_w_c0_v_loop
s_cmp_lg_u32 s73, -1
s_cbranch_scc1 main_kernel_w_epn
s_waitcnt lgkmcnt(0)
ds_read_b128 v[48:51], v136 offset:1024
s_add_u32 m0, s19, 49152
s_nop 0
v_mfma_f32_16x16x32_bf16 v[64:67], v[16:19], v[0:3], v[64:67]
ds_read_b64_tr_b16 v[32:33], v128 offset:8192
s_add_u32 s32, s23, 1
s_bitcmp0_b32 s32, 2
s_cselect_b32 s34, 7, 2
s_cselect_b32 s35, 2, 4
s_lshl_b32 s59, s23, 13
s_add_u32 s59, s59, 0x8404000
v_mfma_f32_16x16x32_bf16 v[68:71], v[16:19], v[4:7], v[68:71]
ds_read_b64_tr_b16 v[34:35], v128 offset:12288
buffer_load_dwordx4 v137, s[8:11], s15 offen offset:0 lds
v_lshrrev_b32 v253, 3, v250
v_add_lshl_u32 v253, s24, v253, 9
v_mfma_f32_16x16x32_bf16 v[72:75], v[16:19], v[8:11], v[72:75]
ds_read_b64_tr_b16 v[36:37], v129 offset:8192
v_and_b32 v254, 3, v250
v_lshl_add_u32 v253, v254, s34, v253
v_mfma_f32_16x16x32_bf16 v[76:79], v[16:19], v[12:15], v[76:79]
ds_read_b64_tr_b16 v[38:39], v129 offset:12288
v_bfe_u32 v254, v250, 2, 1
v_add_u32 v254, s25, v254
v_lshl_add_u32 v248, v254, s35, v253
v_mfma_f32_16x16x32_bf16 v[80:83], v[20:23], v[0:3], v[80:83]
ds_read_b64_tr_b16 v[40:41], v130 offset:8192
buffer_load_dwordx4 v138, s[8:11], s15 offen offset:1024 lds
s_lshl_b32 s0, 4, s54
v_readfirstlane_b32 s28, v249
v_mfma_f32_16x16x32_bf16 v[84:87], v[20:23], v[4:7], v[84:87]
ds_read_b64_tr_b16 v[42:43], v130 offset:12288
s_nop 1
v_cmp_ge_u32 vcc, s28, v229
v_mfma_f32_16x16x32_bf16 v[88:91], v[20:23], v[8:11], v[88:91]
ds_read_b64_tr_b16 v[44:45], v131 offset:8192
s_nop 1
s_bcnt1_i32_b64 s32, vcc
v_mfma_f32_16x16x32_bf16 v[92:95], v[20:23], v[12:15], v[92:95]
ds_read_b64_tr_b16 v[46:47], v131 offset:12288
buffer_load_dwordx4 v139, s[8:11], s15 offen offset:2048 lds
s_sub_u32 s32, s32, 1
v_readlane_b32 s36, v230, s32
s_nop 1
v_mfma_f32_16x16x32_bf16 v[96:99], v[24:27], v[0:3], v[96:99]
ds_read_b128 v[52:55], v136 offset:3072
s_and_b32 s32, s36, 0x7ff
s_sub_u32 s28, s28, s32
v_mfma_f32_16x16x32_bf16 v[100:103], v[24:27], v[4:7], v[100:103]
ds_read_b128 v[56:59], v136 offset:5120
buffer_load_dwordx4 v140, s[8:11], s15 offen offset:3072 lds
s_bfe_u32 s32, s36, 0x3001a
s_lshr_b32 s25, s28, s32
v_mfma_f32_16x16x32_bf16 v[104:107], v[24:27], v[8:11], v[104:107]
ds_read_b128 v[60:63], v136 offset:7168
s_lshl_b32 s33, s25, s32
s_sub_u32 s24, s28, s33
v_mfma_f32_16x16x32_bf16 v[108:111], v[24:27], v[12:15], v[108:111]
s_bfe_u32 s34, s36, 0x1001d
s_lshl_b32 s24, s24, s34
s_bfe_u32 s35, s36, 0x1001e
v_mfma_f32_16x16x32_bf16 v[112:115], v[28:31], v[0:3], v[112:115]
s_add_u32 s15, s15, s17
s_lshl_b32 s25, s25, s35
s_bfe_u32 s32, s36, 0x40011
v_mfma_f32_16x16x32_bf16 v[116:119], v[28:31], v[4:7], v[116:119]
s_add_u32 s24, s24, s32
s_bfe_u32 s32, s36, 0x50015
v_mfma_f32_16x16x32_bf16 v[120:123], v[28:31], v[8:11], v[120:123]
s_add_u32 s25, s25, s32
s_bfe_u32 s23, s36, 0x4000b
v_mfma_f32_16x16x32_bf16 v[124:127], v[28:31], v[12:15], v[124:127]
s_waitcnt lgkmcnt(0)
v_mfma_f32_16x16x32_bf16 v[64:67], v[48:51], v[32:35], v[64:67]
s_waitcnt vmcnt(16)
s_barrier
ds_read_b128 v[16:19], v136 offset:16384
s_add_u32 m0, s20, 0
s_nop 0
s_bfe_u32 s36, s36, 0x6000b
s_lshl_b32 s32, s24, 8
s_or_b32 s36, s36, s32
v_mfma_f32_16x16x32_bf16 v[68:71], v[48:51], v[36:39], v[68:71]
ds_read_b64_tr_b16 v[0:1], v128 offset:16384
s_lshl_b32 s32, s25, 16
s_or_b32 s36, s36, s32
v_mfma_f32_16x16x32_bf16 v[72:75], v[48:51], v[40:43], v[72:75]
ds_read_b64_tr_b16 v[2:3], v128 offset:20480
buffer_load_dwordx4 v141, s[4:7], s16 offen offset:0 sc1 lds
s_cmp_eq_u32 s23, 4
s_cselect_b32 s32, 1, 0
s_sub_u32 s48, s24, s32
v_mfma_f32_16x16x32_bf16 v[76:79], v[48:51], v[44:47], v[76:79]
ds_read_b64_tr_b16 v[4:5], v129 offset:16384
s_max_i32 s48, s48, 0
s_add_u32 s49, s24, s34
s_add_u32 s49, s49, s32
v_mfma_f32_16x16x32_bf16 v[80:83], v[52:55], v[32:35], v[80:83]
ds_read_b64_tr_b16 v[6:7], v129 offset:20480
s_min_u32 s49, s49, 15
s_cmp_eq_u32 s23, 6
s_cselect_b32 s51, 3, 7
v_mfma_f32_16x16x32_bf16 v[84:87], v[52:55], v[36:39], v[84:87]
ds_read_b64_tr_b16 v[8:9], v130 offset:16384
buffer_load_dwordx4 v141, s[4:7], s16 offen offset:1024 sc1 lds
s_cmp_eq_u32 s23, 7
s_cselect_b32 s51, 27, s51
s_cselect_b32 s50, 5, 4
s_add_u32 s33, s25, s35
v_mfma_f32_16x16x32_bf16 v[88:91], v[52:55], v[40:43], v[88:91]
ds_read_b64_tr_b16 v[10:11], v130 offset:20480
s_lshl_b32 s34, s24, 9
s_cmp_eq_u32 s23, 8
s_cselect_b32 s51, 0, s51
s_cselect_b32 s48, s25, s48
s_cselect_b32 s49, s33, s49
v_mfma_f32_16x16x32_bf16 v[92:95], v[52:55], v[44:47], v[92:95]
ds_read_b64_tr_b16 v[12:13], v131 offset:16384
buffer_load_dwordx4 v142, s[4:7], s16 offen offset:2048 sc1 lds
s_cmp_eq_u32 s23, 8
s_cselect_b32 s63, 2, 9
s_cselect_b32 s61, 0, 0x7f000000
s_cselect_b32 s34, s34, 0
v_lshrrev_b32 v228, s50, v250
v_lshlrev_b32 v254, s50, v228
v_mfma_f32_16x16x32_bf16 v[96:99], v[56:59], v[32:35], v[96:99]
ds_read_b64_tr_b16 v[14:15], v131 offset:20480
v_sub_u32 v254, v250, v254
s_cmp_lt_u32 s23, 4
s_cselect_b32 s39, 10, s23
v_mfma_f32_16x16x32_bf16 v[100:103], v[56:59], v[36:39], v[100:103]
ds_read_b128 v[20:23], v136 offset:18432
v_min_u32 v254, s51, v254
s_lshl_b32 s39, s39, 13
v_mfma_f32_16x16x32_bf16 v[104:107], v[56:59], v[40:43], v[104:107]
ds_read_b128 v[24:27], v136 offset:20480
buffer_load_dwordx4 v142, s[4:7], s16 offen offset:3072 sc1 lds
s_cmp_eq_u32 s23, 3
s_cselect_b32 s34, 4, s34
v_add_u32 v228, s48, v228
v_mfma_f32_16x16x32_bf16 v[108:111], v[56:59], v[44:47], v[108:111]
ds_read_b128 v[28:31], v136 offset:22528
s_add_u32 s39, s39, s34
s_add_u32 s39, s39, 0x8402000
v_min_u32 v228, s49, v228
v_mfma_f32_16x16x32_bf16 v[112:115], v[60:63], v[32:35], v[112:115]
s_add_u32 s16, s16, 2048
s_lshl_b32 s60, s24, 10
s_add_u32 s60, s60, 0x8400000
v_mfma_f32_16x16x32_bf16 v[116:119], v[60:63], v[36:39], v[116:119]
v_lshlrev_b32 v228, s63, v228
v_lshl_add_u32 v228, v254, 4, v228
v_mfma_f32_16x16x32_bf16 v[120:123], v[60:63], v[40:43], v[120:123]
v_or_b32 v146, s61, v251
s_mov_b64 exec, s[100:101]
buffer_load_dword v231, v228, s[4:7], s39 offen sc1
buffer_load_dwordx4 v[232:235], v146, s[4:7], s60 offen sc1
s_mov_b64 exec, -1
v_mfma_f32_16x16x32_bf16 v[124:127], v[60:63], v[44:47], v[124:127]
s_waitcnt lgkmcnt(0)
ds_read_b128 v[48:51], v136 offset:17408
s_add_u32 m0, s19, 0
s_nop 0
v_mfma_f32_16x16x32_bf16 v[64:67], v[16:19], v[0:3], v[64:67]
ds_read_b64_tr_b16 v[32:33], v128 offset:24576
s_mov_b32 s1, s21
v_mfma_f32_16x16x32_bf16 v[68:71], v[16:19], v[4:7], v[68:71]
ds_read_b64_tr_b16 v[34:35], v128 offset:28672
buffer_load_dwordx4 v137, s[8:11], s15 offen offset:0 lds
v_mfma_f32_16x16x32_bf16 v[72:75], v[16:19], v[8:11], v[72:75]
ds_read_b64_tr_b16 v[36:37], v129 offset:24576
v_mfma_f32_16x16x32_bf16 v[76:79], v[16:19], v[12:15], v[76:79]
ds_read_b64_tr_b16 v[38:39], v129 offset:28672
s_mov_b32 s2, s22
v_mfma_f32_16x16x32_bf16 v[80:83], v[20:23], v[0:3], v[80:83]
ds_read_b64_tr_b16 v[40:41], v130 offset:24576
buffer_load_dwordx4 v138, s[8:11], s15 offen offset:1024 lds
v_mfma_f32_16x16x32_bf16 v[84:87], v[20:23], v[4:7], v[84:87]
ds_read_b64_tr_b16 v[42:43], v130 offset:28672
v_mfma_f32_16x16x32_bf16 v[88:91], v[20:23], v[8:11], v[88:91]
ds_read_b64_tr_b16 v[44:45], v131 offset:24576
v_mfma_f32_16x16x32_bf16 v[92:95], v[20:23], v[12:15], v[92:95]
ds_read_b64_tr_b16 v[46:47], v131 offset:28672
buffer_load_dwordx4 v139, s[8:11], s15 offen offset:2048 lds
s_mov_b32 s3, s26
v_mfma_f32_16x16x32_bf16 v[96:99], v[24:27], v[0:3], v[96:99]
ds_read_b128 v[52:55], v136 offset:19456
v_mfma_f32_16x16x32_bf16 v[100:103], v[24:27], v[4:7], v[100:103]
ds_read_b128 v[56:59], v136 offset:21504
buffer_load_dwordx4 v140, s[8:11], s15 offen offset:3072 lds
v_mfma_f32_16x16x32_bf16 v[104:107], v[24:27], v[8:11], v[104:107]
ds_read_b128 v[60:63], v136 offset:23552
v_mfma_f32_16x16x32_bf16 v[108:111], v[24:27], v[12:15], v[108:111]
s_mov_b32 s56, s57
v_mfma_f32_16x16x32_bf16 v[112:115], v[28:31], v[0:3], v[112:115]
s_add_u32 s15, s15, s17
v_mfma_f32_16x16x32_bf16 v[116:119], v[28:31], v[4:7], v[116:119]
v_mfma_f32_16x16x32_bf16 v[120:123], v[28:31], v[8:11], v[120:123]
v_mfma_f32_16x16x32_bf16 v[124:127], v[28:31], v[12:15], v[124:127]
s_waitcnt lgkmcnt(0)
v_mfma_f32_16x16x32_bf16 v[64:67], v[48:51], v[32:35], v[64:67]
s_waitcnt vmcnt(16)
s_barrier
ds_read_b128 v[16:19], v136 offset:32768
s_add_u32 m0, s20, 16384
s_nop 0
v_mov_b32 v145, v252
v_mfma_f32_16x16x32_bf16 v[68:71], v[48:51], v[36:39], v[68:71]
ds_read_b64_tr_b16 v[0:1], v128 offset:32768
v_mfma_f32_16x16x32_bf16 v[72:75], v[48:51], v[40:43], v[72:75]
ds_read_b64_tr_b16 v[2:3], v128 offset:36864
buffer_load_dwordx4 v141, s[4:7], s16 offen offset:0 sc1 lds
v_mfma_f32_16x16x32_bf16 v[76:79], v[48:51], v[44:47], v[76:79]
ds_read_b64_tr_b16 v[4:5], v129 offset:32768
v_mfma_f32_16x16x32_bf16 v[80:83], v[52:55], v[32:35], v[80:83]
ds_read_b64_tr_b16 v[6:7], v129 offset:36864
v_mfma_f32_16x16x32_bf16 v[84:87], v[52:55], v[36:39], v[84:87]
ds_read_b64_tr_b16 v[8:9], v130 offset:32768
buffer_load_dwordx4 v141, s[4:7], s16 offen offset:1024 sc1 lds
v_mfma_f32_16x16x32_bf16 v[88:91], v[52:55], v[40:43], v[88:91]
ds_read_b64_tr_b16 v[10:11], v130 offset:36864
v_mfma_f32_16x16x32_bf16 v[92:95], v[52:55], v[44:47], v[92:95]
ds_read_b64_tr_b16 v[12:13], v131 offset:32768
buffer_load_dwordx4 v142, s[4:7], s16 offen offset:2048 sc1 lds
v_mov_b32 v255, 131072
v_mfma_f32_16x16x32_bf16 v[96:99], v[56:59], v[32:35], v[96:99]
ds_read_b64_tr_b16 v[14:15], v131 offset:36864
v_mfma_f32_16x16x32_bf16 v[100:103], v[56:59], v[36:39], v[100:103]
ds_read_b128 v[20:23], v136 offset:34816
v_mfma_f32_16x16x32_bf16 v[104:107], v[56:59], v[40:43], v[104:107]
ds_read_b128 v[24:27], v136 offset:36864
buffer_load_dwordx4 v142, s[4:7], s16 offen offset:3072 sc1 lds
v_mfma_f32_16x16x32_bf16 v[108:111], v[56:59], v[44:47], v[108:111]
ds_read_b128 v[28:31], v136 offset:38912
v_mfma_f32_16x16x32_bf16 v[112:115], v[60:63], v[32:35], v[112:115]
s_add_u32 s16, s16, 2048
v_mfma_f32_16x16x32_bf16 v[116:119], v[60:63], v[36:39], v[116:119]
v_mfma_f32_16x16x32_bf16 v[120:123], v[60:63], v[40:43], v[120:123]
v_mfma_f32_16x16x32_bf16 v[124:127], v[60:63], v[44:47], v[124:127]
s_waitcnt lgkmcnt(0)
ds_read_b128 v[48:51], v136 offset:33792
s_add_u32 m0, s19, 16384
s_nop 0
v_mfma_f32_16x16x32_bf16 v[64:67], v[16:19], v[0:3], v[64:67]
ds_read_b64_tr_b16 v[32:33], v128 offset:40960
v_mfma_f32_16x16x32_bf16 v[68:71], v[16:19], v[4:7], v[68:71]
ds_read_b64_tr_b16 v[34:35], v128 offset:45056
buffer_load_dwordx4 v137, s[8:11], s15 offen offset:0 lds
v_mfma_f32_16x16x32_bf16 v[72:75], v[16:19], v[8:11], v[72:75]
ds_read_b64_tr_b16 v[36:37], v129 offset:40960
v_mfma_f32_16x16x32_bf16 v[76:79], v[16:19], v[12:15], v[76:79]
ds_read_b64_tr_b16 v[38:39], v129 offset:45056
v_mfma_f32_16x16x32_bf16 v[80:83], v[20:23], v[0:3], v[80:83]
ds_read_b64_tr_b16 v[40:41], v130 offset:40960
buffer_load_dwordx4 v138, s[8:11], s15 offen offset:1024 lds
v_mfma_f32_16x16x32_bf16 v[84:87], v[20:23], v[4:7], v[84:87]
ds_read_b64_tr_b16 v[42:43], v130 offset:45056
v_mfma_f32_16x16x32_bf16 v[88:91], v[20:23], v[8:11], v[88:91]
ds_read_b64_tr_b16 v[44:45], v131 offset:40960
v_mfma_f32_16x16x32_bf16 v[92:95], v[20:23], v[12:15], v[92:95]
ds_read_b64_tr_b16 v[46:47], v131 offset:45056
buffer_load_dwordx4 v139, s[8:11], s15 offen offset:2048 lds
v_mfma_f32_16x16x32_bf16 v[96:99], v[24:27], v[0:3], v[96:99]
ds_read_b128 v[52:55], v136 offset:35840
v_mfma_f32_16x16x32_bf16 v[100:103], v[24:27], v[4:7], v[100:103]
ds_read_b128 v[56:59], v136 offset:37888
buffer_load_dwordx4 v140, s[8:11], s15 offen offset:3072 lds
v_mfma_f32_16x16x32_bf16 v[104:107], v[24:27], v[8:11], v[104:107]
ds_read_b128 v[60:63], v136 offset:39936
v_mfma_f32_16x16x32_bf16 v[108:111], v[24:27], v[12:15], v[108:111]
v_mfma_f32_16x16x32_bf16 v[112:115], v[28:31], v[0:3], v[112:115]
s_add_u32 s15, s15, s17
v_mfma_f32_16x16x32_bf16 v[116:119], v[28:31], v[4:7], v[116:119]
v_mfma_f32_16x16x32_bf16 v[120:123], v[28:31], v[8:11], v[120:123]
v_mfma_f32_16x16x32_bf16 v[124:127], v[28:31], v[12:15], v[124:127]
s_waitcnt lgkmcnt(0)
v_mfma_f32_16x16x32_bf16 v[64:67], v[48:51], v[32:35], v[64:67]
s_waitcnt vmcnt(16)
s_barrier
ds_read_b128 v[16:19], v136 offset:49152
s_add_u32 m0, s20, 32768
s_nop 0
v_mfma_f32_16x16x32_bf16 v[68:71], v[48:51], v[36:39], v[68:71]
ds_read_b64_tr_b16 v[0:1], v128 offset:49152
v_mfma_f32_16x16x32_bf16 v[72:75], v[48:51], v[40:43], v[72:75]
ds_read_b64_tr_b16 v[2:3], v128 offset:53248
buffer_load_dwordx4 v141, s[4:7], s16 offen offset:0 sc1 lds
v_mfma_f32_16x16x32_bf16 v[76:79], v[48:51], v[44:47], v[76:79]
ds_read_b64_tr_b16 v[4:5], v129 offset:49152
v_mfma_f32_16x16x32_bf16 v[80:83], v[52:55], v[32:35], v[80:83]
ds_read_b64_tr_b16 v[6:7], v129 offset:53248
s_waitcnt vmcnt(13)
v_mfma_f32_16x16x32_bf16 v[84:87], v[52:55], v[36:39], v[84:87]
ds_read_b64_tr_b16 v[8:9], v130 offset:49152
buffer_load_dwordx4 v141, s[4:7], s16 offen offset:1024 sc1 lds
v_min3_u32 v253, v232, v233, v234
v_mfma_f32_16x16x32_bf16 v[88:91], v[52:55], v[40:43], v[88:91]
ds_read_b64_tr_b16 v[10:11], v130 offset:53248
v_min_u32 v253, v253, v235
v_mfma_f32_16x16x32_bf16 v[92:95], v[52:55], v[44:47], v[92:95]
ds_read_b64_tr_b16 v[12:13], v131 offset:49152
buffer_load_dwordx4 v142, s[4:7], s16 offen offset:2048 sc1 lds
v_or_b32 v253, s61, v253
v_mfma_f32_16x16x32_bf16 v[96:99], v[56:59], v[32:35], v[96:99]
ds_read_b64_tr_b16 v[14:15], v131 offset:53248
v_min_u32 v253, v253, v231
v_mfma_f32_16x16x32_bf16 v[100:103], v[56:59], v[36:39], v[100:103]
ds_read_b128 v[20:23], v136 offset:51200
v_cmp_eq_u32 vcc, 0, v253
v_mfma_f32_16x16x32_bf16 v[104:107], v[56:59], v[40:43], v[104:107]
ds_read_b128 v[24:27], v136 offset:53248
buffer_load_dwordx4 v142, s[4:7], s16 offen offset:3072 sc1 lds
s_nop 1
v_mfma_f32_16x16x32_bf16 v[108:111], v[56:59], v[44:47], v[108:111]
ds_read_b128 v[28:31], v136 offset:55296
s_cmp_eq_u64 vcc, 0
s_cselect_b32 s32, s36, -4
v_mfma_f32_16x16x32_bf16 v[112:115], v[60:63], v[32:35], v[112:115]
s_add_u32 s16, s16, 2048
s_bitcmp1_b32 0x1df, s23
s_cselect_b32 s32, s32, -4
v_mfma_f32_16x16x32_bf16 v[116:119], v[60:63], v[36:39], v[116:119]
v_mov_b32 v254, s32
v_mfma_f32_16x16x32_bf16 v[120:123], v[60:63], v[40:43], v[120:123]
s_mov_b64 exec, s[100:101]
ds_write_b32 v255, v254
s_mov_b64 exec, -1
v_mfma_f32_16x16x32_bf16 v[124:127], v[60:63], v[44:47], v[124:127]
s_waitcnt lgkmcnt(0)
ds_read_b128 v[48:51], v136 offset:50176
s_add_u32 m0, s19, 32768
s_nop 0
v_mfma_f32_16x16x32_bf16 v[64:67], v[16:19], v[0:3], v[64:67]
ds_read_b64_tr_b16 v[32:33], v128 offset:57344
v_mfma_f32_16x16x32_bf16 v[68:71], v[16:19], v[4:7], v[68:71]
ds_read_b64_tr_b16 v[34:35], v128 offset:61440
buffer_load_dwordx4 v137, s[8:11], s15 offen offset:0 lds
v_mfma_f32_16x16x32_bf16 v[72:75], v[16:19], v[8:11], v[72:75]
ds_read_b64_tr_b16 v[36:37], v129 offset:57344
v_mfma_f32_16x16x32_bf16 v[76:79], v[16:19], v[12:15], v[76:79]
ds_read_b64_tr_b16 v[38:39], v129 offset:61440
v_mfma_f32_16x16x32_bf16 v[80:83], v[20:23], v[0:3], v[80:83]
ds_read_b64_tr_b16 v[40:41], v130 offset:57344
buffer_load_dwordx4 v138, s[8:11], s15 offen offset:1024 lds
v_mfma_f32_16x16x32_bf16 v[84:87], v[20:23], v[4:7], v[84:87]
ds_read_b64_tr_b16 v[42:43], v130 offset:61440
v_mfma_f32_16x16x32_bf16 v[88:91], v[20:23], v[8:11], v[88:91]
ds_read_b64_tr_b16 v[44:45], v131 offset:57344
v_mfma_f32_16x16x32_bf16 v[92:95], v[20:23], v[12:15], v[92:95]
ds_read_b64_tr_b16 v[46:47], v131 offset:61440
buffer_load_dwordx4 v139, s[8:11], s15 offen offset:2048 lds
v_mfma_f32_16x16x32_bf16 v[96:99], v[24:27], v[0:3], v[96:99]
ds_read_b128 v[52:55], v136 offset:52224
v_mfma_f32_16x16x32_bf16 v[100:103], v[24:27], v[4:7], v[100:103]
ds_read_b128 v[56:59], v136 offset:54272
buffer_load_dwordx4 v140, s[8:11], s15 offen offset:3072 lds
v_mfma_f32_16x16x32_bf16 v[104:107], v[24:27], v[8:11], v[104:107]
ds_read_b128 v[60:63], v136 offset:56320
v_mfma_f32_16x16x32_bf16 v[108:111], v[24:27], v[12:15], v[108:111]
v_mfma_f32_16x16x32_bf16 v[112:115], v[28:31], v[0:3], v[112:115]
s_add_u32 s15, s15, s17
v_mfma_f32_16x16x32_bf16 v[116:119], v[28:31], v[4:7], v[116:119]
v_mfma_f32_16x16x32_bf16 v[120:123], v[28:31], v[8:11], v[120:123]
v_mfma_f32_16x16x32_bf16 v[124:127], v[28:31], v[12:15], v[124:127]
s_waitcnt lgkmcnt(0)
v_mfma_f32_16x16x32_bf16 v[64:67], v[48:51], v[32:35], v[64:67]
s_waitcnt vmcnt(16)
s_barrier
ds_read_b128 v[16:19], v136 offset:0
s_add_u32 m0, s20, 49152
s_nop 0
ds_read_b32 v254, v255
v_mfma_f32_16x16x32_bf16 v[68:71], v[48:51], v[36:39], v[68:71]
ds_read_b64_tr_b16 v[0:1], v128 offset:0
v_mfma_f32_16x16x32_bf16 v[72:75], v[48:51], v[40:43], v[72:75]
ds_read_b64_tr_b16 v[2:3], v128 offset:4096
buffer_load_dwordx4 v141, s[4:7], s16 offen offset:0 sc1 lds
v_mfma_f32_16x16x32_bf16 v[76:79], v[48:51], v[44:47], v[76:79]
ds_read_b64_tr_b16 v[4:5], v129 offset:0
v_mfma_f32_16x16x32_bf16 v[80:83], v[52:55], v[32:35], v[80:83]
ds_read_b64_tr_b16 v[6:7], v129 offset:4096
v_mfma_f32_16x16x32_bf16 v[84:87], v[52:55], v[36:39], v[84:87]
ds_read_b64_tr_b16 v[8:9], v130 offset:0
buffer_load_dwordx4 v141, s[4:7], s16 offen offset:1024 sc1 lds
v_mfma_f32_16x16x32_bf16 v[88:91], v[52:55], v[40:43], v[88:91]
ds_read_b64_tr_b16 v[10:11], v130 offset:4096
v_mfma_f32_16x16x32_bf16 v[92:95], v[52:55], v[44:47], v[92:95]
ds_read_b64_tr_b16 v[12:13], v131 offset:0
buffer_load_dwordx4 v142, s[4:7], s16 offen offset:2048 sc1 lds
v_mfma_f32_16x16x32_bf16 v[96:99], v[56:59], v[32:35], v[96:99]
ds_read_b64_tr_b16 v[14:15], v131 offset:4096
v_mfma_f32_16x16x32_bf16 v[100:103], v[56:59], v[36:39], v[100:103]
ds_read_b128 v[20:23], v136 offset:2048
v_mfma_f32_16x16x32_bf16 v[104:107], v[56:59], v[40:43], v[104:107]
ds_read_b128 v[24:27], v136 offset:4096
buffer_load_dwordx4 v142, s[4:7], s16 offen offset:3072 sc1 lds
v_mfma_f32_16x16x32_bf16 v[108:111], v[56:59], v[44:47], v[108:111]
ds_read_b128 v[28:31], v136 offset:6144
v_mfma_f32_16x16x32_bf16 v[112:115], v[60:63], v[32:35], v[112:115]
s_add_u32 s16, s16, 2048
v_mfma_f32_16x16x32_bf16 v[116:119], v[60:63], v[36:39], v[116:119]
v_mfma_f32_16x16x32_bf16 v[120:123], v[60:63], v[40:43], v[120:123]
v_mfma_f32_16x16x32_bf16 v[124:127], v[60:63], v[44:47], v[124:127]
s_waitcnt lgkmcnt(0)
ds_read_b128 v[48:51], v136 offset:1024
s_add_u32 m0, s19, 49152
s_nop 0
v_mfma_f32_16x16x32_bf16 v[64:67], v[16:19], v[0:3], v[64:67]
ds_read_b64_tr_b16 v[32:33], v128 offset:8192
v_readfirstlane_b32 s62, v254
v_mfma_f32_16x16x32_bf16 v[68:71], v[16:19], v[4:7], v[68:71]
ds_read_b64_tr_b16 v[34:35], v128 offset:12288
buffer_load_dwordx4 v137, s[8:11], s15 offen offset:0 lds
v_mfma_f32_16x16x32_bf16 v[72:75], v[16:19], v[8:11], v[72:75]
ds_read_b64_tr_b16 v[36:37], v129 offset:8192
s_nop 1
v_mfma_f32_16x16x32_bf16 v[76:79], v[16:19], v[12:15], v[76:79]
ds_read_b64_tr_b16 v[38:39], v129 offset:12288
v_mfma_f32_16x16x32_bf16 v[80:83], v[20:23], v[0:3], v[80:83]
ds_read_b64_tr_b16 v[40:41], v130 offset:8192
buffer_load_dwordx4 v138, s[8:11], s15 offen offset:1024 lds
v_mfma_f32_16x16x32_bf16 v[84:87], v[20:23], v[4:7], v[84:87]
ds_read_b64_tr_b16 v[42:43], v130 offset:12288
s_and_b32 s23, s62, 15
v_mfma_f32_16x16x32_bf16 v[88:91], v[20:23], v[8:11], v[88:91]
ds_read_b64_tr_b16 v[44:45], v131 offset:8192
v_mfma_f32_16x16x32_bf16 v[92:95], v[20:23], v[12:15], v[92:95]
ds_read_b64_tr_b16 v[46:47], v131 offset:12288
buffer_load_dwordx4 v139, s[8:11], s15 offen offset:2048 lds
s_bfe_u32 s54, s62, 0x20004
v_mfma_f32_16x16x32_bf16 v[96:99], v[24:27], v[0:3], v[96:99]
ds_read_b128 v[52:55], v136 offset:3072
v_mfma_f32_16x16x32_bf16 v[100:103], v[24:27], v[4:7], v[100:103]
ds_read_b128 v[56:59], v136 offset:5120
buffer_load_dwordx4 v140, s[8:11], s15 offen offset:3072 lds
v_mfma_f32_16x16x32_bf16 v[104:107], v[24:27], v[8:11], v[104:107]
ds_read_b128 v[60:63], v136 offset:7168
s_bfe_u32 s24, s62, 0x80008
v_mfma_f32_16x16x32_bf16 v[108:111], v[24:27], v[12:15], v[108:111]
v_mfma_f32_16x16x32_bf16 v[112:115], v[28:31], v[0:3], v[112:115]
s_add_u32 s15, s15, s17
s_lshr_b32 s25, s62, 16
v_mfma_f32_16x16x32_bf16 v[116:119], v[28:31], v[4:7], v[116:119]
v_mfma_f32_16x16x32_bf16 v[120:123], v[28:31], v[8:11], v[120:123]
v_mfma_f32_16x16x32_bf16 v[124:127], v[28:31], v[12:15], v[124:127]
s_cmp_eq_u32 s54, 0
s_cselect_b32 s73, 1, -1
s_cbranch_scc1 main_kernel_w_c0_task
s_waitcnt lgkmcnt(0)
v_mfma_f32_16x16x32_bf16 v[64:67], v[48:51], v[32:35], v[64:67]
s_waitcnt vmcnt(16)
s_barrier
ds_read_b128 v[16:19], v136 offset:16384
v_mfma_f32_16x16x32_bf16 v[68:71], v[48:51], v[36:39], v[68:71]
ds_read_b64_tr_b16 v[0:1], v128 offset:16384
v_mfma_f32_16x16x32_bf16 v[72:75], v[48:51], v[40:43], v[72:75]
ds_read_b64_tr_b16 v[2:3], v128 offset:20480
v_mfma_f32_16x16x32_bf16 v[76:79], v[48:51], v[44:47], v[76:79]
ds_read_b64_tr_b16 v[4:5], v129 offset:16384
v_mfma_f32_16x16x32_bf16 v[80:83], v[52:55], v[32:35], v[80:83]
ds_read_b64_tr_b16 v[6:7], v129 offset:20480
v_mfma_f32_16x16x32_bf16 v[84:87], v[52:55], v[36:39], v[84:87]
ds_read_b64_tr_b16 v[8:9], v130 offset:16384
v_mfma_f32_16x16x32_bf16 v[88:91], v[52:55], v[40:43], v[88:91]
ds_read_b64_tr_b16 v[10:11], v130 offset:20480
v_mfma_f32_16x16x32_bf16 v[92:95], v[52:55], v[44:47], v[92:95]
ds_read_b64_tr_b16 v[12:13], v131 offset:16384
v_mfma_f32_16x16x32_bf16 v[96:99], v[56:59], v[32:35], v[96:99]
ds_read_b64_tr_b16 v[14:15], v131 offset:20480
v_mfma_f32_16x16x32_bf16 v[100:103], v[56:59], v[36:39], v[100:103]
ds_read_b128 v[20:23], v136 offset:18432
v_mfma_f32_16x16x32_bf16 v[104:107], v[56:59], v[40:43], v[104:107]
ds_read_b128 v[24:27], v136 offset:20480
v_mfma_f32_16x16x32_bf16 v[108:111], v[56:59], v[44:47], v[108:111]
ds_read_b128 v[28:31], v136 offset:22528
v_mfma_f32_16x16x32_bf16 v[112:115], v[60:63], v[32:35], v[112:115]
v_mfma_f32_16x16x32_bf16 v[116:119], v[60:63], v[36:39], v[116:119]
v_mfma_f32_16x16x32_bf16 v[120:123], v[60:63], v[40:43], v[120:123]
v_mfma_f32_16x16x32_bf16 v[124:127], v[60:63], v[44:47], v[124:127]
s_waitcnt lgkmcnt(0)
ds_read_b128 v[48:51], v136 offset:17408
v_mfma_f32_16x16x32_bf16 v[64:67], v[16:19], v[0:3], v[64:67]
ds_read_b64_tr_b16 v[32:33], v128 offset:24576
v_mfma_f32_16x16x32_bf16 v[68:71], v[16:19], v[4:7], v[68:71]
ds_read_b64_tr_b16 v[34:35], v128 offset:28672
v_mfma_f32_16x16x32_bf16 v[72:75], v[16:19], v[8:11], v[72:75]
ds_read_b64_tr_b16 v[36:37], v129 offset:24576
v_mfma_f32_16x16x32_bf16 v[76:79], v[16:19], v[12:15], v[76:79]
ds_read_b64_tr_b16 v[38:39], v129 offset:28672
v_mfma_f32_16x16x32_bf16 v[80:83], v[20:23], v[0:3], v[80:83]
ds_read_b64_tr_b16 v[40:41], v130 offset:24576
v_mfma_f32_16x16x32_bf16 v[84:87], v[20:23], v[4:7], v[84:87]
ds_read_b64_tr_b16 v[42:43], v130 offset:28672
v_mfma_f32_16x16x32_bf16 v[88:91], v[20:23], v[8:11], v[88:91]
ds_read_b64_tr_b16 v[44:45], v131 offset:24576
v_mfma_f32_16x16x32_bf16 v[92:95], v[20:23], v[12:15], v[92:95]
ds_read_b64_tr_b16 v[46:47], v131 offset:28672
v_mfma_f32_16x16x32_bf16 v[96:99], v[24:27], v[0:3], v[96:99]
ds_read_b128 v[52:55], v136 offset:19456
v_mfma_f32_16x16x32_bf16 v[100:103], v[24:27], v[4:7], v[100:103]
ds_read_b128 v[56:59], v136 offset:21504
v_mfma_f32_16x16x32_bf16 v[104:107], v[24:27], v[8:11], v[104:107]
ds_read_b128 v[60:63], v136 offset:23552
v_mfma_f32_16x16x32_bf16 v[108:111], v[24:27], v[12:15], v[108:111]
v_mfma_f32_16x16x32_bf16 v[112:115], v[28:31], v[0:3], v[112:115]
v_mfma_f32_16x16x32_bf16 v[116:119], v[28:31], v[4:7], v[116:119]
v_mfma_f32_16x16x32_bf16 v[120:123], v[28:31], v[8:11], v[120:123]
v_mfma_f32_16x16x32_bf16 v[124:127], v[28:31], v[12:15], v[124:127]
s_waitcnt lgkmcnt(0)
v_mfma_f32_16x16x32_bf16 v[64:67], v[48:51], v[32:35], v[64:67]
s_waitcnt vmcnt(8)
s_barrier
ds_read_b128 v[16:19], v136 offset:32768
v_mfma_f32_16x16x32_bf16 v[68:71], v[48:51], v[36:39], v[68:71]
ds_read_b64_tr_b16 v[0:1], v128 offset:32768
v_mfma_f32_16x16x32_bf16 v[72:75], v[48:51], v[40:43], v[72:75]
ds_read_b64_tr_b16 v[2:3], v128 offset:36864
v_mfma_f32_16x16x32_bf16 v[76:79], v[48:51], v[44:47], v[76:79]
ds_read_b64_tr_b16 v[4:5], v129 offset:32768
v_mfma_f32_16x16x32_bf16 v[80:83], v[52:55], v[32:35], v[80:83]
ds_read_b64_tr_b16 v[6:7], v129 offset:36864
v_mfma_f32_16x16x32_bf16 v[84:87], v[52:55], v[36:39], v[84:87]
ds_read_b64_tr_b16 v[8:9], v130 offset:32768
v_mfma_f32_16x16x32_bf16 v[88:91], v[52:55], v[40:43], v[88:91]
ds_read_b64_tr_b16 v[10:11], v130 offset:36864
v_mfma_f32_16x16x32_bf16 v[92:95], v[52:55], v[44:47], v[92:95]
ds_read_b64_tr_b16 v[12:13], v131 offset:32768
v_mfma_f32_16x16x32_bf16 v[96:99], v[56:59], v[32:35], v[96:99]
ds_read_b64_tr_b16 v[14:15], v131 offset:36864
v_mfma_f32_16x16x32_bf16 v[100:103], v[56:59], v[36:39], v[100:103]
ds_read_b128 v[20:23], v136 offset:34816
v_mfma_f32_16x16x32_bf16 v[104:107], v[56:59], v[40:43], v[104:107]
ds_read_b128 v[24:27], v136 offset:36864
v_mfma_f32_16x16x32_bf16 v[108:111], v[56:59], v[44:47], v[108:111]
ds_read_b128 v[28:31], v136 offset:38912
v_mfma_f32_16x16x32_bf16 v[112:115], v[60:63], v[32:35], v[112:115]
v_mfma_f32_16x16x32_bf16 v[116:119], v[60:63], v[36:39], v[116:119]
v_mfma_f32_16x16x32_bf16 v[120:123], v[60:63], v[40:43], v[120:123]
v_mfma_f32_16x16x32_bf16 v[124:127], v[60:63], v[44:47], v[124:127]
s_waitcnt lgkmcnt(0)
ds_read_b128 v[48:51], v136 offset:33792
v_mfma_f32_16x16x32_bf16 v[64:67], v[16:19], v[0:3], v[64:67]
ds_read_b64_tr_b16 v[32:33], v128 offset:40960
v_mfma_f32_16x16x32_bf16 v[68:71], v[16:19], v[4:7], v[68:71]
ds_read_b64_tr_b16 v[34:35], v128 offset:45056
v_mfma_f32_16x16x32_bf16 v[72:75], v[16:19], v[8:11], v[72:75]
ds_read_b64_tr_b16 v[36:37], v129 offset:40960
v_mfma_f32_16x16x32_bf16 v[76:79], v[16:19], v[12:15], v[76:79]
ds_read_b64_tr_b16 v[38:39], v129 offset:45056
v_mfma_f32_16x16x32_bf16 v[80:83], v[20:23], v[0:3], v[80:83]
ds_read_b64_tr_b16 v[40:41], v130 offset:40960
v_mfma_f32_16x16x32_bf16 v[84:87], v[20:23], v[4:7], v[84:87]
ds_read_b64_tr_b16 v[42:43], v130 offset:45056
v_mfma_f32_16x16x32_bf16 v[88:91], v[20:23], v[8:11], v[88:91]
ds_read_b64_tr_b16 v[44:45], v131 offset:40960
v_mfma_f32_16x16x32_bf16 v[92:95], v[20:23], v[12:15], v[92:95]
ds_read_b64_tr_b16 v[46:47], v131 offset:45056
v_mfma_f32_16x16x32_bf16 v[96:99], v[24:27], v[0:3], v[96:99]
ds_read_b128 v[52:55], v136 offset:35840
v_mfma_f32_16x16x32_bf16 v[100:103], v[24:27], v[4:7], v[100:103]
ds_read_b128 v[56:59], v136 offset:37888
v_mfma_f32_16x16x32_bf16 v[104:107], v[24:27], v[8:11], v[104:107]
ds_read_b128 v[60:63], v136 offset:39936
v_mfma_f32_16x16x32_bf16 v[108:111], v[24:27], v[12:15], v[108:111]
v_mfma_f32_16x16x32_bf16 v[112:115], v[28:31], v[0:3], v[112:115]
v_mfma_f32_16x16x32_bf16 v[116:119], v[28:31], v[4:7], v[116:119]
v_mfma_f32_16x16x32_bf16 v[120:123], v[28:31], v[8:11], v[120:123]
v_mfma_f32_16x16x32_bf16 v[124:127], v[28:31], v[12:15], v[124:127]
s_waitcnt lgkmcnt(0)
v_mfma_f32_16x16x32_bf16 v[64:67], v[48:51], v[32:35], v[64:67]
s_waitcnt vmcnt(0)
s_barrier
ds_read_b128 v[16:19], v136 offset:49152
v_mfma_f32_16x16x32_bf16 v[68:71], v[48:51], v[36:39], v[68:71]
ds_read_b64_tr_b16 v[0:1], v128 offset:49152
v_mfma_f32_16x16x32_bf16 v[72:75], v[48:51], v[40:43], v[72:75]
ds_read_b64_tr_b16 v[2:3], v128 offset:53248
v_mfma_f32_16x16x32_bf16 v[76:79], v[48:51], v[44:47], v[76:79]
ds_read_b64_tr_b16 v[4:5], v129 offset:49152
v_mfma_f32_16x16x32_bf16 v[80:83], v[52:55], v[32:35], v[80:83]
ds_read_b64_tr_b16 v[6:7], v129 offset:53248
v_mfma_f32_16x16x32_bf16 v[84:87], v[52:55], v[36:39], v[84:87]
ds_read_b64_tr_b16 v[8:9], v130 offset:49152
v_mfma_f32_16x16x32_bf16 v[88:91], v[52:55], v[40:43], v[88:91]
ds_read_b64_tr_b16 v[10:11], v130 offset:53248
v_mfma_f32_16x16x32_bf16 v[92:95], v[52:55], v[44:47], v[92:95]
ds_read_b64_tr_b16 v[12:13], v131 offset:49152
v_mfma_f32_16x16x32_bf16 v[96:99], v[56:59], v[32:35], v[96:99]
ds_read_b64_tr_b16 v[14:15], v131 offset:53248
v_mfma_f32_16x16x32_bf16 v[100:103], v[56:59], v[36:39], v[100:103]
ds_read_b128 v[20:23], v136 offset:51200
v_mfma_f32_16x16x32_bf16 v[104:107], v[56:59], v[40:43], v[104:107]
ds_read_b128 v[24:27], v136 offset:53248
v_mfma_f32_16x16x32_bf16 v[108:111], v[56:59], v[44:47], v[108:111]
ds_read_b128 v[28:31], v136 offset:55296
v_mfma_f32_16x16x32_bf16 v[112:115], v[60:63], v[32:35], v[112:115]
v_mfma_f32_16x16x32_bf16 v[116:119], v[60:63], v[36:39], v[116:119]
v_mfma_f32_16x16x32_bf16 v[120:123], v[60:63], v[40:43], v[120:123]
v_mfma_f32_16x16x32_bf16 v[124:127], v[60:63], v[44:47], v[124:127]
s_waitcnt lgkmcnt(0)
ds_read_b128 v[48:51], v136 offset:50176
v_mfma_f32_16x16x32_bf16 v[64:67], v[16:19], v[0:3], v[64:67]
ds_read_b64_tr_b16 v[32:33], v128 offset:57344
v_mfma_f32_16x16x32_bf16 v[68:71], v[16:19], v[4:7], v[68:71]
ds_read_b64_tr_b16 v[34:35], v128 offset:61440
v_mfma_f32_16x16x32_bf16 v[72:75], v[16:19], v[8:11], v[72:75]
ds_read_b64_tr_b16 v[36:37], v129 offset:57344
v_mfma_f32_16x16x32_bf16 v[76:79], v[16:19], v[12:15], v[76:79]
ds_read_b64_tr_b16 v[38:39], v129 offset:61440
v_mfma_f32_16x16x32_bf16 v[80:83], v[20:23], v[0:3], v[80:83]
ds_read_b64_tr_b16 v[40:41], v130 offset:57344
v_mfma_f32_16x16x32_bf16 v[84:87], v[20:23], v[4:7], v[84:87]
ds_read_b64_tr_b16 v[42:43], v130 offset:61440
v_mfma_f32_16x16x32_bf16 v[88:91], v[20:23], v[8:11], v[88:91]
ds_read_b64_tr_b16 v[44:45], v131 offset:57344
v_mfma_f32_16x16x32_bf16 v[92:95], v[20:23], v[12:15], v[92:95]
ds_read_b64_tr_b16 v[46:47], v131 offset:61440
v_mfma_f32_16x16x32_bf16 v[96:99], v[24:27], v[0:3], v[96:99]
ds_read_b128 v[52:55], v136 offset:52224
v_mfma_f32_16x16x32_bf16 v[100:103], v[24:27], v[4:7], v[100:103]
ds_read_b128 v[56:59], v136 offset:54272
v_mfma_f32_16x16x32_bf16 v[104:107], v[24:27], v[8:11], v[104:107]
ds_read_b128 v[60:63], v136 offset:56320
v_mfma_f32_16x16x32_bf16 v[108:111], v[24:27], v[12:15], v[108:111]
v_mfma_f32_16x16x32_bf16 v[112:115], v[28:31], v[0:3], v[112:115]
v_mfma_f32_16x16x32_bf16 v[116:119], v[28:31], v[4:7], v[116:119]
v_mfma_f32_16x16x32_bf16 v[120:123], v[28:31], v[8:11], v[120:123]
v_mfma_f32_16x16x32_bf16 v[124:127], v[28:31], v[12:15], v[124:127]
s_waitcnt lgkmcnt(0)
v_mfma_f32_16x16x32_bf16 v[64:67], v[48:51], v[32:35], v[64:67]
s_barrier
v_mfma_f32_16x16x32_bf16 v[68:71], v[48:51], v[36:39], v[68:71]
v_mfma_f32_16x16x32_bf16 v[72:75], v[48:51], v[40:43], v[72:75]
v_mfma_f32_16x16x32_bf16 v[76:79], v[48:51], v[44:47], v[76:79]
v_mfma_f32_16x16x32_bf16 v[80:83], v[52:55], v[32:35], v[80:83]
v_mfma_f32_16x16x32_bf16 v[84:87], v[52:55], v[36:39], v[84:87]
v_mfma_f32_16x16x32_bf16 v[88:91], v[52:55], v[40:43], v[88:91]
v_mfma_f32_16x16x32_bf16 v[92:95], v[52:55], v[44:47], v[92:95]
v_mfma_f32_16x16x32_bf16 v[96:99], v[56:59], v[32:35], v[96:99]
v_mfma_f32_16x16x32_bf16 v[100:103], v[56:59], v[36:39], v[100:103]
v_mfma_f32_16x16x32_bf16 v[104:107], v[56:59], v[40:43], v[104:107]
v_mfma_f32_16x16x32_bf16 v[108:111], v[56:59], v[44:47], v[108:111]
v_mfma_f32_16x16x32_bf16 v[112:115], v[60:63], v[32:35], v[112:115]
v_mfma_f32_16x16x32_bf16 v[116:119], v[60:63], v[36:39], v[116:119]
v_mfma_f32_16x16x32_bf16 v[120:123], v[60:63], v[40:43], v[120:123]
v_mfma_f32_16x16x32_bf16 v[124:127], v[60:63], v[44:47], v[124:127]
s_cmp_lg_u32 s62, -4
s_cbranch_scc1 main_kernel_w_gemm
s_branch main_kernel_w_slow
main_kernel_w_c0_v_ev:
s_mov_b32 s55, 1
s_cmp_eq_u32 s56, 0
s_cbranch_scc1 main_kernel_w_c0_v_et
s_bfm_b64 exec, s0, 0
buffer_store_dword v244, v248, s[4:7], s59 offen sc1
s_mov_b64 exec, -1
s_mov_b32 s56, 0
main_kernel_w_c0_v_et:
s_cmp_lg_u32 s18, 1
s_cbranch_scc1 main_kernel_w_c0_v_loop
s_lshl_b32 s32, s27, 8
s_add_u32 s32, s32, 0x841e000
s_mov_b64 exec, 1
v_mov_b32 v249, 1
buffer_atomic_add v249, off, s[4:7], s32 sc0 sc1
s_mov_b64 exec, -1
s_branch main_kernel_w_c0_v_loop
main_kernel_w_c1_task:
s_cmp_eq_u32 s23, 0
s_cbranch_scc1 main_kernel_w_c1_set0
s_cmp_eq_u32 s23, 1
s_cbranch_scc1 main_kernel_w_c1_set1
s_cmp_eq_u32 s23, 2
s_cbranch_scc1 main_kernel_w_c1_set2
s_cmp_eq_u32 s23, 3
s_cbranch_scc1 main_kernel_w_c1_set3
s_cmp_eq_u32 s23, 6
s_cbranch_scc1 main_kernel_w_c1_set6
s_branch main_kernel_end2
main_kernel_w_c1_set0:
s_mov_b32 s57, 6
s_lshl_b32 s32, s25, 8
s_add_u32 s8, s40, s32
s_addc_u32 s9, s41, 0
s_and_b32 s9, s9, 0xffff
s_sub_u32 s10, 0x800000, s32
s_mov_b32 s11, 0x20000
s_mov_b32 s30, 8192
s_mov_b32 s31, 32768
s_mul_i32 s16, s24, 262144
s_add_u32 s16, s16, 0x0
s_mov_b32 s18, 7
s_lshl_b32 s32, s24, 3
s_mul_i32 s33, s38, 4
s_add_u32 s32, s32, s33
s_mul_i32 s32, s32, 131072
s_lshl_b32 s33, s25, 12
s_add_u32 s32, s32, s33
s_mul_i32 s33, s37, 4096
s_add_u32 s32, s32, s33
s_add_u32 s21, s32, 0x800000
s_mov_b32 s22, 131072
s_mov_b32 s26, 0x7f000000
s_branch main_kernel_w_c1_go
main_kernel_w_c1_set1:
s_mov_b32 s57, 7
s_lshl_b32 s32, s25, 8
s_add_u32 s8, s42, s32
s_addc_u32 s9, s43, 0
s_and_b32 s9, s9, 0xffff
s_sub_u32 s10, 0x800000, s32
s_mov_b32 s11, 0x20000
s_mov_b32 s30, 8192
s_mov_b32 s31, 32768
s_mul_i32 s16, s24, 262144
s_add_u32 s16, s16, 0x0
s_mov_b32 s18, 7
s_lshl_b32 s32, s24, 3
s_mul_i32 s33, s38, 4
s_add_u32 s32, s32, s33
s_mul_i32 s32, s32, 131072
s_lshl_b32 s33, s25, 12
s_add_u32 s32, s32, s33
s_mul_i32 s33, s37, 4096
s_add_u32 s32, s32, s33
s_add_u32 s21, s32, 0x1800000
s_mov_b32 s22, 131072
s_mov_b32 s26, 0x7f000000
s_branch main_kernel_w_c1_go
main_kernel_w_c1_set2:
s_mov_b32 s57, 8
s_lshl_b32 s32, s25, 8
s_add_u32 s8, s44, s32
s_addc_u32 s9, s45, 0
s_and_b32 s9, s9, 0xffff
s_sub_u32 s10, 0x800000, s32
s_mov_b32 s11, 0x20000
s_mov_b32 s30, 8192
s_mov_b32 s31, 32768
s_mul_i32 s16, s24, 262144
s_add_u32 s16, s16, 0x0
s_mov_b32 s18, 7
s_lshl_b32 s32, s24, 2
s_mul_i32 s33, s38, 2
s_add_u32 s32, s32, s33
s_lshl_b32 s32, s32, 18
s_lshl_b32 s33, s25, 13
s_add_u32 s32, s32, s33
s_mul_i32 s33, s37, 8192
s_add_u32 s32, s32, s33
s_add_u32 s21, s32, 0x2800000
s_branch main_kernel_w_c1_gov
main_kernel_w_c1_set3:
s_mov_b32 s57, 9
s_lshl_b32 s32, s25, 8
s_add_u32 s8, s64, s32
s_addc_u32 s9, s65, 0
s_and_b32 s9, s9, 0xffff
s_sub_u32 s10, 0x200000, s32
s_mov_b32 s11, 0x20000
s_mov_b32 s30, 2048
s_mov_b32 s31, 32768
s_mul_i32 s16, s24, 262144
s_add_u32 s16, s16, 0x400000
s_mov_b32 s18, 7
s_lshl_b32 s32, s24, 3
s_mul_i32 s33, s38, 4
s_add_u32 s32, s32, s33
s_mul_i32 s32, s32, 32768
s_lshl_b32 s33, s25, 12
s_add_u32 s32, s32, s33
s_mul_i32 s33, s37, 4096
s_add_u32 s32, s32, s33
s_add_u32 s21, s32, 0x4800000
s_mov_b32 s22, 32768
s_mov_b32 s26, 0x7f000000
s_lshr_b32 s32, s25, 2
s_add_u32 s32, s32, 1
s_sub_u32 s33, 0, s32
s_bitcmp1_b32 s25, 1
s_cselect_b32 s32, s33, s32
s_add_u32 s32, s32, 16
v_and_b32 v253, 15, v250
v_add_u32 v253, s32, v253
v_lshrrev_b32 v254, 4, v253
v_lshlrev_b32 v254, 15, v254
v_and_b32 v253, 15, v253
v_lshl_add_u32 v254, v253, 4, v254
v_and_b32 v253, 0x300, v251
v_add_u32 v252, v253, v254
s_branch main_kernel_w_c1_go
main_kernel_w_c1_set6:
s_mov_b32 s57, 10
s_lshl_b32 s32, s25, 8
s_add_u32 s8, s68, s32
s_addc_u32 s9, s69, 0
s_and_b32 s9, s9, 0xffff
s_sub_u32 s10, 0x700000, s32
s_mov_b32 s11, 0x20000
s_mov_b32 s30, 7168
s_mov_b32 s31, 32768
s_mul_i32 s16, s24, 262144
s_add_u32 s16, s16, 0x6800000
s_mov_b32 s18, 7
s_lshl_b32 s32, s24, 3
s_mul_i32 s33, s38, 4
s_add_u32 s32, s32, s33
s_mul_i32 s32, s32, 114688
s_lshl_b32 s33, s25, 12
s_add_u32 s32, s32, s33
s_mul_i32 s33, s37, 4096
s_add_u32 s32, s32, s33
s_add_u32 s21, s32, 0x5400000
s_mov_b32 s22, 114688
s_mov_b32 s26, 0x7f000000
s_branch main_kernel_w_c1_go
main_kernel_w_c1_str:
s_mul_i32 s32, s14, 2
s_mul_i32 s32, s32, s31
v_mad_u32_u24 v137, v147, s30, v151
v_mad_u32_u24 v138, v148, s30, v152
v_mad_u32_u24 v139, v149, s30, v153
v_mad_u32_u24 v140, v150, s30, v154
v_add_u32 v141, s32, v251
s_add_u32 s32, s32, s31
s_sub_u32 s32, s32, 1024
v_add_u32 v142, s32, v251
s_mul_i32 s17, s30, 32
s_mov_b32 s15, 0
s_mov_b32 s18, 1
s_cmp_eq_u32 s73, 2
s_cbranch_scc1 main_kernel_w_c1_n_mid
s_branch main_kernel_w_c1_v_mid
main_kernel_w_c1_go:
s_mov_b32 s58, 2
s_mov_b32 s72, s18
s_cmp_lg_u32 s73, -1
s_cbranch_scc1 main_kernel_w_c1_str
s_waitcnt lgkmcnt(0)
v_lshrrev_b32 v0, 4, v250
v_bfe_u32 v1, v250, 2, 2
v_lshl_add_u32 v4, v0, 2, v1
v_and_b32 v5, 7, v4
v_mul_u32_u24 v4, 512, v4
v_and_b32 v6, 3, v250
v_lshl_add_u32 v4, v6, 3, v4
s_mul_i32 s32, s37, 8
v_xor_b32 v5, s32, v5
v_lshl_add_u32 v128, v5, 5, v4
v_xor_b32 v129, 32, v128
v_xor_b32 v130, 64, v128
v_xor_b32 v131, 96, v128
v_xor_b32 v132, 128, v128
v_xor_b32 v133, 160, v128
v_xor_b32 v134, 192, v128
v_xor_b32 v135, 224, v128
s_mul_i32 s32, s38, 4096
s_add_u32 s32, s32, 65536
v_add_u32 v136, s32, v251
v_lshrrev_b32 v2, 5, v250
v_and_b32 v3, 31, v250
s_mul_i32 s32, s14, 8
v_add_u32 v147, s32, v2
v_and_b32 v6, 7, v147
v_lshlrev_b32 v6, 1, v6
v_xor_b32 v6, v6, v3
v_lshlrev_b32 v151, 4, v6
v_add_u32 v148, 2, v147
v_and_b32 v6, 7, v148
v_lshlrev_b32 v6, 1, v6
v_xor_b32 v6, v6, v3
v_lshlrev_b32 v152, 4, v6
v_subrev_u32 v152, 1024, v152
v_add_u32 v149, 4, v147
v_and_b32 v6, 7, v149
v_lshlrev_b32 v6, 1, v6
v_xor_b32 v6, v6, v3
v_lshlrev_b32 v153, 4, v6
v_subrev_u32 v153, 2048, v153
v_add_u32 v150, 6, v147
v_and_b32 v6, 7, v150
v_lshlrev_b32 v6, 1, v6
v_xor_b32 v6, v6, v3
v_lshlrev_b32 v154, 4, v6
v_subrev_u32 v154, 3072, v154
s_mul_i32 s19, s14, 4096
s_mul_i32 s20, s14, 2048
s_add_u32 s20, s20, 65536
s_mul_i32 s32, s14, 2
s_mul_i32 s32, s32, s31
v_mad_u32_u24 v137, v147, s30, v151
v_mad_u32_u24 v138, v148, s30, v152
v_mad_u32_u24 v139, v149, s30, v153
v_mad_u32_u24 v140, v150, s30, v154
v_add_u32 v141, s32, v251
s_add_u32 s32, s32, s31
s_sub_u32 s32, s32, 1024
v_add_u32 v142, s32, v251
s_mul_i32 s17, s30, 32
s_mov_b32 s15, 0
s_waitcnt vmcnt(0)
s_add_u32 m0, s20, 0
s_nop 0
buffer_load_dwordx4 v141, s[4:7], s16 offen offset:0 sc1 lds
buffer_load_dwordx4 v142, s[4:7], s16 offen offset:1024 sc1 lds
s_add_u32 s16, s16, 1024
s_add_u32 m0, s19, 0
s_nop 0
buffer_load_dwordx4 v137, s[8:11], s15 offen offset:0 lds
buffer_load_dwordx4 v138, s[8:11], s15 offen offset:1024 lds
buffer_load_dwordx4 v139, s[8:11], s15 offen offset:2048 lds
buffer_load_dwordx4 v140, s[8:11], s15 offen offset:3072 lds
s_add_u32 s15, s15, s17
s_add_u32 m0, s20, 8192
s_nop 0
buffer_load_dwordx4 v141, s[4:7], s16 offen offset:0 sc1 lds
buffer_load_dwordx4 v142, s[4:7], s16 offen offset:1024 sc1 lds
s_add_u32 s16, s16, 1024
s_add_u32 m0, s19, 16384
s_nop 0
buffer_load_dwordx4 v137, s[8:11], s15 offen offset:0 lds
buffer_load_dwordx4 v138, s[8:11], s15 offen offset:1024 lds
buffer_load_dwordx4 v139, s[8:11], s15 offen offset:2048 lds
buffer_load_dwordx4 v140, s[8:11], s15 offen offset:3072 lds
s_add_u32 s15, s15, s17
s_add_u32 m0, s20, 16384
s_nop 0
buffer_load_dwordx4 v141, s[4:7], s16 offen offset:0 sc1 lds
buffer_load_dwordx4 v142, s[4:7], s16 offen offset:1024 sc1 lds
s_add_u32 s16, s16, 1024
s_add_u32 m0, s19, 32768
s_nop 0
buffer_load_dwordx4 v137, s[8:11], s15 offen offset:0 lds
buffer_load_dwordx4 v138, s[8:11], s15 offen offset:1024 lds
buffer_load_dwordx4 v139, s[8:11], s15 offen offset:2048 lds
buffer_load_dwordx4 v140, s[8:11], s15 offen offset:3072 lds
s_add_u32 s15, s15, s17
s_add_u32 m0, s20, 24576
s_nop 0
buffer_load_dwordx4 v141, s[4:7], s16 offen offset:0 sc1 lds
buffer_load_dwordx4 v142, s[4:7], s16 offen offset:1024 sc1 lds
s_add_u32 s16, s16, 1024
s_add_u32 m0, s19, 49152
s_nop 0
buffer_load_dwordx4 v137, s[8:11], s15 offen offset:0 lds
buffer_load_dwordx4 v138, s[8:11], s15 offen offset:1024 lds
buffer_load_dwordx4 v139, s[8:11], s15 offen offset:2048 lds
buffer_load_dwordx4 v140, s[8:11], s15 offen offset:3072 lds
s_add_u32 s15, s15, s17
s_cmp_lg_u32 s56, 0
s_cbranch_scc1 main_kernel_w_epi
main_kernel_w_c1_n_ent:
v_mfma_f32_32x32x16_bf16 a[0:15], v[224:227], v[224:227], 0
s_waitcnt vmcnt(18)
s_barrier
ds_read_b128 v[32:35], v136 offset:0
ds_read_b64_tr_b16 v[0:1], v128 offset:0
ds_read_b64_tr_b16 v[2:3], v128 offset:8192
v_mfma_f32_32x32x16_bf16 a[16:31], v[224:227], v[224:227], 0
ds_read_b64_tr_b16 v[4:5], v129 offset:0
ds_read_b64_tr_b16 v[6:7], v129 offset:8192
ds_read_b64_tr_b16 v[8:9], v130 offset:0
v_mfma_f32_32x32x16_bf16 a[32:47], v[224:227], v[224:227], 0
ds_read_b64_tr_b16 v[10:11], v130 offset:8192
ds_read_b64_tr_b16 v[12:13], v131 offset:0
ds_read_b64_tr_b16 v[14:15], v131 offset:8192
v_mfma_f32_32x32x16_bf16 a[48:63], v[224:227], v[224:227], 0
ds_read_b64_tr_b16 v[16:17], v132 offset:0
ds_read_b64_tr_b16 v[18:19], v132 offset:8192
ds_read_b64_tr_b16 v[20:21], v133 offset:0
v_mfma_f32_32x32x16_bf16 a[64:79], v[224:227], v[224:227], 0
ds_read_b64_tr_b16 v[22:23], v133 offset:8192
ds_read_b64_tr_b16 v[24:25], v134 offset:0
ds_read_b64_tr_b16 v[26:27], v134 offset:8192
v_mfma_f32_32x32x16_bf16 a[80:95], v[224:227], v[224:227], 0
ds_read_b64_tr_b16 v[28:29], v135 offset:0
ds_read_b64_tr_b16 v[30:31], v135 offset:8192
ds_read_b128 v[36:39], v136 offset:1024
v_mfma_f32_32x32x16_bf16 a[96:111], v[224:227], v[224:227], 0
ds_read_b128 v[40:43], v136 offset:2048
ds_read_b128 v[44:47], v136 offset:3072
v_mfma_f32_32x32x16_bf16 a[112:127], v[224:227], v[224:227], 0
s_sub_u32 s18, s72, 1
s_sub_u32 s55, s72, 2
s_orn2_b32 s55, s55, s100
s_mov_b32 s73, -1
s_nop 0
main_kernel_w_c1_n_loop:
main_kernel_w_c1_n_mid:
s_waitcnt lgkmcnt(0)
v_mfma_f32_16x16x32_bf16 a[0:3], v[0:3], v[32:35], a[0:3]
s_waitcnt vmcnt(12)
s_barrier
ds_read_b128 v[80:83], v136 offset:8192
s_add_u32 m0, s20, 0
s_nop 0
v_mfma_f32_16x16x32_bf16 a[4:7], v[4:7], v[32:35], a[4:7]
ds_read_b64_tr_b16 v[48:49], v128 offset:16384
v_mfma_f32_16x16x32_bf16 a[8:11], v[8:11], v[32:35], a[8:11]
ds_read_b64_tr_b16 v[50:51], v128 offset:24576
v_mfma_f32_16x16x32_bf16 a[12:15], v[12:15], v[32:35], a[12:15]
ds_read_b64_tr_b16 v[52:53], v129 offset:16384
buffer_load_dwordx4 v141, s[4:7], s16 offen offset:0 sc1 lds
v_mfma_f32_16x16x32_bf16 a[16:19], v[16:19], v[32:35], a[16:19]
ds_read_b64_tr_b16 v[54:55], v129 offset:24576
v_mfma_f32_16x16x32_bf16 a[20:23], v[20:23], v[32:35], a[20:23]
ds_read_b64_tr_b16 v[56:57], v130 offset:16384
v_mfma_f32_16x16x32_bf16 a[24:27], v[24:27], v[32:35], a[24:27]
ds_read_b64_tr_b16 v[58:59], v130 offset:24576
buffer_load_dwordx4 v142, s[4:7], s16 offen offset:1024 sc1 lds
v_mfma_f32_16x16x32_bf16 a[28:31], v[28:31], v[32:35], a[28:31]
ds_read_b64_tr_b16 v[60:61], v131 offset:16384
v_mfma_f32_16x16x32_bf16 a[32:35], v[0:3], v[36:39], a[32:35]
ds_read_b64_tr_b16 v[62:63], v131 offset:24576
v_mfma_f32_16x16x32_bf16 a[36:39], v[4:7], v[36:39], a[36:39]
ds_read_b64_tr_b16 v[64:65], v132 offset:16384
s_add_u32 s16, s16, 1024
v_mfma_f32_16x16x32_bf16 a[40:43], v[8:11], v[36:39], a[40:43]
ds_read_b64_tr_b16 v[66:67], v132 offset:24576
v_mfma_f32_16x16x32_bf16 a[44:47], v[12:15], v[36:39], a[44:47]
ds_read_b64_tr_b16 v[68:69], v133 offset:16384
v_mfma_f32_16x16x32_bf16 a[48:51], v[16:19], v[36:39], a[48:51]
ds_read_b64_tr_b16 v[70:71], v133 offset:24576
s_add_u32 m0, s19, 0
s_nop 0
v_mfma_f32_16x16x32_bf16 a[52:55], v[20:23], v[36:39], a[52:55]
ds_read_b64_tr_b16 v[72:73], v134 offset:16384
v_mfma_f32_16x16x32_bf16 a[56:59], v[24:27], v[36:39], a[56:59]
ds_read_b64_tr_b16 v[74:75], v134 offset:24576
v_mfma_f32_16x16x32_bf16 a[60:63], v[28:31], v[36:39], a[60:63]
ds_read_b64_tr_b16 v[76:77], v135 offset:16384
buffer_load_dwordx4 v137, s[8:11], s15 offen offset:0 lds
v_mfma_f32_16x16x32_bf16 a[64:67], v[0:3], v[40:43], a[64:67]
ds_read_b64_tr_b16 v[78:79], v135 offset:24576
v_mfma_f32_16x16x32_bf16 a[68:71], v[4:7], v[40:43], a[68:71]
ds_read_b128 v[84:87], v136 offset:9216
v_mfma_f32_16x16x32_bf16 a[72:75], v[8:11], v[40:43], a[72:75]
ds_read_b128 v[88:91], v136 offset:10240
buffer_load_dwordx4 v138, s[8:11], s15 offen offset:1024 lds
v_mfma_f32_16x16x32_bf16 a[76:79], v[12:15], v[40:43], a[76:79]
ds_read_b128 v[92:95], v136 offset:11264
v_mfma_f32_16x16x32_bf16 a[80:83], v[16:19], v[40:43], a[80:83]
v_mfma_f32_16x16x32_bf16 a[84:87], v[20:23], v[40:43], a[84:87]
buffer_load_dwordx4 v139, s[8:11], s15 offen offset:2048 lds
v_mfma_f32_16x16x32_bf16 a[88:91], v[24:27], v[40:43], a[88:91]
v_mfma_f32_16x16x32_bf16 a[92:95], v[28:31], v[40:43], a[92:95]
v_mfma_f32_16x16x32_bf16 a[96:99], v[0:3], v[44:47], a[96:99]
buffer_load_dwordx4 v140, s[8:11], s15 offen offset:3072 lds
v_mfma_f32_16x16x32_bf16 a[100:103], v[4:7], v[44:47], a[100:103]
v_mfma_f32_16x16x32_bf16 a[104:107], v[8:11], v[44:47], a[104:107]
v_mfma_f32_16x16x32_bf16 a[108:111], v[12:15], v[44:47], a[108:111]
s_add_u32 s15, s15, s17
v_mfma_f32_16x16x32_bf16 a[112:115], v[16:19], v[44:47], a[112:115]
v_mfma_f32_16x16x32_bf16 a[116:119], v[20:23], v[44:47], a[116:119]
v_mfma_f32_16x16x32_bf16 a[120:123], v[24:27], v[44:47], a[120:123]
v_mfma_f32_16x16x32_bf16 a[124:127], v[28:31], v[44:47], a[124:127]
s_waitcnt lgkmcnt(0)
v_mfma_f32_16x16x32_bf16 a[0:3], v[48:51], v[80:83], a[0:3]
s_waitcnt vmcnt(12)
s_barrier
ds_read_b128 v[32:35], v136 offset:16384
s_add_u32 m0, s20, 8192
s_nop 0
v_mfma_f32_16x16x32_bf16 a[4:7], v[52:55], v[80:83], a[4:7]
ds_read_b64_tr_b16 v[0:1], v128 offset:32768
v_mfma_f32_16x16x32_bf16 a[8:11], v[56:59], v[80:83], a[8:11]
ds_read_b64_tr_b16 v[2:3], v128 offset:40960
v_mfma_f32_16x16x32_bf16 a[12:15], v[60:63], v[80:83], a[12:15]
ds_read_b64_tr_b16 v[4:5], v129 offset:32768
buffer_load_dwordx4 v141, s[4:7], s16 offen offset:0 sc1 lds
v_mfma_f32_16x16x32_bf16 a[16:19], v[64:67], v[80:83], a[16:19]
ds_read_b64_tr_b16 v[6:7], v129 offset:40960
v_mfma_f32_16x16x32_bf16 a[20:23], v[68:71], v[80:83], a[20:23]
ds_read_b64_tr_b16 v[8:9], v130 offset:32768
v_mfma_f32_16x16x32_bf16 a[24:27], v[72:75], v[80:83], a[24:27]
ds_read_b64_tr_b16 v[10:11], v130 offset:40960
buffer_load_dwordx4 v142, s[4:7], s16 offen offset:1024 sc1 lds
v_mfma_f32_16x16x32_bf16 a[28:31], v[76:79], v[80:83], a[28:31]
ds_read_b64_tr_b16 v[12:13], v131 offset:32768
v_mfma_f32_16x16x32_bf16 a[32:35], v[48:51], v[84:87], a[32:35]
ds_read_b64_tr_b16 v[14:15], v131 offset:40960
v_mfma_f32_16x16x32_bf16 a[36:39], v[52:55], v[84:87], a[36:39]
ds_read_b64_tr_b16 v[16:17], v132 offset:32768
s_add_u32 s16, s16, 1024
v_mfma_f32_16x16x32_bf16 a[40:43], v[56:59], v[84:87], a[40:43]
ds_read_b64_tr_b16 v[18:19], v132 offset:40960
v_mfma_f32_16x16x32_bf16 a[44:47], v[60:63], v[84:87], a[44:47]
ds_read_b64_tr_b16 v[20:21], v133 offset:32768
v_mfma_f32_16x16x32_bf16 a[48:51], v[64:67], v[84:87], a[48:51]
ds_read_b64_tr_b16 v[22:23], v133 offset:40960
s_add_u32 m0, s19, 16384
s_nop 0
v_mfma_f32_16x16x32_bf16 a[52:55], v[68:71], v[84:87], a[52:55]
ds_read_b64_tr_b16 v[24:25], v134 offset:32768
v_mfma_f32_16x16x32_bf16 a[56:59], v[72:75], v[84:87], a[56:59]
ds_read_b64_tr_b16 v[26:27], v134 offset:40960
v_mfma_f32_16x16x32_bf16 a[60:63], v[76:79], v[84:87], a[60:63]
ds_read_b64_tr_b16 v[28:29], v135 offset:32768
buffer_load_dwordx4 v137, s[8:11], s15 offen offset:0 lds
v_mfma_f32_16x16x32_bf16 a[64:67], v[48:51], v[88:91], a[64:67]
ds_read_b64_tr_b16 v[30:31], v135 offset:40960
v_mfma_f32_16x16x32_bf16 a[68:71], v[52:55], v[88:91], a[68:71]
ds_read_b128 v[36:39], v136 offset:17408
v_mfma_f32_16x16x32_bf16 a[72:75], v[56:59], v[88:91], a[72:75]
ds_read_b128 v[40:43], v136 offset:18432
buffer_load_dwordx4 v138, s[8:11], s15 offen offset:1024 lds
v_mfma_f32_16x16x32_bf16 a[76:79], v[60:63], v[88:91], a[76:79]
ds_read_b128 v[44:47], v136 offset:19456
v_mfma_f32_16x16x32_bf16 a[80:83], v[64:67], v[88:91], a[80:83]
v_mfma_f32_16x16x32_bf16 a[84:87], v[68:71], v[88:91], a[84:87]
buffer_load_dwordx4 v139, s[8:11], s15 offen offset:2048 lds
v_mfma_f32_16x16x32_bf16 a[88:91], v[72:75], v[88:91], a[88:91]
v_mfma_f32_16x16x32_bf16 a[92:95], v[76:79], v[88:91], a[92:95]
v_mfma_f32_16x16x32_bf16 a[96:99], v[48:51], v[92:95], a[96:99]
buffer_load_dwordx4 v140, s[8:11], s15 offen offset:3072 lds
v_mfma_f32_16x16x32_bf16 a[100:103], v[52:55], v[92:95], a[100:103]
v_mfma_f32_16x16x32_bf16 a[104:107], v[56:59], v[92:95], a[104:107]
v_mfma_f32_16x16x32_bf16 a[108:111], v[60:63], v[92:95], a[108:111]
s_add_u32 s15, s15, s17
v_mfma_f32_16x16x32_bf16 a[112:115], v[64:67], v[92:95], a[112:115]
v_mfma_f32_16x16x32_bf16 a[116:119], v[68:71], v[92:95], a[116:119]
v_mfma_f32_16x16x32_bf16 a[120:123], v[72:75], v[92:95], a[120:123]
v_mfma_f32_16x16x32_bf16 a[124:127], v[76:79], v[92:95], a[124:127]
s_waitcnt lgkmcnt(0)
v_mfma_f32_16x16x32_bf16 a[0:3], v[0:3], v[32:35], a[0:3]
s_waitcnt vmcnt(12)
s_barrier
ds_read_b128 v[80:83], v136 offset:24576
s_add_u32 m0, s20, 16384
s_nop 0
v_mfma_f32_16x16x32_bf16 a[4:7], v[4:7], v[32:35], a[4:7]
ds_read_b64_tr_b16 v[48:49], v128 offset:49152
v_mfma_f32_16x16x32_bf16 a[8:11], v[8:11], v[32:35], a[8:11]
ds_read_b64_tr_b16 v[50:51], v128 offset:57344
v_mfma_f32_16x16x32_bf16 a[12:15], v[12:15], v[32:35], a[12:15]
ds_read_b64_tr_b16 v[52:53], v129 offset:49152
buffer_load_dwordx4 v141, s[4:7], s16 offen offset:0 sc1 lds
v_mfma_f32_16x16x32_bf16 a[16:19], v[16:19], v[32:35], a[16:19]
ds_read_b64_tr_b16 v[54:55], v129 offset:57344
v_mfma_f32_16x16x32_bf16 a[20:23], v[20:23], v[32:35], a[20:23]
ds_read_b64_tr_b16 v[56:57], v130 offset:49152
v_mfma_f32_16x16x32_bf16 a[24:27], v[24:27], v[32:35], a[24:27]
ds_read_b64_tr_b16 v[58:59], v130 offset:57344
buffer_load_dwordx4 v142, s[4:7], s16 offen offset:1024 sc1 lds
v_mfma_f32_16x16x32_bf16 a[28:31], v[28:31], v[32:35], a[28:31]
ds_read_b64_tr_b16 v[60:61], v131 offset:49152
v_mfma_f32_16x16x32_bf16 a[32:35], v[0:3], v[36:39], a[32:35]
ds_read_b64_tr_b16 v[62:63], v131 offset:57344
v_mfma_f32_16x16x32_bf16 a[36:39], v[4:7], v[36:39], a[36:39]
ds_read_b64_tr_b16 v[64:65], v132 offset:49152
s_add_u32 s16, s16, 1024
v_mfma_f32_16x16x32_bf16 a[40:43], v[8:11], v[36:39], a[40:43]
ds_read_b64_tr_b16 v[66:67], v132 offset:57344
v_mfma_f32_16x16x32_bf16 a[44:47], v[12:15], v[36:39], a[44:47]
ds_read_b64_tr_b16 v[68:69], v133 offset:49152
v_mfma_f32_16x16x32_bf16 a[48:51], v[16:19], v[36:39], a[48:51]
ds_read_b64_tr_b16 v[70:71], v133 offset:57344
s_add_u32 m0, s19, 32768
s_nop 0
v_mfma_f32_16x16x32_bf16 a[52:55], v[20:23], v[36:39], a[52:55]
ds_read_b64_tr_b16 v[72:73], v134 offset:49152
v_mfma_f32_16x16x32_bf16 a[56:59], v[24:27], v[36:39], a[56:59]
ds_read_b64_tr_b16 v[74:75], v134 offset:57344
v_mfma_f32_16x16x32_bf16 a[60:63], v[28:31], v[36:39], a[60:63]
ds_read_b64_tr_b16 v[76:77], v135 offset:49152
buffer_load_dwordx4 v137, s[8:11], s15 offen offset:0 lds
v_mfma_f32_16x16x32_bf16 a[64:67], v[0:3], v[40:43], a[64:67]
ds_read_b64_tr_b16 v[78:79], v135 offset:57344
v_mfma_f32_16x16x32_bf16 a[68:71], v[4:7], v[40:43], a[68:71]
ds_read_b128 v[84:87], v136 offset:25600
v_mfma_f32_16x16x32_bf16 a[72:75], v[8:11], v[40:43], a[72:75]
ds_read_b128 v[88:91], v136 offset:26624
buffer_load_dwordx4 v138, s[8:11], s15 offen offset:1024 lds
v_mfma_f32_16x16x32_bf16 a[76:79], v[12:15], v[40:43], a[76:79]
ds_read_b128 v[92:95], v136 offset:27648
v_mfma_f32_16x16x32_bf16 a[80:83], v[16:19], v[40:43], a[80:83]
v_mfma_f32_16x16x32_bf16 a[84:87], v[20:23], v[40:43], a[84:87]
buffer_load_dwordx4 v139, s[8:11], s15 offen offset:2048 lds
v_mfma_f32_16x16x32_bf16 a[88:91], v[24:27], v[40:43], a[88:91]
v_mfma_f32_16x16x32_bf16 a[92:95], v[28:31], v[40:43], a[92:95]
v_mfma_f32_16x16x32_bf16 a[96:99], v[0:3], v[44:47], a[96:99]
buffer_load_dwordx4 v140, s[8:11], s15 offen offset:3072 lds
v_mfma_f32_16x16x32_bf16 a[100:103], v[4:7], v[44:47], a[100:103]
v_mfma_f32_16x16x32_bf16 a[104:107], v[8:11], v[44:47], a[104:107]
v_mfma_f32_16x16x32_bf16 a[108:111], v[12:15], v[44:47], a[108:111]
s_add_u32 s15, s15, s17
v_mfma_f32_16x16x32_bf16 a[112:115], v[16:19], v[44:47], a[112:115]
v_mfma_f32_16x16x32_bf16 a[116:119], v[20:23], v[44:47], a[116:119]
v_mfma_f32_16x16x32_bf16 a[120:123], v[24:27], v[44:47], a[120:123]
v_mfma_f32_16x16x32_bf16 a[124:127], v[28:31], v[44:47], a[124:127]
s_waitcnt lgkmcnt(0)
v_mfma_f32_16x16x32_bf16 a[0:3], v[48:51], v[80:83], a[0:3]
s_waitcnt vmcnt(12)
s_barrier
ds_read_b128 v[32:35], v136 offset:0
s_add_u32 m0, s20, 24576
s_nop 0
v_mfma_f32_16x16x32_bf16 a[4:7], v[52:55], v[80:83], a[4:7]
ds_read_b64_tr_b16 v[0:1], v128 offset:0
v_mfma_f32_16x16x32_bf16 a[8:11], v[56:59], v[80:83], a[8:11]
ds_read_b64_tr_b16 v[2:3], v128 offset:8192
v_mfma_f32_16x16x32_bf16 a[12:15], v[60:63], v[80:83], a[12:15]
ds_read_b64_tr_b16 v[4:5], v129 offset:0
buffer_load_dwordx4 v141, s[4:7], s16 offen offset:0 sc1 lds
v_mfma_f32_16x16x32_bf16 a[16:19], v[64:67], v[80:83], a[16:19]
ds_read_b64_tr_b16 v[6:7], v129 offset:8192
v_mfma_f32_16x16x32_bf16 a[20:23], v[68:71], v[80:83], a[20:23]
ds_read_b64_tr_b16 v[8:9], v130 offset:0
v_mfma_f32_16x16x32_bf16 a[24:27], v[72:75], v[80:83], a[24:27]
ds_read_b64_tr_b16 v[10:11], v130 offset:8192
buffer_load_dwordx4 v142, s[4:7], s16 offen offset:1024 sc1 lds
v_mfma_f32_16x16x32_bf16 a[28:31], v[76:79], v[80:83], a[28:31]
ds_read_b64_tr_b16 v[12:13], v131 offset:0
v_mfma_f32_16x16x32_bf16 a[32:35], v[48:51], v[84:87], a[32:35]
ds_read_b64_tr_b16 v[14:15], v131 offset:8192
v_mfma_f32_16x16x32_bf16 a[36:39], v[52:55], v[84:87], a[36:39]
ds_read_b64_tr_b16 v[16:17], v132 offset:0
s_add_u32 s16, s16, 1024
v_mfma_f32_16x16x32_bf16 a[40:43], v[56:59], v[84:87], a[40:43]
ds_read_b64_tr_b16 v[18:19], v132 offset:8192
v_mfma_f32_16x16x32_bf16 a[44:47], v[60:63], v[84:87], a[44:47]
ds_read_b64_tr_b16 v[20:21], v133 offset:0
v_mfma_f32_16x16x32_bf16 a[48:51], v[64:67], v[84:87], a[48:51]
ds_read_b64_tr_b16 v[22:23], v133 offset:8192
s_add_u32 m0, s19, 49152
s_nop 0
v_mfma_f32_16x16x32_bf16 a[52:55], v[68:71], v[84:87], a[52:55]
ds_read_b64_tr_b16 v[24:25], v134 offset:0
v_mfma_f32_16x16x32_bf16 a[56:59], v[72:75], v[84:87], a[56:59]
ds_read_b64_tr_b16 v[26:27], v134 offset:8192
v_mfma_f32_16x16x32_bf16 a[60:63], v[76:79], v[84:87], a[60:63]
ds_read_b64_tr_b16 v[28:29], v135 offset:0
buffer_load_dwordx4 v137, s[8:11], s15 offen offset:0 lds
v_mfma_f32_16x16x32_bf16 a[64:67], v[48:51], v[88:91], a[64:67]
ds_read_b64_tr_b16 v[30:31], v135 offset:8192
v_mfma_f32_16x16x32_bf16 a[68:71], v[52:55], v[88:91], a[68:71]
ds_read_b128 v[36:39], v136 offset:1024
v_mfma_f32_16x16x32_bf16 a[72:75], v[56:59], v[88:91], a[72:75]
ds_read_b128 v[40:43], v136 offset:2048
buffer_load_dwordx4 v138, s[8:11], s15 offen offset:1024 lds
v_mfma_f32_16x16x32_bf16 a[76:79], v[60:63], v[88:91], a[76:79]
ds_read_b128 v[44:47], v136 offset:3072
v_mfma_f32_16x16x32_bf16 a[80:83], v[64:67], v[88:91], a[80:83]
v_mfma_f32_16x16x32_bf16 a[84:87], v[68:71], v[88:91], a[84:87]
buffer_load_dwordx4 v139, s[8:11], s15 offen offset:2048 lds
v_mfma_f32_16x16x32_bf16 a[88:91], v[72:75], v[88:91], a[88:91]
v_mfma_f32_16x16x32_bf16 a[92:95], v[76:79], v[88:91], a[92:95]
v_mfma_f32_16x16x32_bf16 a[96:99], v[48:51], v[92:95], a[96:99]
buffer_load_dwordx4 v140, s[8:11], s15 offen offset:3072 lds
v_mfma_f32_16x16x32_bf16 a[100:103], v[52:55], v[92:95], a[100:103]
v_mfma_f32_16x16x32_bf16 a[104:107], v[56:59], v[92:95], a[104:107]
v_mfma_f32_16x16x32_bf16 a[108:111], v[60:63], v[92:95], a[108:111]
s_add_u32 s15, s15, s17
v_mfma_f32_16x16x32_bf16 a[112:115], v[64:67], v[92:95], a[112:115]
v_mfma_f32_16x16x32_bf16 a[116:119], v[68:71], v[92:95], a[116:119]
v_mfma_f32_16x16x32_bf16 a[120:123], v[72:75], v[92:95], a[120:123]
v_mfma_f32_16x16x32_bf16 a[124:127], v[76:79], v[92:95], a[124:127]
s_sub_u32 s18, s18, 1
s_cmp_eq_u32 s18, s55
s_cbranch_scc1 main_kernel_w_c1_n_ev
s_cmp_lg_u32 s18, 0
s_cbranch_scc1 main_kernel_w_c1_n_loop
s_cmp_lg_u32 s73, -1
s_cbranch_scc1 main_kernel_w_epn
s_waitcnt lgkmcnt(0)
v_mfma_f32_16x16x32_bf16 a[0:3], v[0:3], v[32:35], a[0:3]
s_waitcnt vmcnt(12)
s_barrier
ds_read_b128 v[80:83], v136 offset:8192
s_add_u32 m0, s20, 0
s_nop 0
s_add_u32 s32, s23, 1
s_bitcmp0_b32 s32, 2
s_cselect_b32 s34, 7, 2
s_cselect_b32 s35, 2, 4
s_lshl_b32 s59, s23, 13
s_add_u32 s59, s59, 0x8404000
v_mfma_f32_16x16x32_bf16 a[4:7], v[4:7], v[32:35], a[4:7]
ds_read_b64_tr_b16 v[48:49], v128 offset:16384
v_lshrrev_b32 v253, 3, v250
v_add_lshl_u32 v253, s24, v253, 9
v_mfma_f32_16x16x32_bf16 a[8:11], v[8:11], v[32:35], a[8:11]
ds_read_b64_tr_b16 v[50:51], v128 offset:24576
v_and_b32 v254, 3, v250
v_lshl_add_u32 v253, v254, s34, v253
v_mfma_f32_16x16x32_bf16 a[12:15], v[12:15], v[32:35], a[12:15]
ds_read_b64_tr_b16 v[52:53], v129 offset:16384
buffer_load_dwordx4 v141, s[4:7], s16 offen offset:0 sc1 lds
v_bfe_u32 v254, v250, 2, 1
v_add_u32 v254, s25, v254
v_mfma_f32_16x16x32_bf16 a[16:19], v[16:19], v[32:35], a[16:19]
ds_read_b64_tr_b16 v[54:55], v129 offset:24576
v_lshl_add_u32 v248, v254, s35, v253
s_lshl_b32 s0, 4, s54
v_mfma_f32_16x16x32_bf16 a[20:23], v[20:23], v[32:35], a[20:23]
ds_read_b64_tr_b16 v[56:57], v130 offset:16384
v_readfirstlane_b32 s28, v249
s_nop 1
v_cmp_ge_u32 vcc, s28, v229
v_mfma_f32_16x16x32_bf16 a[24:27], v[24:27], v[32:35], a[24:27]
ds_read_b64_tr_b16 v[58:59], v130 offset:24576
buffer_load_dwordx4 v142, s[4:7], s16 offen offset:1024 sc1 lds
s_nop 1
s_bcnt1_i32_b64 s32, vcc
v_mfma_f32_16x16x32_bf16 a[28:31], v[28:31], v[32:35], a[28:31]
ds_read_b64_tr_b16 v[60:61], v131 offset:16384
s_sub_u32 s32, s32, 1
v_readlane_b32 s36, v230, s32
v_mfma_f32_16x16x32_bf16 a[32:35], v[0:3], v[36:39], a[32:35]
ds_read_b64_tr_b16 v[62:63], v131 offset:24576
s_nop 1
s_and_b32 s32, s36, 0x7ff
v_mfma_f32_16x16x32_bf16 a[36:39], v[4:7], v[36:39], a[36:39]
ds_read_b64_tr_b16 v[64:65], v132 offset:16384
s_add_u32 s16, s16, 1024
s_sub_u32 s28, s28, s32
s_bfe_u32 s32, s36, 0x3001a
v_mfma_f32_16x16x32_bf16 a[40:43], v[8:11], v[36:39], a[40:43]
ds_read_b64_tr_b16 v[66:67], v132 offset:24576
s_lshr_b32 s25, s28, s32
s_lshl_b32 s33, s25, s32
s_sub_u32 s24, s28, s33
v_mfma_f32_16x16x32_bf16 a[44:47], v[12:15], v[36:39], a[44:47]
ds_read_b64_tr_b16 v[68:69], v133 offset:16384
s_bfe_u32 s34, s36, 0x1001d
s_lshl_b32 s24, s24, s34
v_mfma_f32_16x16x32_bf16 a[48:51], v[16:19], v[36:39], a[48:51]
ds_read_b64_tr_b16 v[70:71], v133 offset:24576
s_add_u32 m0, s19, 0
s_nop 0
s_bfe_u32 s35, s36, 0x1001e
s_lshl_b32 s25, s25, s35
v_mfma_f32_16x16x32_bf16 a[52:55], v[20:23], v[36:39], a[52:55]
ds_read_b64_tr_b16 v[72:73], v134 offset:16384
s_bfe_u32 s32, s36, 0x40011
s_add_u32 s24, s24, s32
v_mfma_f32_16x16x32_bf16 a[56:59], v[24:27], v[36:39], a[56:59]
ds_read_b64_tr_b16 v[74:75], v134 offset:24576
s_bfe_u32 s32, s36, 0x50015
s_add_u32 s25, s25, s32
v_mfma_f32_16x16x32_bf16 a[60:63], v[28:31], v[36:39], a[60:63]
ds_read_b64_tr_b16 v[76:77], v135 offset:16384
buffer_load_dwordx4 v137, s[8:11], s15 offen offset:0 lds
s_bfe_u32 s23, s36, 0x4000b
s_bfe_u32 s36, s36, 0x6000b
s_lshl_b32 s32, s24, 8
v_mfma_f32_16x16x32_bf16 a[64:67], v[0:3], v[40:43], a[64:67]
ds_read_b64_tr_b16 v[78:79], v135 offset:24576
s_or_b32 s36, s36, s32
s_lshl_b32 s32, s25, 16
v_mfma_f32_16x16x32_bf16 a[68:71], v[4:7], v[40:43], a[68:71]
ds_read_b128 v[84:87], v136 offset:9216
s_or_b32 s36, s36, s32
s_cmp_eq_u32 s23, 4
s_cselect_b32 s32, 1, 0
v_mfma_f32_16x16x32_bf16 a[72:75], v[8:11], v[40:43], a[72:75]
ds_read_b128 v[88:91], v136 offset:10240
buffer_load_dwordx4 v138, s[8:11], s15 offen offset:1024 lds
s_sub_u32 s48, s24, s32
s_max_i32 s48, s48, 0
v_mfma_f32_16x16x32_bf16 a[76:79], v[12:15], v[40:43], a[76:79]
ds_read_b128 v[92:95], v136 offset:11264
s_add_u32 s49, s24, s34
s_add_u32 s49, s49, s32
v_mfma_f32_16x16x32_bf16 a[80:83], v[16:19], v[40:43], a[80:83]
s_min_u32 s49, s49, 15
s_cmp_eq_u32 s23, 6
s_cselect_b32 s51, 3, 7
s_cmp_eq_u32 s23, 7
s_cselect_b32 s51, 27, s51
s_cselect_b32 s50, 5, 4
v_mfma_f32_16x16x32_bf16 a[84:87], v[20:23], v[40:43], a[84:87]
buffer_load_dwordx4 v139, s[8:11], s15 offen offset:2048 lds
s_add_u32 s33, s25, s35
s_lshl_b32 s34, s24, 9
v_mfma_f32_16x16x32_bf16 a[88:91], v[24:27], v[40:43], a[88:91]
s_cmp_eq_u32 s23, 8
s_cselect_b32 s51, 0, s51
s_cselect_b32 s48, s25, s48
s_cselect_b32 s49, s33, s49
s_cmp_eq_u32 s23, 8
s_cselect_b32 s63, 2, 9
s_cselect_b32 s61, 0, 0x7f000000
s_cselect_b32 s34, s34, 0
v_mfma_f32_16x16x32_bf16 a[92:95], v[28:31], v[40:43], a[92:95]
v_lshrrev_b32 v228, s50, v250
v_lshlrev_b32 v254, s50, v228
v_mfma_f32_16x16x32_bf16 a[96:99], v[0:3], v[44:47], a[96:99]
buffer_load_dwordx4 v140, s[8:11], s15 offen offset:3072 lds
v_sub_u32 v254, v250, v254
s_cmp_lt_u32 s23, 4
s_cselect_b32 s39, 10, s23
v_mfma_f32_16x16x32_bf16 a[100:103], v[4:7], v[44:47], a[100:103]
v_min_u32 v254, s51, v254
s_lshl_b32 s39, s39, 13
s_cmp_eq_u32 s23, 3
s_cselect_b32 s34, 4, s34
v_mfma_f32_16x16x32_bf16 a[104:107], v[8:11], v[44:47], a[104:107]
v_add_u32 v228, s48, v228
s_add_u32 s39, s39, s34
v_mfma_f32_16x16x32_bf16 a[108:111], v[12:15], v[44:47], a[108:111]
s_add_u32 s15, s15, s17
s_add_u32 s39, s39, 0x8402000
v_min_u32 v228, s49, v228
v_mfma_f32_16x16x32_bf16 a[112:115], v[16:19], v[44:47], a[112:115]
s_lshl_b32 s60, s24, 10
s_add_u32 s60, s60, 0x8400000
v_mfma_f32_16x16x32_bf16 a[116:119], v[20:23], v[44:47], a[116:119]
v_lshlrev_b32 v228, s63, v228
v_lshl_add_u32 v228, v254, 4, v228
v_mfma_f32_16x16x32_bf16 a[120:123], v[24:27], v[44:47], a[120:123]
v_or_b32 v146, s61, v251
s_mov_b64 exec, s[100:101]
buffer_load_dword v231, v228, s[4:7], s39 offen sc1
buffer_load_dwordx4 v[232:235], v146, s[4:7], s60 offen sc1
s_mov_b64 exec, -1
v_mfma_f32_16x16x32_bf16 a[124:127], v[28:31], v[44:47], a[124:127]
s_waitcnt lgkmcnt(0)
v_mfma_f32_16x16x32_bf16 a[0:3], v[48:51], v[80:83], a[0:3]
s_waitcnt vmcnt(12)
s_barrier
ds_read_b128 v[32:35], v136 offset:16384
s_add_u32 m0, s20, 8192
s_nop 0
s_mov_b32 s1, s21
v_mfma_f32_16x16x32_bf16 a[4:7], v[52:55], v[80:83], a[4:7]
ds_read_b64_tr_b16 v[0:1], v128 offset:32768
v_mfma_f32_16x16x32_bf16 a[8:11], v[56:59], v[80:83], a[8:11]
ds_read_b64_tr_b16 v[2:3], v128 offset:40960
v_mfma_f32_16x16x32_bf16 a[12:15], v[60:63], v[80:83], a[12:15]
ds_read_b64_tr_b16 v[4:5], v129 offset:32768
buffer_load_dwordx4 v141, s[4:7], s16 offen offset:0 sc1 lds
v_mfma_f32_16x16x32_bf16 a[16:19], v[64:67], v[80:83], a[16:19]
ds_read_b64_tr_b16 v[6:7], v129 offset:40960
v_mfma_f32_16x16x32_bf16 a[20:23], v[68:71], v[80:83], a[20:23]
ds_read_b64_tr_b16 v[8:9], v130 offset:32768
s_mov_b32 s2, s22
v_mfma_f32_16x16x32_bf16 a[24:27], v[72:75], v[80:83], a[24:27]
ds_read_b64_tr_b16 v[10:11], v130 offset:40960
buffer_load_dwordx4 v142, s[4:7], s16 offen offset:1024 sc1 lds
v_mfma_f32_16x16x32_bf16 a[28:31], v[76:79], v[80:83], a[28:31]
ds_read_b64_tr_b16 v[12:13], v131 offset:32768
v_mfma_f32_16x16x32_bf16 a[32:35], v[48:51], v[84:87], a[32:35]
ds_read_b64_tr_b16 v[14:15], v131 offset:40960
v_mfma_f32_16x16x32_bf16 a[36:39], v[52:55], v[84:87], a[36:39]
ds_read_b64_tr_b16 v[16:17], v132 offset:32768
s_add_u32 s16, s16, 1024
v_mfma_f32_16x16x32_bf16 a[40:43], v[56:59], v[84:87], a[40:43]
ds_read_b64_tr_b16 v[18:19], v132 offset:40960
s_mov_b32 s3, s26
v_mfma_f32_16x16x32_bf16 a[44:47], v[60:63], v[84:87], a[44:47]
ds_read_b64_tr_b16 v[20:21], v133 offset:32768
v_mfma_f32_16x16x32_bf16 a[48:51], v[64:67], v[84:87], a[48:51]
ds_read_b64_tr_b16 v[22:23], v133 offset:40960
s_add_u32 m0, s19, 16384
s_nop 0
v_mfma_f32_16x16x32_bf16 a[52:55], v[68:71], v[84:87], a[52:55]
ds_read_b64_tr_b16 v[24:25], v134 offset:32768
v_mfma_f32_16x16x32_bf16 a[56:59], v[72:75], v[84:87], a[56:59]
ds_read_b64_tr_b16 v[26:27], v134 offset:40960
v_mfma_f32_16x16x32_bf16 a[60:63], v[76:79], v[84:87], a[60:63]
ds_read_b64_tr_b16 v[28:29], v135 offset:32768
buffer_load_dwordx4 v137, s[8:11], s15 offen offset:0 lds
s_mov_b32 s56, s57
v_mfma_f32_16x16x32_bf16 a[64:67], v[48:51], v[88:91], a[64:67]
ds_read_b64_tr_b16 v[30:31], v135 offset:40960
v_mfma_f32_16x16x32_bf16 a[68:71], v[52:55], v[88:91], a[68:71]
ds_read_b128 v[36:39], v136 offset:17408
v_mfma_f32_16x16x32_bf16 a[72:75], v[56:59], v[88:91], a[72:75]
ds_read_b128 v[40:43], v136 offset:18432
buffer_load_dwordx4 v138, s[8:11], s15 offen offset:1024 lds
v_mfma_f32_16x16x32_bf16 a[76:79], v[60:63], v[88:91], a[76:79]
ds_read_b128 v[44:47], v136 offset:19456
v_mfma_f32_16x16x32_bf16 a[80:83], v[64:67], v[88:91], a[80:83]
v_mov_b32 v145, v252
v_mfma_f32_16x16x32_bf16 a[84:87], v[68:71], v[88:91], a[84:87]
buffer_load_dwordx4 v139, s[8:11], s15 offen offset:2048 lds
v_mfma_f32_16x16x32_bf16 a[88:91], v[72:75], v[88:91], a[88:91]
v_mfma_f32_16x16x32_bf16 a[92:95], v[76:79], v[88:91], a[92:95]
v_mfma_f32_16x16x32_bf16 a[96:99], v[48:51], v[92:95], a[96:99]
buffer_load_dwordx4 v140, s[8:11], s15 offen offset:3072 lds
v_mfma_f32_16x16x32_bf16 a[100:103], v[52:55], v[92:95], a[100:103]
v_mov_b32 v255, 131072
v_mfma_f32_16x16x32_bf16 a[104:107], v[56:59], v[92:95], a[104:107]
v_mfma_f32_16x16x32_bf16 a[108:111], v[60:63], v[92:95], a[108:111]
s_add_u32 s15, s15, s17
v_mfma_f32_16x16x32_bf16 a[112:115], v[64:67], v[92:95], a[112:115]
v_mfma_f32_16x16x32_bf16 a[116:119], v[68:71], v[92:95], a[116:119]
v_mfma_f32_16x16x32_bf16 a[120:123], v[72:75], v[92:95], a[120:123]
v_mfma_f32_16x16x32_bf16 a[124:127], v[76:79], v[92:95], a[124:127]
s_waitcnt lgkmcnt(0)
v_mfma_f32_16x16x32_bf16 a[0:3], v[0:3], v[32:35], a[0:3]
s_waitcnt vmcnt(12)
s_barrier
ds_read_b128 v[80:83], v136 offset:24576
s_add_u32 m0, s20, 16384
s_nop 0
v_mfma_f32_16x16x32_bf16 a[4:7], v[4:7], v[32:35], a[4:7]
ds_read_b64_tr_b16 v[48:49], v128 offset:49152
v_mfma_f32_16x16x32_bf16 a[8:11], v[8:11], v[32:35], a[8:11]
ds_read_b64_tr_b16 v[50:51], v128 offset:57344
v_mfma_f32_16x16x32_bf16 a[12:15], v[12:15], v[32:35], a[12:15]
ds_read_b64_tr_b16 v[52:53], v129 offset:49152
buffer_load_dwordx4 v141, s[4:7], s16 offen offset:0 sc1 lds
v_mfma_f32_16x16x32_bf16 a[16:19], v[16:19], v[32:35], a[16:19]
ds_read_b64_tr_b16 v[54:55], v129 offset:57344
v_mfma_f32_16x16x32_bf16 a[20:23], v[20:23], v[32:35], a[20:23]
ds_read_b64_tr_b16 v[56:57], v130 offset:49152
v_mfma_f32_16x16x32_bf16 a[24:27], v[24:27], v[32:35], a[24:27]
ds_read_b64_tr_b16 v[58:59], v130 offset:57344
buffer_load_dwordx4 v142, s[4:7], s16 offen offset:1024 sc1 lds
v_mfma_f32_16x16x32_bf16 a[28:31], v[28:31], v[32:35], a[28:31]
ds_read_b64_tr_b16 v[60:61], v131 offset:49152
v_mfma_f32_16x16x32_bf16 a[32:35], v[0:3], v[36:39], a[32:35]
ds_read_b64_tr_b16 v[62:63], v131 offset:57344
v_mfma_f32_16x16x32_bf16 a[36:39], v[4:7], v[36:39], a[36:39]
ds_read_b64_tr_b16 v[64:65], v132 offset:49152
s_add_u32 s16, s16, 1024
v_mfma_f32_16x16x32_bf16 a[40:43], v[8:11], v[36:39], a[40:43]
ds_read_b64_tr_b16 v[66:67], v132 offset:57344
v_mfma_f32_16x16x32_bf16 a[44:47], v[12:15], v[36:39], a[44:47]
ds_read_b64_tr_b16 v[68:69], v133 offset:49152
v_mfma_f32_16x16x32_bf16 a[48:51], v[16:19], v[36:39], a[48:51]
ds_read_b64_tr_b16 v[70:71], v133 offset:57344
s_add_u32 m0, s19, 32768
s_nop 0
v_mfma_f32_16x16x32_bf16 a[52:55], v[20:23], v[36:39], a[52:55]
ds_read_b64_tr_b16 v[72:73], v134 offset:49152
v_mfma_f32_16x16x32_bf16 a[56:59], v[24:27], v[36:39], a[56:59]
ds_read_b64_tr_b16 v[74:75], v134 offset:57344
v_mfma_f32_16x16x32_bf16 a[60:63], v[28:31], v[36:39], a[60:63]
ds_read_b64_tr_b16 v[76:77], v135 offset:49152
buffer_load_dwordx4 v137, s[8:11], s15 offen offset:0 lds
v_mfma_f32_16x16x32_bf16 a[64:67], v[0:3], v[40:43], a[64:67]
ds_read_b64_tr_b16 v[78:79], v135 offset:57344
v_mfma_f32_16x16x32_bf16 a[68:71], v[4:7], v[40:43], a[68:71]
ds_read_b128 v[84:87], v136 offset:25600
v_mfma_f32_16x16x32_bf16 a[72:75], v[8:11], v[40:43], a[72:75]
ds_read_b128 v[88:91], v136 offset:26624
buffer_load_dwordx4 v138, s[8:11], s15 offen offset:1024 lds
v_mfma_f32_16x16x32_bf16 a[76:79], v[12:15], v[40:43], a[76:79]
ds_read_b128 v[92:95], v136 offset:27648
v_mfma_f32_16x16x32_bf16 a[80:83], v[16:19], v[40:43], a[80:83]
s_waitcnt vmcnt(10)
v_mfma_f32_16x16x32_bf16 a[84:87], v[20:23], v[40:43], a[84:87]
buffer_load_dwordx4 v139, s[8:11], s15 offen offset:2048 lds
v_min3_u32 v253, v232, v233, v234
v_mfma_f32_16x16x32_bf16 a[88:91], v[24:27], v[40:43], a[88:91]
v_min_u32 v253, v253, v235
v_mfma_f32_16x16x32_bf16 a[92:95], v[28:31], v[40:43], a[92:95]
v_or_b32 v253, s61, v253
v_mfma_f32_16x16x32_bf16 a[96:99], v[0:3], v[44:47], a[96:99]
buffer_load_dwordx4 v140, s[8:11], s15 offen offset:3072 lds
v_min_u32 v253, v253, v231
v_mfma_f32_16x16x32_bf16 a[100:103], v[4:7], v[44:47], a[100:103]
v_cmp_eq_u32 vcc, 0, v253
v_mfma_f32_16x16x32_bf16 a[104:107], v[8:11], v[44:47], a[104:107]
s_nop 1
v_mfma_f32_16x16x32_bf16 a[108:111], v[12:15], v[44:47], a[108:111]
s_add_u32 s15, s15, s17
s_cmp_eq_u64 vcc, 0
s_cselect_b32 s32, s36, -4
v_mfma_f32_16x16x32_bf16 a[112:115], v[16:19], v[44:47], a[112:115]
s_bitcmp1_b32 0x1df, s23
s_cselect_b32 s32, s32, -4
v_mfma_f32_16x16x32_bf16 a[116:119], v[20:23], v[44:47], a[116:119]
v_mov_b32 v254, s32
v_mfma_f32_16x16x32_bf16 a[120:123], v[24:27], v[44:47], a[120:123]
s_mov_b64 exec, s[100:101]
ds_write_b32 v255, v254
s_mov_b64 exec, -1
v_mfma_f32_16x16x32_bf16 a[124:127], v[28:31], v[44:47], a[124:127]
s_waitcnt lgkmcnt(0)
v_mfma_f32_16x16x32_bf16 a[0:3], v[48:51], v[80:83], a[0:3]
s_waitcnt vmcnt(12)
s_barrier
ds_read_b128 v[32:35], v136 offset:0
s_add_u32 m0, s20, 24576
s_nop 0
ds_read_b32 v254, v255
v_mfma_f32_16x16x32_bf16 a[4:7], v[52:55], v[80:83], a[4:7]
ds_read_b64_tr_b16 v[0:1], v128 offset:0
v_mfma_f32_16x16x32_bf16 a[8:11], v[56:59], v[80:83], a[8:11]
ds_read_b64_tr_b16 v[2:3], v128 offset:8192
v_mfma_f32_16x16x32_bf16 a[12:15], v[60:63], v[80:83], a[12:15]
ds_read_b64_tr_b16 v[4:5], v129 offset:0
buffer_load_dwordx4 v141, s[4:7], s16 offen offset:0 sc1 lds
v_mfma_f32_16x16x32_bf16 a[16:19], v[64:67], v[80:83], a[16:19]
ds_read_b64_tr_b16 v[6:7], v129 offset:8192
v_mfma_f32_16x16x32_bf16 a[20:23], v[68:71], v[80:83], a[20:23]
ds_read_b64_tr_b16 v[8:9], v130 offset:0
v_mfma_f32_16x16x32_bf16 a[24:27], v[72:75], v[80:83], a[24:27]
ds_read_b64_tr_b16 v[10:11], v130 offset:8192
buffer_load_dwordx4 v142, s[4:7], s16 offen offset:1024 sc1 lds
v_mfma_f32_16x16x32_bf16 a[28:31], v[76:79], v[80:83], a[28:31]
ds_read_b64_tr_b16 v[12:13], v131 offset:0
v_mfma_f32_16x16x32_bf16 a[32:35], v[48:51], v[84:87], a[32:35]
ds_read_b64_tr_b16 v[14:15], v131 offset:8192
v_mfma_f32_16x16x32_bf16 a[36:39], v[52:55], v[84:87], a[36:39]
ds_read_b64_tr_b16 v[16:17], v132 offset:0
s_add_u32 s16, s16, 1024
v_mfma_f32_16x16x32_bf16 a[40:43], v[56:59], v[84:87], a[40:43]
ds_read_b64_tr_b16 v[18:19], v132 offset:8192
v_mfma_f32_16x16x32_bf16 a[44:47], v[60:63], v[84:87], a[44:47]
ds_read_b64_tr_b16 v[20:21], v133 offset:0
v_mfma_f32_16x16x32_bf16 a[48:51], v[64:67], v[84:87], a[48:51]
ds_read_b64_tr_b16 v[22:23], v133 offset:8192
s_add_u32 m0, s19, 49152
s_nop 0
v_mfma_f32_16x16x32_bf16 a[52:55], v[68:71], v[84:87], a[52:55]
ds_read_b64_tr_b16 v[24:25], v134 offset:0
v_mfma_f32_16x16x32_bf16 a[56:59], v[72:75], v[84:87], a[56:59]
ds_read_b64_tr_b16 v[26:27], v134 offset:8192
v_mfma_f32_16x16x32_bf16 a[60:63], v[76:79], v[84:87], a[60:63]
ds_read_b64_tr_b16 v[28:29], v135 offset:0
buffer_load_dwordx4 v137, s[8:11], s15 offen offset:0 lds
v_mfma_f32_16x16x32_bf16 a[64:67], v[48:51], v[88:91], a[64:67]
ds_read_b64_tr_b16 v[30:31], v135 offset:8192
v_mfma_f32_16x16x32_bf16 a[68:71], v[52:55], v[88:91], a[68:71]
ds_read_b128 v[36:39], v136 offset:1024
v_mfma_f32_16x16x32_bf16 a[72:75], v[56:59], v[88:91], a[72:75]
ds_read_b128 v[40:43], v136 offset:2048
buffer_load_dwordx4 v138, s[8:11], s15 offen offset:1024 lds
v_mfma_f32_16x16x32_bf16 a[76:79], v[60:63], v[88:91], a[76:79]
ds_read_b128 v[44:47], v136 offset:3072
v_mfma_f32_16x16x32_bf16 a[80:83], v[64:67], v[88:91], a[80:83]
s_waitcnt lgkmcnt(8)
v_mfma_f32_16x16x32_bf16 a[84:87], v[68:71], v[88:91], a[84:87]
buffer_load_dwordx4 v139, s[8:11], s15 offen offset:2048 lds
v_readfirstlane_b32 s62, v254
v_mfma_f32_16x16x32_bf16 a[88:91], v[72:75], v[88:91], a[88:91]
v_mfma_f32_16x16x32_bf16 a[92:95], v[76:79], v[88:91], a[92:95]
s_nop 1
v_mfma_f32_16x16x32_bf16 a[96:99], v[48:51], v[92:95], a[96:99]
buffer_load_dwordx4 v140, s[8:11], s15 offen offset:3072 lds
s_and_b32 s23, s62, 15
v_mfma_f32_16x16x32_bf16 a[100:103], v[52:55], v[92:95], a[100:103]
v_mfma_f32_16x16x32_bf16 a[104:107], v[56:59], v[92:95], a[104:107]
s_bfe_u32 s54, s62, 0x20004
v_mfma_f32_16x16x32_bf16 a[108:111], v[60:63], v[92:95], a[108:111]
s_add_u32 s15, s15, s17
s_bfe_u32 s24, s62, 0x80008
v_mfma_f32_16x16x32_bf16 a[112:115], v[64:67], v[92:95], a[112:115]
v_mfma_f32_16x16x32_bf16 a[116:119], v[68:71], v[92:95], a[116:119]
s_lshr_b32 s25, s62, 16
v_mfma_f32_16x16x32_bf16 a[120:123], v[72:75], v[92:95], a[120:123]
v_mfma_f32_16x16x32_bf16 a[124:127], v[76:79], v[92:95], a[124:127]
s_cmp_eq_u32 s54, 1
s_cselect_b32 s73, 2, -1
s_cbranch_scc1 main_kernel_w_c1_task
s_waitcnt lgkmcnt(0)
v_mfma_f32_16x16x32_bf16 a[0:3], v[0:3], v[32:35], a[0:3]
s_waitcnt vmcnt(12)
s_barrier
ds_read_b128 v[80:83], v136 offset:8192
v_mfma_f32_16x16x32_bf16 a[4:7], v[4:7], v[32:35], a[4:7]
ds_read_b64_tr_b16 v[48:49], v128 offset:16384
v_mfma_f32_16x16x32_bf16 a[8:11], v[8:11], v[32:35], a[8:11]
ds_read_b64_tr_b16 v[50:51], v128 offset:24576
v_mfma_f32_16x16x32_bf16 a[12:15], v[12:15], v[32:35], a[12:15]
ds_read_b64_tr_b16 v[52:53], v129 offset:16384
v_mfma_f32_16x16x32_bf16 a[16:19], v[16:19], v[32:35], a[16:19]
ds_read_b64_tr_b16 v[54:55], v129 offset:24576
v_mfma_f32_16x16x32_bf16 a[20:23], v[20:23], v[32:35], a[20:23]
ds_read_b64_tr_b16 v[56:57], v130 offset:16384
v_mfma_f32_16x16x32_bf16 a[24:27], v[24:27], v[32:35], a[24:27]
ds_read_b64_tr_b16 v[58:59], v130 offset:24576
v_mfma_f32_16x16x32_bf16 a[28:31], v[28:31], v[32:35], a[28:31]
ds_read_b64_tr_b16 v[60:61], v131 offset:16384
v_mfma_f32_16x16x32_bf16 a[32:35], v[0:3], v[36:39], a[32:35]
ds_read_b64_tr_b16 v[62:63], v131 offset:24576
v_mfma_f32_16x16x32_bf16 a[36:39], v[4:7], v[36:39], a[36:39]
ds_read_b64_tr_b16 v[64:65], v132 offset:16384
v_mfma_f32_16x16x32_bf16 a[40:43], v[8:11], v[36:39], a[40:43]
ds_read_b64_tr_b16 v[66:67], v132 offset:24576
v_mfma_f32_16x16x32_bf16 a[44:47], v[12:15], v[36:39], a[44:47]
ds_read_b64_tr_b16 v[68:69], v133 offset:16384
v_mfma_f32_16x16x32_bf16 a[48:51], v[16:19], v[36:39], a[48:51]
ds_read_b64_tr_b16 v[70:71], v133 offset:24576
v_mfma_f32_16x16x32_bf16 a[52:55], v[20:23], v[36:39], a[52:55]
ds_read_b64_tr_b16 v[72:73], v134 offset:16384
v_mfma_f32_16x16x32_bf16 a[56:59], v[24:27], v[36:39], a[56:59]
ds_read_b64_tr_b16 v[74:75], v134 offset:24576
v_mfma_f32_16x16x32_bf16 a[60:63], v[28:31], v[36:39], a[60:63]
ds_read_b64_tr_b16 v[76:77], v135 offset:16384
v_mfma_f32_16x16x32_bf16 a[64:67], v[0:3], v[40:43], a[64:67]
ds_read_b64_tr_b16 v[78:79], v135 offset:24576
v_mfma_f32_16x16x32_bf16 a[68:71], v[4:7], v[40:43], a[68:71]
ds_read_b128 v[84:87], v136 offset:9216
v_mfma_f32_16x16x32_bf16 a[72:75], v[8:11], v[40:43], a[72:75]
ds_read_b128 v[88:91], v136 offset:10240
v_mfma_f32_16x16x32_bf16 a[76:79], v[12:15], v[40:43], a[76:79]
ds_read_b128 v[92:95], v136 offset:11264
v_mfma_f32_16x16x32_bf16 a[80:83], v[16:19], v[40:43], a[80:83]
v_mfma_f32_16x16x32_bf16 a[84:87], v[20:23], v[40:43], a[84:87]
v_mfma_f32_16x16x32_bf16 a[88:91], v[24:27], v[40:43], a[88:91]
v_mfma_f32_16x16x32_bf16 a[92:95], v[28:31], v[40:43], a[92:95]
v_mfma_f32_16x16x32_bf16 a[96:99], v[0:3], v[44:47], a[96:99]
v_mfma_f32_16x16x32_bf16 a[100:103], v[4:7], v[44:47], a[100:103]
v_mfma_f32_16x16x32_bf16 a[104:107], v[8:11], v[44:47], a[104:107]
v_mfma_f32_16x16x32_bf16 a[108:111], v[12:15], v[44:47], a[108:111]
v_mfma_f32_16x16x32_bf16 a[112:115], v[16:19], v[44:47], a[112:115]
v_mfma_f32_16x16x32_bf16 a[116:119], v[20:23], v[44:47], a[116:119]
v_mfma_f32_16x16x32_bf16 a[120:123], v[24:27], v[44:47], a[120:123]
v_mfma_f32_16x16x32_bf16 a[124:127], v[28:31], v[44:47], a[124:127]
s_waitcnt lgkmcnt(0)
v_mfma_f32_16x16x32_bf16 a[0:3], v[48:51], v[80:83], a[0:3]
s_waitcnt vmcnt(6)
s_barrier
ds_read_b128 v[32:35], v136 offset:16384
v_mfma_f32_16x16x32_bf16 a[4:7], v[52:55], v[80:83], a[4:7]
ds_read_b64_tr_b16 v[0:1], v128 offset:32768
v_mfma_f32_16x16x32_bf16 a[8:11], v[56:59], v[80:83], a[8:11]
ds_read_b64_tr_b16 v[2:3], v128 offset:40960
v_mfma_f32_16x16x32_bf16 a[12:15], v[60:63], v[80:83], a[12:15]
ds_read_b64_tr_b16 v[4:5], v129 offset:32768
v_mfma_f32_16x16x32_bf16 a[16:19], v[64:67], v[80:83], a[16:19]
ds_read_b64_tr_b16 v[6:7], v129 offset:40960
v_mfma_f32_16x16x32_bf16 a[20:23], v[68:71], v[80:83], a[20:23]
ds_read_b64_tr_b16 v[8:9], v130 offset:32768
v_mfma_f32_16x16x32_bf16 a[24:27], v[72:75], v[80:83], a[24:27]
ds_read_b64_tr_b16 v[10:11], v130 offset:40960
v_mfma_f32_16x16x32_bf16 a[28:31], v[76:79], v[80:83], a[28:31]
ds_read_b64_tr_b16 v[12:13], v131 offset:32768
v_mfma_f32_16x16x32_bf16 a[32:35], v[48:51], v[84:87], a[32:35]
ds_read_b64_tr_b16 v[14:15], v131 offset:40960
v_mfma_f32_16x16x32_bf16 a[36:39], v[52:55], v[84:87], a[36:39]
ds_read_b64_tr_b16 v[16:17], v132 offset:32768
v_mfma_f32_16x16x32_bf16 a[40:43], v[56:59], v[84:87], a[40:43]
ds_read_b64_tr_b16 v[18:19], v132 offset:40960
v_mfma_f32_16x16x32_bf16 a[44:47], v[60:63], v[84:87], a[44:47]
ds_read_b64_tr_b16 v[20:21], v133 offset:32768
v_mfma_f32_16x16x32_bf16 a[48:51], v[64:67], v[84:87], a[48:51]
ds_read_b64_tr_b16 v[22:23], v133 offset:40960
v_mfma_f32_16x16x32_bf16 a[52:55], v[68:71], v[84:87], a[52:55]
ds_read_b64_tr_b16 v[24:25], v134 offset:32768
v_mfma_f32_16x16x32_bf16 a[56:59], v[72:75], v[84:87], a[56:59]
ds_read_b64_tr_b16 v[26:27], v134 offset:40960
v_mfma_f32_16x16x32_bf16 a[60:63], v[76:79], v[84:87], a[60:63]
ds_read_b64_tr_b16 v[28:29], v135 offset:32768
v_mfma_f32_16x16x32_bf16 a[64:67], v[48:51], v[88:91], a[64:67]
ds_read_b64_tr_b16 v[30:31], v135 offset:40960
v_mfma_f32_16x16x32_bf16 a[68:71], v[52:55], v[88:91], a[68:71]
ds_read_b128 v[36:39], v136 offset:17408
v_mfma_f32_16x16x32_bf16 a[72:75], v[56:59], v[88:91], a[72:75]
ds_read_b128 v[40:43], v136 offset:18432
v_mfma_f32_16x16x32_bf16 a[76:79], v[60:63], v[88:91], a[76:79]
ds_read_b128 v[44:47], v136 offset:19456
v_mfma_f32_16x16x32_bf16 a[80:83], v[64:67], v[88:91], a[80:83]
v_mfma_f32_16x16x32_bf16 a[84:87], v[68:71], v[88:91], a[84:87]
v_mfma_f32_16x16x32_bf16 a[88:91], v[72:75], v[88:91], a[88:91]
v_mfma_f32_16x16x32_bf16 a[92:95], v[76:79], v[88:91], a[92:95]
v_mfma_f32_16x16x32_bf16 a[96:99], v[48:51], v[92:95], a[96:99]
v_mfma_f32_16x16x32_bf16 a[100:103], v[52:55], v[92:95], a[100:103]
v_mfma_f32_16x16x32_bf16 a[104:107], v[56:59], v[92:95], a[104:107]
v_mfma_f32_16x16x32_bf16 a[108:111], v[60:63], v[92:95], a[108:111]
v_mfma_f32_16x16x32_bf16 a[112:115], v[64:67], v[92:95], a[112:115]
v_mfma_f32_16x16x32_bf16 a[116:119], v[68:71], v[92:95], a[116:119]
v_mfma_f32_16x16x32_bf16 a[120:123], v[72:75], v[92:95], a[120:123]
v_mfma_f32_16x16x32_bf16 a[124:127], v[76:79], v[92:95], a[124:127]
s_waitcnt lgkmcnt(0)
v_mfma_f32_16x16x32_bf16 a[0:3], v[0:3], v[32:35], a[0:3]
s_waitcnt vmcnt(0)
s_barrier
ds_read_b128 v[80:83], v136 offset:24576
v_mfma_f32_16x16x32_bf16 a[4:7], v[4:7], v[32:35], a[4:7]
ds_read_b64_tr_b16 v[48:49], v128 offset:49152
v_mfma_f32_16x16x32_bf16 a[8:11], v[8:11], v[32:35], a[8:11]
ds_read_b64_tr_b16 v[50:51], v128 offset:57344
v_mfma_f32_16x16x32_bf16 a[12:15], v[12:15], v[32:35], a[12:15]
ds_read_b64_tr_b16 v[52:53], v129 offset:49152
v_mfma_f32_16x16x32_bf16 a[16:19], v[16:19], v[32:35], a[16:19]
ds_read_b64_tr_b16 v[54:55], v129 offset:57344
v_mfma_f32_16x16x32_bf16 a[20:23], v[20:23], v[32:35], a[20:23]
ds_read_b64_tr_b16 v[56:57], v130 offset:49152
v_mfma_f32_16x16x32_bf16 a[24:27], v[24:27], v[32:35], a[24:27]
ds_read_b64_tr_b16 v[58:59], v130 offset:57344
v_mfma_f32_16x16x32_bf16 a[28:31], v[28:31], v[32:35], a[28:31]
ds_read_b64_tr_b16 v[60:61], v131 offset:49152
v_mfma_f32_16x16x32_bf16 a[32:35], v[0:3], v[36:39], a[32:35]
ds_read_b64_tr_b16 v[62:63], v131 offset:57344
v_mfma_f32_16x16x32_bf16 a[36:39], v[4:7], v[36:39], a[36:39]
ds_read_b64_tr_b16 v[64:65], v132 offset:49152
v_mfma_f32_16x16x32_bf16 a[40:43], v[8:11], v[36:39], a[40:43]
ds_read_b64_tr_b16 v[66:67], v132 offset:57344
v_mfma_f32_16x16x32_bf16 a[44:47], v[12:15], v[36:39], a[44:47]
ds_read_b64_tr_b16 v[68:69], v133 offset:49152
v_mfma_f32_16x16x32_bf16 a[48:51], v[16:19], v[36:39], a[48:51]
ds_read_b64_tr_b16 v[70:71], v133 offset:57344
v_mfma_f32_16x16x32_bf16 a[52:55], v[20:23], v[36:39], a[52:55]
ds_read_b64_tr_b16 v[72:73], v134 offset:49152
v_mfma_f32_16x16x32_bf16 a[56:59], v[24:27], v[36:39], a[56:59]
ds_read_b64_tr_b16 v[74:75], v134 offset:57344
v_mfma_f32_16x16x32_bf16 a[60:63], v[28:31], v[36:39], a[60:63]
ds_read_b64_tr_b16 v[76:77], v135 offset:49152
v_mfma_f32_16x16x32_bf16 a[64:67], v[0:3], v[40:43], a[64:67]
ds_read_b64_tr_b16 v[78:79], v135 offset:57344
v_mfma_f32_16x16x32_bf16 a[68:71], v[4:7], v[40:43], a[68:71]
ds_read_b128 v[84:87], v136 offset:25600
v_mfma_f32_16x16x32_bf16 a[72:75], v[8:11], v[40:43], a[72:75]
ds_read_b128 v[88:91], v136 offset:26624
v_mfma_f32_16x16x32_bf16 a[76:79], v[12:15], v[40:43], a[76:79]
ds_read_b128 v[92:95], v136 offset:27648
v_mfma_f32_16x16x32_bf16 a[80:83], v[16:19], v[40:43], a[80:83]
v_mfma_f32_16x16x32_bf16 a[84:87], v[20:23], v[40:43], a[84:87]
v_mfma_f32_16x16x32_bf16 a[88:91], v[24:27], v[40:43], a[88:91]
v_mfma_f32_16x16x32_bf16 a[92:95], v[28:31], v[40:43], a[92:95]
v_mfma_f32_16x16x32_bf16 a[96:99], v[0:3], v[44:47], a[96:99]
v_mfma_f32_16x16x32_bf16 a[100:103], v[4:7], v[44:47], a[100:103]
v_mfma_f32_16x16x32_bf16 a[104:107], v[8:11], v[44:47], a[104:107]
v_mfma_f32_16x16x32_bf16 a[108:111], v[12:15], v[44:47], a[108:111]
v_mfma_f32_16x16x32_bf16 a[112:115], v[16:19], v[44:47], a[112:115]
v_mfma_f32_16x16x32_bf16 a[116:119], v[20:23], v[44:47], a[116:119]
v_mfma_f32_16x16x32_bf16 a[120:123], v[24:27], v[44:47], a[120:123]
v_mfma_f32_16x16x32_bf16 a[124:127], v[28:31], v[44:47], a[124:127]
s_waitcnt lgkmcnt(0)
v_mfma_f32_16x16x32_bf16 a[0:3], v[48:51], v[80:83], a[0:3]
s_barrier
v_mfma_f32_16x16x32_bf16 a[4:7], v[52:55], v[80:83], a[4:7]
v_mfma_f32_16x16x32_bf16 a[8:11], v[56:59], v[80:83], a[8:11]
v_mfma_f32_16x16x32_bf16 a[12:15], v[60:63], v[80:83], a[12:15]
v_mfma_f32_16x16x32_bf16 a[16:19], v[64:67], v[80:83], a[16:19]
v_mfma_f32_16x16x32_bf16 a[20:23], v[68:71], v[80:83], a[20:23]
v_mfma_f32_16x16x32_bf16 a[24:27], v[72:75], v[80:83], a[24:27]
v_mfma_f32_16x16x32_bf16 a[28:31], v[76:79], v[80:83], a[28:31]
v_mfma_f32_16x16x32_bf16 a[32:35], v[48:51], v[84:87], a[32:35]
v_mfma_f32_16x16x32_bf16 a[36:39], v[52:55], v[84:87], a[36:39]
v_mfma_f32_16x16x32_bf16 a[40:43], v[56:59], v[84:87], a[40:43]
v_mfma_f32_16x16x32_bf16 a[44:47], v[60:63], v[84:87], a[44:47]
v_mfma_f32_16x16x32_bf16 a[48:51], v[64:67], v[84:87], a[48:51]
v_mfma_f32_16x16x32_bf16 a[52:55], v[68:71], v[84:87], a[52:55]
v_mfma_f32_16x16x32_bf16 a[56:59], v[72:75], v[84:87], a[56:59]
v_mfma_f32_16x16x32_bf16 a[60:63], v[76:79], v[84:87], a[60:63]
v_mfma_f32_16x16x32_bf16 a[64:67], v[48:51], v[88:91], a[64:67]
v_mfma_f32_16x16x32_bf16 a[68:71], v[52:55], v[88:91], a[68:71]
v_mfma_f32_16x16x32_bf16 a[72:75], v[56:59], v[88:91], a[72:75]
v_mfma_f32_16x16x32_bf16 a[76:79], v[60:63], v[88:91], a[76:79]
v_mfma_f32_16x16x32_bf16 a[80:83], v[64:67], v[88:91], a[80:83]
v_mfma_f32_16x16x32_bf16 a[84:87], v[68:71], v[88:91], a[84:87]
v_mfma_f32_16x16x32_bf16 a[88:91], v[72:75], v[88:91], a[88:91]
v_mfma_f32_16x16x32_bf16 a[92:95], v[76:79], v[88:91], a[92:95]
v_mfma_f32_16x16x32_bf16 a[96:99], v[48:51], v[92:95], a[96:99]
v_mfma_f32_16x16x32_bf16 a[100:103], v[52:55], v[92:95], a[100:103]
v_mfma_f32_16x16x32_bf16 a[104:107], v[56:59], v[92:95], a[104:107]
v_mfma_f32_16x16x32_bf16 a[108:111], v[60:63], v[92:95], a[108:111]
v_mfma_f32_16x16x32_bf16 a[112:115], v[64:67], v[92:95], a[112:115]
v_mfma_f32_16x16x32_bf16 a[116:119], v[68:71], v[92:95], a[116:119]
v_mfma_f32_16x16x32_bf16 a[120:123], v[72:75], v[92:95], a[120:123]
v_mfma_f32_16x16x32_bf16 a[124:127], v[76:79], v[92:95], a[124:127]
s_cmp_lg_u32 s62, -4
s_cbranch_scc1 main_kernel_w_gemm
s_branch main_kernel_w_slow
main_kernel_w_c1_n_ev:
s_mov_b32 s55, 1
s_cmp_eq_u32 s56, 0
s_cbranch_scc1 main_kernel_w_c1_n_et
s_bfm_b64 exec, s0, 0
buffer_store_dword v244, v248, s[4:7], s59 offen sc1
s_mov_b64 exec, -1
s_mov_b32 s56, 0
main_kernel_w_c1_n_et:
s_cmp_lg_u32 s18, 1
s_cbranch_scc1 main_kernel_w_c1_n_loop
s_lshl_b32 s32, s27, 8
s_add_u32 s32, s32, 0x841e000
s_mov_b64 exec, 1
v_mov_b32 v249, 1
buffer_atomic_add v249, off, s[4:7], s32 sc0 sc1
s_mov_b64 exec, -1
s_branch main_kernel_w_c1_n_loop
main_kernel_w_c1_gov:
s_mov_b32 s58, 3
s_mov_b32 s72, s18
s_cmp_lg_u32 s73, -1
s_cbranch_scc1 main_kernel_w_c1_str
s_waitcnt lgkmcnt(0)
v_lshrrev_b32 v0, 4, v250
v_bfe_u32 v1, v250, 2, 2
v_lshl_add_u32 v4, v0, 2, v1
v_and_b32 v5, 7, v4
v_mul_u32_u24 v4, 512, v4
v_and_b32 v6, 3, v250
v_lshl_add_u32 v4, v6, 3, v4
s_mul_i32 s32, s37, 8
v_xor_b32 v5, s32, v5
v_lshl_add_u32 v128, v5, 5, v4
v_xor_b32 v129, 32, v128
v_xor_b32 v130, 64, v128
v_xor_b32 v131, 96, v128
v_xor_b32 v132, 128, v128
v_xor_b32 v133, 160, v128
v_xor_b32 v134, 192, v128
v_xor_b32 v135, 224, v128
s_mul_i32 s32, s38, 4096
s_add_u32 s32, s32, 65536
v_add_u32 v136, s32, v251
v_lshrrev_b32 v2, 5, v250
v_and_b32 v3, 31, v250
s_mul_i32 s32, s14, 8
v_add_u32 v147, s32, v2
v_and_b32 v6, 7, v147
v_lshlrev_b32 v6, 1, v6
v_xor_b32 v6, v6, v3
v_lshlrev_b32 v151, 4, v6
v_add_u32 v148, 2, v147
v_and_b32 v6, 7, v148
v_lshlrev_b32 v6, 1, v6
v_xor_b32 v6, v6, v3
v_lshlrev_b32 v152, 4, v6
v_subrev_u32 v152, 1024, v152
v_add_u32 v149, 4, v147
v_and_b32 v6, 7, v149
v_lshlrev_b32 v6, 1, v6
v_xor_b32 v6, v6, v3
v_lshlrev_b32 v153, 4, v6
v_subrev_u32 v153, 2048, v153
v_add_u32 v150, 6, v147
v_and_b32 v6, 7, v150
v_lshlrev_b32 v6, 1, v6
v_xor_b32 v6, v6, v3
v_lshlrev_b32 v154, 4, v6
v_subrev_u32 v154, 3072, v154
s_mul_i32 s19, s14, 4096
s_mul_i32 s20, s14, 2048
s_add_u32 s20, s20, 65536
s_mul_i32 s32, s14, 2
s_mul_i32 s32, s32, s31
v_mad_u32_u24 v137, v147, s30, v151
v_mad_u32_u24 v138, v148, s30, v152
v_mad_u32_u24 v139, v149, s30, v153
v_mad_u32_u24 v140, v150, s30, v154
v_add_u32 v141, s32, v251
s_add_u32 s32, s32, s31
s_sub_u32 s32, s32, 1024
v_add_u32 v142, s32, v251
s_mul_i32 s17, s30, 32
s_mov_b32 s15, 0
s_waitcnt vmcnt(0)
s_add_u32 m0, s20, 0
s_nop 0
buffer_load_dwordx4 v141, s[4:7], s16 offen offset:0 sc1 lds
buffer_load_dwordx4 v142, s[4:7], s16 offen offset:1024 sc1 lds
s_add_u32 s16, s16, 1024
s_add_u32 m0, s19, 0
s_nop 0
buffer_load_dwordx4 v137, s[8:11], s15 offen offset:0 lds
buffer_load_dwordx4 v138, s[8:11], s15 offen offset:1024 lds
buffer_load_dwordx4 v139, s[8:11], s15 offen offset:2048 lds
buffer_load_dwordx4 v140, s[8:11], s15 offen offset:3072 lds
s_add_u32 s15, s15, s17
s_add_u32 m0, s20, 8192
s_nop 0
buffer_load_dwordx4 v141, s[4:7], s16 offen offset:0 sc1 lds
buffer_load_dwordx4 v142, s[4:7], s16 offen offset:1024 sc1 lds
s_add_u32 s16, s16, 1024
s_add_u32 m0, s19, 16384
s_nop 0
buffer_load_dwordx4 v137, s[8:11], s15 offen offset:0 lds
buffer_load_dwordx4 v138, s[8:11], s15 offen offset:1024 lds
buffer_load_dwordx4 v139, s[8:11], s15 offen offset:2048 lds
buffer_load_dwordx4 v140, s[8:11], s15 offen offset:3072 lds
s_add_u32 s15, s15, s17
s_add_u32 m0, s20, 16384
s_nop 0
buffer_load_dwordx4 v141, s[4:7], s16 offen offset:0 sc1 lds
buffer_load_dwordx4 v142, s[4:7], s16 offen offset:1024 sc1 lds
s_add_u32 s16, s16, 1024
s_add_u32 m0, s19, 32768
s_nop 0
buffer_load_dwordx4 v137, s[8:11], s15 offen offset:0 lds
buffer_load_dwordx4 v138, s[8:11], s15 offen offset:1024 lds
buffer_load_dwordx4 v139, s[8:11], s15 offen offset:2048 lds
buffer_load_dwordx4 v140, s[8:11], s15 offen offset:3072 lds
s_add_u32 s15, s15, s17
s_add_u32 m0, s20, 24576
s_nop 0
buffer_load_dwordx4 v141, s[4:7], s16 offen offset:0 sc1 lds
buffer_load_dwordx4 v142, s[4:7], s16 offen offset:1024 sc1 lds
s_add_u32 s16, s16, 1024
s_add_u32 m0, s19, 49152
s_nop 0
buffer_load_dwordx4 v137, s[8:11], s15 offen offset:0 lds
buffer_load_dwordx4 v138, s[8:11], s15 offen offset:1024 lds
buffer_load_dwordx4 v139, s[8:11], s15 offen offset:2048 lds
buffer_load_dwordx4 v140, s[8:11], s15 offen offset:3072 lds
s_add_u32 s15, s15, s17
s_cmp_lg_u32 s56, 0
s_cbranch_scc1 main_kernel_w_epi
main_kernel_w_c1_v_ent:
v_mfma_f32_32x32x16_bf16 a[0:15], v[224:227], v[224:227], 0
s_waitcnt vmcnt(18)
s_barrier
ds_read_b128 v[32:35], v136 offset:0
ds_read_b64_tr_b16 v[0:1], v128 offset:0
ds_read_b64_tr_b16 v[2:3], v128 offset:8192
v_mfma_f32_32x32x16_bf16 a[16:31], v[224:227], v[224:227], 0
ds_read_b64_tr_b16 v[4:5], v129 offset:0
ds_read_b64_tr_b16 v[6:7], v129 offset:8192
ds_read_b64_tr_b16 v[8:9], v130 offset:0
v_mfma_f32_32x32x16_bf16 a[32:47], v[224:227], v[224:227], 0
ds_read_b64_tr_b16 v[10:11], v130 offset:8192
ds_read_b64_tr_b16 v[12:13], v131 offset:0
ds_read_b64_tr_b16 v[14:15], v131 offset:8192
v_mfma_f32_32x32x16_bf16 a[48:63], v[224:227], v[224:227], 0
ds_read_b64_tr_b16 v[16:17], v132 offset:0
ds_read_b64_tr_b16 v[18:19], v132 offset:8192
ds_read_b64_tr_b16 v[20:21], v133 offset:0
v_mfma_f32_32x32x16_bf16 a[64:79], v[224:227], v[224:227], 0
ds_read_b64_tr_b16 v[22:23], v133 offset:8192
ds_read_b64_tr_b16 v[24:25], v134 offset:0
ds_read_b64_tr_b16 v[26:27], v134 offset:8192
v_mfma_f32_32x32x16_bf16 a[80:95], v[224:227], v[224:227], 0
ds_read_b64_tr_b16 v[28:29], v135 offset:0
ds_read_b64_tr_b16 v[30:31], v135 offset:8192
ds_read_b128 v[36:39], v136 offset:1024
v_mfma_f32_32x32x16_bf16 a[96:111], v[224:227], v[224:227], 0
ds_read_b128 v[40:43], v136 offset:2048
ds_read_b128 v[44:47], v136 offset:3072
v_mfma_f32_32x32x16_bf16 a[112:127], v[224:227], v[224:227], 0
s_sub_u32 s18, s72, 1
s_sub_u32 s55, s72, 2
s_orn2_b32 s55, s55, s100
s_mov_b32 s73, -1
s_nop 0
main_kernel_w_c1_v_loop:
main_kernel_w_c1_v_mid:
s_waitcnt lgkmcnt(0)
v_mfma_f32_16x16x32_bf16 a[0:3], v[32:35], v[0:3], a[0:3]
s_waitcnt vmcnt(12)
s_barrier
ds_read_b128 v[80:83], v136 offset:8192
s_add_u32 m0, s20, 0
s_nop 0
v_mfma_f32_16x16x32_bf16 a[4:7], v[32:35], v[4:7], a[4:7]
ds_read_b64_tr_b16 v[48:49], v128 offset:16384
v_mfma_f32_16x16x32_bf16 a[8:11], v[32:35], v[8:11], a[8:11]
ds_read_b64_tr_b16 v[50:51], v128 offset:24576
v_mfma_f32_16x16x32_bf16 a[12:15], v[32:35], v[12:15], a[12:15]
ds_read_b64_tr_b16 v[52:53], v129 offset:16384
buffer_load_dwordx4 v141, s[4:7], s16 offen offset:0 sc1 lds
v_mfma_f32_16x16x32_bf16 a[16:19], v[32:35], v[16:19], a[16:19]
ds_read_b64_tr_b16 v[54:55], v129 offset:24576
v_mfma_f32_16x16x32_bf16 a[20:23], v[32:35], v[20:23], a[20:23]
ds_read_b64_tr_b16 v[56:57], v130 offset:16384
v_mfma_f32_16x16x32_bf16 a[24:27], v[32:35], v[24:27], a[24:27]
ds_read_b64_tr_b16 v[58:59], v130 offset:24576
buffer_load_dwordx4 v142, s[4:7], s16 offen offset:1024 sc1 lds
v_mfma_f32_16x16x32_bf16 a[28:31], v[32:35], v[28:31], a[28:31]
ds_read_b64_tr_b16 v[60:61], v131 offset:16384
v_mfma_f32_16x16x32_bf16 a[32:35], v[36:39], v[0:3], a[32:35]
ds_read_b64_tr_b16 v[62:63], v131 offset:24576
v_mfma_f32_16x16x32_bf16 a[36:39], v[36:39], v[4:7], a[36:39]
ds_read_b64_tr_b16 v[64:65], v132 offset:16384
s_add_u32 s16, s16, 1024
v_mfma_f32_16x16x32_bf16 a[40:43], v[36:39], v[8:11], a[40:43]
ds_read_b64_tr_b16 v[66:67], v132 offset:24576
v_mfma_f32_16x16x32_bf16 a[44:47], v[36:39], v[12:15], a[44:47]
ds_read_b64_tr_b16 v[68:69], v133 offset:16384
v_mfma_f32_16x16x32_bf16 a[48:51], v[36:39], v[16:19], a[48:51]
ds_read_b64_tr_b16 v[70:71], v133 offset:24576
s_add_u32 m0, s19, 0
s_nop 0
v_mfma_f32_16x16x32_bf16 a[52:55], v[36:39], v[20:23], a[52:55]
ds_read_b64_tr_b16 v[72:73], v134 offset:16384
v_mfma_f32_16x16x32_bf16 a[56:59], v[36:39], v[24:27], a[56:59]
ds_read_b64_tr_b16 v[74:75], v134 offset:24576
v_mfma_f32_16x16x32_bf16 a[60:63], v[36:39], v[28:31], a[60:63]
ds_read_b64_tr_b16 v[76:77], v135 offset:16384
buffer_load_dwordx4 v137, s[8:11], s15 offen offset:0 lds
v_mfma_f32_16x16x32_bf16 a[64:67], v[40:43], v[0:3], a[64:67]
ds_read_b64_tr_b16 v[78:79], v135 offset:24576
v_mfma_f32_16x16x32_bf16 a[68:71], v[40:43], v[4:7], a[68:71]
ds_read_b128 v[84:87], v136 offset:9216
v_mfma_f32_16x16x32_bf16 a[72:75], v[40:43], v[8:11], a[72:75]
ds_read_b128 v[88:91], v136 offset:10240
buffer_load_dwordx4 v138, s[8:11], s15 offen offset:1024 lds
v_mfma_f32_16x16x32_bf16 a[76:79], v[40:43], v[12:15], a[76:79]
ds_read_b128 v[92:95], v136 offset:11264
v_mfma_f32_16x16x32_bf16 a[80:83], v[40:43], v[16:19], a[80:83]
v_mfma_f32_16x16x32_bf16 a[84:87], v[40:43], v[20:23], a[84:87]
buffer_load_dwordx4 v139, s[8:11], s15 offen offset:2048 lds
v_mfma_f32_16x16x32_bf16 a[88:91], v[40:43], v[24:27], a[88:91]
v_mfma_f32_16x16x32_bf16 a[92:95], v[40:43], v[28:31], a[92:95]
v_mfma_f32_16x16x32_bf16 a[96:99], v[44:47], v[0:3], a[96:99]
buffer_load_dwordx4 v140, s[8:11], s15 offen offset:3072 lds
v_mfma_f32_16x16x32_bf16 a[100:103], v[44:47], v[4:7], a[100:103]
v_mfma_f32_16x16x32_bf16 a[104:107], v[44:47], v[8:11], a[104:107]
v_mfma_f32_16x16x32_bf16 a[108:111], v[44:47], v[12:15], a[108:111]
s_add_u32 s15, s15, s17
v_mfma_f32_16x16x32_bf16 a[112:115], v[44:47], v[16:19], a[112:115]
v_mfma_f32_16x16x32_bf16 a[116:119], v[44:47], v[20:23], a[116:119]
v_mfma_f32_16x16x32_bf16 a[120:123], v[44:47], v[24:27], a[120:123]
v_mfma_f32_16x16x32_bf16 a[124:127], v[44:47], v[28:31], a[124:127]
s_waitcnt lgkmcnt(0)
v_mfma_f32_16x16x32_bf16 a[0:3], v[80:83], v[48:51], a[0:3]
s_waitcnt vmcnt(12)
s_barrier
ds_read_b128 v[32:35], v136 offset:16384
s_add_u32 m0, s20, 8192
s_nop 0
v_mfma_f32_16x16x32_bf16 a[4:7], v[80:83], v[52:55], a[4:7]
ds_read_b64_tr_b16 v[0:1], v128 offset:32768
v_mfma_f32_16x16x32_bf16 a[8:11], v[80:83], v[56:59], a[8:11]
ds_read_b64_tr_b16 v[2:3], v128 offset:40960
v_mfma_f32_16x16x32_bf16 a[12:15], v[80:83], v[60:63], a[12:15]
ds_read_b64_tr_b16 v[4:5], v129 offset:32768
buffer_load_dwordx4 v141, s[4:7], s16 offen offset:0 sc1 lds
v_mfma_f32_16x16x32_bf16 a[16:19], v[80:83], v[64:67], a[16:19]
ds_read_b64_tr_b16 v[6:7], v129 offset:40960
v_mfma_f32_16x16x32_bf16 a[20:23], v[80:83], v[68:71], a[20:23]
ds_read_b64_tr_b16 v[8:9], v130 offset:32768
v_mfma_f32_16x16x32_bf16 a[24:27], v[80:83], v[72:75], a[24:27]
ds_read_b64_tr_b16 v[10:11], v130 offset:40960
buffer_load_dwordx4 v142, s[4:7], s16 offen offset:1024 sc1 lds
v_mfma_f32_16x16x32_bf16 a[28:31], v[80:83], v[76:79], a[28:31]
ds_read_b64_tr_b16 v[12:13], v131 offset:32768
v_mfma_f32_16x16x32_bf16 a[32:35], v[84:87], v[48:51], a[32:35]
ds_read_b64_tr_b16 v[14:15], v131 offset:40960
v_mfma_f32_16x16x32_bf16 a[36:39], v[84:87], v[52:55], a[36:39]
ds_read_b64_tr_b16 v[16:17], v132 offset:32768
s_add_u32 s16, s16, 1024
v_mfma_f32_16x16x32_bf16 a[40:43], v[84:87], v[56:59], a[40:43]
ds_read_b64_tr_b16 v[18:19], v132 offset:40960
v_mfma_f32_16x16x32_bf16 a[44:47], v[84:87], v[60:63], a[44:47]
ds_read_b64_tr_b16 v[20:21], v133 offset:32768
v_mfma_f32_16x16x32_bf16 a[48:51], v[84:87], v[64:67], a[48:51]
ds_read_b64_tr_b16 v[22:23], v133 offset:40960
s_add_u32 m0, s19, 16384
s_nop 0
v_mfma_f32_16x16x32_bf16 a[52:55], v[84:87], v[68:71], a[52:55]
ds_read_b64_tr_b16 v[24:25], v134 offset:32768
v_mfma_f32_16x16x32_bf16 a[56:59], v[84:87], v[72:75], a[56:59]
ds_read_b64_tr_b16 v[26:27], v134 offset:40960
v_mfma_f32_16x16x32_bf16 a[60:63], v[84:87], v[76:79], a[60:63]
ds_read_b64_tr_b16 v[28:29], v135 offset:32768
buffer_load_dwordx4 v137, s[8:11], s15 offen offset:0 lds
v_mfma_f32_16x16x32_bf16 a[64:67], v[88:91], v[48:51], a[64:67]
ds_read_b64_tr_b16 v[30:31], v135 offset:40960
v_mfma_f32_16x16x32_bf16 a[68:71], v[88:91], v[52:55], a[68:71]
ds_read_b128 v[36:39], v136 offset:17408
v_mfma_f32_16x16x32_bf16 a[72:75], v[88:91], v[56:59], a[72:75]
ds_read_b128 v[40:43], v136 offset:18432
buffer_load_dwordx4 v138, s[8:11], s15 offen offset:1024 lds
v_mfma_f32_16x16x32_bf16 a[76:79], v[88:91], v[60:63], a[76:79]
ds_read_b128 v[44:47], v136 offset:19456
v_mfma_f32_16x16x32_bf16 a[80:83], v[88:91], v[64:67], a[80:83]
v_mfma_f32_16x16x32_bf16 a[84:87], v[88:91], v[68:71], a[84:87]
buffer_load_dwordx4 v139, s[8:11], s15 offen offset:2048 lds
v_mfma_f32_16x16x32_bf16 a[88:91], v[88:91], v[72:75], a[88:91]
v_mfma_f32_16x16x32_bf16 a[92:95], v[88:91], v[76:79], a[92:95]
v_mfma_f32_16x16x32_bf16 a[96:99], v[92:95], v[48:51], a[96:99]
buffer_load_dwordx4 v140, s[8:11], s15 offen offset:3072 lds
v_mfma_f32_16x16x32_bf16 a[100:103], v[92:95], v[52:55], a[100:103]
v_mfma_f32_16x16x32_bf16 a[104:107], v[92:95], v[56:59], a[104:107]
v_mfma_f32_16x16x32_bf16 a[108:111], v[92:95], v[60:63], a[108:111]
s_add_u32 s15, s15, s17
v_mfma_f32_16x16x32_bf16 a[112:115], v[92:95], v[64:67], a[112:115]
v_mfma_f32_16x16x32_bf16 a[116:119], v[92:95], v[68:71], a[116:119]
v_mfma_f32_16x16x32_bf16 a[120:123], v[92:95], v[72:75], a[120:123]
v_mfma_f32_16x16x32_bf16 a[124:127], v[92:95], v[76:79], a[124:127]
s_waitcnt lgkmcnt(0)
v_mfma_f32_16x16x32_bf16 a[0:3], v[32:35], v[0:3], a[0:3]
s_waitcnt vmcnt(12)
s_barrier
ds_read_b128 v[80:83], v136 offset:24576
s_add_u32 m0, s20, 16384
s_nop 0
v_mfma_f32_16x16x32_bf16 a[4:7], v[32:35], v[4:7], a[4:7]
ds_read_b64_tr_b16 v[48:49], v128 offset:49152
v_mfma_f32_16x16x32_bf16 a[8:11], v[32:35], v[8:11], a[8:11]
ds_read_b64_tr_b16 v[50:51], v128 offset:57344
v_mfma_f32_16x16x32_bf16 a[12:15], v[32:35], v[12:15], a[12:15]
ds_read_b64_tr_b16 v[52:53], v129 offset:49152
buffer_load_dwordx4 v141, s[4:7], s16 offen offset:0 sc1 lds
v_mfma_f32_16x16x32_bf16 a[16:19], v[32:35], v[16:19], a[16:19]
ds_read_b64_tr_b16 v[54:55], v129 offset:57344
v_mfma_f32_16x16x32_bf16 a[20:23], v[32:35], v[20:23], a[20:23]
ds_read_b64_tr_b16 v[56:57], v130 offset:49152
v_mfma_f32_16x16x32_bf16 a[24:27], v[32:35], v[24:27], a[24:27]
ds_read_b64_tr_b16 v[58:59], v130 offset:57344
buffer_load_dwordx4 v142, s[4:7], s16 offen offset:1024 sc1 lds
v_mfma_f32_16x16x32_bf16 a[28:31], v[32:35], v[28:31], a[28:31]
ds_read_b64_tr_b16 v[60:61], v131 offset:49152
v_mfma_f32_16x16x32_bf16 a[32:35], v[36:39], v[0:3], a[32:35]
ds_read_b64_tr_b16 v[62:63], v131 offset:57344
v_mfma_f32_16x16x32_bf16 a[36:39], v[36:39], v[4:7], a[36:39]
ds_read_b64_tr_b16 v[64:65], v132 offset:49152
s_add_u32 s16, s16, 1024
v_mfma_f32_16x16x32_bf16 a[40:43], v[36:39], v[8:11], a[40:43]
ds_read_b64_tr_b16 v[66:67], v132 offset:57344
v_mfma_f32_16x16x32_bf16 a[44:47], v[36:39], v[12:15], a[44:47]
ds_read_b64_tr_b16 v[68:69], v133 offset:49152
v_mfma_f32_16x16x32_bf16 a[48:51], v[36:39], v[16:19], a[48:51]
ds_read_b64_tr_b16 v[70:71], v133 offset:57344
s_add_u32 m0, s19, 32768
s_nop 0
v_mfma_f32_16x16x32_bf16 a[52:55], v[36:39], v[20:23], a[52:55]
ds_read_b64_tr_b16 v[72:73], v134 offset:49152
v_mfma_f32_16x16x32_bf16 a[56:59], v[36:39], v[24:27], a[56:59]
ds_read_b64_tr_b16 v[74:75], v134 offset:57344
v_mfma_f32_16x16x32_bf16 a[60:63], v[36:39], v[28:31], a[60:63]
ds_read_b64_tr_b16 v[76:77], v135 offset:49152
buffer_load_dwordx4 v137, s[8:11], s15 offen offset:0 lds
v_mfma_f32_16x16x32_bf16 a[64:67], v[40:43], v[0:3], a[64:67]
ds_read_b64_tr_b16 v[78:79], v135 offset:57344
v_mfma_f32_16x16x32_bf16 a[68:71], v[40:43], v[4:7], a[68:71]
ds_read_b128 v[84:87], v136 offset:25600
v_mfma_f32_16x16x32_bf16 a[72:75], v[40:43], v[8:11], a[72:75]
ds_read_b128 v[88:91], v136 offset:26624
buffer_load_dwordx4 v138, s[8:11], s15 offen offset:1024 lds
v_mfma_f32_16x16x32_bf16 a[76:79], v[40:43], v[12:15], a[76:79]
ds_read_b128 v[92:95], v136 offset:27648
v_mfma_f32_16x16x32_bf16 a[80:83], v[40:43], v[16:19], a[80:83]
v_mfma_f32_16x16x32_bf16 a[84:87], v[40:43], v[20:23], a[84:87]
buffer_load_dwordx4 v139, s[8:11], s15 offen offset:2048 lds
v_mfma_f32_16x16x32_bf16 a[88:91], v[40:43], v[24:27], a[88:91]
v_mfma_f32_16x16x32_bf16 a[92:95], v[40:43], v[28:31], a[92:95]
v_mfma_f32_16x16x32_bf16 a[96:99], v[44:47], v[0:3], a[96:99]
buffer_load_dwordx4 v140, s[8:11], s15 offen offset:3072 lds
v_mfma_f32_16x16x32_bf16 a[100:103], v[44:47], v[4:7], a[100:103]
v_mfma_f32_16x16x32_bf16 a[104:107], v[44:47], v[8:11], a[104:107]
v_mfma_f32_16x16x32_bf16 a[108:111], v[44:47], v[12:15], a[108:111]
s_add_u32 s15, s15, s17
v_mfma_f32_16x16x32_bf16 a[112:115], v[44:47], v[16:19], a[112:115]
v_mfma_f32_16x16x32_bf16 a[116:119], v[44:47], v[20:23], a[116:119]
v_mfma_f32_16x16x32_bf16 a[120:123], v[44:47], v[24:27], a[120:123]
v_mfma_f32_16x16x32_bf16 a[124:127], v[44:47], v[28:31], a[124:127]
s_waitcnt lgkmcnt(0)
v_mfma_f32_16x16x32_bf16 a[0:3], v[80:83], v[48:51], a[0:3]
s_waitcnt vmcnt(12)
s_barrier
ds_read_b128 v[32:35], v136 offset:0
s_add_u32 m0, s20, 24576
s_nop 0
v_mfma_f32_16x16x32_bf16 a[4:7], v[80:83], v[52:55], a[4:7]
ds_read_b64_tr_b16 v[0:1], v128 offset:0
v_mfma_f32_16x16x32_bf16 a[8:11], v[80:83], v[56:59], a[8:11]
ds_read_b64_tr_b16 v[2:3], v128 offset:8192
v_mfma_f32_16x16x32_bf16 a[12:15], v[80:83], v[60:63], a[12:15]
ds_read_b64_tr_b16 v[4:5], v129 offset:0
buffer_load_dwordx4 v141, s[4:7], s16 offen offset:0 sc1 lds
v_mfma_f32_16x16x32_bf16 a[16:19], v[80:83], v[64:67], a[16:19]
ds_read_b64_tr_b16 v[6:7], v129 offset:8192
v_mfma_f32_16x16x32_bf16 a[20:23], v[80:83], v[68:71], a[20:23]
ds_read_b64_tr_b16 v[8:9], v130 offset:0
v_mfma_f32_16x16x32_bf16 a[24:27], v[80:83], v[72:75], a[24:27]
ds_read_b64_tr_b16 v[10:11], v130 offset:8192
buffer_load_dwordx4 v142, s[4:7], s16 offen offset:1024 sc1 lds
v_mfma_f32_16x16x32_bf16 a[28:31], v[80:83], v[76:79], a[28:31]
ds_read_b64_tr_b16 v[12:13], v131 offset:0
v_mfma_f32_16x16x32_bf16 a[32:35], v[84:87], v[48:51], a[32:35]
ds_read_b64_tr_b16 v[14:15], v131 offset:8192
v_mfma_f32_16x16x32_bf16 a[36:39], v[84:87], v[52:55], a[36:39]
ds_read_b64_tr_b16 v[16:17], v132 offset:0
s_add_u32 s16, s16, 1024
v_mfma_f32_16x16x32_bf16 a[40:43], v[84:87], v[56:59], a[40:43]
ds_read_b64_tr_b16 v[18:19], v132 offset:8192
v_mfma_f32_16x16x32_bf16 a[44:47], v[84:87], v[60:63], a[44:47]
ds_read_b64_tr_b16 v[20:21], v133 offset:0
v_mfma_f32_16x16x32_bf16 a[48:51], v[84:87], v[64:67], a[48:51]
ds_read_b64_tr_b16 v[22:23], v133 offset:8192
s_add_u32 m0, s19, 49152
s_nop 0
v_mfma_f32_16x16x32_bf16 a[52:55], v[84:87], v[68:71], a[52:55]
ds_read_b64_tr_b16 v[24:25], v134 offset:0
v_mfma_f32_16x16x32_bf16 a[56:59], v[84:87], v[72:75], a[56:59]
ds_read_b64_tr_b16 v[26:27], v134 offset:8192
v_mfma_f32_16x16x32_bf16 a[60:63], v[84:87], v[76:79], a[60:63]
ds_read_b64_tr_b16 v[28:29], v135 offset:0
buffer_load_dwordx4 v137, s[8:11], s15 offen offset:0 lds
v_mfma_f32_16x16x32_bf16 a[64:67], v[88:91], v[48:51], a[64:67]
ds_read_b64_tr_b16 v[30:31], v135 offset:8192
v_mfma_f32_16x16x32_bf16 a[68:71], v[88:91], v[52:55], a[68:71]
ds_read_b128 v[36:39], v136 offset:1024
v_mfma_f32_16x16x32_bf16 a[72:75], v[88:91], v[56:59], a[72:75]
ds_read_b128 v[40:43], v136 offset:2048
buffer_load_dwordx4 v138, s[8:11], s15 offen offset:1024 lds
v_mfma_f32_16x16x32_bf16 a[76:79], v[88:91], v[60:63], a[76:79]
ds_read_b128 v[44:47], v136 offset:3072
v_mfma_f32_16x16x32_bf16 a[80:83], v[88:91], v[64:67], a[80:83]
v_mfma_f32_16x16x32_bf16 a[84:87], v[88:91], v[68:71], a[84:87]
buffer_load_dwordx4 v139, s[8:11], s15 offen offset:2048 lds
v_mfma_f32_16x16x32_bf16 a[88:91], v[88:91], v[72:75], a[88:91]
v_mfma_f32_16x16x32_bf16 a[92:95], v[88:91], v[76:79], a[92:95]
v_mfma_f32_16x16x32_bf16 a[96:99], v[92:95], v[48:51], a[96:99]
buffer_load_dwordx4 v140, s[8:11], s15 offen offset:3072 lds
v_mfma_f32_16x16x32_bf16 a[100:103], v[92:95], v[52:55], a[100:103]
v_mfma_f32_16x16x32_bf16 a[104:107], v[92:95], v[56:59], a[104:107]
v_mfma_f32_16x16x32_bf16 a[108:111], v[92:95], v[60:63], a[108:111]
s_add_u32 s15, s15, s17
v_mfma_f32_16x16x32_bf16 a[112:115], v[92:95], v[64:67], a[112:115]
v_mfma_f32_16x16x32_bf16 a[116:119], v[92:95], v[68:71], a[116:119]
v_mfma_f32_16x16x32_bf16 a[120:123], v[92:95], v[72:75], a[120:123]
v_mfma_f32_16x16x32_bf16 a[124:127], v[92:95], v[76:79], a[124:127]
s_sub_u32 s18, s18, 1
s_cmp_eq_u32 s18, s55
s_cbranch_scc1 main_kernel_w_c1_v_ev
s_cmp_lg_u32 s18, 0
s_cbranch_scc1 main_kernel_w_c1_v_loop
s_cmp_lg_u32 s73, -1
s_cbranch_scc1 main_kernel_w_epn
s_waitcnt lgkmcnt(0)
v_mfma_f32_16x16x32_bf16 a[0:3], v[32:35], v[0:3], a[0:3]
s_waitcnt vmcnt(12)
s_barrier
ds_read_b128 v[80:83], v136 offset:8192
s_add_u32 m0, s20, 0
s_nop 0
s_add_u32 s32, s23, 1
s_bitcmp0_b32 s32, 2
s_cselect_b32 s34, 7, 2
s_cselect_b32 s35, 2, 4
s_lshl_b32 s59, s23, 13
s_add_u32 s59, s59, 0x8404000
v_mfma_f32_16x16x32_bf16 a[4:7], v[32:35], v[4:7], a[4:7]
ds_read_b64_tr_b16 v[48:49], v128 offset:16384
v_lshrrev_b32 v253, 3, v250
v_add_lshl_u32 v253, s24, v253, 9
v_mfma_f32_16x16x32_bf16 a[8:11], v[32:35], v[8:11], a[8:11]
ds_read_b64_tr_b16 v[50:51], v128 offset:24576
v_and_b32 v254, 3, v250
v_lshl_add_u32 v253, v254, s34, v253
v_mfma_f32_16x16x32_bf16 a[12:15], v[32:35], v[12:15], a[12:15]
ds_read_b64_tr_b16 v[52:53], v129 offset:16384
buffer_load_dwordx4 v141, s[4:7], s16 offen offset:0 sc1 lds
v_bfe_u32 v254, v250, 2, 1
v_add_u32 v254, s25, v254
v_mfma_f32_16x16x32_bf16 a[16:19], v[32:35], v[16:19], a[16:19]
ds_read_b64_tr_b16 v[54:55], v129 offset:24576
v_lshl_add_u32 v248, v254, s35, v253
s_lshl_b32 s0, 4, s54
v_mfma_f32_16x16x32_bf16 a[20:23], v[32:35], v[20:23], a[20:23]
ds_read_b64_tr_b16 v[56:57], v130 offset:16384
v_readfirstlane_b32 s28, v249
s_nop 1
v_cmp_ge_u32 vcc, s28, v229
v_mfma_f32_16x16x32_bf16 a[24:27], v[32:35], v[24:27], a[24:27]
ds_read_b64_tr_b16 v[58:59], v130 offset:24576
buffer_load_dwordx4 v142, s[4:7], s16 offen offset:1024 sc1 lds
s_nop 1
s_bcnt1_i32_b64 s32, vcc
v_mfma_f32_16x16x32_bf16 a[28:31], v[32:35], v[28:31], a[28:31]
ds_read_b64_tr_b16 v[60:61], v131 offset:16384
s_sub_u32 s32, s32, 1
v_readlane_b32 s36, v230, s32
v_mfma_f32_16x16x32_bf16 a[32:35], v[36:39], v[0:3], a[32:35]
ds_read_b64_tr_b16 v[62:63], v131 offset:24576
s_nop 1
s_and_b32 s32, s36, 0x7ff
v_mfma_f32_16x16x32_bf16 a[36:39], v[36:39], v[4:7], a[36:39]
ds_read_b64_tr_b16 v[64:65], v132 offset:16384
s_add_u32 s16, s16, 1024
s_sub_u32 s28, s28, s32
s_bfe_u32 s32, s36, 0x3001a
v_mfma_f32_16x16x32_bf16 a[40:43], v[36:39], v[8:11], a[40:43]
ds_read_b64_tr_b16 v[66:67], v132 offset:24576
s_lshr_b32 s25, s28, s32
s_lshl_b32 s33, s25, s32
s_sub_u32 s24, s28, s33
v_mfma_f32_16x16x32_bf16 a[44:47], v[36:39], v[12:15], a[44:47]
ds_read_b64_tr_b16 v[68:69], v133 offset:16384
s_bfe_u32 s34, s36, 0x1001d
s_lshl_b32 s24, s24, s34
v_mfma_f32_16x16x32_bf16 a[48:51], v[36:39], v[16:19], a[48:51]
ds_read_b64_tr_b16 v[70:71], v133 offset:24576
s_add_u32 m0, s19, 0
s_nop 0
s_bfe_u32 s35, s36, 0x1001e
s_lshl_b32 s25, s25, s35
v_mfma_f32_16x16x32_bf16 a[52:55], v[36:39], v[20:23], a[52:55]
ds_read_b64_tr_b16 v[72:73], v134 offset:16384
s_bfe_u32 s32, s36, 0x40011
s_add_u32 s24, s24, s32
v_mfma_f32_16x16x32_bf16 a[56:59], v[36:39], v[24:27], a[56:59]
ds_read_b64_tr_b16 v[74:75], v134 offset:24576
s_bfe_u32 s32, s36, 0x50015
s_add_u32 s25, s25, s32
v_mfma_f32_16x16x32_bf16 a[60:63], v[36:39], v[28:31], a[60:63]
ds_read_b64_tr_b16 v[76:77], v135 offset:16384
buffer_load_dwordx4 v137, s[8:11], s15 offen offset:0 lds
s_bfe_u32 s23, s36, 0x4000b
s_bfe_u32 s36, s36, 0x6000b
s_lshl_b32 s32, s24, 8
v_mfma_f32_16x16x32_bf16 a[64:67], v[40:43], v[0:3], a[64:67]
ds_read_b64_tr_b16 v[78:79], v135 offset:24576
s_or_b32 s36, s36, s32
s_lshl_b32 s32, s25, 16
v_mfma_f32_16x16x32_bf16 a[68:71], v[40:43], v[4:7], a[68:71]
ds_read_b128 v[84:87], v136 offset:9216
s_or_b32 s36, s36, s32
s_cmp_eq_u32 s23, 4
s_cselect_b32 s32, 1, 0
v_mfma_f32_16x16x32_bf16 a[72:75], v[40:43], v[8:11], a[72:75]
ds_read_b128 v[88:91], v136 offset:10240
buffer_load_dwordx4 v138, s[8:11], s15 offen offset:1024 lds
s_sub_u32 s48, s24, s32
s_max_i32 s48, s48, 0
v_mfma_f32_16x16x32_bf16 a[76:79], v[40:43], v[12:15], a[76:79]
ds_read_b128 v[92:95], v136 offset:11264
s_add_u32 s49, s24, s34
s_add_u32 s49, s49, s32
v_mfma_f32_16x16x32_bf16 a[80:83], v[40:43], v[16:19], a[80:83]
s_min_u32 s49, s49, 15
s_cmp_eq_u32 s23, 6
s_cselect_b32 s51, 3, 7
s_cmp_eq_u32 s23, 7
s_cselect_b32 s51, 27, s51
s_cselect_b32 s50, 5, 4
v_mfma_f32_16x16x32_bf16 a[84:87], v[40:43], v[20:23], a[84:87]
buffer_load_dwordx4 v139, s[8:11], s15 offen offset:2048 lds
s_add_u32 s33, s25, s35
s_lshl_b32 s34, s24, 9
v_mfma_f32_16x16x32_bf16 a[88:91], v[40:43], v[24:27], a[88:91]
s_cmp_eq_u32 s23, 8
s_cselect_b32 s51, 0, s51
s_cselect_b32 s48, s25, s48
s_cselect_b32 s49, s33, s49
s_cmp_eq_u32 s23, 8
s_cselect_b32 s63, 2, 9
s_cselect_b32 s61, 0, 0x7f000000
s_cselect_b32 s34, s34, 0
v_mfma_f32_16x16x32_bf16 a[92:95], v[40:43], v[28:31], a[92:95]
v_lshrrev_b32 v228, s50, v250
v_lshlrev_b32 v254, s50, v228
v_mfma_f32_16x16x32_bf16 a[96:99], v[44:47], v[0:3], a[96:99]
buffer_load_dwordx4 v140, s[8:11], s15 offen offset:3072 lds
v_sub_u32 v254, v250, v254
s_cmp_lt_u32 s23, 4
s_cselect_b32 s39, 10, s23
v_mfma_f32_16x16x32_bf16 a[100:103], v[44:47], v[4:7], a[100:103]
v_min_u32 v254, s51, v254
s_lshl_b32 s39, s39, 13
s_cmp_eq_u32 s23, 3
s_cselect_b32 s34, 4, s34
v_mfma_f32_16x16x32_bf16 a[104:107], v[44:47], v[8:11], a[104:107]
v_add_u32 v228, s48, v228
s_add_u32 s39, s39, s34
v_mfma_f32_16x16x32_bf16 a[108:111], v[44:47], v[12:15], a[108:111]
s_add_u32 s15, s15, s17
s_add_u32 s39, s39, 0x8402000
v_min_u32 v228, s49, v228
v_mfma_f32_16x16x32_bf16 a[112:115], v[44:47], v[16:19], a[112:115]
s_lshl_b32 s60, s24, 10
s_add_u32 s60, s60, 0x8400000
v_mfma_f32_16x16x32_bf16 a[116:119], v[44:47], v[20:23], a[116:119]
v_lshlrev_b32 v228, s63, v228
v_lshl_add_u32 v228, v254, 4, v228
v_mfma_f32_16x16x32_bf16 a[120:123], v[44:47], v[24:27], a[120:123]
v_or_b32 v146, s61, v251
s_mov_b64 exec, s[100:101]
buffer_load_dword v231, v228, s[4:7], s39 offen sc1
buffer_load_dwordx4 v[232:235], v146, s[4:7], s60 offen sc1
s_mov_b64 exec, -1
v_mfma_f32_16x16x32_bf16 a[124:127], v[44:47], v[28:31], a[124:127]
s_waitcnt lgkmcnt(0)
v_mfma_f32_16x16x32_bf16 a[0:3], v[80:83], v[48:51], a[0:3]
s_waitcnt vmcnt(12)
s_barrier
ds_read_b128 v[32:35], v136 offset:16384
s_add_u32 m0, s20, 8192
s_nop 0
s_mov_b32 s1, s21
v_mfma_f32_16x16x32_bf16 a[4:7], v[80:83], v[52:55], a[4:7]
ds_read_b64_tr_b16 v[0:1], v128 offset:32768
v_mfma_f32_16x16x32_bf16 a[8:11], v[80:83], v[56:59], a[8:11]
ds_read_b64_tr_b16 v[2:3], v128 offset:40960
v_mfma_f32_16x16x32_bf16 a[12:15], v[80:83], v[60:63], a[12:15]
ds_read_b64_tr_b16 v[4:5], v129 offset:32768
buffer_load_dwordx4 v141, s[4:7], s16 offen offset:0 sc1 lds
v_mfma_f32_16x16x32_bf16 a[16:19], v[80:83], v[64:67], a[16:19]
ds_read_b64_tr_b16 v[6:7], v129 offset:40960
v_mfma_f32_16x16x32_bf16 a[20:23], v[80:83], v[68:71], a[20:23]
ds_read_b64_tr_b16 v[8:9], v130 offset:32768
s_mov_b32 s2, s22
v_mfma_f32_16x16x32_bf16 a[24:27], v[80:83], v[72:75], a[24:27]
ds_read_b64_tr_b16 v[10:11], v130 offset:40960
buffer_load_dwordx4 v142, s[4:7], s16 offen offset:1024 sc1 lds
v_mfma_f32_16x16x32_bf16 a[28:31], v[80:83], v[76:79], a[28:31]
ds_read_b64_tr_b16 v[12:13], v131 offset:32768
v_mfma_f32_16x16x32_bf16 a[32:35], v[84:87], v[48:51], a[32:35]
ds_read_b64_tr_b16 v[14:15], v131 offset:40960
v_mfma_f32_16x16x32_bf16 a[36:39], v[84:87], v[52:55], a[36:39]
ds_read_b64_tr_b16 v[16:17], v132 offset:32768
s_add_u32 s16, s16, 1024
v_mfma_f32_16x16x32_bf16 a[40:43], v[84:87], v[56:59], a[40:43]
ds_read_b64_tr_b16 v[18:19], v132 offset:40960
s_mov_b32 s3, s26
v_mfma_f32_16x16x32_bf16 a[44:47], v[84:87], v[60:63], a[44:47]
ds_read_b64_tr_b16 v[20:21], v133 offset:32768
v_mfma_f32_16x16x32_bf16 a[48:51], v[84:87], v[64:67], a[48:51]
ds_read_b64_tr_b16 v[22:23], v133 offset:40960
s_add_u32 m0, s19, 16384
s_nop 0
v_mfma_f32_16x16x32_bf16 a[52:55], v[84:87], v[68:71], a[52:55]
ds_read_b64_tr_b16 v[24:25], v134 offset:32768
v_mfma_f32_16x16x32_bf16 a[56:59], v[84:87], v[72:75], a[56:59]
ds_read_b64_tr_b16 v[26:27], v134 offset:40960
v_mfma_f32_16x16x32_bf16 a[60:63], v[84:87], v[76:79], a[60:63]
ds_read_b64_tr_b16 v[28:29], v135 offset:32768
buffer_load_dwordx4 v137, s[8:11], s15 offen offset:0 lds
s_mov_b32 s56, s57
v_mfma_f32_16x16x32_bf16 a[64:67], v[88:91], v[48:51], a[64:67]
ds_read_b64_tr_b16 v[30:31], v135 offset:40960
v_mfma_f32_16x16x32_bf16 a[68:71], v[88:91], v[52:55], a[68:71]
ds_read_b128 v[36:39], v136 offset:17408
v_mfma_f32_16x16x32_bf16 a[72:75], v[88:91], v[56:59], a[72:75]
ds_read_b128 v[40:43], v136 offset:18432
buffer_load_dwordx4 v138, s[8:11], s15 offen offset:1024 lds
v_mfma_f32_16x16x32_bf16 a[76:79], v[88:91], v[60:63], a[76:79]
ds_read_b128 v[44:47], v136 offset:19456
v_mfma_f32_16x16x32_bf16 a[80:83], v[88:91], v[64:67], a[80:83]
v_mov_b32 v145, v252
v_mfma_f32_16x16x32_bf16 a[84:87], v[88:91], v[68:71], a[84:87]
buffer_load_dwordx4 v139, s[8:11], s15 offen offset:2048 lds
v_mfma_f32_16x16x32_bf16 a[88:91], v[88:91], v[72:75], a[88:91]
v_mfma_f32_16x16x32_bf16 a[92:95], v[88:91], v[76:79], a[92:95]
v_mfma_f32_16x16x32_bf16 a[96:99], v[92:95], v[48:51], a[96:99]
buffer_load_dwordx4 v140, s[8:11], s15 offen offset:3072 lds
v_mfma_f32_16x16x32_bf16 a[100:103], v[92:95], v[52:55], a[100:103]
v_mov_b32 v255, 131072
v_mfma_f32_16x16x32_bf16 a[104:107], v[92:95], v[56:59], a[104:107]
v_mfma_f32_16x16x32_bf16 a[108:111], v[92:95], v[60:63], a[108:111]
s_add_u32 s15, s15, s17
v_mfma_f32_16x16x32_bf16 a[112:115], v[92:95], v[64:67], a[112:115]
v_mfma_f32_16x16x32_bf16 a[116:119], v[92:95], v[68:71], a[116:119]
v_mfma_f32_16x16x32_bf16 a[120:123], v[92:95], v[72:75], a[120:123]
v_mfma_f32_16x16x32_bf16 a[124:127], v[92:95], v[76:79], a[124:127]
s_waitcnt lgkmcnt(0)
v_mfma_f32_16x16x32_bf16 a[0:3], v[32:35], v[0:3], a[0:3]
s_waitcnt vmcnt(12)
s_barrier
ds_read_b128 v[80:83], v136 offset:24576
s_add_u32 m0, s20, 16384
s_nop 0
v_mfma_f32_16x16x32_bf16 a[4:7], v[32:35], v[4:7], a[4:7]
ds_read_b64_tr_b16 v[48:49], v128 offset:49152
v_mfma_f32_16x16x32_bf16 a[8:11], v[32:35], v[8:11], a[8:11]
ds_read_b64_tr_b16 v[50:51], v128 offset:57344
v_mfma_f32_16x16x32_bf16 a[12:15], v[32:35], v[12:15], a[12:15]
ds_read_b64_tr_b16 v[52:53], v129 offset:49152
buffer_load_dwordx4 v141, s[4:7], s16 offen offset:0 sc1 lds
v_mfma_f32_16x16x32_bf16 a[16:19], v[32:35], v[16:19], a[16:19]
ds_read_b64_tr_b16 v[54:55], v129 offset:57344
v_mfma_f32_16x16x32_bf16 a[20:23], v[32:35], v[20:23], a[20:23]
ds_read_b64_tr_b16 v[56:57], v130 offset:49152
v_mfma_f32_16x16x32_bf16 a[24:27], v[32:35], v[24:27], a[24:27]
ds_read_b64_tr_b16 v[58:59], v130 offset:57344
buffer_load_dwordx4 v142, s[4:7], s16 offen offset:1024 sc1 lds
v_mfma_f32_16x16x32_bf16 a[28:31], v[32:35], v[28:31], a[28:31]
ds_read_b64_tr_b16 v[60:61], v131 offset:49152
v_mfma_f32_16x16x32_bf16 a[32:35], v[36:39], v[0:3], a[32:35]
ds_read_b64_tr_b16 v[62:63], v131 offset:57344
v_mfma_f32_16x16x32_bf16 a[36:39], v[36:39], v[4:7], a[36:39]
ds_read_b64_tr_b16 v[64:65], v132 offset:49152
s_add_u32 s16, s16, 1024
v_mfma_f32_16x16x32_bf16 a[40:43], v[36:39], v[8:11], a[40:43]
ds_read_b64_tr_b16 v[66:67], v132 offset:57344
v_mfma_f32_16x16x32_bf16 a[44:47], v[36:39], v[12:15], a[44:47]
ds_read_b64_tr_b16 v[68:69], v133 offset:49152
v_mfma_f32_16x16x32_bf16 a[48:51], v[36:39], v[16:19], a[48:51]
ds_read_b64_tr_b16 v[70:71], v133 offset:57344
s_add_u32 m0, s19, 32768
s_nop 0
v_mfma_f32_16x16x32_bf16 a[52:55], v[36:39], v[20:23], a[52:55]
ds_read_b64_tr_b16 v[72:73], v134 offset:49152
v_mfma_f32_16x16x32_bf16 a[56:59], v[36:39], v[24:27], a[56:59]
ds_read_b64_tr_b16 v[74:75], v134 offset:57344
v_mfma_f32_16x16x32_bf16 a[60:63], v[36:39], v[28:31], a[60:63]
ds_read_b64_tr_b16 v[76:77], v135 offset:49152
buffer_load_dwordx4 v137, s[8:11], s15 offen offset:0 lds
v_mfma_f32_16x16x32_bf16 a[64:67], v[40:43], v[0:3], a[64:67]
ds_read_b64_tr_b16 v[78:79], v135 offset:57344
v_mfma_f32_16x16x32_bf16 a[68:71], v[40:43], v[4:7], a[68:71]
ds_read_b128 v[84:87], v136 offset:25600
v_mfma_f32_16x16x32_bf16 a[72:75], v[40:43], v[8:11], a[72:75]
ds_read_b128 v[88:91], v136 offset:26624
buffer_load_dwordx4 v138, s[8:11], s15 offen offset:1024 lds
v_mfma_f32_16x16x32_bf16 a[76:79], v[40:43], v[12:15], a[76:79]
ds_read_b128 v[92:95], v136 offset:27648
v_mfma_f32_16x16x32_bf16 a[80:83], v[40:43], v[16:19], a[80:83]
s_waitcnt vmcnt(10)
v_mfma_f32_16x16x32_bf16 a[84:87], v[40:43], v[20:23], a[84:87]
buffer_load_dwordx4 v139, s[8:11], s15 offen offset:2048 lds
v_min3_u32 v253, v232, v233, v234
v_mfma_f32_16x16x32_bf16 a[88:91], v[40:43], v[24:27], a[88:91]
v_min_u32 v253, v253, v235
v_mfma_f32_16x16x32_bf16 a[92:95], v[40:43], v[28:31], a[92:95]
v_or_b32 v253, s61, v253
v_mfma_f32_16x16x32_bf16 a[96:99], v[44:47], v[0:3], a[96:99]
buffer_load_dwordx4 v140, s[8:11], s15 offen offset:3072 lds
v_min_u32 v253, v253, v231
v_mfma_f32_16x16x32_bf16 a[100:103], v[44:47], v[4:7], a[100:103]
v_cmp_eq_u32 vcc, 0, v253
v_mfma_f32_16x16x32_bf16 a[104:107], v[44:47], v[8:11], a[104:107]
s_nop 1
v_mfma_f32_16x16x32_bf16 a[108:111], v[44:47], v[12:15], a[108:111]
s_add_u32 s15, s15, s17
s_cmp_eq_u64 vcc, 0
s_cselect_b32 s32, s36, -4
v_mfma_f32_16x16x32_bf16 a[112:115], v[44:47], v[16:19], a[112:115]
s_bitcmp1_b32 0x1df, s23
s_cselect_b32 s32, s32, -4
v_mfma_f32_16x16x32_bf16 a[116:119], v[44:47], v[20:23], a[116:119]
v_mov_b32 v254, s32
v_mfma_f32_16x16x32_bf16 a[120:123], v[44:47], v[24:27], a[120:123]
s_mov_b64 exec, s[100:101]
ds_write_b32 v255, v254
s_mov_b64 exec, -1
v_mfma_f32_16x16x32_bf16 a[124:127], v[44:47], v[28:31], a[124:127]
s_waitcnt lgkmcnt(0)
v_mfma_f32_16x16x32_bf16 a[0:3], v[80:83], v[48:51], a[0:3]
s_waitcnt vmcnt(12)
s_barrier
ds_read_b128 v[32:35], v136 offset:0
s_add_u32 m0, s20, 24576
s_nop 0
ds_read_b32 v254, v255
v_mfma_f32_16x16x32_bf16 a[4:7], v[80:83], v[52:55], a[4:7]
ds_read_b64_tr_b16 v[0:1], v128 offset:0
v_mfma_f32_16x16x32_bf16 a[8:11], v[80:83], v[56:59], a[8:11]
ds_read_b64_tr_b16 v[2:3], v128 offset:8192
v_mfma_f32_16x16x32_bf16 a[12:15], v[80:83], v[60:63], a[12:15]
ds_read_b64_tr_b16 v[4:5], v129 offset:0
buffer_load_dwordx4 v141, s[4:7], s16 offen offset:0 sc1 lds
v_mfma_f32_16x16x32_bf16 a[16:19], v[80:83], v[64:67], a[16:19]
ds_read_b64_tr_b16 v[6:7], v129 offset:8192
v_mfma_f32_16x16x32_bf16 a[20:23], v[80:83], v[68:71], a[20:23]
ds_read_b64_tr_b16 v[8:9], v130 offset:0
v_mfma_f32_16x16x32_bf16 a[24:27], v[80:83], v[72:75], a[24:27]
ds_read_b64_tr_b16 v[10:11], v130 offset:8192
buffer_load_dwordx4 v142, s[4:7], s16 offen offset:1024 sc1 lds
v_mfma_f32_16x16x32_bf16 a[28:31], v[80:83], v[76:79], a[28:31]
ds_read_b64_tr_b16 v[12:13], v131 offset:0
v_mfma_f32_16x16x32_bf16 a[32:35], v[84:87], v[48:51], a[32:35]
ds_read_b64_tr_b16 v[14:15], v131 offset:8192
v_mfma_f32_16x16x32_bf16 a[36:39], v[84:87], v[52:55], a[36:39]
ds_read_b64_tr_b16 v[16:17], v132 offset:0
s_add_u32 s16, s16, 1024
v_mfma_f32_16x16x32_bf16 a[40:43], v[84:87], v[56:59], a[40:43]
ds_read_b64_tr_b16 v[18:19], v132 offset:8192
v_mfma_f32_16x16x32_bf16 a[44:47], v[84:87], v[60:63], a[44:47]
ds_read_b64_tr_b16 v[20:21], v133 offset:0
v_mfma_f32_16x16x32_bf16 a[48:51], v[84:87], v[64:67], a[48:51]
ds_read_b64_tr_b16 v[22:23], v133 offset:8192
s_add_u32 m0, s19, 49152
s_nop 0
v_mfma_f32_16x16x32_bf16 a[52:55], v[84:87], v[68:71], a[52:55]
ds_read_b64_tr_b16 v[24:25], v134 offset:0
v_mfma_f32_16x16x32_bf16 a[56:59], v[84:87], v[72:75], a[56:59]
ds_read_b64_tr_b16 v[26:27], v134 offset:8192
v_mfma_f32_16x16x32_bf16 a[60:63], v[84:87], v[76:79], a[60:63]
ds_read_b64_tr_b16 v[28:29], v135 offset:0
buffer_load_dwordx4 v137, s[8:11], s15 offen offset:0 lds
v_mfma_f32_16x16x32_bf16 a[64:67], v[88:91], v[48:51], a[64:67]
ds_read_b64_tr_b16 v[30:31], v135 offset:8192
v_mfma_f32_16x16x32_bf16 a[68:71], v[88:91], v[52:55], a[68:71]
ds_read_b128 v[36:39], v136 offset:1024
v_mfma_f32_16x16x32_bf16 a[72:75], v[88:91], v[56:59], a[72:75]
ds_read_b128 v[40:43], v136 offset:2048
buffer_load_dwordx4 v138, s[8:11], s15 offen offset:1024 lds
v_mfma_f32_16x16x32_bf16 a[76:79], v[88:91], v[60:63], a[76:79]
ds_read_b128 v[44:47], v136 offset:3072
v_mfma_f32_16x16x32_bf16 a[80:83], v[88:91], v[64:67], a[80:83]
s_waitcnt lgkmcnt(8)
v_mfma_f32_16x16x32_bf16 a[84:87], v[88:91], v[68:71], a[84:87]
buffer_load_dwordx4 v139, s[8:11], s15 offen offset:2048 lds
v_readfirstlane_b32 s62, v254
v_mfma_f32_16x16x32_bf16 a[88:91], v[88:91], v[72:75], a[88:91]
v_mfma_f32_16x16x32_bf16 a[92:95], v[88:91], v[76:79], a[92:95]
s_nop 1
v_mfma_f32_16x16x32_bf16 a[96:99], v[92:95], v[48:51], a[96:99]
buffer_load_dwordx4 v140, s[8:11], s15 offen offset:3072 lds
s_and_b32 s23, s62, 15
v_mfma_f32_16x16x32_bf16 a[100:103], v[92:95], v[52:55], a[100:103]
v_mfma_f32_16x16x32_bf16 a[104:107], v[92:95], v[56:59], a[104:107]
s_bfe_u32 s54, s62, 0x20004
v_mfma_f32_16x16x32_bf16 a[108:111], v[92:95], v[60:63], a[108:111]
s_add_u32 s15, s15, s17
s_bfe_u32 s24, s62, 0x80008
v_mfma_f32_16x16x32_bf16 a[112:115], v[92:95], v[64:67], a[112:115]
v_mfma_f32_16x16x32_bf16 a[116:119], v[92:95], v[68:71], a[116:119]
s_lshr_b32 s25, s62, 16
v_mfma_f32_16x16x32_bf16 a[120:123], v[92:95], v[72:75], a[120:123]
v_mfma_f32_16x16x32_bf16 a[124:127], v[92:95], v[76:79], a[124:127]
s_cmp_eq_u32 s54, 1
s_cselect_b32 s73, 3, -1
s_cbranch_scc1 main_kernel_w_c1_task
s_waitcnt lgkmcnt(0)
v_mfma_f32_16x16x32_bf16 a[0:3], v[32:35], v[0:3], a[0:3]
s_waitcnt vmcnt(12)
s_barrier
ds_read_b128 v[80:83], v136 offset:8192
v_mfma_f32_16x16x32_bf16 a[4:7], v[32:35], v[4:7], a[4:7]
ds_read_b64_tr_b16 v[48:49], v128 offset:16384
v_mfma_f32_16x16x32_bf16 a[8:11], v[32:35], v[8:11], a[8:11]
ds_read_b64_tr_b16 v[50:51], v128 offset:24576
v_mfma_f32_16x16x32_bf16 a[12:15], v[32:35], v[12:15], a[12:15]
ds_read_b64_tr_b16 v[52:53], v129 offset:16384
v_mfma_f32_16x16x32_bf16 a[16:19], v[32:35], v[16:19], a[16:19]
ds_read_b64_tr_b16 v[54:55], v129 offset:24576
v_mfma_f32_16x16x32_bf16 a[20:23], v[32:35], v[20:23], a[20:23]
ds_read_b64_tr_b16 v[56:57], v130 offset:16384
v_mfma_f32_16x16x32_bf16 a[24:27], v[32:35], v[24:27], a[24:27]
ds_read_b64_tr_b16 v[58:59], v130 offset:24576
v_mfma_f32_16x16x32_bf16 a[28:31], v[32:35], v[28:31], a[28:31]
ds_read_b64_tr_b16 v[60:61], v131 offset:16384
v_mfma_f32_16x16x32_bf16 a[32:35], v[36:39], v[0:3], a[32:35]
ds_read_b64_tr_b16 v[62:63], v131 offset:24576
v_mfma_f32_16x16x32_bf16 a[36:39], v[36:39], v[4:7], a[36:39]
ds_read_b64_tr_b16 v[64:65], v132 offset:16384
v_mfma_f32_16x16x32_bf16 a[40:43], v[36:39], v[8:11], a[40:43]
ds_read_b64_tr_b16 v[66:67], v132 offset:24576
v_mfma_f32_16x16x32_bf16 a[44:47], v[36:39], v[12:15], a[44:47]
ds_read_b64_tr_b16 v[68:69], v133 offset:16384
v_mfma_f32_16x16x32_bf16 a[48:51], v[36:39], v[16:19], a[48:51]
ds_read_b64_tr_b16 v[70:71], v133 offset:24576
v_mfma_f32_16x16x32_bf16 a[52:55], v[36:39], v[20:23], a[52:55]
ds_read_b64_tr_b16 v[72:73], v134 offset:16384
v_mfma_f32_16x16x32_bf16 a[56:59], v[36:39], v[24:27], a[56:59]
ds_read_b64_tr_b16 v[74:75], v134 offset:24576
v_mfma_f32_16x16x32_bf16 a[60:63], v[36:39], v[28:31], a[60:63]
ds_read_b64_tr_b16 v[76:77], v135 offset:16384
v_mfma_f32_16x16x32_bf16 a[64:67], v[40:43], v[0:3], a[64:67]
ds_read_b64_tr_b16 v[78:79], v135 offset:24576
v_mfma_f32_16x16x32_bf16 a[68:71], v[40:43], v[4:7], a[68:71]
ds_read_b128 v[84:87], v136 offset:9216
v_mfma_f32_16x16x32_bf16 a[72:75], v[40:43], v[8:11], a[72:75]
ds_read_b128 v[88:91], v136 offset:10240
v_mfma_f32_16x16x32_bf16 a[76:79], v[40:43], v[12:15], a[76:79]
ds_read_b128 v[92:95], v136 offset:11264
v_mfma_f32_16x16x32_bf16 a[80:83], v[40:43], v[16:19], a[80:83]
v_mfma_f32_16x16x32_bf16 a[84:87], v[40:43], v[20:23], a[84:87]
v_mfma_f32_16x16x32_bf16 a[88:91], v[40:43], v[24:27], a[88:91]
v_mfma_f32_16x16x32_bf16 a[92:95], v[40:43], v[28:31], a[92:95]
v_mfma_f32_16x16x32_bf16 a[96:99], v[44:47], v[0:3], a[96:99]
v_mfma_f32_16x16x32_bf16 a[100:103], v[44:47], v[4:7], a[100:103]
v_mfma_f32_16x16x32_bf16 a[104:107], v[44:47], v[8:11], a[104:107]
v_mfma_f32_16x16x32_bf16 a[108:111], v[44:47], v[12:15], a[108:111]
v_mfma_f32_16x16x32_bf16 a[112:115], v[44:47], v[16:19], a[112:115]
v_mfma_f32_16x16x32_bf16 a[116:119], v[44:47], v[20:23], a[116:119]
v_mfma_f32_16x16x32_bf16 a[120:123], v[44:47], v[24:27], a[120:123]
v_mfma_f32_16x16x32_bf16 a[124:127], v[44:47], v[28:31], a[124:127]
s_waitcnt lgkmcnt(0)
v_mfma_f32_16x16x32_bf16 a[0:3], v[80:83], v[48:51], a[0:3]
s_waitcnt vmcnt(6)
s_barrier
ds_read_b128 v[32:35], v136 offset:16384
v_mfma_f32_16x16x32_bf16 a[4:7], v[80:83], v[52:55], a[4:7]
ds_read_b64_tr_b16 v[0:1], v128 offset:32768
v_mfma_f32_16x16x32_bf16 a[8:11], v[80:83], v[56:59], a[8:11]
ds_read_b64_tr_b16 v[2:3], v128 offset:40960
v_mfma_f32_16x16x32_bf16 a[12:15], v[80:83], v[60:63], a[12:15]
ds_read_b64_tr_b16 v[4:5], v129 offset:32768
v_mfma_f32_16x16x32_bf16 a[16:19], v[80:83], v[64:67], a[16:19]
ds_read_b64_tr_b16 v[6:7], v129 offset:40960
v_mfma_f32_16x16x32_bf16 a[20:23], v[80:83], v[68:71], a[20:23]
ds_read_b64_tr_b16 v[8:9], v130 offset:32768
v_mfma_f32_16x16x32_bf16 a[24:27], v[80:83], v[72:75], a[24:27]
ds_read_b64_tr_b16 v[10:11], v130 offset:40960
v_mfma_f32_16x16x32_bf16 a[28:31], v[80:83], v[76:79], a[28:31]
ds_read_b64_tr_b16 v[12:13], v131 offset:32768
v_mfma_f32_16x16x32_bf16 a[32:35], v[84:87], v[48:51], a[32:35]
ds_read_b64_tr_b16 v[14:15], v131 offset:40960
v_mfma_f32_16x16x32_bf16 a[36:39], v[84:87], v[52:55], a[36:39]
ds_read_b64_tr_b16 v[16:17], v132 offset:32768
v_mfma_f32_16x16x32_bf16 a[40:43], v[84:87], v[56:59], a[40:43]
ds_read_b64_tr_b16 v[18:19], v132 offset:40960
v_mfma_f32_16x16x32_bf16 a[44:47], v[84:87], v[60:63], a[44:47]
ds_read_b64_tr_b16 v[20:21], v133 offset:32768
v_mfma_f32_16x16x32_bf16 a[48:51], v[84:87], v[64:67], a[48:51]
ds_read_b64_tr_b16 v[22:23], v133 offset:40960
v_mfma_f32_16x16x32_bf16 a[52:55], v[84:87], v[68:71], a[52:55]
ds_read_b64_tr_b16 v[24:25], v134 offset:32768
v_mfma_f32_16x16x32_bf16 a[56:59], v[84:87], v[72:75], a[56:59]
ds_read_b64_tr_b16 v[26:27], v134 offset:40960
v_mfma_f32_16x16x32_bf16 a[60:63], v[84:87], v[76:79], a[60:63]
ds_read_b64_tr_b16 v[28:29], v135 offset:32768
v_mfma_f32_16x16x32_bf16 a[64:67], v[88:91], v[48:51], a[64:67]
ds_read_b64_tr_b16 v[30:31], v135 offset:40960
v_mfma_f32_16x16x32_bf16 a[68:71], v[88:91], v[52:55], a[68:71]
ds_read_b128 v[36:39], v136 offset:17408
v_mfma_f32_16x16x32_bf16 a[72:75], v[88:91], v[56:59], a[72:75]
ds_read_b128 v[40:43], v136 offset:18432
v_mfma_f32_16x16x32_bf16 a[76:79], v[88:91], v[60:63], a[76:79]
ds_read_b128 v[44:47], v136 offset:19456
v_mfma_f32_16x16x32_bf16 a[80:83], v[88:91], v[64:67], a[80:83]
v_mfma_f32_16x16x32_bf16 a[84:87], v[88:91], v[68:71], a[84:87]
v_mfma_f32_16x16x32_bf16 a[88:91], v[88:91], v[72:75], a[88:91]
v_mfma_f32_16x16x32_bf16 a[92:95], v[88:91], v[76:79], a[92:95]
v_mfma_f32_16x16x32_bf16 a[96:99], v[92:95], v[48:51], a[96:99]
v_mfma_f32_16x16x32_bf16 a[100:103], v[92:95], v[52:55], a[100:103]
v_mfma_f32_16x16x32_bf16 a[104:107], v[92:95], v[56:59], a[104:107]
v_mfma_f32_16x16x32_bf16 a[108:111], v[92:95], v[60:63], a[108:111]
v_mfma_f32_16x16x32_bf16 a[112:115], v[92:95], v[64:67], a[112:115]
v_mfma_f32_16x16x32_bf16 a[116:119], v[92:95], v[68:71], a[116:119]
v_mfma_f32_16x16x32_bf16 a[120:123], v[92:95], v[72:75], a[120:123]
v_mfma_f32_16x16x32_bf16 a[124:127], v[92:95], v[76:79], a[124:127]
s_waitcnt lgkmcnt(0)
v_mfma_f32_16x16x32_bf16 a[0:3], v[32:35], v[0:3], a[0:3]
s_waitcnt vmcnt(0)
s_barrier
ds_read_b128 v[80:83], v136 offset:24576
v_mfma_f32_16x16x32_bf16 a[4:7], v[32:35], v[4:7], a[4:7]
ds_read_b64_tr_b16 v[48:49], v128 offset:49152
v_mfma_f32_16x16x32_bf16 a[8:11], v[32:35], v[8:11], a[8:11]
ds_read_b64_tr_b16 v[50:51], v128 offset:57344
v_mfma_f32_16x16x32_bf16 a[12:15], v[32:35], v[12:15], a[12:15]
ds_read_b64_tr_b16 v[52:53], v129 offset:49152
v_mfma_f32_16x16x32_bf16 a[16:19], v[32:35], v[16:19], a[16:19]
ds_read_b64_tr_b16 v[54:55], v129 offset:57344
v_mfma_f32_16x16x32_bf16 a[20:23], v[32:35], v[20:23], a[20:23]
ds_read_b64_tr_b16 v[56:57], v130 offset:49152
v_mfma_f32_16x16x32_bf16 a[24:27], v[32:35], v[24:27], a[24:27]
ds_read_b64_tr_b16 v[58:59], v130 offset:57344
v_mfma_f32_16x16x32_bf16 a[28:31], v[32:35], v[28:31], a[28:31]
ds_read_b64_tr_b16 v[60:61], v131 offset:49152
v_mfma_f32_16x16x32_bf16 a[32:35], v[36:39], v[0:3], a[32:35]
ds_read_b64_tr_b16 v[62:63], v131 offset:57344
v_mfma_f32_16x16x32_bf16 a[36:39], v[36:39], v[4:7], a[36:39]
ds_read_b64_tr_b16 v[64:65], v132 offset:49152
v_mfma_f32_16x16x32_bf16 a[40:43], v[36:39], v[8:11], a[40:43]
ds_read_b64_tr_b16 v[66:67], v132 offset:57344
v_mfma_f32_16x16x32_bf16 a[44:47], v[36:39], v[12:15], a[44:47]
ds_read_b64_tr_b16 v[68:69], v133 offset:49152
v_mfma_f32_16x16x32_bf16 a[48:51], v[36:39], v[16:19], a[48:51]
ds_read_b64_tr_b16 v[70:71], v133 offset:57344
v_mfma_f32_16x16x32_bf16 a[52:55], v[36:39], v[20:23], a[52:55]
ds_read_b64_tr_b16 v[72:73], v134 offset:49152
v_mfma_f32_16x16x32_bf16 a[56:59], v[36:39], v[24:27], a[56:59]
ds_read_b64_tr_b16 v[74:75], v134 offset:57344
v_mfma_f32_16x16x32_bf16 a[60:63], v[36:39], v[28:31], a[60:63]
ds_read_b64_tr_b16 v[76:77], v135 offset:49152
v_mfma_f32_16x16x32_bf16 a[64:67], v[40:43], v[0:3], a[64:67]
ds_read_b64_tr_b16 v[78:79], v135 offset:57344
v_mfma_f32_16x16x32_bf16 a[68:71], v[40:43], v[4:7], a[68:71]
ds_read_b128 v[84:87], v136 offset:25600
v_mfma_f32_16x16x32_bf16 a[72:75], v[40:43], v[8:11], a[72:75]
ds_read_b128 v[88:91], v136 offset:26624
v_mfma_f32_16x16x32_bf16 a[76:79], v[40:43], v[12:15], a[76:79]
ds_read_b128 v[92:95], v136 offset:27648
v_mfma_f32_16x16x32_bf16 a[80:83], v[40:43], v[16:19], a[80:83]
v_mfma_f32_16x16x32_bf16 a[84:87], v[40:43], v[20:23], a[84:87]
v_mfma_f32_16x16x32_bf16 a[88:91], v[40:43], v[24:27], a[88:91]
v_mfma_f32_16x16x32_bf16 a[92:95], v[40:43], v[28:31], a[92:95]
v_mfma_f32_16x16x32_bf16 a[96:99], v[44:47], v[0:3], a[96:99]
v_mfma_f32_16x16x32_bf16 a[100:103], v[44:47], v[4:7], a[100:103]
v_mfma_f32_16x16x32_bf16 a[104:107], v[44:47], v[8:11], a[104:107]
v_mfma_f32_16x16x32_bf16 a[108:111], v[44:47], v[12:15], a[108:111]
v_mfma_f32_16x16x32_bf16 a[112:115], v[44:47], v[16:19], a[112:115]
v_mfma_f32_16x16x32_bf16 a[116:119], v[44:47], v[20:23], a[116:119]
v_mfma_f32_16x16x32_bf16 a[120:123], v[44:47], v[24:27], a[120:123]
v_mfma_f32_16x16x32_bf16 a[124:127], v[44:47], v[28:31], a[124:127]
s_waitcnt lgkmcnt(0)
v_mfma_f32_16x16x32_bf16 a[0:3], v[80:83], v[48:51], a[0:3]
s_barrier
v_mfma_f32_16x16x32_bf16 a[4:7], v[80:83], v[52:55], a[4:7]
v_mfma_f32_16x16x32_bf16 a[8:11], v[80:83], v[56:59], a[8:11]
v_mfma_f32_16x16x32_bf16 a[12:15], v[80:83], v[60:63], a[12:15]
v_mfma_f32_16x16x32_bf16 a[16:19], v[80:83], v[64:67], a[16:19]
v_mfma_f32_16x16x32_bf16 a[20:23], v[80:83], v[68:71], a[20:23]
v_mfma_f32_16x16x32_bf16 a[24:27], v[80:83], v[72:75], a[24:27]
v_mfma_f32_16x16x32_bf16 a[28:31], v[80:83], v[76:79], a[28:31]
v_mfma_f32_16x16x32_bf16 a[32:35], v[84:87], v[48:51], a[32:35]
v_mfma_f32_16x16x32_bf16 a[36:39], v[84:87], v[52:55], a[36:39]
v_mfma_f32_16x16x32_bf16 a[40:43], v[84:87], v[56:59], a[40:43]
v_mfma_f32_16x16x32_bf16 a[44:47], v[84:87], v[60:63], a[44:47]
v_mfma_f32_16x16x32_bf16 a[48:51], v[84:87], v[64:67], a[48:51]
v_mfma_f32_16x16x32_bf16 a[52:55], v[84:87], v[68:71], a[52:55]
v_mfma_f32_16x16x32_bf16 a[56:59], v[84:87], v[72:75], a[56:59]
v_mfma_f32_16x16x32_bf16 a[60:63], v[84:87], v[76:79], a[60:63]
v_mfma_f32_16x16x32_bf16 a[64:67], v[88:91], v[48:51], a[64:67]
v_mfma_f32_16x16x32_bf16 a[68:71], v[88:91], v[52:55], a[68:71]
v_mfma_f32_16x16x32_bf16 a[72:75], v[88:91], v[56:59], a[72:75]
v_mfma_f32_16x16x32_bf16 a[76:79], v[88:91], v[60:63], a[76:79]
v_mfma_f32_16x16x32_bf16 a[80:83], v[88:91], v[64:67], a[80:83]
v_mfma_f32_16x16x32_bf16 a[84:87], v[88:91], v[68:71], a[84:87]
v_mfma_f32_16x16x32_bf16 a[88:91], v[88:91], v[72:75], a[88:91]
v_mfma_f32_16x16x32_bf16 a[92:95], v[88:91], v[76:79], a[92:95]
v_mfma_f32_16x16x32_bf16 a[96:99], v[92:95], v[48:51], a[96:99]
v_mfma_f32_16x16x32_bf16 a[100:103], v[92:95], v[52:55], a[100:103]
v_mfma_f32_16x16x32_bf16 a[104:107], v[92:95], v[56:59], a[104:107]
v_mfma_f32_16x16x32_bf16 a[108:111], v[92:95], v[60:63], a[108:111]
v_mfma_f32_16x16x32_bf16 a[112:115], v[92:95], v[64:67], a[112:115]
v_mfma_f32_16x16x32_bf16 a[116:119], v[92:95], v[68:71], a[116:119]
v_mfma_f32_16x16x32_bf16 a[120:123], v[92:95], v[72:75], a[120:123]
v_mfma_f32_16x16x32_bf16 a[124:127], v[92:95], v[76:79], a[124:127]
s_cmp_lg_u32 s62, -4
s_cbranch_scc1 main_kernel_w_gemm
s_branch main_kernel_w_slow
main_kernel_w_c1_v_ev:
s_mov_b32 s55, 1
s_cmp_eq_u32 s56, 0
s_cbranch_scc1 main_kernel_w_c1_v_et
s_bfm_b64 exec, s0, 0
buffer_store_dword v244, v248, s[4:7], s59 offen sc1
s_mov_b64 exec, -1
s_mov_b32 s56, 0
main_kernel_w_c1_v_et:
s_cmp_lg_u32 s18, 1
s_cbranch_scc1 main_kernel_w_c1_v_loop
s_lshl_b32 s32, s27, 8
s_add_u32 s32, s32, 0x841e000
s_mov_b64 exec, 1
v_mov_b32 v249, 1
buffer_atomic_add v249, off, s[4:7], s32 sc0 sc1
s_mov_b64 exec, -1
s_branch main_kernel_w_c1_v_loop
main_kernel_w_epn:
s_waitcnt lgkmcnt(0)
s_branch main_kernel_w_epw
main_kernel_w_slow:
s_mov_b32 s58, -1
main_kernel_w_epw:
s_nop 5
main_kernel_w_epi:
s_cmp_eq_u32 s56, 2
s_cbranch_scc1 main_kernel_w_e2
s_cmp_eq_u32 s56, 3
s_cbranch_scc1 main_kernel_w_e3
s_cmp_eq_u32 s56, 4
s_cbranch_scc1 main_kernel_w_e4
s_cmp_eq_u32 s56, 5
s_cbranch_scc1 main_kernel_w_e5
s_cmp_eq_u32 s56, 6
s_cbranch_scc1 main_kernel_w_e6
s_cmp_eq_u32 s56, 7
s_cbranch_scc1 main_kernel_w_e7
s_cmp_eq_u32 s56, 8
s_cbranch_scc1 main_kernel_w_e8
s_cmp_eq_u32 s56, 9
s_cbranch_scc1 main_kernel_w_e9
s_cmp_eq_u32 s56, 10
s_cbranch_scc1 main_kernel_w_e10
main_kernel_w_e1:
s_mov_b32 s53, s1
v_mul_f32 v64, 0x3e0293ee, v64
v_mul_f32 v65, 0x3e0293ee, v65
v_mul_f32 v66, 0x3e0293ee, v66
v_mul_f32 v67, 0x3e0293ee, v67
v_mul_f32 v68, 0x3e0293ee, v68
v_mul_f32 v69, 0x3e0293ee, v69
v_mul_f32 v70, 0x3e0293ee, v70
v_mul_f32 v71, 0x3e0293ee, v71
v_cvt_pk_bf16_f32 v16, v64, v65
v_cvt_pk_bf16_f32 v17, v66, v67
v_cvt_pk_bf16_f32 v18, v68, v69
v_cvt_pk_bf16_f32 v19, v70, v71
buffer_store_dwordx4 v[16:19], v251, s[4:7], s53 offen offset:0 sc1
v_mul_f32 v72, 0x3e0293ee, v72
v_mul_f32 v73, 0x3e0293ee, v73
v_mul_f32 v74, 0x3e0293ee, v74
v_mul_f32 v75, 0x3e0293ee, v75
v_mul_f32 v76, 0x3e0293ee, v76
v_mul_f32 v77, 0x3e0293ee, v77
v_mul_f32 v78, 0x3e0293ee, v78
v_mul_f32 v79, 0x3e0293ee, v79
v_cvt_pk_bf16_f32 v36, v72, v73
v_cvt_pk_bf16_f32 v37, v74, v75
v_cvt_pk_bf16_f32 v38, v76, v77
v_cvt_pk_bf16_f32 v39, v78, v79
buffer_store_dwordx4 v[36:39], v251, s[4:7], s53 offen offset:1024 sc1
s_add_u32 s53, s53, s2
v_mul_f32 v80, 0x3e0293ee, v80
v_mul_f32 v81, 0x3e0293ee, v81
v_mul_f32 v82, 0x3e0293ee, v82
v_mul_f32 v83, 0x3e0293ee, v83
v_mul_f32 v84, 0x3e0293ee, v84
v_mul_f32 v85, 0x3e0293ee, v85
v_mul_f32 v86, 0x3e0293ee, v86
v_mul_f32 v87, 0x3e0293ee, v87
v_cvt_pk_bf16_f32 v56, v80, v81
v_cvt_pk_bf16_f32 v57, v82, v83
v_cvt_pk_bf16_f32 v58, v84, v85
v_cvt_pk_bf16_f32 v59, v86, v87
buffer_store_dwordx4 v[56:59], v251, s[4:7], s53 offen offset:0 sc1
v_mul_f32 v88, 0x3e0293ee, v88
v_mul_f32 v89, 0x3e0293ee, v89
v_mul_f32 v90, 0x3e0293ee, v90
v_mul_f32 v91, 0x3e0293ee, v91
v_mul_f32 v92, 0x3e0293ee, v92
v_mul_f32 v93, 0x3e0293ee, v93
v_mul_f32 v94, 0x3e0293ee, v94
v_mul_f32 v95, 0x3e0293ee, v95
v_cvt_pk_bf16_f32 v16, v88, v89
v_cvt_pk_bf16_f32 v17, v90, v91
v_cvt_pk_bf16_f32 v18, v92, v93
v_cvt_pk_bf16_f32 v19, v94, v95
buffer_store_dwordx4 v[16:19], v251, s[4:7], s53 offen offset:1024 sc1
s_add_u32 s53, s53, s2
v_mul_f32 v96, 0x3e0293ee, v96
v_mul_f32 v97, 0x3e0293ee, v97
v_mul_f32 v98, 0x3e0293ee, v98
v_mul_f32 v99, 0x3e0293ee, v99
v_mul_f32 v100, 0x3e0293ee, v100
v_mul_f32 v101, 0x3e0293ee, v101
v_mul_f32 v102, 0x3e0293ee, v102
v_mul_f32 v103, 0x3e0293ee, v103
v_cvt_pk_bf16_f32 v36, v96, v97
v_cvt_pk_bf16_f32 v37, v98, v99
v_cvt_pk_bf16_f32 v38, v100, v101
v_cvt_pk_bf16_f32 v39, v102, v103
buffer_store_dwordx4 v[36:39], v251, s[4:7], s53 offen offset:0 sc1
v_mul_f32 v104, 0x3e0293ee, v104
v_mul_f32 v105, 0x3e0293ee, v105
v_mul_f32 v106, 0x3e0293ee, v106
v_mul_f32 v107, 0x3e0293ee, v107
v_mul_f32 v108, 0x3e0293ee, v108
v_mul_f32 v109, 0x3e0293ee, v109
v_mul_f32 v110, 0x3e0293ee, v110
v_mul_f32 v111, 0x3e0293ee, v111
v_cvt_pk_bf16_f32 v56, v104, v105
v_cvt_pk_bf16_f32 v57, v106, v107
v_cvt_pk_bf16_f32 v58, v108, v109
v_cvt_pk_bf16_f32 v59, v110, v111
buffer_store_dwordx4 v[56:59], v251, s[4:7], s53 offen offset:1024 sc1
s_add_u32 s53, s53, s2
v_mul_f32 v112, 0x3e0293ee, v112
v_mul_f32 v113, 0x3e0293ee, v113
v_mul_f32 v114, 0x3e0293ee, v114
v_mul_f32 v115, 0x3e0293ee, v115
v_mul_f32 v116, 0x3e0293ee, v116
v_mul_f32 v117, 0x3e0293ee, v117
v_mul_f32 v118, 0x3e0293ee, v118
v_mul_f32 v119, 0x3e0293ee, v119
v_cvt_pk_bf16_f32 v16, v112, v113
v_cvt_pk_bf16_f32 v17, v114, v115
v_cvt_pk_bf16_f32 v18, v116, v117
v_cvt_pk_bf16_f32 v19, v118, v119
buffer_store_dwordx4 v[16:19], v251, s[4:7], s53 offen offset:0 sc1
v_mul_f32 v120, 0x3e0293ee, v120
v_mul_f32 v121, 0x3e0293ee, v121
v_mul_f32 v122, 0x3e0293ee, v122
v_mul_f32 v123, 0x3e0293ee, v123
v_mul_f32 v124, 0x3e0293ee, v124
v_mul_f32 v125, 0x3e0293ee, v125
v_mul_f32 v126, 0x3e0293ee, v126
v_mul_f32 v127, 0x3e0293ee, v127
v_cvt_pk_bf16_f32 v36, v120, v121
v_cvt_pk_bf16_f32 v37, v122, v123
v_cvt_pk_bf16_f32 v38, v124, v125
v_cvt_pk_bf16_f32 v39, v126, v127
buffer_store_dwordx4 v[36:39], v251, s[4:7], s53 offen offset:1024 sc1
s_branch main_kernel_w_ee
main_kernel_w_e2:
s_mov_b32 s53, s1
v_cvt_pk_bf16_f32 v8, v64, v65
v_cvt_pk_bf16_f32 v9, v66, v67
v_cvt_pk_bf16_f32 v10, v80, v81
v_cvt_pk_bf16_f32 v11, v82, v83
buffer_store_dwordx4 v[8:11], v251, s[4:7], s53 offen offset:0 sc1
v_cvt_pk_bf16_f32 v24, v68, v69
v_cvt_pk_bf16_f32 v25, v70, v71
v_cvt_pk_bf16_f32 v26, v84, v85
v_cvt_pk_bf16_f32 v27, v86, v87
buffer_store_dwordx4 v[24:27], v251, s[4:7], s53 offen offset:1024 sc1
v_cvt_pk_bf16_f32 v40, v72, v73
v_cvt_pk_bf16_f32 v41, v74, v75
v_cvt_pk_bf16_f32 v42, v88, v89
v_cvt_pk_bf16_f32 v43, v90, v91
buffer_store_dwordx4 v[40:43], v251, s[4:7], s53 offen offset:2048 sc1
v_cvt_pk_bf16_f32 v56, v76, v77
v_cvt_pk_bf16_f32 v57, v78, v79
v_cvt_pk_bf16_f32 v58, v92, v93
v_cvt_pk_bf16_f32 v59, v94, v95
buffer_store_dwordx4 v[56:59], v251, s[4:7], s53 offen offset:3072 sc1
s_add_u32 s53, s53, 262144
v_cvt_pk_bf16_f32 v8, v96, v97
v_cvt_pk_bf16_f32 v9, v98, v99
v_cvt_pk_bf16_f32 v10, v112, v113
v_cvt_pk_bf16_f32 v11, v114, v115
buffer_store_dwordx4 v[8:11], v251, s[4:7], s53 offen offset:0 sc1
v_cvt_pk_bf16_f32 v24, v100, v101
v_cvt_pk_bf16_f32 v25, v102, v103
v_cvt_pk_bf16_f32 v26, v116, v117
v_cvt_pk_bf16_f32 v27, v118, v119
buffer_store_dwordx4 v[24:27], v251, s[4:7], s53 offen offset:1024 sc1
v_cvt_pk_bf16_f32 v40, v104, v105
v_cvt_pk_bf16_f32 v41, v106, v107
v_cvt_pk_bf16_f32 v42, v120, v121
v_cvt_pk_bf16_f32 v43, v122, v123
buffer_store_dwordx4 v[40:43], v251, s[4:7], s53 offen offset:2048 sc1
v_cvt_pk_bf16_f32 v56, v108, v109
v_cvt_pk_bf16_f32 v57, v110, v111
v_cvt_pk_bf16_f32 v58, v124, v125
v_cvt_pk_bf16_f32 v59, v126, v127
buffer_store_dwordx4 v[56:59], v251, s[4:7], s53 offen offset:3072 sc1
s_add_u32 s53, s53, 262144
s_branch main_kernel_w_ee
main_kernel_w_e3:
s_mov_b32 s53, s1
v_lshlrev_b32 v8, 16, v192
v_and_b32 v9, 0xffff0000, v192
v_lshlrev_b32 v10, 16, v193
v_and_b32 v11, 0xffff0000, v193
v_lshlrev_b32 v12, 16, v194
v_and_b32 v13, 0xffff0000, v194
v_lshlrev_b32 v14, 16, v195
v_and_b32 v15, 0xffff0000, v195
v_pk_add_f32 v[64:65], v[64:65], v[8:9]
v_pk_add_f32 v[66:67], v[66:67], v[10:11]
v_pk_add_f32 v[68:69], v[68:69], v[12:13]
v_pk_add_f32 v[70:71], v[70:71], v[14:15]
v_cvt_pk_bf16_f32 v16, v64, v65
v_cvt_pk_bf16_f32 v17, v66, v67
v_cvt_pk_bf16_f32 v18, v68, v69
v_cvt_pk_bf16_f32 v19, v70, v71
buffer_store_dwordx4 v[16:19], v251, s[4:7], s53 offen offset:0 sc1
v_lshlrev_b32 v28, 16, v196
v_and_b32 v29, 0xffff0000, v196
v_lshlrev_b32 v30, 16, v197
v_and_b32 v31, 0xffff0000, v197
v_lshlrev_b32 v32, 16, v198
v_and_b32 v33, 0xffff0000, v198
v_lshlrev_b32 v34, 16, v199
v_and_b32 v35, 0xffff0000, v199
v_pk_add_f32 v[72:73], v[72:73], v[28:29]
v_pk_add_f32 v[74:75], v[74:75], v[30:31]
v_pk_add_f32 v[76:77], v[76:77], v[32:33]
v_pk_add_f32 v[78:79], v[78:79], v[34:35]
v_cvt_pk_bf16_f32 v36, v72, v73
v_cvt_pk_bf16_f32 v37, v74, v75
v_cvt_pk_bf16_f32 v38, v76, v77
v_cvt_pk_bf16_f32 v39, v78, v79
buffer_store_dwordx4 v[36:39], v251, s[4:7], s53 offen offset:1024 sc1
s_add_u32 s53, s53, s2
v_lshlrev_b32 v48, 16, v200
v_and_b32 v49, 0xffff0000, v200
v_lshlrev_b32 v50, 16, v201
v_and_b32 v51, 0xffff0000, v201
v_lshlrev_b32 v52, 16, v202
v_and_b32 v53, 0xffff0000, v202
v_lshlrev_b32 v54, 16, v203
v_and_b32 v55, 0xffff0000, v203
v_pk_add_f32 v[80:81], v[80:81], v[48:49]
v_pk_add_f32 v[82:83], v[82:83], v[50:51]
v_pk_add_f32 v[84:85], v[84:85], v[52:53]
v_pk_add_f32 v[86:87], v[86:87], v[54:55]
v_cvt_pk_bf16_f32 v56, v80, v81
v_cvt_pk_bf16_f32 v57, v82, v83
v_cvt_pk_bf16_f32 v58, v84, v85
v_cvt_pk_bf16_f32 v59, v86, v87
buffer_store_dwordx4 v[56:59], v251, s[4:7], s53 offen offset:0 sc1
v_lshlrev_b32 v8, 16, v204
v_and_b32 v9, 0xffff0000, v204
v_lshlrev_b32 v10, 16, v205
v_and_b32 v11, 0xffff0000, v205
v_lshlrev_b32 v12, 16, v206
v_and_b32 v13, 0xffff0000, v206
v_lshlrev_b32 v14, 16, v207
v_and_b32 v15, 0xffff0000, v207
v_pk_add_f32 v[88:89], v[88:89], v[8:9]
v_pk_add_f32 v[90:91], v[90:91], v[10:11]
v_pk_add_f32 v[92:93], v[92:93], v[12:13]
v_pk_add_f32 v[94:95], v[94:95], v[14:15]
v_cvt_pk_bf16_f32 v16, v88, v89
v_cvt_pk_bf16_f32 v17, v90, v91
v_cvt_pk_bf16_f32 v18, v92, v93
v_cvt_pk_bf16_f32 v19, v94, v95
buffer_store_dwordx4 v[16:19], v251, s[4:7], s53 offen offset:1024 sc1
s_add_u32 s53, s53, s2
v_lshlrev_b32 v28, 16, v208
v_and_b32 v29, 0xffff0000, v208
v_lshlrev_b32 v30, 16, v209
v_and_b32 v31, 0xffff0000, v209
v_lshlrev_b32 v32, 16, v210
v_and_b32 v33, 0xffff0000, v210
v_lshlrev_b32 v34, 16, v211
v_and_b32 v35, 0xffff0000, v211
v_pk_add_f32 v[96:97], v[96:97], v[28:29]
v_pk_add_f32 v[98:99], v[98:99], v[30:31]
v_pk_add_f32 v[100:101], v[100:101], v[32:33]
v_pk_add_f32 v[102:103], v[102:103], v[34:35]
v_cvt_pk_bf16_f32 v36, v96, v97
v_cvt_pk_bf16_f32 v37, v98, v99
v_cvt_pk_bf16_f32 v38, v100, v101
v_cvt_pk_bf16_f32 v39, v102, v103
buffer_store_dwordx4 v[36:39], v251, s[4:7], s53 offen offset:0 sc1
v_lshlrev_b32 v48, 16, v212
v_and_b32 v49, 0xffff0000, v212
v_lshlrev_b32 v50, 16, v213
v_and_b32 v51, 0xffff0000, v213
v_lshlrev_b32 v52, 16, v214
v_and_b32 v53, 0xffff0000, v214
v_lshlrev_b32 v54, 16, v215
v_and_b32 v55, 0xffff0000, v215
v_pk_add_f32 v[104:105], v[104:105], v[48:49]
v_pk_add_f32 v[106:107], v[106:107], v[50:51]
v_pk_add_f32 v[108:109], v[108:109], v[52:53]
v_pk_add_f32 v[110:111], v[110:111], v[54:55]
v_cvt_pk_bf16_f32 v56, v104, v105
v_cvt_pk_bf16_f32 v57, v106, v107
v_cvt_pk_bf16_f32 v58, v108, v109
v_cvt_pk_bf16_f32 v59, v110, v111
buffer_store_dwordx4 v[56:59], v251, s[4:7], s53 offen offset:1024 sc1
s_add_u32 s53, s53, s2
v_lshlrev_b32 v8, 16, v216
v_and_b32 v9, 0xffff0000, v216
v_lshlrev_b32 v10, 16, v217
v_and_b32 v11, 0xffff0000, v217
v_lshlrev_b32 v12, 16, v218
v_and_b32 v13, 0xffff0000, v218
v_lshlrev_b32 v14, 16, v219
v_and_b32 v15, 0xffff0000, v219
v_pk_add_f32 v[112:113], v[112:113], v[8:9]
v_pk_add_f32 v[114:115], v[114:115], v[10:11]
v_pk_add_f32 v[116:117], v[116:117], v[12:13]
v_pk_add_f32 v[118:119], v[118:119], v[14:15]
v_cvt_pk_bf16_f32 v16, v112, v113
v_cvt_pk_bf16_f32 v17, v114, v115
v_cvt_pk_bf16_f32 v18, v116, v117
v_cvt_pk_bf16_f32 v19, v118, v119
buffer_store_dwordx4 v[16:19], v251, s[4:7], s53 offen offset:0 sc1
v_lshlrev_b32 v28, 16, v220
v_and_b32 v29, 0xffff0000, v220
v_lshlrev_b32 v30, 16, v221
v_and_b32 v31, 0xffff0000, v221
v_lshlrev_b32 v32, 16, v222
v_and_b32 v33, 0xffff0000, v222
v_lshlrev_b32 v34, 16, v223
v_and_b32 v35, 0xffff0000, v223
v_pk_add_f32 v[120:121], v[120:121], v[28:29]
v_pk_add_f32 v[122:123], v[122:123], v[30:31]
v_pk_add_f32 v[124:125], v[124:125], v[32:33]
v_pk_add_f32 v[126:127], v[126:127], v[34:35]
v_cvt_pk_bf16_f32 v36, v120, v121
v_cvt_pk_bf16_f32 v37, v122, v123
v_cvt_pk_bf16_f32 v38, v124, v125
v_cvt_pk_bf16_f32 v39, v126, v127
buffer_store_dwordx4 v[36:39], v251, s[4:7], s53 offen offset:1024 sc1
s_branch main_kernel_w_ee
main_kernel_w_e4:
s_mov_b32 s53, s1
v_lshlrev_b32 v8, 16, v192
v_and_b32 v9, 0xffff0000, v192
v_lshlrev_b32 v10, 16, v193
v_and_b32 v11, 0xffff0000, v193
v_lshlrev_b32 v12, 16, v194
v_and_b32 v13, 0xffff0000, v194
v_lshlrev_b32 v14, 16, v195
v_and_b32 v15, 0xffff0000, v195
v_pk_add_f32 v[64:65], v[64:65], v[8:9]
v_pk_add_f32 v[66:67], v[66:67], v[10:11]
v_pk_add_f32 v[68:69], v[68:69], v[12:13]
v_pk_add_f32 v[70:71], v[70:71], v[14:15]
v_pk_mul_f32 v[8:9], v[64:65], v[246:247]
v_pk_mul_f32 v[10:11], v[66:67], v[246:247]
v_pk_mul_f32 v[12:13], v[68:69], v[246:247]
v_pk_mul_f32 v[14:15], v[70:71], v[246:247]
v_exp_f32 v8, v8
v_exp_f32 v9, v9
v_exp_f32 v10, v10
v_exp_f32 v11, v11
v_exp_f32 v12, v12
v_exp_f32 v13, v13
v_exp_f32 v14, v14
v_exp_f32 v15, v15
v_pk_add_f32 v[8:9], v[8:9], v[244:245]
v_pk_add_f32 v[10:11], v[10:11], v[244:245]
v_pk_add_f32 v[12:13], v[12:13], v[244:245]
v_pk_add_f32 v[14:15], v[14:15], v[244:245]
v_rcp_f32 v8, v8
v_rcp_f32 v9, v9
v_rcp_f32 v10, v10
v_rcp_f32 v11, v11
v_rcp_f32 v12, v12
v_rcp_f32 v13, v13
v_rcp_f32 v14, v14
v_rcp_f32 v15, v15
v_pk_mul_f32 v[64:65], v[8:9], v[64:65]
v_pk_mul_f32 v[66:67], v[10:11], v[66:67]
v_pk_mul_f32 v[68:69], v[12:13], v[68:69]
v_pk_mul_f32 v[70:71], v[14:15], v[70:71]
v_cvt_pk_bf16_f32 v16, v64, v65
v_cvt_pk_bf16_f32 v17, v66, v67
v_cvt_pk_bf16_f32 v18, v68, v69
v_cvt_pk_bf16_f32 v19, v70, v71
buffer_store_dwordx4 v[16:19], v251, s[4:7], s53 offen offset:0 sc1
v_lshlrev_b32 v28, 16, v196
v_and_b32 v29, 0xffff0000, v196
v_lshlrev_b32 v30, 16, v197
v_and_b32 v31, 0xffff0000, v197
v_lshlrev_b32 v32, 16, v198
v_and_b32 v33, 0xffff0000, v198
v_lshlrev_b32 v34, 16, v199
v_and_b32 v35, 0xffff0000, v199
v_pk_add_f32 v[72:73], v[72:73], v[28:29]
v_pk_add_f32 v[74:75], v[74:75], v[30:31]
v_pk_add_f32 v[76:77], v[76:77], v[32:33]
v_pk_add_f32 v[78:79], v[78:79], v[34:35]
v_pk_mul_f32 v[28:29], v[72:73], v[246:247]
v_pk_mul_f32 v[30:31], v[74:75], v[246:247]
v_pk_mul_f32 v[32:33], v[76:77], v[246:247]
v_pk_mul_f32 v[34:35], v[78:79], v[246:247]
v_exp_f32 v28, v28
v_exp_f32 v29, v29
v_exp_f32 v30, v30
v_exp_f32 v31, v31
v_exp_f32 v32, v32
v_exp_f32 v33, v33
v_exp_f32 v34, v34
v_exp_f32 v35, v35
v_pk_add_f32 v[28:29], v[28:29], v[244:245]
v_pk_add_f32 v[30:31], v[30:31], v[244:245]
v_pk_add_f32 v[32:33], v[32:33], v[244:245]
v_pk_add_f32 v[34:35], v[34:35], v[244:245]
v_rcp_f32 v28, v28
v_rcp_f32 v29, v29
v_rcp_f32 v30, v30
v_rcp_f32 v31, v31
v_rcp_f32 v32, v32
v_rcp_f32 v33, v33
v_rcp_f32 v34, v34
v_rcp_f32 v35, v35
v_pk_mul_f32 v[72:73], v[28:29], v[72:73]
v_pk_mul_f32 v[74:75], v[30:31], v[74:75]
v_pk_mul_f32 v[76:77], v[32:33], v[76:77]
v_pk_mul_f32 v[78:79], v[34:35], v[78:79]
v_cvt_pk_bf16_f32 v36, v72, v73
v_cvt_pk_bf16_f32 v37, v74, v75
v_cvt_pk_bf16_f32 v38, v76, v77
v_cvt_pk_bf16_f32 v39, v78, v79
buffer_store_dwordx4 v[36:39], v251, s[4:7], s53 offen offset:1024 sc1
s_add_u32 s53, s53, s2
v_lshlrev_b32 v48, 16, v200
v_and_b32 v49, 0xffff0000, v200
v_lshlrev_b32 v50, 16, v201
v_and_b32 v51, 0xffff0000, v201
v_lshlrev_b32 v52, 16, v202
v_and_b32 v53, 0xffff0000, v202
v_lshlrev_b32 v54, 16, v203
v_and_b32 v55, 0xffff0000, v203
v_pk_add_f32 v[80:81], v[80:81], v[48:49]
v_pk_add_f32 v[82:83], v[82:83], v[50:51]
v_pk_add_f32 v[84:85], v[84:85], v[52:53]
v_pk_add_f32 v[86:87], v[86:87], v[54:55]
v_pk_mul_f32 v[48:49], v[80:81], v[246:247]
v_pk_mul_f32 v[50:51], v[82:83], v[246:247]
v_pk_mul_f32 v[52:53], v[84:85], v[246:247]
v_pk_mul_f32 v[54:55], v[86:87], v[246:247]
v_exp_f32 v48, v48
v_exp_f32 v49, v49
v_exp_f32 v50, v50
v_exp_f32 v51, v51
v_exp_f32 v52, v52
v_exp_f32 v53, v53
v_exp_f32 v54, v54
v_exp_f32 v55, v55
v_pk_add_f32 v[48:49], v[48:49], v[244:245]
v_pk_add_f32 v[50:51], v[50:51], v[244:245]
v_pk_add_f32 v[52:53], v[52:53], v[244:245]
v_pk_add_f32 v[54:55], v[54:55], v[244:245]
v_rcp_f32 v48, v48
v_rcp_f32 v49, v49
v_rcp_f32 v50, v50
v_rcp_f32 v51, v51
v_rcp_f32 v52, v52
v_rcp_f32 v53, v53
v_rcp_f32 v54, v54
v_rcp_f32 v55, v55
v_pk_mul_f32 v[80:81], v[48:49], v[80:81]
v_pk_mul_f32 v[82:83], v[50:51], v[82:83]
v_pk_mul_f32 v[84:85], v[52:53], v[84:85]
v_pk_mul_f32 v[86:87], v[54:55], v[86:87]
v_cvt_pk_bf16_f32 v56, v80, v81
v_cvt_pk_bf16_f32 v57, v82, v83
v_cvt_pk_bf16_f32 v58, v84, v85
v_cvt_pk_bf16_f32 v59, v86, v87
buffer_store_dwordx4 v[56:59], v251, s[4:7], s53 offen offset:0 sc1
v_lshlrev_b32 v8, 16, v204
v_and_b32 v9, 0xffff0000, v204
v_lshlrev_b32 v10, 16, v205
v_and_b32 v11, 0xffff0000, v205
v_lshlrev_b32 v12, 16, v206
v_and_b32 v13, 0xffff0000, v206
v_lshlrev_b32 v14, 16, v207
v_and_b32 v15, 0xffff0000, v207
v_pk_add_f32 v[88:89], v[88:89], v[8:9]
v_pk_add_f32 v[90:91], v[90:91], v[10:11]
v_pk_add_f32 v[92:93], v[92:93], v[12:13]
v_pk_add_f32 v[94:95], v[94:95], v[14:15]
v_pk_mul_f32 v[8:9], v[88:89], v[246:247]
v_pk_mul_f32 v[10:11], v[90:91], v[246:247]
v_pk_mul_f32 v[12:13], v[92:93], v[246:247]
v_pk_mul_f32 v[14:15], v[94:95], v[246:247]
v_exp_f32 v8, v8
v_exp_f32 v9, v9
v_exp_f32 v10, v10
v_exp_f32 v11, v11
v_exp_f32 v12, v12
v_exp_f32 v13, v13
v_exp_f32 v14, v14
v_exp_f32 v15, v15
v_pk_add_f32 v[8:9], v[8:9], v[244:245]
v_pk_add_f32 v[10:11], v[10:11], v[244:245]
v_pk_add_f32 v[12:13], v[12:13], v[244:245]
v_pk_add_f32 v[14:15], v[14:15], v[244:245]
v_rcp_f32 v8, v8
v_rcp_f32 v9, v9
v_rcp_f32 v10, v10
v_rcp_f32 v11, v11
v_rcp_f32 v12, v12
v_rcp_f32 v13, v13
v_rcp_f32 v14, v14
v_rcp_f32 v15, v15
v_pk_mul_f32 v[88:89], v[8:9], v[88:89]
v_pk_mul_f32 v[90:91], v[10:11], v[90:91]
v_pk_mul_f32 v[92:93], v[12:13], v[92:93]
v_pk_mul_f32 v[94:95], v[14:15], v[94:95]
v_cvt_pk_bf16_f32 v16, v88, v89
v_cvt_pk_bf16_f32 v17, v90, v91
v_cvt_pk_bf16_f32 v18, v92, v93
v_cvt_pk_bf16_f32 v19, v94, v95
buffer_store_dwordx4 v[16:19], v251, s[4:7], s53 offen offset:1024 sc1
s_add_u32 s53, s53, s2
v_lshlrev_b32 v28, 16, v208
v_and_b32 v29, 0xffff0000, v208
v_lshlrev_b32 v30, 16, v209
v_and_b32 v31, 0xffff0000, v209
v_lshlrev_b32 v32, 16, v210
v_and_b32 v33, 0xffff0000, v210
v_lshlrev_b32 v34, 16, v211
v_and_b32 v35, 0xffff0000, v211
v_pk_add_f32 v[96:97], v[96:97], v[28:29]
v_pk_add_f32 v[98:99], v[98:99], v[30:31]
v_pk_add_f32 v[100:101], v[100:101], v[32:33]
v_pk_add_f32 v[102:103], v[102:103], v[34:35]
v_pk_mul_f32 v[28:29], v[96:97], v[246:247]
v_pk_mul_f32 v[30:31], v[98:99], v[246:247]
v_pk_mul_f32 v[32:33], v[100:101], v[246:247]
v_pk_mul_f32 v[34:35], v[102:103], v[246:247]
v_exp_f32 v28, v28
v_exp_f32 v29, v29
v_exp_f32 v30, v30
v_exp_f32 v31, v31
v_exp_f32 v32, v32
v_exp_f32 v33, v33
v_exp_f32 v34, v34
v_exp_f32 v35, v35
v_pk_add_f32 v[28:29], v[28:29], v[244:245]
v_pk_add_f32 v[30:31], v[30:31], v[244:245]
v_pk_add_f32 v[32:33], v[32:33], v[244:245]
v_pk_add_f32 v[34:35], v[34:35], v[244:245]
v_rcp_f32 v28, v28
v_rcp_f32 v29, v29
v_rcp_f32 v30, v30
v_rcp_f32 v31, v31
v_rcp_f32 v32, v32
v_rcp_f32 v33, v33
v_rcp_f32 v34, v34
v_rcp_f32 v35, v35
v_pk_mul_f32 v[96:97], v[28:29], v[96:97]
v_pk_mul_f32 v[98:99], v[30:31], v[98:99]
v_pk_mul_f32 v[100:101], v[32:33], v[100:101]
v_pk_mul_f32 v[102:103], v[34:35], v[102:103]
v_cvt_pk_bf16_f32 v36, v96, v97
v_cvt_pk_bf16_f32 v37, v98, v99
v_cvt_pk_bf16_f32 v38, v100, v101
v_cvt_pk_bf16_f32 v39, v102, v103
buffer_store_dwordx4 v[36:39], v251, s[4:7], s53 offen offset:0 sc1
v_lshlrev_b32 v48, 16, v212
v_and_b32 v49, 0xffff0000, v212
v_lshlrev_b32 v50, 16, v213
v_and_b32 v51, 0xffff0000, v213
v_lshlrev_b32 v52, 16, v214
v_and_b32 v53, 0xffff0000, v214
v_lshlrev_b32 v54, 16, v215
v_and_b32 v55, 0xffff0000, v215
v_pk_add_f32 v[104:105], v[104:105], v[48:49]
v_pk_add_f32 v[106:107], v[106:107], v[50:51]
v_pk_add_f32 v[108:109], v[108:109], v[52:53]
v_pk_add_f32 v[110:111], v[110:111], v[54:55]
v_pk_mul_f32 v[48:49], v[104:105], v[246:247]
v_pk_mul_f32 v[50:51], v[106:107], v[246:247]
v_pk_mul_f32 v[52:53], v[108:109], v[246:247]
v_pk_mul_f32 v[54:55], v[110:111], v[246:247]
v_exp_f32 v48, v48
v_exp_f32 v49, v49
v_exp_f32 v50, v50
v_exp_f32 v51, v51
v_exp_f32 v52, v52
v_exp_f32 v53, v53
v_exp_f32 v54, v54
v_exp_f32 v55, v55
v_pk_add_f32 v[48:49], v[48:49], v[244:245]
v_pk_add_f32 v[50:51], v[50:51], v[244:245]
v_pk_add_f32 v[52:53], v[52:53], v[244:245]
v_pk_add_f32 v[54:55], v[54:55], v[244:245]
v_rcp_f32 v48, v48
v_rcp_f32 v49, v49
v_rcp_f32 v50, v50
v_rcp_f32 v51, v51
v_rcp_f32 v52, v52
v_rcp_f32 v53, v53
v_rcp_f32 v54, v54
v_rcp_f32 v55, v55
v_pk_mul_f32 v[104:105], v[48:49], v[104:105]
v_pk_mul_f32 v[106:107], v[50:51], v[106:107]
v_pk_mul_f32 v[108:109], v[52:53], v[108:109]
v_pk_mul_f32 v[110:111], v[54:55], v[110:111]
v_cvt_pk_bf16_f32 v56, v104, v105
v_cvt_pk_bf16_f32 v57, v106, v107
v_cvt_pk_bf16_f32 v58, v108, v109
v_cvt_pk_bf16_f32 v59, v110, v111
buffer_store_dwordx4 v[56:59], v251, s[4:7], s53 offen offset:1024 sc1
s_add_u32 s53, s53, s2
v_lshlrev_b32 v8, 16, v216
v_and_b32 v9, 0xffff0000, v216
v_lshlrev_b32 v10, 16, v217
v_and_b32 v11, 0xffff0000, v217
v_lshlrev_b32 v12, 16, v218
v_and_b32 v13, 0xffff0000, v218
v_lshlrev_b32 v14, 16, v219
v_and_b32 v15, 0xffff0000, v219
v_pk_add_f32 v[112:113], v[112:113], v[8:9]
v_pk_add_f32 v[114:115], v[114:115], v[10:11]
v_pk_add_f32 v[116:117], v[116:117], v[12:13]
v_pk_add_f32 v[118:119], v[118:119], v[14:15]
v_pk_mul_f32 v[8:9], v[112:113], v[246:247]
v_pk_mul_f32 v[10:11], v[114:115], v[246:247]
v_pk_mul_f32 v[12:13], v[116:117], v[246:247]
v_pk_mul_f32 v[14:15], v[118:119], v[246:247]
v_exp_f32 v8, v8
v_exp_f32 v9, v9
v_exp_f32 v10, v10
v_exp_f32 v11, v11
v_exp_f32 v12, v12
v_exp_f32 v13, v13
v_exp_f32 v14, v14
v_exp_f32 v15, v15
v_pk_add_f32 v[8:9], v[8:9], v[244:245]
v_pk_add_f32 v[10:11], v[10:11], v[244:245]
v_pk_add_f32 v[12:13], v[12:13], v[244:245]
v_pk_add_f32 v[14:15], v[14:15], v[244:245]
v_rcp_f32 v8, v8
v_rcp_f32 v9, v9
v_rcp_f32 v10, v10
v_rcp_f32 v11, v11
v_rcp_f32 v12, v12
v_rcp_f32 v13, v13
v_rcp_f32 v14, v14
v_rcp_f32 v15, v15
v_pk_mul_f32 v[112:113], v[8:9], v[112:113]
v_pk_mul_f32 v[114:115], v[10:11], v[114:115]
v_pk_mul_f32 v[116:117], v[12:13], v[116:117]
v_pk_mul_f32 v[118:119], v[14:15], v[118:119]
v_cvt_pk_bf16_f32 v16, v112, v113
v_cvt_pk_bf16_f32 v17, v114, v115
v_cvt_pk_bf16_f32 v18, v116, v117
v_cvt_pk_bf16_f32 v19, v118, v119
buffer_store_dwordx4 v[16:19], v251, s[4:7], s53 offen offset:0 sc1
v_lshlrev_b32 v28, 16, v220
v_and_b32 v29, 0xffff0000, v220
v_lshlrev_b32 v30, 16, v221
v_and_b32 v31, 0xffff0000, v221
v_lshlrev_b32 v32, 16, v222
v_and_b32 v33, 0xffff0000, v222
v_lshlrev_b32 v34, 16, v223
v_and_b32 v35, 0xffff0000, v223
v_pk_add_f32 v[120:121], v[120:121], v[28:29]
v_pk_add_f32 v[122:123], v[122:123], v[30:31]
v_pk_add_f32 v[124:125], v[124:125], v[32:33]
v_pk_add_f32 v[126:127], v[126:127], v[34:35]
v_pk_mul_f32 v[28:29], v[120:121], v[246:247]
v_pk_mul_f32 v[30:31], v[122:123], v[246:247]
v_pk_mul_f32 v[32:33], v[124:125], v[246:247]
v_pk_mul_f32 v[34:35], v[126:127], v[246:247]
v_exp_f32 v28, v28
v_exp_f32 v29, v29
v_exp_f32 v30, v30
v_exp_f32 v31, v31
v_exp_f32 v32, v32
v_exp_f32 v33, v33
v_exp_f32 v34, v34
v_exp_f32 v35, v35
v_pk_add_f32 v[28:29], v[28:29], v[244:245]
v_pk_add_f32 v[30:31], v[30:31], v[244:245]
v_pk_add_f32 v[32:33], v[32:33], v[244:245]
v_pk_add_f32 v[34:35], v[34:35], v[244:245]
v_rcp_f32 v28, v28
v_rcp_f32 v29, v29
v_rcp_f32 v30, v30
v_rcp_f32 v31, v31
v_rcp_f32 v32, v32
v_rcp_f32 v33, v33
v_rcp_f32 v34, v34
v_rcp_f32 v35, v35
v_pk_mul_f32 v[120:121], v[28:29], v[120:121]
v_pk_mul_f32 v[122:123], v[30:31], v[122:123]
v_pk_mul_f32 v[124:125], v[32:33], v[124:125]
v_pk_mul_f32 v[126:127], v[34:35], v[126:127]
v_cvt_pk_bf16_f32 v36, v120, v121
v_cvt_pk_bf16_f32 v37, v122, v123
v_cvt_pk_bf16_f32 v38, v124, v125
v_cvt_pk_bf16_f32 v39, v126, v127
buffer_store_dwordx4 v[36:39], v251, s[4:7], s53 offen offset:1024 sc1
s_branch main_kernel_w_ee
main_kernel_w_e5:
s_mov_b32 s53, s1
v_permlane16_swap_b32 v160, v162
v_permlane16_swap_b32 v161, v163
v_lshlrev_b32 v8, 16, v192
v_and_b32 v9, 0xffff0000, v192
v_lshlrev_b32 v10, 16, v193
v_and_b32 v11, 0xffff0000, v193
v_lshlrev_b32 v12, 16, v194
v_and_b32 v13, 0xffff0000, v194
v_lshlrev_b32 v14, 16, v195
v_and_b32 v15, 0xffff0000, v195
v_permlane32_swap_b32 v160, v162
v_permlane32_swap_b32 v161, v163
v_lshlrev_b32 v16, 16, v160
v_and_b32 v17, 0xffff0000, v160
v_lshlrev_b32 v18, 16, v161
v_and_b32 v19, 0xffff0000, v161
v_lshlrev_b32 v20, 16, v162
v_and_b32 v21, 0xffff0000, v162
v_lshlrev_b32 v22, 16, v163
v_and_b32 v23, 0xffff0000, v163
v_pk_fma_f32 v[8:9], v[64:65], v[8:9], v[16:17]
v_pk_fma_f32 v[10:11], v[66:67], v[10:11], v[18:19]
v_pk_fma_f32 v[12:13], v[68:69], v[12:13], v[20:21]
v_pk_fma_f32 v[14:15], v[70:71], v[14:15], v[22:23]
v_cvt_pk_bf16_f32 v24, v8, v9
v_cvt_pk_bf16_f32 v25, v10, v11
v_cvt_pk_bf16_f32 v26, v12, v13
v_cvt_pk_bf16_f32 v27, v14, v15
s_nop 0
v_permlane32_swap_b32 v24, v26
v_permlane32_swap_b32 v25, v27
s_nop 0
v_permlane16_swap_b32 v24, v26
v_permlane16_swap_b32 v25, v27
buffer_store_dwordx4 v[24:27], v145, s[92:95], s53 offen offset:0
v_permlane16_swap_b32 v164, v166
v_permlane16_swap_b32 v165, v167
v_lshlrev_b32 v36, 16, v196
v_and_b32 v37, 0xffff0000, v196
v_lshlrev_b32 v38, 16, v197
v_and_b32 v39, 0xffff0000, v197
v_lshlrev_b32 v40, 16, v198
v_and_b32 v41, 0xffff0000, v198
v_lshlrev_b32 v42, 16, v199
v_and_b32 v43, 0xffff0000, v199
v_permlane32_swap_b32 v164, v166
v_permlane32_swap_b32 v165, v167
v_lshlrev_b32 v44, 16, v164
v_and_b32 v45, 0xffff0000, v164
v_lshlrev_b32 v46, 16, v165
v_and_b32 v47, 0xffff0000, v165
v_lshlrev_b32 v48, 16, v166
v_and_b32 v49, 0xffff0000, v166
v_lshlrev_b32 v50, 16, v167
v_and_b32 v51, 0xffff0000, v167
v_pk_fma_f32 v[36:37], v[72:73], v[36:37], v[44:45]
v_pk_fma_f32 v[38:39], v[74:75], v[38:39], v[46:47]
v_pk_fma_f32 v[40:41], v[76:77], v[40:41], v[48:49]
v_pk_fma_f32 v[42:43], v[78:79], v[42:43], v[50:51]
v_cvt_pk_bf16_f32 v52, v36, v37
v_cvt_pk_bf16_f32 v53, v38, v39
v_cvt_pk_bf16_f32 v54, v40, v41
v_cvt_pk_bf16_f32 v55, v42, v43
s_nop 0
v_permlane32_swap_b32 v52, v54
v_permlane32_swap_b32 v53, v55
s_nop 0
v_permlane16_swap_b32 v52, v54
v_permlane16_swap_b32 v53, v55
buffer_store_dwordx4 v[52:55], v145, s[92:95], s53 offen offset:64
s_add_u32 s53, s53, 32768
v_permlane16_swap_b32 v168, v170
v_permlane16_swap_b32 v169, v171
v_lshlrev_b32 v8, 16, v200
v_and_b32 v9, 0xffff0000, v200
v_lshlrev_b32 v10, 16, v201
v_and_b32 v11, 0xffff0000, v201
v_lshlrev_b32 v12, 16, v202
v_and_b32 v13, 0xffff0000, v202
v_lshlrev_b32 v14, 16, v203
v_and_b32 v15, 0xffff0000, v203
v_permlane32_swap_b32 v168, v170
v_permlane32_swap_b32 v169, v171
v_lshlrev_b32 v16, 16, v168
v_and_b32 v17, 0xffff0000, v168
v_lshlrev_b32 v18, 16, v169
v_and_b32 v19, 0xffff0000, v169
v_lshlrev_b32 v20, 16, v170
v_and_b32 v21, 0xffff0000, v170
v_lshlrev_b32 v22, 16, v171
v_and_b32 v23, 0xffff0000, v171
v_pk_fma_f32 v[8:9], v[80:81], v[8:9], v[16:17]
v_pk_fma_f32 v[10:11], v[82:83], v[10:11], v[18:19]
v_pk_fma_f32 v[12:13], v[84:85], v[12:13], v[20:21]
v_pk_fma_f32 v[14:15], v[86:87], v[14:15], v[22:23]
v_cvt_pk_bf16_f32 v24, v8, v9
v_cvt_pk_bf16_f32 v25, v10, v11
v_cvt_pk_bf16_f32 v26, v12, v13
v_cvt_pk_bf16_f32 v27, v14, v15
s_nop 0
v_permlane32_swap_b32 v24, v26
v_permlane32_swap_b32 v25, v27
s_nop 0
v_permlane16_swap_b32 v24, v26
v_permlane16_swap_b32 v25, v27
buffer_store_dwordx4 v[24:27], v145, s[92:95], s53 offen offset:0
v_permlane16_swap_b32 v172, v174
v_permlane16_swap_b32 v173, v175
v_lshlrev_b32 v36, 16, v204
v_and_b32 v37, 0xffff0000, v204
v_lshlrev_b32 v38, 16, v205
v_and_b32 v39, 0xffff0000, v205
v_lshlrev_b32 v40, 16, v206
v_and_b32 v41, 0xffff0000, v206
v_lshlrev_b32 v42, 16, v207
v_and_b32 v43, 0xffff0000, v207
v_permlane32_swap_b32 v172, v174
v_permlane32_swap_b32 v173, v175
v_lshlrev_b32 v44, 16, v172
v_and_b32 v45, 0xffff0000, v172
v_lshlrev_b32 v46, 16, v173
v_and_b32 v47, 0xffff0000, v173
v_lshlrev_b32 v48, 16, v174
v_and_b32 v49, 0xffff0000, v174
v_lshlrev_b32 v50, 16, v175
v_and_b32 v51, 0xffff0000, v175
v_pk_fma_f32 v[36:37], v[88:89], v[36:37], v[44:45]
v_pk_fma_f32 v[38:39], v[90:91], v[38:39], v[46:47]
v_pk_fma_f32 v[40:41], v[92:93], v[40:41], v[48:49]
v_pk_fma_f32 v[42:43], v[94:95], v[42:43], v[50:51]
v_cvt_pk_bf16_f32 v52, v36, v37
v_cvt_pk_bf16_f32 v53, v38, v39
v_cvt_pk_bf16_f32 v54, v40, v41
v_cvt_pk_bf16_f32 v55, v42, v43
s_nop 0
v_permlane32_swap_b32 v52, v54
v_permlane32_swap_b32 v53, v55
s_nop 0
v_permlane16_swap_b32 v52, v54
v_permlane16_swap_b32 v53, v55
buffer_store_dwordx4 v[52:55], v145, s[92:95], s53 offen offset:64
s_add_u32 s53, s53, 32768
v_permlane16_swap_b32 v176, v178
v_permlane16_swap_b32 v177, v179
v_lshlrev_b32 v8, 16, v208
v_and_b32 v9, 0xffff0000, v208
v_lshlrev_b32 v10, 16, v209
v_and_b32 v11, 0xffff0000, v209
v_lshlrev_b32 v12, 16, v210
v_and_b32 v13, 0xffff0000, v210
v_lshlrev_b32 v14, 16, v211
v_and_b32 v15, 0xffff0000, v211
v_permlane32_swap_b32 v176, v178
v_permlane32_swap_b32 v177, v179
v_lshlrev_b32 v16, 16, v176
v_and_b32 v17, 0xffff0000, v176
v_lshlrev_b32 v18, 16, v177
v_and_b32 v19, 0xffff0000, v177
v_lshlrev_b32 v20, 16, v178
v_and_b32 v21, 0xffff0000, v178
v_lshlrev_b32 v22, 16, v179
v_and_b32 v23, 0xffff0000, v179
v_pk_fma_f32 v[8:9], v[96:97], v[8:9], v[16:17]
v_pk_fma_f32 v[10:11], v[98:99], v[10:11], v[18:19]
v_pk_fma_f32 v[12:13], v[100:101], v[12:13], v[20:21]
v_pk_fma_f32 v[14:15], v[102:103], v[14:15], v[22:23]
v_cvt_pk_bf16_f32 v24, v8, v9
v_cvt_pk_bf16_f32 v25, v10, v11
v_cvt_pk_bf16_f32 v26, v12, v13
v_cvt_pk_bf16_f32 v27, v14, v15
s_nop 0
v_permlane32_swap_b32 v24, v26
v_permlane32_swap_b32 v25, v27
s_nop 0
v_permlane16_swap_b32 v24, v26
v_permlane16_swap_b32 v25, v27
buffer_store_dwordx4 v[24:27], v145, s[92:95], s53 offen offset:0
v_permlane16_swap_b32 v180, v182
v_permlane16_swap_b32 v181, v183
v_lshlrev_b32 v36, 16, v212
v_and_b32 v37, 0xffff0000, v212
v_lshlrev_b32 v38, 16, v213
v_and_b32 v39, 0xffff0000, v213
v_lshlrev_b32 v40, 16, v214
v_and_b32 v41, 0xffff0000, v214
v_lshlrev_b32 v42, 16, v215
v_and_b32 v43, 0xffff0000, v215
v_permlane32_swap_b32 v180, v182
v_permlane32_swap_b32 v181, v183
v_lshlrev_b32 v44, 16, v180
v_and_b32 v45, 0xffff0000, v180
v_lshlrev_b32 v46, 16, v181
v_and_b32 v47, 0xffff0000, v181
v_lshlrev_b32 v48, 16, v182
v_and_b32 v49, 0xffff0000, v182
v_lshlrev_b32 v50, 16, v183
v_and_b32 v51, 0xffff0000, v183
v_pk_fma_f32 v[36:37], v[104:105], v[36:37], v[44:45]
v_pk_fma_f32 v[38:39], v[106:107], v[38:39], v[46:47]
v_pk_fma_f32 v[40:41], v[108:109], v[40:41], v[48:49]
v_pk_fma_f32 v[42:43], v[110:111], v[42:43], v[50:51]
v_cvt_pk_bf16_f32 v52, v36, v37
v_cvt_pk_bf16_f32 v53, v38, v39
v_cvt_pk_bf16_f32 v54, v40, v41
v_cvt_pk_bf16_f32 v55, v42, v43
s_nop 0
v_permlane32_swap_b32 v52, v54
v_permlane32_swap_b32 v53, v55
s_nop 0
v_permlane16_swap_b32 v52, v54
v_permlane16_swap_b32 v53, v55
buffer_store_dwordx4 v[52:55], v145, s[92:95], s53 offen offset:64
s_add_u32 s53, s53, 32768
v_permlane16_swap_b32 v184, v186
v_permlane16_swap_b32 v185, v187
v_lshlrev_b32 v8, 16, v216
v_and_b32 v9, 0xffff0000, v216
v_lshlrev_b32 v10, 16, v217
v_and_b32 v11, 0xffff0000, v217
v_lshlrev_b32 v12, 16, v218
v_and_b32 v13, 0xffff0000, v218
v_lshlrev_b32 v14, 16, v219
v_and_b32 v15, 0xffff0000, v219
v_permlane32_swap_b32 v184, v186
v_permlane32_swap_b32 v185, v187
v_lshlrev_b32 v16, 16, v184
v_and_b32 v17, 0xffff0000, v184
v_lshlrev_b32 v18, 16, v185
v_and_b32 v19, 0xffff0000, v185
v_lshlrev_b32 v20, 16, v186
v_and_b32 v21, 0xffff0000, v186
v_lshlrev_b32 v22, 16, v187
v_and_b32 v23, 0xffff0000, v187
v_pk_fma_f32 v[8:9], v[112:113], v[8:9], v[16:17]
v_pk_fma_f32 v[10:11], v[114:115], v[10:11], v[18:19]
v_pk_fma_f32 v[12:13], v[116:117], v[12:13], v[20:21]
v_pk_fma_f32 v[14:15], v[118:119], v[14:15], v[22:23]
v_cvt_pk_bf16_f32 v24, v8, v9
v_cvt_pk_bf16_f32 v25, v10, v11
v_cvt_pk_bf16_f32 v26, v12, v13
v_cvt_pk_bf16_f32 v27, v14, v15
s_nop 0
v_permlane32_swap_b32 v24, v26
v_permlane32_swap_b32 v25, v27
s_nop 0
v_permlane16_swap_b32 v24, v26
v_permlane16_swap_b32 v25, v27
buffer_store_dwordx4 v[24:27], v145, s[92:95], s53 offen offset:0
v_permlane16_swap_b32 v188, v190
v_permlane16_swap_b32 v189, v191
v_lshlrev_b32 v36, 16, v220
v_and_b32 v37, 0xffff0000, v220
v_lshlrev_b32 v38, 16, v221
v_and_b32 v39, 0xffff0000, v221
v_lshlrev_b32 v40, 16, v222
v_and_b32 v41, 0xffff0000, v222
v_lshlrev_b32 v42, 16, v223
v_and_b32 v43, 0xffff0000, v223
v_permlane32_swap_b32 v188, v190
v_permlane32_swap_b32 v189, v191
v_lshlrev_b32 v44, 16, v188
v_and_b32 v45, 0xffff0000, v188
v_lshlrev_b32 v46, 16, v189
v_and_b32 v47, 0xffff0000, v189
v_lshlrev_b32 v48, 16, v190
v_and_b32 v49, 0xffff0000, v190
v_lshlrev_b32 v50, 16, v191
v_and_b32 v51, 0xffff0000, v191
v_pk_fma_f32 v[36:37], v[120:121], v[36:37], v[44:45]
v_pk_fma_f32 v[38:39], v[122:123], v[38:39], v[46:47]
v_pk_fma_f32 v[40:41], v[124:125], v[40:41], v[48:49]
v_pk_fma_f32 v[42:43], v[126:127], v[42:43], v[50:51]
v_cvt_pk_bf16_f32 v52, v36, v37
v_cvt_pk_bf16_f32 v53, v38, v39
v_cvt_pk_bf16_f32 v54, v40, v41
v_cvt_pk_bf16_f32 v55, v42, v43
s_nop 0
v_permlane32_swap_b32 v52, v54
v_permlane32_swap_b32 v53, v55
s_nop 0
v_permlane16_swap_b32 v52, v54
v_permlane16_swap_b32 v53, v55
buffer_store_dwordx4 v[52:55], v145, s[92:95], s53 offen offset:64
s_branch main_kernel_w_ee
main_kernel_w_e6:
s_mov_b32 s53, s1
v_accvgpr_read_b32 v0, a0
v_accvgpr_read_b32 v1, a1
v_accvgpr_read_b32 v2, a2
v_accvgpr_read_b32 v3, a3
v_accvgpr_read_b32 v4, a4
v_accvgpr_read_b32 v5, a5
v_accvgpr_read_b32 v6, a6
v_accvgpr_read_b32 v7, a7
v_cvt_pk_bf16_f32 v16, v0, v1
v_cvt_pk_bf16_f32 v17, v2, v3
v_cvt_pk_bf16_f32 v18, v4, v5
v_cvt_pk_bf16_f32 v19, v6, v7
buffer_store_dwordx4 v[16:19], v251, s[4:7], s53 offen offset:0 sc1
v_accvgpr_read_b32 v20, a8
v_accvgpr_read_b32 v21, a9
v_accvgpr_read_b32 v22, a10
v_accvgpr_read_b32 v23, a11
v_accvgpr_read_b32 v24, a12
v_accvgpr_read_b32 v25, a13
v_accvgpr_read_b32 v26, a14
v_accvgpr_read_b32 v27, a15
v_cvt_pk_bf16_f32 v36, v20, v21
v_cvt_pk_bf16_f32 v37, v22, v23
v_cvt_pk_bf16_f32 v38, v24, v25
v_cvt_pk_bf16_f32 v39, v26, v27
buffer_store_dwordx4 v[36:39], v251, s[4:7], s53 offen offset:1024 sc1
v_accvgpr_read_b32 v40, a16
v_accvgpr_read_b32 v41, a17
v_accvgpr_read_b32 v42, a18
v_accvgpr_read_b32 v43, a19
v_accvgpr_read_b32 v44, a20
v_accvgpr_read_b32 v45, a21
v_accvgpr_read_b32 v46, a22
v_accvgpr_read_b32 v47, a23
v_cvt_pk_bf16_f32 v56, v40, v41
v_cvt_pk_bf16_f32 v57, v42, v43
v_cvt_pk_bf16_f32 v58, v44, v45
v_cvt_pk_bf16_f32 v59, v46, v47
buffer_store_dwordx4 v[56:59], v251, s[4:7], s53 offen offset:2048 sc1
v_accvgpr_read_b32 v0, a24
v_accvgpr_read_b32 v1, a25
v_accvgpr_read_b32 v2, a26
v_accvgpr_read_b32 v3, a27
v_accvgpr_read_b32 v4, a28
v_accvgpr_read_b32 v5, a29
v_accvgpr_read_b32 v6, a30
v_accvgpr_read_b32 v7, a31
v_cvt_pk_bf16_f32 v16, v0, v1
v_cvt_pk_bf16_f32 v17, v2, v3
v_cvt_pk_bf16_f32 v18, v4, v5
v_cvt_pk_bf16_f32 v19, v6, v7
buffer_store_dwordx4 v[16:19], v251, s[4:7], s53 offen offset:3072 sc1
s_add_u32 s53, s53, s2
v_accvgpr_read_b32 v20, a32
v_accvgpr_read_b32 v21, a33
v_accvgpr_read_b32 v22, a34
v_accvgpr_read_b32 v23, a35
v_accvgpr_read_b32 v24, a36
v_accvgpr_read_b32 v25, a37
v_accvgpr_read_b32 v26, a38
v_accvgpr_read_b32 v27, a39
v_cvt_pk_bf16_f32 v36, v20, v21
v_cvt_pk_bf16_f32 v37, v22, v23
v_cvt_pk_bf16_f32 v38, v24, v25
v_cvt_pk_bf16_f32 v39, v26, v27
buffer_store_dwordx4 v[36:39], v251, s[4:7], s53 offen offset:0 sc1
v_accvgpr_read_b32 v40, a40
v_accvgpr_read_b32 v41, a41
v_accvgpr_read_b32 v42, a42
v_accvgpr_read_b32 v43, a43
v_accvgpr_read_b32 v44, a44
v_accvgpr_read_b32 v45, a45
v_accvgpr_read_b32 v46, a46
v_accvgpr_read_b32 v47, a47
v_cvt_pk_bf16_f32 v56, v40, v41
v_cvt_pk_bf16_f32 v57, v42, v43
v_cvt_pk_bf16_f32 v58, v44, v45
v_cvt_pk_bf16_f32 v59, v46, v47
buffer_store_dwordx4 v[56:59], v251, s[4:7], s53 offen offset:1024 sc1
v_accvgpr_read_b32 v0, a48
v_accvgpr_read_b32 v1, a49
v_accvgpr_read_b32 v2, a50
v_accvgpr_read_b32 v3, a51
v_accvgpr_read_b32 v4, a52
v_accvgpr_read_b32 v5, a53
v_accvgpr_read_b32 v6, a54
v_accvgpr_read_b32 v7, a55
v_cvt_pk_bf16_f32 v16, v0, v1
v_cvt_pk_bf16_f32 v17, v2, v3
v_cvt_pk_bf16_f32 v18, v4, v5
v_cvt_pk_bf16_f32 v19, v6, v7
buffer_store_dwordx4 v[16:19], v251, s[4:7], s53 offen offset:2048 sc1
v_accvgpr_read_b32 v20, a56
v_accvgpr_read_b32 v21, a57
v_accvgpr_read_b32 v22, a58
v_accvgpr_read_b32 v23, a59
v_accvgpr_read_b32 v24, a60
v_accvgpr_read_b32 v25, a61
v_accvgpr_read_b32 v26, a62
v_accvgpr_read_b32 v27, a63
v_cvt_pk_bf16_f32 v36, v20, v21
v_cvt_pk_bf16_f32 v37, v22, v23
v_cvt_pk_bf16_f32 v38, v24, v25
v_cvt_pk_bf16_f32 v39, v26, v27
buffer_store_dwordx4 v[36:39], v251, s[4:7], s53 offen offset:3072 sc1
s_add_u32 s53, s53, s2
v_accvgpr_read_b32 v40, a64
v_accvgpr_read_b32 v41, a65
v_accvgpr_read_b32 v42, a66
v_accvgpr_read_b32 v43, a67
v_accvgpr_read_b32 v44, a68
v_accvgpr_read_b32 v45, a69
v_accvgpr_read_b32 v46, a70
v_accvgpr_read_b32 v47, a71
v_cvt_pk_bf16_f32 v56, v40, v41
v_cvt_pk_bf16_f32 v57, v42, v43
v_cvt_pk_bf16_f32 v58, v44, v45
v_cvt_pk_bf16_f32 v59, v46, v47
buffer_store_dwordx4 v[56:59], v251, s[4:7], s53 offen offset:0 sc1
v_accvgpr_read_b32 v0, a72
v_accvgpr_read_b32 v1, a73
v_accvgpr_read_b32 v2, a74
v_accvgpr_read_b32 v3, a75
v_accvgpr_read_b32 v4, a76
v_accvgpr_read_b32 v5, a77
v_accvgpr_read_b32 v6, a78
v_accvgpr_read_b32 v7, a79
v_cvt_pk_bf16_f32 v16, v0, v1
v_cvt_pk_bf16_f32 v17, v2, v3
v_cvt_pk_bf16_f32 v18, v4, v5
v_cvt_pk_bf16_f32 v19, v6, v7
buffer_store_dwordx4 v[16:19], v251, s[4:7], s53 offen offset:1024 sc1
v_accvgpr_read_b32 v20, a80
v_accvgpr_read_b32 v21, a81
v_accvgpr_read_b32 v22, a82
v_accvgpr_read_b32 v23, a83
v_accvgpr_read_b32 v24, a84
v_accvgpr_read_b32 v25, a85
v_accvgpr_read_b32 v26, a86
v_accvgpr_read_b32 v27, a87
v_cvt_pk_bf16_f32 v36, v20, v21
v_cvt_pk_bf16_f32 v37, v22, v23
v_cvt_pk_bf16_f32 v38, v24, v25
v_cvt_pk_bf16_f32 v39, v26, v27
buffer_store_dwordx4 v[36:39], v251, s[4:7], s53 offen offset:2048 sc1
v_accvgpr_read_b32 v40, a88
v_accvgpr_read_b32 v41, a89
v_accvgpr_read_b32 v42, a90
v_accvgpr_read_b32 v43, a91
v_accvgpr_read_b32 v44, a92
v_accvgpr_read_b32 v45, a93
v_accvgpr_read_b32 v46, a94
v_accvgpr_read_b32 v47, a95
v_cvt_pk_bf16_f32 v56, v40, v41
v_cvt_pk_bf16_f32 v57, v42, v43
v_cvt_pk_bf16_f32 v58, v44, v45
v_cvt_pk_bf16_f32 v59, v46, v47
buffer_store_dwordx4 v[56:59], v251, s[4:7], s53 offen offset:3072 sc1
s_add_u32 s53, s53, s2
v_accvgpr_read_b32 v0, a96
v_accvgpr_read_b32 v1, a97
v_accvgpr_read_b32 v2, a98
v_accvgpr_read_b32 v3, a99
v_accvgpr_read_b32 v4, a100
v_accvgpr_read_b32 v5, a101
v_accvgpr_read_b32 v6, a102
v_accvgpr_read_b32 v7, a103
v_cvt_pk_bf16_f32 v16, v0, v1
v_cvt_pk_bf16_f32 v17, v2, v3
v_cvt_pk_bf16_f32 v18, v4, v5
v_cvt_pk_bf16_f32 v19, v6, v7
buffer_store_dwordx4 v[16:19], v251, s[4:7], s53 offen offset:0 sc1
v_accvgpr_read_b32 v20, a104
v_accvgpr_read_b32 v21, a105
v_accvgpr_read_b32 v22, a106
v_accvgpr_read_b32 v23, a107
v_accvgpr_read_b32 v24, a108
v_accvgpr_read_b32 v25, a109
v_accvgpr_read_b32 v26, a110
v_accvgpr_read_b32 v27, a111
v_cvt_pk_bf16_f32 v36, v20, v21
v_cvt_pk_bf16_f32 v37, v22, v23
v_cvt_pk_bf16_f32 v38, v24, v25
v_cvt_pk_bf16_f32 v39, v26, v27
buffer_store_dwordx4 v[36:39], v251, s[4:7], s53 offen offset:1024 sc1
v_accvgpr_read_b32 v40, a112
v_accvgpr_read_b32 v41, a113
v_accvgpr_read_b32 v42, a114
v_accvgpr_read_b32 v43, a115
v_accvgpr_read_b32 v44, a116
v_accvgpr_read_b32 v45, a117
v_accvgpr_read_b32 v46, a118
v_accvgpr_read_b32 v47, a119
v_cvt_pk_bf16_f32 v56, v40, v41
v_cvt_pk_bf16_f32 v57, v42, v43
v_cvt_pk_bf16_f32 v58, v44, v45
v_cvt_pk_bf16_f32 v59, v46, v47
buffer_store_dwordx4 v[56:59], v251, s[4:7], s53 offen offset:2048 sc1
v_accvgpr_read_b32 v0, a120
v_accvgpr_read_b32 v1, a121
v_accvgpr_read_b32 v2, a122
v_accvgpr_read_b32 v3, a123
v_accvgpr_read_b32 v4, a124
v_accvgpr_read_b32 v5, a125
v_accvgpr_read_b32 v6, a126
v_accvgpr_read_b32 v7, a127
v_cvt_pk_bf16_f32 v16, v0, v1
v_cvt_pk_bf16_f32 v17, v2, v3
v_cvt_pk_bf16_f32 v18, v4, v5
v_cvt_pk_bf16_f32 v19, v6, v7
buffer_store_dwordx4 v[16:19], v251, s[4:7], s53 offen offset:3072 sc1
s_branch main_kernel_w_ee
main_kernel_w_e7:
s_mov_b32 s53, s1
v_accvgpr_read_b32 v0, a0
v_accvgpr_read_b32 v1, a1
v_accvgpr_read_b32 v2, a2
v_accvgpr_read_b32 v3, a3
v_accvgpr_read_b32 v4, a4
v_accvgpr_read_b32 v5, a5
v_accvgpr_read_b32 v6, a6
v_accvgpr_read_b32 v7, a7
v_mul_f32 v0, 0x3e0293ee, v0
v_mul_f32 v1, 0x3e0293ee, v1
v_mul_f32 v2, 0x3e0293ee, v2
v_mul_f32 v3, 0x3e0293ee, v3
v_mul_f32 v4, 0x3e0293ee, v4
v_mul_f32 v5, 0x3e0293ee, v5
v_mul_f32 v6, 0x3e0293ee, v6
v_mul_f32 v7, 0x3e0293ee, v7
v_cvt_pk_bf16_f32 v16, v0, v1
v_cvt_pk_bf16_f32 v17, v2, v3
v_cvt_pk_bf16_f32 v18, v4, v5
v_cvt_pk_bf16_f32 v19, v6, v7
buffer_store_dwordx4 v[16:19], v251, s[4:7], s53 offen offset:0 sc1
v_accvgpr_read_b32 v20, a8
v_accvgpr_read_b32 v21, a9
v_accvgpr_read_b32 v22, a10
v_accvgpr_read_b32 v23, a11
v_accvgpr_read_b32 v24, a12
v_accvgpr_read_b32 v25, a13
v_accvgpr_read_b32 v26, a14
v_accvgpr_read_b32 v27, a15
v_mul_f32 v20, 0x3e0293ee, v20
v_mul_f32 v21, 0x3e0293ee, v21
v_mul_f32 v22, 0x3e0293ee, v22
v_mul_f32 v23, 0x3e0293ee, v23
v_mul_f32 v24, 0x3e0293ee, v24
v_mul_f32 v25, 0x3e0293ee, v25
v_mul_f32 v26, 0x3e0293ee, v26
v_mul_f32 v27, 0x3e0293ee, v27
v_cvt_pk_bf16_f32 v36, v20, v21
v_cvt_pk_bf16_f32 v37, v22, v23
v_cvt_pk_bf16_f32 v38, v24, v25
v_cvt_pk_bf16_f32 v39, v26, v27
buffer_store_dwordx4 v[36:39], v251, s[4:7], s53 offen offset:1024 sc1
v_accvgpr_read_b32 v40, a16
v_accvgpr_read_b32 v41, a17
v_accvgpr_read_b32 v42, a18
v_accvgpr_read_b32 v43, a19
v_accvgpr_read_b32 v44, a20
v_accvgpr_read_b32 v45, a21
v_accvgpr_read_b32 v46, a22
v_accvgpr_read_b32 v47, a23
v_mul_f32 v40, 0x3e0293ee, v40
v_mul_f32 v41, 0x3e0293ee, v41
v_mul_f32 v42, 0x3e0293ee, v42
v_mul_f32 v43, 0x3e0293ee, v43
v_mul_f32 v44, 0x3e0293ee, v44
v_mul_f32 v45, 0x3e0293ee, v45
v_mul_f32 v46, 0x3e0293ee, v46
v_mul_f32 v47, 0x3e0293ee, v47
v_cvt_pk_bf16_f32 v56, v40, v41
v_cvt_pk_bf16_f32 v57, v42, v43
v_cvt_pk_bf16_f32 v58, v44, v45
v_cvt_pk_bf16_f32 v59, v46, v47
buffer_store_dwordx4 v[56:59], v251, s[4:7], s53 offen offset:2048 sc1
v_accvgpr_read_b32 v0, a24
v_accvgpr_read_b32 v1, a25
v_accvgpr_read_b32 v2, a26
v_accvgpr_read_b32 v3, a27
v_accvgpr_read_b32 v4, a28
v_accvgpr_read_b32 v5, a29
v_accvgpr_read_b32 v6, a30
v_accvgpr_read_b32 v7, a31
v_mul_f32 v0, 0x3e0293ee, v0
v_mul_f32 v1, 0x3e0293ee, v1
v_mul_f32 v2, 0x3e0293ee, v2
v_mul_f32 v3, 0x3e0293ee, v3
v_mul_f32 v4, 0x3e0293ee, v4
v_mul_f32 v5, 0x3e0293ee, v5
v_mul_f32 v6, 0x3e0293ee, v6
v_mul_f32 v7, 0x3e0293ee, v7
v_cvt_pk_bf16_f32 v16, v0, v1
v_cvt_pk_bf16_f32 v17, v2, v3
v_cvt_pk_bf16_f32 v18, v4, v5
v_cvt_pk_bf16_f32 v19, v6, v7
buffer_store_dwordx4 v[16:19], v251, s[4:7], s53 offen offset:3072 sc1
s_add_u32 s53, s53, s2
v_accvgpr_read_b32 v20, a32
v_accvgpr_read_b32 v21, a33
v_accvgpr_read_b32 v22, a34
v_accvgpr_read_b32 v23, a35
v_accvgpr_read_b32 v24, a36
v_accvgpr_read_b32 v25, a37
v_accvgpr_read_b32 v26, a38
v_accvgpr_read_b32 v27, a39
v_mul_f32 v20, 0x3e0293ee, v20
v_mul_f32 v21, 0x3e0293ee, v21
v_mul_f32 v22, 0x3e0293ee, v22
v_mul_f32 v23, 0x3e0293ee, v23
v_mul_f32 v24, 0x3e0293ee, v24
v_mul_f32 v25, 0x3e0293ee, v25
v_mul_f32 v26, 0x3e0293ee, v26
v_mul_f32 v27, 0x3e0293ee, v27
v_cvt_pk_bf16_f32 v36, v20, v21
v_cvt_pk_bf16_f32 v37, v22, v23
v_cvt_pk_bf16_f32 v38, v24, v25
v_cvt_pk_bf16_f32 v39, v26, v27
buffer_store_dwordx4 v[36:39], v251, s[4:7], s53 offen offset:0 sc1
v_accvgpr_read_b32 v40, a40
v_accvgpr_read_b32 v41, a41
v_accvgpr_read_b32 v42, a42
v_accvgpr_read_b32 v43, a43
v_accvgpr_read_b32 v44, a44
v_accvgpr_read_b32 v45, a45
v_accvgpr_read_b32 v46, a46
v_accvgpr_read_b32 v47, a47
v_mul_f32 v40, 0x3e0293ee, v40
v_mul_f32 v41, 0x3e0293ee, v41
v_mul_f32 v42, 0x3e0293ee, v42
v_mul_f32 v43, 0x3e0293ee, v43
v_mul_f32 v44, 0x3e0293ee, v44
v_mul_f32 v45, 0x3e0293ee, v45
v_mul_f32 v46, 0x3e0293ee, v46
v_mul_f32 v47, 0x3e0293ee, v47
v_cvt_pk_bf16_f32 v56, v40, v41
v_cvt_pk_bf16_f32 v57, v42, v43
v_cvt_pk_bf16_f32 v58, v44, v45
v_cvt_pk_bf16_f32 v59, v46, v47
buffer_store_dwordx4 v[56:59], v251, s[4:7], s53 offen offset:1024 sc1
v_accvgpr_read_b32 v0, a48
v_accvgpr_read_b32 v1, a49
v_accvgpr_read_b32 v2, a50
v_accvgpr_read_b32 v3, a51
v_accvgpr_read_b32 v4, a52
v_accvgpr_read_b32 v5, a53
v_accvgpr_read_b32 v6, a54
v_accvgpr_read_b32 v7, a55
v_mul_f32 v0, 0x3e0293ee, v0
v_mul_f32 v1, 0x3e0293ee, v1
v_mul_f32 v2, 0x3e0293ee, v2
v_mul_f32 v3, 0x3e0293ee, v3
v_mul_f32 v4, 0x3e0293ee, v4
v_mul_f32 v5, 0x3e0293ee, v5
v_mul_f32 v6, 0x3e0293ee, v6
v_mul_f32 v7, 0x3e0293ee, v7
v_cvt_pk_bf16_f32 v16, v0, v1
v_cvt_pk_bf16_f32 v17, v2, v3
v_cvt_pk_bf16_f32 v18, v4, v5
v_cvt_pk_bf16_f32 v19, v6, v7
buffer_store_dwordx4 v[16:19], v251, s[4:7], s53 offen offset:2048 sc1
v_accvgpr_read_b32 v20, a56
v_accvgpr_read_b32 v21, a57
v_accvgpr_read_b32 v22, a58
v_accvgpr_read_b32 v23, a59
v_accvgpr_read_b32 v24, a60
v_accvgpr_read_b32 v25, a61
v_accvgpr_read_b32 v26, a62
v_accvgpr_read_b32 v27, a63
v_mul_f32 v20, 0x3e0293ee, v20
v_mul_f32 v21, 0x3e0293ee, v21
v_mul_f32 v22, 0x3e0293ee, v22
v_mul_f32 v23, 0x3e0293ee, v23
v_mul_f32 v24, 0x3e0293ee, v24
v_mul_f32 v25, 0x3e0293ee, v25
v_mul_f32 v26, 0x3e0293ee, v26
v_mul_f32 v27, 0x3e0293ee, v27
v_cvt_pk_bf16_f32 v36, v20, v21
v_cvt_pk_bf16_f32 v37, v22, v23
v_cvt_pk_bf16_f32 v38, v24, v25
v_cvt_pk_bf16_f32 v39, v26, v27
buffer_store_dwordx4 v[36:39], v251, s[4:7], s53 offen offset:3072 sc1
s_add_u32 s53, s53, s2
v_accvgpr_read_b32 v40, a64
v_accvgpr_read_b32 v41, a65
v_accvgpr_read_b32 v42, a66
v_accvgpr_read_b32 v43, a67
v_accvgpr_read_b32 v44, a68
v_accvgpr_read_b32 v45, a69
v_accvgpr_read_b32 v46, a70
v_accvgpr_read_b32 v47, a71
v_mul_f32 v40, 0x3e0293ee, v40
v_mul_f32 v41, 0x3e0293ee, v41
v_mul_f32 v42, 0x3e0293ee, v42
v_mul_f32 v43, 0x3e0293ee, v43
v_mul_f32 v44, 0x3e0293ee, v44
v_mul_f32 v45, 0x3e0293ee, v45
v_mul_f32 v46, 0x3e0293ee, v46
v_mul_f32 v47, 0x3e0293ee, v47
v_cvt_pk_bf16_f32 v56, v40, v41
v_cvt_pk_bf16_f32 v57, v42, v43
v_cvt_pk_bf16_f32 v58, v44, v45
v_cvt_pk_bf16_f32 v59, v46, v47
buffer_store_dwordx4 v[56:59], v251, s[4:7], s53 offen offset:0 sc1
v_accvgpr_read_b32 v0, a72
v_accvgpr_read_b32 v1, a73
v_accvgpr_read_b32 v2, a74
v_accvgpr_read_b32 v3, a75
v_accvgpr_read_b32 v4, a76
v_accvgpr_read_b32 v5, a77
v_accvgpr_read_b32 v6, a78
v_accvgpr_read_b32 v7, a79
v_mul_f32 v0, 0x3e0293ee, v0
v_mul_f32 v1, 0x3e0293ee, v1
v_mul_f32 v2, 0x3e0293ee, v2
v_mul_f32 v3, 0x3e0293ee, v3
v_mul_f32 v4, 0x3e0293ee, v4
v_mul_f32 v5, 0x3e0293ee, v5
v_mul_f32 v6, 0x3e0293ee, v6
v_mul_f32 v7, 0x3e0293ee, v7
v_cvt_pk_bf16_f32 v16, v0, v1
v_cvt_pk_bf16_f32 v17, v2, v3
v_cvt_pk_bf16_f32 v18, v4, v5
v_cvt_pk_bf16_f32 v19, v6, v7
buffer_store_dwordx4 v[16:19], v251, s[4:7], s53 offen offset:1024 sc1
v_accvgpr_read_b32 v20, a80
v_accvgpr_read_b32 v21, a81
v_accvgpr_read_b32 v22, a82
v_accvgpr_read_b32 v23, a83
v_accvgpr_read_b32 v24, a84
v_accvgpr_read_b32 v25, a85
v_accvgpr_read_b32 v26, a86
v_accvgpr_read_b32 v27, a87
v_mul_f32 v20, 0x3e0293ee, v20
v_mul_f32 v21, 0x3e0293ee, v21
v_mul_f32 v22, 0x3e0293ee, v22
v_mul_f32 v23, 0x3e0293ee, v23
v_mul_f32 v24, 0x3e0293ee, v24
v_mul_f32 v25, 0x3e0293ee, v25
v_mul_f32 v26, 0x3e0293ee, v26
v_mul_f32 v27, 0x3e0293ee, v27
v_cvt_pk_bf16_f32 v36, v20, v21
v_cvt_pk_bf16_f32 v37, v22, v23
v_cvt_pk_bf16_f32 v38, v24, v25
v_cvt_pk_bf16_f32 v39, v26, v27
buffer_store_dwordx4 v[36:39], v251, s[4:7], s53 offen offset:2048 sc1
v_accvgpr_read_b32 v40, a88
v_accvgpr_read_b32 v41, a89
v_accvgpr_read_b32 v42, a90
v_accvgpr_read_b32 v43, a91
v_accvgpr_read_b32 v44, a92
v_accvgpr_read_b32 v45, a93
v_accvgpr_read_b32 v46, a94
v_accvgpr_read_b32 v47, a95
v_mul_f32 v40, 0x3e0293ee, v40
v_mul_f32 v41, 0x3e0293ee, v41
v_mul_f32 v42, 0x3e0293ee, v42
v_mul_f32 v43, 0x3e0293ee, v43
v_mul_f32 v44, 0x3e0293ee, v44
v_mul_f32 v45, 0x3e0293ee, v45
v_mul_f32 v46, 0x3e0293ee, v46
v_mul_f32 v47, 0x3e0293ee, v47
v_cvt_pk_bf16_f32 v56, v40, v41
v_cvt_pk_bf16_f32 v57, v42, v43
v_cvt_pk_bf16_f32 v58, v44, v45
v_cvt_pk_bf16_f32 v59, v46, v47
buffer_store_dwordx4 v[56:59], v251, s[4:7], s53 offen offset:3072 sc1
s_add_u32 s53, s53, s2
v_accvgpr_read_b32 v0, a96
v_accvgpr_read_b32 v1, a97
v_accvgpr_read_b32 v2, a98
v_accvgpr_read_b32 v3, a99
v_accvgpr_read_b32 v4, a100
v_accvgpr_read_b32 v5, a101
v_accvgpr_read_b32 v6, a102
v_accvgpr_read_b32 v7, a103
v_mul_f32 v0, 0x3e0293ee, v0
v_mul_f32 v1, 0x3e0293ee, v1
v_mul_f32 v2, 0x3e0293ee, v2
v_mul_f32 v3, 0x3e0293ee, v3
v_mul_f32 v4, 0x3e0293ee, v4
v_mul_f32 v5, 0x3e0293ee, v5
v_mul_f32 v6, 0x3e0293ee, v6
v_mul_f32 v7, 0x3e0293ee, v7
v_cvt_pk_bf16_f32 v16, v0, v1
v_cvt_pk_bf16_f32 v17, v2, v3
v_cvt_pk_bf16_f32 v18, v4, v5
v_cvt_pk_bf16_f32 v19, v6, v7
buffer_store_dwordx4 v[16:19], v251, s[4:7], s53 offen offset:0 sc1
v_accvgpr_read_b32 v20, a104
v_accvgpr_read_b32 v21, a105
v_accvgpr_read_b32 v22, a106
v_accvgpr_read_b32 v23, a107
v_accvgpr_read_b32 v24, a108
v_accvgpr_read_b32 v25, a109
v_accvgpr_read_b32 v26, a110
v_accvgpr_read_b32 v27, a111
v_mul_f32 v20, 0x3e0293ee, v20
v_mul_f32 v21, 0x3e0293ee, v21
v_mul_f32 v22, 0x3e0293ee, v22
v_mul_f32 v23, 0x3e0293ee, v23
v_mul_f32 v24, 0x3e0293ee, v24
v_mul_f32 v25, 0x3e0293ee, v25
v_mul_f32 v26, 0x3e0293ee, v26
v_mul_f32 v27, 0x3e0293ee, v27
v_cvt_pk_bf16_f32 v36, v20, v21
v_cvt_pk_bf16_f32 v37, v22, v23
v_cvt_pk_bf16_f32 v38, v24, v25
v_cvt_pk_bf16_f32 v39, v26, v27
buffer_store_dwordx4 v[36:39], v251, s[4:7], s53 offen offset:1024 sc1
v_accvgpr_read_b32 v40, a112
v_accvgpr_read_b32 v41, a113
v_accvgpr_read_b32 v42, a114
v_accvgpr_read_b32 v43, a115
v_accvgpr_read_b32 v44, a116
v_accvgpr_read_b32 v45, a117
v_accvgpr_read_b32 v46, a118
v_accvgpr_read_b32 v47, a119
v_mul_f32 v40, 0x3e0293ee, v40
v_mul_f32 v41, 0x3e0293ee, v41
v_mul_f32 v42, 0x3e0293ee, v42
v_mul_f32 v43, 0x3e0293ee, v43
v_mul_f32 v44, 0x3e0293ee, v44
v_mul_f32 v45, 0x3e0293ee, v45
v_mul_f32 v46, 0x3e0293ee, v46
v_mul_f32 v47, 0x3e0293ee, v47
v_cvt_pk_bf16_f32 v56, v40, v41
v_cvt_pk_bf16_f32 v57, v42, v43
v_cvt_pk_bf16_f32 v58, v44, v45
v_cvt_pk_bf16_f32 v59, v46, v47
buffer_store_dwordx4 v[56:59], v251, s[4:7], s53 offen offset:2048 sc1
v_accvgpr_read_b32 v0, a120
v_accvgpr_read_b32 v1, a121
v_accvgpr_read_b32 v2, a122
v_accvgpr_read_b32 v3, a123
v_accvgpr_read_b32 v4, a124
v_accvgpr_read_b32 v5, a125
v_accvgpr_read_b32 v6, a126
v_accvgpr_read_b32 v7, a127
v_mul_f32 v0, 0x3e0293ee, v0
v_mul_f32 v1, 0x3e0293ee, v1
v_mul_f32 v2, 0x3e0293ee, v2
v_mul_f32 v3, 0x3e0293ee, v3
v_mul_f32 v4, 0x3e0293ee, v4
v_mul_f32 v5, 0x3e0293ee, v5
v_mul_f32 v6, 0x3e0293ee, v6
v_mul_f32 v7, 0x3e0293ee, v7
v_cvt_pk_bf16_f32 v16, v0, v1
v_cvt_pk_bf16_f32 v17, v2, v3
v_cvt_pk_bf16_f32 v18, v4, v5
v_cvt_pk_bf16_f32 v19, v6, v7
buffer_store_dwordx4 v[16:19], v251, s[4:7], s53 offen offset:3072 sc1
s_branch main_kernel_w_ee
main_kernel_w_e8:
s_mov_b32 s53, s1
v_accvgpr_read_b32 v0, a0
v_accvgpr_read_b32 v1, a1
v_accvgpr_read_b32 v2, a2
v_accvgpr_read_b32 v3, a3
v_accvgpr_read_b32 v4, a32
v_accvgpr_read_b32 v5, a33
v_accvgpr_read_b32 v6, a34
v_accvgpr_read_b32 v7, a35
v_cvt_pk_bf16_f32 v8, v0, v1
v_cvt_pk_bf16_f32 v9, v2, v3
v_cvt_pk_bf16_f32 v10, v4, v5
v_cvt_pk_bf16_f32 v11, v6, v7
buffer_store_dwordx4 v[8:11], v251, s[4:7], s53 offen offset:0 sc1
v_accvgpr_read_b32 v16, a4
v_accvgpr_read_b32 v17, a5
v_accvgpr_read_b32 v18, a6
v_accvgpr_read_b32 v19, a7
v_accvgpr_read_b32 v20, a36
v_accvgpr_read_b32 v21, a37
v_accvgpr_read_b32 v22, a38
v_accvgpr_read_b32 v23, a39
v_cvt_pk_bf16_f32 v24, v16, v17
v_cvt_pk_bf16_f32 v25, v18, v19
v_cvt_pk_bf16_f32 v26, v20, v21
v_cvt_pk_bf16_f32 v27, v22, v23
buffer_store_dwordx4 v[24:27], v251, s[4:7], s53 offen offset:1024 sc1
v_accvgpr_read_b32 v32, a8
v_accvgpr_read_b32 v33, a9
v_accvgpr_read_b32 v34, a10
v_accvgpr_read_b32 v35, a11
v_accvgpr_read_b32 v36, a40
v_accvgpr_read_b32 v37, a41
v_accvgpr_read_b32 v38, a42
v_accvgpr_read_b32 v39, a43
v_cvt_pk_bf16_f32 v40, v32, v33
v_cvt_pk_bf16_f32 v41, v34, v35
v_cvt_pk_bf16_f32 v42, v36, v37
v_cvt_pk_bf16_f32 v43, v38, v39
buffer_store_dwordx4 v[40:43], v251, s[4:7], s53 offen offset:2048 sc1
v_accvgpr_read_b32 v48, a12
v_accvgpr_read_b32 v49, a13
v_accvgpr_read_b32 v50, a14
v_accvgpr_read_b32 v51, a15
v_accvgpr_read_b32 v52, a44
v_accvgpr_read_b32 v53, a45
v_accvgpr_read_b32 v54, a46
v_accvgpr_read_b32 v55, a47
v_cvt_pk_bf16_f32 v56, v48, v49
v_cvt_pk_bf16_f32 v57, v50, v51
v_cvt_pk_bf16_f32 v58, v52, v53
v_cvt_pk_bf16_f32 v59, v54, v55
buffer_store_dwordx4 v[56:59], v251, s[4:7], s53 offen offset:3072 sc1
s_add_u32 s53, s53, 4096
v_accvgpr_read_b32 v0, a16
v_accvgpr_read_b32 v1, a17
v_accvgpr_read_b32 v2, a18
v_accvgpr_read_b32 v3, a19
v_accvgpr_read_b32 v4, a48
v_accvgpr_read_b32 v5, a49
v_accvgpr_read_b32 v6, a50
v_accvgpr_read_b32 v7, a51
v_cvt_pk_bf16_f32 v8, v0, v1
v_cvt_pk_bf16_f32 v9, v2, v3
v_cvt_pk_bf16_f32 v10, v4, v5
v_cvt_pk_bf16_f32 v11, v6, v7
buffer_store_dwordx4 v[8:11], v251, s[4:7], s53 offen offset:0 sc1
v_accvgpr_read_b32 v16, a20
v_accvgpr_read_b32 v17, a21
v_accvgpr_read_b32 v18, a22
v_accvgpr_read_b32 v19, a23
v_accvgpr_read_b32 v20, a52
v_accvgpr_read_b32 v21, a53
v_accvgpr_read_b32 v22, a54
v_accvgpr_read_b32 v23, a55
v_cvt_pk_bf16_f32 v24, v16, v17
v_cvt_pk_bf16_f32 v25, v18, v19
v_cvt_pk_bf16_f32 v26, v20, v21
v_cvt_pk_bf16_f32 v27, v22, v23
buffer_store_dwordx4 v[24:27], v251, s[4:7], s53 offen offset:1024 sc1
v_accvgpr_read_b32 v32, a24
v_accvgpr_read_b32 v33, a25
v_accvgpr_read_b32 v34, a26
v_accvgpr_read_b32 v35, a27
v_accvgpr_read_b32 v36, a56
v_accvgpr_read_b32 v37, a57
v_accvgpr_read_b32 v38, a58
v_accvgpr_read_b32 v39, a59
v_cvt_pk_bf16_f32 v40, v32, v33
v_cvt_pk_bf16_f32 v41, v34, v35
v_cvt_pk_bf16_f32 v42, v36, v37
v_cvt_pk_bf16_f32 v43, v38, v39
buffer_store_dwordx4 v[40:43], v251, s[4:7], s53 offen offset:2048 sc1
v_accvgpr_read_b32 v48, a28
v_accvgpr_read_b32 v49, a29
v_accvgpr_read_b32 v50, a30
v_accvgpr_read_b32 v51, a31
v_accvgpr_read_b32 v52, a60
v_accvgpr_read_b32 v53, a61
v_accvgpr_read_b32 v54, a62
v_accvgpr_read_b32 v55, a63
v_cvt_pk_bf16_f32 v56, v48, v49
v_cvt_pk_bf16_f32 v57, v50, v51
v_cvt_pk_bf16_f32 v58, v52, v53
v_cvt_pk_bf16_f32 v59, v54, v55
buffer_store_dwordx4 v[56:59], v251, s[4:7], s53 offen offset:3072 sc1
s_add_u32 s53, s53, 258048
v_accvgpr_read_b32 v0, a64
v_accvgpr_read_b32 v1, a65
v_accvgpr_read_b32 v2, a66
v_accvgpr_read_b32 v3, a67
v_accvgpr_read_b32 v4, a96
v_accvgpr_read_b32 v5, a97
v_accvgpr_read_b32 v6, a98
v_accvgpr_read_b32 v7, a99
v_cvt_pk_bf16_f32 v8, v0, v1
v_cvt_pk_bf16_f32 v9, v2, v3
v_cvt_pk_bf16_f32 v10, v4, v5
v_cvt_pk_bf16_f32 v11, v6, v7
buffer_store_dwordx4 v[8:11], v251, s[4:7], s53 offen offset:0 sc1
v_accvgpr_read_b32 v16, a68
v_accvgpr_read_b32 v17, a69
v_accvgpr_read_b32 v18, a70
v_accvgpr_read_b32 v19, a71
v_accvgpr_read_b32 v20, a100
v_accvgpr_read_b32 v21, a101
v_accvgpr_read_b32 v22, a102
v_accvgpr_read_b32 v23, a103
v_cvt_pk_bf16_f32 v24, v16, v17
v_cvt_pk_bf16_f32 v25, v18, v19
v_cvt_pk_bf16_f32 v26, v20, v21
v_cvt_pk_bf16_f32 v27, v22, v23
buffer_store_dwordx4 v[24:27], v251, s[4:7], s53 offen offset:1024 sc1
v_accvgpr_read_b32 v32, a72
v_accvgpr_read_b32 v33, a73
v_accvgpr_read_b32 v34, a74
v_accvgpr_read_b32 v35, a75
v_accvgpr_read_b32 v36, a104
v_accvgpr_read_b32 v37, a105
v_accvgpr_read_b32 v38, a106
v_accvgpr_read_b32 v39, a107
v_cvt_pk_bf16_f32 v40, v32, v33
v_cvt_pk_bf16_f32 v41, v34, v35
v_cvt_pk_bf16_f32 v42, v36, v37
v_cvt_pk_bf16_f32 v43, v38, v39
buffer_store_dwordx4 v[40:43], v251, s[4:7], s53 offen offset:2048 sc1
v_accvgpr_read_b32 v48, a76
v_accvgpr_read_b32 v49, a77
v_accvgpr_read_b32 v50, a78
v_accvgpr_read_b32 v51, a79
v_accvgpr_read_b32 v52, a108
v_accvgpr_read_b32 v53, a109
v_accvgpr_read_b32 v54, a110
v_accvgpr_read_b32 v55, a111
v_cvt_pk_bf16_f32 v56, v48, v49
v_cvt_pk_bf16_f32 v57, v50, v51
v_cvt_pk_bf16_f32 v58, v52, v53
v_cvt_pk_bf16_f32 v59, v54, v55
buffer_store_dwordx4 v[56:59], v251, s[4:7], s53 offen offset:3072 sc1
s_add_u32 s53, s53, 4096
v_accvgpr_read_b32 v0, a80
v_accvgpr_read_b32 v1, a81
v_accvgpr_read_b32 v2, a82
v_accvgpr_read_b32 v3, a83
v_accvgpr_read_b32 v4, a112
v_accvgpr_read_b32 v5, a113
v_accvgpr_read_b32 v6, a114
v_accvgpr_read_b32 v7, a115
v_cvt_pk_bf16_f32 v8, v0, v1
v_cvt_pk_bf16_f32 v9, v2, v3
v_cvt_pk_bf16_f32 v10, v4, v5
v_cvt_pk_bf16_f32 v11, v6, v7
buffer_store_dwordx4 v[8:11], v251, s[4:7], s53 offen offset:0 sc1
v_accvgpr_read_b32 v16, a84
v_accvgpr_read_b32 v17, a85
v_accvgpr_read_b32 v18, a86
v_accvgpr_read_b32 v19, a87
v_accvgpr_read_b32 v20, a116
v_accvgpr_read_b32 v21, a117
v_accvgpr_read_b32 v22, a118
v_accvgpr_read_b32 v23, a119
v_cvt_pk_bf16_f32 v24, v16, v17
v_cvt_pk_bf16_f32 v25, v18, v19
v_cvt_pk_bf16_f32 v26, v20, v21
v_cvt_pk_bf16_f32 v27, v22, v23
buffer_store_dwordx4 v[24:27], v251, s[4:7], s53 offen offset:1024 sc1
v_accvgpr_read_b32 v32, a88
v_accvgpr_read_b32 v33, a89
v_accvgpr_read_b32 v34, a90
v_accvgpr_read_b32 v35, a91
v_accvgpr_read_b32 v36, a120
v_accvgpr_read_b32 v37, a121
v_accvgpr_read_b32 v38, a122
v_accvgpr_read_b32 v39, a123
v_cvt_pk_bf16_f32 v40, v32, v33
v_cvt_pk_bf16_f32 v41, v34, v35
v_cvt_pk_bf16_f32 v42, v36, v37
v_cvt_pk_bf16_f32 v43, v38, v39
buffer_store_dwordx4 v[40:43], v251, s[4:7], s53 offen offset:2048 sc1
v_accvgpr_read_b32 v48, a92
v_accvgpr_read_b32 v49, a93
v_accvgpr_read_b32 v50, a94
v_accvgpr_read_b32 v51, a95
v_accvgpr_read_b32 v52, a124
v_accvgpr_read_b32 v53, a125
v_accvgpr_read_b32 v54, a126
v_accvgpr_read_b32 v55, a127
v_cvt_pk_bf16_f32 v56, v48, v49
v_cvt_pk_bf16_f32 v57, v50, v51
v_cvt_pk_bf16_f32 v58, v52, v53
v_cvt_pk_bf16_f32 v59, v54, v55
buffer_store_dwordx4 v[56:59], v251, s[4:7], s53 offen offset:3072 sc1
s_add_u32 s53, s53, 258048
s_branch main_kernel_w_ee
main_kernel_w_e9:
s_mov_b32 s53, s1
v_accvgpr_read_b32 v0, a0
v_accvgpr_read_b32 v1, a1
v_accvgpr_read_b32 v2, a2
v_accvgpr_read_b32 v3, a3
v_accvgpr_read_b32 v4, a4
v_accvgpr_read_b32 v5, a5
v_accvgpr_read_b32 v6, a6
v_accvgpr_read_b32 v7, a7
v_pk_mul_f32 v[8:9], v[0:1], v[0:1]
v_pk_mul_f32 v[10:11], v[2:3], v[2:3]
v_pk_mul_f32 v[12:13], v[4:5], v[4:5]
v_pk_mul_f32 v[14:15], v[6:7], v[6:7]
v_pk_fma_f32 v[8:9], v[8:9], v[242:243], v[240:241]
v_pk_fma_f32 v[10:11], v[10:11], v[242:243], v[240:241]
v_pk_fma_f32 v[12:13], v[12:13], v[242:243], v[240:241]
v_pk_fma_f32 v[14:15], v[14:15], v[242:243], v[240:241]
v_pk_mul_f32 v[8:9], v[8:9], v[0:1]
v_pk_mul_f32 v[10:11], v[10:11], v[2:3]
v_pk_mul_f32 v[12:13], v[12:13], v[4:5]
v_pk_mul_f32 v[14:15], v[14:15], v[6:7]
v_exp_f32 v8, v8
v_exp_f32 v9, v9
v_exp_f32 v10, v10
v_exp_f32 v11, v11
v_exp_f32 v12, v12
v_exp_f32 v13, v13
v_exp_f32 v14, v14
v_exp_f32 v15, v15
v_pk_add_f32 v[8:9], v[8:9], v[244:245]
v_pk_add_f32 v[10:11], v[10:11], v[244:245]
v_pk_add_f32 v[12:13], v[12:13], v[244:245]
v_pk_add_f32 v[14:15], v[14:15], v[244:245]
v_rcp_f32 v8, v8
v_rcp_f32 v9, v9
v_rcp_f32 v10, v10
v_rcp_f32 v11, v11
v_rcp_f32 v12, v12
v_rcp_f32 v13, v13
v_rcp_f32 v14, v14
v_rcp_f32 v15, v15
v_pk_mul_f32 v[0:1], v[8:9], v[0:1]
v_pk_mul_f32 v[2:3], v[10:11], v[2:3]
v_pk_mul_f32 v[4:5], v[12:13], v[4:5]
v_pk_mul_f32 v[6:7], v[14:15], v[6:7]
v_cvt_pk_bf16_f32 v16, v0, v1
v_cvt_pk_bf16_f32 v17, v2, v3
v_cvt_pk_bf16_f32 v18, v4, v5
v_cvt_pk_bf16_f32 v19, v6, v7
buffer_store_dwordx4 v[16:19], v145, s[4:7], s53 offen offset:0 sc1
v_accvgpr_read_b32 v20, a8
v_accvgpr_read_b32 v21, a9
v_accvgpr_read_b32 v22, a10
v_accvgpr_read_b32 v23, a11
v_accvgpr_read_b32 v24, a12
v_accvgpr_read_b32 v25, a13
v_accvgpr_read_b32 v26, a14
v_accvgpr_read_b32 v27, a15
v_pk_mul_f32 v[28:29], v[20:21], v[20:21]
v_pk_mul_f32 v[30:31], v[22:23], v[22:23]
v_pk_mul_f32 v[32:33], v[24:25], v[24:25]
v_pk_mul_f32 v[34:35], v[26:27], v[26:27]
v_pk_fma_f32 v[28:29], v[28:29], v[242:243], v[240:241]
v_pk_fma_f32 v[30:31], v[30:31], v[242:243], v[240:241]
v_pk_fma_f32 v[32:33], v[32:33], v[242:243], v[240:241]
v_pk_fma_f32 v[34:35], v[34:35], v[242:243], v[240:241]
v_pk_mul_f32 v[28:29], v[28:29], v[20:21]
v_pk_mul_f32 v[30:31], v[30:31], v[22:23]
v_pk_mul_f32 v[32:33], v[32:33], v[24:25]
v_pk_mul_f32 v[34:35], v[34:35], v[26:27]
v_exp_f32 v28, v28
v_exp_f32 v29, v29
v_exp_f32 v30, v30
v_exp_f32 v31, v31
v_exp_f32 v32, v32
v_exp_f32 v33, v33
v_exp_f32 v34, v34
v_exp_f32 v35, v35
v_pk_add_f32 v[28:29], v[28:29], v[244:245]
v_pk_add_f32 v[30:31], v[30:31], v[244:245]
v_pk_add_f32 v[32:33], v[32:33], v[244:245]
v_pk_add_f32 v[34:35], v[34:35], v[244:245]
v_rcp_f32 v28, v28
v_rcp_f32 v29, v29
v_rcp_f32 v30, v30
v_rcp_f32 v31, v31
v_rcp_f32 v32, v32
v_rcp_f32 v33, v33
v_rcp_f32 v34, v34
v_rcp_f32 v35, v35
v_pk_mul_f32 v[20:21], v[28:29], v[20:21]
v_pk_mul_f32 v[22:23], v[30:31], v[22:23]
v_pk_mul_f32 v[24:25], v[32:33], v[24:25]
v_pk_mul_f32 v[26:27], v[34:35], v[26:27]
v_cvt_pk_bf16_f32 v36, v20, v21
v_cvt_pk_bf16_f32 v37, v22, v23
v_cvt_pk_bf16_f32 v38, v24, v25
v_cvt_pk_bf16_f32 v39, v26, v27
buffer_store_dwordx4 v[36:39], v145, s[4:7], s53 offen offset:1024 sc1
v_accvgpr_read_b32 v40, a16
v_accvgpr_read_b32 v41, a17
v_accvgpr_read_b32 v42, a18
v_accvgpr_read_b32 v43, a19
v_accvgpr_read_b32 v44, a20
v_accvgpr_read_b32 v45, a21
v_accvgpr_read_b32 v46, a22
v_accvgpr_read_b32 v47, a23
v_pk_mul_f32 v[48:49], v[40:41], v[40:41]
v_pk_mul_f32 v[50:51], v[42:43], v[42:43]
v_pk_mul_f32 v[52:53], v[44:45], v[44:45]
v_pk_mul_f32 v[54:55], v[46:47], v[46:47]
v_pk_fma_f32 v[48:49], v[48:49], v[242:243], v[240:241]
v_pk_fma_f32 v[50:51], v[50:51], v[242:243], v[240:241]
v_pk_fma_f32 v[52:53], v[52:53], v[242:243], v[240:241]
v_pk_fma_f32 v[54:55], v[54:55], v[242:243], v[240:241]
v_pk_mul_f32 v[48:49], v[48:49], v[40:41]
v_pk_mul_f32 v[50:51], v[50:51], v[42:43]
v_pk_mul_f32 v[52:53], v[52:53], v[44:45]
v_pk_mul_f32 v[54:55], v[54:55], v[46:47]
v_exp_f32 v48, v48
v_exp_f32 v49, v49
v_exp_f32 v50, v50
v_exp_f32 v51, v51
v_exp_f32 v52, v52
v_exp_f32 v53, v53
v_exp_f32 v54, v54
v_exp_f32 v55, v55
v_pk_add_f32 v[48:49], v[48:49], v[244:245]
v_pk_add_f32 v[50:51], v[50:51], v[244:245]
v_pk_add_f32 v[52:53], v[52:53], v[244:245]
v_pk_add_f32 v[54:55], v[54:55], v[244:245]
v_rcp_f32 v48, v48
v_rcp_f32 v49, v49
v_rcp_f32 v50, v50
v_rcp_f32 v51, v51
v_rcp_f32 v52, v52
v_rcp_f32 v53, v53
v_rcp_f32 v54, v54
v_rcp_f32 v55, v55
v_pk_mul_f32 v[40:41], v[48:49], v[40:41]
v_pk_mul_f32 v[42:43], v[50:51], v[42:43]
v_pk_mul_f32 v[44:45], v[52:53], v[44:45]
v_pk_mul_f32 v[46:47], v[54:55], v[46:47]
v_cvt_pk_bf16_f32 v56, v40, v41
v_cvt_pk_bf16_f32 v57, v42, v43
v_cvt_pk_bf16_f32 v58, v44, v45
v_cvt_pk_bf16_f32 v59, v46, v47
buffer_store_dwordx4 v[56:59], v145, s[4:7], s53 offen offset:2048 sc1
v_accvgpr_read_b32 v0, a24
v_accvgpr_read_b32 v1, a25
v_accvgpr_read_b32 v2, a26
v_accvgpr_read_b32 v3, a27
v_accvgpr_read_b32 v4, a28
v_accvgpr_read_b32 v5, a29
v_accvgpr_read_b32 v6, a30
v_accvgpr_read_b32 v7, a31
v_pk_mul_f32 v[8:9], v[0:1], v[0:1]
v_pk_mul_f32 v[10:11], v[2:3], v[2:3]
v_pk_mul_f32 v[12:13], v[4:5], v[4:5]
v_pk_mul_f32 v[14:15], v[6:7], v[6:7]
v_pk_fma_f32 v[8:9], v[8:9], v[242:243], v[240:241]
v_pk_fma_f32 v[10:11], v[10:11], v[242:243], v[240:241]
v_pk_fma_f32 v[12:13], v[12:13], v[242:243], v[240:241]
v_pk_fma_f32 v[14:15], v[14:15], v[242:243], v[240:241]
v_pk_mul_f32 v[8:9], v[8:9], v[0:1]
v_pk_mul_f32 v[10:11], v[10:11], v[2:3]
v_pk_mul_f32 v[12:13], v[12:13], v[4:5]
v_pk_mul_f32 v[14:15], v[14:15], v[6:7]
v_exp_f32 v8, v8
v_exp_f32 v9, v9
v_exp_f32 v10, v10
v_exp_f32 v11, v11
v_exp_f32 v12, v12
v_exp_f32 v13, v13
v_exp_f32 v14, v14
v_exp_f32 v15, v15
v_pk_add_f32 v[8:9], v[8:9], v[244:245]
v_pk_add_f32 v[10:11], v[10:11], v[244:245]
v_pk_add_f32 v[12:13], v[12:13], v[244:245]
v_pk_add_f32 v[14:15], v[14:15], v[244:245]
v_rcp_f32 v8, v8
v_rcp_f32 v9, v9
v_rcp_f32 v10, v10
v_rcp_f32 v11, v11
v_rcp_f32 v12, v12
v_rcp_f32 v13, v13
v_rcp_f32 v14, v14
v_rcp_f32 v15, v15
v_pk_mul_f32 v[0:1], v[8:9], v[0:1]
v_pk_mul_f32 v[2:3], v[10:11], v[2:3]
v_pk_mul_f32 v[4:5], v[12:13], v[4:5]
v_pk_mul_f32 v[6:7], v[14:15], v[6:7]
v_cvt_pk_bf16_f32 v16, v0, v1
v_cvt_pk_bf16_f32 v17, v2, v3
v_cvt_pk_bf16_f32 v18, v4, v5
v_cvt_pk_bf16_f32 v19, v6, v7
buffer_store_dwordx4 v[16:19], v145, s[4:7], s53 offen offset:3072 sc1
s_add_u32 s53, s53, s2
v_accvgpr_read_b32 v20, a32
v_accvgpr_read_b32 v21, a33
v_accvgpr_read_b32 v22, a34
v_accvgpr_read_b32 v23, a35
v_accvgpr_read_b32 v24, a36
v_accvgpr_read_b32 v25, a37
v_accvgpr_read_b32 v26, a38
v_accvgpr_read_b32 v27, a39
v_pk_mul_f32 v[28:29], v[20:21], v[20:21]
v_pk_mul_f32 v[30:31], v[22:23], v[22:23]
v_pk_mul_f32 v[32:33], v[24:25], v[24:25]
v_pk_mul_f32 v[34:35], v[26:27], v[26:27]
v_pk_fma_f32 v[28:29], v[28:29], v[242:243], v[240:241]
v_pk_fma_f32 v[30:31], v[30:31], v[242:243], v[240:241]
v_pk_fma_f32 v[32:33], v[32:33], v[242:243], v[240:241]
v_pk_fma_f32 v[34:35], v[34:35], v[242:243], v[240:241]
v_pk_mul_f32 v[28:29], v[28:29], v[20:21]
v_pk_mul_f32 v[30:31], v[30:31], v[22:23]
v_pk_mul_f32 v[32:33], v[32:33], v[24:25]
v_pk_mul_f32 v[34:35], v[34:35], v[26:27]
v_exp_f32 v28, v28
v_exp_f32 v29, v29
v_exp_f32 v30, v30
v_exp_f32 v31, v31
v_exp_f32 v32, v32
v_exp_f32 v33, v33
v_exp_f32 v34, v34
v_exp_f32 v35, v35
v_pk_add_f32 v[28:29], v[28:29], v[244:245]
v_pk_add_f32 v[30:31], v[30:31], v[244:245]
v_pk_add_f32 v[32:33], v[32:33], v[244:245]
v_pk_add_f32 v[34:35], v[34:35], v[244:245]
v_rcp_f32 v28, v28
v_rcp_f32 v29, v29
v_rcp_f32 v30, v30
v_rcp_f32 v31, v31
v_rcp_f32 v32, v32
v_rcp_f32 v33, v33
v_rcp_f32 v34, v34
v_rcp_f32 v35, v35
v_pk_mul_f32 v[20:21], v[28:29], v[20:21]
v_pk_mul_f32 v[22:23], v[30:31], v[22:23]
v_pk_mul_f32 v[24:25], v[32:33], v[24:25]
v_pk_mul_f32 v[26:27], v[34:35], v[26:27]
v_cvt_pk_bf16_f32 v36, v20, v21
v_cvt_pk_bf16_f32 v37, v22, v23
v_cvt_pk_bf16_f32 v38, v24, v25
v_cvt_pk_bf16_f32 v39, v26, v27
buffer_store_dwordx4 v[36:39], v145, s[4:7], s53 offen offset:0 sc1
v_accvgpr_read_b32 v40, a40
v_accvgpr_read_b32 v41, a41
v_accvgpr_read_b32 v42, a42
v_accvgpr_read_b32 v43, a43
v_accvgpr_read_b32 v44, a44
v_accvgpr_read_b32 v45, a45
v_accvgpr_read_b32 v46, a46
v_accvgpr_read_b32 v47, a47
v_pk_mul_f32 v[48:49], v[40:41], v[40:41]
v_pk_mul_f32 v[50:51], v[42:43], v[42:43]
v_pk_mul_f32 v[52:53], v[44:45], v[44:45]
v_pk_mul_f32 v[54:55], v[46:47], v[46:47]
v_pk_fma_f32 v[48:49], v[48:49], v[242:243], v[240:241]
v_pk_fma_f32 v[50:51], v[50:51], v[242:243], v[240:241]
v_pk_fma_f32 v[52:53], v[52:53], v[242:243], v[240:241]
v_pk_fma_f32 v[54:55], v[54:55], v[242:243], v[240:241]
v_pk_mul_f32 v[48:49], v[48:49], v[40:41]
v_pk_mul_f32 v[50:51], v[50:51], v[42:43]
v_pk_mul_f32 v[52:53], v[52:53], v[44:45]
v_pk_mul_f32 v[54:55], v[54:55], v[46:47]
v_exp_f32 v48, v48
v_exp_f32 v49, v49
v_exp_f32 v50, v50
v_exp_f32 v51, v51
v_exp_f32 v52, v52
v_exp_f32 v53, v53
v_exp_f32 v54, v54
v_exp_f32 v55, v55
v_pk_add_f32 v[48:49], v[48:49], v[244:245]
v_pk_add_f32 v[50:51], v[50:51], v[244:245]
v_pk_add_f32 v[52:53], v[52:53], v[244:245]
v_pk_add_f32 v[54:55], v[54:55], v[244:245]
v_rcp_f32 v48, v48
v_rcp_f32 v49, v49
v_rcp_f32 v50, v50
v_rcp_f32 v51, v51
v_rcp_f32 v52, v52
v_rcp_f32 v53, v53
v_rcp_f32 v54, v54
v_rcp_f32 v55, v55
v_pk_mul_f32 v[40:41], v[48:49], v[40:41]
v_pk_mul_f32 v[42:43], v[50:51], v[42:43]
v_pk_mul_f32 v[44:45], v[52:53], v[44:45]
v_pk_mul_f32 v[46:47], v[54:55], v[46:47]
v_cvt_pk_bf16_f32 v56, v40, v41
v_cvt_pk_bf16_f32 v57, v42, v43
v_cvt_pk_bf16_f32 v58, v44, v45
v_cvt_pk_bf16_f32 v59, v46, v47
buffer_store_dwordx4 v[56:59], v145, s[4:7], s53 offen offset:1024 sc1
v_accvgpr_read_b32 v0, a48
v_accvgpr_read_b32 v1, a49
v_accvgpr_read_b32 v2, a50
v_accvgpr_read_b32 v3, a51
v_accvgpr_read_b32 v4, a52
v_accvgpr_read_b32 v5, a53
v_accvgpr_read_b32 v6, a54
v_accvgpr_read_b32 v7, a55
v_pk_mul_f32 v[8:9], v[0:1], v[0:1]
v_pk_mul_f32 v[10:11], v[2:3], v[2:3]
v_pk_mul_f32 v[12:13], v[4:5], v[4:5]
v_pk_mul_f32 v[14:15], v[6:7], v[6:7]
v_pk_fma_f32 v[8:9], v[8:9], v[242:243], v[240:241]
v_pk_fma_f32 v[10:11], v[10:11], v[242:243], v[240:241]
v_pk_fma_f32 v[12:13], v[12:13], v[242:243], v[240:241]
v_pk_fma_f32 v[14:15], v[14:15], v[242:243], v[240:241]
v_pk_mul_f32 v[8:9], v[8:9], v[0:1]
v_pk_mul_f32 v[10:11], v[10:11], v[2:3]
v_pk_mul_f32 v[12:13], v[12:13], v[4:5]
v_pk_mul_f32 v[14:15], v[14:15], v[6:7]
v_exp_f32 v8, v8
v_exp_f32 v9, v9
v_exp_f32 v10, v10
v_exp_f32 v11, v11
v_exp_f32 v12, v12
v_exp_f32 v13, v13
v_exp_f32 v14, v14
v_exp_f32 v15, v15
v_pk_add_f32 v[8:9], v[8:9], v[244:245]
v_pk_add_f32 v[10:11], v[10:11], v[244:245]
v_pk_add_f32 v[12:13], v[12:13], v[244:245]
v_pk_add_f32 v[14:15], v[14:15], v[244:245]
v_rcp_f32 v8, v8
v_rcp_f32 v9, v9
v_rcp_f32 v10, v10
v_rcp_f32 v11, v11
v_rcp_f32 v12, v12
v_rcp_f32 v13, v13
v_rcp_f32 v14, v14
v_rcp_f32 v15, v15
v_pk_mul_f32 v[0:1], v[8:9], v[0:1]
v_pk_mul_f32 v[2:3], v[10:11], v[2:3]
v_pk_mul_f32 v[4:5], v[12:13], v[4:5]
v_pk_mul_f32 v[6:7], v[14:15], v[6:7]
v_cvt_pk_bf16_f32 v16, v0, v1
v_cvt_pk_bf16_f32 v17, v2, v3
v_cvt_pk_bf16_f32 v18, v4, v5
v_cvt_pk_bf16_f32 v19, v6, v7
buffer_store_dwordx4 v[16:19], v145, s[4:7], s53 offen offset:2048 sc1
v_accvgpr_read_b32 v20, a56
v_accvgpr_read_b32 v21, a57
v_accvgpr_read_b32 v22, a58
v_accvgpr_read_b32 v23, a59
v_accvgpr_read_b32 v24, a60
v_accvgpr_read_b32 v25, a61
v_accvgpr_read_b32 v26, a62
v_accvgpr_read_b32 v27, a63
v_pk_mul_f32 v[28:29], v[20:21], v[20:21]
v_pk_mul_f32 v[30:31], v[22:23], v[22:23]
v_pk_mul_f32 v[32:33], v[24:25], v[24:25]
v_pk_mul_f32 v[34:35], v[26:27], v[26:27]
v_pk_fma_f32 v[28:29], v[28:29], v[242:243], v[240:241]
v_pk_fma_f32 v[30:31], v[30:31], v[242:243], v[240:241]
v_pk_fma_f32 v[32:33], v[32:33], v[242:243], v[240:241]
v_pk_fma_f32 v[34:35], v[34:35], v[242:243], v[240:241]
v_pk_mul_f32 v[28:29], v[28:29], v[20:21]
v_pk_mul_f32 v[30:31], v[30:31], v[22:23]
v_pk_mul_f32 v[32:33], v[32:33], v[24:25]
v_pk_mul_f32 v[34:35], v[34:35], v[26:27]
v_exp_f32 v28, v28
v_exp_f32 v29, v29
v_exp_f32 v30, v30
v_exp_f32 v31, v31
v_exp_f32 v32, v32
v_exp_f32 v33, v33
v_exp_f32 v34, v34
v_exp_f32 v35, v35
v_pk_add_f32 v[28:29], v[28:29], v[244:245]
v_pk_add_f32 v[30:31], v[30:31], v[244:245]
v_pk_add_f32 v[32:33], v[32:33], v[244:245]
v_pk_add_f32 v[34:35], v[34:35], v[244:245]
v_rcp_f32 v28, v28
v_rcp_f32 v29, v29
v_rcp_f32 v30, v30
v_rcp_f32 v31, v31
v_rcp_f32 v32, v32
v_rcp_f32 v33, v33
v_rcp_f32 v34, v34
v_rcp_f32 v35, v35
v_pk_mul_f32 v[20:21], v[28:29], v[20:21]
v_pk_mul_f32 v[22:23], v[30:31], v[22:23]
v_pk_mul_f32 v[24:25], v[32:33], v[24:25]
v_pk_mul_f32 v[26:27], v[34:35], v[26:27]
v_cvt_pk_bf16_f32 v36, v20, v21
v_cvt_pk_bf16_f32 v37, v22, v23
v_cvt_pk_bf16_f32 v38, v24, v25
v_cvt_pk_bf16_f32 v39, v26, v27
buffer_store_dwordx4 v[36:39], v145, s[4:7], s53 offen offset:3072 sc1
s_add_u32 s53, s53, s2
v_accvgpr_read_b32 v40, a64
v_accvgpr_read_b32 v41, a65
v_accvgpr_read_b32 v42, a66
v_accvgpr_read_b32 v43, a67
v_accvgpr_read_b32 v44, a68
v_accvgpr_read_b32 v45, a69
v_accvgpr_read_b32 v46, a70
v_accvgpr_read_b32 v47, a71
v_pk_mul_f32 v[48:49], v[40:41], v[40:41]
v_pk_mul_f32 v[50:51], v[42:43], v[42:43]
v_pk_mul_f32 v[52:53], v[44:45], v[44:45]
v_pk_mul_f32 v[54:55], v[46:47], v[46:47]
v_pk_fma_f32 v[48:49], v[48:49], v[242:243], v[240:241]
v_pk_fma_f32 v[50:51], v[50:51], v[242:243], v[240:241]
v_pk_fma_f32 v[52:53], v[52:53], v[242:243], v[240:241]
v_pk_fma_f32 v[54:55], v[54:55], v[242:243], v[240:241]
v_pk_mul_f32 v[48:49], v[48:49], v[40:41]
v_pk_mul_f32 v[50:51], v[50:51], v[42:43]
v_pk_mul_f32 v[52:53], v[52:53], v[44:45]
v_pk_mul_f32 v[54:55], v[54:55], v[46:47]
v_exp_f32 v48, v48
v_exp_f32 v49, v49
v_exp_f32 v50, v50
v_exp_f32 v51, v51
v_exp_f32 v52, v52
v_exp_f32 v53, v53
v_exp_f32 v54, v54
v_exp_f32 v55, v55
v_pk_add_f32 v[48:49], v[48:49], v[244:245]
v_pk_add_f32 v[50:51], v[50:51], v[244:245]
v_pk_add_f32 v[52:53], v[52:53], v[244:245]
v_pk_add_f32 v[54:55], v[54:55], v[244:245]
v_rcp_f32 v48, v48
v_rcp_f32 v49, v49
v_rcp_f32 v50, v50
v_rcp_f32 v51, v51
v_rcp_f32 v52, v52
v_rcp_f32 v53, v53
v_rcp_f32 v54, v54
v_rcp_f32 v55, v55
v_pk_mul_f32 v[40:41], v[48:49], v[40:41]
v_pk_mul_f32 v[42:43], v[50:51], v[42:43]
v_pk_mul_f32 v[44:45], v[52:53], v[44:45]
v_pk_mul_f32 v[46:47], v[54:55], v[46:47]
v_cvt_pk_bf16_f32 v56, v40, v41
v_cvt_pk_bf16_f32 v57, v42, v43
v_cvt_pk_bf16_f32 v58, v44, v45
v_cvt_pk_bf16_f32 v59, v46, v47
buffer_store_dwordx4 v[56:59], v145, s[4:7], s53 offen offset:0 sc1
v_accvgpr_read_b32 v0, a72
v_accvgpr_read_b32 v1, a73
v_accvgpr_read_b32 v2, a74
v_accvgpr_read_b32 v3, a75
v_accvgpr_read_b32 v4, a76
v_accvgpr_read_b32 v5, a77
v_accvgpr_read_b32 v6, a78
v_accvgpr_read_b32 v7, a79
v_pk_mul_f32 v[8:9], v[0:1], v[0:1]
v_pk_mul_f32 v[10:11], v[2:3], v[2:3]
v_pk_mul_f32 v[12:13], v[4:5], v[4:5]
v_pk_mul_f32 v[14:15], v[6:7], v[6:7]
v_pk_fma_f32 v[8:9], v[8:9], v[242:243], v[240:241]
v_pk_fma_f32 v[10:11], v[10:11], v[242:243], v[240:241]
v_pk_fma_f32 v[12:13], v[12:13], v[242:243], v[240:241]
v_pk_fma_f32 v[14:15], v[14:15], v[242:243], v[240:241]
v_pk_mul_f32 v[8:9], v[8:9], v[0:1]
v_pk_mul_f32 v[10:11], v[10:11], v[2:3]
v_pk_mul_f32 v[12:13], v[12:13], v[4:5]
v_pk_mul_f32 v[14:15], v[14:15], v[6:7]
v_exp_f32 v8, v8
v_exp_f32 v9, v9
v_exp_f32 v10, v10
v_exp_f32 v11, v11
v_exp_f32 v12, v12
v_exp_f32 v13, v13
v_exp_f32 v14, v14
v_exp_f32 v15, v15
v_pk_add_f32 v[8:9], v[8:9], v[244:245]
v_pk_add_f32 v[10:11], v[10:11], v[244:245]
v_pk_add_f32 v[12:13], v[12:13], v[244:245]
v_pk_add_f32 v[14:15], v[14:15], v[244:245]
v_rcp_f32 v8, v8
v_rcp_f32 v9, v9
v_rcp_f32 v10, v10
v_rcp_f32 v11, v11
v_rcp_f32 v12, v12
v_rcp_f32 v13, v13
v_rcp_f32 v14, v14
v_rcp_f32 v15, v15
v_pk_mul_f32 v[0:1], v[8:9], v[0:1]
v_pk_mul_f32 v[2:3], v[10:11], v[2:3]
v_pk_mul_f32 v[4:5], v[12:13], v[4:5]
v_pk_mul_f32 v[6:7], v[14:15], v[6:7]
v_cvt_pk_bf16_f32 v16, v0, v1
v_cvt_pk_bf16_f32 v17, v2, v3
v_cvt_pk_bf16_f32 v18, v4, v5
v_cvt_pk_bf16_f32 v19, v6, v7
buffer_store_dwordx4 v[16:19], v145, s[4:7], s53 offen offset:1024 sc1
v_accvgpr_read_b32 v20, a80
v_accvgpr_read_b32 v21, a81
v_accvgpr_read_b32 v22, a82
v_accvgpr_read_b32 v23, a83
v_accvgpr_read_b32 v24, a84
v_accvgpr_read_b32 v25, a85
v_accvgpr_read_b32 v26, a86
v_accvgpr_read_b32 v27, a87
v_pk_mul_f32 v[28:29], v[20:21], v[20:21]
v_pk_mul_f32 v[30:31], v[22:23], v[22:23]
v_pk_mul_f32 v[32:33], v[24:25], v[24:25]
v_pk_mul_f32 v[34:35], v[26:27], v[26:27]
v_pk_fma_f32 v[28:29], v[28:29], v[242:243], v[240:241]
v_pk_fma_f32 v[30:31], v[30:31], v[242:243], v[240:241]
v_pk_fma_f32 v[32:33], v[32:33], v[242:243], v[240:241]
v_pk_fma_f32 v[34:35], v[34:35], v[242:243], v[240:241]
v_pk_mul_f32 v[28:29], v[28:29], v[20:21]
v_pk_mul_f32 v[30:31], v[30:31], v[22:23]
v_pk_mul_f32 v[32:33], v[32:33], v[24:25]
v_pk_mul_f32 v[34:35], v[34:35], v[26:27]
v_exp_f32 v28, v28
v_exp_f32 v29, v29
v_exp_f32 v30, v30
v_exp_f32 v31, v31
v_exp_f32 v32, v32
v_exp_f32 v33, v33
v_exp_f32 v34, v34
v_exp_f32 v35, v35
v_pk_add_f32 v[28:29], v[28:29], v[244:245]
v_pk_add_f32 v[30:31], v[30:31], v[244:245]
v_pk_add_f32 v[32:33], v[32:33], v[244:245]
v_pk_add_f32 v[34:35], v[34:35], v[244:245]
v_rcp_f32 v28, v28
v_rcp_f32 v29, v29
v_rcp_f32 v30, v30
v_rcp_f32 v31, v31
v_rcp_f32 v32, v32
v_rcp_f32 v33, v33
v_rcp_f32 v34, v34
v_rcp_f32 v35, v35
v_pk_mul_f32 v[20:21], v[28:29], v[20:21]
v_pk_mul_f32 v[22:23], v[30:31], v[22:23]
v_pk_mul_f32 v[24:25], v[32:33], v[24:25]
v_pk_mul_f32 v[26:27], v[34:35], v[26:27]
v_cvt_pk_bf16_f32 v36, v20, v21
v_cvt_pk_bf16_f32 v37, v22, v23
v_cvt_pk_bf16_f32 v38, v24, v25
v_cvt_pk_bf16_f32 v39, v26, v27
buffer_store_dwordx4 v[36:39], v145, s[4:7], s53 offen offset:2048 sc1
v_accvgpr_read_b32 v40, a88
v_accvgpr_read_b32 v41, a89
v_accvgpr_read_b32 v42, a90
v_accvgpr_read_b32 v43, a91
v_accvgpr_read_b32 v44, a92
v_accvgpr_read_b32 v45, a93
v_accvgpr_read_b32 v46, a94
v_accvgpr_read_b32 v47, a95
v_pk_mul_f32 v[48:49], v[40:41], v[40:41]
v_pk_mul_f32 v[50:51], v[42:43], v[42:43]
v_pk_mul_f32 v[52:53], v[44:45], v[44:45]
v_pk_mul_f32 v[54:55], v[46:47], v[46:47]
v_pk_fma_f32 v[48:49], v[48:49], v[242:243], v[240:241]
v_pk_fma_f32 v[50:51], v[50:51], v[242:243], v[240:241]
v_pk_fma_f32 v[52:53], v[52:53], v[242:243], v[240:241]
v_pk_fma_f32 v[54:55], v[54:55], v[242:243], v[240:241]
v_pk_mul_f32 v[48:49], v[48:49], v[40:41]
v_pk_mul_f32 v[50:51], v[50:51], v[42:43]
v_pk_mul_f32 v[52:53], v[52:53], v[44:45]
v_pk_mul_f32 v[54:55], v[54:55], v[46:47]
v_exp_f32 v48, v48
v_exp_f32 v49, v49
v_exp_f32 v50, v50
v_exp_f32 v51, v51
v_exp_f32 v52, v52
v_exp_f32 v53, v53
v_exp_f32 v54, v54
v_exp_f32 v55, v55
v_pk_add_f32 v[48:49], v[48:49], v[244:245]
v_pk_add_f32 v[50:51], v[50:51], v[244:245]
v_pk_add_f32 v[52:53], v[52:53], v[244:245]
v_pk_add_f32 v[54:55], v[54:55], v[244:245]
v_rcp_f32 v48, v48
v_rcp_f32 v49, v49
v_rcp_f32 v50, v50
v_rcp_f32 v51, v51
v_rcp_f32 v52, v52
v_rcp_f32 v53, v53
v_rcp_f32 v54, v54
v_rcp_f32 v55, v55
v_pk_mul_f32 v[40:41], v[48:49], v[40:41]
v_pk_mul_f32 v[42:43], v[50:51], v[42:43]
v_pk_mul_f32 v[44:45], v[52:53], v[44:45]
v_pk_mul_f32 v[46:47], v[54:55], v[46:47]
v_cvt_pk_bf16_f32 v56, v40, v41
v_cvt_pk_bf16_f32 v57, v42, v43
v_cvt_pk_bf16_f32 v58, v44, v45
v_cvt_pk_bf16_f32 v59, v46, v47
buffer_store_dwordx4 v[56:59], v145, s[4:7], s53 offen offset:3072 sc1
s_add_u32 s53, s53, s2
v_accvgpr_read_b32 v0, a96
v_accvgpr_read_b32 v1, a97
v_accvgpr_read_b32 v2, a98
v_accvgpr_read_b32 v3, a99
v_accvgpr_read_b32 v4, a100
v_accvgpr_read_b32 v5, a101
v_accvgpr_read_b32 v6, a102
v_accvgpr_read_b32 v7, a103
v_pk_mul_f32 v[8:9], v[0:1], v[0:1]
v_pk_mul_f32 v[10:11], v[2:3], v[2:3]
v_pk_mul_f32 v[12:13], v[4:5], v[4:5]
v_pk_mul_f32 v[14:15], v[6:7], v[6:7]
v_pk_fma_f32 v[8:9], v[8:9], v[242:243], v[240:241]
v_pk_fma_f32 v[10:11], v[10:11], v[242:243], v[240:241]
v_pk_fma_f32 v[12:13], v[12:13], v[242:243], v[240:241]
v_pk_fma_f32 v[14:15], v[14:15], v[242:243], v[240:241]
v_pk_mul_f32 v[8:9], v[8:9], v[0:1]
v_pk_mul_f32 v[10:11], v[10:11], v[2:3]
v_pk_mul_f32 v[12:13], v[12:13], v[4:5]
v_pk_mul_f32 v[14:15], v[14:15], v[6:7]
v_exp_f32 v8, v8
v_exp_f32 v9, v9
v_exp_f32 v10, v10
v_exp_f32 v11, v11
v_exp_f32 v12, v12
v_exp_f32 v13, v13
v_exp_f32 v14, v14
v_exp_f32 v15, v15
v_pk_add_f32 v[8:9], v[8:9], v[244:245]
v_pk_add_f32 v[10:11], v[10:11], v[244:245]
v_pk_add_f32 v[12:13], v[12:13], v[244:245]
v_pk_add_f32 v[14:15], v[14:15], v[244:245]
v_rcp_f32 v8, v8
v_rcp_f32 v9, v9
v_rcp_f32 v10, v10
v_rcp_f32 v11, v11
v_rcp_f32 v12, v12
v_rcp_f32 v13, v13
v_rcp_f32 v14, v14
v_rcp_f32 v15, v15
v_pk_mul_f32 v[0:1], v[8:9], v[0:1]
v_pk_mul_f32 v[2:3], v[10:11], v[2:3]
v_pk_mul_f32 v[4:5], v[12:13], v[4:5]
v_pk_mul_f32 v[6:7], v[14:15], v[6:7]
v_cvt_pk_bf16_f32 v16, v0, v1
v_cvt_pk_bf16_f32 v17, v2, v3
v_cvt_pk_bf16_f32 v18, v4, v5
v_cvt_pk_bf16_f32 v19, v6, v7
buffer_store_dwordx4 v[16:19], v145, s[4:7], s53 offen offset:0 sc1
v_accvgpr_read_b32 v20, a104
v_accvgpr_read_b32 v21, a105
v_accvgpr_read_b32 v22, a106
v_accvgpr_read_b32 v23, a107
v_accvgpr_read_b32 v24, a108
v_accvgpr_read_b32 v25, a109
v_accvgpr_read_b32 v26, a110
v_accvgpr_read_b32 v27, a111
v_pk_mul_f32 v[28:29], v[20:21], v[20:21]
v_pk_mul_f32 v[30:31], v[22:23], v[22:23]
v_pk_mul_f32 v[32:33], v[24:25], v[24:25]
v_pk_mul_f32 v[34:35], v[26:27], v[26:27]
v_pk_fma_f32 v[28:29], v[28:29], v[242:243], v[240:241]
v_pk_fma_f32 v[30:31], v[30:31], v[242:243], v[240:241]
v_pk_fma_f32 v[32:33], v[32:33], v[242:243], v[240:241]
v_pk_fma_f32 v[34:35], v[34:35], v[242:243], v[240:241]
v_pk_mul_f32 v[28:29], v[28:29], v[20:21]
v_pk_mul_f32 v[30:31], v[30:31], v[22:23]
v_pk_mul_f32 v[32:33], v[32:33], v[24:25]
v_pk_mul_f32 v[34:35], v[34:35], v[26:27]
v_exp_f32 v28, v28
v_exp_f32 v29, v29
v_exp_f32 v30, v30
v_exp_f32 v31, v31
v_exp_f32 v32, v32
v_exp_f32 v33, v33
v_exp_f32 v34, v34
v_exp_f32 v35, v35
v_pk_add_f32 v[28:29], v[28:29], v[244:245]
v_pk_add_f32 v[30:31], v[30:31], v[244:245]
v_pk_add_f32 v[32:33], v[32:33], v[244:245]
v_pk_add_f32 v[34:35], v[34:35], v[244:245]
v_rcp_f32 v28, v28
v_rcp_f32 v29, v29
v_rcp_f32 v30, v30
v_rcp_f32 v31, v31
v_rcp_f32 v32, v32
v_rcp_f32 v33, v33
v_rcp_f32 v34, v34
v_rcp_f32 v35, v35
v_pk_mul_f32 v[20:21], v[28:29], v[20:21]
v_pk_mul_f32 v[22:23], v[30:31], v[22:23]
v_pk_mul_f32 v[24:25], v[32:33], v[24:25]
v_pk_mul_f32 v[26:27], v[34:35], v[26:27]
v_cvt_pk_bf16_f32 v36, v20, v21
v_cvt_pk_bf16_f32 v37, v22, v23
v_cvt_pk_bf16_f32 v38, v24, v25
v_cvt_pk_bf16_f32 v39, v26, v27
buffer_store_dwordx4 v[36:39], v145, s[4:7], s53 offen offset:1024 sc1
v_accvgpr_read_b32 v40, a112
v_accvgpr_read_b32 v41, a113
v_accvgpr_read_b32 v42, a114
v_accvgpr_read_b32 v43, a115
v_accvgpr_read_b32 v44, a116
v_accvgpr_read_b32 v45, a117
v_accvgpr_read_b32 v46, a118
v_accvgpr_read_b32 v47, a119
v_pk_mul_f32 v[48:49], v[40:41], v[40:41]
v_pk_mul_f32 v[50:51], v[42:43], v[42:43]
v_pk_mul_f32 v[52:53], v[44:45], v[44:45]
v_pk_mul_f32 v[54:55], v[46:47], v[46:47]
v_pk_fma_f32 v[48:49], v[48:49], v[242:243], v[240:241]
v_pk_fma_f32 v[50:51], v[50:51], v[242:243], v[240:241]
v_pk_fma_f32 v[52:53], v[52:53], v[242:243], v[240:241]
v_pk_fma_f32 v[54:55], v[54:55], v[242:243], v[240:241]
v_pk_mul_f32 v[48:49], v[48:49], v[40:41]
v_pk_mul_f32 v[50:51], v[50:51], v[42:43]
v_pk_mul_f32 v[52:53], v[52:53], v[44:45]
v_pk_mul_f32 v[54:55], v[54:55], v[46:47]
v_exp_f32 v48, v48
v_exp_f32 v49, v49
v_exp_f32 v50, v50
v_exp_f32 v51, v51
v_exp_f32 v52, v52
v_exp_f32 v53, v53
v_exp_f32 v54, v54
v_exp_f32 v55, v55
v_pk_add_f32 v[48:49], v[48:49], v[244:245]
v_pk_add_f32 v[50:51], v[50:51], v[244:245]
v_pk_add_f32 v[52:53], v[52:53], v[244:245]
v_pk_add_f32 v[54:55], v[54:55], v[244:245]
v_rcp_f32 v48, v48
v_rcp_f32 v49, v49
v_rcp_f32 v50, v50
v_rcp_f32 v51, v51
v_rcp_f32 v52, v52
v_rcp_f32 v53, v53
v_rcp_f32 v54, v54
v_rcp_f32 v55, v55
v_pk_mul_f32 v[40:41], v[48:49], v[40:41]
v_pk_mul_f32 v[42:43], v[50:51], v[42:43]
v_pk_mul_f32 v[44:45], v[52:53], v[44:45]
v_pk_mul_f32 v[46:47], v[54:55], v[46:47]
v_cvt_pk_bf16_f32 v56, v40, v41
v_cvt_pk_bf16_f32 v57, v42, v43
v_cvt_pk_bf16_f32 v58, v44, v45
v_cvt_pk_bf16_f32 v59, v46, v47
buffer_store_dwordx4 v[56:59], v145, s[4:7], s53 offen offset:2048 sc1
v_accvgpr_read_b32 v0, a120
v_accvgpr_read_b32 v1, a121
v_accvgpr_read_b32 v2, a122
v_accvgpr_read_b32 v3, a123
v_accvgpr_read_b32 v4, a124
v_accvgpr_read_b32 v5, a125
v_accvgpr_read_b32 v6, a126
v_accvgpr_read_b32 v7, a127
v_pk_mul_f32 v[8:9], v[0:1], v[0:1]
v_pk_mul_f32 v[10:11], v[2:3], v[2:3]
v_pk_mul_f32 v[12:13], v[4:5], v[4:5]
v_pk_mul_f32 v[14:15], v[6:7], v[6:7]
v_pk_fma_f32 v[8:9], v[8:9], v[242:243], v[240:241]
v_pk_fma_f32 v[10:11], v[10:11], v[242:243], v[240:241]
v_pk_fma_f32 v[12:13], v[12:13], v[242:243], v[240:241]
v_pk_fma_f32 v[14:15], v[14:15], v[242:243], v[240:241]
v_pk_mul_f32 v[8:9], v[8:9], v[0:1]
v_pk_mul_f32 v[10:11], v[10:11], v[2:3]
v_pk_mul_f32 v[12:13], v[12:13], v[4:5]
v_pk_mul_f32 v[14:15], v[14:15], v[6:7]
v_exp_f32 v8, v8
v_exp_f32 v9, v9
v_exp_f32 v10, v10
v_exp_f32 v11, v11
v_exp_f32 v12, v12
v_exp_f32 v13, v13
v_exp_f32 v14, v14
v_exp_f32 v15, v15
v_pk_add_f32 v[8:9], v[8:9], v[244:245]
v_pk_add_f32 v[10:11], v[10:11], v[244:245]
v_pk_add_f32 v[12:13], v[12:13], v[244:245]
v_pk_add_f32 v[14:15], v[14:15], v[244:245]
v_rcp_f32 v8, v8
v_rcp_f32 v9, v9
v_rcp_f32 v10, v10
v_rcp_f32 v11, v11
v_rcp_f32 v12, v12
v_rcp_f32 v13, v13
v_rcp_f32 v14, v14
v_rcp_f32 v15, v15
v_pk_mul_f32 v[0:1], v[8:9], v[0:1]
v_pk_mul_f32 v[2:3], v[10:11], v[2:3]
v_pk_mul_f32 v[4:5], v[12:13], v[4:5]
v_pk_mul_f32 v[6:7], v[14:15], v[6:7]
v_cvt_pk_bf16_f32 v16, v0, v1
v_cvt_pk_bf16_f32 v17, v2, v3
v_cvt_pk_bf16_f32 v18, v4, v5
v_cvt_pk_bf16_f32 v19, v6, v7
buffer_store_dwordx4 v[16:19], v145, s[4:7], s53 offen offset:3072 sc1
s_branch main_kernel_w_ee
main_kernel_w_e10:
s_mov_b32 s53, s1
v_accvgpr_read_b32 v0, a0
v_accvgpr_read_b32 v1, a1
v_accvgpr_read_b32 v2, a2
v_accvgpr_read_b32 v3, a3
v_accvgpr_read_b32 v4, a4
v_accvgpr_read_b32 v5, a5
v_accvgpr_read_b32 v6, a6
v_accvgpr_read_b32 v7, a7
v_pk_mul_f32 v[8:9], v[0:1], v[0:1]
v_pk_mul_f32 v[10:11], v[2:3], v[2:3]
v_pk_mul_f32 v[12:13], v[4:5], v[4:5]
v_pk_mul_f32 v[14:15], v[6:7], v[6:7]
v_pk_fma_f32 v[8:9], v[8:9], v[242:243], v[240:241]
v_pk_fma_f32 v[10:11], v[10:11], v[242:243], v[240:241]
v_pk_fma_f32 v[12:13], v[12:13], v[242:243], v[240:241]
v_pk_fma_f32 v[14:15], v[14:15], v[242:243], v[240:241]
v_pk_mul_f32 v[8:9], v[8:9], v[0:1]
v_pk_mul_f32 v[10:11], v[10:11], v[2:3]
v_pk_mul_f32 v[12:13], v[12:13], v[4:5]
v_pk_mul_f32 v[14:15], v[14:15], v[6:7]
v_exp_f32 v8, v8
v_exp_f32 v9, v9
v_exp_f32 v10, v10
v_exp_f32 v11, v11
v_exp_f32 v12, v12
v_exp_f32 v13, v13
v_exp_f32 v14, v14
v_exp_f32 v15, v15
v_pk_add_f32 v[8:9], v[8:9], v[244:245]
v_pk_add_f32 v[10:11], v[10:11], v[244:245]
v_pk_add_f32 v[12:13], v[12:13], v[244:245]
v_pk_add_f32 v[14:15], v[14:15], v[244:245]
v_rcp_f32 v8, v8
v_rcp_f32 v9, v9
v_rcp_f32 v10, v10
v_rcp_f32 v11, v11
v_rcp_f32 v12, v12
v_rcp_f32 v13, v13
v_rcp_f32 v14, v14
v_rcp_f32 v15, v15
v_pk_mul_f32 v[0:1], v[8:9], v[0:1]
v_pk_mul_f32 v[2:3], v[10:11], v[2:3]
v_pk_mul_f32 v[4:5], v[12:13], v[4:5]
v_pk_mul_f32 v[6:7], v[14:15], v[6:7]
v_cvt_pk_bf16_f32 v16, v0, v1
v_cvt_pk_bf16_f32 v17, v2, v3
v_cvt_pk_bf16_f32 v18, v4, v5
v_cvt_pk_bf16_f32 v19, v6, v7
buffer_store_dwordx4 v[16:19], v251, s[4:7], s53 offen offset:0 sc1
v_accvgpr_read_b32 v20, a8
v_accvgpr_read_b32 v21, a9
v_accvgpr_read_b32 v22, a10
v_accvgpr_read_b32 v23, a11
v_accvgpr_read_b32 v24, a12
v_accvgpr_read_b32 v25, a13
v_accvgpr_read_b32 v26, a14
v_accvgpr_read_b32 v27, a15
v_pk_mul_f32 v[28:29], v[20:21], v[20:21]
v_pk_mul_f32 v[30:31], v[22:23], v[22:23]
v_pk_mul_f32 v[32:33], v[24:25], v[24:25]
v_pk_mul_f32 v[34:35], v[26:27], v[26:27]
v_pk_fma_f32 v[28:29], v[28:29], v[242:243], v[240:241]
v_pk_fma_f32 v[30:31], v[30:31], v[242:243], v[240:241]
v_pk_fma_f32 v[32:33], v[32:33], v[242:243], v[240:241]
v_pk_fma_f32 v[34:35], v[34:35], v[242:243], v[240:241]
v_pk_mul_f32 v[28:29], v[28:29], v[20:21]
v_pk_mul_f32 v[30:31], v[30:31], v[22:23]
v_pk_mul_f32 v[32:33], v[32:33], v[24:25]
v_pk_mul_f32 v[34:35], v[34:35], v[26:27]
v_exp_f32 v28, v28
v_exp_f32 v29, v29
v_exp_f32 v30, v30
v_exp_f32 v31, v31
v_exp_f32 v32, v32
v_exp_f32 v33, v33
v_exp_f32 v34, v34
v_exp_f32 v35, v35
v_pk_add_f32 v[28:29], v[28:29], v[244:245]
v_pk_add_f32 v[30:31], v[30:31], v[244:245]
v_pk_add_f32 v[32:33], v[32:33], v[244:245]
v_pk_add_f32 v[34:35], v[34:35], v[244:245]
v_rcp_f32 v28, v28
v_rcp_f32 v29, v29
v_rcp_f32 v30, v30
v_rcp_f32 v31, v31
v_rcp_f32 v32, v32
v_rcp_f32 v33, v33
v_rcp_f32 v34, v34
v_rcp_f32 v35, v35
v_pk_mul_f32 v[20:21], v[28:29], v[20:21]
v_pk_mul_f32 v[22:23], v[30:31], v[22:23]
v_pk_mul_f32 v[24:25], v[32:33], v[24:25]
v_pk_mul_f32 v[26:27], v[34:35], v[26:27]
v_cvt_pk_bf16_f32 v36, v20, v21
v_cvt_pk_bf16_f32 v37, v22, v23
v_cvt_pk_bf16_f32 v38, v24, v25
v_cvt_pk_bf16_f32 v39, v26, v27
buffer_store_dwordx4 v[36:39], v251, s[4:7], s53 offen offset:1024 sc1
v_accvgpr_read_b32 v40, a16
v_accvgpr_read_b32 v41, a17
v_accvgpr_read_b32 v42, a18
v_accvgpr_read_b32 v43, a19
v_accvgpr_read_b32 v44, a20
v_accvgpr_read_b32 v45, a21
v_accvgpr_read_b32 v46, a22
v_accvgpr_read_b32 v47, a23
v_pk_mul_f32 v[48:49], v[40:41], v[40:41]
v_pk_mul_f32 v[50:51], v[42:43], v[42:43]
v_pk_mul_f32 v[52:53], v[44:45], v[44:45]
v_pk_mul_f32 v[54:55], v[46:47], v[46:47]
v_pk_fma_f32 v[48:49], v[48:49], v[242:243], v[240:241]
v_pk_fma_f32 v[50:51], v[50:51], v[242:243], v[240:241]
v_pk_fma_f32 v[52:53], v[52:53], v[242:243], v[240:241]
v_pk_fma_f32 v[54:55], v[54:55], v[242:243], v[240:241]
v_pk_mul_f32 v[48:49], v[48:49], v[40:41]
v_pk_mul_f32 v[50:51], v[50:51], v[42:43]
v_pk_mul_f32 v[52:53], v[52:53], v[44:45]
v_pk_mul_f32 v[54:55], v[54:55], v[46:47]
v_exp_f32 v48, v48
v_exp_f32 v49, v49
v_exp_f32 v50, v50
v_exp_f32 v51, v51
v_exp_f32 v52, v52
v_exp_f32 v53, v53
v_exp_f32 v54, v54
v_exp_f32 v55, v55
v_pk_add_f32 v[48:49], v[48:49], v[244:245]
v_pk_add_f32 v[50:51], v[50:51], v[244:245]
v_pk_add_f32 v[52:53], v[52:53], v[244:245]
v_pk_add_f32 v[54:55], v[54:55], v[244:245]
v_rcp_f32 v48, v48
v_rcp_f32 v49, v49
v_rcp_f32 v50, v50
v_rcp_f32 v51, v51
v_rcp_f32 v52, v52
v_rcp_f32 v53, v53
v_rcp_f32 v54, v54
v_rcp_f32 v55, v55
v_pk_mul_f32 v[40:41], v[48:49], v[40:41]
v_pk_mul_f32 v[42:43], v[50:51], v[42:43]
v_pk_mul_f32 v[44:45], v[52:53], v[44:45]
v_pk_mul_f32 v[46:47], v[54:55], v[46:47]
v_cvt_pk_bf16_f32 v56, v40, v41
v_cvt_pk_bf16_f32 v57, v42, v43
v_cvt_pk_bf16_f32 v58, v44, v45
v_cvt_pk_bf16_f32 v59, v46, v47
buffer_store_dwordx4 v[56:59], v251, s[4:7], s53 offen offset:2048 sc1
v_accvgpr_read_b32 v0, a24
v_accvgpr_read_b32 v1, a25
v_accvgpr_read_b32 v2, a26
v_accvgpr_read_b32 v3, a27
v_accvgpr_read_b32 v4, a28
v_accvgpr_read_b32 v5, a29
v_accvgpr_read_b32 v6, a30
v_accvgpr_read_b32 v7, a31
v_pk_mul_f32 v[8:9], v[0:1], v[0:1]
v_pk_mul_f32 v[10:11], v[2:3], v[2:3]
v_pk_mul_f32 v[12:13], v[4:5], v[4:5]
v_pk_mul_f32 v[14:15], v[6:7], v[6:7]
v_pk_fma_f32 v[8:9], v[8:9], v[242:243], v[240:241]
v_pk_fma_f32 v[10:11], v[10:11], v[242:243], v[240:241]
v_pk_fma_f32 v[12:13], v[12:13], v[242:243], v[240:241]
v_pk_fma_f32 v[14:15], v[14:15], v[242:243], v[240:241]
v_pk_mul_f32 v[8:9], v[8:9], v[0:1]
v_pk_mul_f32 v[10:11], v[10:11], v[2:3]
v_pk_mul_f32 v[12:13], v[12:13], v[4:5]
v_pk_mul_f32 v[14:15], v[14:15], v[6:7]
v_exp_f32 v8, v8
v_exp_f32 v9, v9
v_exp_f32 v10, v10
v_exp_f32 v11, v11
v_exp_f32 v12, v12
v_exp_f32 v13, v13
v_exp_f32 v14, v14
v_exp_f32 v15, v15
v_pk_add_f32 v[8:9], v[8:9], v[244:245]
v_pk_add_f32 v[10:11], v[10:11], v[244:245]
v_pk_add_f32 v[12:13], v[12:13], v[244:245]
v_pk_add_f32 v[14:15], v[14:15], v[244:245]
v_rcp_f32 v8, v8
v_rcp_f32 v9, v9
v_rcp_f32 v10, v10
v_rcp_f32 v11, v11
v_rcp_f32 v12, v12
v_rcp_f32 v13, v13
v_rcp_f32 v14, v14
v_rcp_f32 v15, v15
v_pk_mul_f32 v[0:1], v[8:9], v[0:1]
v_pk_mul_f32 v[2:3], v[10:11], v[2:3]
v_pk_mul_f32 v[4:5], v[12:13], v[4:5]
v_pk_mul_f32 v[6:7], v[14:15], v[6:7]
v_cvt_pk_bf16_f32 v16, v0, v1
v_cvt_pk_bf16_f32 v17, v2, v3
v_cvt_pk_bf16_f32 v18, v4, v5
v_cvt_pk_bf16_f32 v19, v6, v7
buffer_store_dwordx4 v[16:19], v251, s[4:7], s53 offen offset:3072 sc1
s_add_u32 s53, s53, s2
v_accvgpr_read_b32 v20, a32
v_accvgpr_read_b32 v21, a33
v_accvgpr_read_b32 v22, a34
v_accvgpr_read_b32 v23, a35
v_accvgpr_read_b32 v24, a36
v_accvgpr_read_b32 v25, a37
v_accvgpr_read_b32 v26, a38
v_accvgpr_read_b32 v27, a39
v_pk_mul_f32 v[28:29], v[20:21], v[20:21]
v_pk_mul_f32 v[30:31], v[22:23], v[22:23]
v_pk_mul_f32 v[32:33], v[24:25], v[24:25]
v_pk_mul_f32 v[34:35], v[26:27], v[26:27]
v_pk_fma_f32 v[28:29], v[28:29], v[242:243], v[240:241]
v_pk_fma_f32 v[30:31], v[30:31], v[242:243], v[240:241]
v_pk_fma_f32 v[32:33], v[32:33], v[242:243], v[240:241]
v_pk_fma_f32 v[34:35], v[34:35], v[242:243], v[240:241]
v_pk_mul_f32 v[28:29], v[28:29], v[20:21]
v_pk_mul_f32 v[30:31], v[30:31], v[22:23]
v_pk_mul_f32 v[32:33], v[32:33], v[24:25]
v_pk_mul_f32 v[34:35], v[34:35], v[26:27]
v_exp_f32 v28, v28
v_exp_f32 v29, v29
v_exp_f32 v30, v30
v_exp_f32 v31, v31
v_exp_f32 v32, v32
v_exp_f32 v33, v33
v_exp_f32 v34, v34
v_exp_f32 v35, v35
v_pk_add_f32 v[28:29], v[28:29], v[244:245]
v_pk_add_f32 v[30:31], v[30:31], v[244:245]
v_pk_add_f32 v[32:33], v[32:33], v[244:245]
v_pk_add_f32 v[34:35], v[34:35], v[244:245]
v_rcp_f32 v28, v28
v_rcp_f32 v29, v29
v_rcp_f32 v30, v30
v_rcp_f32 v31, v31
v_rcp_f32 v32, v32
v_rcp_f32 v33, v33
v_rcp_f32 v34, v34
v_rcp_f32 v35, v35
v_pk_mul_f32 v[20:21], v[28:29], v[20:21]
v_pk_mul_f32 v[22:23], v[30:31], v[22:23]
v_pk_mul_f32 v[24:25], v[32:33], v[24:25]
v_pk_mul_f32 v[26:27], v[34:35], v[26:27]
v_cvt_pk_bf16_f32 v36, v20, v21
v_cvt_pk_bf16_f32 v37, v22, v23
v_cvt_pk_bf16_f32 v38, v24, v25
v_cvt_pk_bf16_f32 v39, v26, v27
buffer_store_dwordx4 v[36:39], v251, s[4:7], s53 offen offset:0 sc1
v_accvgpr_read_b32 v40, a40
v_accvgpr_read_b32 v41, a41
v_accvgpr_read_b32 v42, a42
v_accvgpr_read_b32 v43, a43
v_accvgpr_read_b32 v44, a44
v_accvgpr_read_b32 v45, a45
v_accvgpr_read_b32 v46, a46
v_accvgpr_read_b32 v47, a47
v_pk_mul_f32 v[48:49], v[40:41], v[40:41]
v_pk_mul_f32 v[50:51], v[42:43], v[42:43]
v_pk_mul_f32 v[52:53], v[44:45], v[44:45]
v_pk_mul_f32 v[54:55], v[46:47], v[46:47]
v_pk_fma_f32 v[48:49], v[48:49], v[242:243], v[240:241]
v_pk_fma_f32 v[50:51], v[50:51], v[242:243], v[240:241]
v_pk_fma_f32 v[52:53], v[52:53], v[242:243], v[240:241]
v_pk_fma_f32 v[54:55], v[54:55], v[242:243], v[240:241]
v_pk_mul_f32 v[48:49], v[48:49], v[40:41]
v_pk_mul_f32 v[50:51], v[50:51], v[42:43]
v_pk_mul_f32 v[52:53], v[52:53], v[44:45]
v_pk_mul_f32 v[54:55], v[54:55], v[46:47]
v_exp_f32 v48, v48
v_exp_f32 v49, v49
v_exp_f32 v50, v50
v_exp_f32 v51, v51
v_exp_f32 v52, v52
v_exp_f32 v53, v53
v_exp_f32 v54, v54
v_exp_f32 v55, v55
v_pk_add_f32 v[48:49], v[48:49], v[244:245]
v_pk_add_f32 v[50:51], v[50:51], v[244:245]
v_pk_add_f32 v[52:53], v[52:53], v[244:245]
v_pk_add_f32 v[54:55], v[54:55], v[244:245]
v_rcp_f32 v48, v48
v_rcp_f32 v49, v49
v_rcp_f32 v50, v50
v_rcp_f32 v51, v51
v_rcp_f32 v52, v52
v_rcp_f32 v53, v53
v_rcp_f32 v54, v54
v_rcp_f32 v55, v55
v_pk_mul_f32 v[40:41], v[48:49], v[40:41]
v_pk_mul_f32 v[42:43], v[50:51], v[42:43]
v_pk_mul_f32 v[44:45], v[52:53], v[44:45]
v_pk_mul_f32 v[46:47], v[54:55], v[46:47]
v_cvt_pk_bf16_f32 v56, v40, v41
v_cvt_pk_bf16_f32 v57, v42, v43
v_cvt_pk_bf16_f32 v58, v44, v45
v_cvt_pk_bf16_f32 v59, v46, v47
buffer_store_dwordx4 v[56:59], v251, s[4:7], s53 offen offset:1024 sc1
v_accvgpr_read_b32 v0, a48
v_accvgpr_read_b32 v1, a49
v_accvgpr_read_b32 v2, a50
v_accvgpr_read_b32 v3, a51
v_accvgpr_read_b32 v4, a52
v_accvgpr_read_b32 v5, a53
v_accvgpr_read_b32 v6, a54
v_accvgpr_read_b32 v7, a55
v_pk_mul_f32 v[8:9], v[0:1], v[0:1]
v_pk_mul_f32 v[10:11], v[2:3], v[2:3]
v_pk_mul_f32 v[12:13], v[4:5], v[4:5]
v_pk_mul_f32 v[14:15], v[6:7], v[6:7]
v_pk_fma_f32 v[8:9], v[8:9], v[242:243], v[240:241]
v_pk_fma_f32 v[10:11], v[10:11], v[242:243], v[240:241]
v_pk_fma_f32 v[12:13], v[12:13], v[242:243], v[240:241]
v_pk_fma_f32 v[14:15], v[14:15], v[242:243], v[240:241]
v_pk_mul_f32 v[8:9], v[8:9], v[0:1]
v_pk_mul_f32 v[10:11], v[10:11], v[2:3]
v_pk_mul_f32 v[12:13], v[12:13], v[4:5]
v_pk_mul_f32 v[14:15], v[14:15], v[6:7]
v_exp_f32 v8, v8
v_exp_f32 v9, v9
v_exp_f32 v10, v10
v_exp_f32 v11, v11
v_exp_f32 v12, v12
v_exp_f32 v13, v13
v_exp_f32 v14, v14
v_exp_f32 v15, v15
v_pk_add_f32 v[8:9], v[8:9], v[244:245]
v_pk_add_f32 v[10:11], v[10:11], v[244:245]
v_pk_add_f32 v[12:13], v[12:13], v[244:245]
v_pk_add_f32 v[14:15], v[14:15], v[244:245]
v_rcp_f32 v8, v8
v_rcp_f32 v9, v9
v_rcp_f32 v10, v10
v_rcp_f32 v11, v11
v_rcp_f32 v12, v12
v_rcp_f32 v13, v13
v_rcp_f32 v14, v14
v_rcp_f32 v15, v15
v_pk_mul_f32 v[0:1], v[8:9], v[0:1]
v_pk_mul_f32 v[2:3], v[10:11], v[2:3]
v_pk_mul_f32 v[4:5], v[12:13], v[4:5]
v_pk_mul_f32 v[6:7], v[14:15], v[6:7]
v_cvt_pk_bf16_f32 v16, v0, v1
v_cvt_pk_bf16_f32 v17, v2, v3
v_cvt_pk_bf16_f32 v18, v4, v5
v_cvt_pk_bf16_f32 v19, v6, v7
buffer_store_dwordx4 v[16:19], v251, s[4:7], s53 offen offset:2048 sc1
v_accvgpr_read_b32 v20, a56
v_accvgpr_read_b32 v21, a57
v_accvgpr_read_b32 v22, a58
v_accvgpr_read_b32 v23, a59
v_accvgpr_read_b32 v24, a60
v_accvgpr_read_b32 v25, a61
v_accvgpr_read_b32 v26, a62
v_accvgpr_read_b32 v27, a63
v_pk_mul_f32 v[28:29], v[20:21], v[20:21]
v_pk_mul_f32 v[30:31], v[22:23], v[22:23]
v_pk_mul_f32 v[32:33], v[24:25], v[24:25]
v_pk_mul_f32 v[34:35], v[26:27], v[26:27]
v_pk_fma_f32 v[28:29], v[28:29], v[242:243], v[240:241]
v_pk_fma_f32 v[30:31], v[30:31], v[242:243], v[240:241]
v_pk_fma_f32 v[32:33], v[32:33], v[242:243], v[240:241]
v_pk_fma_f32 v[34:35], v[34:35], v[242:243], v[240:241]
v_pk_mul_f32 v[28:29], v[28:29], v[20:21]
v_pk_mul_f32 v[30:31], v[30:31], v[22:23]
v_pk_mul_f32 v[32:33], v[32:33], v[24:25]
v_pk_mul_f32 v[34:35], v[34:35], v[26:27]
v_exp_f32 v28, v28
v_exp_f32 v29, v29
v_exp_f32 v30, v30
v_exp_f32 v31, v31
v_exp_f32 v32, v32
v_exp_f32 v33, v33
v_exp_f32 v34, v34
v_exp_f32 v35, v35
v_pk_add_f32 v[28:29], v[28:29], v[244:245]
v_pk_add_f32 v[30:31], v[30:31], v[244:245]
v_pk_add_f32 v[32:33], v[32:33], v[244:245]
v_pk_add_f32 v[34:35], v[34:35], v[244:245]
v_rcp_f32 v28, v28
v_rcp_f32 v29, v29
v_rcp_f32 v30, v30
v_rcp_f32 v31, v31
v_rcp_f32 v32, v32
v_rcp_f32 v33, v33
v_rcp_f32 v34, v34
v_rcp_f32 v35, v35
v_pk_mul_f32 v[20:21], v[28:29], v[20:21]
v_pk_mul_f32 v[22:23], v[30:31], v[22:23]
v_pk_mul_f32 v[24:25], v[32:33], v[24:25]
v_pk_mul_f32 v[26:27], v[34:35], v[26:27]
v_cvt_pk_bf16_f32 v36, v20, v21
v_cvt_pk_bf16_f32 v37, v22, v23
v_cvt_pk_bf16_f32 v38, v24, v25
v_cvt_pk_bf16_f32 v39, v26, v27
buffer_store_dwordx4 v[36:39], v251, s[4:7], s53 offen offset:3072 sc1
s_add_u32 s53, s53, s2
v_accvgpr_read_b32 v40, a64
v_accvgpr_read_b32 v41, a65
v_accvgpr_read_b32 v42, a66
v_accvgpr_read_b32 v43, a67
v_accvgpr_read_b32 v44, a68
v_accvgpr_read_b32 v45, a69
v_accvgpr_read_b32 v46, a70
v_accvgpr_read_b32 v47, a71
v_pk_mul_f32 v[48:49], v[40:41], v[40:41]
v_pk_mul_f32 v[50:51], v[42:43], v[42:43]
v_pk_mul_f32 v[52:53], v[44:45], v[44:45]
v_pk_mul_f32 v[54:55], v[46:47], v[46:47]
v_pk_fma_f32 v[48:49], v[48:49], v[242:243], v[240:241]
v_pk_fma_f32 v[50:51], v[50:51], v[242:243], v[240:241]
v_pk_fma_f32 v[52:53], v[52:53], v[242:243], v[240:241]
v_pk_fma_f32 v[54:55], v[54:55], v[242:243], v[240:241]
v_pk_mul_f32 v[48:49], v[48:49], v[40:41]
v_pk_mul_f32 v[50:51], v[50:51], v[42:43]
v_pk_mul_f32 v[52:53], v[52:53], v[44:45]
v_pk_mul_f32 v[54:55], v[54:55], v[46:47]
v_exp_f32 v48, v48
v_exp_f32 v49, v49
v_exp_f32 v50, v50
v_exp_f32 v51, v51
v_exp_f32 v52, v52
v_exp_f32 v53, v53
v_exp_f32 v54, v54
v_exp_f32 v55, v55
v_pk_add_f32 v[48:49], v[48:49], v[244:245]
v_pk_add_f32 v[50:51], v[50:51], v[244:245]
v_pk_add_f32 v[52:53], v[52:53], v[244:245]
v_pk_add_f32 v[54:55], v[54:55], v[244:245]
v_rcp_f32 v48, v48
v_rcp_f32 v49, v49
v_rcp_f32 v50, v50
v_rcp_f32 v51, v51
v_rcp_f32 v52, v52
v_rcp_f32 v53, v53
v_rcp_f32 v54, v54
v_rcp_f32 v55, v55
v_pk_mul_f32 v[40:41], v[48:49], v[40:41]
v_pk_mul_f32 v[42:43], v[50:51], v[42:43]
v_pk_mul_f32 v[44:45], v[52:53], v[44:45]
v_pk_mul_f32 v[46:47], v[54:55], v[46:47]
v_cvt_pk_bf16_f32 v56, v40, v41
v_cvt_pk_bf16_f32 v57, v42, v43
v_cvt_pk_bf16_f32 v58, v44, v45
v_cvt_pk_bf16_f32 v59, v46, v47
buffer_store_dwordx4 v[56:59], v251, s[4:7], s53 offen offset:0 sc1
v_accvgpr_read_b32 v0, a72
v_accvgpr_read_b32 v1, a73
v_accvgpr_read_b32 v2, a74
v_accvgpr_read_b32 v3, a75
v_accvgpr_read_b32 v4, a76
v_accvgpr_read_b32 v5, a77
v_accvgpr_read_b32 v6, a78
v_accvgpr_read_b32 v7, a79
v_pk_mul_f32 v[8:9], v[0:1], v[0:1]
v_pk_mul_f32 v[10:11], v[2:3], v[2:3]
v_pk_mul_f32 v[12:13], v[4:5], v[4:5]
v_pk_mul_f32 v[14:15], v[6:7], v[6:7]
v_pk_fma_f32 v[8:9], v[8:9], v[242:243], v[240:241]
v_pk_fma_f32 v[10:11], v[10:11], v[242:243], v[240:241]
v_pk_fma_f32 v[12:13], v[12:13], v[242:243], v[240:241]
v_pk_fma_f32 v[14:15], v[14:15], v[242:243], v[240:241]
v_pk_mul_f32 v[8:9], v[8:9], v[0:1]
v_pk_mul_f32 v[10:11], v[10:11], v[2:3]
v_pk_mul_f32 v[12:13], v[12:13], v[4:5]
v_pk_mul_f32 v[14:15], v[14:15], v[6:7]
v_exp_f32 v8, v8
v_exp_f32 v9, v9
v_exp_f32 v10, v10
v_exp_f32 v11, v11
v_exp_f32 v12, v12
v_exp_f32 v13, v13
v_exp_f32 v14, v14
v_exp_f32 v15, v15
v_pk_add_f32 v[8:9], v[8:9], v[244:245]
v_pk_add_f32 v[10:11], v[10:11], v[244:245]
v_pk_add_f32 v[12:13], v[12:13], v[244:245]
v_pk_add_f32 v[14:15], v[14:15], v[244:245]
v_rcp_f32 v8, v8
v_rcp_f32 v9, v9
v_rcp_f32 v10, v10
v_rcp_f32 v11, v11
v_rcp_f32 v12, v12
v_rcp_f32 v13, v13
v_rcp_f32 v14, v14
v_rcp_f32 v15, v15
v_pk_mul_f32 v[0:1], v[8:9], v[0:1]
v_pk_mul_f32 v[2:3], v[10:11], v[2:3]
v_pk_mul_f32 v[4:5], v[12:13], v[4:5]
v_pk_mul_f32 v[6:7], v[14:15], v[6:7]
v_cvt_pk_bf16_f32 v16, v0, v1
v_cvt_pk_bf16_f32 v17, v2, v3
v_cvt_pk_bf16_f32 v18, v4, v5
v_cvt_pk_bf16_f32 v19, v6, v7
buffer_store_dwordx4 v[16:19], v251, s[4:7], s53 offen offset:1024 sc1
v_accvgpr_read_b32 v20, a80
v_accvgpr_read_b32 v21, a81
v_accvgpr_read_b32 v22, a82
v_accvgpr_read_b32 v23, a83
v_accvgpr_read_b32 v24, a84
v_accvgpr_read_b32 v25, a85
v_accvgpr_read_b32 v26, a86
v_accvgpr_read_b32 v27, a87
v_pk_mul_f32 v[28:29], v[20:21], v[20:21]
v_pk_mul_f32 v[30:31], v[22:23], v[22:23]
v_pk_mul_f32 v[32:33], v[24:25], v[24:25]
v_pk_mul_f32 v[34:35], v[26:27], v[26:27]
v_pk_fma_f32 v[28:29], v[28:29], v[242:243], v[240:241]
v_pk_fma_f32 v[30:31], v[30:31], v[242:243], v[240:241]
v_pk_fma_f32 v[32:33], v[32:33], v[242:243], v[240:241]
v_pk_fma_f32 v[34:35], v[34:35], v[242:243], v[240:241]
v_pk_mul_f32 v[28:29], v[28:29], v[20:21]
v_pk_mul_f32 v[30:31], v[30:31], v[22:23]
v_pk_mul_f32 v[32:33], v[32:33], v[24:25]
v_pk_mul_f32 v[34:35], v[34:35], v[26:27]
v_exp_f32 v28, v28
v_exp_f32 v29, v29
v_exp_f32 v30, v30
v_exp_f32 v31, v31
v_exp_f32 v32, v32
v_exp_f32 v33, v33
v_exp_f32 v34, v34
v_exp_f32 v35, v35
v_pk_add_f32 v[28:29], v[28:29], v[244:245]
v_pk_add_f32 v[30:31], v[30:31], v[244:245]
v_pk_add_f32 v[32:33], v[32:33], v[244:245]
v_pk_add_f32 v[34:35], v[34:35], v[244:245]
v_rcp_f32 v28, v28
v_rcp_f32 v29, v29
v_rcp_f32 v30, v30
v_rcp_f32 v31, v31
v_rcp_f32 v32, v32
v_rcp_f32 v33, v33
v_rcp_f32 v34, v34
v_rcp_f32 v35, v35
v_pk_mul_f32 v[20:21], v[28:29], v[20:21]
v_pk_mul_f32 v[22:23], v[30:31], v[22:23]
v_pk_mul_f32 v[24:25], v[32:33], v[24:25]
v_pk_mul_f32 v[26:27], v[34:35], v[26:27]
v_cvt_pk_bf16_f32 v36, v20, v21
v_cvt_pk_bf16_f32 v37, v22, v23
v_cvt_pk_bf16_f32 v38, v24, v25
v_cvt_pk_bf16_f32 v39, v26, v27
buffer_store_dwordx4 v[36:39], v251, s[4:7], s53 offen offset:2048 sc1
v_accvgpr_read_b32 v40, a88
v_accvgpr_read_b32 v41, a89
v_accvgpr_read_b32 v42, a90
v_accvgpr_read_b32 v43, a91
v_accvgpr_read_b32 v44, a92
v_accvgpr_read_b32 v45, a93
v_accvgpr_read_b32 v46, a94
v_accvgpr_read_b32 v47, a95
v_pk_mul_f32 v[48:49], v[40:41], v[40:41]
v_pk_mul_f32 v[50:51], v[42:43], v[42:43]
v_pk_mul_f32 v[52:53], v[44:45], v[44:45]
v_pk_mul_f32 v[54:55], v[46:47], v[46:47]
v_pk_fma_f32 v[48:49], v[48:49], v[242:243], v[240:241]
v_pk_fma_f32 v[50:51], v[50:51], v[242:243], v[240:241]
v_pk_fma_f32 v[52:53], v[52:53], v[242:243], v[240:241]
v_pk_fma_f32 v[54:55], v[54:55], v[242:243], v[240:241]
v_pk_mul_f32 v[48:49], v[48:49], v[40:41]
v_pk_mul_f32 v[50:51], v[50:51], v[42:43]
v_pk_mul_f32 v[52:53], v[52:53], v[44:45]
v_pk_mul_f32 v[54:55], v[54:55], v[46:47]
v_exp_f32 v48, v48
v_exp_f32 v49, v49
v_exp_f32 v50, v50
v_exp_f32 v51, v51
v_exp_f32 v52, v52
v_exp_f32 v53, v53
v_exp_f32 v54, v54
v_exp_f32 v55, v55
v_pk_add_f32 v[48:49], v[48:49], v[244:245]
v_pk_add_f32 v[50:51], v[50:51], v[244:245]
v_pk_add_f32 v[52:53], v[52:53], v[244:245]
v_pk_add_f32 v[54:55], v[54:55], v[244:245]
v_rcp_f32 v48, v48
v_rcp_f32 v49, v49
v_rcp_f32 v50, v50
v_rcp_f32 v51, v51
v_rcp_f32 v52, v52
v_rcp_f32 v53, v53
v_rcp_f32 v54, v54
v_rcp_f32 v55, v55
v_pk_mul_f32 v[40:41], v[48:49], v[40:41]
v_pk_mul_f32 v[42:43], v[50:51], v[42:43]
v_pk_mul_f32 v[44:45], v[52:53], v[44:45]
v_pk_mul_f32 v[46:47], v[54:55], v[46:47]
v_cvt_pk_bf16_f32 v56, v40, v41
v_cvt_pk_bf16_f32 v57, v42, v43
v_cvt_pk_bf16_f32 v58, v44, v45
v_cvt_pk_bf16_f32 v59, v46, v47
buffer_store_dwordx4 v[56:59], v251, s[4:7], s53 offen offset:3072 sc1
s_add_u32 s53, s53, s2
v_accvgpr_read_b32 v0, a96
v_accvgpr_read_b32 v1, a97
v_accvgpr_read_b32 v2, a98
v_accvgpr_read_b32 v3, a99
v_accvgpr_read_b32 v4, a100
v_accvgpr_read_b32 v5, a101
v_accvgpr_read_b32 v6, a102
v_accvgpr_read_b32 v7, a103
v_pk_mul_f32 v[8:9], v[0:1], v[0:1]
v_pk_mul_f32 v[10:11], v[2:3], v[2:3]
v_pk_mul_f32 v[12:13], v[4:5], v[4:5]
v_pk_mul_f32 v[14:15], v[6:7], v[6:7]
v_pk_fma_f32 v[8:9], v[8:9], v[242:243], v[240:241]
v_pk_fma_f32 v[10:11], v[10:11], v[242:243], v[240:241]
v_pk_fma_f32 v[12:13], v[12:13], v[242:243], v[240:241]
v_pk_fma_f32 v[14:15], v[14:15], v[242:243], v[240:241]
v_pk_mul_f32 v[8:9], v[8:9], v[0:1]
v_pk_mul_f32 v[10:11], v[10:11], v[2:3]
v_pk_mul_f32 v[12:13], v[12:13], v[4:5]
v_pk_mul_f32 v[14:15], v[14:15], v[6:7]
v_exp_f32 v8, v8
v_exp_f32 v9, v9
v_exp_f32 v10, v10
v_exp_f32 v11, v11
v_exp_f32 v12, v12
v_exp_f32 v13, v13
v_exp_f32 v14, v14
v_exp_f32 v15, v15
v_pk_add_f32 v[8:9], v[8:9], v[244:245]
v_pk_add_f32 v[10:11], v[10:11], v[244:245]
v_pk_add_f32 v[12:13], v[12:13], v[244:245]
v_pk_add_f32 v[14:15], v[14:15], v[244:245]
v_rcp_f32 v8, v8
v_rcp_f32 v9, v9
v_rcp_f32 v10, v10
v_rcp_f32 v11, v11
v_rcp_f32 v12, v12
v_rcp_f32 v13, v13
v_rcp_f32 v14, v14
v_rcp_f32 v15, v15
v_pk_mul_f32 v[0:1], v[8:9], v[0:1]
v_pk_mul_f32 v[2:3], v[10:11], v[2:3]
v_pk_mul_f32 v[4:5], v[12:13], v[4:5]
v_pk_mul_f32 v[6:7], v[14:15], v[6:7]
v_cvt_pk_bf16_f32 v16, v0, v1
v_cvt_pk_bf16_f32 v17, v2, v3
v_cvt_pk_bf16_f32 v18, v4, v5
v_cvt_pk_bf16_f32 v19, v6, v7
buffer_store_dwordx4 v[16:19], v251, s[4:7], s53 offen offset:0 sc1
v_accvgpr_read_b32 v20, a104
v_accvgpr_read_b32 v21, a105
v_accvgpr_read_b32 v22, a106
v_accvgpr_read_b32 v23, a107
v_accvgpr_read_b32 v24, a108
v_accvgpr_read_b32 v25, a109
v_accvgpr_read_b32 v26, a110
v_accvgpr_read_b32 v27, a111
v_pk_mul_f32 v[28:29], v[20:21], v[20:21]
v_pk_mul_f32 v[30:31], v[22:23], v[22:23]
v_pk_mul_f32 v[32:33], v[24:25], v[24:25]
v_pk_mul_f32 v[34:35], v[26:27], v[26:27]
v_pk_fma_f32 v[28:29], v[28:29], v[242:243], v[240:241]
v_pk_fma_f32 v[30:31], v[30:31], v[242:243], v[240:241]
v_pk_fma_f32 v[32:33], v[32:33], v[242:243], v[240:241]
v_pk_fma_f32 v[34:35], v[34:35], v[242:243], v[240:241]
v_pk_mul_f32 v[28:29], v[28:29], v[20:21]
v_pk_mul_f32 v[30:31], v[30:31], v[22:23]
v_pk_mul_f32 v[32:33], v[32:33], v[24:25]
v_pk_mul_f32 v[34:35], v[34:35], v[26:27]
v_exp_f32 v28, v28
v_exp_f32 v29, v29
v_exp_f32 v30, v30
v_exp_f32 v31, v31
v_exp_f32 v32, v32
v_exp_f32 v33, v33
v_exp_f32 v34, v34
v_exp_f32 v35, v35
v_pk_add_f32 v[28:29], v[28:29], v[244:245]
v_pk_add_f32 v[30:31], v[30:31], v[244:245]
v_pk_add_f32 v[32:33], v[32:33], v[244:245]
v_pk_add_f32 v[34:35], v[34:35], v[244:245]
v_rcp_f32 v28, v28
v_rcp_f32 v29, v29
v_rcp_f32 v30, v30
v_rcp_f32 v31, v31
v_rcp_f32 v32, v32
v_rcp_f32 v33, v33
v_rcp_f32 v34, v34
v_rcp_f32 v35, v35
v_pk_mul_f32 v[20:21], v[28:29], v[20:21]
v_pk_mul_f32 v[22:23], v[30:31], v[22:23]
v_pk_mul_f32 v[24:25], v[32:33], v[24:25]
v_pk_mul_f32 v[26:27], v[34:35], v[26:27]
v_cvt_pk_bf16_f32 v36, v20, v21
v_cvt_pk_bf16_f32 v37, v22, v23
v_cvt_pk_bf16_f32 v38, v24, v25
v_cvt_pk_bf16_f32 v39, v26, v27
buffer_store_dwordx4 v[36:39], v251, s[4:7], s53 offen offset:1024 sc1
v_accvgpr_read_b32 v40, a112
v_accvgpr_read_b32 v41, a113
v_accvgpr_read_b32 v42, a114
v_accvgpr_read_b32 v43, a115
v_accvgpr_read_b32 v44, a116
v_accvgpr_read_b32 v45, a117
v_accvgpr_read_b32 v46, a118
v_accvgpr_read_b32 v47, a119
v_pk_mul_f32 v[48:49], v[40:41], v[40:41]
v_pk_mul_f32 v[50:51], v[42:43], v[42:43]
v_pk_mul_f32 v[52:53], v[44:45], v[44:45]
v_pk_mul_f32 v[54:55], v[46:47], v[46:47]
v_pk_fma_f32 v[48:49], v[48:49], v[242:243], v[240:241]
v_pk_fma_f32 v[50:51], v[50:51], v[242:243], v[240:241]
v_pk_fma_f32 v[52:53], v[52:53], v[242:243], v[240:241]
v_pk_fma_f32 v[54:55], v[54:55], v[242:243], v[240:241]
v_pk_mul_f32 v[48:49], v[48:49], v[40:41]
v_pk_mul_f32 v[50:51], v[50:51], v[42:43]
v_pk_mul_f32 v[52:53], v[52:53], v[44:45]
v_pk_mul_f32 v[54:55], v[54:55], v[46:47]
v_exp_f32 v48, v48
v_exp_f32 v49, v49
v_exp_f32 v50, v50
v_exp_f32 v51, v51
v_exp_f32 v52, v52
v_exp_f32 v53, v53
v_exp_f32 v54, v54
v_exp_f32 v55, v55
v_pk_add_f32 v[48:49], v[48:49], v[244:245]
v_pk_add_f32 v[50:51], v[50:51], v[244:245]
v_pk_add_f32 v[52:53], v[52:53], v[244:245]
v_pk_add_f32 v[54:55], v[54:55], v[244:245]
v_rcp_f32 v48, v48
v_rcp_f32 v49, v49
v_rcp_f32 v50, v50
v_rcp_f32 v51, v51
v_rcp_f32 v52, v52
v_rcp_f32 v53, v53
v_rcp_f32 v54, v54
v_rcp_f32 v55, v55
v_pk_mul_f32 v[40:41], v[48:49], v[40:41]
v_pk_mul_f32 v[42:43], v[50:51], v[42:43]
v_pk_mul_f32 v[44:45], v[52:53], v[44:45]
v_pk_mul_f32 v[46:47], v[54:55], v[46:47]
v_cvt_pk_bf16_f32 v56, v40, v41
v_cvt_pk_bf16_f32 v57, v42, v43
v_cvt_pk_bf16_f32 v58, v44, v45
v_cvt_pk_bf16_f32 v59, v46, v47
buffer_store_dwordx4 v[56:59], v251, s[4:7], s53 offen offset:2048 sc1
v_accvgpr_read_b32 v0, a120
v_accvgpr_read_b32 v1, a121
v_accvgpr_read_b32 v2, a122
v_accvgpr_read_b32 v3, a123
v_accvgpr_read_b32 v4, a124
v_accvgpr_read_b32 v5, a125
v_accvgpr_read_b32 v6, a126
v_accvgpr_read_b32 v7, a127
v_pk_mul_f32 v[8:9], v[0:1], v[0:1]
v_pk_mul_f32 v[10:11], v[2:3], v[2:3]
v_pk_mul_f32 v[12:13], v[4:5], v[4:5]
v_pk_mul_f32 v[14:15], v[6:7], v[6:7]
v_pk_fma_f32 v[8:9], v[8:9], v[242:243], v[240:241]
v_pk_fma_f32 v[10:11], v[10:11], v[242:243], v[240:241]
v_pk_fma_f32 v[12:13], v[12:13], v[242:243], v[240:241]
v_pk_fma_f32 v[14:15], v[14:15], v[242:243], v[240:241]
v_pk_mul_f32 v[8:9], v[8:9], v[0:1]
v_pk_mul_f32 v[10:11], v[10:11], v[2:3]
v_pk_mul_f32 v[12:13], v[12:13], v[4:5]
v_pk_mul_f32 v[14:15], v[14:15], v[6:7]
v_exp_f32 v8, v8
v_exp_f32 v9, v9
v_exp_f32 v10, v10
v_exp_f32 v11, v11
v_exp_f32 v12, v12
v_exp_f32 v13, v13
v_exp_f32 v14, v14
v_exp_f32 v15, v15
v_pk_add_f32 v[8:9], v[8:9], v[244:245]
v_pk_add_f32 v[10:11], v[10:11], v[244:245]
v_pk_add_f32 v[12:13], v[12:13], v[244:245]
v_pk_add_f32 v[14:15], v[14:15], v[244:245]
v_rcp_f32 v8, v8
v_rcp_f32 v9, v9
v_rcp_f32 v10, v10
v_rcp_f32 v11, v11
v_rcp_f32 v12, v12
v_rcp_f32 v13, v13
v_rcp_f32 v14, v14
v_rcp_f32 v15, v15
v_pk_mul_f32 v[0:1], v[8:9], v[0:1]
v_pk_mul_f32 v[2:3], v[10:11], v[2:3]
v_pk_mul_f32 v[4:5], v[12:13], v[4:5]
v_pk_mul_f32 v[6:7], v[14:15], v[6:7]
v_cvt_pk_bf16_f32 v16, v0, v1
v_cvt_pk_bf16_f32 v17, v2, v3
v_cvt_pk_bf16_f32 v18, v4, v5
v_cvt_pk_bf16_f32 v19, v6, v7
buffer_store_dwordx4 v[16:19], v251, s[4:7], s53 offen offset:3072 sc1
main_kernel_w_ee:
s_cmp_eq_u32 s58, 0
s_cbranch_scc1 main_kernel_w_c0_n_ent
s_cmp_eq_u32 s58, 1
s_cbranch_scc1 main_kernel_w_c0_v_ent
s_cmp_eq_u32 s58, 2
s_cbranch_scc1 main_kernel_w_c1_n_ent
s_cmp_eq_u32 s58, 3
s_cbranch_scc1 main_kernel_w_c1_v_ent
s_branch main_kernel_w_drain
main_kernel_w_pref:
s_cmp_lg_u32 s24, 0
s_cbranch_scc1 main_kernel_w_pf0
s_mov_b32 s8, s64
s_and_b32 s9, s65, 0xffff
s_mov_b32 s10, 0x200000
s_mov_b32 s11, 0x20000
s_branch main_kernel_w_pfg
main_kernel_w_pf0:
s_cmp_lg_u32 s24, 1
s_cbranch_scc1 main_kernel_w_pf1
s_mov_b32 s8, s66
s_and_b32 s9, s67, 0xffff
s_mov_b32 s10, 0x200000
s_mov_b32 s11, 0x20000
s_branch main_kernel_w_pfg
main_kernel_w_pf1:
s_cmp_lg_u32 s24, 2
s_cbranch_scc1 main_kernel_w_pf2
s_mov_b32 s8, s68
s_and_b32 s9, s69, 0xffff
s_mov_b32 s10, 0x700000
s_mov_b32 s11, 0x20000
s_branch main_kernel_w_pfg
main_kernel_w_pf2:
s_mov_b32 s8, s70
s_and_b32 s9, s71, 0xffff
s_mov_b32 s10, 0x700000
s_mov_b32 s11, 0x20000
main_kernel_w_pfg:
s_lshl_b32 s32, s25, 19
s_lshl_b32 s33, s14, 17
s_add_u32 s32, s32, s33
v_lshlrev_b32 v253, 7, v250
buffer_load_dword v0, v253, s[8:11], s32 offen
s_add_u32 s32, s32, 8192
buffer_load_dword v0, v253, s[8:11], s32 offen
s_add_u32 s32, s32, 8192
buffer_load_dword v0, v253, s[8:11], s32 offen
s_add_u32 s32, s32, 8192
buffer_load_dword v0, v253, s[8:11], s32 offen
s_add_u32 s32, s32, 8192
buffer_load_dword v0, v253, s[8:11], s32 offen
s_add_u32 s32, s32, 8192
buffer_load_dword v0, v253, s[8:11], s32 offen
s_add_u32 s32, s32, 8192
buffer_load_dword v0, v253, s[8:11], s32 offen
s_add_u32 s32, s32, 8192
buffer_load_dword v0, v253, s[8:11], s32 offen
s_add_u32 s32, s32, 8192
buffer_load_dword v0, v253, s[8:11], s32 offen
s_add_u32 s32, s32, 8192
buffer_load_dword v0, v253, s[8:11], s32 offen
s_add_u32 s32, s32, 8192
buffer_load_dword v0, v253, s[8:11], s32 offen
s_add_u32 s32, s32, 8192
buffer_load_dword v0, v253, s[8:11], s32 offen
s_add_u32 s32, s32, 8192
buffer_load_dword v0, v253, s[8:11], s32 offen
s_add_u32 s32, s32, 8192
buffer_load_dword v0, v253, s[8:11], s32 offen
s_add_u32 s32, s32, 8192
buffer_load_dword v0, v253, s[8:11], s32 offen
s_add_u32 s32, s32, 8192
buffer_load_dword v0, v253, s[8:11], s32 offen
s_add_u32 s32, s32, 8192
s_branch main_kernel_w_done
main_kernel_w_fill:
s_lshl_b32 s32, s24, 2
s_add_u32 s32, s32, s25
s_lshl_b32 s33, s32, 16
s_add_u32 s32, s33, 0x6e00000
s_add_u32 s35, s33, 0x8c00000
s_add_u32 s33, s33, 0x8000000
s_lshl_b32 s34, s14, 12
v_add_u32 v253, s34, v251
v_mov_b32 v0, -1
v_mov_b32 v1, -1
v_mov_b32 v2, -1
v_mov_b32 v3, -1
s_mov_b32 s18, 4
main_kernel_w_fl:
buffer_store_dwordx4 v[0:3], v253, s[4:7], s32 offen offset:0 sc1
buffer_store_dwordx4 v[0:3], v253, s[4:7], s32 offen offset:1024 sc1
buffer_store_dwordx4 v[0:3], v253, s[4:7], s32 offen offset:2048 sc1
buffer_store_dwordx4 v[0:3], v253, s[4:7], s32 offen offset:3072 sc1
s_add_u32 s32, s32, 16384
buffer_store_dwordx4 v[0:3], v253, s[4:7], s33 offen offset:0 sc1
buffer_store_dwordx4 v[0:3], v253, s[4:7], s33 offen offset:1024 sc1
buffer_store_dwordx4 v[0:3], v253, s[4:7], s33 offen offset:2048 sc1
buffer_store_dwordx4 v[0:3], v253, s[4:7], s33 offen offset:3072 sc1
s_add_u32 s33, s33, 16384
buffer_store_dwordx4 v[0:3], v253, s[4:7], s35 offen offset:0 sc1
buffer_store_dwordx4 v[0:3], v253, s[4:7], s35 offen offset:1024 sc1
buffer_store_dwordx4 v[0:3], v253, s[4:7], s35 offen offset:2048 sc1
buffer_store_dwordx4 v[0:3], v253, s[4:7], s35 offen offset:3072 sc1
s_add_u32 s35, s35, 16384
s_sub_u32 s18, s18, 1
s_cmp_lg_u32 s18, 0
s_cbranch_scc1 main_kernel_w_fl
s_branch main_kernel_w_done
main_kernel_w_ln2:
s_lshl_b32 s32, s24, 3
s_mul_i32 s33, s25, 2
s_add_u32 s32, s32, s33
s_lshl_b32 s32, s32, 15
s_lshl_b32 s33, s14, 13
s_add_u32 s32, s32, s33
s_add_u32 s21, s32, 0x6800000
s_add_u32 s32, s32, 0x5000000
buffer_load_dwordx4 v[0:3], v251, s[4:7], s32 offen offset:0 sc1
buffer_load_dwordx4 v[4:7], v251, s[4:7], s32 offen offset:1024 sc1
buffer_load_dwordx4 v[8:11], v251, s[4:7], s32 offen offset:2048 sc1
buffer_load_dwordx4 v[12:15], v251, s[4:7], s32 offen offset:3072 sc1
s_add_u32 s32, s32, 4096
buffer_load_dwordx4 v[16:19], v251, s[4:7], s32 offen offset:0 sc1
buffer_load_dwordx4 v[20:23], v251, s[4:7], s32 offen offset:1024 sc1
buffer_load_dwordx4 v[24:27], v251, s[4:7], s32 offen offset:2048 sc1
buffer_load_dwordx4 v[28:31], v251, s[4:7], s32 offen offset:3072 sc1
s_add_u32 s32, s32, 28672
buffer_load_dwordx4 v[32:35], v251, s[4:7], s32 offen offset:0 sc1
buffer_load_dwordx4 v[36:39], v251, s[4:7], s32 offen offset:1024 sc1
buffer_load_dwordx4 v[40:43], v251, s[4:7], s32 offen offset:2048 sc1
buffer_load_dwordx4 v[44:47], v251, s[4:7], s32 offen offset:3072 sc1
s_add_u32 s32, s32, 4096
buffer_load_dwordx4 v[48:51], v251, s[4:7], s32 offen offset:0 sc1
buffer_load_dwordx4 v[52:55], v251, s[4:7], s32 offen offset:1024 sc1
buffer_load_dwordx4 v[56:59], v251, s[4:7], s32 offen offset:2048 sc1
buffer_load_dwordx4 v[60:63], v251, s[4:7], s32 offen offset:3072 sc1
s_add_u32 s32, s32, 28672
v_and_b32 v255, 15, v250
v_lshlrev_b32 v254, 6, v255
v_add_u32 v254, 132096, v254
v_lshrrev_b32 v255, 4, v250
v_lshl_add_u32 v253, v255, 2, v254
v_lshl_add_u32 v253, s14, 4, v253
s_waitcnt vmcnt(8)
v_lshlrev_b32 v128, 16, v0
v_and_b32 v129, 0xffff0000, v0
v_lshlrev_b32 v130, 16, v1
v_and_b32 v131, 0xffff0000, v1
v_lshlrev_b32 v132, 16, v2
v_and_b32 v133, 0xffff0000, v2
v_lshlrev_b32 v134, 16, v3
v_and_b32 v135, 0xffff0000, v3
v_lshlrev_b32 v136, 16, v4
v_and_b32 v137, 0xffff0000, v4
v_lshlrev_b32 v138, 16, v5
v_and_b32 v139, 0xffff0000, v5
v_lshlrev_b32 v140, 16, v6
v_and_b32 v141, 0xffff0000, v6
v_lshlrev_b32 v142, 16, v7
v_and_b32 v143, 0xffff0000, v7
v_lshlrev_b32 v144, 16, v8
v_and_b32 v145, 0xffff0000, v8
v_lshlrev_b32 v146, 16, v9
v_and_b32 v147, 0xffff0000, v9
v_lshlrev_b32 v148, 16, v10
v_and_b32 v149, 0xffff0000, v10
v_lshlrev_b32 v150, 16, v11
v_and_b32 v151, 0xffff0000, v11
v_lshlrev_b32 v152, 16, v12
v_and_b32 v153, 0xffff0000, v12
v_lshlrev_b32 v154, 16, v13
v_and_b32 v155, 0xffff0000, v13
v_lshlrev_b32 v156, 16, v14
v_and_b32 v157, 0xffff0000, v14
v_lshlrev_b32 v158, 16, v15
v_and_b32 v159, 0xffff0000, v15
v_lshlrev_b32 v160, 16, v16
v_and_b32 v161, 0xffff0000, v16
v_lshlrev_b32 v162, 16, v17
v_and_b32 v163, 0xffff0000, v17
v_lshlrev_b32 v164, 16, v18
v_and_b32 v165, 0xffff0000, v18
v_lshlrev_b32 v166, 16, v19
v_and_b32 v167, 0xffff0000, v19
v_lshlrev_b32 v168, 16, v20
v_and_b32 v169, 0xffff0000, v20
v_lshlrev_b32 v170, 16, v21
v_and_b32 v171, 0xffff0000, v21
v_lshlrev_b32 v172, 16, v22
v_and_b32 v173, 0xffff0000, v22
v_lshlrev_b32 v174, 16, v23
v_and_b32 v175, 0xffff0000, v23
v_lshlrev_b32 v176, 16, v24
v_and_b32 v177, 0xffff0000, v24
v_lshlrev_b32 v178, 16, v25
v_and_b32 v179, 0xffff0000, v25
v_lshlrev_b32 v180, 16, v26
v_and_b32 v181, 0xffff0000, v26
v_lshlrev_b32 v182, 16, v27
v_and_b32 v183, 0xffff0000, v27
v_lshlrev_b32 v184, 16, v28
v_and_b32 v185, 0xffff0000, v28
v_lshlrev_b32 v186, 16, v29
v_and_b32 v187, 0xffff0000, v29
v_lshlrev_b32 v188, 16, v30
v_and_b32 v189, 0xffff0000, v30
v_lshlrev_b32 v190, 16, v31
v_and_b32 v191, 0xffff0000, v31
v_pk_add_f32 v[192:193], v[128:129], v[136:137]
v_pk_add_f32 v[194:195], v[130:131], v[138:139]
v_pk_add_f32 v[196:197], v[132:133], v[140:141]
v_pk_add_f32 v[198:199], v[134:135], v[142:143]
v_pk_add_f32 v[192:193], v[192:193], v[144:145]
v_pk_add_f32 v[194:195], v[194:195], v[146:147]
v_pk_add_f32 v[196:197], v[196:197], v[148:149]
v_pk_add_f32 v[198:199], v[198:199], v[150:151]
v_pk_add_f32 v[192:193], v[192:193], v[152:153]
v_pk_add_f32 v[194:195], v[194:195], v[154:155]
v_pk_add_f32 v[196:197], v[196:197], v[156:157]
v_pk_add_f32 v[198:199], v[198:199], v[158:159]
v_pk_add_f32 v[192:193], v[192:193], v[160:161]
v_pk_add_f32 v[194:195], v[194:195], v[162:163]
v_pk_add_f32 v[196:197], v[196:197], v[164:165]
v_pk_add_f32 v[198:199], v[198:199], v[166:167]
v_pk_add_f32 v[192:193], v[192:193], v[168:169]
v_pk_add_f32 v[194:195], v[194:195], v[170:171]
v_pk_add_f32 v[196:197], v[196:197], v[172:173]
v_pk_add_f32 v[198:199], v[198:199], v[174:175]
v_pk_add_f32 v[192:193], v[192:193], v[176:177]
v_pk_add_f32 v[194:195], v[194:195], v[178:179]
v_pk_add_f32 v[196:197], v[196:197], v[180:181]
v_pk_add_f32 v[198:199], v[198:199], v[182:183]
v_pk_add_f32 v[192:193], v[192:193], v[184:185]
v_pk_add_f32 v[194:195], v[194:195], v[186:187]
v_pk_add_f32 v[196:197], v[196:197], v[188:189]
v_pk_add_f32 v[198:199], v[198:199], v[190:191]
v_pk_add_f32 v[192:193], v[192:193], v[194:195]
v_pk_add_f32 v[196:197], v[196:197], v[198:199]
v_pk_add_f32 v[192:193], v[192:193], v[196:197]
v_add_f32 v192, v192, v193
ds_write_b32 v253, v192 offset:0
s_waitcnt lgkmcnt(0)
s_barrier
ds_read_b128 v[192:195], v254 offset:0
ds_read_b128 v[196:199], v254 offset:16
ds_read_b128 v[200:203], v254 offset:32
ds_read_b128 v[204:207], v254 offset:48
s_waitcnt lgkmcnt(2)
v_pk_add_f32 v[192:193], v[192:193], v[194:195]
v_pk_add_f32 v[196:197], v[196:197], v[198:199]
s_waitcnt lgkmcnt(0)
v_pk_add_f32 v[200:201], v[200:201], v[202:203]
v_pk_add_f32 v[204:205], v[204:205], v[206:207]
v_pk_add_f32 v[192:193], v[192:193], v[196:197]
v_pk_add_f32 v[200:201], v[200:201], v[204:205]
v_pk_add_f32 v[192:193], v[192:193], v[200:201]
v_add_f32 v192, v192, v193
v_mul_f32 v192, 0xba800000, v192
v_mov_b32 v193, v192
v_pk_add_f32 v[128:129], v[128:129], v[192:193]
v_pk_add_f32 v[130:131], v[130:131], v[192:193]
v_pk_add_f32 v[132:133], v[132:133], v[192:193]
v_pk_add_f32 v[134:135], v[134:135], v[192:193]
v_pk_add_f32 v[136:137], v[136:137], v[192:193]
v_pk_add_f32 v[138:139], v[138:139], v[192:193]
v_pk_add_f32 v[140:141], v[140:141], v[192:193]
v_pk_add_f32 v[142:143], v[142:143], v[192:193]
v_pk_add_f32 v[144:145], v[144:145], v[192:193]
v_pk_add_f32 v[146:147], v[146:147], v[192:193]
v_pk_add_f32 v[148:149], v[148:149], v[192:193]
v_pk_add_f32 v[150:151], v[150:151], v[192:193]
v_pk_add_f32 v[152:153], v[152:153], v[192:193]
v_pk_add_f32 v[154:155], v[154:155], v[192:193]
v_pk_add_f32 v[156:157], v[156:157], v[192:193]
v_pk_add_f32 v[158:159], v[158:159], v[192:193]
v_pk_add_f32 v[160:161], v[160:161], v[192:193]
v_pk_add_f32 v[162:163], v[162:163], v[192:193]
v_pk_add_f32 v[164:165], v[164:165], v[192:193]
v_pk_add_f32 v[166:167], v[166:167], v[192:193]
v_pk_add_f32 v[168:169], v[168:169], v[192:193]
v_pk_add_f32 v[170:171], v[170:171], v[192:193]
v_pk_add_f32 v[172:173], v[172:173], v[192:193]
v_pk_add_f32 v[174:175], v[174:175], v[192:193]
v_pk_add_f32 v[176:177], v[176:177], v[192:193]
v_pk_add_f32 v[178:179], v[178:179], v[192:193]
v_pk_add_f32 v[180:181], v[180:181], v[192:193]
v_pk_add_f32 v[182:183], v[182:183], v[192:193]
v_pk_add_f32 v[184:185], v[184:185], v[192:193]
v_pk_add_f32 v[186:187], v[186:187], v[192:193]
v_pk_add_f32 v[188:189], v[188:189], v[192:193]
v_pk_add_f32 v[190:191], v[190:191], v[192:193]
v_pk_mul_f32 v[192:193], v[128:129], v[128:129]
v_pk_mul_f32 v[194:195], v[130:131], v[130:131]
v_pk_mul_f32 v[196:197], v[132:133], v[132:133]
v_pk_mul_f32 v[198:199], v[134:135], v[134:135]
v_pk_fma_f32 v[192:193], v[136:137], v[136:137], v[192:193]
v_pk_fma_f32 v[194:195], v[138:139], v[138:139], v[194:195]
v_pk_fma_f32 v[196:197], v[140:141], v[140:141], v[196:197]
v_pk_fma_f32 v[198:199], v[142:143], v[142:143], v[198:199]
v_pk_fma_f32 v[192:193], v[144:145], v[144:145], v[192:193]
v_pk_fma_f32 v[194:195], v[146:147], v[146:147], v[194:195]
v_pk_fma_f32 v[196:197], v[148:149], v[148:149], v[196:197]
v_pk_fma_f32 v[198:199], v[150:151], v[150:151], v[198:199]
v_pk_fma_f32 v[192:193], v[152:153], v[152:153], v[192:193]
v_pk_fma_f32 v[194:195], v[154:155], v[154:155], v[194:195]
v_pk_fma_f32 v[196:197], v[156:157], v[156:157], v[196:197]
v_pk_fma_f32 v[198:199], v[158:159], v[158:159], v[198:199]
v_pk_fma_f32 v[192:193], v[160:161], v[160:161], v[192:193]
v_pk_fma_f32 v[194:195], v[162:163], v[162:163], v[194:195]
v_pk_fma_f32 v[196:197], v[164:165], v[164:165], v[196:197]
v_pk_fma_f32 v[198:199], v[166:167], v[166:167], v[198:199]
v_pk_fma_f32 v[192:193], v[168:169], v[168:169], v[192:193]
v_pk_fma_f32 v[194:195], v[170:171], v[170:171], v[194:195]
v_pk_fma_f32 v[196:197], v[172:173], v[172:173], v[196:197]
v_pk_fma_f32 v[198:199], v[174:175], v[174:175], v[198:199]
v_pk_fma_f32 v[192:193], v[176:177], v[176:177], v[192:193]
v_pk_fma_f32 v[194:195], v[178:179], v[178:179], v[194:195]
v_pk_fma_f32 v[196:197], v[180:181], v[180:181], v[196:197]
v_pk_fma_f32 v[198:199], v[182:183], v[182:183], v[198:199]
v_pk_fma_f32 v[192:193], v[184:185], v[184:185], v[192:193]
v_pk_fma_f32 v[194:195], v[186:187], v[186:187], v[194:195]
v_pk_fma_f32 v[196:197], v[188:189], v[188:189], v[196:197]
v_pk_fma_f32 v[198:199], v[190:191], v[190:191], v[198:199]
v_pk_add_f32 v[192:193], v[192:193], v[194:195]
v_pk_add_f32 v[196:197], v[196:197], v[198:199]
v_pk_add_f32 v[192:193], v[192:193], v[196:197]
v_add_f32 v192, v192, v193
ds_write_b32 v253, v192 offset:1024
s_waitcnt lgkmcnt(0)
s_barrier
ds_read_b128 v[192:195], v254 offset:1024
ds_read_b128 v[196:199], v254 offset:1040
ds_read_b128 v[200:203], v254 offset:1056
ds_read_b128 v[204:207], v254 offset:1072
s_waitcnt lgkmcnt(2)
v_pk_add_f32 v[192:193], v[192:193], v[194:195]
v_pk_add_f32 v[196:197], v[196:197], v[198:199]
s_waitcnt lgkmcnt(0)
v_pk_add_f32 v[200:201], v[200:201], v[202:203]
v_pk_add_f32 v[204:205], v[204:205], v[206:207]
v_pk_add_f32 v[192:193], v[192:193], v[196:197]
v_pk_add_f32 v[200:201], v[200:201], v[204:205]
v_pk_add_f32 v[192:193], v[192:193], v[200:201]
v_add_f32 v192, v192, v193
v_mov_b32 v193, 0x3727c5ac
v_fmac_f32 v193, 0x3a800000, v192
v_rsq_f32 v192, v193
s_nop 0
v_mov_b32 v193, v192
v_pk_mul_f32 v[128:129], v[128:129], v[192:193]
v_pk_mul_f32 v[130:131], v[130:131], v[192:193]
v_pk_mul_f32 v[132:133], v[132:133], v[192:193]
v_pk_mul_f32 v[134:135], v[134:135], v[192:193]
v_pk_mul_f32 v[136:137], v[136:137], v[192:193]
v_pk_mul_f32 v[138:139], v[138:139], v[192:193]
v_pk_mul_f32 v[140:141], v[140:141], v[192:193]
v_pk_mul_f32 v[142:143], v[142:143], v[192:193]
v_pk_mul_f32 v[144:145], v[144:145], v[192:193]
v_pk_mul_f32 v[146:147], v[146:147], v[192:193]
v_pk_mul_f32 v[148:149], v[148:149], v[192:193]
v_pk_mul_f32 v[150:151], v[150:151], v[192:193]
v_pk_mul_f32 v[152:153], v[152:153], v[192:193]
v_pk_mul_f32 v[154:155], v[154:155], v[192:193]
v_pk_mul_f32 v[156:157], v[156:157], v[192:193]
v_pk_mul_f32 v[158:159], v[158:159], v[192:193]
v_pk_mul_f32 v[160:161], v[160:161], v[192:193]
v_pk_mul_f32 v[162:163], v[162:163], v[192:193]
v_pk_mul_f32 v[164:165], v[164:165], v[192:193]
v_pk_mul_f32 v[166:167], v[166:167], v[192:193]
v_pk_mul_f32 v[168:169], v[168:169], v[192:193]
v_pk_mul_f32 v[170:171], v[170:171], v[192:193]
v_pk_mul_f32 v[172:173], v[172:173], v[192:193]
v_pk_mul_f32 v[174:175], v[174:175], v[192:193]
v_pk_mul_f32 v[176:177], v[176:177], v[192:193]
v_pk_mul_f32 v[178:179], v[178:179], v[192:193]
v_pk_mul_f32 v[180:181], v[180:181], v[192:193]
v_pk_mul_f32 v[182:183], v[182:183], v[192:193]
v_pk_mul_f32 v[184:185], v[184:185], v[192:193]
v_pk_mul_f32 v[186:187], v[186:187], v[192:193]
v_pk_mul_f32 v[188:189], v[188:189], v[192:193]
v_pk_mul_f32 v[190:191], v[190:191], v[192:193]
v_cvt_pk_bf16_f32 v0, v128, v129
v_cvt_pk_bf16_f32 v1, v130, v131
v_cvt_pk_bf16_f32 v2, v132, v133
v_cvt_pk_bf16_f32 v3, v134, v135
v_cvt_pk_bf16_f32 v4, v136, v137
v_cvt_pk_bf16_f32 v5, v138, v139
v_cvt_pk_bf16_f32 v6, v140, v141
v_cvt_pk_bf16_f32 v7, v142, v143
v_cvt_pk_bf16_f32 v8, v144, v145
v_cvt_pk_bf16_f32 v9, v146, v147
v_cvt_pk_bf16_f32 v10, v148, v149
v_cvt_pk_bf16_f32 v11, v150, v151
v_cvt_pk_bf16_f32 v12, v152, v153
v_cvt_pk_bf16_f32 v13, v154, v155
v_cvt_pk_bf16_f32 v14, v156, v157
v_cvt_pk_bf16_f32 v15, v158, v159
v_cvt_pk_bf16_f32 v16, v160, v161
v_cvt_pk_bf16_f32 v17, v162, v163
v_cvt_pk_bf16_f32 v18, v164, v165
v_cvt_pk_bf16_f32 v19, v166, v167
v_cvt_pk_bf16_f32 v20, v168, v169
v_cvt_pk_bf16_f32 v21, v170, v171
v_cvt_pk_bf16_f32 v22, v172, v173
v_cvt_pk_bf16_f32 v23, v174, v175
v_cvt_pk_bf16_f32 v24, v176, v177
v_cvt_pk_bf16_f32 v25, v178, v179
v_cvt_pk_bf16_f32 v26, v180, v181
v_cvt_pk_bf16_f32 v27, v182, v183
v_cvt_pk_bf16_f32 v28, v184, v185
v_cvt_pk_bf16_f32 v29, v186, v187
v_cvt_pk_bf16_f32 v30, v188, v189
v_cvt_pk_bf16_f32 v31, v190, v191
buffer_store_dwordx4 v[0:3], v251, s[4:7], s21 offen offset:0 sc1
buffer_store_dwordx4 v[4:7], v251, s[4:7], s21 offen offset:1024 sc1
buffer_store_dwordx4 v[8:11], v251, s[4:7], s21 offen offset:2048 sc1
buffer_store_dwordx4 v[12:15], v251, s[4:7], s21 offen offset:3072 sc1
s_add_u32 s21, s21, 4096
buffer_store_dwordx4 v[16:19], v251, s[4:7], s21 offen offset:0 sc1
buffer_store_dwordx4 v[20:23], v251, s[4:7], s21 offen offset:1024 sc1
buffer_store_dwordx4 v[24:27], v251, s[4:7], s21 offen offset:2048 sc1
buffer_store_dwordx4 v[28:31], v251, s[4:7], s21 offen offset:3072 sc1
s_add_u32 s21, s21, 28672
s_waitcnt vmcnt(8)
v_lshlrev_b32 v128, 16, v32
v_and_b32 v129, 0xffff0000, v32
v_lshlrev_b32 v130, 16, v33
v_and_b32 v131, 0xffff0000, v33
v_lshlrev_b32 v132, 16, v34
v_and_b32 v133, 0xffff0000, v34
v_lshlrev_b32 v134, 16, v35
v_and_b32 v135, 0xffff0000, v35
v_lshlrev_b32 v136, 16, v36
v_and_b32 v137, 0xffff0000, v36
v_lshlrev_b32 v138, 16, v37
v_and_b32 v139, 0xffff0000, v37
v_lshlrev_b32 v140, 16, v38
v_and_b32 v141, 0xffff0000, v38
v_lshlrev_b32 v142, 16, v39
v_and_b32 v143, 0xffff0000, v39
v_lshlrev_b32 v144, 16, v40
v_and_b32 v145, 0xffff0000, v40
v_lshlrev_b32 v146, 16, v41
v_and_b32 v147, 0xffff0000, v41
v_lshlrev_b32 v148, 16, v42
v_and_b32 v149, 0xffff0000, v42
v_lshlrev_b32 v150, 16, v43
v_and_b32 v151, 0xffff0000, v43
v_lshlrev_b32 v152, 16, v44
v_and_b32 v153, 0xffff0000, v44
v_lshlrev_b32 v154, 16, v45
v_and_b32 v155, 0xffff0000, v45
v_lshlrev_b32 v156, 16, v46
v_and_b32 v157, 0xffff0000, v46
v_lshlrev_b32 v158, 16, v47
v_and_b32 v159, 0xffff0000, v47
v_lshlrev_b32 v160, 16, v48
v_and_b32 v161, 0xffff0000, v48
v_lshlrev_b32 v162, 16, v49
v_and_b32 v163, 0xffff0000, v49
v_lshlrev_b32 v164, 16, v50
v_and_b32 v165, 0xffff0000, v50
v_lshlrev_b32 v166, 16, v51
v_and_b32 v167, 0xffff0000, v51
v_lshlrev_b32 v168, 16, v52
v_and_b32 v169, 0xffff0000, v52
v_lshlrev_b32 v170, 16, v53
v_and_b32 v171, 0xffff0000, v53
v_lshlrev_b32 v172, 16, v54
v_and_b32 v173, 0xffff0000, v54
v_lshlrev_b32 v174, 16, v55
v_and_b32 v175, 0xffff0000, v55
v_lshlrev_b32 v176, 16, v56
v_and_b32 v177, 0xffff0000, v56
v_lshlrev_b32 v178, 16, v57
v_and_b32 v179, 0xffff0000, v57
v_lshlrev_b32 v180, 16, v58
v_and_b32 v181, 0xffff0000, v58
v_lshlrev_b32 v182, 16, v59
v_and_b32 v183, 0xffff0000, v59
v_lshlrev_b32 v184, 16, v60
v_and_b32 v185, 0xffff0000, v60
v_lshlrev_b32 v186, 16, v61
v_and_b32 v187, 0xffff0000, v61
v_lshlrev_b32 v188, 16, v62
v_and_b32 v189, 0xffff0000, v62
v_lshlrev_b32 v190, 16, v63
v_and_b32 v191, 0xffff0000, v63
v_pk_add_f32 v[192:193], v[128:129], v[136:137]
v_pk_add_f32 v[194:195], v[130:131], v[138:139]
v_pk_add_f32 v[196:197], v[132:133], v[140:141]
v_pk_add_f32 v[198:199], v[134:135], v[142:143]
v_pk_add_f32 v[192:193], v[192:193], v[144:145]
v_pk_add_f32 v[194:195], v[194:195], v[146:147]
v_pk_add_f32 v[196:197], v[196:197], v[148:149]
v_pk_add_f32 v[198:199], v[198:199], v[150:151]
v_pk_add_f32 v[192:193], v[192:193], v[152:153]
v_pk_add_f32 v[194:195], v[194:195], v[154:155]
v_pk_add_f32 v[196:197], v[196:197], v[156:157]
v_pk_add_f32 v[198:199], v[198:199], v[158:159]
v_pk_add_f32 v[192:193], v[192:193], v[160:161]
v_pk_add_f32 v[194:195], v[194:195], v[162:163]
v_pk_add_f32 v[196:197], v[196:197], v[164:165]
v_pk_add_f32 v[198:199], v[198:199], v[166:167]
v_pk_add_f32 v[192:193], v[192:193], v[168:169]
v_pk_add_f32 v[194:195], v[194:195], v[170:171]
v_pk_add_f32 v[196:197], v[196:197], v[172:173]
v_pk_add_f32 v[198:199], v[198:199], v[174:175]
v_pk_add_f32 v[192:193], v[192:193], v[176:177]
v_pk_add_f32 v[194:195], v[194:195], v[178:179]
v_pk_add_f32 v[196:197], v[196:197], v[180:181]
v_pk_add_f32 v[198:199], v[198:199], v[182:183]
v_pk_add_f32 v[192:193], v[192:193], v[184:185]
v_pk_add_f32 v[194:195], v[194:195], v[186:187]
v_pk_add_f32 v[196:197], v[196:197], v[188:189]
v_pk_add_f32 v[198:199], v[198:199], v[190:191]
v_pk_add_f32 v[192:193], v[192:193], v[194:195]
v_pk_add_f32 v[196:197], v[196:197], v[198:199]
v_pk_add_f32 v[192:193], v[192:193], v[196:197]
v_add_f32 v192, v192, v193
ds_write_b32 v253, v192 offset:0
s_waitcnt lgkmcnt(0)
s_barrier
ds_read_b128 v[192:195], v254 offset:0
ds_read_b128 v[196:199], v254 offset:16
ds_read_b128 v[200:203], v254 offset:32
ds_read_b128 v[204:207], v254 offset:48
s_waitcnt lgkmcnt(2)
v_pk_add_f32 v[192:193], v[192:193], v[194:195]
v_pk_add_f32 v[196:197], v[196:197], v[198:199]
s_waitcnt lgkmcnt(0)
v_pk_add_f32 v[200:201], v[200:201], v[202:203]
v_pk_add_f32 v[204:205], v[204:205], v[206:207]
v_pk_add_f32 v[192:193], v[192:193], v[196:197]
v_pk_add_f32 v[200:201], v[200:201], v[204:205]
v_pk_add_f32 v[192:193], v[192:193], v[200:201]
v_add_f32 v192, v192, v193
v_mul_f32 v192, 0xba800000, v192
v_mov_b32 v193, v192
v_pk_add_f32 v[128:129], v[128:129], v[192:193]
v_pk_add_f32 v[130:131], v[130:131], v[192:193]
v_pk_add_f32 v[132:133], v[132:133], v[192:193]
v_pk_add_f32 v[134:135], v[134:135], v[192:193]
v_pk_add_f32 v[136:137], v[136:137], v[192:193]
v_pk_add_f32 v[138:139], v[138:139], v[192:193]
v_pk_add_f32 v[140:141], v[140:141], v[192:193]
v_pk_add_f32 v[142:143], v[142:143], v[192:193]
v_pk_add_f32 v[144:145], v[144:145], v[192:193]
v_pk_add_f32 v[146:147], v[146:147], v[192:193]
v_pk_add_f32 v[148:149], v[148:149], v[192:193]
v_pk_add_f32 v[150:151], v[150:151], v[192:193]
v_pk_add_f32 v[152:153], v[152:153], v[192:193]
v_pk_add_f32 v[154:155], v[154:155], v[192:193]
v_pk_add_f32 v[156:157], v[156:157], v[192:193]
v_pk_add_f32 v[158:159], v[158:159], v[192:193]
v_pk_add_f32 v[160:161], v[160:161], v[192:193]
v_pk_add_f32 v[162:163], v[162:163], v[192:193]
v_pk_add_f32 v[164:165], v[164:165], v[192:193]
v_pk_add_f32 v[166:167], v[166:167], v[192:193]
v_pk_add_f32 v[168:169], v[168:169], v[192:193]
v_pk_add_f32 v[170:171], v[170:171], v[192:193]
v_pk_add_f32 v[172:173], v[172:173], v[192:193]
v_pk_add_f32 v[174:175], v[174:175], v[192:193]
v_pk_add_f32 v[176:177], v[176:177], v[192:193]
v_pk_add_f32 v[178:179], v[178:179], v[192:193]
v_pk_add_f32 v[180:181], v[180:181], v[192:193]
v_pk_add_f32 v[182:183], v[182:183], v[192:193]
v_pk_add_f32 v[184:185], v[184:185], v[192:193]
v_pk_add_f32 v[186:187], v[186:187], v[192:193]
v_pk_add_f32 v[188:189], v[188:189], v[192:193]
v_pk_add_f32 v[190:191], v[190:191], v[192:193]
v_pk_mul_f32 v[192:193], v[128:129], v[128:129]
v_pk_mul_f32 v[194:195], v[130:131], v[130:131]
v_pk_mul_f32 v[196:197], v[132:133], v[132:133]
v_pk_mul_f32 v[198:199], v[134:135], v[134:135]
v_pk_fma_f32 v[192:193], v[136:137], v[136:137], v[192:193]
v_pk_fma_f32 v[194:195], v[138:139], v[138:139], v[194:195]
v_pk_fma_f32 v[196:197], v[140:141], v[140:141], v[196:197]
v_pk_fma_f32 v[198:199], v[142:143], v[142:143], v[198:199]
v_pk_fma_f32 v[192:193], v[144:145], v[144:145], v[192:193]
v_pk_fma_f32 v[194:195], v[146:147], v[146:147], v[194:195]
v_pk_fma_f32 v[196:197], v[148:149], v[148:149], v[196:197]
v_pk_fma_f32 v[198:199], v[150:151], v[150:151], v[198:199]
v_pk_fma_f32 v[192:193], v[152:153], v[152:153], v[192:193]
v_pk_fma_f32 v[194:195], v[154:155], v[154:155], v[194:195]
v_pk_fma_f32 v[196:197], v[156:157], v[156:157], v[196:197]
v_pk_fma_f32 v[198:199], v[158:159], v[158:159], v[198:199]
v_pk_fma_f32 v[192:193], v[160:161], v[160:161], v[192:193]
v_pk_fma_f32 v[194:195], v[162:163], v[162:163], v[194:195]
v_pk_fma_f32 v[196:197], v[164:165], v[164:165], v[196:197]
v_pk_fma_f32 v[198:199], v[166:167], v[166:167], v[198:199]
v_pk_fma_f32 v[192:193], v[168:169], v[168:169], v[192:193]
v_pk_fma_f32 v[194:195], v[170:171], v[170:171], v[194:195]
v_pk_fma_f32 v[196:197], v[172:173], v[172:173], v[196:197]
v_pk_fma_f32 v[198:199], v[174:175], v[174:175], v[198:199]
v_pk_fma_f32 v[192:193], v[176:177], v[176:177], v[192:193]
v_pk_fma_f32 v[194:195], v[178:179], v[178:179], v[194:195]
v_pk_fma_f32 v[196:197], v[180:181], v[180:181], v[196:197]
v_pk_fma_f32 v[198:199], v[182:183], v[182:183], v[198:199]
v_pk_fma_f32 v[192:193], v[184:185], v[184:185], v[192:193]
v_pk_fma_f32 v[194:195], v[186:187], v[186:187], v[194:195]
v_pk_fma_f32 v[196:197], v[188:189], v[188:189], v[196:197]
v_pk_fma_f32 v[198:199], v[190:191], v[190:191], v[198:199]
v_pk_add_f32 v[192:193], v[192:193], v[194:195]
v_pk_add_f32 v[196:197], v[196:197], v[198:199]
v_pk_add_f32 v[192:193], v[192:193], v[196:197]
v_add_f32 v192, v192, v193
ds_write_b32 v253, v192 offset:1024
s_waitcnt lgkmcnt(0)
s_barrier
ds_read_b128 v[192:195], v254 offset:1024
ds_read_b128 v[196:199], v254 offset:1040
ds_read_b128 v[200:203], v254 offset:1056
ds_read_b128 v[204:207], v254 offset:1072
s_waitcnt lgkmcnt(2)
v_pk_add_f32 v[192:193], v[192:193], v[194:195]
v_pk_add_f32 v[196:197], v[196:197], v[198:199]
s_waitcnt lgkmcnt(0)
v_pk_add_f32 v[200:201], v[200:201], v[202:203]
v_pk_add_f32 v[204:205], v[204:205], v[206:207]
v_pk_add_f32 v[192:193], v[192:193], v[196:197]
v_pk_add_f32 v[200:201], v[200:201], v[204:205]
v_pk_add_f32 v[192:193], v[192:193], v[200:201]
v_add_f32 v192, v192, v193
v_mov_b32 v193, 0x3727c5ac
v_fmac_f32 v193, 0x3a800000, v192
v_rsq_f32 v192, v193
s_nop 0
v_mov_b32 v193, v192
v_pk_mul_f32 v[128:129], v[128:129], v[192:193]
v_pk_mul_f32 v[130:131], v[130:131], v[192:193]
v_pk_mul_f32 v[132:133], v[132:133], v[192:193]
v_pk_mul_f32 v[134:135], v[134:135], v[192:193]
v_pk_mul_f32 v[136:137], v[136:137], v[192:193]
v_pk_mul_f32 v[138:139], v[138:139], v[192:193]
v_pk_mul_f32 v[140:141], v[140:141], v[192:193]
v_pk_mul_f32 v[142:143], v[142:143], v[192:193]
v_pk_mul_f32 v[144:145], v[144:145], v[192:193]
v_pk_mul_f32 v[146:147], v[146:147], v[192:193]
v_pk_mul_f32 v[148:149], v[148:149], v[192:193]
v_pk_mul_f32 v[150:151], v[150:151], v[192:193]
v_pk_mul_f32 v[152:153], v[152:153], v[192:193]
v_pk_mul_f32 v[154:155], v[154:155], v[192:193]
v_pk_mul_f32 v[156:157], v[156:157], v[192:193]
v_pk_mul_f32 v[158:159], v[158:159], v[192:193]
v_pk_mul_f32 v[160:161], v[160:161], v[192:193]
v_pk_mul_f32 v[162:163], v[162:163], v[192:193]
v_pk_mul_f32 v[164:165], v[164:165], v[192:193]
v_pk_mul_f32 v[166:167], v[166:167], v[192:193]
v_pk_mul_f32 v[168:169], v[168:169], v[192:193]
v_pk_mul_f32 v[170:171], v[170:171], v[192:193]
v_pk_mul_f32 v[172:173], v[172:173], v[192:193]
v_pk_mul_f32 v[174:175], v[174:175], v[192:193]
v_pk_mul_f32 v[176:177], v[176:177], v[192:193]
v_pk_mul_f32 v[178:179], v[178:179], v[192:193]
v_pk_mul_f32 v[180:181], v[180:181], v[192:193]
v_pk_mul_f32 v[182:183], v[182:183], v[192:193]
v_pk_mul_f32 v[184:185], v[184:185], v[192:193]
v_pk_mul_f32 v[186:187], v[186:187], v[192:193]
v_pk_mul_f32 v[188:189], v[188:189], v[192:193]
v_pk_mul_f32 v[190:191], v[190:191], v[192:193]
v_cvt_pk_bf16_f32 v32, v128, v129
v_cvt_pk_bf16_f32 v33, v130, v131
v_cvt_pk_bf16_f32 v34, v132, v133
v_cvt_pk_bf16_f32 v35, v134, v135
v_cvt_pk_bf16_f32 v36, v136, v137
v_cvt_pk_bf16_f32 v37, v138, v139
v_cvt_pk_bf16_f32 v38, v140, v141
v_cvt_pk_bf16_f32 v39, v142, v143
v_cvt_pk_bf16_f32 v40, v144, v145
v_cvt_pk_bf16_f32 v41, v146, v147
v_cvt_pk_bf16_f32 v42, v148, v149
v_cvt_pk_bf16_f32 v43, v150, v151
v_cvt_pk_bf16_f32 v44, v152, v153
v_cvt_pk_bf16_f32 v45, v154, v155
v_cvt_pk_bf16_f32 v46, v156, v157
v_cvt_pk_bf16_f32 v47, v158, v159
v_cvt_pk_bf16_f32 v48, v160, v161
v_cvt_pk_bf16_f32 v49, v162, v163
v_cvt_pk_bf16_f32 v50, v164, v165
v_cvt_pk_bf16_f32 v51, v166, v167
v_cvt_pk_bf16_f32 v52, v168, v169
v_cvt_pk_bf16_f32 v53, v170, v171
v_cvt_pk_bf16_f32 v54, v172, v173
v_cvt_pk_bf16_f32 v55, v174, v175
v_cvt_pk_bf16_f32 v56, v176, v177
v_cvt_pk_bf16_f32 v57, v178, v179
v_cvt_pk_bf16_f32 v58, v180, v181
v_cvt_pk_bf16_f32 v59, v182, v183
v_cvt_pk_bf16_f32 v60, v184, v185
v_cvt_pk_bf16_f32 v61, v186, v187
v_cvt_pk_bf16_f32 v62, v188, v189
v_cvt_pk_bf16_f32 v63, v190, v191
buffer_store_dwordx4 v[32:35], v251, s[4:7], s21 offen offset:0 sc1
buffer_store_dwordx4 v[36:39], v251, s[4:7], s21 offen offset:1024 sc1
buffer_store_dwordx4 v[40:43], v251, s[4:7], s21 offen offset:2048 sc1
buffer_store_dwordx4 v[44:47], v251, s[4:7], s21 offen offset:3072 sc1
s_add_u32 s21, s21, 4096
buffer_store_dwordx4 v[48:51], v251, s[4:7], s21 offen offset:0 sc1
buffer_store_dwordx4 v[52:55], v251, s[4:7], s21 offen offset:1024 sc1
buffer_store_dwordx4 v[56:59], v251, s[4:7], s21 offen offset:2048 sc1
buffer_store_dwordx4 v[60:63], v251, s[4:7], s21 offen offset:3072 sc1
s_add_u32 s21, s21, 28672
s_mov_b32 s54, 0
main_kernel_w_done:
s_add_u32 s32, s23, 1
s_bitcmp0_b32 s32, 2
s_cselect_b32 s34, 7, 2
s_cselect_b32 s35, 2, 4
s_lshl_b32 s59, s23, 13
s_add_u32 s59, s59, 0x8404000
v_lshrrev_b32 v253, 3, v250
v_add_lshl_u32 v253, s24, v253, 9
v_and_b32 v254, 3, v250
v_lshl_add_u32 v253, v254, s34, v253
v_bfe_u32 v254, v250, 2, 1
v_add_u32 v254, s25, v254
v_lshl_add_u32 v248, v254, s35, v253
s_lshl_b32 s0, 4, s54
main_kernel_w_drain:
s_waitcnt vmcnt(0)
s_barrier
s_cmp_lg_u32 s14, 0
s_cbranch_scc1 main_kernel_w_bar
s_bfm_b64 exec, s0, 0
buffer_store_dword v244, v248, s[4:7], s59 offen sc1
s_mov_b64 exec, -1
s_cmp_eq_u32 s58, -1
s_cbranch_scc1 main_kernel_w_chk
s_lshl_b32 s32, s27, 8
s_add_u32 s32, s32, 0x841e000
s_mov_b64 exec, 1
v_mov_b32 v249, 1
buffer_atomic_add v249, off, s[4:7], s32 sc0 sc1
s_mov_b64 exec, -1
s_branch main_kernel_w_dec
.section .rodata,"a"
.p2align 6
.amdhsa_kernel main_kernel
  .amdhsa_next_free_vgpr 512
  .amdhsa_next_free_sgpr 102
  .amdhsa_accum_offset 256
  .amdhsa_group_segment_fixed_size 0
  .amdhsa_kernarg_size 120
  .amdhsa_user_sgpr_count 2
  .amdhsa_user_sgpr_kernarg_segment_ptr 1
  .amdhsa_system_sgpr_workgroup_id_x 1
.end_amdhsa_kernel
```

```asm
; @launch kernel=main_kernel grid=(256,1,1) block=(256,1,1) lds=163840
.amdgcn_target "amdgcn-amd-amdhsa--gfx950"
.text
.text
.globl main_kernel
.p2align 8
.type main_kernel,@function
main_kernel:
s_load_dwordx4 s[20:23], s[0:1], 104
s_load_dwordx8 s[40:47], s[0:1], 16
s_load_dwordx8 s[64:71], s[0:1], 64
s_load_dwordx2 s[72:73], s[0:1], 0
s_load_dwordx2 s[74:75], s[0:1], 96
s_load_dwordx2 s[76:77], s[0:1], 8
s_cmp_ge_u32 s2, 256
s_cbranch_scc1 main_kernel_end
v_lshrrev_b32 v126, 6, v0
v_and_b32 v94, 63, v0
v_and_b32 v250, 63, v0
v_readfirstlane_b32 s14, v126
s_mov_b32 s29, 0x80000
s_waitcnt lgkmcnt(0)
s_mov_b32 s60, s20
s_and_b32 s61, s21, 0xffff
s_mov_b32 s62, 0x100
s_mov_b32 s63, 0x20000
s_mov_b32 s4, s22
s_and_b32 s5, s23, 0xffff
s_mov_b32 s6, 0x10000000
s_mov_b32 s7, 0x20000
s_cmp_lg_u32 s14, 0
s_cbranch_scc1 main_kernel_slot_wait
s_getreg_b32 s12, hwreg(HW_REG_XCC_ID, 0, 4)
s_and_b32 s12, s12, 7
s_lshl_b32 s32, s12, 5
v_mov_b32 v126, 0
v_mov_b32 v127, 1
s_mov_b64 exec, 1
buffer_atomic_add v127, v126, s[60:63], s32 offen sc0 sc1
s_waitcnt vmcnt(0)
s_mov_b64 exec, -1
v_readfirstlane_b32 s13, v127
s_nop 3
s_cmp_lt_u32 s13, 32
s_cbranch_scc1 main_kernel_slot_pub
v_and_b32 v126, 7, v94
v_lshlrev_b32 v126, 5, v126
main_kernel_ovf_cnt:
buffer_load_dword v127, v126, s[60:63], 0 offen sc1
s_waitcnt vmcnt(0)
v_readlane_b32 s48, v127, 0
v_readlane_b32 s49, v127, 1
v_readlane_b32 s50, v127, 2
v_readlane_b32 s51, v127, 3
v_readlane_b32 s52, v127, 4
v_readlane_b32 s53, v127, 5
v_readlane_b32 s54, v127, 6
v_readlane_b32 s55, v127, 7
s_nop 3
s_add_u32 s33, s48, s49
s_add_u32 s33, s33, s50
s_add_u32 s33, s33, s51
s_add_u32 s33, s33, s52
s_add_u32 s33, s33, s53
s_add_u32 s33, s33, s54
s_add_u32 s33, s33, s55
s_cmp_ge_u32 s33, 256
s_cbranch_scc1 main_kernel_ovf_cnt_ok
s_sub_u32 s29, s29, 1
s_cbranch_scc1 main_kernel_end
s_sleep 4
s_branch main_kernel_ovf_cnt
main_kernel_ovf_cnt_ok:
v_mov_b32 v126, 0
v_mov_b32 v127, 1
s_mov_b64 exec, 1
buffer_atomic_add v127, v126, s[60:63], 0 offen offset:8 sc0 sc1
s_waitcnt vmcnt(0)
s_mov_b64 exec, -1
v_readfirstlane_b32 s33, v127
s_nop 3
s_min_u32 s34, s48, 32
s_sub_u32 s35, 32, s34
s_mov_b32 s12, 0
s_add_u32 s13, s34, s33
s_cmp_lt_u32 s33, s35
s_cbranch_scc1 main_kernel_slot_pub
s_sub_u32 s33, s33, s35
s_min_u32 s34, s49, 32
s_sub_u32 s35, 32, s34
s_mov_b32 s12, 1
s_add_u32 s13, s34, s33
s_cmp_lt_u32 s33, s35
s_cbranch_scc1 main_kernel_slot_pub
s_sub_u32 s33, s33, s35
s_min_u32 s34, s50, 32
s_sub_u32 s35, 32, s34
s_mov_b32 s12, 2
s_add_u32 s13, s34, s33
s_cmp_lt_u32 s33, s35
s_cbranch_scc1 main_kernel_slot_pub
s_sub_u32 s33, s33, s35
s_min_u32 s34, s51, 32
s_sub_u32 s35, 32, s34
s_mov_b32 s12, 3
s_add_u32 s13, s34, s33
s_cmp_lt_u32 s33, s35
s_cbranch_scc1 main_kernel_slot_pub
s_sub_u32 s33, s33, s35
s_min_u32 s34, s52, 32
s_sub_u32 s35, 32, s34
s_mov_b32 s12, 4
s_add_u32 s13, s34, s33
s_cmp_lt_u32 s33, s35
s_cbranch_scc1 main_kernel_slot_pub
s_sub_u32 s33, s33, s35
s_min_u32 s34, s53, 32
s_sub_u32 s35, 32, s34
s_mov_b32 s12, 5
s_add_u32 s13, s34, s33
s_cmp_lt_u32 s33, s35
s_cbranch_scc1 main_kernel_slot_pub
s_sub_u32 s33, s33, s35
s_min_u32 s34, s54, 32
s_sub_u32 s35, 32, s34
s_mov_b32 s12, 6
s_add_u32 s13, s34, s33
s_cmp_lt_u32 s33, s35
s_cbranch_scc1 main_kernel_slot_pub
s_sub_u32 s33, s33, s35
s_min_u32 s34, s55, 32
s_sub_u32 s35, 32, s34
s_mov_b32 s12, 7
s_add_u32 s13, s34, s33
s_cmp_lt_u32 s33, s35
s_cbranch_scc1 main_kernel_slot_pub
s_sub_u32 s33, s33, s35
s_mov_b32 s12, 8
s_mov_b32 s13, 0
main_kernel_slot_pub:
v_mov_b32 v126, 0
v_mov_b32 v127, s12
v_mov_b32 v95, s13
ds_write_b32 v126, v127
ds_write_b32 v126, v95 offset:4
s_waitcnt lgkmcnt(0)
main_kernel_slot_wait:
s_barrier
v_mov_b32 v126, 0
ds_read_b32 v127, v126
ds_read_b32 v95, v126 offset:4
s_waitcnt lgkmcnt(0)
v_readfirstlane_b32 s12, v127
v_readfirstlane_b32 s13, v95
s_nop 3
s_barrier
s_cmp_ge_u32 s12, 8
s_cbranch_scc1 main_kernel_end
s_cmp_lt_u32 s12, 2
s_cbranch_scc1 main_kernel_chain
s_mov_b32 s96, s72
s_and_b32 s97, s73, 0xffff
s_mov_b32 s98, 0x400000
s_mov_b32 s99, 0x20000
s_mov_b32 s92, s74
s_and_b32 s93, s75, 0xffff
s_mov_b32 s94, 0x400000
s_mov_b32 s95, 0x20000
v_lshlrev_b32 v1, 4, v0
v_lshlrev_b32 v251, 4, v250
v_mov_b32 v4, 0
v_mov_b32 v8, -1
v_mov_b32 v5, 0
v_mov_b32 v9, -1
v_mov_b32 v6, 0
v_mov_b32 v10, -1
v_mov_b32 v7, 0
v_mov_b32 v11, -1
v_mul_u32_u24 v12, 128, v0
s_lshl_b32 s15, s12, 4
s_and_b32 s32, s12, 1
s_lshl_b32 s32, s32, 5
s_cmp_lt_u32 s12, 4
s_cselect_b32 s15, s32, s15
s_cselect_b32 s32, 32, 16
s_add_u32 s15, s15, s13
s_sub_u32 s16, s15, 80
s_sub_u32 s27, s12, 2
s_mov_b32 s52, 0
s_cmp_lt_u32 s13, s32
s_cbranch_scc1 main_kernel_s_ln
s_cmp_lg_u32 s13, 16
s_cbranch_scc1 main_kernel_s_fill
s_lshl_b32 s32, s16, 11
s_add_u32 s32, s32, 0x8400000
buffer_store_dwordx4 v[4:7], v1, s[4:7], s32 offen sc1
s_add_u32 s32, s32, 4096
buffer_store_dwordx4 v[4:7], v1, s[4:7], s32 offen sc1
s_add_u32 s32, s32, 4096
buffer_store_dwordx4 v[4:7], v1, s[4:7], s32 offen sc1
s_add_u32 s32, s32, 4096
buffer_store_dwordx4 v[4:7], v1, s[4:7], s32 offen sc1
s_add_u32 s32, s32, 4096
buffer_store_dwordx4 v[4:7], v1, s[4:7], s32 offen sc1
s_add_u32 s32, s32, 4096
buffer_store_dwordx4 v[4:7], v1, s[4:7], s32 offen sc1
s_add_u32 s32, s32, 4096
buffer_store_dwordx4 v[4:7], v1, s[4:7], s32 offen sc1
s_add_u32 s32, s32, 4096
buffer_store_dwordx4 v[4:7], v1, s[4:7], s32 offen sc1
s_add_u32 s32, s32, 4096
v_bfe_u32 v2, v0, 2, 1
s_lshr_b32 s32, s14, 1
v_and_b32 v2, s32, v2
s_bitcmp1_b32 s14, 0
s_cselect_b32 s32, 15, 0
s_cselect_b32 s33, 4161536, 0
v_xor_b32 v2, s32, v2
v_lshlrev_b32 v2, 4, v2
v_and_b32 v3, 3, v0
v_lshl_add_u32 v2, v3, 8, v2
v_lshrrev_b32 v3, 3, v0
v_lshl_add_u32 v2, v3, 10, v2
s_add_u32 s33, s33, 0x4808000
buffer_store_dwordx4 v[4:7], v2, s[4:7], s33 offen sc1
s_waitcnt vmcnt(0)
s_barrier
s_cmp_lg_u32 s14, 0
s_cbranch_scc1 main_kernel_s_fill
v_mov_b32 v2, 1
s_mov_b64 exec, 1
buffer_atomic_add v2, v4, s[60:63], 0 offen offset:12 sc1
s_mov_b64 exec, -1
s_branch main_kernel_s_fill
main_kernel_s_ln:
v_and_b32 v3, 15, v250
v_and_b32 v2, 48, v250
v_lshl_add_u32 v3, v3, 11, v2
s_lshl_b32 s34, s15, 15
s_lshl_b32 s32, s14, 9
s_add_u32 s32, s34, s32
buffer_load_dwordx4 v[32:35], v3, s[96:99], s32 offen offset:0
buffer_load_dwordx4 v[36:39], v3, s[96:99], s32 offen offset:64
buffer_load_dwordx4 v[40:43], v3, s[96:99], s32 offen offset:128
buffer_load_dwordx4 v[44:47], v3, s[96:99], s32 offen offset:192
buffer_load_dwordx4 v[48:51], v3, s[96:99], s32 offen offset:256
buffer_load_dwordx4 v[52:55], v3, s[96:99], s32 offen offset:320
buffer_load_dwordx4 v[56:59], v3, s[96:99], s32 offen offset:384
buffer_load_dwordx4 v[60:63], v3, s[96:99], s32 offen offset:448
v_and_b32 v255, 15, v250
v_lshlrev_b32 v254, 6, v255
v_add_u32 v254, 132096, v254
v_lshrrev_b32 v255, 4, v250
v_lshl_add_u32 v253, v255, 2, v254
v_lshl_add_u32 v253, s14, 4, v253
s_lshl_b32 s32, s14, 13
s_add_u32 s34, s34, s32
s_waitcnt vmcnt(0)
v_permlane16_swap_b32 v32, v34
v_permlane16_swap_b32 v33, v35
v_permlane16_swap_b32 v36, v38
v_permlane16_swap_b32 v37, v39
v_permlane16_swap_b32 v40, v42
v_permlane16_swap_b32 v41, v43
v_permlane16_swap_b32 v44, v46
v_permlane16_swap_b32 v45, v47
v_permlane16_swap_b32 v48, v50
v_permlane16_swap_b32 v49, v51
v_permlane16_swap_b32 v52, v54
v_permlane16_swap_b32 v53, v55
v_permlane16_swap_b32 v56, v58
v_permlane16_swap_b32 v57, v59
v_permlane16_swap_b32 v60, v62
v_permlane16_swap_b32 v61, v63
v_permlane32_swap_b32 v32, v34
v_permlane32_swap_b32 v33, v35
v_permlane32_swap_b32 v36, v38
v_permlane32_swap_b32 v37, v39
v_permlane32_swap_b32 v40, v42
v_permlane32_swap_b32 v41, v43
v_permlane32_swap_b32 v44, v46
v_permlane32_swap_b32 v45, v47
v_permlane32_swap_b32 v48, v50
v_permlane32_swap_b32 v49, v51
v_permlane32_swap_b32 v52, v54
v_permlane32_swap_b32 v53, v55
v_permlane32_swap_b32 v56, v58
v_permlane32_swap_b32 v57, v59
v_permlane32_swap_b32 v60, v62
v_permlane32_swap_b32 v61, v63
s_lshr_b32 s32, s15, 3
s_lshl_b32 s32, s32, 9
s_and_b32 s33, s15, 7
s_lshl_b32 s33, s33, 4
s_add_u32 s32, s32, s33
s_add_u32 s16, s32, 0x8416000
v_lshlrev_b32 v64, 16, v32
v_and_b32 v65, 0xffff0000, v32
v_lshlrev_b32 v66, 16, v33
v_and_b32 v67, 0xffff0000, v33
v_lshlrev_b32 v68, 16, v34
v_and_b32 v69, 0xffff0000, v34
v_lshlrev_b32 v70, 16, v35
v_and_b32 v71, 0xffff0000, v35
v_lshlrev_b32 v72, 16, v36
v_and_b32 v73, 0xffff0000, v36
v_lshlrev_b32 v74, 16, v37
v_and_b32 v75, 0xffff0000, v37
v_lshlrev_b32 v76, 16, v38
v_and_b32 v77, 0xffff0000, v38
v_lshlrev_b32 v78, 16, v39
v_and_b32 v79, 0xffff0000, v39
v_lshlrev_b32 v80, 16, v40
v_and_b32 v81, 0xffff0000, v40
v_lshlrev_b32 v82, 16, v41
v_and_b32 v83, 0xffff0000, v41
v_lshlrev_b32 v84, 16, v42
v_and_b32 v85, 0xffff0000, v42
v_lshlrev_b32 v86, 16, v43
v_and_b32 v87, 0xffff0000, v43
v_lshlrev_b32 v88, 16, v44
v_and_b32 v89, 0xffff0000, v44
v_lshlrev_b32 v90, 16, v45
v_and_b32 v91, 0xffff0000, v45
v_lshlrev_b32 v92, 16, v46
v_and_b32 v93, 0xffff0000, v46
v_lshlrev_b32 v94, 16, v47
v_and_b32 v95, 0xffff0000, v47
v_lshlrev_b32 v96, 16, v48
v_and_b32 v97, 0xffff0000, v48
v_lshlrev_b32 v98, 16, v49
v_and_b32 v99, 0xffff0000, v49
v_lshlrev_b32 v100, 16, v50
v_and_b32 v101, 0xffff0000, v50
v_lshlrev_b32 v102, 16, v51
v_and_b32 v103, 0xffff0000, v51
v_lshlrev_b32 v104, 16, v52
v_and_b32 v105, 0xffff0000, v52
v_lshlrev_b32 v106, 16, v53
v_and_b32 v107, 0xffff0000, v53
v_lshlrev_b32 v108, 16, v54
v_and_b32 v109, 0xffff0000, v54
v_lshlrev_b32 v110, 16, v55
v_and_b32 v111, 0xffff0000, v55
v_lshlrev_b32 v112, 16, v56
v_and_b32 v113, 0xffff0000, v56
v_lshlrev_b32 v114, 16, v57
v_and_b32 v115, 0xffff0000, v57
v_lshlrev_b32 v116, 16, v58
v_and_b32 v117, 0xffff0000, v58
v_lshlrev_b32 v118, 16, v59
v_and_b32 v119, 0xffff0000, v59
v_lshlrev_b32 v120, 16, v60
v_and_b32 v121, 0xffff0000, v60
v_lshlrev_b32 v122, 16, v61
v_and_b32 v123, 0xffff0000, v61
v_lshlrev_b32 v124, 16, v62
v_and_b32 v125, 0xffff0000, v62
v_lshlrev_b32 v126, 16, v63
v_and_b32 v127, 0xffff0000, v63
v_pk_add_f32 v[16:17], v[64:65], v[72:73]
v_pk_add_f32 v[18:19], v[66:67], v[74:75]
v_pk_add_f32 v[20:21], v[68:69], v[76:77]
v_pk_add_f32 v[22:23], v[70:71], v[78:79]
v_pk_add_f32 v[16:17], v[16:17], v[80:81]
v_pk_add_f32 v[18:19], v[18:19], v[82:83]
v_pk_add_f32 v[20:21], v[20:21], v[84:85]
v_pk_add_f32 v[22:23], v[22:23], v[86:87]
v_pk_add_f32 v[16:17], v[16:17], v[88:89]
v_pk_add_f32 v[18:19], v[18:19], v[90:91]
v_pk_add_f32 v[20:21], v[20:21], v[92:93]
v_pk_add_f32 v[22:23], v[22:23], v[94:95]
v_pk_add_f32 v[16:17], v[16:17], v[96:97]
v_pk_add_f32 v[18:19], v[18:19], v[98:99]
v_pk_add_f32 v[20:21], v[20:21], v[100:101]
v_pk_add_f32 v[22:23], v[22:23], v[102:103]
v_pk_add_f32 v[16:17], v[16:17], v[104:105]
v_pk_add_f32 v[18:19], v[18:19], v[106:107]
v_pk_add_f32 v[20:21], v[20:21], v[108:109]
v_pk_add_f32 v[22:23], v[22:23], v[110:111]
v_pk_add_f32 v[16:17], v[16:17], v[112:113]
v_pk_add_f32 v[18:19], v[18:19], v[114:115]
v_pk_add_f32 v[20:21], v[20:21], v[116:117]
v_pk_add_f32 v[22:23], v[22:23], v[118:119]
v_pk_add_f32 v[16:17], v[16:17], v[120:121]
v_pk_add_f32 v[18:19], v[18:19], v[122:123]
v_pk_add_f32 v[20:21], v[20:21], v[124:125]
v_pk_add_f32 v[22:23], v[22:23], v[126:127]
v_pk_add_f32 v[16:17], v[16:17], v[18:19]
v_pk_add_f32 v[20:21], v[20:21], v[22:23]
v_pk_add_f32 v[16:17], v[16:17], v[20:21]
v_add_f32 v16, v16, v17
ds_write_b32 v253, v16 offset:0
s_waitcnt lgkmcnt(0)
s_barrier
ds_read_b128 v[16:19], v254 offset:0
ds_read_b128 v[20:23], v254 offset:16
ds_read_b128 v[24:27], v254 offset:32
ds_read_b128 v[28:31], v254 offset:48
s_waitcnt lgkmcnt(2)
v_pk_add_f32 v[16:17], v[16:17], v[18:19]
v_pk_add_f32 v[20:21], v[20:21], v[22:23]
s_waitcnt lgkmcnt(0)
v_pk_add_f32 v[24:25], v[24:25], v[26:27]
v_pk_add_f32 v[28:29], v[28:29], v[30:31]
v_pk_add_f32 v[16:17], v[16:17], v[20:21]
v_pk_add_f32 v[24:25], v[24:25], v[28:29]
v_pk_add_f32 v[16:17], v[16:17], v[24:25]
v_add_f32 v16, v16, v17
v_mul_f32 v16, 0xba800000, v16
v_mov_b32 v17, v16
v_pk_add_f32 v[64:65], v[64:65], v[16:17]
v_pk_add_f32 v[66:67], v[66:67], v[16:17]
v_pk_add_f32 v[68:69], v[68:69], v[16:17]
v_pk_add_f32 v[70:71], v[70:71], v[16:17]
v_pk_add_f32 v[72:73], v[72:73], v[16:17]
v_pk_add_f32 v[74:75], v[74:75], v[16:17]
v_pk_add_f32 v[76:77], v[76:77], v[16:17]
v_pk_add_f32 v[78:79], v[78:79], v[16:17]
v_pk_add_f32 v[80:81], v[80:81], v[16:17]
v_pk_add_f32 v[82:83], v[82:83], v[16:17]
v_pk_add_f32 v[84:85], v[84:85], v[16:17]
v_pk_add_f32 v[86:87], v[86:87], v[16:17]
v_pk_add_f32 v[88:89], v[88:89], v[16:17]
v_pk_add_f32 v[90:91], v[90:91], v[16:17]
v_pk_add_f32 v[92:93], v[92:93], v[16:17]
v_pk_add_f32 v[94:95], v[94:95], v[16:17]
v_pk_add_f32 v[96:97], v[96:97], v[16:17]
v_pk_add_f32 v[98:99], v[98:99], v[16:17]
v_pk_add_f32 v[100:101], v[100:101], v[16:17]
v_pk_add_f32 v[102:103], v[102:103], v[16:17]
v_pk_add_f32 v[104:105], v[104:105], v[16:17]
v_pk_add_f32 v[106:107], v[106:107], v[16:17]
v_pk_add_f32 v[108:109], v[108:109], v[16:17]
v_pk_add_f32 v[110:111], v[110:111], v[16:17]
v_pk_add_f32 v[112:113], v[112:113], v[16:17]
v_pk_add_f32 v[114:115], v[114:115], v[16:17]
v_pk_add_f32 v[116:117], v[116:117], v[16:17]
v_pk_add_f32 v[118:119], v[118:119], v[16:17]
v_pk_add_f32 v[120:121], v[120:121], v[16:17]
v_pk_add_f32 v[122:123], v[122:123], v[16:17]
v_pk_add_f32 v[124:125], v[124:125], v[16:17]
v_pk_add_f32 v[126:127], v[126:127], v[16:17]
v_pk_mul_f32 v[16:17], v[64:65], v[64:65]
v_pk_mul_f32 v[18:19], v[66:67], v[66:67]
v_pk_mul_f32 v[20:21], v[68:69], v[68:69]
v_pk_mul_f32 v[22:23], v[70:71], v[70:71]
v_pk_fma_f32 v[16:17], v[72:73], v[72:73], v[16:17]
v_pk_fma_f32 v[18:19], v[74:75], v[74:75], v[18:19]
v_pk_fma_f32 v[20:21], v[76:77], v[76:77], v[20:21]
v_pk_fma_f32 v[22:23], v[78:79], v[78:79], v[22:23]
v_pk_fma_f32 v[16:17], v[80:81], v[80:81], v[16:17]
v_pk_fma_f32 v[18:19], v[82:83], v[82:83], v[18:19]
v_pk_fma_f32 v[20:21], v[84:85], v[84:85], v[20:21]
v_pk_fma_f32 v[22:23], v[86:87], v[86:87], v[22:23]
v_pk_fma_f32 v[16:17], v[88:89], v[88:89], v[16:17]
v_pk_fma_f32 v[18:19], v[90:91], v[90:91], v[18:19]
v_pk_fma_f32 v[20:21], v[92:93], v[92:93], v[20:21]
v_pk_fma_f32 v[22:23], v[94:95], v[94:95], v[22:23]
v_pk_fma_f32 v[16:17], v[96:97], v[96:97], v[16:17]
v_pk_fma_f32 v[18:19], v[98:99], v[98:99], v[18:19]
v_pk_fma_f32 v[20:21], v[100:101], v[100:101], v[20:21]
v_pk_fma_f32 v[22:23], v[102:103], v[102:103], v[22:23]
v_pk_fma_f32 v[16:17], v[104:105], v[104:105], v[16:17]
v_pk_fma_f32 v[18:19], v[106:107], v[106:107], v[18:19]
v_pk_fma_f32 v[20:21], v[108:109], v[108:109], v[20:21]
v_pk_fma_f32 v[22:23], v[110:111], v[110:111], v[22:23]
v_pk_fma_f32 v[16:17], v[112:113], v[112:113], v[16:17]
v_pk_fma_f32 v[18:19], v[114:115], v[114:115], v[18:19]
v_pk_fma_f32 v[20:21], v[116:117], v[116:117], v[20:21]
v_pk_fma_f32 v[22:23], v[118:119], v[118:119], v[22:23]
v_pk_fma_f32 v[16:17], v[120:121], v[120:121], v[16:17]
v_pk_fma_f32 v[18:19], v[122:123], v[122:123], v[18:19]
v_pk_fma_f32 v[20:21], v[124:125], v[124:125], v[20:21]
v_pk_fma_f32 v[22:23], v[126:127], v[126:127], v[22:23]
v_pk_add_f32 v[16:17], v[16:17], v[18:19]
v_pk_add_f32 v[20:21], v[20:21], v[22:23]
v_pk_add_f32 v[16:17], v[16:17], v[20:21]
v_add_f32 v16, v16, v17
ds_write_b32 v253, v16 offset:1024
s_waitcnt lgkmcnt(0)
s_barrier
ds_read_b128 v[16:19], v254 offset:1024
ds_read_b128 v[20:23], v254 offset:1040
ds_read_b128 v[24:27], v254 offset:1056
ds_read_b128 v[28:31], v254 offset:1072
s_waitcnt lgkmcnt(2)
v_pk_add_f32 v[16:17], v[16:17], v[18:19]
v_pk_add_f32 v[20:21], v[20:21], v[22:23]
s_waitcnt lgkmcnt(0)
v_pk_add_f32 v[24:25], v[24:25], v[26:27]
v_pk_add_f32 v[28:29], v[28:29], v[30:31]
v_pk_add_f32 v[16:17], v[16:17], v[20:21]
v_pk_add_f32 v[24:25], v[24:25], v[28:29]
v_pk_add_f32 v[16:17], v[16:17], v[24:25]
v_add_f32 v16, v16, v17
v_mov_b32 v17, 0x3727c5ac
v_fmac_f32 v17, 0x3a800000, v16
v_rsq_f32 v16, v17
s_nop 0
v_mov_b32 v17, v16
v_pk_mul_f32 v[64:65], v[64:65], v[16:17]
v_pk_mul_f32 v[66:67], v[66:67], v[16:17]
v_pk_mul_f32 v[68:69], v[68:69], v[16:17]
v_pk_mul_f32 v[70:71], v[70:71], v[16:17]
v_pk_mul_f32 v[72:73], v[72:73], v[16:17]
v_pk_mul_f32 v[74:75], v[74:75], v[16:17]
v_pk_mul_f32 v[76:77], v[76:77], v[16:17]
v_pk_mul_f32 v[78:79], v[78:79], v[16:17]
v_pk_mul_f32 v[80:81], v[80:81], v[16:17]
v_pk_mul_f32 v[82:83], v[82:83], v[16:17]
v_pk_mul_f32 v[84:85], v[84:85], v[16:17]
v_pk_mul_f32 v[86:87], v[86:87], v[16:17]
v_pk_mul_f32 v[88:89], v[88:89], v[16:17]
v_pk_mul_f32 v[90:91], v[90:91], v[16:17]
v_pk_mul_f32 v[92:93], v[92:93], v[16:17]
v_pk_mul_f32 v[94:95], v[94:95], v[16:17]
v_pk_mul_f32 v[96:97], v[96:97], v[16:17]
v_pk_mul_f32 v[98:99], v[98:99], v[16:17]
v_pk_mul_f32 v[100:101], v[100:101], v[16:17]
v_pk_mul_f32 v[102:103], v[102:103], v[16:17]
v_pk_mul_f32 v[104:105], v[104:105], v[16:17]
v_pk_mul_f32 v[106:107], v[106:107], v[16:17]
v_pk_mul_f32 v[108:109], v[108:109], v[16:17]
v_pk_mul_f32 v[110:111], v[110:111], v[16:17]
v_pk_mul_f32 v[112:113], v[112:113], v[16:17]
v_pk_mul_f32 v[114:115], v[114:115], v[16:17]
v_pk_mul_f32 v[116:117], v[116:117], v[16:17]
v_pk_mul_f32 v[118:119], v[118:119], v[16:17]
v_pk_mul_f32 v[120:121], v[120:121], v[16:17]
v_pk_mul_f32 v[122:123], v[122:123], v[16:17]
v_pk_mul_f32 v[124:125], v[124:125], v[16:17]
v_pk_mul_f32 v[126:127], v[126:127], v[16:17]
v_cvt_pk_bf16_f32 v128, v64, v65
v_cvt_pk_bf16_f32 v129, v66, v67
v_cvt_pk_bf16_f32 v130, v68, v69
v_cvt_pk_bf16_f32 v131, v70, v71
v_cvt_pk_bf16_f32 v132, v72, v73
v_cvt_pk_bf16_f32 v133, v74, v75
v_cvt_pk_bf16_f32 v134, v76, v77
v_cvt_pk_bf16_f32 v135, v78, v79
v_cvt_pk_bf16_f32 v136, v80, v81
v_cvt_pk_bf16_f32 v137, v82, v83
v_cvt_pk_bf16_f32 v138, v84, v85
v_cvt_pk_bf16_f32 v139, v86, v87
v_cvt_pk_bf16_f32 v140, v88, v89
v_cvt_pk_bf16_f32 v141, v90, v91
v_cvt_pk_bf16_f32 v142, v92, v93
v_cvt_pk_bf16_f32 v143, v94, v95
v_cvt_pk_bf16_f32 v144, v96, v97
v_cvt_pk_bf16_f32 v145, v98, v99
v_cvt_pk_bf16_f32 v146, v100, v101
v_cvt_pk_bf16_f32 v147, v102, v103
v_cvt_pk_bf16_f32 v148, v104, v105
v_cvt_pk_bf16_f32 v149, v106, v107
v_cvt_pk_bf16_f32 v150, v108, v109
v_cvt_pk_bf16_f32 v151, v110, v111
v_cvt_pk_bf16_f32 v152, v112, v113
v_cvt_pk_bf16_f32 v153, v114, v115
v_cvt_pk_bf16_f32 v154, v116, v117
v_cvt_pk_bf16_f32 v155, v118, v119
v_cvt_pk_bf16_f32 v156, v120, v121
v_cvt_pk_bf16_f32 v157, v122, v123
v_cvt_pk_bf16_f32 v158, v124, v125
v_cvt_pk_bf16_f32 v159, v126, v127
s_add_u32 s32, s34, 0x0
s_add_u32 s33, s32, 4096
buffer_store_dwordx4 v[128:131], v251, s[4:7], s32 offen offset:0 sc1
buffer_store_dwordx4 v[132:135], v251, s[4:7], s32 offen offset:1024 sc1
buffer_store_dwordx4 v[136:139], v251, s[4:7], s32 offen offset:2048 sc1
buffer_store_dwordx4 v[140:143], v251, s[4:7], s32 offen offset:3072 sc1
buffer_store_dwordx4 v[144:147], v251, s[4:7], s33 offen offset:0 sc1
buffer_store_dwordx4 v[148:151], v251, s[4:7], s33 offen offset:1024 sc1
buffer_store_dwordx4 v[152:155], v251, s[4:7], s33 offen offset:2048 sc1
buffer_store_dwordx4 v[156:159], v251, s[4:7], s33 offen offset:3072 sc1
buffer_load_dword v2, v4, s[60:63], 0 offen offset:12 sc1
v_lshlrev_b32 v64, 16, v128
v_and_b32 v65, 0xffff0000, v128
v_lshlrev_b32 v66, 16, v129
v_and_b32 v67, 0xffff0000, v129
v_lshlrev_b32 v68, 16, v130
v_and_b32 v69, 0xffff0000, v130
v_lshlrev_b32 v70, 16, v131
v_and_b32 v71, 0xffff0000, v131
v_lshlrev_b32 v72, 16, v132
v_and_b32 v73, 0xffff0000, v132
v_lshlrev_b32 v74, 16, v133
v_and_b32 v75, 0xffff0000, v133
v_lshlrev_b32 v76, 16, v134
v_and_b32 v77, 0xffff0000, v134
v_lshlrev_b32 v78, 16, v135
v_and_b32 v79, 0xffff0000, v135
v_lshlrev_b32 v80, 16, v136
v_and_b32 v81, 0xffff0000, v136
v_lshlrev_b32 v82, 16, v137
v_and_b32 v83, 0xffff0000, v137
v_lshlrev_b32 v84, 16, v138
v_and_b32 v85, 0xffff0000, v138
v_lshlrev_b32 v86, 16, v139
v_and_b32 v87, 0xffff0000, v139
v_lshlrev_b32 v88, 16, v140
v_and_b32 v89, 0xffff0000, v140
v_lshlrev_b32 v90, 16, v141
v_and_b32 v91, 0xffff0000, v141
v_lshlrev_b32 v92, 16, v142
v_and_b32 v93, 0xffff0000, v142
v_lshlrev_b32 v94, 16, v143
v_and_b32 v95, 0xffff0000, v143
v_lshlrev_b32 v96, 16, v144
v_and_b32 v97, 0xffff0000, v144
v_lshlrev_b32 v98, 16, v145
v_and_b32 v99, 0xffff0000, v145
v_lshlrev_b32 v100, 16, v146
v_and_b32 v101, 0xffff0000, v146
v_lshlrev_b32 v102, 16, v147
v_and_b32 v103, 0xffff0000, v147
v_lshlrev_b32 v104, 16, v148
v_and_b32 v105, 0xffff0000, v148
v_lshlrev_b32 v106, 16, v149
v_and_b32 v107, 0xffff0000, v149
v_lshlrev_b32 v108, 16, v150
v_and_b32 v109, 0xffff0000, v150
v_lshlrev_b32 v110, 16, v151
v_and_b32 v111, 0xffff0000, v151
v_lshlrev_b32 v112, 16, v152
v_and_b32 v113, 0xffff0000, v152
v_lshlrev_b32 v114, 16, v153
v_and_b32 v115, 0xffff0000, v153
v_lshlrev_b32 v116, 16, v154
v_and_b32 v117, 0xffff0000, v154
v_lshlrev_b32 v118, 16, v155
v_and_b32 v119, 0xffff0000, v155
v_lshlrev_b32 v120, 16, v156
v_and_b32 v121, 0xffff0000, v156
v_lshlrev_b32 v122, 16, v157
v_and_b32 v123, 0xffff0000, v157
v_lshlrev_b32 v124, 16, v158
v_and_b32 v125, 0xffff0000, v158
v_lshlrev_b32 v126, 16, v159
v_and_b32 v127, 0xffff0000, v159
v_pk_add_f32 v[16:17], v[64:65], v[72:73]
v_pk_add_f32 v[18:19], v[66:67], v[74:75]
v_pk_add_f32 v[20:21], v[68:69], v[76:77]
v_pk_add_f32 v[22:23], v[70:71], v[78:79]
v_pk_add_f32 v[16:17], v[16:17], v[80:81]
v_pk_add_f32 v[18:19], v[18:19], v[82:83]
v_pk_add_f32 v[20:21], v[20:21], v[84:85]
v_pk_add_f32 v[22:23], v[22:23], v[86:87]
v_pk_add_f32 v[16:17], v[16:17], v[88:89]
v_pk_add_f32 v[18:19], v[18:19], v[90:91]
v_pk_add_f32 v[20:21], v[20:21], v[92:93]
v_pk_add_f32 v[22:23], v[22:23], v[94:95]
v_pk_add_f32 v[16:17], v[16:17], v[96:97]
v_pk_add_f32 v[18:19], v[18:19], v[98:99]
v_pk_add_f32 v[20:21], v[20:21], v[100:101]
v_pk_add_f32 v[22:23], v[22:23], v[102:103]
v_pk_add_f32 v[16:17], v[16:17], v[104:105]
v_pk_add_f32 v[18:19], v[18:19], v[106:107]
v_pk_add_f32 v[20:21], v[20:21], v[108:109]
v_pk_add_f32 v[22:23], v[22:23], v[110:111]
v_pk_add_f32 v[16:17], v[16:17], v[112:113]
v_pk_add_f32 v[18:19], v[18:19], v[114:115]
v_pk_add_f32 v[20:21], v[20:21], v[116:117]
v_pk_add_f32 v[22:23], v[22:23], v[118:119]
v_pk_add_f32 v[16:17], v[16:17], v[120:121]
v_pk_add_f32 v[18:19], v[18:19], v[122:123]
v_pk_add_f32 v[20:21], v[20:21], v[124:125]
v_pk_add_f32 v[22:23], v[22:23], v[126:127]
v_pk_add_f32 v[16:17], v[16:17], v[18:19]
v_pk_add_f32 v[20:21], v[20:21], v[22:23]
v_pk_add_f32 v[16:17], v[16:17], v[20:21]
v_add_f32 v16, v16, v17
ds_write_b32 v253, v16 offset:0
s_waitcnt lgkmcnt(0)
s_barrier
ds_read_b128 v[16:19], v254 offset:0
ds_read_b128 v[20:23], v254 offset:16
ds_read_b128 v[24:27], v254 offset:32
ds_read_b128 v[28:31], v254 offset:48
s_waitcnt lgkmcnt(2)
v_pk_add_f32 v[16:17], v[16:17], v[18:19]
v_pk_add_f32 v[20:21], v[20:21], v[22:23]
s_waitcnt lgkmcnt(0)
v_pk_add_f32 v[24:25], v[24:25], v[26:27]
v_pk_add_f32 v[28:29], v[28:29], v[30:31]
v_pk_add_f32 v[16:17], v[16:17], v[20:21]
v_pk_add_f32 v[24:25], v[24:25], v[28:29]
v_pk_add_f32 v[16:17], v[16:17], v[24:25]
v_add_f32 v16, v16, v17
v_mul_f32 v16, 0xba800000, v16
v_mov_b32 v17, v16
v_pk_add_f32 v[64:65], v[64:65], v[16:17]
v_pk_add_f32 v[66:67], v[66:67], v[16:17]
v_pk_add_f32 v[68:69], v[68:69], v[16:17]
v_pk_add_f32 v[70:71], v[70:71], v[16:17]
v_pk_add_f32 v[72:73], v[72:73], v[16:17]
v_pk_add_f32 v[74:75], v[74:75], v[16:17]
v_pk_add_f32 v[76:77], v[76:77], v[16:17]
v_pk_add_f32 v[78:79], v[78:79], v[16:17]
v_pk_add_f32 v[80:81], v[80:81], v[16:17]
v_pk_add_f32 v[82:83], v[82:83], v[16:17]
v_pk_add_f32 v[84:85], v[84:85], v[16:17]
v_pk_add_f32 v[86:87], v[86:87], v[16:17]
v_pk_add_f32 v[88:89], v[88:89], v[16:17]
v_pk_add_f32 v[90:91], v[90:91], v[16:17]
v_pk_add_f32 v[92:93], v[92:93], v[16:17]
v_pk_add_f32 v[94:95], v[94:95], v[16:17]
v_pk_add_f32 v[96:97], v[96:97], v[16:17]
v_pk_add_f32 v[98:99], v[98:99], v[16:17]
v_pk_add_f32 v[100:101], v[100:101], v[16:17]
v_pk_add_f32 v[102:103], v[102:103], v[16:17]
v_pk_add_f32 v[104:105], v[104:105], v[16:17]
v_pk_add_f32 v[106:107], v[106:107], v[16:17]
v_pk_add_f32 v[108:109], v[108:109], v[16:17]
v_pk_add_f32 v[110:111], v[110:111], v[16:17]
v_pk_add_f32 v[112:113], v[112:113], v[16:17]
v_pk_add_f32 v[114:115], v[114:115], v[16:17]
v_pk_add_f32 v[116:117], v[116:117], v[16:17]
v_pk_add_f32 v[118:119], v[118:119], v[16:17]
v_pk_add_f32 v[120:121], v[120:121], v[16:17]
v_pk_add_f32 v[122:123], v[122:123], v[16:17]
v_pk_add_f32 v[124:125], v[124:125], v[16:17]
v_pk_add_f32 v[126:127], v[126:127], v[16:17]
v_pk_mul_f32 v[16:17], v[64:65], v[64:65]
v_pk_mul_f32 v[18:19], v[66:67], v[66:67]
v_pk_mul_f32 v[20:21], v[68:69], v[68:69]
v_pk_mul_f32 v[22:23], v[70:71], v[70:71]
v_pk_fma_f32 v[16:17], v[72:73], v[72:73], v[16:17]
v_pk_fma_f32 v[18:19], v[74:75], v[74:75], v[18:19]
v_pk_fma_f32 v[20:21], v[76:77], v[76:77], v[20:21]
v_pk_fma_f32 v[22:23], v[78:79], v[78:79], v[22:23]
v_pk_fma_f32 v[16:17], v[80:81], v[80:81], v[16:17]
v_pk_fma_f32 v[18:19], v[82:83], v[82:83], v[18:19]
v_pk_fma_f32 v[20:21], v[84:85], v[84:85], v[20:21]
v_pk_fma_f32 v[22:23], v[86:87], v[86:87], v[22:23]
v_pk_fma_f32 v[16:17], v[88:89], v[88:89], v[16:17]
v_pk_fma_f32 v[18:19], v[90:91], v[90:91], v[18:19]
v_pk_fma_f32 v[20:21], v[92:93], v[92:93], v[20:21]
v_pk_fma_f32 v[22:23], v[94:95], v[94:95], v[22:23]
v_pk_fma_f32 v[16:17], v[96:97], v[96:97], v[16:17]
v_pk_fma_f32 v[18:19], v[98:99], v[98:99], v[18:19]
v_pk_fma_f32 v[20:21], v[100:101], v[100:101], v[20:21]
v_pk_fma_f32 v[22:23], v[102:103], v[102:103], v[22:23]
v_pk_fma_f32 v[16:17], v[104:105], v[104:105], v[16:17]
v_pk_fma_f32 v[18:19], v[106:107], v[106:107], v[18:19]
v_pk_fma_f32 v[20:21], v[108:109], v[108:109], v[20:21]
v_pk_fma_f32 v[22:23], v[110:111], v[110:111], v[22:23]
v_pk_fma_f32 v[16:17], v[112:113], v[112:113], v[16:17]
v_pk_fma_f32 v[18:19], v[114:115], v[114:115], v[18:19]
v_pk_fma_f32 v[20:21], v[116:117], v[116:117], v[20:21]
v_pk_fma_f32 v[22:23], v[118:119], v[118:119], v[22:23]
v_pk_fma_f32 v[16:17], v[120:121], v[120:121], v[16:17]
v_pk_fma_f32 v[18:19], v[122:123], v[122:123], v[18:19]
v_pk_fma_f32 v[20:21], v[124:125], v[124:125], v[20:21]
v_pk_fma_f32 v[22:23], v[126:127], v[126:127], v[22:23]
v_pk_add_f32 v[16:17], v[16:17], v[18:19]
v_pk_add_f32 v[20:21], v[20:21], v[22:23]
v_pk_add_f32 v[16:17], v[16:17], v[20:21]
v_add_f32 v16, v16, v17
ds_write_b32 v253, v16 offset:1024
s_waitcnt lgkmcnt(0)
s_waitcnt vmcnt(0)
s_barrier
s_cmp_lg_u32 s14, 0
s_cbranch_scc1 main_kernel_s_nf
v_cmp_gt_u32 vcc, 4, v2
s_cbranch_vccz main_kernel_s_wa1_ok
v_mov_b32 v2, 0
main_kernel_s_wa1:
buffer_load_dword v3, v2, s[60:63], 0 offen offset:12 sc1
s_waitcnt vmcnt(0)
v_cmp_gt_u32 vcc, 4, v3
s_cbranch_vccz main_kernel_s_wa1_ok
s_sleep 4
s_sub_u32 s29, s29, 1
s_cbranch_scc0 main_kernel_s_wa1
s_branch main_kernel_end
main_kernel_s_wa1_ok:
s_mov_b64 exec, 1
buffer_store_dword v8, v4, s[4:7], s16 offen sc1
s_mov_b64 exec, -1
main_kernel_s_nf:
ds_read_b128 v[16:19], v254 offset:1024
ds_read_b128 v[20:23], v254 offset:1040
ds_read_b128 v[24:27], v254 offset:1056
ds_read_b128 v[28:31], v254 offset:1072
s_waitcnt lgkmcnt(2)
v_pk_add_f32 v[16:17], v[16:17], v[18:19]
v_pk_add_f32 v[20:21], v[20:21], v[22:23]
s_waitcnt lgkmcnt(0)
v_pk_add_f32 v[24:25], v[24:25], v[26:27]
v_pk_add_f32 v[28:29], v[28:29], v[30:31]
v_pk_add_f32 v[16:17], v[16:17], v[20:21]
v_pk_add_f32 v[24:25], v[24:25], v[28:29]
v_pk_add_f32 v[16:17], v[16:17], v[24:25]
v_add_f32 v16, v16, v17
v_mov_b32 v17, 0x3727c5ac
v_fmac_f32 v17, 0x3a800000, v16
v_rsq_f32 v16, v17
s_nop 0
v_mov_b32 v17, v16
v_pk_mul_f32 v[64:65], v[64:65], v[16:17]
v_pk_mul_f32 v[66:67], v[66:67], v[16:17]
v_pk_mul_f32 v[68:69], v[68:69], v[16:17]
v_pk_mul_f32 v[70:71], v[70:71], v[16:17]
v_pk_mul_f32 v[72:73], v[72:73], v[16:17]
v_pk_mul_f32 v[74:75], v[74:75], v[16:17]
v_pk_mul_f32 v[76:77], v[76:77], v[16:17]
v_pk_mul_f32 v[78:79], v[78:79], v[16:17]
v_pk_mul_f32 v[80:81], v[80:81], v[16:17]
v_pk_mul_f32 v[82:83], v[82:83], v[16:17]
v_pk_mul_f32 v[84:85], v[84:85], v[16:17]
v_pk_mul_f32 v[86:87], v[86:87], v[16:17]
v_pk_mul_f32 v[88:89], v[88:89], v[16:17]
v_pk_mul_f32 v[90:91], v[90:91], v[16:17]
v_pk_mul_f32 v[92:93], v[92:93], v[16:17]
v_pk_mul_f32 v[94:95], v[94:95], v[16:17]
v_pk_mul_f32 v[96:97], v[96:97], v[16:17]
v_pk_mul_f32 v[98:99], v[98:99], v[16:17]
v_pk_mul_f32 v[100:101], v[100:101], v[16:17]
v_pk_mul_f32 v[102:103], v[102:103], v[16:17]
v_pk_mul_f32 v[104:105], v[104:105], v[16:17]
v_pk_mul_f32 v[106:107], v[106:107], v[16:17]
v_pk_mul_f32 v[108:109], v[108:109], v[16:17]
v_pk_mul_f32 v[110:111], v[110:111], v[16:17]
v_pk_mul_f32 v[112:113], v[112:113], v[16:17]
v_pk_mul_f32 v[114:115], v[114:115], v[16:17]
v_pk_mul_f32 v[116:117], v[116:117], v[16:17]
v_pk_mul_f32 v[118:119], v[118:119], v[16:17]
v_pk_mul_f32 v[120:121], v[120:121], v[16:17]
v_pk_mul_f32 v[122:123], v[122:123], v[16:17]
v_pk_mul_f32 v[124:125], v[124:125], v[16:17]
v_pk_mul_f32 v[126:127], v[126:127], v[16:17]
v_cvt_pk_bf16_f32 v32, v64, v65
v_cvt_pk_bf16_f32 v33, v66, v67
v_cvt_pk_bf16_f32 v34, v68, v69
v_cvt_pk_bf16_f32 v35, v70, v71
v_cvt_pk_bf16_f32 v36, v72, v73
v_cvt_pk_bf16_f32 v37, v74, v75
v_cvt_pk_bf16_f32 v38, v76, v77
v_cvt_pk_bf16_f32 v39, v78, v79
v_cvt_pk_bf16_f32 v40, v80, v81
v_cvt_pk_bf16_f32 v41, v82, v83
v_cvt_pk_bf16_f32 v42, v84, v85
v_cvt_pk_bf16_f32 v43, v86, v87
v_cvt_pk_bf16_f32 v44, v88, v89
v_cvt_pk_bf16_f32 v45, v90, v91
v_cvt_pk_bf16_f32 v46, v92, v93
v_cvt_pk_bf16_f32 v47, v94, v95
v_cvt_pk_bf16_f32 v48, v96, v97
v_cvt_pk_bf16_f32 v49, v98, v99
v_cvt_pk_bf16_f32 v50, v100, v101
v_cvt_pk_bf16_f32 v51, v102, v103
v_cvt_pk_bf16_f32 v52, v104, v105
v_cvt_pk_bf16_f32 v53, v106, v107
v_cvt_pk_bf16_f32 v54, v108, v109
v_cvt_pk_bf16_f32 v55, v110, v111
v_cvt_pk_bf16_f32 v56, v112, v113
v_cvt_pk_bf16_f32 v57, v114, v115
v_cvt_pk_bf16_f32 v58, v116, v117
v_cvt_pk_bf16_f32 v59, v118, v119
v_cvt_pk_bf16_f32 v60, v120, v121
v_cvt_pk_bf16_f32 v61, v122, v123
v_cvt_pk_bf16_f32 v62, v124, v125
v_cvt_pk_bf16_f32 v63, v126, v127
s_add_u32 s32, s34, 0x400000
s_add_u32 s33, s32, 4096
buffer_store_dwordx4 v[32:35], v251, s[4:7], s32 offen offset:0 sc1
buffer_store_dwordx4 v[36:39], v251, s[4:7], s32 offen offset:1024 sc1
buffer_store_dwordx4 v[40:43], v251, s[4:7], s32 offen offset:2048 sc1
buffer_store_dwordx4 v[44:47], v251, s[4:7], s32 offen offset:3072 sc1
buffer_store_dwordx4 v[48:51], v251, s[4:7], s33 offen offset:0 sc1
buffer_store_dwordx4 v[52:55], v251, s[4:7], s33 offen offset:1024 sc1
buffer_store_dwordx4 v[56:59], v251, s[4:7], s33 offen offset:2048 sc1
buffer_store_dwordx4 v[60:63], v251, s[4:7], s33 offen offset:3072 sc1
s_add_u32 s16, s16, 4
s_branch main_kernel_s_wa2_ok
main_kernel_s_fill:
s_lshl_b32 s32, s16, 2
s_sub_u32 s33, s32, 48
s_lshl_b32 s34, s32, 12
s_add_u32 s34, s34, 0x6c00000
s_cmp_lt_u32 s33, 16
s_cselect_b32 s34, 0x7f000000, s34
buffer_store_dwordx4 v[8:11], v1, s[4:7], s34 offen sc1
s_sub_u32 s33, s32, 47
s_lshl_b32 s34, s32, 12
s_add_u32 s34, s34, 0x6c01000
s_cmp_lt_u32 s33, 16
s_cselect_b32 s34, 0x7f000000, s34
buffer_store_dwordx4 v[8:11], v1, s[4:7], s34 offen sc1
s_sub_u32 s33, s32, 46
s_lshl_b32 s34, s32, 12
s_add_u32 s34, s34, 0x6c02000
s_cmp_lt_u32 s33, 16
s_cselect_b32 s34, 0x7f000000, s34
buffer_store_dwordx4 v[8:11], v1, s[4:7], s34 offen sc1
s_sub_u32 s33, s32, 45
s_lshl_b32 s34, s32, 12
s_add_u32 s34, s34, 0x6c03000
s_cmp_lt_u32 s33, 16
s_cselect_b32 s34, 0x7f000000, s34
buffer_store_dwordx4 v[8:11], v1, s[4:7], s34 offen sc1
s_lshl_b32 s32, s16, 12
s_add_u32 s33, s32, 0x8c00000
s_add_u32 s34, s32, 0x6e00000
buffer_store_dwordx4 v[8:11], v1, s[4:7], s34 offen sc1
s_add_u32 s32, s32, 0x8000000
buffer_store_dwordx4 v[8:11], v1, s[4:7], s32 offen sc1
buffer_store_dwordx4 v[8:11], v1, s[4:7], s33 offen sc1
s_lshl_b32 s16, s16, 2
s_add_u32 s16, s16, 0x841f000
s_cmp_lg_u32 s16, 0x841f034
s_cbranch_scc1 main_kernel_s_fd
s_mov_b32 s8, s76
s_and_b32 s9, s77, 0xffff
s_mov_b32 s10, 0x4000
s_mov_b32 s11, 0x20000
v_and_b32 v2, 7, v0
v_lshlrev_b32 v2, 11, v2
v_lshrrev_b32 v3, 6, v0
v_lshl_add_u32 v2, v3, 7, v2
v_bfe_u32 v3, v0, 4, 2
v_lshl_add_u32 v2, v3, 5, v2
v_bfe_u32 v3, v0, 3, 1
v_lshl_add_u32 v2, v3, 4, v2
buffer_load_dwordx4 v[16:19], v2, s[8:11], 0 offen offset:0
buffer_load_dwordx4 v[20:23], v2, s[8:11], 0 offen offset:512
buffer_load_dwordx4 v[24:27], v2, s[8:11], 0 offen offset:1024
buffer_load_dwordx4 v[28:31], v2, s[8:11], 0 offen offset:1536
s_mov_b32 s32, 0x6c30000
s_waitcnt vmcnt(0)
s_cmp_lt_u32 s14, 0
s_cbranch_scc1 main_kernel_s_m0b
v_lshlrev_b32 v2, 16, v16
v_and_b32 v3, 0xffff0000, v16
v_cvt_pk_f16_f32 v16, v2, v3
v_lshlrev_b32 v2, 16, v17
v_and_b32 v3, 0xffff0000, v17
v_cvt_pk_f16_f32 v17, v2, v3
v_lshlrev_b32 v2, 16, v18
v_and_b32 v3, 0xffff0000, v18
v_cvt_pk_f16_f32 v18, v2, v3
v_lshlrev_b32 v2, 16, v19
v_and_b32 v3, 0xffff0000, v19
v_cvt_pk_f16_f32 v19, v2, v3
v_lshlrev_b32 v2, 16, v20
v_and_b32 v3, 0xffff0000, v20
v_cvt_pk_f16_f32 v20, v2, v3
v_lshlrev_b32 v2, 16, v21
v_and_b32 v3, 0xffff0000, v21
v_cvt_pk_f16_f32 v21, v2, v3
v_lshlrev_b32 v2, 16, v22
v_and_b32 v3, 0xffff0000, v22
v_cvt_pk_f16_f32 v22, v2, v3
v_lshlrev_b32 v2, 16, v23
v_and_b32 v3, 0xffff0000, v23
v_cvt_pk_f16_f32 v23, v2, v3
v_lshlrev_b32 v2, 16, v24
v_and_b32 v3, 0xffff0000, v24
v_cvt_pk_f16_f32 v24, v2, v3
v_lshlrev_b32 v2, 16, v25
v_and_b32 v3, 0xffff0000, v25
v_cvt_pk_f16_f32 v25, v2, v3
v_lshlrev_b32 v2, 16, v26
v_and_b32 v3, 0xffff0000, v26
v_cvt_pk_f16_f32 v26, v2, v3
v_lshlrev_b32 v2, 16, v27
v_and_b32 v3, 0xffff0000, v27
v_cvt_pk_f16_f32 v27, v2, v3
v_lshlrev_b32 v2, 16, v28
v_and_b32 v3, 0xffff0000, v28
v_cvt_pk_f16_f32 v28, v2, v3
v_lshlrev_b32 v2, 16, v29
v_and_b32 v3, 0xffff0000, v29
v_cvt_pk_f16_f32 v29, v2, v3
v_lshlrev_b32 v2, 16, v30
v_and_b32 v3, 0xffff0000, v30
v_cvt_pk_f16_f32 v30, v2, v3
v_lshlrev_b32 v2, 16, v31
v_and_b32 v3, 0xffff0000, v31
v_cvt_pk_f16_f32 v31, v2, v3
main_kernel_s_m0b:
v_xor_b32 v2, 0, v1
buffer_store_dwordx4 v[16:19], v1, s[4:7], s32 offen sc1
s_add_u32 s32, s32, 4096
buffer_store_dwordx4 v[20:23], v2, s[4:7], s32 offen sc1
s_add_u32 s32, s32, 4096
buffer_store_dwordx4 v[24:27], v1, s[4:7], s32 offen sc1
s_add_u32 s32, s32, 4096
buffer_store_dwordx4 v[28:31], v2, s[4:7], s32 offen sc1
s_add_u32 s32, s32, 4096
buffer_store_dwordx4 v[4:7], v1, s[4:7], s32 offen sc1
s_add_u32 s32, s32, 4096
buffer_store_dwordx4 v[4:7], v2, s[4:7], s32 offen sc1
s_add_u32 s32, s32, 4096
buffer_store_dwordx4 v[4:7], v1, s[4:7], s32 offen sc1
s_add_u32 s32, s32, 4096
buffer_store_dwordx4 v[4:7], v2, s[4:7], s32 offen sc1
s_add_u32 s32, s32, 4096
buffer_store_dwordx4 v[16:19], v1, s[4:7], s32 offen sc1
s_add_u32 s32, s32, 4096
buffer_store_dwordx4 v[20:23], v2, s[4:7], s32 offen sc1
s_add_u32 s32, s32, 4096
buffer_store_dwordx4 v[24:27], v1, s[4:7], s32 offen sc1
s_add_u32 s32, s32, 4096
buffer_store_dwordx4 v[28:31], v2, s[4:7], s32 offen sc1
s_add_u32 s32, s32, 4096
buffer_store_dwordx4 v[4:7], v1, s[4:7], s32 offen sc1
s_add_u32 s32, s32, 4096
buffer_store_dwordx4 v[4:7], v2, s[4:7], s32 offen sc1
s_add_u32 s32, s32, 4096
buffer_store_dwordx4 v[4:7], v1, s[4:7], s32 offen sc1
s_add_u32 s32, s32, 4096
buffer_store_dwordx4 v[4:7], v2, s[4:7], s32 offen sc1
s_add_u32 s32, s32, 4096
v_mov_b32 v2, 0
main_kernel_s_wa3:
buffer_load_dword v3, v2, s[60:63], 0 offen offset:12 sc1
s_waitcnt vmcnt(0)
v_cmp_gt_u32 vcc, 4, v3
s_cbranch_vccz main_kernel_s_wa3_ok
s_sleep 4
s_sub_u32 s29, s29, 1
s_cbranch_scc0 main_kernel_s_wa3
s_branch main_kernel_end
main_kernel_s_wa3_ok:
v_lshlrev_b32 v2, 7, v250
s_mov_b32 s32, 0x841a000
s_mov_b64 exec, 15
buffer_store_dwordx4 v[8:11], v2, s[4:7], s32 offen sc1
s_mov_b64 exec, -1
main_kernel_s_fd:
s_cmp_lg_u32 s14, 0
s_cbranch_scc1 main_kernel_s_wa2_ok
v_mov_b32 v2, 0
main_kernel_s_wa2:
buffer_load_dword v3, v2, s[60:63], 0 offen offset:12 sc1
s_waitcnt vmcnt(0)
v_cmp_gt_u32 vcc, 4, v3
s_cbranch_vccz main_kernel_s_wa2_ok
s_sleep 4
s_sub_u32 s29, s29, 1
s_cbranch_scc0 main_kernel_s_wa2
s_branch main_kernel_end
main_kernel_s_wa2_ok:
s_waitcnt vmcnt(0)
s_barrier
s_cmp_lg_u32 s14, 0
s_cbranch_scc1 main_kernel_s_end
s_mov_b64 exec, 1
buffer_store_dword v8, v4, s[4:7], s16 offen sc1
s_mov_b64 exec, -1
main_kernel_s_end:
s_lshl_b32 s32, s12, 5
s_add_u32 s32, s32, s13
s_sub_u32 s32, s32, 96
s_cmp_lt_u32 s32, 16
s_cbranch_scc1 main_kernel_att
s_branch main_kernel_worker
main_kernel_end:
s_endpgm
main_kernel_chain:
s_lshr_b32 s15, s13, 1
s_lshl_b32 s32, s12, 4
s_add_u32 s15, s15, s32
s_and_b32 s16, s13, 1
s_lshl_b32 s36, s14, 15
s_add_u32 s36, s36, 32768
v_lshrrev_b32 v126, 3, v94
v_and_b32 v127, 7, v94
v_lshlrev_b32 v126, 13, v126
v_lshl_add_u32 v64, v127, 4, v126
v_lshrrev_b32 v126, 2, v94
v_and_b32 v70, 3, v94
v_lshlrev_b32 v126, 11, v126
v_lshl_add_u32 v65, v70, 4, v126
v_lshrrev_b32 v126, 5, v94
v_lshlrev_b32 v69, 4, v126
v_bfe_u32 v126, v94, 4, 1
v_lshl_add_u32 v69, v126, 2, v69
v_bfe_u32 v126, v94, 2, 1
v_add_u32 v69, v69, v126
v_bfe_u32 v126, v94, 3, 1
v_lshl_add_u32 v69, v126, 3, v69
v_lshl_add_u32 v126, v69, 7, s36
v_lshl_add_u32 v67, v70, 3, v126
v_lshl_add_u32 v126, v69, 6, s36
v_lshl_add_u32 v68, v70, 3, v126
v_lshlrev_b32 v116, 4, v94
v_add_u32 v113, s36, v116
v_lshlrev_b32 v126, 7, v69
v_lshl_add_u32 v41, v70, 3, v126
v_lshl_add_u32 v41, s14, 5, v41
v_and_b32 v127, 1, v70
v_lshl_add_u32 v40, v127, 3, v126
v_lshrrev_b32 v127, 1, v70
v_lshl_add_u32 v40, v127, 5, v40
s_lshr_b32 s32, s14, 1
s_and_b32 s33, s14, 1
v_lshl_add_u32 v40, s32, 6, v40
v_lshl_add_u32 v40, s33, 4, v40
s_xor_b32 s32, s14, 0
s_lshl_b32 s32, s32, 15
s_add_u32 s32, s32, 32768
v_add_u32 v32, s32, v40
v_add_u32 v36, s32, v41
s_xor_b32 s32, s14, 1
s_lshl_b32 s32, s32, 15
s_add_u32 s32, s32, 32768
v_add_u32 v33, s32, v40
v_add_u32 v37, s32, v41
s_xor_b32 s32, s14, 2
s_lshl_b32 s32, s32, 15
s_add_u32 s32, s32, 32768
v_add_u32 v34, s32, v40
v_add_u32 v38, s32, v41
s_xor_b32 s32, s14, 3
s_lshl_b32 s32, s32, 15
s_add_u32 s32, s32, 32768
v_add_u32 v35, s32, v40
v_add_u32 v39, s32, v41
s_lshl_b32 s34, s14, 21
s_lshl_b32 s32, s15, 8
s_add_u32 s34, s34, s32
s_lshl_b32 s32, s16, 7
s_add_u32 s34, s34, s32
s_lshl_b32 s35, s12, 22
s_lshl_b32 s32, s14, 20
s_add_u32 s35, s35, s32
s_lshl_b32 s32, s13, 6
s_add_u32 s35, s35, s32
s_xor_b32 s32, s14, s13
s_and_b32 s32, s32, 3
s_lshl_b32 s32, s32, 19
s_add_u32 s34, s34, s32
s_xor_b32 s32, s14, s13
s_and_b32 s32, s32, 7
s_lshl_b32 s32, s32, 17
s_add_u32 s35, s35, s32
v_bfe_u32 v126, v94, 2, 1
v_lshl_add_u32 v126, s13, 1, v126
v_lshlrev_b32 v126, 13, v126
v_lshl_add_u32 v80, v70, 10, v126
v_and_b32 v126, 7, v94
v_lshl_add_u32 v126, s13, 3, v126
v_lshlrev_b32 v81, 10, v126
v_min_u32 v73, 8, v94
v_lshlrev_b32 v73, 5, v73
v_mov_b32 v126, 12
v_cmp_gt_u32 vcc, 8, v94
v_lshlrev_b32 v74, 2, v94
v_add_u32 v74, 0x841f000, v74
v_cndmask_b32 v73, v126, v73, vcc
v_and_b32 v75, 1, v94
s_lshl_b32 s32, s15, 2
s_add_u32 s32, s32, 0x8406000
v_lshl_add_u32 v75, v75, 13, s32
s_mov_b32 s8, s42
s_and_b32 s9, s43, 0xffff
s_mov_b32 s10, 0x800000
s_mov_b32 s11, 0x20000
s_sub_u32 s39, 511, s42
s_and_b32 s39, s39, 0x380
s_lshr_b32 s33, s39, 7
s_xor_b32 s33, s14, s33
s_and_b32 s33, s33, 3
s_lshl_b32 s33, s33, 19
s_add_u32 s39, s39, s33
s_andn2_b32 s32, s34, 0x180fff
s_add_u32 s39, s39, s32
s_xor_b32 s32, s39, 0x0
buffer_load_dword v82, v80, s[8:11], s32 offen
s_xor_b32 s32, s34, 0x0
s_add_u32 m0, s36, 0
s_nop 0
buffer_load_dwordx4 v64, s[8:11], s32 offen lds
s_xor_b32 s32, s34, 0x10000
s_add_u32 m0, s36, 1024
s_nop 0
buffer_load_dwordx4 v64, s[8:11], s32 offen lds
s_xor_b32 s32, s34, 0x20000
s_add_u32 m0, s36, 2048
s_nop 0
buffer_load_dwordx4 v64, s[8:11], s32 offen lds
s_xor_b32 s32, s34, 0x30000
s_add_u32 m0, s36, 3072
s_nop 0
buffer_load_dwordx4 v64, s[8:11], s32 offen lds
s_xor_b32 s32, s34, 0x40000
s_add_u32 m0, s36, 4096
s_nop 0
buffer_load_dwordx4 v64, s[8:11], s32 offen lds
s_xor_b32 s32, s34, 0x50000
s_add_u32 m0, s36, 5120
s_nop 0
buffer_load_dwordx4 v64, s[8:11], s32 offen lds
s_xor_b32 s32, s34, 0x60000
s_add_u32 m0, s36, 6144
s_nop 0
buffer_load_dwordx4 v64, s[8:11], s32 offen lds
s_xor_b32 s32, s34, 0x70000
s_add_u32 m0, s36, 7168
s_nop 0
buffer_load_dwordx4 v64, s[8:11], s32 offen lds
s_xor_b32 s32, s39, 0x80000
buffer_load_dword v82, v80, s[8:11], s32 offen
s_xor_b32 s32, s34, 0x80000
s_add_u32 m0, s36, 8192
s_nop 0
buffer_load_dwordx4 v64, s[8:11], s32 offen lds
s_xor_b32 s32, s34, 0x90000
s_add_u32 m0, s36, 9216
s_nop 0
buffer_load_dwordx4 v64, s[8:11], s32 offen lds
s_xor_b32 s32, s34, 0xa0000
s_add_u32 m0, s36, 10240
s_nop 0
buffer_load_dwordx4 v64, s[8:11], s32 offen lds
s_xor_b32 s32, s34, 0xb0000
s_add_u32 m0, s36, 11264
s_nop 0
buffer_load_dwordx4 v64, s[8:11], s32 offen lds
s_xor_b32 s32, s34, 0xc0000
s_add_u32 m0, s36, 12288
s_nop 0
buffer_load_dwordx4 v64, s[8:11], s32 offen lds
s_xor_b32 s32, s34, 0xd0000
s_add_u32 m0, s36, 13312
s_nop 0
buffer_load_dwordx4 v64, s[8:11], s32 offen lds
s_xor_b32 s32, s34, 0xe0000
s_add_u32 m0, s36, 14336
s_nop 0
buffer_load_dwordx4 v64, s[8:11], s32 offen lds
s_xor_b32 s32, s34, 0xf0000
s_add_u32 m0, s36, 15360
s_nop 0
buffer_load_dwordx4 v64, s[8:11], s32 offen lds
s_xor_b32 s32, s39, 0x100000
buffer_load_dword v82, v80, s[8:11], s32 offen
s_xor_b32 s32, s34, 0x100000
s_add_u32 m0, s36, 16384
s_nop 0
buffer_load_dwordx4 v64, s[8:11], s32 offen lds
s_xor_b32 s32, s34, 0x110000
s_add_u32 m0, s36, 17408
s_nop 0
buffer_load_dwordx4 v64, s[8:11], s32 offen lds
s_xor_b32 s32, s34, 0x120000
s_add_u32 m0, s36, 18432
s_nop 0
buffer_load_dwordx4 v64, s[8:11], s32 offen lds
s_xor_b32 s32, s34, 0x130000
s_add_u32 m0, s36, 19456
s_nop 0
buffer_load_dwordx4 v64, s[8:11], s32 offen lds
s_xor_b32 s32, s34, 0x140000
s_add_u32 m0, s36, 20480
s_nop 0
buffer_load_dwordx4 v64, s[8:11], s32 offen lds
s_xor_b32 s32, s34, 0x150000
s_add_u32 m0, s36, 21504
s_nop 0
buffer_load_dwordx4 v64, s[8:11], s32 offen lds
s_xor_b32 s32, s34, 0x160000
s_add_u32 m0, s36, 22528
s_nop 0
buffer_load_dwordx4 v64, s[8:11], s32 offen lds
s_xor_b32 s32, s34, 0x170000
s_add_u32 m0, s36, 23552
s_nop 0
buffer_load_dwordx4 v64, s[8:11], s32 offen lds
s_xor_b32 s32, s39, 0x180000
buffer_load_dword v82, v80, s[8:11], s32 offen
s_xor_b32 s32, s34, 0x180000
s_add_u32 m0, s36, 24576
s_nop 0
buffer_load_dwordx4 v64, s[8:11], s32 offen lds
s_xor_b32 s32, s34, 0x190000
s_add_u32 m0, s36, 25600
s_nop 0
buffer_load_dwordx4 v64, s[8:11], s32 offen lds
s_xor_b32 s32, s34, 0x1a0000
s_add_u32 m0, s36, 26624
s_nop 0
buffer_load_dwordx4 v64, s[8:11], s32 offen lds
s_xor_b32 s32, s34, 0x1b0000
s_add_u32 m0, s36, 27648
s_nop 0
buffer_load_dwordx4 v64, s[8:11], s32 offen lds
s_xor_b32 s32, s34, 0x1c0000
s_add_u32 m0, s36, 28672
s_nop 0
buffer_load_dwordx4 v64, s[8:11], s32 offen lds
s_xor_b32 s32, s34, 0x1d0000
s_add_u32 m0, s36, 29696
s_nop 0
buffer_load_dwordx4 v64, s[8:11], s32 offen lds
s_xor_b32 s32, s34, 0x1e0000
s_add_u32 m0, s36, 30720
s_nop 0
buffer_load_dwordx4 v64, s[8:11], s32 offen lds
s_xor_b32 s32, s34, 0x1f0000
s_add_u32 m0, s36, 31744
s_nop 0
buffer_load_dwordx4 v64, s[8:11], s32 offen lds
s_waitcnt vmcnt(27)
s_barrier
ds_read_b64_tr_b16 v[0:1], v32 offset:0
ds_read_b64_tr_b16 v[2:3], v32 offset:256
ds_read_b64_tr_b16 v[4:5], v32 offset:4096
ds_read_b64_tr_b16 v[6:7], v32 offset:4352
ds_read_b64_tr_b16 v[8:9], v33 offset:0
ds_read_b64_tr_b16 v[10:11], v33 offset:256
ds_read_b64_tr_b16 v[12:13], v33 offset:4096
ds_read_b64_tr_b16 v[14:15], v33 offset:4352
ds_read_b64_tr_b16 v[16:17], v34 offset:0
ds_read_b64_tr_b16 v[18:19], v34 offset:256
ds_read_b64_tr_b16 v[20:21], v34 offset:4096
ds_read_b64_tr_b16 v[22:23], v34 offset:4352
ds_read_b64_tr_b16 v[24:25], v35 offset:0
ds_read_b64_tr_b16 v[26:27], v35 offset:256
ds_read_b64_tr_b16 v[28:29], v35 offset:4096
ds_read_b64_tr_b16 v[30:31], v35 offset:4352
s_waitcnt lgkmcnt(0)
s_barrier
s_mov_b32 s8, s44
s_and_b32 s9, s45, 0xffff
s_mov_b32 s10, 0x800000
s_mov_b32 s11, 0x20000
s_sub_u32 s39, 511, s44
s_and_b32 s39, s39, 0x380
s_lshr_b32 s33, s39, 7
s_xor_b32 s33, s14, s33
s_and_b32 s33, s33, 3
s_lshl_b32 s33, s33, 19
s_add_u32 s39, s39, s33
s_andn2_b32 s32, s34, 0x180fff
s_add_u32 s39, s39, s32
s_xor_b32 s32, s39, 0x0
buffer_load_dword v82, v80, s[8:11], s32 offen
s_xor_b32 s32, s34, 0x0
s_add_u32 m0, s36, 0
s_nop 0
buffer_load_dwordx4 v64, s[8:11], s32 offen lds
s_xor_b32 s32, s34, 0x10000
s_add_u32 m0, s36, 1024
s_nop 0
buffer_load_dwordx4 v64, s[8:11], s32 offen lds
s_xor_b32 s32, s34, 0x20000
s_add_u32 m0, s36, 2048
s_nop 0
buffer_load_dwordx4 v64, s[8:11], s32 offen lds
s_xor_b32 s32, s34, 0x30000
s_add_u32 m0, s36, 3072
s_nop 0
buffer_load_dwordx4 v64, s[8:11], s32 offen lds
s_xor_b32 s32, s34, 0x40000
s_add_u32 m0, s36, 4096
s_nop 0
buffer_load_dwordx4 v64, s[8:11], s32 offen lds
s_xor_b32 s32, s34, 0x50000
s_add_u32 m0, s36, 5120
s_nop 0
buffer_load_dwordx4 v64, s[8:11], s32 offen lds
s_xor_b32 s32, s34, 0x60000
s_add_u32 m0, s36, 6144
s_nop 0
buffer_load_dwordx4 v64, s[8:11], s32 offen lds
s_xor_b32 s32, s34, 0x70000
s_add_u32 m0, s36, 7168
s_nop 0
buffer_load_dwordx4 v64, s[8:11], s32 offen lds
v_lshlrev_b32 v42, 16, v0
v_and_b32 v43, 0xffff0000, v0
v_cvt_pk_f16_f32 v0, v42, v43
v_lshlrev_b32 v44, 16, v1
v_and_b32 v45, 0xffff0000, v1
v_cvt_pk_f16_f32 v1, v44, v45
v_lshlrev_b32 v42, 16, v2
v_and_b32 v43, 0xffff0000, v2
v_cvt_pk_f16_f32 v2, v42, v43
v_lshlrev_b32 v44, 16, v3
v_and_b32 v45, 0xffff0000, v3
v_cvt_pk_f16_f32 v3, v44, v45
v_lshlrev_b32 v42, 16, v4
v_and_b32 v43, 0xffff0000, v4
v_cvt_pk_f16_f32 v4, v42, v43
v_lshlrev_b32 v44, 16, v5
v_and_b32 v45, 0xffff0000, v5
v_cvt_pk_f16_f32 v5, v44, v45
v_lshlrev_b32 v42, 16, v6
v_and_b32 v43, 0xffff0000, v6
v_cvt_pk_f16_f32 v6, v42, v43
v_lshlrev_b32 v44, 16, v7
v_and_b32 v45, 0xffff0000, v7
v_cvt_pk_f16_f32 v7, v44, v45
v_accvgpr_write_b32 a128, v0
v_accvgpr_write_b32 a129, v1
v_accvgpr_write_b32 a130, v2
v_accvgpr_write_b32 a131, v3
v_accvgpr_write_b32 a132, v4
v_accvgpr_write_b32 a133, v5
v_accvgpr_write_b32 a134, v6
v_accvgpr_write_b32 a135, v7
v_lshlrev_b32 v42, 16, v8
v_and_b32 v43, 0xffff0000, v8
v_cvt_pk_f16_f32 v8, v42, v43
v_lshlrev_b32 v44, 16, v9
v_and_b32 v45, 0xffff0000, v9
v_cvt_pk_f16_f32 v9, v44, v45
v_lshlrev_b32 v42, 16, v10
v_and_b32 v43, 0xffff0000, v10
v_cvt_pk_f16_f32 v10, v42, v43
v_lshlrev_b32 v44, 16, v11
v_and_b32 v45, 0xffff0000, v11
v_cvt_pk_f16_f32 v11, v44, v45
v_lshlrev_b32 v42, 16, v12
v_and_b32 v43, 0xffff0000, v12
v_cvt_pk_f16_f32 v12, v42, v43
v_lshlrev_b32 v44, 16, v13
v_and_b32 v45, 0xffff0000, v13
v_cvt_pk_f16_f32 v13, v44, v45
v_lshlrev_b32 v42, 16, v14
v_and_b32 v43, 0xffff0000, v14
v_cvt_pk_f16_f32 v14, v42, v43
v_lshlrev_b32 v44, 16, v15
v_and_b32 v45, 0xffff0000, v15
v_cvt_pk_f16_f32 v15, v44, v45
v_accvgpr_write_b32 a160, v8
v_accvgpr_write_b32 a161, v9
v_accvgpr_write_b32 a162, v10
v_accvgpr_write_b32 a163, v11
v_accvgpr_write_b32 a164, v12
v_accvgpr_write_b32 a165, v13
v_accvgpr_write_b32 a166, v14
v_accvgpr_write_b32 a167, v15
v_lshlrev_b32 v42, 16, v16
v_and_b32 v43, 0xffff0000, v16
v_cvt_pk_f16_f32 v16, v42, v43
v_lshlrev_b32 v44, 16, v17
v_and_b32 v45, 0xffff0000, v17
v_cvt_pk_f16_f32 v17, v44, v45
v_lshlrev_b32 v42, 16, v18
v_and_b32 v43, 0xffff0000, v18
v_cvt_pk_f16_f32 v18, v42, v43
v_lshlrev_b32 v44, 16, v19
v_and_b32 v45, 0xffff0000, v19
v_cvt_pk_f16_f32 v19, v44, v45
v_lshlrev_b32 v42, 16, v20
v_and_b32 v43, 0xffff0000, v20
v_cvt_pk_f16_f32 v20, v42, v43
v_lshlrev_b32 v44, 16, v21
v_and_b32 v45, 0xffff0000, v21
v_cvt_pk_f16_f32 v21, v44, v45
v_lshlrev_b32 v42, 16, v22
v_and_b32 v43, 0xffff0000, v22
v_cvt_pk_f16_f32 v22, v42, v43
v_lshlrev_b32 v44, 16, v23
v_and_b32 v45, 0xffff0000, v23
v_cvt_pk_f16_f32 v23, v44, v45
v_accvgpr_write_b32 a192, v16
v_accvgpr_write_b32 a193, v17
v_accvgpr_write_b32 a194, v18
v_accvgpr_write_b32 a195, v19
v_accvgpr_write_b32 a196, v20
v_accvgpr_write_b32 a197, v21
v_accvgpr_write_b32 a198, v22
v_accvgpr_write_b32 a199, v23
v_lshlrev_b32 v42, 16, v24
v_and_b32 v43, 0xffff0000, v24
v_cvt_pk_f16_f32 v24, v42, v43
v_lshlrev_b32 v44, 16, v25
v_and_b32 v45, 0xffff0000, v25
v_cvt_pk_f16_f32 v25, v44, v45
v_lshlrev_b32 v42, 16, v26
v_and_b32 v43, 0xffff0000, v26
v_cvt_pk_f16_f32 v26, v42, v43
v_lshlrev_b32 v44, 16, v27
v_and_b32 v45, 0xffff0000, v27
v_cvt_pk_f16_f32 v27, v44, v45
v_lshlrev_b32 v42, 16, v28
v_and_b32 v43, 0xffff0000, v28
v_cvt_pk_f16_f32 v28, v42, v43
v_lshlrev_b32 v44, 16, v29
v_and_b32 v45, 0xffff0000, v29
v_cvt_pk_f16_f32 v29, v44, v45
v_lshlrev_b32 v42, 16, v30
v_and_b32 v43, 0xffff0000, v30
v_cvt_pk_f16_f32 v30, v42, v43
v_lshlrev_b32 v44, 16, v31
v_and_b32 v45, 0xffff0000, v31
v_cvt_pk_f16_f32 v31, v44, v45
v_accvgpr_write_b32 a224, v24
v_accvgpr_write_b32 a225, v25
v_accvgpr_write_b32 a226, v26
v_accvgpr_write_b32 a227, v27
v_accvgpr_write_b32 a228, v28
v_accvgpr_write_b32 a229, v29
v_accvgpr_write_b32 a230, v30
v_accvgpr_write_b32 a231, v31
s_waitcnt vmcnt(27)
s_barrier
ds_read_b64_tr_b16 v[0:1], v32 offset:8192
ds_read_b64_tr_b16 v[2:3], v32 offset:8448
ds_read_b64_tr_b16 v[4:5], v32 offset:12288
ds_read_b64_tr_b16 v[6:7], v32 offset:12544
ds_read_b64_tr_b16 v[8:9], v33 offset:8192
ds_read_b64_tr_b16 v[10:11], v33 offset:8448
ds_read_b64_tr_b16 v[12:13], v33 offset:12288
ds_read_b64_tr_b16 v[14:15], v33 offset:12544
ds_read_b64_tr_b16 v[16:17], v34 offset:8192
ds_read_b64_tr_b16 v[18:19], v34 offset:8448
ds_read_b64_tr_b16 v[20:21], v34 offset:12288
ds_read_b64_tr_b16 v[22:23], v34 offset:12544
ds_read_b64_tr_b16 v[24:25], v35 offset:8192
ds_read_b64_tr_b16 v[26:27], v35 offset:8448
ds_read_b64_tr_b16 v[28:29], v35 offset:12288
ds_read_b64_tr_b16 v[30:31], v35 offset:12544
s_waitcnt lgkmcnt(0)
s_barrier
s_xor_b32 s32, s39, 0x80000
buffer_load_dword v82, v80, s[8:11], s32 offen
s_xor_b32 s32, s34, 0x80000
s_add_u32 m0, s36, 8192
s_nop 0
buffer_load_dwordx4 v64, s[8:11], s32 offen lds
s_xor_b32 s32, s34, 0x90000
s_add_u32 m0, s36, 9216
s_nop 0
buffer_load_dwordx4 v64, s[8:11], s32 offen lds
s_xor_b32 s32, s34, 0xa0000
s_add_u32 m0, s36, 10240
s_nop 0
buffer_load_dwordx4 v64, s[8:11], s32 offen lds
s_xor_b32 s32, s34, 0xb0000
s_add_u32 m0, s36, 11264
s_nop 0
buffer_load_dwordx4 v64, s[8:11], s32 offen lds
s_xor_b32 s32, s34, 0xc0000
s_add_u32 m0, s36, 12288
s_nop 0
buffer_load_dwordx4 v64, s[8:11], s32 offen lds
s_xor_b32 s32, s34, 0xd0000
s_add_u32 m0, s36, 13312
s_nop 0
buffer_load_dwordx4 v64, s[8:11], s32 offen lds
s_xor_b32 s32, s34, 0xe0000
s_add_u32 m0, s36, 14336
s_nop 0
buffer_load_dwordx4 v64, s[8:11], s32 offen lds
s_xor_b32 s32, s34, 0xf0000
s_add_u32 m0, s36, 15360
s_nop 0
buffer_load_dwordx4 v64, s[8:11], s32 offen lds
v_lshlrev_b32 v42, 16, v0
v_and_b32 v43, 0xffff0000, v0
v_cvt_pk_f16_f32 v0, v42, v43
v_lshlrev_b32 v44, 16, v1
v_and_b32 v45, 0xffff0000, v1
v_cvt_pk_f16_f32 v1, v44, v45
v_lshlrev_b32 v42, 16, v2
v_and_b32 v43, 0xffff0000, v2
v_cvt_pk_f16_f32 v2, v42, v43
v_lshlrev_b32 v44, 16, v3
v_and_b32 v45, 0xffff0000, v3
v_cvt_pk_f16_f32 v3, v44, v45
v_lshlrev_b32 v42, 16, v4
v_and_b32 v43, 0xffff0000, v4
v_cvt_pk_f16_f32 v4, v42, v43
v_lshlrev_b32 v44, 16, v5
v_and_b32 v45, 0xffff0000, v5
v_cvt_pk_f16_f32 v5, v44, v45
v_lshlrev_b32 v42, 16, v6
v_and_b32 v43, 0xffff0000, v6
v_cvt_pk_f16_f32 v6, v42, v43
v_lshlrev_b32 v44, 16, v7
v_and_b32 v45, 0xffff0000, v7
v_cvt_pk_f16_f32 v7, v44, v45
v_accvgpr_write_b32 a136, v0
v_accvgpr_write_b32 a137, v1
v_accvgpr_write_b32 a138, v2
v_accvgpr_write_b32 a139, v3
v_accvgpr_write_b32 a140, v4
v_accvgpr_write_b32 a141, v5
v_accvgpr_write_b32 a142, v6
v_accvgpr_write_b32 a143, v7
v_lshlrev_b32 v42, 16, v8
v_and_b32 v43, 0xffff0000, v8
v_cvt_pk_f16_f32 v8, v42, v43
v_lshlrev_b32 v44, 16, v9
v_and_b32 v45, 0xffff0000, v9
v_cvt_pk_f16_f32 v9, v44, v45
v_lshlrev_b32 v42, 16, v10
v_and_b32 v43, 0xffff0000, v10
v_cvt_pk_f16_f32 v10, v42, v43
v_lshlrev_b32 v44, 16, v11
v_and_b32 v45, 0xffff0000, v11
v_cvt_pk_f16_f32 v11, v44, v45
v_lshlrev_b32 v42, 16, v12
v_and_b32 v43, 0xffff0000, v12
v_cvt_pk_f16_f32 v12, v42, v43
v_lshlrev_b32 v44, 16, v13
v_and_b32 v45, 0xffff0000, v13
v_cvt_pk_f16_f32 v13, v44, v45
v_lshlrev_b32 v42, 16, v14
v_and_b32 v43, 0xffff0000, v14
v_cvt_pk_f16_f32 v14, v42, v43
v_lshlrev_b32 v44, 16, v15
v_and_b32 v45, 0xffff0000, v15
v_cvt_pk_f16_f32 v15, v44, v45
v_accvgpr_write_b32 a168, v8
v_accvgpr_write_b32 a169, v9
v_accvgpr_write_b32 a170, v10
v_accvgpr_write_b32 a171, v11
v_accvgpr_write_b32 a172, v12
v_accvgpr_write_b32 a173, v13
v_accvgpr_write_b32 a174, v14
v_accvgpr_write_b32 a175, v15
v_lshlrev_b32 v42, 16, v16
v_and_b32 v43, 0xffff0000, v16
v_cvt_pk_f16_f32 v16, v42, v43
v_lshlrev_b32 v44, 16, v17
v_and_b32 v45, 0xffff0000, v17
v_cvt_pk_f16_f32 v17, v44, v45
v_lshlrev_b32 v42, 16, v18
v_and_b32 v43, 0xffff0000, v18
v_cvt_pk_f16_f32 v18, v42, v43
v_lshlrev_b32 v44, 16, v19
v_and_b32 v45, 0xffff0000, v19
v_cvt_pk_f16_f32 v19, v44, v45
v_lshlrev_b32 v42, 16, v20
v_and_b32 v43, 0xffff0000, v20
v_cvt_pk_f16_f32 v20, v42, v43
v_lshlrev_b32 v44, 16, v21
v_and_b32 v45, 0xffff0000, v21
v_cvt_pk_f16_f32 v21, v44, v45
v_lshlrev_b32 v42, 16, v22
v_and_b32 v43, 0xffff0000, v22
v_cvt_pk_f16_f32 v22, v42, v43
v_lshlrev_b32 v44, 16, v23
v_and_b32 v45, 0xffff0000, v23
v_cvt_pk_f16_f32 v23, v44, v45
v_accvgpr_write_b32 a200, v16
v_accvgpr_write_b32 a201, v17
v_accvgpr_write_b32 a202, v18
v_accvgpr_write_b32 a203, v19
v_accvgpr_write_b32 a204, v20
v_accvgpr_write_b32 a205, v21
v_accvgpr_write_b32 a206, v22
v_accvgpr_write_b32 a207, v23
v_lshlrev_b32 v42, 16, v24
v_and_b32 v43, 0xffff0000, v24
v_cvt_pk_f16_f32 v24, v42, v43
v_lshlrev_b32 v44, 16, v25
v_and_b32 v45, 0xffff0000, v25
v_cvt_pk_f16_f32 v25, v44, v45
v_lshlrev_b32 v42, 16, v26
v_and_b32 v43, 0xffff0000, v26
v_cvt_pk_f16_f32 v26, v42, v43
v_lshlrev_b32 v44, 16, v27
v_and_b32 v45, 0xffff0000, v27
v_cvt_pk_f16_f32 v27, v44, v45
v_lshlrev_b32 v42, 16, v28
v_and_b32 v43, 0xffff0000, v28
v_cvt_pk_f16_f32 v28, v42, v43
v_lshlrev_b32 v44, 16, v29
v_and_b32 v45, 0xffff0000, v29
v_cvt_pk_f16_f32 v29, v44, v45
v_lshlrev_b32 v42, 16, v30
v_and_b32 v43, 0xffff0000, v30
v_cvt_pk_f16_f32 v30, v42, v43
v_lshlrev_b32 v44, 16, v31
v_and_b32 v45, 0xffff0000, v31
v_cvt_pk_f16_f32 v31, v44, v45
v_accvgpr_write_b32 a232, v24
v_accvgpr_write_b32 a233, v25
v_accvgpr_write_b32 a234, v26
v_accvgpr_write_b32 a235, v27
v_accvgpr_write_b32 a236, v28
v_accvgpr_write_b32 a237, v29
v_accvgpr_write_b32 a238, v30
v_accvgpr_write_b32 a239, v31
s_waitcnt vmcnt(27)
s_barrier
ds_read_b64_tr_b16 v[0:1], v32 offset:16384
ds_read_b64_tr_b16 v[2:3], v32 offset:16640
ds_read_b64_tr_b16 v[4:5], v32 offset:20480
ds_read_b64_tr_b16 v[6:7], v32 offset:20736
ds_read_b64_tr_b16 v[8:9], v33 offset:16384
ds_read_b64_tr_b16 v[10:11], v33 offset:16640
ds_read_b64_tr_b16 v[12:13], v33 offset:20480
ds_read_b64_tr_b16 v[14:15], v33 offset:20736
ds_read_b64_tr_b16 v[16:17], v34 offset:16384
ds_read_b64_tr_b16 v[18:19], v34 offset:16640
ds_read_b64_tr_b16 v[20:21], v34 offset:20480
ds_read_b64_tr_b16 v[22:23], v34 offset:20736
ds_read_b64_tr_b16 v[24:25], v35 offset:16384
ds_read_b64_tr_b16 v[26:27], v35 offset:16640
ds_read_b64_tr_b16 v[28:29], v35 offset:20480
ds_read_b64_tr_b16 v[30:31], v35 offset:20736
s_waitcnt lgkmcnt(0)
s_barrier
s_xor_b32 s32, s39, 0x100000
buffer_load_dword v82, v80, s[8:11], s32 offen
s_xor_b32 s32, s34, 0x100000
s_add_u32 m0, s36, 16384
s_nop 0
buffer_load_dwordx4 v64, s[8:11], s32 offen lds
s_xor_b32 s32, s34, 0x110000
s_add_u32 m0, s36, 17408
s_nop 0
buffer_load_dwordx4 v64, s[8:11], s32 offen lds
s_xor_b32 s32, s34, 0x120000
s_add_u32 m0, s36, 18432
s_nop 0
buffer_load_dwordx4 v64, s[8:11], s32 offen lds
s_xor_b32 s32, s34, 0x130000
s_add_u32 m0, s36, 19456
s_nop 0
buffer_load_dwordx4 v64, s[8:11], s32 offen lds
s_xor_b32 s32, s34, 0x140000
s_add_u32 m0, s36, 20480
s_nop 0
buffer_load_dwordx4 v64, s[8:11], s32 offen lds
s_xor_b32 s32, s34, 0x150000
s_add_u32 m0, s36, 21504
s_nop 0
buffer_load_dwordx4 v64, s[8:11], s32 offen lds
s_xor_b32 s32, s34, 0x160000
s_add_u32 m0, s36, 22528
s_nop 0
buffer_load_dwordx4 v64, s[8:11], s32 offen lds
s_xor_b32 s32, s34, 0x170000
s_add_u32 m0, s36, 23552
s_nop 0
buffer_load_dwordx4 v64, s[8:11], s32 offen lds
v_lshlrev_b32 v42, 16, v0
v_and_b32 v43, 0xffff0000, v0
v_cvt_pk_f16_f32 v0, v42, v43
v_lshlrev_b32 v44, 16, v1
v_and_b32 v45, 0xffff0000, v1
v_cvt_pk_f16_f32 v1, v44, v45
v_lshlrev_b32 v42, 16, v2
v_and_b32 v43, 0xffff0000, v2
v_cvt_pk_f16_f32 v2, v42, v43
v_lshlrev_b32 v44, 16, v3
v_and_b32 v45, 0xffff0000, v3
v_cvt_pk_f16_f32 v3, v44, v45
v_lshlrev_b32 v42, 16, v4
v_and_b32 v43, 0xffff0000, v4
v_cvt_pk_f16_f32 v4, v42, v43
v_lshlrev_b32 v44, 16, v5
v_and_b32 v45, 0xffff0000, v5
v_cvt_pk_f16_f32 v5, v44, v45
v_lshlrev_b32 v42, 16, v6
v_and_b32 v43, 0xffff0000, v6
v_cvt_pk_f16_f32 v6, v42, v43
v_lshlrev_b32 v44, 16, v7
v_and_b32 v45, 0xffff0000, v7
v_cvt_pk_f16_f32 v7, v44, v45
v_accvgpr_write_b32 a144, v0
v_accvgpr_write_b32 a145, v1
v_accvgpr_write_b32 a146, v2
v_accvgpr_write_b32 a147, v3
v_accvgpr_write_b32 a148, v4
v_accvgpr_write_b32 a149, v5
v_accvgpr_write_b32 a150, v6
v_accvgpr_write_b32 a151, v7
v_lshlrev_b32 v42, 16, v8
v_and_b32 v43, 0xffff0000, v8
v_cvt_pk_f16_f32 v8, v42, v43
v_lshlrev_b32 v44, 16, v9
v_and_b32 v45, 0xffff0000, v9
v_cvt_pk_f16_f32 v9, v44, v45
v_lshlrev_b32 v42, 16, v10
v_and_b32 v43, 0xffff0000, v10
v_cvt_pk_f16_f32 v10, v42, v43
v_lshlrev_b32 v44, 16, v11
v_and_b32 v45, 0xffff0000, v11
v_cvt_pk_f16_f32 v11, v44, v45
v_lshlrev_b32 v42, 16, v12
v_and_b32 v43, 0xffff0000, v12
v_cvt_pk_f16_f32 v12, v42, v43
v_lshlrev_b32 v44, 16, v13
v_and_b32 v45, 0xffff0000, v13
v_cvt_pk_f16_f32 v13, v44, v45
v_lshlrev_b32 v42, 16, v14
v_and_b32 v43, 0xffff0000, v14
v_cvt_pk_f16_f32 v14, v42, v43
v_lshlrev_b32 v44, 16, v15
v_and_b32 v45, 0xffff0000, v15
v_cvt_pk_f16_f32 v15, v44, v45
v_accvgpr_write_b32 a176, v8
v_accvgpr_write_b32 a177, v9
v_accvgpr_write_b32 a178, v10
v_accvgpr_write_b32 a179, v11
v_accvgpr_write_b32 a180, v12
v_accvgpr_write_b32 a181, v13
v_accvgpr_write_b32 a182, v14
v_accvgpr_write_b32 a183, v15
v_lshlrev_b32 v42, 16, v16
v_and_b32 v43, 0xffff0000, v16
v_cvt_pk_f16_f32 v16, v42, v43
v_lshlrev_b32 v44, 16, v17
v_and_b32 v45, 0xffff0000, v17
v_cvt_pk_f16_f32 v17, v44, v45
v_lshlrev_b32 v42, 16, v18
v_and_b32 v43, 0xffff0000, v18
v_cvt_pk_f16_f32 v18, v42, v43
v_lshlrev_b32 v44, 16, v19
v_and_b32 v45, 0xffff0000, v19
v_cvt_pk_f16_f32 v19, v44, v45
v_lshlrev_b32 v42, 16, v20
v_and_b32 v43, 0xffff0000, v20
v_cvt_pk_f16_f32 v20, v42, v43
v_lshlrev_b32 v44, 16, v21
v_and_b32 v45, 0xffff0000, v21
v_cvt_pk_f16_f32 v21, v44, v45
v_lshlrev_b32 v42, 16, v22
v_and_b32 v43, 0xffff0000, v22
v_cvt_pk_f16_f32 v22, v42, v43
v_lshlrev_b32 v44, 16, v23
v_and_b32 v45, 0xffff0000, v23
v_cvt_pk_f16_f32 v23, v44, v45
v_accvgpr_write_b32 a208, v16
v_accvgpr_write_b32 a209, v17
v_accvgpr_write_b32 a210, v18
v_accvgpr_write_b32 a211, v19
v_accvgpr_write_b32 a212, v20
v_accvgpr_write_b32 a213, v21
v_accvgpr_write_b32 a214, v22
v_accvgpr_write_b32 a215, v23
v_lshlrev_b32 v42, 16, v24
v_and_b32 v43, 0xffff0000, v24
v_cvt_pk_f16_f32 v24, v42, v43
v_lshlrev_b32 v44, 16, v25
v_and_b32 v45, 0xffff0000, v25
v_cvt_pk_f16_f32 v25, v44, v45
v_lshlrev_b32 v42, 16, v26
v_and_b32 v43, 0xffff0000, v26
v_cvt_pk_f16_f32 v26, v42, v43
v_lshlrev_b32 v44, 16, v27
v_and_b32 v45, 0xffff0000, v27
v_cvt_pk_f16_f32 v27, v44, v45
v_lshlrev_b32 v42, 16, v28
v_and_b32 v43, 0xffff0000, v28
v_cvt_pk_f16_f32 v28, v42, v43
v_lshlrev_b32 v44, 16, v29
v_and_b32 v45, 0xffff0000, v29
v_cvt_pk_f16_f32 v29, v44, v45
v_lshlrev_b32 v42, 16, v30
v_and_b32 v43, 0xffff0000, v30
v_cvt_pk_f16_f32 v30, v42, v43
v_lshlrev_b32 v44, 16, v31
v_and_b32 v45, 0xffff0000, v31
v_cvt_pk_f16_f32 v31, v44, v45
v_accvgpr_write_b32 a240, v24
v_accvgpr_write_b32 a241, v25
v_accvgpr_write_b32 a242, v26
v_accvgpr_write_b32 a243, v27
v_accvgpr_write_b32 a244, v28
v_accvgpr_write_b32 a245, v29
v_accvgpr_write_b32 a246, v30
v_accvgpr_write_b32 a247, v31
s_waitcnt vmcnt(27)
s_barrier
ds_read_b64_tr_b16 v[0:1], v32 offset:24576
ds_read_b64_tr_b16 v[2:3], v32 offset:24832
ds_read_b64_tr_b16 v[4:5], v32 offset:28672
ds_read_b64_tr_b16 v[6:7], v32 offset:28928
ds_read_b64_tr_b16 v[8:9], v33 offset:24576
ds_read_b64_tr_b16 v[10:11], v33 offset:24832
ds_read_b64_tr_b16 v[12:13], v33 offset:28672
ds_read_b64_tr_b16 v[14:15], v33 offset:28928
ds_read_b64_tr_b16 v[16:17], v34 offset:24576
ds_read_b64_tr_b16 v[18:19], v34 offset:24832
ds_read_b64_tr_b16 v[20:21], v34 offset:28672
ds_read_b64_tr_b16 v[22:23], v34 offset:28928
ds_read_b64_tr_b16 v[24:25], v35 offset:24576
ds_read_b64_tr_b16 v[26:27], v35 offset:24832
ds_read_b64_tr_b16 v[28:29], v35 offset:28672
ds_read_b64_tr_b16 v[30:31], v35 offset:28928
s_waitcnt lgkmcnt(0)
s_barrier
s_xor_b32 s32, s39, 0x180000
buffer_load_dword v82, v80, s[8:11], s32 offen
s_xor_b32 s32, s34, 0x180000
s_add_u32 m0, s36, 24576
s_nop 0
buffer_load_dwordx4 v64, s[8:11], s32 offen lds
s_xor_b32 s32, s34, 0x190000
s_add_u32 m0, s36, 25600
s_nop 0
buffer_load_dwordx4 v64, s[8:11], s32 offen lds
s_xor_b32 s32, s34, 0x1a0000
s_add_u32 m0, s36, 26624
s_nop 0
buffer_load_dwordx4 v64, s[8:11], s32 offen lds
s_xor_b32 s32, s34, 0x1b0000
s_add_u32 m0, s36, 27648
s_nop 0
buffer_load_dwordx4 v64, s[8:11], s32 offen lds
s_xor_b32 s32, s34, 0x1c0000
s_add_u32 m0, s36, 28672
s_nop 0
buffer_load_dwordx4 v64, s[8:11], s32 offen lds
s_xor_b32 s32, s34, 0x1d0000
s_add_u32 m0, s36, 29696
s_nop 0
buffer_load_dwordx4 v64, s[8:11], s32 offen lds
s_xor_b32 s32, s34, 0x1e0000
s_add_u32 m0, s36, 30720
s_nop 0
buffer_load_dwordx4 v64, s[8:11], s32 offen lds
s_xor_b32 s32, s34, 0x1f0000
s_add_u32 m0, s36, 31744
s_nop 0
buffer_load_dwordx4 v64, s[8:11], s32 offen lds
v_lshlrev_b32 v42, 16, v0
v_and_b32 v43, 0xffff0000, v0
v_cvt_pk_f16_f32 v0, v42, v43
v_lshlrev_b32 v44, 16, v1
v_and_b32 v45, 0xffff0000, v1
v_cvt_pk_f16_f32 v1, v44, v45
v_lshlrev_b32 v42, 16, v2
v_and_b32 v43, 0xffff0000, v2
v_cvt_pk_f16_f32 v2, v42, v43
v_lshlrev_b32 v44, 16, v3
v_and_b32 v45, 0xffff0000, v3
v_cvt_pk_f16_f32 v3, v44, v45
v_lshlrev_b32 v42, 16, v4
v_and_b32 v43, 0xffff0000, v4
v_cvt_pk_f16_f32 v4, v42, v43
v_lshlrev_b32 v44, 16, v5
v_and_b32 v45, 0xffff0000, v5
v_cvt_pk_f16_f32 v5, v44, v45
v_lshlrev_b32 v42, 16, v6
v_and_b32 v43, 0xffff0000, v6
v_cvt_pk_f16_f32 v6, v42, v43
v_lshlrev_b32 v44, 16, v7
v_and_b32 v45, 0xffff0000, v7
v_cvt_pk_f16_f32 v7, v44, v45
v_accvgpr_write_b32 a152, v0
v_accvgpr_write_b32 a153, v1
v_accvgpr_write_b32 a154, v2
v_accvgpr_write_b32 a155, v3
v_accvgpr_write_b32 a156, v4
v_accvgpr_write_b32 a157, v5
v_accvgpr_write_b32 a158, v6
v_accvgpr_write_b32 a159, v7
v_lshlrev_b32 v42, 16, v8
v_and_b32 v43, 0xffff0000, v8
v_cvt_pk_f16_f32 v8, v42, v43
v_lshlrev_b32 v44, 16, v9
v_and_b32 v45, 0xffff0000, v9
v_cvt_pk_f16_f32 v9, v44, v45
v_lshlrev_b32 v42, 16, v10
v_and_b32 v43, 0xffff0000, v10
v_cvt_pk_f16_f32 v10, v42, v43
v_lshlrev_b32 v44, 16, v11
v_and_b32 v45, 0xffff0000, v11
v_cvt_pk_f16_f32 v11, v44, v45
v_lshlrev_b32 v42, 16, v12
v_and_b32 v43, 0xffff0000, v12
v_cvt_pk_f16_f32 v12, v42, v43
v_lshlrev_b32 v44, 16, v13
v_and_b32 v45, 0xffff0000, v13
v_cvt_pk_f16_f32 v13, v44, v45
v_lshlrev_b32 v42, 16, v14
v_and_b32 v43, 0xffff0000, v14
v_cvt_pk_f16_f32 v14, v42, v43
v_lshlrev_b32 v44, 16, v15
v_and_b32 v45, 0xffff0000, v15
v_cvt_pk_f16_f32 v15, v44, v45
v_accvgpr_write_b32 a184, v8
v_accvgpr_write_b32 a185, v9
v_accvgpr_write_b32 a186, v10
v_accvgpr_write_b32 a187, v11
v_accvgpr_write_b32 a188, v12
v_accvgpr_write_b32 a189, v13
v_accvgpr_write_b32 a190, v14
v_accvgpr_write_b32 a191, v15
v_lshlrev_b32 v42, 16, v16
v_and_b32 v43, 0xffff0000, v16
v_cvt_pk_f16_f32 v16, v42, v43
v_lshlrev_b32 v44, 16, v17
v_and_b32 v45, 0xffff0000, v17
v_cvt_pk_f16_f32 v17, v44, v45
v_lshlrev_b32 v42, 16, v18
v_and_b32 v43, 0xffff0000, v18
v_cvt_pk_f16_f32 v18, v42, v43
v_lshlrev_b32 v44, 16, v19
v_and_b32 v45, 0xffff0000, v19
v_cvt_pk_f16_f32 v19, v44, v45
v_lshlrev_b32 v42, 16, v20
v_and_b32 v43, 0xffff0000, v20
v_cvt_pk_f16_f32 v20, v42, v43
v_lshlrev_b32 v44, 16, v21
v_and_b32 v45, 0xffff0000, v21
v_cvt_pk_f16_f32 v21, v44, v45
v_lshlrev_b32 v42, 16, v22
v_and_b32 v43, 0xffff0000, v22
v_cvt_pk_f16_f32 v22, v42, v43
v_lshlrev_b32 v44, 16, v23
v_and_b32 v45, 0xffff0000, v23
v_cvt_pk_f16_f32 v23, v44, v45
v_accvgpr_write_b32 a216, v16
v_accvgpr_write_b32 a217, v17
v_accvgpr_write_b32 a218, v18
v_accvgpr_write_b32 a219, v19
v_accvgpr_write_b32 a220, v20
v_accvgpr_write_b32 a221, v21
v_accvgpr_write_b32 a222, v22
v_accvgpr_write_b32 a223, v23
v_lshlrev_b32 v42, 16, v24
v_and_b32 v43, 0xffff0000, v24
v_cvt_pk_f16_f32 v24, v42, v43
v_lshlrev_b32 v44, 16, v25
v_and_b32 v45, 0xffff0000, v25
v_cvt_pk_f16_f32 v25, v44, v45
v_lshlrev_b32 v42, 16, v26
v_and_b32 v43, 0xffff0000, v26
v_cvt_pk_f16_f32 v26, v42, v43
v_lshlrev_b32 v44, 16, v27
v_and_b32 v45, 0xffff0000, v27
v_cvt_pk_f16_f32 v27, v44, v45
v_lshlrev_b32 v42, 16, v28
v_and_b32 v43, 0xffff0000, v28
v_cvt_pk_f16_f32 v28, v42, v43
v_lshlrev_b32 v44, 16, v29
v_and_b32 v45, 0xffff0000, v29
v_cvt_pk_f16_f32 v29, v44, v45
v_lshlrev_b32 v42, 16, v30
v_and_b32 v43, 0xffff0000, v30
v_cvt_pk_f16_f32 v30, v42, v43
v_lshlrev_b32 v44, 16, v31
v_and_b32 v45, 0xffff0000, v31
v_cvt_pk_f16_f32 v31, v44, v45
v_accvgpr_write_b32 a248, v24
v_accvgpr_write_b32 a249, v25
v_accvgpr_write_b32 a250, v26
v_accvgpr_write_b32 a251, v27
v_accvgpr_write_b32 a252, v28
v_accvgpr_write_b32 a253, v29
v_accvgpr_write_b32 a254, v30
v_accvgpr_write_b32 a255, v31
s_waitcnt vmcnt(27)
s_barrier
ds_read_b64_tr_b16 v[128:129], v36 offset:0
ds_read_b64_tr_b16 v[130:131], v36 offset:256
ds_read_b64_tr_b16 v[132:133], v36 offset:4096
ds_read_b64_tr_b16 v[134:135], v36 offset:4352
ds_read_b64_tr_b16 v[136:137], v37 offset:0
ds_read_b64_tr_b16 v[138:139], v37 offset:256
ds_read_b64_tr_b16 v[140:141], v37 offset:4096
ds_read_b64_tr_b16 v[142:143], v37 offset:4352
ds_read_b64_tr_b16 v[144:145], v38 offset:0
ds_read_b64_tr_b16 v[146:147], v38 offset:256
ds_read_b64_tr_b16 v[148:149], v38 offset:4096
ds_read_b64_tr_b16 v[150:151], v38 offset:4352
ds_read_b64_tr_b16 v[152:153], v39 offset:0
ds_read_b64_tr_b16 v[154:155], v39 offset:256
ds_read_b64_tr_b16 v[156:157], v39 offset:4096
ds_read_b64_tr_b16 v[158:159], v39 offset:4352
s_waitcnt lgkmcnt(0)
s_barrier
s_mov_b32 s8, s40
s_and_b32 s9, s41, 0xffff
s_mov_b32 s10, 0x800000
s_mov_b32 s11, 0x20000
s_sub_u32 s39, 511, s40
s_and_b32 s39, s39, 0x380
s_lshr_b32 s33, s39, 7
s_xor_b32 s33, s14, s33
s_and_b32 s33, s33, 3
s_lshl_b32 s33, s33, 19
s_add_u32 s39, s39, s33
s_andn2_b32 s32, s34, 0x180fff
s_add_u32 s39, s39, s32
s_xor_b32 s32, s39, 0x0
buffer_load_dword v82, v80, s[8:11], s32 offen
s_xor_b32 s32, s34, 0x0
s_add_u32 m0, s36, 0
s_nop 0
buffer_load_dwordx4 v64, s[8:11], s32 offen lds
s_xor_b32 s32, s34, 0x10000
s_add_u32 m0, s36, 1024
s_nop 0
buffer_load_dwordx4 v64, s[8:11], s32 offen lds
s_xor_b32 s32, s34, 0x20000
s_add_u32 m0, s36, 2048
s_nop 0
buffer_load_dwordx4 v64, s[8:11], s32 offen lds
s_xor_b32 s32, s34, 0x30000
s_add_u32 m0, s36, 3072
s_nop 0
buffer_load_dwordx4 v64, s[8:11], s32 offen lds
s_xor_b32 s32, s34, 0x40000
s_add_u32 m0, s36, 4096
s_nop 0
buffer_load_dwordx4 v64, s[8:11], s32 offen lds
s_xor_b32 s32, s34, 0x50000
s_add_u32 m0, s36, 5120
s_nop 0
buffer_load_dwordx4 v64, s[8:11], s32 offen lds
s_xor_b32 s32, s34, 0x60000
s_add_u32 m0, s36, 6144
s_nop 0
buffer_load_dwordx4 v64, s[8:11], s32 offen lds
s_xor_b32 s32, s34, 0x70000
s_add_u32 m0, s36, 7168
s_nop 0
buffer_load_dwordx4 v64, s[8:11], s32 offen lds
v_lshlrev_b32 v42, 16, v128
v_and_b32 v43, 0xffff0000, v128
v_cvt_pk_f16_f32 v128, v42, v43
v_lshlrev_b32 v44, 16, v129
v_and_b32 v45, 0xffff0000, v129
v_cvt_pk_f16_f32 v129, v44, v45
v_lshlrev_b32 v42, 16, v130
v_and_b32 v43, 0xffff0000, v130
v_cvt_pk_f16_f32 v130, v42, v43
v_lshlrev_b32 v44, 16, v131
v_and_b32 v45, 0xffff0000, v131
v_cvt_pk_f16_f32 v131, v44, v45
v_lshlrev_b32 v42, 16, v132
v_and_b32 v43, 0xffff0000, v132
v_cvt_pk_f16_f32 v132, v42, v43
v_lshlrev_b32 v44, 16, v133
v_and_b32 v45, 0xffff0000, v133
v_cvt_pk_f16_f32 v133, v44, v45
v_lshlrev_b32 v42, 16, v134
v_and_b32 v43, 0xffff0000, v134
v_cvt_pk_f16_f32 v134, v42, v43
v_lshlrev_b32 v44, 16, v135
v_and_b32 v45, 0xffff0000, v135
v_cvt_pk_f16_f32 v135, v44, v45
v_lshlrev_b32 v42, 16, v136
v_and_b32 v43, 0xffff0000, v136
v_cvt_pk_f16_f32 v136, v42, v43
v_lshlrev_b32 v44, 16, v137
v_and_b32 v45, 0xffff0000, v137
v_cvt_pk_f16_f32 v137, v44, v45
v_lshlrev_b32 v42, 16, v138
v_and_b32 v43, 0xffff0000, v138
v_cvt_pk_f16_f32 v138, v42, v43
v_lshlrev_b32 v44, 16, v139
v_and_b32 v45, 0xffff0000, v139
v_cvt_pk_f16_f32 v139, v44, v45
v_lshlrev_b32 v42, 16, v140
v_and_b32 v43, 0xffff0000, v140
v_cvt_pk_f16_f32 v140, v42, v43
v_lshlrev_b32 v44, 16, v141
v_and_b32 v45, 0xffff0000, v141
v_cvt_pk_f16_f32 v141, v44, v45
v_lshlrev_b32 v42, 16, v142
v_and_b32 v43, 0xffff0000, v142
v_cvt_pk_f16_f32 v142, v42, v43
v_lshlrev_b32 v44, 16, v143
v_and_b32 v45, 0xffff0000, v143
v_cvt_pk_f16_f32 v143, v44, v45
v_lshlrev_b32 v42, 16, v144
v_and_b32 v43, 0xffff0000, v144
v_cvt_pk_f16_f32 v144, v42, v43
v_lshlrev_b32 v44, 16, v145
v_and_b32 v45, 0xffff0000, v145
v_cvt_pk_f16_f32 v145, v44, v45
v_lshlrev_b32 v42, 16, v146
v_and_b32 v43, 0xffff0000, v146
v_cvt_pk_f16_f32 v146, v42, v43
v_lshlrev_b32 v44, 16, v147
v_and_b32 v45, 0xffff0000, v147
v_cvt_pk_f16_f32 v147, v44, v45
v_lshlrev_b32 v42, 16, v148
v_and_b32 v43, 0xffff0000, v148
v_cvt_pk_f16_f32 v148, v42, v43
v_lshlrev_b32 v44, 16, v149
v_and_b32 v45, 0xffff0000, v149
v_cvt_pk_f16_f32 v149, v44, v45
v_lshlrev_b32 v42, 16, v150
v_and_b32 v43, 0xffff0000, v150
v_cvt_pk_f16_f32 v150, v42, v43
v_lshlrev_b32 v44, 16, v151
v_and_b32 v45, 0xffff0000, v151
v_cvt_pk_f16_f32 v151, v44, v45
v_lshlrev_b32 v42, 16, v152
v_and_b32 v43, 0xffff0000, v152
v_cvt_pk_f16_f32 v152, v42, v43
v_lshlrev_b32 v44, 16, v153
v_and_b32 v45, 0xffff0000, v153
v_cvt_pk_f16_f32 v153, v44, v45
v_lshlrev_b32 v42, 16, v154
v_and_b32 v43, 0xffff0000, v154
v_cvt_pk_f16_f32 v154, v42, v43
v_lshlrev_b32 v44, 16, v155
v_and_b32 v45, 0xffff0000, v155
v_cvt_pk_f16_f32 v155, v44, v45
v_lshlrev_b32 v42, 16, v156
v_and_b32 v43, 0xffff0000, v156
v_cvt_pk_f16_f32 v156, v42, v43
v_lshlrev_b32 v44, 16, v157
v_and_b32 v45, 0xffff0000, v157
v_cvt_pk_f16_f32 v157, v44, v45
v_lshlrev_b32 v42, 16, v158
v_and_b32 v43, 0xffff0000, v158
v_cvt_pk_f16_f32 v158, v42, v43
v_lshlrev_b32 v44, 16, v159
v_and_b32 v45, 0xffff0000, v159
v_cvt_pk_f16_f32 v159, v44, v45
s_waitcnt vmcnt(27)
s_barrier
ds_read_b64_tr_b16 v[160:161], v36 offset:8192
ds_read_b64_tr_b16 v[162:163], v36 offset:8448
ds_read_b64_tr_b16 v[164:165], v36 offset:12288
ds_read_b64_tr_b16 v[166:167], v36 offset:12544
ds_read_b64_tr_b16 v[168:169], v37 offset:8192
ds_read_b64_tr_b16 v[170:171], v37 offset:8448
ds_read_b64_tr_b16 v[172:173], v37 offset:12288
ds_read_b64_tr_b16 v[174:175], v37 offset:12544
ds_read_b64_tr_b16 v[176:177], v38 offset:8192
ds_read_b64_tr_b16 v[178:179], v38 offset:8448
ds_read_b64_tr_b16 v[180:181], v38 offset:12288
ds_read_b64_tr_b16 v[182:183], v38 offset:12544
ds_read_b64_tr_b16 v[184:185], v39 offset:8192
ds_read_b64_tr_b16 v[186:187], v39 offset:8448
ds_read_b64_tr_b16 v[188:189], v39 offset:12288
ds_read_b64_tr_b16 v[190:191], v39 offset:12544
s_waitcnt lgkmcnt(0)
s_barrier
s_xor_b32 s32, s39, 0x80000
buffer_load_dword v82, v80, s[8:11], s32 offen
s_xor_b32 s32, s34, 0x80000
s_add_u32 m0, s36, 8192
s_nop 0
buffer_load_dwordx4 v64, s[8:11], s32 offen lds
s_xor_b32 s32, s34, 0x90000
s_add_u32 m0, s36, 9216
s_nop 0
buffer_load_dwordx4 v64, s[8:11], s32 offen lds
s_xor_b32 s32, s34, 0xa0000
s_add_u32 m0, s36, 10240
s_nop 0
buffer_load_dwordx4 v64, s[8:11], s32 offen lds
s_xor_b32 s32, s34, 0xb0000
s_add_u32 m0, s36, 11264
s_nop 0
buffer_load_dwordx4 v64, s[8:11], s32 offen lds
s_xor_b32 s32, s34, 0xc0000
s_add_u32 m0, s36, 12288
s_nop 0
buffer_load_dwordx4 v64, s[8:11], s32 offen lds
s_xor_b32 s32, s34, 0xd0000
s_add_u32 m0, s36, 13312
s_nop 0
buffer_load_dwordx4 v64, s[8:11], s32 offen lds
s_xor_b32 s32, s34, 0xe0000
s_add_u32 m0, s36, 14336
s_nop 0
buffer_load_dwordx4 v64, s[8:11], s32 offen lds
s_xor_b32 s32, s34, 0xf0000
s_add_u32 m0, s36, 15360
s_nop 0
buffer_load_dwordx4 v64, s[8:11], s32 offen lds
v_lshlrev_b32 v42, 16, v160
v_and_b32 v43, 0xffff0000, v160
v_cvt_pk_f16_f32 v160, v42, v43
v_lshlrev_b32 v44, 16, v161
v_and_b32 v45, 0xffff0000, v161
v_cvt_pk_f16_f32 v161, v44, v45
v_lshlrev_b32 v42, 16, v162
v_and_b32 v43, 0xffff0000, v162
v_cvt_pk_f16_f32 v162, v42, v43
v_lshlrev_b32 v44, 16, v163
v_and_b32 v45, 0xffff0000, v163
v_cvt_pk_f16_f32 v163, v44, v45
v_lshlrev_b32 v42, 16, v164
v_and_b32 v43, 0xffff0000, v164
v_cvt_pk_f16_f32 v164, v42, v43
v_lshlrev_b32 v44, 16, v165
v_and_b32 v45, 0xffff0000, v165
v_cvt_pk_f16_f32 v165, v44, v45
v_lshlrev_b32 v42, 16, v166
v_and_b32 v43, 0xffff0000, v166
v_cvt_pk_f16_f32 v166, v42, v43
v_lshlrev_b32 v44, 16, v167
v_and_b32 v45, 0xffff0000, v167
v_cvt_pk_f16_f32 v167, v44, v45
v_lshlrev_b32 v42, 16, v168
v_and_b32 v43, 0xffff0000, v168
v_cvt_pk_f16_f32 v168, v42, v43
v_lshlrev_b32 v44, 16, v169
v_and_b32 v45, 0xffff0000, v169
v_cvt_pk_f16_f32 v169, v44, v45
v_lshlrev_b32 v42, 16, v170
v_and_b32 v43, 0xffff0000, v170
v_cvt_pk_f16_f32 v170, v42, v43
v_lshlrev_b32 v44, 16, v171
v_and_b32 v45, 0xffff0000, v171
v_cvt_pk_f16_f32 v171, v44, v45
v_lshlrev_b32 v42, 16, v172
v_and_b32 v43, 0xffff0000, v172
v_cvt_pk_f16_f32 v172, v42, v43
v_lshlrev_b32 v44, 16, v173
v_and_b32 v45, 0xffff0000, v173
v_cvt_pk_f16_f32 v173, v44, v45
v_lshlrev_b32 v42, 16, v174
v_and_b32 v43, 0xffff0000, v174
v_cvt_pk_f16_f32 v174, v42, v43
v_lshlrev_b32 v44, 16, v175
v_and_b32 v45, 0xffff0000, v175
v_cvt_pk_f16_f32 v175, v44, v45
v_lshlrev_b32 v42, 16, v176
v_and_b32 v43, 0xffff0000, v176
v_cvt_pk_f16_f32 v176, v42, v43
v_lshlrev_b32 v44, 16, v177
v_and_b32 v45, 0xffff0000, v177
v_cvt_pk_f16_f32 v177, v44, v45
v_lshlrev_b32 v42, 16, v178
v_and_b32 v43, 0xffff0000, v178
v_cvt_pk_f16_f32 v178, v42, v43
v_lshlrev_b32 v44, 16, v179
v_and_b32 v45, 0xffff0000, v179
v_cvt_pk_f16_f32 v179, v44, v45
v_lshlrev_b32 v42, 16, v180
v_and_b32 v43, 0xffff0000, v180
v_cvt_pk_f16_f32 v180, v42, v43
v_lshlrev_b32 v44, 16, v181
v_and_b32 v45, 0xffff0000, v181
v_cvt_pk_f16_f32 v181, v44, v45
v_lshlrev_b32 v42, 16, v182
v_and_b32 v43, 0xffff0000, v182
v_cvt_pk_f16_f32 v182, v42, v43
v_lshlrev_b32 v44, 16, v183
v_and_b32 v45, 0xffff0000, v183
v_cvt_pk_f16_f32 v183, v44, v45
v_lshlrev_b32 v42, 16, v184
v_and_b32 v43, 0xffff0000, v184
v_cvt_pk_f16_f32 v184, v42, v43
v_lshlrev_b32 v44, 16, v185
v_and_b32 v45, 0xffff0000, v185
v_cvt_pk_f16_f32 v185, v44, v45
v_lshlrev_b32 v42, 16, v186
v_and_b32 v43, 0xffff0000, v186
v_cvt_pk_f16_f32 v186, v42, v43
v_lshlrev_b32 v44, 16, v187
v_and_b32 v45, 0xffff0000, v187
v_cvt_pk_f16_f32 v187, v44, v45
v_lshlrev_b32 v42, 16, v188
v_and_b32 v43, 0xffff0000, v188
v_cvt_pk_f16_f32 v188, v42, v43
v_lshlrev_b32 v44, 16, v189
v_and_b32 v45, 0xffff0000, v189
v_cvt_pk_f16_f32 v189, v44, v45
v_lshlrev_b32 v42, 16, v190
v_and_b32 v43, 0xffff0000, v190
v_cvt_pk_f16_f32 v190, v42, v43
v_lshlrev_b32 v44, 16, v191
v_and_b32 v45, 0xffff0000, v191
v_cvt_pk_f16_f32 v191, v44, v45
s_waitcnt vmcnt(27)
s_barrier
ds_read_b64_tr_b16 v[192:193], v36 offset:16384
ds_read_b64_tr_b16 v[194:195], v36 offset:16640
ds_read_b64_tr_b16 v[196:197], v36 offset:20480
ds_read_b64_tr_b16 v[198:199], v36 offset:20736
ds_read_b64_tr_b16 v[200:201], v37 offset:16384
ds_read_b64_tr_b16 v[202:203], v37 offset:16640
ds_read_b64_tr_b16 v[204:205], v37 offset:20480
ds_read_b64_tr_b16 v[206:207], v37 offset:20736
ds_read_b64_tr_b16 v[208:209], v38 offset:16384
ds_read_b64_tr_b16 v[210:211], v38 offset:16640
ds_read_b64_tr_b16 v[212:213], v38 offset:20480
ds_read_b64_tr_b16 v[214:215], v38 offset:20736
ds_read_b64_tr_b16 v[216:217], v39 offset:16384
ds_read_b64_tr_b16 v[218:219], v39 offset:16640
ds_read_b64_tr_b16 v[220:221], v39 offset:20480
ds_read_b64_tr_b16 v[222:223], v39 offset:20736
s_waitcnt lgkmcnt(0)
s_barrier
buffer_load_dword v72, v73, s[60:63], 0 offen sc1
buffer_load_dwordx2 v[84:85], off, s[60:63], 0 offset:16 sc1
s_xor_b32 s32, s39, 0x100000
buffer_load_dword v82, v80, s[8:11], s32 offen
s_xor_b32 s32, s34, 0x100000
s_add_u32 m0, s36, 16384
s_nop 0
buffer_load_dwordx4 v64, s[8:11], s32 offen lds
s_xor_b32 s32, s34, 0x110000
s_add_u32 m0, s36, 17408
s_nop 0
buffer_load_dwordx4 v64, s[8:11], s32 offen lds
s_xor_b32 s32, s34, 0x120000
s_add_u32 m0, s36, 18432
s_nop 0
buffer_load_dwordx4 v64, s[8:11], s32 offen lds
s_xor_b32 s32, s34, 0x130000
s_add_u32 m0, s36, 19456
s_nop 0
buffer_load_dwordx4 v64, s[8:11], s32 offen lds
s_xor_b32 s32, s34, 0x140000
s_add_u32 m0, s36, 20480
s_nop 0
buffer_load_dwordx4 v64, s[8:11], s32 offen lds
s_xor_b32 s32, s34, 0x150000
s_add_u32 m0, s36, 21504
s_nop 0
buffer_load_dwordx4 v64, s[8:11], s32 offen lds
s_xor_b32 s32, s34, 0x160000
s_add_u32 m0, s36, 22528
s_nop 0
buffer_load_dwordx4 v64, s[8:11], s32 offen lds
s_xor_b32 s32, s34, 0x170000
s_add_u32 m0, s36, 23552
s_nop 0
buffer_load_dwordx4 v64, s[8:11], s32 offen lds
v_lshlrev_b32 v42, 16, v192
v_and_b32 v43, 0xffff0000, v192
v_cvt_pk_f16_f32 v192, v42, v43
v_lshlrev_b32 v44, 16, v193
v_and_b32 v45, 0xffff0000, v193
v_cvt_pk_f16_f32 v193, v44, v45
v_lshlrev_b32 v42, 16, v194
v_and_b32 v43, 0xffff0000, v194
v_cvt_pk_f16_f32 v194, v42, v43
v_lshlrev_b32 v44, 16, v195
v_and_b32 v45, 0xffff0000, v195
v_cvt_pk_f16_f32 v195, v44, v45
v_lshlrev_b32 v42, 16, v196
v_and_b32 v43, 0xffff0000, v196
v_cvt_pk_f16_f32 v196, v42, v43
v_lshlrev_b32 v44, 16, v197
v_and_b32 v45, 0xffff0000, v197
v_cvt_pk_f16_f32 v197, v44, v45
v_lshlrev_b32 v42, 16, v198
v_and_b32 v43, 0xffff0000, v198
v_cvt_pk_f16_f32 v198, v42, v43
v_lshlrev_b32 v44, 16, v199
v_and_b32 v45, 0xffff0000, v199
v_cvt_pk_f16_f32 v199, v44, v45
v_lshlrev_b32 v42, 16, v200
v_and_b32 v43, 0xffff0000, v200
v_cvt_pk_f16_f32 v200, v42, v43
v_lshlrev_b32 v44, 16, v201
v_and_b32 v45, 0xffff0000, v201
v_cvt_pk_f16_f32 v201, v44, v45
v_lshlrev_b32 v42, 16, v202
v_and_b32 v43, 0xffff0000, v202
v_cvt_pk_f16_f32 v202, v42, v43
v_lshlrev_b32 v44, 16, v203
v_and_b32 v45, 0xffff0000, v203
v_cvt_pk_f16_f32 v203, v44, v45
v_lshlrev_b32 v42, 16, v204
v_and_b32 v43, 0xffff0000, v204
v_cvt_pk_f16_f32 v204, v42, v43
v_lshlrev_b32 v44, 16, v205
v_and_b32 v45, 0xffff0000, v205
v_cvt_pk_f16_f32 v205, v44, v45
v_lshlrev_b32 v42, 16, v206
v_and_b32 v43, 0xffff0000, v206
v_cvt_pk_f16_f32 v206, v42, v43
v_lshlrev_b32 v44, 16, v207
v_and_b32 v45, 0xffff0000, v207
v_cvt_pk_f16_f32 v207, v44, v45
v_lshlrev_b32 v42, 16, v208
v_and_b32 v43, 0xffff0000, v208
v_cvt_pk_f16_f32 v208, v42, v43
v_lshlrev_b32 v44, 16, v209
v_and_b32 v45, 0xffff0000, v209
v_cvt_pk_f16_f32 v209, v44, v45
v_lshlrev_b32 v42, 16, v210
v_and_b32 v43, 0xffff0000, v210
v_cvt_pk_f16_f32 v210, v42, v43
v_lshlrev_b32 v44, 16, v211
v_and_b32 v45, 0xffff0000, v211
v_cvt_pk_f16_f32 v211, v44, v45
v_lshlrev_b32 v42, 16, v212
v_and_b32 v43, 0xffff0000, v212
v_cvt_pk_f16_f32 v212, v42, v43
v_lshlrev_b32 v44, 16, v213
v_and_b32 v45, 0xffff0000, v213
v_cvt_pk_f16_f32 v213, v44, v45
v_lshlrev_b32 v42, 16, v214
v_and_b32 v43, 0xffff0000, v214
v_cvt_pk_f16_f32 v214, v42, v43
v_lshlrev_b32 v44, 16, v215
v_and_b32 v45, 0xffff0000, v215
v_cvt_pk_f16_f32 v215, v44, v45
v_lshlrev_b32 v42, 16, v216
v_and_b32 v43, 0xffff0000, v216
v_cvt_pk_f16_f32 v216, v42, v43
v_lshlrev_b32 v44, 16, v217
v_and_b32 v45, 0xffff0000, v217
v_cvt_pk_f16_f32 v217, v44, v45
v_lshlrev_b32 v42, 16, v218
v_and_b32 v43, 0xffff0000, v218
v_cvt_pk_f16_f32 v218, v42, v43
v_lshlrev_b32 v44, 16, v219
v_and_b32 v45, 0xffff0000, v219
v_cvt_pk_f16_f32 v219, v44, v45
v_lshlrev_b32 v42, 16, v220
v_and_b32 v43, 0xffff0000, v220
v_cvt_pk_f16_f32 v220, v42, v43
v_lshlrev_b32 v44, 16, v221
v_and_b32 v45, 0xffff0000, v221
v_cvt_pk_f16_f32 v221, v44, v45
v_lshlrev_b32 v42, 16, v222
v_and_b32 v43, 0xffff0000, v222
v_cvt_pk_f16_f32 v222, v42, v43
v_lshlrev_b32 v44, 16, v223
v_and_b32 v45, 0xffff0000, v223
v_cvt_pk_f16_f32 v223, v44, v45
s_waitcnt vmcnt(29)
s_barrier
ds_read_b64_tr_b16 v[224:225], v36 offset:24576
ds_read_b64_tr_b16 v[226:227], v36 offset:24832
ds_read_b64_tr_b16 v[228:229], v36 offset:28672
ds_read_b64_tr_b16 v[230:231], v36 offset:28928
ds_read_b64_tr_b16 v[232:233], v37 offset:24576
ds_read_b64_tr_b16 v[234:235], v37 offset:24832
ds_read_b64_tr_b16 v[236:237], v37 offset:28672
ds_read_b64_tr_b16 v[238:239], v37 offset:28928
ds_read_b64_tr_b16 v[240:241], v38 offset:24576
ds_read_b64_tr_b16 v[242:243], v38 offset:24832
ds_read_b64_tr_b16 v[244:245], v38 offset:28672
ds_read_b64_tr_b16 v[246:247], v38 offset:28928
ds_read_b64_tr_b16 v[248:249], v39 offset:24576
ds_read_b64_tr_b16 v[250:251], v39 offset:24832
ds_read_b64_tr_b16 v[252:253], v39 offset:28672
ds_read_b64_tr_b16 v[254:255], v39 offset:28928
s_waitcnt lgkmcnt(0)
s_barrier
s_xor_b32 s32, s39, 0x180000
buffer_load_dword v82, v80, s[8:11], s32 offen
s_xor_b32 s32, s34, 0x180000
s_add_u32 m0, s36, 24576
s_nop 0
buffer_load_dwordx4 v64, s[8:11], s32 offen lds
s_xor_b32 s32, s34, 0x190000
s_add_u32 m0, s36, 25600
s_nop 0
buffer_load_dwordx4 v64, s[8:11], s32 offen lds
s_xor_b32 s32, s34, 0x1a0000
s_add_u32 m0, s36, 26624
s_nop 0
buffer_load_dwordx4 v64, s[8:11], s32 offen lds
s_xor_b32 s32, s34, 0x1b0000
s_add_u32 m0, s36, 27648
s_nop 0
buffer_load_dwordx4 v64, s[8:11], s32 offen lds
s_xor_b32 s32, s34, 0x1c0000
s_add_u32 m0, s36, 28672
s_nop 0
buffer_load_dwordx4 v64, s[8:11], s32 offen lds
s_xor_b32 s32, s34, 0x1d0000
s_add_u32 m0, s36, 29696
s_nop 0
buffer_load_dwordx4 v64, s[8:11], s32 offen lds
s_xor_b32 s32, s34, 0x1e0000
s_add_u32 m0, s36, 30720
s_nop 0
buffer_load_dwordx4 v64, s[8:11], s32 offen lds
s_xor_b32 s32, s34, 0x1f0000
s_add_u32 m0, s36, 31744
s_nop 0
buffer_load_dwordx4 v64, s[8:11], s32 offen lds
v_lshlrev_b32 v42, 16, v224
v_and_b32 v43, 0xffff0000, v224
v_cvt_pk_f16_f32 v224, v42, v43
v_lshlrev_b32 v44, 16, v225
v_and_b32 v45, 0xffff0000, v225
v_cvt_pk_f16_f32 v225, v44, v45
v_lshlrev_b32 v42, 16, v226
v_and_b32 v43, 0xffff0000, v226
v_cvt_pk_f16_f32 v226, v42, v43
v_lshlrev_b32 v44, 16, v227
v_and_b32 v45, 0xffff0000, v227
v_cvt_pk_f16_f32 v227, v44, v45
v_lshlrev_b32 v42, 16, v228
v_and_b32 v43, 0xffff0000, v228
v_cvt_pk_f16_f32 v228, v42, v43
v_lshlrev_b32 v44, 16, v229
v_and_b32 v45, 0xffff0000, v229
v_cvt_pk_f16_f32 v229, v44, v45
v_lshlrev_b32 v42, 16, v230
v_and_b32 v43, 0xffff0000, v230
v_cvt_pk_f16_f32 v230, v42, v43
v_lshlrev_b32 v44, 16, v231
v_and_b32 v45, 0xffff0000, v231
v_cvt_pk_f16_f32 v231, v44, v45
v_lshlrev_b32 v42, 16, v232
v_and_b32 v43, 0xffff0000, v232
v_cvt_pk_f16_f32 v232, v42, v43
v_lshlrev_b32 v44, 16, v233
v_and_b32 v45, 0xffff0000, v233
v_cvt_pk_f16_f32 v233, v44, v45
v_lshlrev_b32 v42, 16, v234
v_and_b32 v43, 0xffff0000, v234
v_cvt_pk_f16_f32 v234, v42, v43
v_lshlrev_b32 v44, 16, v235
v_and_b32 v45, 0xffff0000, v235
v_cvt_pk_f16_f32 v235, v44, v45
v_lshlrev_b32 v42, 16, v236
v_and_b32 v43, 0xffff0000, v236
v_cvt_pk_f16_f32 v236, v42, v43
v_lshlrev_b32 v44, 16, v237
v_and_b32 v45, 0xffff0000, v237
v_cvt_pk_f16_f32 v237, v44, v45
v_lshlrev_b32 v42, 16, v238
v_and_b32 v43, 0xffff0000, v238
v_cvt_pk_f16_f32 v238, v42, v43
v_lshlrev_b32 v44, 16, v239
v_and_b32 v45, 0xffff0000, v239
v_cvt_pk_f16_f32 v239, v44, v45
v_lshlrev_b32 v42, 16, v240
v_and_b32 v43, 0xffff0000, v240
v_cvt_pk_f16_f32 v240, v42, v43
v_lshlrev_b32 v44, 16, v241
v_and_b32 v45, 0xffff0000, v241
v_cvt_pk_f16_f32 v241, v44, v45
v_lshlrev_b32 v42, 16, v242
v_and_b32 v43, 0xffff0000, v242
v_cvt_pk_f16_f32 v242, v42, v43
v_lshlrev_b32 v44, 16, v243
v_and_b32 v45, 0xffff0000, v243
v_cvt_pk_f16_f32 v243, v44, v45
v_lshlrev_b32 v42, 16, v244
v_and_b32 v43, 0xffff0000, v244
v_cvt_pk_f16_f32 v244, v42, v43
v_lshlrev_b32 v44, 16, v245
v_and_b32 v45, 0xffff0000, v245
v_cvt_pk_f16_f32 v245, v44, v45
v_lshlrev_b32 v42, 16, v246
v_and_b32 v43, 0xffff0000, v246
v_cvt_pk_f16_f32 v246, v42, v43
v_lshlrev_b32 v44, 16, v247
v_and_b32 v45, 0xffff0000, v247
v_cvt_pk_f16_f32 v247, v44, v45
v_lshlrev_b32 v42, 16, v248
v_and_b32 v43, 0xffff0000, v248
v_cvt_pk_f16_f32 v248, v42, v43
v_lshlrev_b32 v44, 16, v249
v_and_b32 v45, 0xffff0000, v249
v_cvt_pk_f16_f32 v249, v44, v45
v_lshlrev_b32 v42, 16, v250
v_and_b32 v43, 0xffff0000, v250
v_cvt_pk_f16_f32 v250, v42, v43
v_lshlrev_b32 v44, 16, v251
v_and_b32 v45, 0xffff0000, v251
v_cvt_pk_f16_f32 v251, v44, v45
v_lshlrev_b32 v42, 16, v252
v_and_b32 v43, 0xffff0000, v252
v_cvt_pk_f16_f32 v252, v42, v43
v_lshlrev_b32 v44, 16, v253
v_and_b32 v45, 0xffff0000, v253
v_cvt_pk_f16_f32 v253, v44, v45
v_lshlrev_b32 v42, 16, v254
v_and_b32 v43, 0xffff0000, v254
v_cvt_pk_f16_f32 v254, v42, v43
v_lshlrev_b32 v44, 16, v255
v_and_b32 v45, 0xffff0000, v255
v_cvt_pk_f16_f32 v255, v44, v45
s_waitcnt vmcnt(29)
s_barrier
ds_read_b64_tr_b16 v[0:1], v32 offset:0
ds_read_b64_tr_b16 v[2:3], v32 offset:256
ds_read_b64_tr_b16 v[4:5], v32 offset:4096
ds_read_b64_tr_b16 v[6:7], v32 offset:4352
ds_read_b64_tr_b16 v[8:9], v33 offset:0
ds_read_b64_tr_b16 v[10:11], v33 offset:256
ds_read_b64_tr_b16 v[12:13], v33 offset:4096
ds_read_b64_tr_b16 v[14:15], v33 offset:4352
ds_read_b64_tr_b16 v[16:17], v34 offset:0
ds_read_b64_tr_b16 v[18:19], v34 offset:256
ds_read_b64_tr_b16 v[20:21], v34 offset:4096
ds_read_b64_tr_b16 v[22:23], v34 offset:4352
ds_read_b64_tr_b16 v[24:25], v35 offset:0
ds_read_b64_tr_b16 v[26:27], v35 offset:256
ds_read_b64_tr_b16 v[28:29], v35 offset:4096
ds_read_b64_tr_b16 v[30:31], v35 offset:4352
s_waitcnt lgkmcnt(0)
s_barrier
s_mov_b32 s8, s46
s_and_b32 s9, s47, 0xffff
s_mov_b32 s10, 0x800000
s_mov_b32 s11, 0x20000
s_sub_u32 s39, 511, s46
s_and_b32 s39, s39, 0x380
s_lshr_b32 s33, s39, 6
s_xor_b32 s33, s14, s33
s_and_b32 s33, s33, 6
s_lshl_b32 s33, s33, 17
s_add_u32 s39, s39, s33
s_andn2_b32 s32, s35, 0xe0fff
s_add_u32 s39, s39, s32
s_xor_b32 s32, s39, 0x0
buffer_load_dword v82, v81, s[8:11], s32 offen
s_xor_b32 s32, s35, 0x0
s_add_u32 m0, s36, 0
s_nop 0
buffer_load_dwordx4 v65, s[8:11], s32 offen lds
s_xor_b32 s32, s35, 0x8000
s_add_u32 m0, s36, 1024
s_nop 0
buffer_load_dwordx4 v65, s[8:11], s32 offen lds
s_xor_b32 s32, s35, 0x10000
s_add_u32 m0, s36, 2048
s_nop 0
buffer_load_dwordx4 v65, s[8:11], s32 offen lds
s_xor_b32 s32, s35, 0x18000
s_add_u32 m0, s36, 3072
s_nop 0
buffer_load_dwordx4 v65, s[8:11], s32 offen lds
s_xor_b32 s32, s35, 0x20000
s_add_u32 m0, s36, 4096
s_nop 0
buffer_load_dwordx4 v65, s[8:11], s32 offen lds
s_xor_b32 s32, s35, 0x28000
s_add_u32 m0, s36, 5120
s_nop 0
buffer_load_dwordx4 v65, s[8:11], s32 offen lds
s_xor_b32 s32, s35, 0x30000
s_add_u32 m0, s36, 6144
s_nop 0
buffer_load_dwordx4 v65, s[8:11], s32 offen lds
s_xor_b32 s32, s35, 0x38000
s_add_u32 m0, s36, 7168
s_nop 0
buffer_load_dwordx4 v65, s[8:11], s32 offen lds
v_lshlrev_b32 v42, 16, v0
v_and_b32 v43, 0xffff0000, v0
v_cvt_pk_f16_f32 v0, v42, v43
v_lshlrev_b32 v44, 16, v1
v_and_b32 v45, 0xffff0000, v1
v_cvt_pk_f16_f32 v1, v44, v45
v_lshlrev_b32 v42, 16, v2
v_and_b32 v43, 0xffff0000, v2
v_cvt_pk_f16_f32 v2, v42, v43
v_lshlrev_b32 v44, 16, v3
v_and_b32 v45, 0xffff0000, v3
v_cvt_pk_f16_f32 v3, v44, v45
v_lshlrev_b32 v42, 16, v4
v_and_b32 v43, 0xffff0000, v4
v_cvt_pk_f16_f32 v4, v42, v43
v_lshlrev_b32 v44, 16, v5
v_and_b32 v45, 0xffff0000, v5
v_cvt_pk_f16_f32 v5, v44, v45
v_lshlrev_b32 v42, 16, v6
v_and_b32 v43, 0xffff0000, v6
v_cvt_pk_f16_f32 v6, v42, v43
v_lshlrev_b32 v44, 16, v7
v_and_b32 v45, 0xffff0000, v7
v_cvt_pk_f16_f32 v7, v44, v45
v_accvgpr_write_b32 a0, v0
v_accvgpr_write_b32 a1, v1
v_accvgpr_write_b32 a2, v2
v_accvgpr_write_b32 a3, v3
v_accvgpr_write_b32 a4, v4
v_accvgpr_write_b32 a5, v5
v_accvgpr_write_b32 a6, v6
v_accvgpr_write_b32 a7, v7
v_lshlrev_b32 v42, 16, v8
v_and_b32 v43, 0xffff0000, v8
v_cvt_pk_f16_f32 v8, v42, v43
v_lshlrev_b32 v44, 16, v9
v_and_b32 v45, 0xffff0000, v9
v_cvt_pk_f16_f32 v9, v44, v45
v_lshlrev_b32 v42, 16, v10
v_and_b32 v43, 0xffff0000, v10
v_cvt_pk_f16_f32 v10, v42, v43
v_lshlrev_b32 v44, 16, v11
v_and_b32 v45, 0xffff0000, v11
v_cvt_pk_f16_f32 v11, v44, v45
v_lshlrev_b32 v42, 16, v12
v_and_b32 v43, 0xffff0000, v12
v_cvt_pk_f16_f32 v12, v42, v43
v_lshlrev_b32 v44, 16, v13
v_and_b32 v45, 0xffff0000, v13
v_cvt_pk_f16_f32 v13, v44, v45
v_lshlrev_b32 v42, 16, v14
v_and_b32 v43, 0xffff0000, v14
v_cvt_pk_f16_f32 v14, v42, v43
v_lshlrev_b32 v44, 16, v15
v_and_b32 v45, 0xffff0000, v15
v_cvt_pk_f16_f32 v15, v44, v45
v_accvgpr_write_b32 a32, v8
v_accvgpr_write_b32 a33, v9
v_accvgpr_write_b32 a34, v10
v_accvgpr_write_b32 a35, v11
v_accvgpr_write_b32 a36, v12
v_accvgpr_write_b32 a37, v13
v_accvgpr_write_b32 a38, v14
v_accvgpr_write_b32 a39, v15
v_lshlrev_b32 v42, 16, v16
v_and_b32 v43, 0xffff0000, v16
v_cvt_pk_f16_f32 v16, v42, v43
v_lshlrev_b32 v44, 16, v17
v_and_b32 v45, 0xffff0000, v17
v_cvt_pk_f16_f32 v17, v44, v45
v_lshlrev_b32 v42, 16, v18
v_and_b32 v43, 0xffff0000, v18
v_cvt_pk_f16_f32 v18, v42, v43
v_lshlrev_b32 v44, 16, v19
v_and_b32 v45, 0xffff0000, v19
v_cvt_pk_f16_f32 v19, v44, v45
v_lshlrev_b32 v42, 16, v20
v_and_b32 v43, 0xffff0000, v20
v_cvt_pk_f16_f32 v20, v42, v43
v_lshlrev_b32 v44, 16, v21
v_and_b32 v45, 0xffff0000, v21
v_cvt_pk_f16_f32 v21, v44, v45
v_lshlrev_b32 v42, 16, v22
v_and_b32 v43, 0xffff0000, v22
v_cvt_pk_f16_f32 v22, v42, v43
v_lshlrev_b32 v44, 16, v23
v_and_b32 v45, 0xffff0000, v23
v_cvt_pk_f16_f32 v23, v44, v45
v_accvgpr_write_b32 a64, v16
v_accvgpr_write_b32 a65, v17
v_accvgpr_write_b32 a66, v18
v_accvgpr_write_b32 a67, v19
v_accvgpr_write_b32 a68, v20
v_accvgpr_write_b32 a69, v21
v_accvgpr_write_b32 a70, v22
v_accvgpr_write_b32 a71, v23
v_lshlrev_b32 v42, 16, v24
v_and_b32 v43, 0xffff0000, v24
v_cvt_pk_f16_f32 v24, v42, v43
v_lshlrev_b32 v44, 16, v25
v_and_b32 v45, 0xffff0000, v25
v_cvt_pk_f16_f32 v25, v44, v45
v_lshlrev_b32 v42, 16, v26
v_and_b32 v43, 0xffff0000, v26
v_cvt_pk_f16_f32 v26, v42, v43
v_lshlrev_b32 v44, 16, v27
v_and_b32 v45, 0xffff0000, v27
v_cvt_pk_f16_f32 v27, v44, v45
v_lshlrev_b32 v42, 16, v28
v_and_b32 v43, 0xffff0000, v28
v_cvt_pk_f16_f32 v28, v42, v43
v_lshlrev_b32 v44, 16, v29
v_and_b32 v45, 0xffff0000, v29
v_cvt_pk_f16_f32 v29, v44, v45
v_lshlrev_b32 v42, 16, v30
v_and_b32 v43, 0xffff0000, v30
v_cvt_pk_f16_f32 v30, v42, v43
v_lshlrev_b32 v44, 16, v31
v_and_b32 v45, 0xffff0000, v31
v_cvt_pk_f16_f32 v31, v44, v45
v_accvgpr_write_b32 a96, v24
v_accvgpr_write_b32 a97, v25
v_accvgpr_write_b32 a98, v26
v_accvgpr_write_b32 a99, v27
v_accvgpr_write_b32 a100, v28
v_accvgpr_write_b32 a101, v29
v_accvgpr_write_b32 a102, v30
v_accvgpr_write_b32 a103, v31
s_waitcnt vmcnt(29)
s_barrier
ds_read_b64_tr_b16 v[0:1], v32 offset:8192
ds_read_b64_tr_b16 v[2:3], v32 offset:8448
ds_read_b64_tr_b16 v[4:5], v32 offset:12288
ds_read_b64_tr_b16 v[6:7], v32 offset:12544
ds_read_b64_tr_b16 v[8:9], v33 offset:8192
ds_read_b64_tr_b16 v[10:11], v33 offset:8448
ds_read_b64_tr_b16 v[12:13], v33 offset:12288
ds_read_b64_tr_b16 v[14:15], v33 offset:12544
ds_read_b64_tr_b16 v[16:17], v34 offset:8192
ds_read_b64_tr_b16 v[18:19], v34 offset:8448
ds_read_b64_tr_b16 v[20:21], v34 offset:12288
ds_read_b64_tr_b16 v[22:23], v34 offset:12544
ds_read_b64_tr_b16 v[24:25], v35 offset:8192
ds_read_b64_tr_b16 v[26:27], v35 offset:8448
ds_read_b64_tr_b16 v[28:29], v35 offset:12288
ds_read_b64_tr_b16 v[30:31], v35 offset:12544
s_waitcnt lgkmcnt(0)
s_barrier
s_xor_b32 s32, s39, 0x40000
buffer_load_dword v82, v81, s[8:11], s32 offen
s_xor_b32 s32, s35, 0x40000
s_add_u32 m0, s36, 8192
s_nop 0
buffer_load_dwordx4 v65, s[8:11], s32 offen lds
s_xor_b32 s32, s35, 0x48000
s_add_u32 m0, s36, 9216
s_nop 0
buffer_load_dwordx4 v65, s[8:11], s32 offen lds
s_xor_b32 s32, s35, 0x50000
s_add_u32 m0, s36, 10240
s_nop 0
buffer_load_dwordx4 v65, s[8:11], s32 offen lds
s_xor_b32 s32, s35, 0x58000
s_add_u32 m0, s36, 11264
s_nop 0
buffer_load_dwordx4 v65, s[8:11], s32 offen lds
s_xor_b32 s32, s35, 0x60000
s_add_u32 m0, s36, 12288
s_nop 0
buffer_load_dwordx4 v65, s[8:11], s32 offen lds
s_xor_b32 s32, s35, 0x68000
s_add_u32 m0, s36, 13312
s_nop 0
buffer_load_dwordx4 v65, s[8:11], s32 offen lds
s_xor_b32 s32, s35, 0x70000
s_add_u32 m0, s36, 14336
s_nop 0
buffer_load_dwordx4 v65, s[8:11], s32 offen lds
s_xor_b32 s32, s35, 0x78000
s_add_u32 m0, s36, 15360
s_nop 0
buffer_load_dwordx4 v65, s[8:11], s32 offen lds
v_lshlrev_b32 v42, 16, v0
v_and_b32 v43, 0xffff0000, v0
v_cvt_pk_f16_f32 v0, v42, v43
v_lshlrev_b32 v44, 16, v1
v_and_b32 v45, 0xffff0000, v1
v_cvt_pk_f16_f32 v1, v44, v45
v_lshlrev_b32 v42, 16, v2
v_and_b32 v43, 0xffff0000, v2
v_cvt_pk_f16_f32 v2, v42, v43
v_lshlrev_b32 v44, 16, v3
v_and_b32 v45, 0xffff0000, v3
v_cvt_pk_f16_f32 v3, v44, v45
v_lshlrev_b32 v42, 16, v4
v_and_b32 v43, 0xffff0000, v4
v_cvt_pk_f16_f32 v4, v42, v43
v_lshlrev_b32 v44, 16, v5
v_and_b32 v45, 0xffff0000, v5
v_cvt_pk_f16_f32 v5, v44, v45
v_lshlrev_b32 v42, 16, v6
v_and_b32 v43, 0xffff0000, v6
v_cvt_pk_f16_f32 v6, v42, v43
v_lshlrev_b32 v44, 16, v7
v_and_b32 v45, 0xffff0000, v7
v_cvt_pk_f16_f32 v7, v44, v45
v_accvgpr_write_b32 a8, v0
v_accvgpr_write_b32 a9, v1
v_accvgpr_write_b32 a10, v2
v_accvgpr_write_b32 a11, v3
v_accvgpr_write_b32 a12, v4
v_accvgpr_write_b32 a13, v5
v_accvgpr_write_b32 a14, v6
v_accvgpr_write_b32 a15, v7
v_lshlrev_b32 v42, 16, v8
v_and_b32 v43, 0xffff0000, v8
v_cvt_pk_f16_f32 v8, v42, v43
v_lshlrev_b32 v44, 16, v9
v_and_b32 v45, 0xffff0000, v9
v_cvt_pk_f16_f32 v9, v44, v45
v_lshlrev_b32 v42, 16, v10
v_and_b32 v43, 0xffff0000, v10
v_cvt_pk_f16_f32 v10, v42, v43
v_lshlrev_b32 v44, 16, v11
v_and_b32 v45, 0xffff0000, v11
v_cvt_pk_f16_f32 v11, v44, v45
v_lshlrev_b32 v42, 16, v12
v_and_b32 v43, 0xffff0000, v12
v_cvt_pk_f16_f32 v12, v42, v43
v_lshlrev_b32 v44, 16, v13
v_and_b32 v45, 0xffff0000, v13
v_cvt_pk_f16_f32 v13, v44, v45
v_lshlrev_b32 v42, 16, v14
v_and_b32 v43, 0xffff0000, v14
v_cvt_pk_f16_f32 v14, v42, v43
v_lshlrev_b32 v44, 16, v15
v_and_b32 v45, 0xffff0000, v15
v_cvt_pk_f16_f32 v15, v44, v45
v_accvgpr_write_b32 a40, v8
v_accvgpr_write_b32 a41, v9
v_accvgpr_write_b32 a42, v10
v_accvgpr_write_b32 a43, v11
v_accvgpr_write_b32 a44, v12
v_accvgpr_write_b32 a45, v13
v_accvgpr_write_b32 a46, v14
v_accvgpr_write_b32 a47, v15
v_lshlrev_b32 v42, 16, v16
v_and_b32 v43, 0xffff0000, v16
v_cvt_pk_f16_f32 v16, v42, v43
v_lshlrev_b32 v44, 16, v17
v_and_b32 v45, 0xffff0000, v17
v_cvt_pk_f16_f32 v17, v44, v45
v_lshlrev_b32 v42, 16, v18
v_and_b32 v43, 0xffff0000, v18
v_cvt_pk_f16_f32 v18, v42, v43
v_lshlrev_b32 v44, 16, v19
v_and_b32 v45, 0xffff0000, v19
v_cvt_pk_f16_f32 v19, v44, v45
v_lshlrev_b32 v42, 16, v20
v_and_b32 v43, 0xffff0000, v20
v_cvt_pk_f16_f32 v20, v42, v43
v_lshlrev_b32 v44, 16, v21
v_and_b32 v45, 0xffff0000, v21
v_cvt_pk_f16_f32 v21, v44, v45
v_lshlrev_b32 v42, 16, v22
v_and_b32 v43, 0xffff0000, v22
v_cvt_pk_f16_f32 v22, v42, v43
v_lshlrev_b32 v44, 16, v23
v_and_b32 v45, 0xffff0000, v23
v_cvt_pk_f16_f32 v23, v44, v45
v_accvgpr_write_b32 a72, v16
v_accvgpr_write_b32 a73, v17
v_accvgpr_write_b32 a74, v18
v_accvgpr_write_b32 a75, v19
v_accvgpr_write_b32 a76, v20
v_accvgpr_write_b32 a77, v21
v_accvgpr_write_b32 a78, v22
v_accvgpr_write_b32 a79, v23
v_lshlrev_b32 v42, 16, v24
v_and_b32 v43, 0xffff0000, v24
v_cvt_pk_f16_f32 v24, v42, v43
v_lshlrev_b32 v44, 16, v25
v_and_b32 v45, 0xffff0000, v25
v_cvt_pk_f16_f32 v25, v44, v45
v_lshlrev_b32 v42, 16, v26
v_and_b32 v43, 0xffff0000, v26
v_cvt_pk_f16_f32 v26, v42, v43
v_lshlrev_b32 v44, 16, v27
v_and_b32 v45, 0xffff0000, v27
v_cvt_pk_f16_f32 v27, v44, v45
v_lshlrev_b32 v42, 16, v28
v_and_b32 v43, 0xffff0000, v28
v_cvt_pk_f16_f32 v28, v42, v43
v_lshlrev_b32 v44, 16, v29
v_and_b32 v45, 0xffff0000, v29
v_cvt_pk_f16_f32 v29, v44, v45
v_lshlrev_b32 v42, 16, v30
v_and_b32 v43, 0xffff0000, v30
v_cvt_pk_f16_f32 v30, v42, v43
v_lshlrev_b32 v44, 16, v31
v_and_b32 v45, 0xffff0000, v31
v_cvt_pk_f16_f32 v31, v44, v45
v_accvgpr_write_b32 a104, v24
v_accvgpr_write_b32 a105, v25
v_accvgpr_write_b32 a106, v26
v_accvgpr_write_b32 a107, v27
v_accvgpr_write_b32 a108, v28
v_accvgpr_write_b32 a109, v29
v_accvgpr_write_b32 a110, v30
v_accvgpr_write_b32 a111, v31
s_waitcnt vmcnt(27)
v_readlane_b32 s48, v72, 0
v_readlane_b32 s49, v72, 1
v_readlane_b32 s50, v72, 2
v_readlane_b32 s51, v72, 3
v_readlane_b32 s52, v72, 4
v_readlane_b32 s53, v72, 5
v_readlane_b32 s54, v72, 6
v_readlane_b32 s55, v72, 7
v_readlane_b32 s38, v72, 8
s_nop 3
s_add_u32 s33, s48, s49
s_add_u32 s33, s33, s50
s_add_u32 s33, s33, s51
s_add_u32 s33, s33, s52
s_add_u32 s33, s33, s53
s_add_u32 s33, s33, s54
s_add_u32 s33, s33, s55
s_cmp_ge_u32 s38, 4
s_cselect_b32 s33, s33, 0
s_cmp_ge_u32 s33, 256
s_cselect_b32 s38, 0, 1
s_barrier
ds_read_b64_tr_b16 v[0:1], v32 offset:16384
ds_read_b64_tr_b16 v[2:3], v32 offset:16640
ds_read_b64_tr_b16 v[4:5], v32 offset:20480
ds_read_b64_tr_b16 v[6:7], v32 offset:20736
ds_read_b64_tr_b16 v[8:9], v33 offset:16384
ds_read_b64_tr_b16 v[10:11], v33 offset:16640
ds_read_b64_tr_b16 v[12:13], v33 offset:20480
ds_read_b64_tr_b16 v[14:15], v33 offset:20736
ds_read_b64_tr_b16 v[16:17], v34 offset:16384
ds_read_b64_tr_b16 v[18:19], v34 offset:16640
ds_read_b64_tr_b16 v[20:21], v34 offset:20480
ds_read_b64_tr_b16 v[22:23], v34 offset:20736
ds_read_b64_tr_b16 v[24:25], v35 offset:16384
ds_read_b64_tr_b16 v[26:27], v35 offset:16640
ds_read_b64_tr_b16 v[28:29], v35 offset:20480
ds_read_b64_tr_b16 v[30:31], v35 offset:20736
s_waitcnt lgkmcnt(0)
s_barrier
s_xor_b32 s32, s39, 0x80000
buffer_load_dword v82, v81, s[8:11], s32 offen
s_xor_b32 s32, s35, 0x80000
s_add_u32 m0, s36, 16384
s_nop 0
buffer_load_dwordx4 v65, s[8:11], s32 offen lds
s_xor_b32 s32, s35, 0x88000
s_add_u32 m0, s36, 17408
s_nop 0
buffer_load_dwordx4 v65, s[8:11], s32 offen lds
s_xor_b32 s32, s35, 0x90000
s_add_u32 m0, s36, 18432
s_nop 0
buffer_load_dwordx4 v65, s[8:11], s32 offen lds
s_xor_b32 s32, s35, 0x98000
s_add_u32 m0, s36, 19456
s_nop 0
buffer_load_dwordx4 v65, s[8:11], s32 offen lds
s_xor_b32 s32, s35, 0xa0000
s_add_u32 m0, s36, 20480
s_nop 0
buffer_load_dwordx4 v65, s[8:11], s32 offen lds
s_xor_b32 s32, s35, 0xa8000
s_add_u32 m0, s36, 21504
s_nop 0
buffer_load_dwordx4 v65, s[8:11], s32 offen lds
s_xor_b32 s32, s35, 0xb0000
s_add_u32 m0, s36, 22528
s_nop 0
buffer_load_dwordx4 v65, s[8:11], s32 offen lds
s_xor_b32 s32, s35, 0xb8000
s_add_u32 m0, s36, 23552
s_nop 0
buffer_load_dwordx4 v65, s[8:11], s32 offen lds
v_lshlrev_b32 v42, 16, v0
v_and_b32 v43, 0xffff0000, v0
v_cvt_pk_f16_f32 v0, v42, v43
v_lshlrev_b32 v44, 16, v1
v_and_b32 v45, 0xffff0000, v1
v_cvt_pk_f16_f32 v1, v44, v45
v_lshlrev_b32 v42, 16, v2
v_and_b32 v43, 0xffff0000, v2
v_cvt_pk_f16_f32 v2, v42, v43
v_lshlrev_b32 v44, 16, v3
v_and_b32 v45, 0xffff0000, v3
v_cvt_pk_f16_f32 v3, v44, v45
v_lshlrev_b32 v42, 16, v4
v_and_b32 v43, 0xffff0000, v4
v_cvt_pk_f16_f32 v4, v42, v43
v_lshlrev_b32 v44, 16, v5
v_and_b32 v45, 0xffff0000, v5
v_cvt_pk_f16_f32 v5, v44, v45
v_lshlrev_b32 v42, 16, v6
v_and_b32 v43, 0xffff0000, v6
v_cvt_pk_f16_f32 v6, v42, v43
v_lshlrev_b32 v44, 16, v7
v_and_b32 v45, 0xffff0000, v7
v_cvt_pk_f16_f32 v7, v44, v45
v_accvgpr_write_b32 a16, v0
v_accvgpr_write_b32 a17, v1
v_accvgpr_write_b32 a18, v2
v_accvgpr_write_b32 a19, v3
v_accvgpr_write_b32 a20, v4
v_accvgpr_write_b32 a21, v5
v_accvgpr_write_b32 a22, v6
v_accvgpr_write_b32 a23, v7
v_lshlrev_b32 v42, 16, v8
v_and_b32 v43, 0xffff0000, v8
v_cvt_pk_f16_f32 v8, v42, v43
v_lshlrev_b32 v44, 16, v9
v_and_b32 v45, 0xffff0000, v9
v_cvt_pk_f16_f32 v9, v44, v45
v_lshlrev_b32 v42, 16, v10
v_and_b32 v43, 0xffff0000, v10
v_cvt_pk_f16_f32 v10, v42, v43
v_lshlrev_b32 v44, 16, v11
v_and_b32 v45, 0xffff0000, v11
v_cvt_pk_f16_f32 v11, v44, v45
v_lshlrev_b32 v42, 16, v12
v_and_b32 v43, 0xffff0000, v12
v_cvt_pk_f16_f32 v12, v42, v43
v_lshlrev_b32 v44, 16, v13
v_and_b32 v45, 0xffff0000, v13
v_cvt_pk_f16_f32 v13, v44, v45
v_lshlrev_b32 v42, 16, v14
v_and_b32 v43, 0xffff0000, v14
v_cvt_pk_f16_f32 v14, v42, v43
v_lshlrev_b32 v44, 16, v15
v_and_b32 v45, 0xffff0000, v15
v_cvt_pk_f16_f32 v15, v44, v45
v_accvgpr_write_b32 a48, v8
v_accvgpr_write_b32 a49, v9
v_accvgpr_write_b32 a50, v10
v_accvgpr_write_b32 a51, v11
v_accvgpr_write_b32 a52, v12
v_accvgpr_write_b32 a53, v13
v_accvgpr_write_b32 a54, v14
v_accvgpr_write_b32 a55, v15
v_lshlrev_b32 v42, 16, v16
v_and_b32 v43, 0xffff0000, v16
v_cvt_pk_f16_f32 v16, v42, v43
v_lshlrev_b32 v44, 16, v17
v_and_b32 v45, 0xffff0000, v17
v_cvt_pk_f16_f32 v17, v44, v45
v_lshlrev_b32 v42, 16, v18
v_and_b32 v43, 0xffff0000, v18
v_cvt_pk_f16_f32 v18, v42, v43
v_lshlrev_b32 v44, 16, v19
v_and_b32 v45, 0xffff0000, v19
v_cvt_pk_f16_f32 v19, v44, v45
v_lshlrev_b32 v42, 16, v20
v_and_b32 v43, 0xffff0000, v20
v_cvt_pk_f16_f32 v20, v42, v43
v_lshlrev_b32 v44, 16, v21
v_and_b32 v45, 0xffff0000, v21
v_cvt_pk_f16_f32 v21, v44, v45
v_lshlrev_b32 v42, 16, v22
v_and_b32 v43, 0xffff0000, v22
v_cvt_pk_f16_f32 v22, v42, v43
v_lshlrev_b32 v44, 16, v23
v_and_b32 v45, 0xffff0000, v23
v_cvt_pk_f16_f32 v23, v44, v45
v_accvgpr_write_b32 a80, v16
v_accvgpr_write_b32 a81, v17
v_accvgpr_write_b32 a82, v18
v_accvgpr_write_b32 a83, v19
v_accvgpr_write_b32 a84, v20
v_accvgpr_write_b32 a85, v21
v_accvgpr_write_b32 a86, v22
v_accvgpr_write_b32 a87, v23
v_lshlrev_b32 v42, 16, v24
v_and_b32 v43, 0xffff0000, v24
v_cvt_pk_f16_f32 v24, v42, v43
v_lshlrev_b32 v44, 16, v25
v_and_b32 v45, 0xffff0000, v25
v_cvt_pk_f16_f32 v25, v44, v45
v_lshlrev_b32 v42, 16, v26
v_and_b32 v43, 0xffff0000, v26
v_cvt_pk_f16_f32 v26, v42, v43
v_lshlrev_b32 v44, 16, v27
v_and_b32 v45, 0xffff0000, v27
v_cvt_pk_f16_f32 v27, v44, v45
v_lshlrev_b32 v42, 16, v28
v_and_b32 v43, 0xffff0000, v28
v_cvt_pk_f16_f32 v28, v42, v43
v_lshlrev_b32 v44, 16, v29
v_and_b32 v45, 0xffff0000, v29
v_cvt_pk_f16_f32 v29, v44, v45
v_lshlrev_b32 v42, 16, v30
v_and_b32 v43, 0xffff0000, v30
v_cvt_pk_f16_f32 v30, v42, v43
v_lshlrev_b32 v44, 16, v31
v_and_b32 v45, 0xffff0000, v31
v_cvt_pk_f16_f32 v31, v44, v45
v_accvgpr_write_b32 a112, v24
v_accvgpr_write_b32 a113, v25
v_accvgpr_write_b32 a114, v26
v_accvgpr_write_b32 a115, v27
v_accvgpr_write_b32 a116, v28
v_accvgpr_write_b32 a117, v29
v_accvgpr_write_b32 a118, v30
v_accvgpr_write_b32 a119, v31
s_waitcnt vmcnt(27)
s_barrier
ds_read_b64_tr_b16 v[0:1], v32 offset:24576
ds_read_b64_tr_b16 v[2:3], v32 offset:24832
ds_read_b64_tr_b16 v[4:5], v32 offset:28672
ds_read_b64_tr_b16 v[6:7], v32 offset:28928
ds_read_b64_tr_b16 v[8:9], v33 offset:24576
ds_read_b64_tr_b16 v[10:11], v33 offset:24832
ds_read_b64_tr_b16 v[12:13], v33 offset:28672
ds_read_b64_tr_b16 v[14:15], v33 offset:28928
ds_read_b64_tr_b16 v[16:17], v34 offset:24576
ds_read_b64_tr_b16 v[18:19], v34 offset:24832
ds_read_b64_tr_b16 v[20:21], v34 offset:28672
ds_read_b64_tr_b16 v[22:23], v34 offset:28928
ds_read_b64_tr_b16 v[24:25], v35 offset:24576
ds_read_b64_tr_b16 v[26:27], v35 offset:24832
ds_read_b64_tr_b16 v[28:29], v35 offset:28672
ds_read_b64_tr_b16 v[30:31], v35 offset:28928
s_waitcnt lgkmcnt(0)
s_barrier
s_xor_b32 s32, s39, 0xc0000
buffer_load_dword v82, v81, s[8:11], s32 offen
s_xor_b32 s32, s35, 0xc0000
s_add_u32 m0, s36, 24576
s_nop 0
buffer_load_dwordx4 v65, s[8:11], s32 offen lds
s_xor_b32 s32, s35, 0xc8000
s_add_u32 m0, s36, 25600
s_nop 0
buffer_load_dwordx4 v65, s[8:11], s32 offen lds
s_xor_b32 s32, s35, 0xd0000
s_add_u32 m0, s36, 26624
s_nop 0
buffer_load_dwordx4 v65, s[8:11], s32 offen lds
s_xor_b32 s32, s35, 0xd8000
s_add_u32 m0, s36, 27648
s_nop 0
buffer_load_dwordx4 v65, s[8:11], s32 offen lds
s_xor_b32 s32, s35, 0xe0000
s_add_u32 m0, s36, 28672
s_nop 0
buffer_load_dwordx4 v65, s[8:11], s32 offen lds
s_xor_b32 s32, s35, 0xe8000
s_add_u32 m0, s36, 29696
s_nop 0
buffer_load_dwordx4 v65, s[8:11], s32 offen lds
s_xor_b32 s32, s35, 0xf0000
s_add_u32 m0, s36, 30720
s_nop 0
buffer_load_dwordx4 v65, s[8:11], s32 offen lds
s_xor_b32 s32, s35, 0xf8000
s_add_u32 m0, s36, 31744
s_nop 0
buffer_load_dwordx4 v65, s[8:11], s32 offen lds
v_lshlrev_b32 v42, 16, v0
v_and_b32 v43, 0xffff0000, v0
v_cvt_pk_f16_f32 v0, v42, v43
v_lshlrev_b32 v44, 16, v1
v_and_b32 v45, 0xffff0000, v1
v_cvt_pk_f16_f32 v1, v44, v45
v_lshlrev_b32 v42, 16, v2
v_and_b32 v43, 0xffff0000, v2
v_cvt_pk_f16_f32 v2, v42, v43
v_lshlrev_b32 v44, 16, v3
v_and_b32 v45, 0xffff0000, v3
v_cvt_pk_f16_f32 v3, v44, v45
v_lshlrev_b32 v42, 16, v4
v_and_b32 v43, 0xffff0000, v4
v_cvt_pk_f16_f32 v4, v42, v43
v_lshlrev_b32 v44, 16, v5
v_and_b32 v45, 0xffff0000, v5
v_cvt_pk_f16_f32 v5, v44, v45
v_lshlrev_b32 v42, 16, v6
v_and_b32 v43, 0xffff0000, v6
v_cvt_pk_f16_f32 v6, v42, v43
v_lshlrev_b32 v44, 16, v7
v_and_b32 v45, 0xffff0000, v7
v_cvt_pk_f16_f32 v7, v44, v45
v_accvgpr_write_b32 a24, v0
v_accvgpr_write_b32 a25, v1
v_accvgpr_write_b32 a26, v2
v_accvgpr_write_b32 a27, v3
v_accvgpr_write_b32 a28, v4
v_accvgpr_write_b32 a29, v5
v_accvgpr_write_b32 a30, v6
v_accvgpr_write_b32 a31, v7
v_lshlrev_b32 v42, 16, v8
v_and_b32 v43, 0xffff0000, v8
v_cvt_pk_f16_f32 v8, v42, v43
v_lshlrev_b32 v44, 16, v9
v_and_b32 v45, 0xffff0000, v9
v_cvt_pk_f16_f32 v9, v44, v45
v_lshlrev_b32 v42, 16, v10
v_and_b32 v43, 0xffff0000, v10
v_cvt_pk_f16_f32 v10, v42, v43
v_lshlrev_b32 v44, 16, v11
v_and_b32 v45, 0xffff0000, v11
v_cvt_pk_f16_f32 v11, v44, v45
v_lshlrev_b32 v42, 16, v12
v_and_b32 v43, 0xffff0000, v12
v_cvt_pk_f16_f32 v12, v42, v43
v_lshlrev_b32 v44, 16, v13
v_and_b32 v45, 0xffff0000, v13
v_cvt_pk_f16_f32 v13, v44, v45
v_lshlrev_b32 v42, 16, v14
v_and_b32 v43, 0xffff0000, v14
v_cvt_pk_f16_f32 v14, v42, v43
v_lshlrev_b32 v44, 16, v15
v_and_b32 v45, 0xffff0000, v15
v_cvt_pk_f16_f32 v15, v44, v45
v_accvgpr_write_b32 a56, v8
v_accvgpr_write_b32 a57, v9
v_accvgpr_write_b32 a58, v10
v_accvgpr_write_b32 a59, v11
v_accvgpr_write_b32 a60, v12
v_accvgpr_write_b32 a61, v13
v_accvgpr_write_b32 a62, v14
v_accvgpr_write_b32 a63, v15
v_lshlrev_b32 v42, 16, v16
v_and_b32 v43, 0xffff0000, v16
v_cvt_pk_f16_f32 v16, v42, v43
v_lshlrev_b32 v44, 16, v17
v_and_b32 v45, 0xffff0000, v17
v_cvt_pk_f16_f32 v17, v44, v45
v_lshlrev_b32 v42, 16, v18
v_and_b32 v43, 0xffff0000, v18
v_cvt_pk_f16_f32 v18, v42, v43
v_lshlrev_b32 v44, 16, v19
v_and_b32 v45, 0xffff0000, v19
v_cvt_pk_f16_f32 v19, v44, v45
v_lshlrev_b32 v42, 16, v20
v_and_b32 v43, 0xffff0000, v20
v_cvt_pk_f16_f32 v20, v42, v43
v_lshlrev_b32 v44, 16, v21
v_and_b32 v45, 0xffff0000, v21
v_cvt_pk_f16_f32 v21, v44, v45
v_lshlrev_b32 v42, 16, v22
v_and_b32 v43, 0xffff0000, v22
v_cvt_pk_f16_f32 v22, v42, v43
v_lshlrev_b32 v44, 16, v23
v_and_b32 v45, 0xffff0000, v23
v_cvt_pk_f16_f32 v23, v44, v45
v_accvgpr_write_b32 a88, v16
v_accvgpr_write_b32 a89, v17
v_accvgpr_write_b32 a90, v18
v_accvgpr_write_b32 a91, v19
v_accvgpr_write_b32 a92, v20
v_accvgpr_write_b32 a93, v21
v_accvgpr_write_b32 a94, v22
v_accvgpr_write_b32 a95, v23
v_lshlrev_b32 v42, 16, v24
v_and_b32 v43, 0xffff0000, v24
v_cvt_pk_f16_f32 v24, v42, v43
v_lshlrev_b32 v44, 16, v25
v_and_b32 v45, 0xffff0000, v25
v_cvt_pk_f16_f32 v25, v44, v45
v_lshlrev_b32 v42, 16, v26
v_and_b32 v43, 0xffff0000, v26
v_cvt_pk_f16_f32 v26, v42, v43
v_lshlrev_b32 v44, 16, v27
v_and_b32 v45, 0xffff0000, v27
v_cvt_pk_f16_f32 v27, v44, v45
v_lshlrev_b32 v42, 16, v28
v_and_b32 v43, 0xffff0000, v28
v_cvt_pk_f16_f32 v28, v42, v43
v_lshlrev_b32 v44, 16, v29
v_and_b32 v45, 0xffff0000, v29
v_cvt_pk_f16_f32 v29, v44, v45
v_lshlrev_b32 v42, 16, v30
v_and_b32 v43, 0xffff0000, v30
v_cvt_pk_f16_f32 v30, v42, v43
v_lshlrev_b32 v44, 16, v31
v_and_b32 v45, 0xffff0000, v31
v_cvt_pk_f16_f32 v31, v44, v45
v_accvgpr_write_b32 a120, v24
v_accvgpr_write_b32 a121, v25
v_accvgpr_write_b32 a122, v26
v_accvgpr_write_b32 a123, v27
v_accvgpr_write_b32 a124, v28
v_accvgpr_write_b32 a125, v29
v_accvgpr_write_b32 a126, v30
v_accvgpr_write_b32 a127, v31
v_and_b32 v64, 15, v94
v_lshrrev_b32 v65, 4, v94
v_bfe_u32 v126, v94, 4, 1
v_lshlrev_b32 v126, 2, v126
v_sub_u32 v126, v64, v126
v_mov_b32 v66, 0x3f80
v_mov_b32 v67, 0x3f800000
s_and_b32 s33, s14, 1
s_lshl_b32 s32, s33, 3
v_subrev_u32 v71, s32, v126
v_lshrrev_b32 v70, 3, v64
v_and_b32 v69, 5, v64
v_lshl_add_u32 v69, v70, 1, v69
v_sub_u32 v126, v126, v64
v_add_u32 v126, v126, v69
v_and_b32 v70, 2, v64
v_lshl_add_u32 v126, v70, 4, v126
v_cmp_eq_u32 vcc, 32, v126
s_nop 1
v_cndmask_b32 v127, 0, v66, vcc
v_cmp_eq_u32 vcc, 33, v126
s_nop 1
v_cndmask_b32 v104, v127, v67, vcc
v_mov_b32 v106, v104
v_cmp_eq_u32 vcc, 34, v126
s_nop 1
v_cndmask_b32 v127, 0, v66, vcc
v_cmp_eq_u32 vcc, 35, v126
s_nop 1
v_cndmask_b32 v105, v127, v67, vcc
v_mov_b32 v107, v105
v_cmp_eq_u32 vcc, 0, v126
s_nop 1
v_cndmask_b32 v127, 0, v66, vcc
v_cmp_eq_u32 vcc, 1, v126
s_nop 1
v_cndmask_b32 v108, v127, v67, vcc
v_mov_b32 v110, v108
v_mov_b32 v106, v108
v_cmp_eq_u32 vcc, 2, v126
s_nop 1
v_cndmask_b32 v127, 0, v66, vcc
v_cmp_eq_u32 vcc, 3, v126
s_nop 1
v_cndmask_b32 v109, v127, v67, vcc
v_mov_b32 v111, v109
v_mov_b32 v107, v109
v_mov_b32 v127, 0x4444
v_mov_b32 v95, 0xeeee
v_cmp_gt_u32 vcc, 8, v64
s_nop 1
v_cndmask_b32 v112, v95, v127, vcc
v_lshrrev_b32 v126, 1, v65
v_lshlrev_b32 v126, 7, v126
v_lshl_add_u32 v126, v64, 4, v126
v_and_b32 v127, 1, v65
v_lshl_add_u32 v126, v127, 3, v126
v_mov_b32 v95, 0x7f000000
v_cndmask_b32 v118, v95, v126, vcc
v_lshlrev_b32 v126, 3, v64
v_lshl_add_u32 v126, v127, 7, v126
v_cmp_le_u32 vcc, 2, v65
s_nop 1
v_cndmask_b32 v120, v95, v126, vcc
v_mov_b32 v126, 0xf149f2ca
v_cndmask_b32 v124, v126, 0, vcc
v_lshrrev_b32 v126, 3, v64
v_cmp_eq_u32 vcc, s33, v126
v_and_b32 v126, 7, v64
v_lshlrev_b32 v126, 4, v126
v_lshl_add_u32 v126, v65, 7, v126
v_cndmask_b32 v117, v95, v116, vcc
v_cndmask_b32 v119, v95, v126, vcc
s_lshl_b32 s32, s14, 11
v_add_u32 v114, s32, v116
s_lshr_b32 s32, s14, 1
s_lshl_b32 s32, s32, 10
s_lshl_b32 s33, s33, 3
s_add_u32 s32, s32, s33
v_add_u32 v115, s32, v116
v_lshrrev_b32 v126, 3, v64
v_lshl_add_u32 v125, v126, 11, v116
v_lshrrev_b32 v71, 1, v65
v_cmp_ne_u32 vcc, 0, v70
v_lshlrev_b32 v126, 4, v64
v_lshl_add_u32 v126, v127, 8, v126
v_lshl_add_u32 v117, v71, 3, v126
v_lshrrev_b32 v120, 1, v117
v_lshlrev_b32 v69, 4, v69
v_lshl_add_u32 v126, v127, 7, v69
v_lshl_add_u32 v126, v71, 3, v126
v_cndmask_b32 v119, v126, v95, vcc
v_lshl_add_u32 v126, v71, 7, v69
v_lshl_add_u32 v126, v127, 3, v126
v_cndmask_b32 v125, v126, v95, vcc
v_cndmask_b32 v118, v95, v126, vcc
s_mov_b32 s17, 0
s_lshl_b32 s32, s12, 14
s_lshl_b32 s33, s14, 12
s_add_u32 s18, s32, s33
s_xor_b32 s33, s14, s13
s_and_b32 s33, s33, 3
s_lshl_b32 s33, s33, 10
s_add_u32 s18, s18, s33
s_xor_b32 s19, s18, 0x4000
s_add_u32 s18, s18, 0x6c30000
s_add_u32 s19, s19, 0x6c38000
s_lshl_b32 s20, s15, 12
s_add_u32 s20, s20, 0x6c00000
s_lshl_b32 s32, s16, 11
s_lshl_b32 s33, s14, 9
s_add_u32 s32, s32, s33
s_add_u32 s21, s20, s32
s_lshl_b32 s32, s16, 11
s_xor_b32 s32, s32, 2048
s_add_u32 s20, s20, s32
s_lshl_b32 s32, s12, 15
s_add_u32 s32, s32, 0x6c20000
s_lshl_b32 s33, s13, 10
s_add_u32 s22, s32, s33
s_lshl_b32 s33, s14, 8
s_add_u32 s22, s22, s33
s_lshl_b32 s33, s14, 13
s_add_u32 s23, s32, s33
s_add_u32 s24, s23, 4096
s_xor_b32 s33, s14, s13
s_and_b32 s33, s33, 7
s_lshl_b32 s33, s33, 10
s_add_u32 s23, s23, s33
s_lshl_b32 s32, s12, 14
s_lshl_b32 s33, s13, 9
s_add_u32 s32, s32, s33
s_bitcmp1_b32 s14, 0
s_cselect_b32 s33, 256, 0
s_add_u32 s32, s32, s33
s_add_u32 s25, s32, 0x6c30000
s_lshl_b32 s32, s16, 6
s_lshl_b32 s33, s14, 4
s_add_u32 s32, s32, s33
s_lshl_b32 s33, s15, 7
s_add_u32 s32, s32, s33
s_lshl_b32 s26, s32, 4
s_add_u32 s26, s26, 0x6e00000
s_lshl_b32 s37, s15, 2
s_lshl_b32 s33, s16, 1
s_add_u32 s37, s37, s33
s_lshr_b32 s33, s14, 1
s_add_u32 s37, s37, s33
s_lshl_b32 s37, s37, 9
s_add_u32 s37, s37, 0x8000000
s_bitcmp1_b32 s14, 0
s_cselect_b32 s33, 256, 0
s_add_u32 s37, s37, s33
s_lshl_b32 s28, s32, 6
s_add_u32 s28, s28, 0x2800000
s_lshl_b32 s27, s15, 12
s_lshl_b32 s36, s14, 11
s_and_b32 s33, s36, 2048
s_lshl_b32 s32, s16, 11
s_xor_b32 s33, s33, s32
s_add_u32 s27, s27, s33
s_lshr_b32 s33, s14, 1
s_lshl_b32 s33, s33, 17
s_add_u32 s27, s27, s33
s_add_u32 s27, s27, 0x1800000
s_add_u32 s36, s36, 24576
s_mov_b32 s30, 0x3e0293ee
s_mov_b32 s31, 0xbe0293ee
v_mov_b32 v100, 0x3f803f80
v_mov_b32 v101, 0x3f803f80
v_mov_b32 v102, 0x3f803f80
v_mov_b32 v103, 0x3f803f80
v_mov_b32 v121, 0x7f000000
v_mov_b32 v122, 0
v_and_b32 v127, 1, v94
v_mov_b32 v77, 0x7f000000
s_lshl_b32 s32, s16, 3
s_lshl_b64 exec, 0xff, s32
s_add_u32 s32, s27, 0x40000
v_lshl_add_u32 v121, v64, 7, s32
v_mov_b32 v122, 0x40000
s_mov_b32 exec_lo, 0xff0000
s_add_u32 s32, s28, 0x40000
v_lshl_add_u32 v121, v64, 7, s32
v_mov_b32 v122, 0x40000
s_mov_b32 exec_lo, 0x000f000f
s_mov_b32 exec_hi, 0x000f000f
s_and_b32 s33, s14, 1
s_lshl_b32 s33, s33, 7
s_add_u32 s32, s21, s33
v_lshl_add_u32 v77, v64, 7, s21
s_mov_b32 exec_lo, 0x00300030
s_mov_b32 exec_hi, 0x00300030
v_lshl_add_u32 v77, v127, 7, s22
s_mov_b32 exec_lo, 0x00400040
s_mov_b32 exec_hi, 0x00400040
s_lshl_b32 s32, s12, 14
s_lshl_b32 s33, s13, 9
s_add_u32 s33, s32, s33
s_add_u32 s33, s33, 0x6c30000
s_andn2_b32 s3, s33, 0x3ff
s_andn2_b32 s34, s22, 0x3ff
s_cmp_eq_u32 s14, 1
s_cselect_b32 s3, s34, s3
s_bitcmp0_b32 s14, 0
s_cselect_b32 s3, s21, s3
s_add_u32 s3, s3, 0x80000
s_lshl_b32 s34, s14, 7
s_add_u32 s33, s33, s34
v_mov_b32 v77, s33
s_mov_b32 exec_lo, 0x00800080
s_mov_b32 exec_hi, 0x00800080
s_add_u32 s32, s32, s34
s_add_u32 s32, s32, 0x6c38000
v_mov_b32 v77, s32
s_mov_b64 exec, -1
v_lshl_add_u32 v77, v65, 18, v77
s_mov_b32 exec_lo, 0
s_mov_b32 exec_hi, 0x300
s_lshl_b32 s32, s15, 2
s_add_u32 s32, s32, 0x8406000
v_lshl_add_u32 v121, v127, 13, s32
s_mov_b32 exec_hi, 0x3c00
s_mov_b32 s32, 0x8418158
v_lshl_add_u32 v121, v64, 2, s32
s_mov_b32 exec_hi, 0x3f00
v_mov_b32 v122, 128
s_mov_b64 exec, -1
s_lshl_b32 s32, s15, 3
s_lshl_b32 s33, s16, 2
s_add_u32 s32, s32, s33
s_add_u32 s32, s32, s14
s_mov_b32 s39, 0x7f000000
s_cmp_eq_u32 s32, 2
s_cselect_b32 s39, 0x841ec00, s39
s_waitcnt vmcnt(27)
ds_read_b64_tr_b16 v[0:1], v68 offset:0
ds_read_b64_tr_b16 v[2:3], v68 offset:128
ds_read_b64_tr_b16 v[4:5], v68 offset:2048
ds_read_b64_tr_b16 v[6:7], v68 offset:2176
ds_read_b64_tr_b16 v[8:9], v68 offset:32
ds_read_b64_tr_b16 v[10:11], v68 offset:160
ds_read_b64_tr_b16 v[12:13], v68 offset:2080
ds_read_b64_tr_b16 v[14:15], v68 offset:2208
ds_read_b64_tr_b16 v[16:17], v68 offset:4096
ds_read_b64_tr_b16 v[18:19], v68 offset:4224
ds_read_b64_tr_b16 v[20:21], v68 offset:6144
ds_read_b64_tr_b16 v[22:23], v68 offset:6272
ds_read_b64_tr_b16 v[24:25], v68 offset:4128
ds_read_b64_tr_b16 v[26:27], v68 offset:4256
ds_read_b64_tr_b16 v[28:29], v68 offset:6176
ds_read_b64_tr_b16 v[30:31], v68 offset:6304
s_waitcnt lgkmcnt(0)
ds_write_b128 v113, v[0:3] offset:0
ds_write_b128 v113, v[4:7] offset:1024
ds_write_b128 v113, v[8:11] offset:2048
ds_write_b128 v113, v[12:15] offset:3072
ds_write_b128 v113, v[16:19] offset:4096
ds_write_b128 v113, v[20:23] offset:5120
ds_write_b128 v113, v[24:27] offset:6144
ds_write_b128 v113, v[28:31] offset:7168
s_waitcnt lgkmcnt(0)
s_waitcnt vmcnt(18)
ds_read_b64_tr_b16 v[0:1], v68 offset:8192
ds_read_b64_tr_b16 v[2:3], v68 offset:8320
ds_read_b64_tr_b16 v[4:5], v68 offset:10240
ds_read_b64_tr_b16 v[6:7], v68 offset:10368
ds_read_b64_tr_b16 v[8:9], v68 offset:8224
ds_read_b64_tr_b16 v[10:11], v68 offset:8352
ds_read_b64_tr_b16 v[12:13], v68 offset:10272
ds_read_b64_tr_b16 v[14:15], v68 offset:10400
ds_read_b64_tr_b16 v[16:17], v68 offset:12288
ds_read_b64_tr_b16 v[18:19], v68 offset:12416
ds_read_b64_tr_b16 v[20:21], v68 offset:14336
ds_read_b64_tr_b16 v[22:23], v68 offset:14464
ds_read_b64_tr_b16 v[24:25], v68 offset:12320
ds_read_b64_tr_b16 v[26:27], v68 offset:12448
ds_read_b64_tr_b16 v[28:29], v68 offset:14368
ds_read_b64_tr_b16 v[30:31], v68 offset:14496
s_waitcnt lgkmcnt(0)
ds_write_b128 v113, v[0:3] offset:8192
ds_write_b128 v113, v[4:7] offset:9216
ds_write_b128 v113, v[8:11] offset:10240
ds_write_b128 v113, v[12:15] offset:11264
ds_write_b128 v113, v[16:19] offset:12288
ds_write_b128 v113, v[20:23] offset:13312
ds_write_b128 v113, v[24:27] offset:14336
ds_write_b128 v113, v[28:31] offset:15360
s_waitcnt lgkmcnt(0)
s_waitcnt vmcnt(9)
buffer_load_dword v76, v74, s[4:7], 0 offen sc1
buffer_load_dword v79, v75, s[4:7], 0 offen sc1
ds_read_b64_tr_b16 v[0:1], v68 offset:16384
ds_read_b64_tr_b16 v[2:3], v68 offset:16512
ds_read_b64_tr_b16 v[4:5], v68 offset:18432
ds_read_b64_tr_b16 v[6:7], v68 offset:18560
ds_read_b64_tr_b16 v[8:9], v68 offset:16416
ds_read_b64_tr_b16 v[10:11], v68 offset:16544
ds_read_b64_tr_b16 v[12:13], v68 offset:18464
ds_read_b64_tr_b16 v[14:15], v68 offset:18592
ds_read_b64_tr_b16 v[16:17], v68 offset:20480
ds_read_b64_tr_b16 v[18:19], v68 offset:20608
ds_read_b64_tr_b16 v[20:21], v68 offset:22528
ds_read_b64_tr_b16 v[22:23], v68 offset:22656
ds_read_b64_tr_b16 v[24:25], v68 offset:20512
ds_read_b64_tr_b16 v[26:27], v68 offset:20640
ds_read_b64_tr_b16 v[28:29], v68 offset:22560
ds_read_b64_tr_b16 v[30:31], v68 offset:22688
s_waitcnt lgkmcnt(0)
ds_write_b128 v113, v[0:3] offset:16384
ds_write_b128 v113, v[4:7] offset:17408
ds_write_b128 v113, v[8:11] offset:18432
ds_write_b128 v113, v[12:15] offset:19456
ds_write_b128 v113, v[16:19] offset:20480
ds_write_b128 v113, v[20:23] offset:21504
ds_write_b128 v113, v[24:27] offset:22528
ds_write_b128 v113, v[28:31] offset:23552
s_waitcnt lgkmcnt(0)
s_waitcnt vmcnt(2)
s_waitcnt vmcnt(0)
v_min_u32 v76, v76, v79
v_cmp_eq_u32 vcc, 0, v76
s_cmp_eq_u32 s38, 0
s_cbranch_scc0 main_kernel_c_sl0
s_cbranch_vccnz main_kernel_c_sl1
s_branch main_kernel_c_kv0_ok
main_kernel_c_sl0:
v_and_b32 v126, 7, v94
v_lshlrev_b32 v126, 5, v126
main_kernel_c_mode_cnt:
buffer_load_dword v127, v126, s[60:63], 0 offen sc1
s_waitcnt vmcnt(0)
v_readlane_b32 s48, v127, 0
v_readlane_b32 s49, v127, 1
v_readlane_b32 s50, v127, 2
v_readlane_b32 s51, v127, 3
v_readlane_b32 s52, v127, 4
v_readlane_b32 s53, v127, 5
v_readlane_b32 s54, v127, 6
v_readlane_b32 s55, v127, 7
s_nop 3
s_add_u32 s33, s48, s49
s_add_u32 s33, s33, s50
s_add_u32 s33, s33, s51
s_add_u32 s33, s33, s52
s_add_u32 s33, s33, s53
s_add_u32 s33, s33, s54
s_add_u32 s33, s33, s55
s_cmp_ge_u32 s33, 256
s_cbranch_scc1 main_kernel_c_mode_cnt_ok
s_sub_u32 s29, s29, 1
s_cbranch_scc1 main_kernel_end
s_sleep 4
s_branch main_kernel_c_mode_cnt
main_kernel_c_mode_cnt_ok:
v_mov_b32 v126, 0
main_kernel_c_wa:
buffer_load_dword v127, v126, s[60:63], 0 offen offset:12 sc1
s_waitcnt vmcnt(0)
v_cmp_gt_u32 vcc, 4, v127
s_cbranch_vccz main_kernel_c_wa_ok
s_sleep 4
s_sub_u32 s29, s29, 1
s_cbranch_scc0 main_kernel_c_wa
s_branch main_kernel_end
main_kernel_c_wa_ok:
main_kernel_c_sl1:
v_lshlrev_b32 v126, 2, v94
s_mov_b32 s32, 0x841f000
main_kernel_c_wf:
buffer_load_dword v0, v126, s[4:7], s32 offen sc1
s_waitcnt vmcnt(0)
v_cmp_eq_u32 vcc, 0, v0
s_cbranch_vccz main_kernel_c_wf_ok
s_sleep 4
s_sub_u32 s29, s29, 1
s_cbranch_scc0 main_kernel_c_wf
s_branch main_kernel_end
main_kernel_c_wf_ok:
s_mov_b32 exec_lo, 0
s_mov_b32 exec_hi, 0x300
v_subrev_u32 v127, 0, v121
main_kernel_c_kv0:
buffer_load_dword v126, v127, s[4:7], 0 offen sc1
s_waitcnt vmcnt(0)
v_cmp_eq_u32 vcc, 0, v126
s_cbranch_vccz main_kernel_c_kv0_ok
s_sleep 2
s_sub_u32 s29, s29, 1
s_cbranch_scc0 main_kernel_c_kv0
s_branch main_kernel_end
main_kernel_c_kv0_ok:
s_mov_b32 exec_lo, 0
s_mov_b32 exec_hi, 0x3f00
v_add_u32 v121, 128, v121
s_mov_b64 exec, -1
s_mov_b32 m0, s36
buffer_load_dwordx4 v[96:99], v116, s[4:7], s28 offen sc1
buffer_load_dwordx4 v116, s[4:7], s27 offen sc1 lds
buffer_load_dwordx4 v116, s[4:7], s27 offen offset:1024 sc1 lds
s_add_u32 s27, s27, 0x40000
buffer_load_dword v123, v77, s[4:7], 0 offen sc1
ds_read_b64_tr_b16 v[0:1], v68 offset:24576
ds_read_b64_tr_b16 v[2:3], v68 offset:24704
ds_read_b64_tr_b16 v[4:5], v68 offset:26624
ds_read_b64_tr_b16 v[6:7], v68 offset:26752
ds_read_b64_tr_b16 v[8:9], v68 offset:24608
ds_read_b64_tr_b16 v[10:11], v68 offset:24736
ds_read_b64_tr_b16 v[12:13], v68 offset:26656
ds_read_b64_tr_b16 v[14:15], v68 offset:26784
ds_read_b64_tr_b16 v[16:17], v68 offset:28672
ds_read_b64_tr_b16 v[18:19], v68 offset:28800
ds_read_b64_tr_b16 v[20:21], v68 offset:30720
ds_read_b64_tr_b16 v[22:23], v68 offset:30848
ds_read_b64_tr_b16 v[24:25], v68 offset:28704
ds_read_b64_tr_b16 v[26:27], v68 offset:28832
ds_read_b64_tr_b16 v[28:29], v68 offset:30752
ds_read_b64_tr_b16 v[30:31], v68 offset:30880
s_waitcnt lgkmcnt(0)
ds_write_b128 v113, v[0:3] offset:24576
ds_write_b128 v113, v[4:7] offset:25600
ds_write_b128 v113, v[8:11] offset:26624
ds_write_b128 v113, v[12:15] offset:27648
ds_write_b128 v113, v[16:19] offset:28672
ds_write_b128 v113, v[20:23] offset:29696
ds_write_b128 v113, v[24:27] offset:30720
ds_write_b128 v113, v[28:31] offset:31744
s_waitcnt lgkmcnt(0)
main_kernel_c_nb:
v_readfirstlane_b32 s33, v84
v_readfirstlane_b32 s32, v85
s_nop 3
s_and_b32 s34, s32, s33
s_cbranch_scc1 main_kernel_c_nb_ok
buffer_load_dwordx2 v[84:85], off, s[60:63], 0 offset:16 sc1
s_sub_u32 s29, s29, 1
s_cbranch_scc1 main_kernel_end
s_waitcnt vmcnt(0)
s_branch main_kernel_c_nb
main_kernel_c_nb_ok:
s_and_b32 s33, s33, 1
s_lshl_b32 s33, s33, 13
s_add_u32 s52, s33, 0x8c10000
s_and_b32 s32, s32, 1
s_lshl_b32 s32, s32, 13
s_sub_u32 s53, s32, s33
s_add_u32 s53, s53, 65536
s_and_b32 s59, s25, 0x7fff
s_and_b32 s33, s59, 0x6000
s_add_u32 s59, s59, s33
s_and_b32 s54, s19, 0x7fff
s_and_b32 s33, s54, 0x6000
s_add_u32 s54, s54, s33
s_xor_b32 s34, s52, 0x2000
s_lshl_b32 s32, s14, 14
s_lshl_b32 s33, s13, 8
s_add_u32 s33, s33, s34
s_add_u32 s55, s32, s33
v_writelane_b32 v121, s55, 39
s_lshl_b32 s32, s12, 15
s_add_u32 s44, s32, s33
s_xor_b32 s32, s32, 0x8000
s_add_u32 s45, s32, s34
s_lshl_b32 s32, s12, 14
s_add_u32 s32, s32, 0x6c78000
s_lshl_b32 s33, s13, 3
s_add_u32 s46, s32, s33
s_andn2_b32 s32, s25, 0x3ff
s_add_u32 s32, s32, 0x80000
s_cmp_eq_u32 s14, 1
s_cselect_b32 s46, s32, s46
s_add_u32 s20, s20, 0xc0000
s_add_u32 s21, s21, 0xc0000
s_add_u32 s22, s22, 0xc0000
s_add_u32 s23, s23, 0xc0000
s_sub_u32 s3, s3, 0x40000
s_sub_u32 s37, s37, 65536
s_sub_u32 s26, s26, 65536
s_cmp_eq_u32 s14, 3
s_cselect_b32 s39, 0, s39
s_mov_b32 s15, 0
s_mov_b32 s16, 0
s_cselect_b32 s27, 0, s27
s_mov_b32 s17, -1
s_memrealtime s[32:33]
s_memtime s[40:41]
s_waitcnt lgkmcnt(0)
s_mul_i32 s32, s32, 22
s_sub_u32 s11, s40, s32
s_sub_u32 s31, s32, 0x20000
s_sub_u32 s43, s31, 0x20000
s_min_u32 s32, s48, s49
s_cmp_ge_u32 s32, 32
s_waitcnt vmcnt(0)
s_cselect_b32 s32, 0, 4
s_add_u32 s32, s32, s14
s_cmp_eq_u32 s32, 1
s_cbranch_scc1 main_kernel_c1_top
s_cmp_eq_u32 s32, 2
s_cbranch_scc1 main_kernel_c2_top
s_cmp_eq_u32 s32, 3
s_cbranch_scc1 main_kernel_c3_top
s_cmp_eq_u32 s32, 4
s_cbranch_scc1 main_kernel_c4_top
s_cmp_eq_u32 s32, 5
s_cbranch_scc1 main_kernel_c5_top
s_cmp_eq_u32 s32, 6
s_cbranch_scc1 main_kernel_c6_top
s_cmp_eq_u32 s32, 7
s_cbranch_scc1 main_kernel_c7_top
s_branch main_kernel_c0_top
.p2align 6
main_kernel_c0_top:
s_barrier
buffer_load_dwordx4 v[0:3], v116, s[4:7], s18 offen sc1
s_add_u32 s20, s20, 0x40000
s_bitset0_b32 s20, 20
s_add_u32 s21, s21, 0x40000
s_bitset0_b32 s21, 20
s_add_u32 s22, s22, 0x40000
s_bitset0_b32 s22, 20
s_add_u32 s23, s23, 0x40000
s_bitset0_b32 s23, 20
s_xor_b32 s32, s18, 1024
buffer_load_dwordx4 v[16:19], v116, s[4:7], s32 offen sc1
s_add_u32 s3, s3, 0x40000
s_bitset0_b32 s3, 20
s_add_u32 s17, s17, 1
s_add_u32 s25, s52, s59
s_nop 3
buffer_load_dwordx4 v[64:67], v116, s[4:7], s19 offen sc1
v_mov_b32 v80, 0
v_mov_b32 v81, 0
s_nop 3
s_xor_b32 s32, s19, 1024
buffer_load_dwordx4 v[68:71], v116, s[4:7], s32 offen sc1
v_mov_b32 v82, 0
v_mov_b32 v83, 0
s_nop 3
s_xor_b32 s32, s18, 2048
buffer_load_dwordx4 v[32:35], v116, s[4:7], s32 offen sc1
v_mov_b32 v84, 0
v_mov_b32 v85, 0
s_nop 3
s_xor_b32 s32, s19, 2048
buffer_load_dwordx4 v[72:75], v116, s[4:7], s32 offen sc1
v_mov_b32 v86, 0
v_mov_b32 v87, 0
s_nop 3
s_xor_b32 s32, s18, 3072
buffer_load_dwordx4 v[48:51], v116, s[4:7], s32 offen sc1
v_mov_b32 v88, 0
v_mov_b32 v89, 0
s_nop 3
s_xor_b32 s32, s19, 3072
buffer_load_dwordx4 v[76:79], v116, s[4:7], s32 offen sc1
v_mov_b32 v90, 0
v_mov_b32 v91, 0
s_waitcnt vmcnt(5)
v_pk_add_f16 v0, v0, v64
v_pk_add_f16 v1, v1, v65
v_pk_add_f16 v2, v2, v66
v_pk_add_f16 v3, v3, v67
v_cmp_u_f16 vcc, v0, v2
s_cbranch_vccnz main_kernel_c0_m0_f
main_kernel_c0_m0:
v_smfmac_f32_16x16x64_f16 v[80:83], v[0:3], a[0:7], v112
ds_write_b128 v116, v[0:3] offset:0
v_smfmac_f32_16x16x64_f16 v[84:87], v[0:3], a[128:135], v112
buffer_load_dword v123, v121, s[4:7], 0 offen sc1
s_waitcnt vmcnt(5)
v_pk_add_f16 v16, v16, v68
v_pk_add_f16 v17, v17, v69
v_pk_add_f16 v18, v18, v70
v_pk_add_f16 v19, v19, v71
v_cmp_u_f16 vcc, v16, v18
s_waitcnt lgkmcnt(0)
s_barrier
ds_read_b128 v[4:7], v116 offset:1024
ds_write_b128 v116, v[16:19] offset:4096
s_cbranch_vccnz main_kernel_c0_m1_f
main_kernel_c0_m1:
v_smfmac_f32_16x16x64_f16 v[80:83], v[16:19], a[8:15], v112
v_smfmac_f32_16x16x64_f16 v[84:87], v[16:19], a[136:143], v112
ds_read_b128 v[8:11], v116 offset:2048
v_smfmac_f32_16x16x64_f16 v[88:91], v[0:3], v[128:135], v112
ds_read_b128 v[12:15], v116 offset:3072
s_waitcnt lgkmcnt(3)
v_smfmac_f32_16x16x64_f16 v[80:83], v[4:7], a[32:39], v112
v_smfmac_f32_16x16x64_f16 v[84:87], v[4:7], a[160:167], v112
v_smfmac_f32_16x16x64_f16 v[88:91], v[4:7], v[136:143], v112
s_waitcnt lgkmcnt(2)
s_barrier
s_waitcnt lgkmcnt(1)
v_smfmac_f32_16x16x64_f16 v[80:83], v[8:11], a[64:71], v112
s_waitcnt vmcnt(3)
ds_read_b128 v[20:23], v116 offset:5120
v_pk_add_f16 v32, v32, v72
v_smfmac_f32_16x16x64_f16 v[84:87], v[8:11], a[192:199], v112
ds_read_b128 v[24:27], v116 offset:6144
s_waitcnt lgkmcnt(2)
v_pk_add_f16 v33, v33, v73
v_smfmac_f32_16x16x64_f16 v[80:83], v[12:15], a[96:103], v112
ds_read_b128 v[28:31], v116 offset:7168
v_pk_add_f16 v34, v34, v74
v_smfmac_f32_16x16x64_f16 v[84:87], v[12:15], a[224:231], v112
s_waitcnt lgkmcnt(2)
v_pk_add_f16 v35, v35, v75
v_smfmac_f32_16x16x64_f16 v[80:83], v[20:23], a[40:47], v112
ds_write_b128 v116, v[32:35] offset:8192
v_cmp_u_f16 vcc, v32, v34
v_smfmac_f32_16x16x64_f16 v[84:87], v[20:23], a[168:175], v112
s_cbranch_vccnz main_kernel_c0_m2_f
main_kernel_c0_m2:
v_smfmac_f32_16x16x64_f16 v[80:83], v[32:35], a[16:23], v112
buffer_load_dwordx4 v[96:99], v116, s[4:7], s28 offen sc1
v_smfmac_f32_16x16x64_f16 v[84:87], v[32:35], a[144:151], v112
s_add_u32 s28, s28, 0x40000
s_waitcnt lgkmcnt(2)
v_smfmac_f32_16x16x64_f16 v[80:83], v[24:27], a[72:79], v112
s_waitcnt vmcnt(2)
v_pk_add_f16 v48, v48, v76
v_smfmac_f32_16x16x64_f16 v[84:87], v[24:27], a[200:207], v112
s_waitcnt lgkmcnt(0)
s_barrier
ds_read_b128 v[36:39], v116 offset:9216
v_pk_add_f16 v49, v49, v77
v_smfmac_f32_16x16x64_f16 v[80:83], v[28:31], a[104:111], v112
ds_read_b128 v[40:43], v116 offset:10240
v_pk_add_f16 v50, v50, v78
v_smfmac_f32_16x16x64_f16 v[84:87], v[28:31], a[232:239], v112
ds_read_b128 v[44:47], v116 offset:11264
v_pk_add_f16 v51, v51, v79
v_smfmac_f32_16x16x64_f16 v[88:91], v[8:11], v[144:151], v112
ds_write_b128 v116, v[48:51] offset:12288
s_waitcnt lgkmcnt(3)
v_cmp_u_f16 vcc, v48, v50
v_smfmac_f32_16x16x64_f16 v[80:83], v[36:39], a[48:55], v112
s_cbranch_vccnz main_kernel_c0_m3_f
main_kernel_c0_m3:
v_smfmac_f32_16x16x64_f16 v[80:83], v[48:51], a[24:31], v112
v_smfmac_f32_16x16x64_f16 v[84:87], v[48:51], a[152:159], v112
v_smfmac_f32_16x16x64_f16 v[84:87], v[36:39], a[176:183], v112
s_waitcnt lgkmcnt(2)
v_smfmac_f32_16x16x64_f16 v[80:83], v[40:43], a[80:87], v112
s_waitcnt lgkmcnt(0)
s_barrier
ds_read_b128 v[52:55], v116 offset:13312
v_smfmac_f32_16x16x64_f16 v[84:87], v[40:43], a[208:215], v112
s_add_u32 s19, s52, s54
ds_read_b128 v[56:59], v116 offset:14336
v_smfmac_f32_16x16x64_f16 v[80:83], v[44:47], a[112:119], v112
s_add_u32 s18, s18, 0x40000
ds_read_b128 v[60:63], v116 offset:15360
v_smfmac_f32_16x16x64_f16 v[84:87], v[44:47], a[240:247], v112
s_bitset0_b32 s18, 20
s_waitcnt lgkmcnt(2)
v_smfmac_f32_16x16x64_f16 v[80:83], v[52:55], a[56:63], v112
s_cmp_eq_u32 s17, 30
s_cselect_b32 s32, s53, 0x10000
s_waitcnt lgkmcnt(1)
v_smfmac_f32_16x16x64_f16 v[80:83], v[56:59], a[88:95], v112
s_add_u32 s52, s52, s32
s_waitcnt lgkmcnt(0)
v_smfmac_f32_16x16x64_f16 v[80:83], v[60:63], a[120:127], v112
s_sub_u32 s24, 0x20000, s32
ds_read_b128 v[64:67], v116 offset:24576
v_smfmac_f32_16x16x64_f16 v[84:87], v[52:55], a[184:191], v112
s_add_u32 s55, s55, s24
ds_read_b128 v[68:71], v116 offset:28672
v_smfmac_f32_16x16x64_f16 v[84:87], v[56:59], a[216:223], v112
ds_read_b128 v[72:75], v116 offset:25600
s_nop 0
v_cvt_pk_bf16_f32 v92, v80, v81
v_smfmac_f32_16x16x64_f16 v[84:87], v[60:63], a[248:255], v112
ds_read_b128 v[76:79], v116 offset:29696
s_nop 0
v_cvt_pk_bf16_f32 v93, v82, v83
v_smfmac_f32_16x16x64_f16 v[88:91], v[12:15], v[152:159], v112
s_nop 3
v_cvt_pk_bf16_f32 v94, v84, v85
v_cvt_pk_bf16_f32 v95, v86, v87
s_mov_b32 vcc_lo, 0xcccccccc
s_mov_b32 vcc_hi, 0xcccccccc
v_mfma_f32_16x16x32_bf16 v[84:87], v[92:95], v[104:107], 0
v_add_u32 v121, v121, v122
v_writelane_b32 v121, s55, 39
s_nop 0
v_smfmac_f32_16x16x64_f16 v[88:91], v[16:19], v[160:167], v112
s_nop 2
s_cmp_eq_u32 s17, 63
v_cvt_pk_bf16_f32 v114, v84, v85
v_cvt_pk_bf16_f32 v115, v86, v87
buffer_store_dwordx2 v[114:115], v117, s[4:7], s21 offen
s_cbranch_scc1 main_kernel_c0_last
ds_write_b64 v117, v[114:115] offset:16384
v_smfmac_f32_16x16x64_f16 v[88:91], v[20:23], v[168:175], v112
v_smfmac_f32_16x16x64_f16 v[88:91], v[24:27], v[176:183], v112
v_smfmac_f32_16x16x64_f16 v[88:91], v[28:31], v[184:191], v112
v_smfmac_f32_16x16x64_f16 v[88:91], v[32:35], v[192:199], v112
s_waitcnt lgkmcnt(0)
s_barrier
ds_read_b128 v[0:3], v116 offset:16384
v_smfmac_f32_16x16x64_f16 v[88:91], v[36:39], v[200:207], v112
ds_read_b128 v[4:7], v116 offset:17408
v_smfmac_f32_16x16x64_f16 v[88:91], v[40:43], v[208:215], v112
ds_read_b128 v[16:19], v116 offset:26624
v_smfmac_f32_16x16x64_f16 v[88:91], v[44:47], v[216:223], v112
ds_read_b128 v[20:23], v116 offset:30720
v_smfmac_f32_16x16x64_f16 v[88:91], v[48:51], v[224:231], v112
ds_read_b128 v[24:27], v116 offset:27648
v_smfmac_f32_16x16x64_f16 v[88:91], v[52:55], v[232:239], v112
ds_read_b128 v[28:31], v116 offset:31744
v_smfmac_f32_16x16x64_f16 v[88:91], v[56:59], v[240:247], v112
v_smfmac_f32_16x16x64_f16 v[88:91], v[60:63], v[248:255], v112
s_waitcnt lgkmcnt(5)
v_mfma_f32_16x16x32_bf16 v[80:83], v[64:67], v[0:3], 0
v_mfma_f32_16x16x32_bf16 v[84:87], v[68:71], v[0:3], 0
buffer_load_dwordx4 v[8:11], v116, s[4:7], s20 offen offset:0 sc1
v_mfma_f32_16x16x32_bf16 v[92:95], v[0:3], v[0:3], 0
buffer_load_dwordx4 v[12:15], v116, s[4:7], s20 offen offset:1024 sc1
v_permlane32_swap_b32 v88, v90
s_waitcnt lgkmcnt(4)
v_mfma_f32_16x16x32_bf16 v[80:83], v[72:75], v[4:7], v[80:83]
v_permlane32_swap_b32 v89, v91
v_mfma_f32_16x16x32_bf16 v[84:87], v[76:79], v[4:7], v[84:87]
v_pk_add_f32 v[88:89], v[88:89], v[90:91]
v_mfma_f32_16x16x32_bf16 v[92:95], v[4:7], v[4:7], v[92:95]
v_cvt_pk_bf16_f32 v124, v88, v89
v_mov_b32 v65, 0
s_waitcnt lgkmcnt(0)
s_waitcnt vmcnt(1)
v_mfma_f32_16x16x32_bf16 v[88:91], v[8:11], v[8:11], v[92:95]
v_mfma_f32_16x16x32_bf16 v[0:3], v[16:19], v[8:11], v[80:83]
v_cmp_u_f32 s[0:1], v8, v10
v_mfma_f32_16x16x32_bf16 v[4:7], v[20:23], v[8:11], v[84:87]
s_waitcnt vmcnt(0)
v_mfma_f32_16x16x32_bf16 v[88:91], v[12:15], v[12:15], v[88:91]
v_mfma_f32_16x16x32_bf16 v[0:3], v[24:27], v[12:15], v[0:3]
v_cmp_u_f32 s[32:33], v12, v14
v_mfma_f32_16x16x32_bf16 v[4:7], v[28:31], v[12:15], v[4:7]
s_or_b64 s[0:1], s[0:1], s[32:33]
s_cbranch_scc1 main_kernel_c0_z_f
main_kernel_c0_z:
v_mul_f32 v88, s30, v88
v_mul_f32 v89, s30, v89
v_exp_f32 v88, v88
v_exp_f32 v89, v89
v_cndmask_b32_dpp v0, v2, v0, vcc quad_perm:[2,3,2,3] row_mask:0xf bank_mask:0xf
v_cvt_pk_bf16_f32 v64, v88, v89
v_cndmask_b32_dpp v1, v3, v1, vcc quad_perm:[2,3,2,3] row_mask:0xf bank_mask:0xf
v_exp_f32 v0, v0
v_mfma_f32_16x16x16_bf16 v[16:19], v[100:101], v[64:65], 0
v_exp_f32 v1, v1
v_cndmask_b32_dpp v4, v6, v4, vcc quad_perm:[2,3,2,3] row_mask:0xf bank_mask:0xf
v_mfma_f32_16x16x16_bf16 v[8:11], v[124:125], v[64:65], 0
v_cndmask_b32_dpp v5, v7, v5, vcc quad_perm:[2,3,2,3] row_mask:0xf bank_mask:0xf
v_exp_f32 v4, v4
v_exp_f32 v5, v5
v_cvt_pk_bf16_f32 v92, v0, v1
v_cvt_pk_bf16_f32 v94, v4, v5
v_mov_b32 v80, 0
v_mov_b32_dpp v93, v92 quad_perm:[0,1,0,1] row_mask:0xf bank_mask:0xf
v_mov_b32_dpp v95, v94 quad_perm:[0,1,0,1] row_mask:0xf bank_mask:0xf
v_mov_b32 v81, 0
v_mov_b32 v82, 0
v_mfma_f32_16x16x32_bf16 v[16:19], v[100:103], v[92:95], v[16:19]
v_mov_b32 v83, 0
v_mov_b32 v84, 0
v_mfma_f32_16x16x32_bf16 v[8:11], v[96:99], v[92:95], v[8:11]
s_nop 1
v_mov_b32 v85, 0
v_mov_b32 v86, 0
v_mov_b32 v87, 0
v_rcp_f32 v126, v16
v_subrev_u32 v127, 0x21800000, v16
v_cmp_lt_u32 vcc, 0x3c000000, v127
v_pk_mul_f32 v[8:9], v[8:9], v[126:127] op_sel_hi:[1,0]
v_pk_mul_f32 v[10:11], v[10:11], v[126:127] op_sel_hi:[1,0]
s_and_b32 s32, vcc_lo, 0xcccc
v_cvt_pk_bf16_f32 v126, v8, v9
v_cvt_pk_bf16_f32 v127, v10, v11
s_cbranch_scc1 main_kernel_c0_sm_f
main_kernel_c0_ost:
buffer_store_dwordx2 v[126:127], v118, s[4:7], s22 offen
v_cmp_eq_u32 s[0:1], 0, v123
v_mov_b32 v24, -1
v_mov_b32 v25, -1
v_mov_b32 v26, -1
v_mov_b32 v27, -1
ds_read_b128 v[32:35], v113 offset:0
ds_read_b128 v[36:39], v113 offset:1024
ds_read_b128 v[40:43], v113 offset:2048
ds_read_b128 v[44:47], v113 offset:3072
ds_read_b128 v[48:51], v113 offset:4096
ds_read_b128 v[52:55], v113 offset:5120
s_and_b32 s10, s1, 0x3f00
buffer_store_dwordx4 v[24:27], v116, s[4:7], s3 offen
s_barrier
buffer_load_dwordx4 v[0:3], v116, s[4:7], s23 offen sc1
ds_read_b128 v[56:59], v113 offset:6144
ds_read_b128 v[60:63], v113 offset:7168
s_add_u32 s37, s37, 65536
s_add_u32 s26, s26, 65536
s_nop 1
s_xor_b32 s32, s23, 1024
buffer_load_dwordx4 v[4:7], v116, s[4:7], s32 offen sc1
ds_read_b128 v[64:67], v113 offset:8192
ds_read_b128 v[68:71], v113 offset:9216
s_nop 3
s_xor_b32 s32, s23, 2048
buffer_load_dwordx4 v[8:11], v116, s[4:7], s32 offen sc1
ds_read_b128 v[72:75], v113 offset:10240
ds_read_b128 v[76:79], v113 offset:11264
s_nop 3
s_xor_b32 s32, s23, 3072
buffer_load_dwordx4 v[12:15], v116, s[4:7], s32 offen sc1
ds_read_b128 v[88:91], v113 offset:12288
ds_read_b128 v[92:95], v113 offset:13312
s_nop 3
s_xor_b32 s32, s23, 4096
buffer_load_dwordx4 v[16:19], v116, s[4:7], s32 offen sc1
s_nop 7
s_xor_b32 s32, s23, 5120
buffer_load_dwordx4 v[20:23], v116, s[4:7], s32 offen sc1
s_nop 7
s_xor_b32 s32, s23, 6144
buffer_load_dwordx4 v[24:27], v116, s[4:7], s32 offen sc1
s_nop 7
s_xor_b32 s32, s23, 7168
buffer_load_dwordx4 v[28:31], v116, s[4:7], s32 offen sc1
s_waitcnt lgkmcnt(12)
s_waitcnt vmcnt(7)
v_cmp_u_f32 vcc, v0, v2
s_cbranch_vccnz main_kernel_c0_o0_f
main_kernel_c0_o0:
v_smfmac_f32_16x16x64_bf16 v[80:83], v[0:3], v[32:39], v112
ds_read_b128 v[32:35], v113 offset:14336
ds_read_b128 v[36:39], v113 offset:15360
s_waitcnt lgkmcnt(12)
s_waitcnt vmcnt(6)
v_cmp_u_f32 vcc, v4, v6
v_smfmac_f32_16x16x64_bf16 v[84:87], v[0:3], v[40:47], v112
ds_read_b128 v[40:43], v113 offset:16384
ds_read_b128 v[44:47], v113 offset:17408
buffer_store_dwordx2 v[114:115], v119, s[4:7], s37 offen sc1
s_cbranch_vccnz main_kernel_c0_o1_f
main_kernel_c0_o1:
s_waitcnt lgkmcnt(12)
v_smfmac_f32_16x16x64_bf16 v[80:83], v[4:7], v[48:55], v112
ds_read_b128 v[48:51], v113 offset:18432
ds_read_b128 v[52:55], v113 offset:19456
s_waitcnt lgkmcnt(12)
s_waitcnt vmcnt(6)
v_cmp_u_f32 vcc, v8, v10
v_smfmac_f32_16x16x64_bf16 v[84:87], v[4:7], v[56:63], v112
ds_read_b128 v[56:59], v113 offset:20480
ds_read_b128 v[60:63], v113 offset:21504
buffer_store_dword v124, v120, s[4:7], s26 offen sc1
s_cbranch_vccnz main_kernel_c0_o2_f
main_kernel_c0_o2:
s_waitcnt lgkmcnt(12)
v_smfmac_f32_16x16x64_bf16 v[80:83], v[8:11], v[64:71], v112
ds_read_b128 v[64:67], v113 offset:22528
ds_read_b128 v[68:71], v113 offset:23552
s_waitcnt lgkmcnt(12)
s_waitcnt vmcnt(6)
v_cmp_u_f32 vcc, v12, v14
v_smfmac_f32_16x16x64_bf16 v[84:87], v[8:11], v[72:79], v112
ds_read_b128 v[72:75], v113 offset:24576
ds_read_b128 v[76:79], v113 offset:25600
s_cbranch_vccnz main_kernel_c0_o3_f
main_kernel_c0_o3:
s_waitcnt lgkmcnt(12)
v_smfmac_f32_16x16x64_bf16 v[80:83], v[12:15], v[88:95], v112
ds_read_b128 v[88:91], v113 offset:26624
ds_read_b128 v[92:95], v113 offset:27648
s_waitcnt lgkmcnt(12)
s_waitcnt vmcnt(5)
v_cmp_u_f32 vcc, v16, v18
v_smfmac_f32_16x16x64_bf16 v[84:87], v[12:15], v[32:39], v112
ds_read_b128 v[32:35], v113 offset:28672
ds_read_b128 v[36:39], v113 offset:29696
s_cbranch_vccnz main_kernel_c0_o4_f
main_kernel_c0_o4:
s_waitcnt lgkmcnt(12)
v_smfmac_f32_16x16x64_bf16 v[80:83], v[16:19], v[40:47], v112
ds_read_b128 v[40:43], v113 offset:30720
ds_read_b128 v[44:47], v113 offset:31744
s_waitcnt lgkmcnt(12)
s_waitcnt vmcnt(4)
v_cmp_u_f32 vcc, v20, v22
v_smfmac_f32_16x16x64_bf16 v[84:87], v[16:19], v[48:55], v112
s_cbranch_vccnz main_kernel_c0_o5_f
main_kernel_c0_o5:
s_waitcnt lgkmcnt(10)
v_smfmac_f32_16x16x64_bf16 v[80:83], v[20:23], v[56:63], v112
s_waitcnt lgkmcnt(8)
s_waitcnt vmcnt(3)
v_cmp_u_f32 vcc, v24, v26
v_smfmac_f32_16x16x64_bf16 v[84:87], v[20:23], v[64:71], v112
s_cbranch_vccnz main_kernel_c0_o6_f
main_kernel_c0_o6:
s_waitcnt lgkmcnt(6)
v_smfmac_f32_16x16x64_bf16 v[80:83], v[24:27], v[72:79], v112
s_waitcnt lgkmcnt(4)
v_smfmac_f32_16x16x64_bf16 v[84:87], v[24:27], v[88:95], v112
s_waitcnt lgkmcnt(2)
s_waitcnt vmcnt(2)
v_cmp_u_f32 vcc, v28, v30
s_cbranch_vccnz main_kernel_c0_o7_f
main_kernel_c0_o7:
v_smfmac_f32_16x16x64_bf16 v[80:83], v[28:31], v[32:39], v112
s_waitcnt lgkmcnt(0)
v_smfmac_f32_16x16x64_bf16 v[84:87], v[28:31], v[40:47], v112
s_nop 4
v_cvt_pk_bf16_f32 v80, v80, v81
v_cvt_pk_bf16_f32 v81, v82, v83
ds_write_b64 v116, v[80:81] offset:20480
v_cvt_pk_bf16_f32 v82, v84, v85
v_cvt_pk_bf16_f32 v83, v86, v87
ds_write_b64 v116, v[82:83] offset:22528
s_waitcnt lgkmcnt(0)
s_barrier
ds_read_b128 v[72:75], v116 offset:20480
ds_read_b128 v[76:79], v116 offset:21504
s_mov_b32 m0, 24576
s_cmp_lg_u32 s10, 0
s_waitcnt lgkmcnt(1)
v_mfma_f32_16x16x32_bf16 v[64:67], v[72:75], v[108:111], 0
s_waitcnt lgkmcnt(0)
v_mfma_f32_16x16x32_bf16 v[64:67], v[76:79], v[108:111], v[64:67]
s_nop 7
v_cvt_pk_f16_f32 v68, v64, v65
v_cvt_pk_f16_f32 v69, v66, v67
buffer_store_dwordx2 v[68:69], v125, s[4:7], s25 offen sc1
s_cbranch_scc1 main_kernel_c0_kvw
main_kernel_c0_kvok:
s_nop 3
buffer_load_dwordx4 v116, s[4:7], s27 offen sc1 lds
buffer_load_dwordx4 v116, s[4:7], s27 offen offset:1024 sc1 lds
s_add_u32 s27, s27, 0x40000
s_branch main_kernel_c0_top
main_kernel_c0_kvw:
s_mov_b32 exec_lo, 0
s_mov_b32 exec_hi, 0x3f00
v_subrev_u32 v127, 128, v121
main_kernel_c0_kvp:
buffer_load_dword v126, v127, s[4:7], 0 offen sc1
s_waitcnt vmcnt(0)
v_cmp_eq_u32 vcc, 0, v126
s_cbranch_vccz main_kernel_c0_kvp_ok
s_sleep 2
s_sub_u32 s29, s29, 1
s_cbranch_scc0 main_kernel_c0_kvp
s_branch main_kernel_end
main_kernel_c0_kvp_ok:
s_mov_b64 exec, -1
s_branch main_kernel_c0_kvok
main_kernel_c0_last:
s_add_u32 s37, s37, 65536
s_add_u32 s26, s26, 65536
buffer_store_dwordx2 v[114:115], v119, s[4:7], s37 offen sc1
v_smfmac_f32_16x16x64_f16 v[88:91], v[20:23], v[168:175], v112
v_smfmac_f32_16x16x64_f16 v[88:91], v[24:27], v[176:183], v112
v_smfmac_f32_16x16x64_f16 v[88:91], v[28:31], v[184:191], v112
v_smfmac_f32_16x16x64_f16 v[88:91], v[32:35], v[192:199], v112
v_smfmac_f32_16x16x64_f16 v[88:91], v[36:39], v[200:207], v112
v_smfmac_f32_16x16x64_f16 v[88:91], v[40:43], v[208:215], v112
v_smfmac_f32_16x16x64_f16 v[88:91], v[44:47], v[216:223], v112
v_smfmac_f32_16x16x64_f16 v[88:91], v[48:51], v[224:231], v112
v_smfmac_f32_16x16x64_f16 v[88:91], v[52:55], v[232:239], v112
v_smfmac_f32_16x16x64_f16 v[88:91], v[56:59], v[240:247], v112
v_smfmac_f32_16x16x64_f16 v[88:91], v[60:63], v[248:255], v112
s_nop 7
v_permlane32_swap_b32 v88, v90
s_nop 1
v_permlane32_swap_b32 v89, v91
s_nop 1
v_pk_add_f32 v[88:89], v[88:89], v[90:91]
s_nop 1
v_cvt_pk_bf16_f32 v124, v88, v89
s_nop 1
buffer_store_dword v124, v120, s[4:7], s26 offen sc1
s_branch main_kernel_end
main_kernel_c0_m0_f:
s_waitcnt lgkmcnt(0)
buffer_load_dwordx4 v[0:3], v116, s[4:7], s18 offen sc1
buffer_load_dwordx4 v[64:67], v116, s[4:7], s19 offen sc1
s_xor_b32 s32, s18, 1024
buffer_load_dwordx4 v[16:19], v116, s[4:7], s32 offen sc1
s_xor_b32 s32, s19, 1024
buffer_load_dwordx4 v[68:71], v116, s[4:7], s32 offen sc1
s_xor_b32 s32, s18, 2048
buffer_load_dwordx4 v[32:35], v116, s[4:7], s32 offen sc1
s_xor_b32 s32, s19, 2048
buffer_load_dwordx4 v[72:75], v116, s[4:7], s32 offen sc1
s_xor_b32 s32, s18, 3072
buffer_load_dwordx4 v[48:51], v116, s[4:7], s32 offen sc1
s_xor_b32 s32, s19, 3072
buffer_load_dwordx4 v[76:79], v116, s[4:7], s32 offen sc1
s_sub_u32 s29, s29, 1
s_cbranch_scc1 main_kernel_end
s_waitcnt vmcnt(0)
v_max_u32 v126, v0, v2
v_max3_u32 v126, v126, v64, v66
v_cmp_eq_u32 vcc, -1, v126
s_cbranch_vccnz main_kernel_c0_m0_f
v_pk_add_f16 v0, v0, v64
v_pk_add_f16 v1, v1, v65
v_pk_add_f16 v2, v2, v66
v_pk_add_f16 v3, v3, v67
s_nop 0
s_branch main_kernel_c0_m0
main_kernel_c0_m1_f:
s_waitcnt lgkmcnt(0)
s_xor_b32 s32, s18, 1024
buffer_load_dwordx4 v[16:19], v116, s[4:7], s32 offen sc1
s_xor_b32 s32, s19, 1024
buffer_load_dwordx4 v[68:71], v116, s[4:7], s32 offen sc1
s_xor_b32 s32, s18, 2048
buffer_load_dwordx4 v[32:35], v116, s[4:7], s32 offen sc1
s_xor_b32 s32, s19, 2048
buffer_load_dwordx4 v[72:75], v116, s[4:7], s32 offen sc1
s_xor_b32 s32, s18, 3072
buffer_load_dwordx4 v[48:51], v116, s[4:7], s32 offen sc1
s_xor_b32 s32, s19, 3072
buffer_load_dwordx4 v[76:79], v116, s[4:7], s32 offen sc1
s_sub_u32 s29, s29, 1
s_cbranch_scc1 main_kernel_end
s_waitcnt vmcnt(0)
v_max_u32 v126, v16, v18
v_max3_u32 v126, v126, v68, v70
v_cmp_eq_u32 vcc, -1, v126
s_cbranch_vccnz main_kernel_c0_m1_f
v_pk_add_f16 v16, v16, v68
v_pk_add_f16 v17, v17, v69
v_pk_add_f16 v18, v18, v70
v_pk_add_f16 v19, v19, v71
ds_write_b128 v116, v[16:19] offset:4096
s_branch main_kernel_c0_m1
main_kernel_c0_m2_f:
s_waitcnt lgkmcnt(0)
s_xor_b32 s32, s18, 2048
buffer_load_dwordx4 v[32:35], v116, s[4:7], s32 offen sc1
s_xor_b32 s32, s19, 2048
buffer_load_dwordx4 v[72:75], v116, s[4:7], s32 offen sc1
s_xor_b32 s32, s18, 3072
buffer_load_dwordx4 v[48:51], v116, s[4:7], s32 offen sc1
s_xor_b32 s32, s19, 3072
buffer_load_dwordx4 v[76:79], v116, s[4:7], s32 offen sc1
s_sub_u32 s29, s29, 1
s_cbranch_scc1 main_kernel_end
s_waitcnt vmcnt(0)
v_max_u32 v126, v32, v34
v_max3_u32 v126, v126, v72, v74
v_cmp_eq_u32 vcc, -1, v126
s_cbranch_vccnz main_kernel_c0_m2_f
v_pk_add_f16 v32, v32, v72
v_pk_add_f16 v33, v33, v73
v_pk_add_f16 v34, v34, v74
v_pk_add_f16 v35, v35, v75
ds_write_b128 v116, v[32:35] offset:8192
s_branch main_kernel_c0_m2
main_kernel_c0_m3_f:
s_waitcnt lgkmcnt(0)
s_xor_b32 s32, s18, 3072
buffer_load_dwordx4 v[48:51], v116, s[4:7], s32 offen sc1
s_xor_b32 s32, s19, 3072
buffer_load_dwordx4 v[76:79], v116, s[4:7], s32 offen sc1
s_sub_u32 s29, s29, 1
s_cbranch_scc1 main_kernel_end
s_waitcnt vmcnt(0)
v_max_u32 v126, v48, v50
v_max3_u32 v126, v126, v76, v78
v_cmp_eq_u32 vcc, -1, v126
s_cbranch_vccnz main_kernel_c0_m3_f
v_pk_add_f16 v48, v48, v76
v_pk_add_f16 v49, v49, v77
v_pk_add_f16 v50, v50, v78
v_pk_add_f16 v51, v51, v79
ds_write_b128 v116, v[48:51] offset:12288
s_branch main_kernel_c0_m3
main_kernel_c0_z_f:
buffer_load_dwordx4 v[8:11], v116, s[4:7], s20 offen offset:0 sc1
buffer_load_dwordx4 v[12:15], v116, s[4:7], s20 offen offset:1024 sc1
s_memtime s[32:33]
ds_read_b32 v126, v116 offset:18432
s_sub_u32 s34, s19, s54
s_xor_b32 s34, s34, 0x2000
s_lshl_b32 s35, s12, 15
s_add_u32 s34, s34, s35
s_lshl_b32 s35, s13, 8
s_add_u32 s35, s35, s34
s_add_u32 s34, s34, 0x4000
s_waitcnt lgkmcnt(0)
s_sub_u32 s32, s32, 450
v_sub_u32 v127, s32, v126
buffer_store_dword v127, off, s[4:7], s34
s_sub_u32 s29, s29, 1
s_cbranch_scc1 main_kernel_end
s_waitcnt vmcnt(1)
main_kernel_c0_z_g:
v_max_u32 v126, v8, v10
v_max3_u32 v126, v126, v12, v14
v_cmp_eq_u32 vcc, -1, v126
s_cbranch_vccnz main_kernel_c0_z_h
v_mfma_f32_16x16x32_bf16 v[88:91], v[8:11], v[8:11], v[92:95]
v_mfma_f32_16x16x32_bf16 v[0:3], v[16:19], v[8:11], v[80:83]
v_mfma_f32_16x16x32_bf16 v[4:7], v[20:23], v[8:11], v[84:87]
v_mfma_f32_16x16x32_bf16 v[88:91], v[12:15], v[12:15], v[88:91]
v_mfma_f32_16x16x32_bf16 v[0:3], v[24:27], v[12:15], v[0:3]
v_mfma_f32_16x16x32_bf16 v[4:7], v[28:31], v[12:15], v[4:7]
buffer_store_dword v127, off, s[4:7], s35 offset:132 sc1
s_mov_b32 vcc_lo, 0xcccccccc
s_mov_b32 vcc_hi, 0xcccccccc
s_branch main_kernel_c0_z
main_kernel_c0_z_h:
buffer_load_dwordx4 v[8:11], v116, s[4:7], s20 offen offset:0 sc1
buffer_load_dwordx4 v[12:15], v116, s[4:7], s20 offen offset:1024 sc1
s_sub_u32 s29, s29, 1
s_cbranch_scc1 main_kernel_end
v_add_u32 v127, 300, v127
s_waitcnt vmcnt(0)
s_branch main_kernel_c0_z_g
main_kernel_c0_sm_f:
s_waitcnt vmcnt(0) lgkmcnt(0)
buffer_load_dwordx4 v[8:11], v116, s[4:7], s20 offen offset:0 sc1
buffer_load_dwordx4 v[12:15], v116, s[4:7], s20 offen offset:1024 sc1
ds_read_b128 v[0:3], v116 offset:16384
ds_read_b128 v[4:7], v116 offset:17408
ds_read_b128 v[64:67], v116 offset:24576
ds_read_b128 v[68:71], v116 offset:28672
ds_read_b128 v[72:75], v116 offset:25600
ds_read_b128 v[76:79], v116 offset:29696
ds_read_b128 v[16:19], v116 offset:26624
ds_read_b128 v[20:23], v116 offset:30720
ds_read_b128 v[24:27], v116 offset:27648
ds_read_b128 v[28:31], v116 offset:31744
s_waitcnt vmcnt(0)
s_waitcnt lgkmcnt(0)
v_mfma_f32_16x16x32_bf16 v[80:83], v[64:67], v[0:3], 0
v_mfma_f32_16x16x32_bf16 v[84:87], v[68:71], v[0:3], 0
v_mfma_f32_16x16x32_bf16 v[92:95], v[0:3], v[0:3], 0
v_mfma_f32_16x16x32_bf16 v[80:83], v[72:75], v[4:7], v[80:83]
v_mfma_f32_16x16x32_bf16 v[84:87], v[76:79], v[4:7], v[84:87]
v_mfma_f32_16x16x32_bf16 v[92:95], v[4:7], v[4:7], v[92:95]
v_mfma_f32_16x16x32_bf16 v[0:3], v[16:19], v[8:11], v[80:83]
v_mfma_f32_16x16x32_bf16 v[4:7], v[20:23], v[8:11], v[84:87]
v_mfma_f32_16x16x32_bf16 v[88:91], v[8:11], v[8:11], v[92:95]
v_mfma_f32_16x16x32_bf16 v[0:3], v[24:27], v[12:15], v[0:3]
v_mfma_f32_16x16x32_bf16 v[4:7], v[28:31], v[12:15], v[4:7]
v_mfma_f32_16x16x32_bf16 v[88:91], v[12:15], v[12:15], v[88:91]
s_nop 7
v_mov_b32 v65, 0
v_max_f32 v126, v88, v89
v_mul_f32 v126, s30, v126
v_max3_f32 v126, v126, v0, v1
v_max3_f32 v126, v126, v2, v3
v_max3_f32 v126, v126, v4, v5
v_max3_f32 v126, v126, v6, v7
v_mov_b32 v127, v126
s_nop 1
v_permlane32_swap_b32 v126, v127
v_max_f32 v126, v126, v127
v_mov_b32 v127, v126
s_nop 1
v_permlane16_swap_b32 v126, v127
v_max_f32 v126, v126, v127
v_mul_f32 v127, 0x40faf233, v126
s_mov_b32 vcc_lo, 0xcccccccc
s_mov_b32 vcc_hi, 0xcccccccc
v_sub_f32 v0, v0, v126
v_sub_f32 v1, v1, v126
v_sub_f32 v2, v2, v126
v_sub_f32 v3, v3, v126
v_sub_f32 v4, v4, v126
v_sub_f32 v5, v5, v126
v_sub_f32 v6, v6, v126
v_sub_f32 v7, v7, v126
v_sub_f32 v88, v88, v127
v_sub_f32 v89, v89, v127
s_waitcnt lgkmcnt(0)
s_nop 0
v_mul_f32 v88, s30, v88
v_mul_f32 v89, s30, v89
v_exp_f32 v88, v88
v_exp_f32 v89, v89
v_cndmask_b32_dpp v0, v2, v0, vcc quad_perm:[2,3,2,3] row_mask:0xf bank_mask:0xf
v_cvt_pk_bf16_f32 v64, v88, v89
v_cndmask_b32_dpp v1, v3, v1, vcc quad_perm:[2,3,2,3] row_mask:0xf bank_mask:0xf
v_exp_f32 v0, v0
v_mfma_f32_16x16x16_bf16 v[16:19], v[100:101], v[64:65], 0
v_exp_f32 v1, v1
v_cndmask_b32_dpp v4, v6, v4, vcc quad_perm:[2,3,2,3] row_mask:0xf bank_mask:0xf
v_mfma_f32_16x16x16_bf16 v[8:11], v[124:125], v[64:65], 0
v_cndmask_b32_dpp v5, v7, v5, vcc quad_perm:[2,3,2,3] row_mask:0xf bank_mask:0xf
v_exp_f32 v4, v4
v_exp_f32 v5, v5
v_cvt_pk_bf16_f32 v92, v0, v1
v_cvt_pk_bf16_f32 v94, v4, v5
v_mov_b32 v80, 0
v_mov_b32_dpp v93, v92 quad_perm:[0,1,0,1] row_mask:0xf bank_mask:0xf
v_mov_b32_dpp v95, v94 quad_perm:[0,1,0,1] row_mask:0xf bank_mask:0xf
v_mov_b32 v81, 0
v_mov_b32 v82, 0
v_mfma_f32_16x16x32_bf16 v[16:19], v[100:103], v[92:95], v[16:19]
v_mov_b32 v83, 0
v_mov_b32 v84, 0
v_mfma_f32_16x16x32_bf16 v[8:11], v[96:99], v[92:95], v[8:11]
s_nop 1
v_mov_b32 v85, 0
v_mov_b32 v86, 0
v_mov_b32 v87, 0
v_rcp_f32 v126, v16
v_subrev_u32 v127, 0x21800000, v16
v_cmp_lt_u32 vcc, 0x3c000000, v127
v_pk_mul_f32 v[8:9], v[8:9], v[126:127] op_sel_hi:[1,0]
v_pk_mul_f32 v[10:11], v[10:11], v[126:127] op_sel_hi:[1,0]
s_and_b32 s32, vcc_lo, 0xcccc
v_cvt_pk_bf16_f32 v126, v8, v9
v_cvt_pk_bf16_f32 v127, v10, v11
s_branch main_kernel_c0_ost
main_kernel_c0_o0_f:
s_nop 0
buffer_load_dwordx4 v[0:3], v116, s[4:7], s23 offen sc1
s_xor_b32 s32, s23, 1024
buffer_load_dwordx4 v[4:7], v116, s[4:7], s32 offen sc1
s_sub_u32 s29, s29, 1
s_cbranch_scc1 main_kernel_end
s_waitcnt vmcnt(0)
v_max_u32 v126, v0, v2
v_cmp_eq_u32 vcc, -1, v126
s_cbranch_vccnz main_kernel_c0_o0_f
s_branch main_kernel_c0_o0
main_kernel_c0_o1_f:
s_nop 0
s_xor_b32 s32, s23, 1024
buffer_load_dwordx4 v[4:7], v116, s[4:7], s32 offen sc1
s_xor_b32 s32, s23, 2048
buffer_load_dwordx4 v[8:11], v116, s[4:7], s32 offen sc1
s_sub_u32 s29, s29, 1
s_cbranch_scc1 main_kernel_end
s_waitcnt vmcnt(0)
v_max_u32 v126, v4, v6
v_cmp_eq_u32 vcc, -1, v126
s_cbranch_vccnz main_kernel_c0_o1_f
s_branch main_kernel_c0_o1
main_kernel_c0_o2_f:
s_nop 0
s_xor_b32 s32, s23, 2048
buffer_load_dwordx4 v[8:11], v116, s[4:7], s32 offen sc1
s_xor_b32 s32, s23, 3072
buffer_load_dwordx4 v[12:15], v116, s[4:7], s32 offen sc1
s_sub_u32 s29, s29, 1
s_cbranch_scc1 main_kernel_end
s_waitcnt vmcnt(0)
v_max_u32 v126, v8, v10
v_cmp_eq_u32 vcc, -1, v126
s_cbranch_vccnz main_kernel_c0_o2_f
s_branch main_kernel_c0_o2
main_kernel_c0_o3_f:
s_nop 0
s_xor_b32 s32, s23, 3072
buffer_load_dwordx4 v[12:15], v116, s[4:7], s32 offen sc1
s_xor_b32 s32, s23, 4096
buffer_load_dwordx4 v[16:19], v116, s[4:7], s32 offen sc1
s_sub_u32 s29, s29, 1
s_cbranch_scc1 main_kernel_end
s_waitcnt vmcnt(0)
v_max_u32 v126, v12, v14
v_cmp_eq_u32 vcc, -1, v126
s_cbranch_vccnz main_kernel_c0_o3_f
s_branch main_kernel_c0_o3
main_kernel_c0_o4_f:
s_nop 0
s_xor_b32 s32, s23, 4096
buffer_load_dwordx4 v[16:19], v116, s[4:7], s32 offen sc1
s_xor_b32 s32, s23, 5120
buffer_load_dwordx4 v[20:23], v116, s[4:7], s32 offen sc1
s_sub_u32 s29, s29, 1
s_cbranch_scc1 main_kernel_end
s_waitcnt vmcnt(0)
v_max_u32 v126, v16, v18
v_cmp_eq_u32 vcc, -1, v126
s_cbranch_vccnz main_kernel_c0_o4_f
s_branch main_kernel_c0_o4
main_kernel_c0_o5_f:
s_nop 0
s_xor_b32 s32, s23, 5120
buffer_load_dwordx4 v[20:23], v116, s[4:7], s32 offen sc1
s_xor_b32 s32, s23, 6144
buffer_load_dwordx4 v[24:27], v116, s[4:7], s32 offen sc1
s_sub_u32 s29, s29, 1
s_cbranch_scc1 main_kernel_end
s_waitcnt vmcnt(0)
v_max_u32 v126, v20, v22
v_cmp_eq_u32 vcc, -1, v126
s_cbranch_vccnz main_kernel_c0_o5_f
s_branch main_kernel_c0_o5
main_kernel_c0_o6_f:
s_nop 0
s_xor_b32 s32, s23, 6144
buffer_load_dwordx4 v[24:27], v116, s[4:7], s32 offen sc1
s_xor_b32 s32, s23, 7168
buffer_load_dwordx4 v[28:31], v116, s[4:7], s32 offen sc1
s_sub_u32 s29, s29, 1
s_cbranch_scc1 main_kernel_end
s_waitcnt vmcnt(0)
v_max_u32 v126, v24, v26
v_cmp_eq_u32 vcc, -1, v126
s_cbranch_vccnz main_kernel_c0_o6_f
s_branch main_kernel_c0_o6
main_kernel_c0_o7_f:
s_nop 0
s_xor_b32 s32, s23, 7168
buffer_load_dwordx4 v[28:31], v116, s[4:7], s32 offen sc1
s_sub_u32 s29, s29, 1
s_cbranch_scc1 main_kernel_end
s_waitcnt vmcnt(0)
v_max_u32 v126, v28, v30
v_cmp_eq_u32 vcc, -1, v126
s_cbranch_vccnz main_kernel_c0_o7_f
s_branch main_kernel_c0_o7
.p2align 6
main_kernel_c1_top:
s_barrier
buffer_load_dwordx4 v[0:3], v116, s[4:7], s18 offen sc1
s_add_u32 s20, s20, 0x40000
s_bitset0_b32 s20, 20
s_add_u32 s21, s21, 0x40000
s_bitset0_b32 s21, 20
s_add_u32 s22, s22, 0x40000
s_bitset0_b32 s22, 20
s_add_u32 s23, s23, 0x40000
s_bitset0_b32 s23, 20
s_xor_b32 s32, s18, 1024
buffer_load_dwordx4 v[16:19], v116, s[4:7], s32 offen sc1
s_add_u32 s3, s3, 0x40000
s_bitset0_b32 s3, 20
s_add_u32 s17, s17, 1
s_add_u32 s25, s52, s59
s_nop 3
buffer_load_dwordx4 v[64:67], v116, s[4:7], s19 offen sc1
v_mov_b32 v80, 0
v_mov_b32 v81, 0
s_nop 3
s_xor_b32 s32, s19, 1024
buffer_load_dwordx4 v[68:71], v116, s[4:7], s32 offen sc1
v_mov_b32 v82, 0
v_mov_b32 v83, 0
s_nop 3
s_xor_b32 s32, s18, 2048
buffer_load_dwordx4 v[32:35], v116, s[4:7], s32 offen sc1
v_mov_b32 v84, 0
v_mov_b32 v85, 0
s_nop 3
s_xor_b32 s32, s19, 2048
buffer_load_dwordx4 v[72:75], v116, s[4:7], s32 offen sc1
v_mov_b32 v86, 0
v_mov_b32 v87, 0
s_nop 3
s_xor_b32 s32, s18, 3072
buffer_load_dwordx4 v[48:51], v116, s[4:7], s32 offen sc1
v_mov_b32 v88, 0
v_mov_b32 v89, 0
s_nop 3
s_xor_b32 s32, s19, 3072
buffer_load_dwordx4 v[76:79], v116, s[4:7], s32 offen sc1
v_mov_b32 v90, 0
v_mov_b32 v91, 0
s_waitcnt vmcnt(5)
v_pk_add_f16 v0, v0, v64
v_pk_add_f16 v1, v1, v65
v_pk_add_f16 v2, v2, v66
v_pk_add_f16 v3, v3, v67
v_cmp_u_f16 vcc, v0, v2
s_cbranch_vccnz main_kernel_c1_m0_f
main_kernel_c1_m0:
v_smfmac_f32_16x16x64_f16 v[80:83], v[0:3], a[0:7], v112
ds_write_b128 v116, v[0:3] offset:1024
v_smfmac_f32_16x16x64_f16 v[84:87], v[0:3], a[128:135], v112
buffer_load_dword v123, v121, s[4:7], 0 offen sc1
s_waitcnt vmcnt(5)
v_pk_add_f16 v16, v16, v68
v_pk_add_f16 v17, v17, v69
v_pk_add_f16 v18, v18, v70
v_pk_add_f16 v19, v19, v71
v_cmp_u_f16 vcc, v16, v18
s_waitcnt lgkmcnt(0)
s_barrier
ds_read_b128 v[4:7], v116 offset:0
ds_write_b128 v116, v[16:19] offset:5120
s_cbranch_vccnz main_kernel_c1_m1_f
main_kernel_c1_m1:
v_smfmac_f32_16x16x64_f16 v[80:83], v[16:19], a[8:15], v112
v_smfmac_f32_16x16x64_f16 v[84:87], v[16:19], a[136:143], v112
ds_read_b128 v[8:11], v116 offset:3072
v_smfmac_f32_16x16x64_f16 v[88:91], v[0:3], v[128:135], v112
ds_read_b128 v[12:15], v116 offset:2048
s_waitcnt lgkmcnt(3)
v_smfmac_f32_16x16x64_f16 v[80:83], v[4:7], a[32:39], v112
v_smfmac_f32_16x16x64_f16 v[84:87], v[4:7], a[160:167], v112
v_smfmac_f32_16x16x64_f16 v[88:91], v[4:7], v[136:143], v112
s_waitcnt lgkmcnt(2)
s_barrier
s_waitcnt lgkmcnt(1)
v_smfmac_f32_16x16x64_f16 v[80:83], v[8:11], a[64:71], v112
s_waitcnt vmcnt(3)
ds_read_b128 v[20:23], v116 offset:4096
v_pk_add_f16 v32, v32, v72
v_smfmac_f32_16x16x64_f16 v[84:87], v[8:11], a[192:199], v112
ds_read_b128 v[24:27], v116 offset:7168
s_waitcnt lgkmcnt(2)
v_pk_add_f16 v33, v33, v73
v_smfmac_f32_16x16x64_f16 v[80:83], v[12:15], a[96:103], v112
ds_read_b128 v[28:31], v116 offset:6144
v_pk_add_f16 v34, v34, v74
v_smfmac_f32_16x16x64_f16 v[84:87], v[12:15], a[224:231], v112
s_waitcnt lgkmcnt(2)
v_pk_add_f16 v35, v35, v75
v_smfmac_f32_16x16x64_f16 v[80:83], v[20:23], a[40:47], v112
ds_write_b128 v116, v[32:35] offset:9216
v_cmp_u_f16 vcc, v32, v34
v_smfmac_f32_16x16x64_f16 v[84:87], v[20:23], a[168:175], v112
s_cbranch_vccnz main_kernel_c1_m2_f
main_kernel_c1_m2:
v_smfmac_f32_16x16x64_f16 v[80:83], v[32:35], a[16:23], v112
buffer_load_dwordx4 v[96:99], v116, s[4:7], s28 offen sc1
v_smfmac_f32_16x16x64_f16 v[84:87], v[32:35], a[144:151], v112
s_add_u32 s28, s28, 0x40000
s_waitcnt lgkmcnt(2)
v_smfmac_f32_16x16x64_f16 v[80:83], v[24:27], a[72:79], v112
s_waitcnt vmcnt(2)
v_pk_add_f16 v48, v48, v76
v_smfmac_f32_16x16x64_f16 v[84:87], v[24:27], a[200:207], v112
s_waitcnt lgkmcnt(0)
s_barrier
ds_read_b128 v[36:39], v116 offset:8192
v_pk_add_f16 v49, v49, v77
v_smfmac_f32_16x16x64_f16 v[80:83], v[28:31], a[104:111], v112
ds_read_b128 v[40:43], v116 offset:11264
v_pk_add_f16 v50, v50, v78
v_smfmac_f32_16x16x64_f16 v[84:87], v[28:31], a[232:239], v112
ds_read_b128 v[44:47], v116 offset:10240
v_pk_add_f16 v51, v51, v79
v_smfmac_f32_16x16x64_f16 v[88:91], v[8:11], v[144:151], v112
ds_write_b128 v116, v[48:51] offset:13312
s_waitcnt lgkmcnt(3)
v_cmp_u_f16 vcc, v48, v50
v_smfmac_f32_16x16x64_f16 v[80:83], v[36:39], a[48:55], v112
s_cbranch_vccnz main_kernel_c1_m3_f
main_kernel_c1_m3:
v_smfmac_f32_16x16x64_f16 v[80:83], v[48:51], a[24:31], v112
v_smfmac_f32_16x16x64_f16 v[84:87], v[48:51], a[152:159], v112
v_smfmac_f32_16x16x64_f16 v[84:87], v[36:39], a[176:183], v112
s_waitcnt lgkmcnt(2)
v_smfmac_f32_16x16x64_f16 v[80:83], v[40:43], a[80:87], v112
s_waitcnt lgkmcnt(0)
s_barrier
ds_read_b128 v[52:55], v116 offset:12288
v_smfmac_f32_16x16x64_f16 v[84:87], v[40:43], a[208:215], v112
s_add_u32 s19, s52, s54
ds_read_b128 v[56:59], v116 offset:15360
v_smfmac_f32_16x16x64_f16 v[80:83], v[44:47], a[112:119], v112
s_add_u32 s18, s18, 0x40000
ds_read_b128 v[60:63], v116 offset:14336
v_smfmac_f32_16x16x64_f16 v[84:87], v[44:47], a[240:247], v112
s_bitset0_b32 s18, 20
s_waitcnt lgkmcnt(2)
v_smfmac_f32_16x16x64_f16 v[80:83], v[52:55], a[56:63], v112
s_cmp_eq_u32 s17, 30
s_cselect_b32 s32, s53, 0x10000
s_waitcnt lgkmcnt(1)
v_smfmac_f32_16x16x64_f16 v[80:83], v[56:59], a[88:95], v112
s_add_u32 s52, s52, s32
s_waitcnt lgkmcnt(0)
v_smfmac_f32_16x16x64_f16 v[80:83], v[60:63], a[120:127], v112
s_sub_u32 s24, 0x20000, s32
ds_read_b128 v[64:67], v116 offset:24576
v_smfmac_f32_16x16x64_f16 v[84:87], v[52:55], a[184:191], v112
s_add_u32 s55, s55, s24
ds_read_b128 v[68:71], v116 offset:28672
v_smfmac_f32_16x16x64_f16 v[84:87], v[56:59], a[216:223], v112
ds_read_b128 v[72:75], v116 offset:25600
s_nop 0
v_cvt_pk_bf16_f32 v92, v80, v81
v_smfmac_f32_16x16x64_f16 v[84:87], v[60:63], a[248:255], v112
ds_read_b128 v[76:79], v116 offset:29696
s_nop 0
v_cvt_pk_bf16_f32 v93, v82, v83
v_smfmac_f32_16x16x64_f16 v[88:91], v[12:15], v[152:159], v112
s_nop 3
v_cvt_pk_bf16_f32 v94, v84, v85
v_cvt_pk_bf16_f32 v95, v86, v87
s_mov_b32 vcc_lo, 0xcccccccc
s_mov_b32 vcc_hi, 0xcccccccc
v_mfma_f32_16x16x32_bf16 v[84:87], v[92:95], v[104:107], 0
v_add_u32 v121, v121, v122
v_writelane_b32 v121, s55, 39
s_nop 0
v_smfmac_f32_16x16x64_f16 v[88:91], v[16:19], v[160:167], v112
s_nop 2
s_cmp_eq_u32 s17, 63
v_cvt_pk_bf16_f32 v114, v84, v85
v_cvt_pk_bf16_f32 v115, v86, v87
buffer_store_dwordx2 v[114:115], v117, s[4:7], s21 offen
s_cbranch_scc1 main_kernel_c1_last
ds_write_b64 v117, v[114:115] offset:16896
v_smfmac_f32_16x16x64_f16 v[88:91], v[20:23], v[168:175], v112
v_smfmac_f32_16x16x64_f16 v[88:91], v[24:27], v[176:183], v112
v_smfmac_f32_16x16x64_f16 v[88:91], v[28:31], v[184:191], v112
v_smfmac_f32_16x16x64_f16 v[88:91], v[32:35], v[192:199], v112
s_waitcnt lgkmcnt(0)
s_barrier
ds_read_b128 v[0:3], v116 offset:16384
v_smfmac_f32_16x16x64_f16 v[88:91], v[36:39], v[200:207], v112
ds_read_b128 v[4:7], v116 offset:17408
v_smfmac_f32_16x16x64_f16 v[88:91], v[40:43], v[208:215], v112
ds_read_b128 v[16:19], v116 offset:26624
v_smfmac_f32_16x16x64_f16 v[88:91], v[44:47], v[216:223], v112
ds_read_b128 v[20:23], v116 offset:30720
v_smfmac_f32_16x16x64_f16 v[88:91], v[48:51], v[224:231], v112
ds_read_b128 v[24:27], v116 offset:27648
v_smfmac_f32_16x16x64_f16 v[88:91], v[52:55], v[232:239], v112
ds_read_b128 v[28:31], v116 offset:31744
v_smfmac_f32_16x16x64_f16 v[88:91], v[56:59], v[240:247], v112
v_smfmac_f32_16x16x64_f16 v[88:91], v[60:63], v[248:255], v112
s_waitcnt lgkmcnt(5)
v_mfma_f32_16x16x32_bf16 v[80:83], v[64:67], v[0:3], 0
v_mfma_f32_16x16x32_bf16 v[84:87], v[68:71], v[0:3], 0
buffer_load_dwordx4 v[8:11], v116, s[4:7], s20 offen offset:0 sc1
v_mfma_f32_16x16x32_bf16 v[92:95], v[0:3], v[0:3], 0
buffer_load_dwordx4 v[12:15], v116, s[4:7], s20 offen offset:1024 sc1
v_permlane32_swap_b32 v88, v90
s_waitcnt lgkmcnt(4)
v_mfma_f32_16x16x32_bf16 v[80:83], v[72:75], v[4:7], v[80:83]
v_permlane32_swap_b32 v89, v91
v_mfma_f32_16x16x32_bf16 v[84:87], v[76:79], v[4:7], v[84:87]
v_pk_add_f32 v[88:89], v[88:89], v[90:91]
v_mfma_f32_16x16x32_bf16 v[92:95], v[4:7], v[4:7], v[92:95]
v_cvt_pk_bf16_f32 v124, v88, v89
v_mov_b32 v65, 0
s_waitcnt lgkmcnt(0)
s_waitcnt vmcnt(1)
v_mfma_f32_16x16x32_bf16 v[88:91], v[8:11], v[8:11], v[92:95]
v_mfma_f32_16x16x32_bf16 v[0:3], v[16:19], v[8:11], v[80:83]
v_cmp_u_f32 s[0:1], v8, v10
v_mfma_f32_16x16x32_bf16 v[4:7], v[20:23], v[8:11], v[84:87]
s_waitcnt vmcnt(0)
v_mfma_f32_16x16x32_bf16 v[88:91], v[12:15], v[12:15], v[88:91]
v_mfma_f32_16x16x32_bf16 v[0:3], v[24:27], v[12:15], v[0:3]
v_cmp_u_f32 s[32:33], v12, v14
v_mfma_f32_16x16x32_bf16 v[4:7], v[28:31], v[12:15], v[4:7]
s_or_b64 s[0:1], s[0:1], s[32:33]
s_cbranch_scc1 main_kernel_c1_z_f
main_kernel_c1_z:
v_mul_f32 v88, s30, v88
v_mul_f32 v89, s30, v89
v_exp_f32 v88, v88
v_exp_f32 v89, v89
v_cndmask_b32_dpp v0, v2, v0, vcc quad_perm:[2,3,2,3] row_mask:0xf bank_mask:0xf
v_cvt_pk_bf16_f32 v64, v88, v89
v_cndmask_b32_dpp v1, v3, v1, vcc quad_perm:[2,3,2,3] row_mask:0xf bank_mask:0xf
v_exp_f32 v0, v0
v_mfma_f32_16x16x16_bf16 v[16:19], v[100:101], v[64:65], 0
v_exp_f32 v1, v1
v_cndmask_b32_dpp v4, v6, v4, vcc quad_perm:[2,3,2,3] row_mask:0xf bank_mask:0xf
v_mfma_f32_16x16x16_bf16 v[8:11], v[124:125], v[64:65], 0
v_cndmask_b32_dpp v5, v7, v5, vcc quad_perm:[2,3,2,3] row_mask:0xf bank_mask:0xf
v_exp_f32 v4, v4
v_exp_f32 v5, v5
v_cvt_pk_bf16_f32 v92, v0, v1
v_cvt_pk_bf16_f32 v94, v4, v5
v_mov_b32 v80, 0
v_mov_b32_dpp v93, v92 quad_perm:[0,1,0,1] row_mask:0xf bank_mask:0xf
v_mov_b32_dpp v95, v94 quad_perm:[0,1,0,1] row_mask:0xf bank_mask:0xf
v_mov_b32 v81, 0
v_mov_b32 v82, 0
v_mfma_f32_16x16x32_bf16 v[16:19], v[100:103], v[92:95], v[16:19]
v_mov_b32 v83, 0
v_mov_b32 v84, 0
v_mfma_f32_16x16x32_bf16 v[8:11], v[96:99], v[92:95], v[8:11]
s_nop 1
v_mov_b32 v85, 0
v_mov_b32 v86, 0
v_mov_b32 v87, 0
v_rcp_f32 v126, v16
v_subrev_u32 v127, 0x21800000, v16
v_cmp_lt_u32 vcc, 0x3c000000, v127
v_pk_mul_f32 v[8:9], v[8:9], v[126:127] op_sel_hi:[1,0]
v_pk_mul_f32 v[10:11], v[10:11], v[126:127] op_sel_hi:[1,0]
s_and_b32 s32, vcc_lo, 0xcccc
v_cvt_pk_bf16_f32 v126, v8, v9
v_cvt_pk_bf16_f32 v127, v10, v11
s_cbranch_scc1 main_kernel_c1_sm_f
main_kernel_c1_ost:
buffer_store_dwordx2 v[126:127], v118, s[4:7], s22 offen
v_cmp_eq_u32 s[0:1], 0, v123
v_mov_b32 v24, -1
v_mov_b32 v25, -1
v_mov_b32 v26, -1
v_mov_b32 v27, -1
ds_read_b128 v[32:35], v113 offset:0
ds_read_b128 v[36:39], v113 offset:1024
ds_read_b128 v[40:43], v113 offset:2048
ds_read_b128 v[44:47], v113 offset:3072
ds_read_b128 v[48:51], v113 offset:4096
ds_read_b128 v[52:55], v113 offset:5120
s_and_b32 s10, s1, 0x3f00
buffer_store_dwordx4 v[24:27], v116, s[4:7], s3 offen
buffer_store_dwordx4 v[24:27], v116, s[4:7], s46 offen
s_barrier
buffer_load_dwordx4 v[0:3], v116, s[4:7], s23 offen sc1
ds_read_b128 v[56:59], v113 offset:6144
ds_read_b128 v[60:63], v113 offset:7168
s_add_u32 s46, s46, 0x40000
s_bitset0_b32 s46, 20
s_add_u32 s37, s37, 65536
s_add_u32 s26, s26, 65536
s_xor_b32 s32, s23, 1024
buffer_load_dwordx4 v[4:7], v116, s[4:7], s32 offen sc1
ds_read_b128 v[64:67], v113 offset:8192
ds_read_b128 v[68:71], v113 offset:9216
s_nop 3
s_xor_b32 s32, s23, 2048
buffer_load_dwordx4 v[8:11], v116, s[4:7], s32 offen sc1
ds_read_b128 v[72:75], v113 offset:10240
ds_read_b128 v[76:79], v113 offset:11264
s_nop 3
s_xor_b32 s32, s23, 3072
buffer_load_dwordx4 v[12:15], v116, s[4:7], s32 offen sc1
ds_read_b128 v[88:91], v113 offset:12288
ds_read_b128 v[92:95], v113 offset:13312
s_nop 3
s_xor_b32 s32, s23, 4096
buffer_load_dwordx4 v[16:19], v116, s[4:7], s32 offen sc1
s_nop 7
s_xor_b32 s32, s23, 5120
buffer_load_dwordx4 v[20:23], v116, s[4:7], s32 offen sc1
s_nop 7
s_xor_b32 s32, s23, 6144
buffer_load_dwordx4 v[24:27], v116, s[4:7], s32 offen sc1
s_nop 7
s_xor_b32 s32, s23, 7168
buffer_load_dwordx4 v[28:31], v116, s[4:7], s32 offen sc1
s_waitcnt lgkmcnt(12)
s_waitcnt vmcnt(7)
v_cmp_u_f32 vcc, v0, v2
s_cbranch_vccnz main_kernel_c1_o0_f
main_kernel_c1_o0:
v_smfmac_f32_16x16x64_bf16 v[80:83], v[0:3], v[32:39], v112
ds_read_b128 v[32:35], v113 offset:14336
ds_read_b128 v[36:39], v113 offset:15360
s_waitcnt lgkmcnt(12)
s_waitcnt vmcnt(6)
v_cmp_u_f32 vcc, v4, v6
v_smfmac_f32_16x16x64_bf16 v[84:87], v[0:3], v[40:47], v112
ds_read_b128 v[40:43], v113 offset:16384
ds_read_b128 v[44:47], v113 offset:17408
buffer_store_dwordx2 v[114:115], v119, s[4:7], s37 offen sc1
s_cbranch_vccnz main_kernel_c1_o1_f
main_kernel_c1_o1:
s_waitcnt lgkmcnt(12)
v_smfmac_f32_16x16x64_bf16 v[80:83], v[4:7], v[48:55], v112
ds_read_b128 v[48:51], v113 offset:18432
ds_read_b128 v[52:55], v113 offset:19456
s_waitcnt lgkmcnt(12)
s_waitcnt vmcnt(6)
v_cmp_u_f32 vcc, v8, v10
v_smfmac_f32_16x16x64_bf16 v[84:87], v[4:7], v[56:63], v112
ds_read_b128 v[56:59], v113 offset:20480
ds_read_b128 v[60:63], v113 offset:21504
buffer_store_dword v124, v120, s[4:7], s26 offen sc1
s_cbranch_vccnz main_kernel_c1_o2_f
main_kernel_c1_o2:
s_waitcnt lgkmcnt(12)
v_smfmac_f32_16x16x64_bf16 v[80:83], v[8:11], v[64:71], v112
ds_read_b128 v[64:67], v113 offset:22528
ds_read_b128 v[68:71], v113 offset:23552
s_waitcnt lgkmcnt(12)
s_waitcnt vmcnt(6)
v_cmp_u_f32 vcc, v12, v14
v_smfmac_f32_16x16x64_bf16 v[84:87], v[8:11], v[72:79], v112
ds_read_b128 v[72:75], v113 offset:24576
ds_read_b128 v[76:79], v113 offset:25600
s_cbranch_vccnz main_kernel_c1_o3_f
main_kernel_c1_o3:
s_waitcnt lgkmcnt(12)
v_smfmac_f32_16x16x64_bf16 v[80:83], v[12:15], v[88:95], v112
ds_read_b128 v[88:91], v113 offset:26624
ds_read_b128 v[92:95], v113 offset:27648
s_waitcnt lgkmcnt(12)
s_waitcnt vmcnt(5)
v_cmp_u_f32 vcc, v16, v18
v_smfmac_f32_16x16x64_bf16 v[84:87], v[12:15], v[32:39], v112
ds_read_b128 v[32:35], v113 offset:28672
ds_read_b128 v[36:39], v113 offset:29696
s_cbranch_vccnz main_kernel_c1_o4_f
main_kernel_c1_o4:
s_waitcnt lgkmcnt(12)
v_smfmac_f32_16x16x64_bf16 v[80:83], v[16:19], v[40:47], v112
ds_read_b128 v[40:43], v113 offset:30720
ds_read_b128 v[44:47], v113 offset:31744
s_waitcnt lgkmcnt(12)
s_waitcnt vmcnt(4)
v_cmp_u_f32 vcc, v20, v22
v_smfmac_f32_16x16x64_bf16 v[84:87], v[16:19], v[48:55], v112
s_cbranch_vccnz main_kernel_c1_o5_f
main_kernel_c1_o5:
s_waitcnt lgkmcnt(10)
v_smfmac_f32_16x16x64_bf16 v[80:83], v[20:23], v[56:63], v112
s_waitcnt lgkmcnt(8)
s_waitcnt vmcnt(3)
v_cmp_u_f32 vcc, v24, v26
v_smfmac_f32_16x16x64_bf16 v[84:87], v[20:23], v[64:71], v112
s_cbranch_vccnz main_kernel_c1_o6_f
main_kernel_c1_o6:
s_waitcnt lgkmcnt(6)
v_smfmac_f32_16x16x64_bf16 v[80:83], v[24:27], v[72:79], v112
s_waitcnt lgkmcnt(4)
v_smfmac_f32_16x16x64_bf16 v[84:87], v[24:27], v[88:95], v112
s_waitcnt lgkmcnt(2)
s_waitcnt vmcnt(2)
v_cmp_u_f32 vcc, v28, v30
s_cbranch_vccnz main_kernel_c1_o7_f
main_kernel_c1_o7:
v_smfmac_f32_16x16x64_bf16 v[80:83], v[28:31], v[32:39], v112
s_waitcnt lgkmcnt(0)
v_smfmac_f32_16x16x64_bf16 v[84:87], v[28:31], v[40:47], v112
s_nop 4
v_cvt_pk_bf16_f32 v80, v80, v81
v_cvt_pk_bf16_f32 v81, v82, v83
ds_write_b64 v116, v[80:81] offset:20488
v_cvt_pk_bf16_f32 v82, v84, v85
v_cvt_pk_bf16_f32 v83, v86, v87
ds_write_b64 v116, v[82:83] offset:22536
s_waitcnt lgkmcnt(0)
s_barrier
ds_read_b128 v[72:75], v116 offset:22528
ds_read_b128 v[76:79], v116 offset:23552
s_mov_b32 m0, 26624
s_cmp_lg_u32 s10, 0
s_waitcnt lgkmcnt(1)
v_mfma_f32_16x16x32_bf16 v[64:67], v[72:75], v[108:111], 0
s_waitcnt lgkmcnt(0)
v_mfma_f32_16x16x32_bf16 v[64:67], v[76:79], v[108:111], v[64:67]
s_nop 7
v_cvt_pk_f16_f32 v68, v64, v65
v_cvt_pk_f16_f32 v69, v66, v67
buffer_store_dwordx2 v[68:69], v125, s[4:7], s25 offen sc1
s_cbranch_scc1 main_kernel_c1_kvw
main_kernel_c1_kvok:
s_nop 3
buffer_load_dwordx4 v116, s[4:7], s27 offen sc1 lds
buffer_load_dwordx4 v116, s[4:7], s27 offen offset:1024 sc1 lds
s_mov_b32 m0, 30720
s_xor_b32 s32, s27, 131072
buffer_load_dwordx4 v116, s[4:7], s32 offen offset:0 sc1 lds
s_add_u32 s27, s27, 0x40000
s_branch main_kernel_c1_top
main_kernel_c1_kvw:
s_mov_b32 exec_lo, 0
s_mov_b32 exec_hi, 0x3f00
v_subrev_u32 v127, 128, v121
main_kernel_c1_kvp:
buffer_load_dword v126, v127, s[4:7], 0 offen sc1
s_waitcnt vmcnt(0)
v_cmp_eq_u32 vcc, 0, v126
s_cbranch_vccz main_kernel_c1_kvp_ok
s_sleep 2
s_sub_u32 s29, s29, 1
s_cbranch_scc0 main_kernel_c1_kvp
s_branch main_kernel_end
main_kernel_c1_kvp_ok:
s_mov_b64 exec, -1
s_branch main_kernel_c1_kvok
main_kernel_c1_last:
s_add_u32 s37, s37, 65536
s_add_u32 s26, s26, 65536
buffer_store_dwordx2 v[114:115], v119, s[4:7], s37 offen sc1
v_smfmac_f32_16x16x64_f16 v[88:91], v[20:23], v[168:175], v112
v_smfmac_f32_16x16x64_f16 v[88:91], v[24:27], v[176:183], v112
v_smfmac_f32_16x16x64_f16 v[88:91], v[28:31], v[184:191], v112
v_smfmac_f32_16x16x64_f16 v[88:91], v[32:35], v[192:199], v112
v_smfmac_f32_16x16x64_f16 v[88:91], v[36:39], v[200:207], v112
v_smfmac_f32_16x16x64_f16 v[88:91], v[40:43], v[208:215], v112
v_smfmac_f32_16x16x64_f16 v[88:91], v[44:47], v[216:223], v112
v_smfmac_f32_16x16x64_f16 v[88:91], v[48:51], v[224:231], v112
v_smfmac_f32_16x16x64_f16 v[88:91], v[52:55], v[232:239], v112
v_smfmac_f32_16x16x64_f16 v[88:91], v[56:59], v[240:247], v112
v_smfmac_f32_16x16x64_f16 v[88:91], v[60:63], v[248:255], v112
s_nop 7
v_permlane32_swap_b32 v88, v90
s_nop 1
v_permlane32_swap_b32 v89, v91
s_nop 1
v_pk_add_f32 v[88:89], v[88:89], v[90:91]
s_nop 1
v_cvt_pk_bf16_f32 v124, v88, v89
s_nop 1
buffer_store_dword v124, v120, s[4:7], s26 offen sc1
s_branch main_kernel_end
main_kernel_c1_m0_f:
s_waitcnt lgkmcnt(0)
buffer_load_dwordx4 v[0:3], v116, s[4:7], s18 offen sc1
buffer_load_dwordx4 v[64:67], v116, s[4:7], s19 offen sc1
s_xor_b32 s32, s18, 1024
buffer_load_dwordx4 v[16:19], v116, s[4:7], s32 offen sc1
s_xor_b32 s32, s19, 1024
buffer_load_dwordx4 v[68:71], v116, s[4:7], s32 offen sc1
s_xor_b32 s32, s18, 2048
buffer_load_dwordx4 v[32:35], v116, s[4:7], s32 offen sc1
s_xor_b32 s32, s19, 2048
buffer_load_dwordx4 v[72:75], v116, s[4:7], s32 offen sc1
s_xor_b32 s32, s18, 3072
buffer_load_dwordx4 v[48:51], v116, s[4:7], s32 offen sc1
s_xor_b32 s32, s19, 3072
buffer_load_dwordx4 v[76:79], v116, s[4:7], s32 offen sc1
s_sub_u32 s29, s29, 1
s_cbranch_scc1 main_kernel_end
s_waitcnt vmcnt(0)
v_max_u32 v126, v0, v2
v_max3_u32 v126, v126, v64, v66
v_cmp_eq_u32 vcc, -1, v126
s_cbranch_vccnz main_kernel_c1_m0_f
v_pk_add_f16 v0, v0, v64
v_pk_add_f16 v1, v1, v65
v_pk_add_f16 v2, v2, v66
v_pk_add_f16 v3, v3, v67
s_nop 0
s_branch main_kernel_c1_m0
main_kernel_c1_m1_f:
s_waitcnt lgkmcnt(0)
s_xor_b32 s32, s18, 1024
buffer_load_dwordx4 v[16:19], v116, s[4:7], s32 offen sc1
s_xor_b32 s32, s19, 1024
buffer_load_dwordx4 v[68:71], v116, s[4:7], s32 offen sc1
s_xor_b32 s32, s18, 2048
buffer_load_dwordx4 v[32:35], v116, s[4:7], s32 offen sc1
s_xor_b32 s32, s19, 2048
buffer_load_dwordx4 v[72:75], v116, s[4:7], s32 offen sc1
s_xor_b32 s32, s18, 3072
buffer_load_dwordx4 v[48:51], v116, s[4:7], s32 offen sc1
s_xor_b32 s32, s19, 3072
buffer_load_dwordx4 v[76:79], v116, s[4:7], s32 offen sc1
s_sub_u32 s29, s29, 1
s_cbranch_scc1 main_kernel_end
s_waitcnt vmcnt(0)
v_max_u32 v126, v16, v18
v_max3_u32 v126, v126, v68, v70
v_cmp_eq_u32 vcc, -1, v126
s_cbranch_vccnz main_kernel_c1_m1_f
v_pk_add_f16 v16, v16, v68
v_pk_add_f16 v17, v17, v69
v_pk_add_f16 v18, v18, v70
v_pk_add_f16 v19, v19, v71
ds_write_b128 v116, v[16:19] offset:5120
s_branch main_kernel_c1_m1
main_kernel_c1_m2_f:
s_waitcnt lgkmcnt(0)
s_xor_b32 s32, s18, 2048
buffer_load_dwordx4 v[32:35], v116, s[4:7], s32 offen sc1
s_xor_b32 s32, s19, 2048
buffer_load_dwordx4 v[72:75], v116, s[4:7], s32 offen sc1
s_xor_b32 s32, s18, 3072
buffer_load_dwordx4 v[48:51], v116, s[4:7], s32 offen sc1
s_xor_b32 s32, s19, 3072
buffer_load_dwordx4 v[76:79], v116, s[4:7], s32 offen sc1
s_sub_u32 s29, s29, 1
s_cbranch_scc1 main_kernel_end
s_waitcnt vmcnt(0)
v_max_u32 v126, v32, v34
v_max3_u32 v126, v126, v72, v74
v_cmp_eq_u32 vcc, -1, v126
s_cbranch_vccnz main_kernel_c1_m2_f
v_pk_add_f16 v32, v32, v72
v_pk_add_f16 v33, v33, v73
v_pk_add_f16 v34, v34, v74
v_pk_add_f16 v35, v35, v75
ds_write_b128 v116, v[32:35] offset:9216
s_branch main_kernel_c1_m2
main_kernel_c1_m3_f:
s_waitcnt lgkmcnt(0)
s_xor_b32 s32, s18, 3072
buffer_load_dwordx4 v[48:51], v116, s[4:7], s32 offen sc1
s_xor_b32 s32, s19, 3072
buffer_load_dwordx4 v[76:79], v116, s[4:7], s32 offen sc1
s_sub_u32 s29, s29, 1
s_cbranch_scc1 main_kernel_end
s_waitcnt vmcnt(0)
v_max_u32 v126, v48, v50
v_max3_u32 v126, v126, v76, v78
v_cmp_eq_u32 vcc, -1, v126
s_cbranch_vccnz main_kernel_c1_m3_f
v_pk_add_f16 v48, v48, v76
v_pk_add_f16 v49, v49, v77
v_pk_add_f16 v50, v50, v78
v_pk_add_f16 v51, v51, v79
ds_write_b128 v116, v[48:51] offset:13312
s_branch main_kernel_c1_m3
main_kernel_c1_z_f:
buffer_load_dwordx4 v[8:11], v116, s[4:7], s20 offen offset:0 sc1
buffer_load_dwordx4 v[12:15], v116, s[4:7], s20 offen offset:1024 sc1
s_memtime s[32:33]
ds_read_b32 v126, v116 offset:18432
s_sub_u32 s34, s19, s54
s_xor_b32 s34, s34, 0x2000
s_lshl_b32 s35, s12, 15
s_add_u32 s34, s34, s35
s_lshl_b32 s35, s13, 8
s_add_u32 s35, s35, s34
s_add_u32 s34, s34, 0x4000
s_waitcnt lgkmcnt(0)
s_sub_u32 s32, s32, 450
v_sub_u32 v127, s32, v126
buffer_store_dword v127, off, s[4:7], s34
s_sub_u32 s29, s29, 1
s_cbranch_scc1 main_kernel_end
s_waitcnt vmcnt(1)
main_kernel_c1_z_g:
v_max_u32 v126, v8, v10
v_max3_u32 v126, v126, v12, v14
v_cmp_eq_u32 vcc, -1, v126
s_cbranch_vccnz main_kernel_c1_z_h
v_mfma_f32_16x16x32_bf16 v[88:91], v[8:11], v[8:11], v[92:95]
v_mfma_f32_16x16x32_bf16 v[0:3], v[16:19], v[8:11], v[80:83]
v_mfma_f32_16x16x32_bf16 v[4:7], v[20:23], v[8:11], v[84:87]
v_mfma_f32_16x16x32_bf16 v[88:91], v[12:15], v[12:15], v[88:91]
v_mfma_f32_16x16x32_bf16 v[0:3], v[24:27], v[12:15], v[0:3]
v_mfma_f32_16x16x32_bf16 v[4:7], v[28:31], v[12:15], v[4:7]
buffer_store_dword v127, off, s[4:7], s35 offset:132 sc1
s_mov_b32 vcc_lo, 0xcccccccc
s_mov_b32 vcc_hi, 0xcccccccc
s_branch main_kernel_c1_z
main_kernel_c1_z_h:
buffer_load_dwordx4 v[8:11], v116, s[4:7], s20 offen offset:0 sc1
buffer_load_dwordx4 v[12:15], v116, s[4:7], s20 offen offset:1024 sc1
s_sub_u32 s29, s29, 1
s_cbranch_scc1 main_kernel_end
v_add_u32 v127, 300, v127
s_waitcnt vmcnt(0)
s_branch main_kernel_c1_z_g
main_kernel_c1_sm_f:
s_waitcnt vmcnt(0) lgkmcnt(0)
buffer_load_dwordx4 v[8:11], v116, s[4:7], s20 offen offset:0 sc1
buffer_load_dwordx4 v[12:15], v116, s[4:7], s20 offen offset:1024 sc1
ds_read_b128 v[0:3], v116 offset:16384
ds_read_b128 v[4:7], v116 offset:17408
ds_read_b128 v[64:67], v116 offset:24576
ds_read_b128 v[68:71], v116 offset:28672
ds_read_b128 v[72:75], v116 offset:25600
ds_read_b128 v[76:79], v116 offset:29696
ds_read_b128 v[16:19], v116 offset:26624
ds_read_b128 v[20:23], v116 offset:30720
ds_read_b128 v[24:27], v116 offset:27648
ds_read_b128 v[28:31], v116 offset:31744
s_waitcnt vmcnt(0)
s_waitcnt lgkmcnt(0)
v_mfma_f32_16x16x32_bf16 v[80:83], v[64:67], v[0:3], 0
v_mfma_f32_16x16x32_bf16 v[84:87], v[68:71], v[0:3], 0
v_mfma_f32_16x16x32_bf16 v[92:95], v[0:3], v[0:3], 0
v_mfma_f32_16x16x32_bf16 v[80:83], v[72:75], v[4:7], v[80:83]
v_mfma_f32_16x16x32_bf16 v[84:87], v[76:79], v[4:7], v[84:87]
v_mfma_f32_16x16x32_bf16 v[92:95], v[4:7], v[4:7], v[92:95]
v_mfma_f32_16x16x32_bf16 v[0:3], v[16:19], v[8:11], v[80:83]
v_mfma_f32_16x16x32_bf16 v[4:7], v[20:23], v[8:11], v[84:87]
v_mfma_f32_16x16x32_bf16 v[88:91], v[8:11], v[8:11], v[92:95]
v_mfma_f32_16x16x32_bf16 v[0:3], v[24:27], v[12:15], v[0:3]
v_mfma_f32_16x16x32_bf16 v[4:7], v[28:31], v[12:15], v[4:7]
v_mfma_f32_16x16x32_bf16 v[88:91], v[12:15], v[12:15], v[88:91]
s_nop 7
v_mov_b32 v65, 0
v_max_f32 v126, v88, v89
v_mul_f32 v126, s30, v126
v_max3_f32 v126, v126, v0, v1
v_max3_f32 v126, v126, v2, v3
v_max3_f32 v126, v126, v4, v5
v_max3_f32 v126, v126, v6, v7
v_mov_b32 v127, v126
s_nop 1
v_permlane32_swap_b32 v126, v127
v_max_f32 v126, v126, v127
v_mov_b32 v127, v126
s_nop 1
v_permlane16_swap_b32 v126, v127
v_max_f32 v126, v126, v127
v_mul_f32 v127, 0x40faf233, v126
s_mov_b32 vcc_lo, 0xcccccccc
s_mov_b32 vcc_hi, 0xcccccccc
v_sub_f32 v0, v0, v126
v_sub_f32 v1, v1, v126
v_sub_f32 v2, v2, v126
v_sub_f32 v3, v3, v126
v_sub_f32 v4, v4, v126
v_sub_f32 v5, v5, v126
v_sub_f32 v6, v6, v126
v_sub_f32 v7, v7, v126
v_sub_f32 v88, v88, v127
v_sub_f32 v89, v89, v127
s_waitcnt lgkmcnt(0)
s_nop 0
v_mul_f32 v88, s30, v88
v_mul_f32 v89, s30, v89
v_exp_f32 v88, v88
v_exp_f32 v89, v89
v_cndmask_b32_dpp v0, v2, v0, vcc quad_perm:[2,3,2,3] row_mask:0xf bank_mask:0xf
v_cvt_pk_bf16_f32 v64, v88, v89
v_cndmask_b32_dpp v1, v3, v1, vcc quad_perm:[2,3,2,3] row_mask:0xf bank_mask:0xf
v_exp_f32 v0, v0
v_mfma_f32_16x16x16_bf16 v[16:19], v[100:101], v[64:65], 0
v_exp_f32 v1, v1
v_cndmask_b32_dpp v4, v6, v4, vcc quad_perm:[2,3,2,3] row_mask:0xf bank_mask:0xf
v_mfma_f32_16x16x16_bf16 v[8:11], v[124:125], v[64:65], 0
v_cndmask_b32_dpp v5, v7, v5, vcc quad_perm:[2,3,2,3] row_mask:0xf bank_mask:0xf
v_exp_f32 v4, v4
v_exp_f32 v5, v5
v_cvt_pk_bf16_f32 v92, v0, v1
v_cvt_pk_bf16_f32 v94, v4, v5
v_mov_b32 v80, 0
v_mov_b32_dpp v93, v92 quad_perm:[0,1,0,1] row_mask:0xf bank_mask:0xf
v_mov_b32_dpp v95, v94 quad_perm:[0,1,0,1] row_mask:0xf bank_mask:0xf
v_mov_b32 v81, 0
v_mov_b32 v82, 0
v_mfma_f32_16x16x32_bf16 v[16:19], v[100:103], v[92:95], v[16:19]
v_mov_b32 v83, 0
v_mov_b32 v84, 0
v_mfma_f32_16x16x32_bf16 v[8:11], v[96:99], v[92:95], v[8:11]
s_nop 1
v_mov_b32 v85, 0
v_mov_b32 v86, 0
v_mov_b32 v87, 0
v_rcp_f32 v126, v16
v_subrev_u32 v127, 0x21800000, v16
v_cmp_lt_u32 vcc, 0x3c000000, v127
v_pk_mul_f32 v[8:9], v[8:9], v[126:127] op_sel_hi:[1,0]
v_pk_mul_f32 v[10:11], v[10:11], v[126:127] op_sel_hi:[1,0]
s_and_b32 s32, vcc_lo, 0xcccc
v_cvt_pk_bf16_f32 v126, v8, v9
v_cvt_pk_bf16_f32 v127, v10, v11
s_branch main_kernel_c1_ost
main_kernel_c1_o0_f:
s_nop 0
buffer_load_dwordx4 v[0:3], v116, s[4:7], s23 offen sc1
s_xor_b32 s32, s23, 1024
buffer_load_dwordx4 v[4:7], v116, s[4:7], s32 offen sc1
s_sub_u32 s29, s29, 1
s_cbranch_scc1 main_kernel_end
s_waitcnt vmcnt(0)
v_max_u32 v126, v0, v2
v_cmp_eq_u32 vcc, -1, v126
s_cbranch_vccnz main_kernel_c1_o0_f
s_branch main_kernel_c1_o0
main_kernel_c1_o1_f:
s_nop 0
s_xor_b32 s32, s23, 1024
buffer_load_dwordx4 v[4:7], v116, s[4:7], s32 offen sc1
s_xor_b32 s32, s23, 2048
buffer_load_dwordx4 v[8:11], v116, s[4:7], s32 offen sc1
s_sub_u32 s29, s29, 1
s_cbranch_scc1 main_kernel_end
s_waitcnt vmcnt(0)
v_max_u32 v126, v4, v6
v_cmp_eq_u32 vcc, -1, v126
s_cbranch_vccnz main_kernel_c1_o1_f
s_branch main_kernel_c1_o1
main_kernel_c1_o2_f:
s_nop 0
s_xor_b32 s32, s23, 2048
buffer_load_dwordx4 v[8:11], v116, s[4:7], s32 offen sc1
s_xor_b32 s32, s23, 3072
buffer_load_dwordx4 v[12:15], v116, s[4:7], s32 offen sc1
s_sub_u32 s29, s29, 1
s_cbranch_scc1 main_kernel_end
s_waitcnt vmcnt(0)
v_max_u32 v126, v8, v10
v_cmp_eq_u32 vcc, -1, v126
s_cbranch_vccnz main_kernel_c1_o2_f
s_branch main_kernel_c1_o2
main_kernel_c1_o3_f:
s_nop 0
s_xor_b32 s32, s23, 3072
buffer_load_dwordx4 v[12:15], v116, s[4:7], s32 offen sc1
s_xor_b32 s32, s23, 4096
buffer_load_dwordx4 v[16:19], v116, s[4:7], s32 offen sc1
s_sub_u32 s29, s29, 1
s_cbranch_scc1 main_kernel_end
s_waitcnt vmcnt(0)
v_max_u32 v126, v12, v14
v_cmp_eq_u32 vcc, -1, v126
s_cbranch_vccnz main_kernel_c1_o3_f
s_branch main_kernel_c1_o3
main_kernel_c1_o4_f:
s_nop 0
s_xor_b32 s32, s23, 4096
buffer_load_dwordx4 v[16:19], v116, s[4:7], s32 offen sc1
s_xor_b32 s32, s23, 5120
buffer_load_dwordx4 v[20:23], v116, s[4:7], s32 offen sc1
s_sub_u32 s29, s29, 1
s_cbranch_scc1 main_kernel_end
s_waitcnt vmcnt(0)
v_max_u32 v126, v16, v18
v_cmp_eq_u32 vcc, -1, v126
s_cbranch_vccnz main_kernel_c1_o4_f
s_branch main_kernel_c1_o4
main_kernel_c1_o5_f:
s_nop 0
s_xor_b32 s32, s23, 5120
buffer_load_dwordx4 v[20:23], v116, s[4:7], s32 offen sc1
s_xor_b32 s32, s23, 6144
buffer_load_dwordx4 v[24:27], v116, s[4:7], s32 offen sc1
s_sub_u32 s29, s29, 1
s_cbranch_scc1 main_kernel_end
s_waitcnt vmcnt(0)
v_max_u32 v126, v20, v22
v_cmp_eq_u32 vcc, -1, v126
s_cbranch_vccnz main_kernel_c1_o5_f
s_branch main_kernel_c1_o5
main_kernel_c1_o6_f:
s_nop 0
s_xor_b32 s32, s23, 6144
buffer_load_dwordx4 v[24:27], v116, s[4:7], s32 offen sc1
s_xor_b32 s32, s23, 7168
buffer_load_dwordx4 v[28:31], v116, s[4:7], s32 offen sc1
s_sub_u32 s29, s29, 1
s_cbranch_scc1 main_kernel_end
s_waitcnt vmcnt(0)
v_max_u32 v126, v24, v26
v_cmp_eq_u32 vcc, -1, v126
s_cbranch_vccnz main_kernel_c1_o6_f
s_branch main_kernel_c1_o6
main_kernel_c1_o7_f:
s_nop 0
s_xor_b32 s32, s23, 7168
buffer_load_dwordx4 v[28:31], v116, s[4:7], s32 offen sc1
s_sub_u32 s29, s29, 1
s_cbranch_scc1 main_kernel_end
s_waitcnt vmcnt(0)
v_max_u32 v126, v28, v30
v_cmp_eq_u32 vcc, -1, v126
s_cbranch_vccnz main_kernel_c1_o7_f
s_branch main_kernel_c1_o7
.p2align 6
main_kernel_c2_top:
s_barrier
buffer_load_dwordx4 v[0:3], v116, s[4:7], s18 offen sc1
s_add_u32 s20, s20, 0x40000
s_bitset0_b32 s20, 20
s_add_u32 s21, s21, 0x40000
s_bitset0_b32 s21, 20
s_add_u32 s22, s22, 0x40000
s_bitset0_b32 s22, 20
s_add_u32 s23, s23, 0x40000
s_bitset0_b32 s23, 20
s_xor_b32 s32, s18, 1024
buffer_load_dwordx4 v[16:19], v116, s[4:7], s32 offen sc1
s_add_u32 s3, s3, 0x40000
s_bitset0_b32 s3, 20
s_add_u32 s17, s17, 1
s_add_u32 s25, s25, 0x40000
s_bitset0_b32 s25, 20
s_nop 2
buffer_load_dwordx4 v[64:67], v116, s[4:7], s19 offen sc1
v_mov_b32 v80, 0
v_mov_b32 v81, 0
s_nop 3
s_xor_b32 s32, s19, 1024
buffer_load_dwordx4 v[68:71], v116, s[4:7], s32 offen sc1
v_mov_b32 v82, 0
v_mov_b32 v83, 0
s_nop 3
s_xor_b32 s32, s18, 2048
buffer_load_dwordx4 v[32:35], v116, s[4:7], s32 offen sc1
v_mov_b32 v84, 0
v_mov_b32 v85, 0
s_nop 3
s_xor_b32 s32, s19, 2048
buffer_load_dwordx4 v[72:75], v116, s[4:7], s32 offen sc1
v_mov_b32 v86, 0
v_mov_b32 v87, 0
s_nop 3
s_xor_b32 s32, s18, 3072
buffer_load_dwordx4 v[48:51], v116, s[4:7], s32 offen sc1
v_mov_b32 v88, 0
v_mov_b32 v89, 0
s_nop 3
s_xor_b32 s32, s19, 3072
buffer_load_dwordx4 v[76:79], v116, s[4:7], s32 offen sc1
v_mov_b32 v90, 0
v_mov_b32 v91, 0
s_waitcnt vmcnt(5)
v_pk_add_f16 v0, v0, v64
v_pk_add_f16 v1, v1, v65
v_pk_add_f16 v2, v2, v66
v_pk_add_f16 v3, v3, v67
v_cmp_u_f16 vcc, v0, v2
s_cbranch_vccnz main_kernel_c2_m0_f
main_kernel_c2_m0:
v_smfmac_f32_16x16x64_f16 v[80:83], v[0:3], a[0:7], v112
ds_write_b128 v116, v[0:3] offset:2048
v_smfmac_f32_16x16x64_f16 v[84:87], v[0:3], a[128:135], v112
buffer_load_dword v123, v121, s[4:7], 0 offen sc1
s_waitcnt vmcnt(5)
v_pk_add_f16 v16, v16, v68
v_pk_add_f16 v17, v17, v69
v_pk_add_f16 v18, v18, v70
v_pk_add_f16 v19, v19, v71
v_cmp_u_f16 vcc, v16, v18
s_waitcnt lgkmcnt(0)
s_barrier
ds_read_b128 v[4:7], v116 offset:3072
s_cbranch_vccnz main_kernel_c2_m1_f
main_kernel_c2_m1:
v_smfmac_f32_16x16x64_f16 v[80:83], v[16:19], a[8:15], v112
ds_write_b128 v116, v[16:19] offset:6144
v_smfmac_f32_16x16x64_f16 v[84:87], v[16:19], a[136:143], v112
ds_read_b128 v[8:11], v116 offset:0
v_smfmac_f32_16x16x64_f16 v[88:91], v[0:3], v[128:135], v112
ds_read_b128 v[12:15], v116 offset:1024
s_waitcnt lgkmcnt(3)
v_smfmac_f32_16x16x64_f16 v[80:83], v[4:7], a[32:39], v112
v_smfmac_f32_16x16x64_f16 v[84:87], v[4:7], a[160:167], v112
v_smfmac_f32_16x16x64_f16 v[88:91], v[4:7], v[136:143], v112
s_waitcnt lgkmcnt(2)
s_barrier
s_waitcnt lgkmcnt(1)
v_smfmac_f32_16x16x64_f16 v[80:83], v[8:11], a[64:71], v112
s_waitcnt vmcnt(3)
ds_read_b128 v[20:23], v116 offset:7168
v_pk_add_f16 v32, v32, v72
v_smfmac_f32_16x16x64_f16 v[84:87], v[8:11], a[192:199], v112
ds_read_b128 v[24:27], v116 offset:4096
s_waitcnt lgkmcnt(2)
v_pk_add_f16 v33, v33, v73
v_smfmac_f32_16x16x64_f16 v[80:83], v[12:15], a[96:103], v112
ds_read_b128 v[28:31], v116 offset:5120
v_pk_add_f16 v34, v34, v74
v_smfmac_f32_16x16x64_f16 v[84:87], v[12:15], a[224:231], v112
s_waitcnt lgkmcnt(2)
v_pk_add_f16 v35, v35, v75
v_smfmac_f32_16x16x64_f16 v[80:83], v[20:23], a[40:47], v112
v_cmp_u_f16 vcc, v32, v34
v_smfmac_f32_16x16x64_f16 v[84:87], v[20:23], a[168:175], v112
ds_write_b128 v116, v[32:35] offset:10240
s_cbranch_vccnz main_kernel_c2_m2_f
main_kernel_c2_m2:
v_smfmac_f32_16x16x64_f16 v[80:83], v[32:35], a[16:23], v112
buffer_load_dwordx4 v[96:99], v116, s[4:7], s28 offen sc1
v_smfmac_f32_16x16x64_f16 v[84:87], v[32:35], a[144:151], v112
s_add_u32 s28, s28, 0x40000
s_waitcnt lgkmcnt(2)
v_smfmac_f32_16x16x64_f16 v[80:83], v[24:27], a[72:79], v112
s_waitcnt vmcnt(2)
v_pk_add_f16 v48, v48, v76
v_smfmac_f32_16x16x64_f16 v[84:87], v[24:27], a[200:207], v112
s_waitcnt lgkmcnt(0)
s_barrier
ds_read_b128 v[36:39], v116 offset:11264
v_pk_add_f16 v49, v49, v77
v_smfmac_f32_16x16x64_f16 v[80:83], v[28:31], a[104:111], v112
ds_read_b128 v[40:43], v116 offset:8192
v_pk_add_f16 v50, v50, v78
v_smfmac_f32_16x16x64_f16 v[84:87], v[28:31], a[232:239], v112
ds_read_b128 v[44:47], v116 offset:9216
v_pk_add_f16 v51, v51, v79
v_smfmac_f32_16x16x64_f16 v[88:91], v[8:11], v[144:151], v112
s_waitcnt lgkmcnt(2)
v_cmp_u_f16 vcc, v48, v50
v_smfmac_f32_16x16x64_f16 v[80:83], v[36:39], a[48:55], v112
ds_write_b128 v116, v[48:51] offset:14336
s_cbranch_vccnz main_kernel_c2_m3_f
main_kernel_c2_m3:
v_smfmac_f32_16x16x64_f16 v[80:83], v[48:51], a[24:31], v112
v_smfmac_f32_16x16x64_f16 v[84:87], v[48:51], a[152:159], v112
v_smfmac_f32_16x16x64_f16 v[84:87], v[36:39], a[176:183], v112
s_waitcnt lgkmcnt(2)
v_smfmac_f32_16x16x64_f16 v[80:83], v[40:43], a[80:87], v112
s_waitcnt lgkmcnt(0)
s_barrier
ds_read_b128 v[52:55], v116 offset:15360
v_smfmac_f32_16x16x64_f16 v[84:87], v[40:43], a[208:215], v112
s_add_u32 s19, s52, s54
ds_read_b128 v[56:59], v116 offset:12288
v_smfmac_f32_16x16x64_f16 v[80:83], v[44:47], a[112:119], v112
s_add_u32 s18, s18, 0x40000
ds_read_b128 v[60:63], v116 offset:13312
v_smfmac_f32_16x16x64_f16 v[84:87], v[44:47], a[240:247], v112
s_bitset0_b32 s18, 20
s_waitcnt lgkmcnt(2)
v_smfmac_f32_16x16x64_f16 v[80:83], v[52:55], a[56:63], v112
s_cmp_eq_u32 s17, 30
s_cselect_b32 s32, s53, 0x10000
s_waitcnt lgkmcnt(1)
v_smfmac_f32_16x16x64_f16 v[80:83], v[56:59], a[88:95], v112
s_add_u32 s52, s52, s32
s_waitcnt lgkmcnt(0)
v_smfmac_f32_16x16x64_f16 v[80:83], v[60:63], a[120:127], v112
s_sub_u32 s24, 0x20000, s32
ds_read_b128 v[64:67], v116 offset:24576
v_smfmac_f32_16x16x64_f16 v[84:87], v[52:55], a[184:191], v112
s_add_u32 s55, s55, s24
ds_read_b128 v[68:71], v116 offset:28672
v_smfmac_f32_16x16x64_f16 v[84:87], v[56:59], a[216:223], v112
ds_read_b128 v[72:75], v116 offset:25600
s_nop 0
v_cvt_pk_bf16_f32 v92, v80, v81
v_smfmac_f32_16x16x64_f16 v[84:87], v[60:63], a[248:255], v112
ds_read_b128 v[76:79], v116 offset:29696
s_nop 0
v_cvt_pk_bf16_f32 v93, v82, v83
v_smfmac_f32_16x16x64_f16 v[88:91], v[12:15], v[152:159], v112
s_nop 3
v_cvt_pk_bf16_f32 v94, v84, v85
v_cvt_pk_bf16_f32 v95, v86, v87
s_mov_b32 vcc_lo, 0xcccccccc
s_mov_b32 vcc_hi, 0xcccccccc
v_mfma_f32_16x16x32_bf16 v[84:87], v[92:95], v[104:107], 0
v_add_u32 v121, v121, v122
v_writelane_b32 v121, s55, 39
s_nop 0
v_smfmac_f32_16x16x64_f16 v[88:91], v[16:19], v[160:167], v112
s_nop 2
s_cmp_eq_u32 s17, 63
v_cvt_pk_bf16_f32 v114, v84, v85
v_cvt_pk_bf16_f32 v115, v86, v87
buffer_store_dwordx2 v[114:115], v117, s[4:7], s21 offen
s_cbranch_scc1 main_kernel_c2_last
ds_write_b64 v117, v[114:115] offset:17408
v_smfmac_f32_16x16x64_f16 v[88:91], v[20:23], v[168:175], v112
v_smfmac_f32_16x16x64_f16 v[88:91], v[24:27], v[176:183], v112
v_smfmac_f32_16x16x64_f16 v[88:91], v[28:31], v[184:191], v112
v_smfmac_f32_16x16x64_f16 v[88:91], v[32:35], v[192:199], v112
s_waitcnt lgkmcnt(0)
s_barrier
ds_read_b128 v[0:3], v116 offset:16384
v_smfmac_f32_16x16x64_f16 v[88:91], v[36:39], v[200:207], v112
ds_read_b128 v[4:7], v116 offset:17408
v_smfmac_f32_16x16x64_f16 v[88:91], v[40:43], v[208:215], v112
ds_read_b128 v[16:19], v116 offset:26624
v_smfmac_f32_16x16x64_f16 v[88:91], v[44:47], v[216:223], v112
ds_read_b128 v[20:23], v116 offset:30720
v_smfmac_f32_16x16x64_f16 v[88:91], v[48:51], v[224:231], v112
ds_read_b128 v[24:27], v116 offset:27648
v_smfmac_f32_16x16x64_f16 v[88:91], v[52:55], v[232:239], v112
ds_read_b128 v[28:31], v116 offset:31744
v_smfmac_f32_16x16x64_f16 v[88:91], v[56:59], v[240:247], v112
v_smfmac_f32_16x16x64_f16 v[88:91], v[60:63], v[248:255], v112
s_waitcnt lgkmcnt(5)
v_mfma_f32_16x16x32_bf16 v[80:83], v[64:67], v[0:3], 0
v_mfma_f32_16x16x32_bf16 v[84:87], v[68:71], v[0:3], 0
buffer_load_dwordx4 v[8:11], v116, s[4:7], s20 offen offset:0 sc1
v_mfma_f32_16x16x32_bf16 v[92:95], v[0:3], v[0:3], 0
buffer_load_dwordx4 v[12:15], v116, s[4:7], s20 offen offset:1024 sc1
v_permlane32_swap_b32 v88, v90
s_waitcnt lgkmcnt(4)
v_mfma_f32_16x16x32_bf16 v[80:83], v[72:75], v[4:7], v[80:83]
v_permlane32_swap_b32 v89, v91
v_mfma_f32_16x16x32_bf16 v[84:87], v[76:79], v[4:7], v[84:87]
v_pk_add_f32 v[88:89], v[88:89], v[90:91]
v_mfma_f32_16x16x32_bf16 v[92:95], v[4:7], v[4:7], v[92:95]
v_cvt_pk_bf16_f32 v124, v88, v89
v_mov_b32 v65, 0
s_waitcnt lgkmcnt(0)
s_waitcnt vmcnt(1)
v_mfma_f32_16x16x32_bf16 v[88:91], v[8:11], v[8:11], v[92:95]
v_mfma_f32_16x16x32_bf16 v[0:3], v[16:19], v[8:11], v[80:83]
v_cmp_u_f32 s[0:1], v8, v10
v_mfma_f32_16x16x32_bf16 v[4:7], v[20:23], v[8:11], v[84:87]
s_waitcnt vmcnt(0)
v_mfma_f32_16x16x32_bf16 v[88:91], v[12:15], v[12:15], v[88:91]
v_mfma_f32_16x16x32_bf16 v[0:3], v[24:27], v[12:15], v[0:3]
v_cmp_u_f32 s[32:33], v12, v14
v_mfma_f32_16x16x32_bf16 v[4:7], v[28:31], v[12:15], v[4:7]
s_or_b64 s[0:1], s[0:1], s[32:33]
s_cbranch_scc1 main_kernel_c2_z_f
main_kernel_c2_z:
v_mul_f32 v88, s30, v88
v_mul_f32 v89, s30, v89
v_exp_f32 v88, v88
v_exp_f32 v89, v89
v_cndmask_b32_dpp v0, v2, v0, vcc quad_perm:[2,3,2,3] row_mask:0xf bank_mask:0xf
v_cvt_pk_bf16_f32 v64, v88, v89
v_cndmask_b32_dpp v1, v3, v1, vcc quad_perm:[2,3,2,3] row_mask:0xf bank_mask:0xf
v_exp_f32 v0, v0
v_mfma_f32_16x16x16_bf16 v[16:19], v[100:101], v[64:65], 0
v_exp_f32 v1, v1
v_cndmask_b32_dpp v4, v6, v4, vcc quad_perm:[2,3,2,3] row_mask:0xf bank_mask:0xf
v_mfma_f32_16x16x16_bf16 v[8:11], v[124:125], v[64:65], 0
v_cndmask_b32_dpp v5, v7, v5, vcc quad_perm:[2,3,2,3] row_mask:0xf bank_mask:0xf
v_exp_f32 v4, v4
v_exp_f32 v5, v5
v_cvt_pk_bf16_f32 v92, v0, v1
v_cvt_pk_bf16_f32 v94, v4, v5
v_mov_b32 v80, 0
v_mov_b32_dpp v93, v92 quad_perm:[0,1,0,1] row_mask:0xf bank_mask:0xf
v_mov_b32_dpp v95, v94 quad_perm:[0,1,0,1] row_mask:0xf bank_mask:0xf
v_mov_b32 v81, 0
v_mov_b32 v82, 0
v_mfma_f32_16x16x32_bf16 v[16:19], v[100:103], v[92:95], v[16:19]
v_mov_b32 v83, 0
v_mov_b32 v84, 0
v_mfma_f32_16x16x32_bf16 v[8:11], v[96:99], v[92:95], v[8:11]
s_nop 1
v_mov_b32 v85, 0
v_mov_b32 v86, 0
v_mov_b32 v87, 0
v_rcp_f32 v126, v16
v_subrev_u32 v127, 0x21800000, v16
v_cmp_lt_u32 vcc, 0x3c000000, v127
v_pk_mul_f32 v[8:9], v[8:9], v[126:127] op_sel_hi:[1,0]
v_pk_mul_f32 v[10:11], v[10:11], v[126:127] op_sel_hi:[1,0]
s_and_b32 s32, vcc_lo, 0xcccc
v_cvt_pk_bf16_f32 v126, v8, v9
v_cvt_pk_bf16_f32 v127, v10, v11
s_cbranch_scc1 main_kernel_c2_sm_f
main_kernel_c2_ost:
buffer_store_dwordx2 v[126:127], v118, s[4:7], s22 offen
v_cmp_eq_u32 s[0:1], 0, v123
v_mov_b32 v24, -1
v_mov_b32 v25, -1
v_mov_b32 v26, -1
v_mov_b32 v27, -1
ds_read_b128 v[32:35], v113 offset:0
ds_read_b128 v[36:39], v113 offset:1024
ds_read_b128 v[40:43], v113 offset:2048
ds_read_b128 v[44:47], v113 offset:3072
ds_read_b128 v[48:51], v113 offset:4096
ds_read_b128 v[52:55], v113 offset:5120
s_and_b32 s10, s1, 0x3f00
buffer_store_dwordx4 v[24:27], v116, s[4:7], s3 offen
s_barrier
buffer_load_dwordx4 v[0:3], v116, s[4:7], s23 offen sc1
ds_read_b128 v[56:59], v113 offset:6144
ds_read_b128 v[60:63], v113 offset:7168
s_add_u32 s37, s37, 65536
s_add_u32 s26, s26, 65536
s_nop 1
s_xor_b32 s32, s23, 1024
buffer_load_dwordx4 v[4:7], v116, s[4:7], s32 offen sc1
ds_read_b128 v[64:67], v113 offset:8192
ds_read_b128 v[68:71], v113 offset:9216
s_nop 3
s_xor_b32 s32, s23, 2048
buffer_load_dwordx4 v[8:11], v116, s[4:7], s32 offen sc1
ds_read_b128 v[72:75], v113 offset:10240
ds_read_b128 v[76:79], v113 offset:11264
s_nop 3
s_xor_b32 s32, s23, 3072
buffer_load_dwordx4 v[12:15], v116, s[4:7], s32 offen sc1
ds_read_b128 v[88:91], v113 offset:12288
ds_read_b128 v[92:95], v113 offset:13312
s_nop 3
s_xor_b32 s32, s23, 4096
buffer_load_dwordx4 v[16:19], v116, s[4:7], s32 offen sc1
s_nop 7
s_xor_b32 s32, s23, 5120
buffer_load_dwordx4 v[20:23], v116, s[4:7], s32 offen sc1
s_nop 7
s_xor_b32 s32, s23, 6144
buffer_load_dwordx4 v[24:27], v116, s[4:7], s32 offen sc1
s_nop 7
s_xor_b32 s32, s23, 7168
buffer_load_dwordx4 v[28:31], v116, s[4:7], s32 offen sc1
s_waitcnt lgkmcnt(12)
s_waitcnt vmcnt(7)
v_cmp_u_f32 vcc, v0, v2
s_cbranch_vccnz main_kernel_c2_o0_f
main_kernel_c2_o0:
v_smfmac_f32_16x16x64_bf16 v[80:83], v[0:3], v[32:39], v112
ds_read_b128 v[32:35], v113 offset:14336
ds_read_b128 v[36:39], v113 offset:15360
s_waitcnt lgkmcnt(12)
s_waitcnt vmcnt(6)
v_cmp_u_f32 vcc, v4, v6
v_smfmac_f32_16x16x64_bf16 v[84:87], v[0:3], v[40:47], v112
ds_read_b128 v[40:43], v113 offset:16384
ds_read_b128 v[44:47], v113 offset:17408
buffer_store_dwordx2 v[114:115], v119, s[4:7], s37 offen sc1
s_cbranch_vccnz main_kernel_c2_o1_f
main_kernel_c2_o1:
s_waitcnt lgkmcnt(12)
v_smfmac_f32_16x16x64_bf16 v[80:83], v[4:7], v[48:55], v112
ds_read_b128 v[48:51], v113 offset:18432
ds_read_b128 v[52:55], v113 offset:19456
s_waitcnt lgkmcnt(12)
s_waitcnt vmcnt(6)
v_cmp_u_f32 vcc, v8, v10
v_smfmac_f32_16x16x64_bf16 v[84:87], v[4:7], v[56:63], v112
ds_read_b128 v[56:59], v113 offset:20480
ds_read_b128 v[60:63], v113 offset:21504
buffer_store_dword v124, v120, s[4:7], s26 offen sc1
s_cbranch_vccnz main_kernel_c2_o2_f
main_kernel_c2_o2:
s_waitcnt lgkmcnt(12)
v_smfmac_f32_16x16x64_bf16 v[80:83], v[8:11], v[64:71], v112
ds_read_b128 v[64:67], v113 offset:22528
ds_read_b128 v[68:71], v113 offset:23552
s_waitcnt lgkmcnt(12)
s_waitcnt vmcnt(6)
v_cmp_u_f32 vcc, v12, v14
v_smfmac_f32_16x16x64_bf16 v[84:87], v[8:11], v[72:79], v112
ds_read_b128 v[72:75], v113 offset:24576
ds_read_b128 v[76:79], v113 offset:25600
s_cbranch_vccnz main_kernel_c2_o3_f
main_kernel_c2_o3:
s_waitcnt lgkmcnt(12)
v_smfmac_f32_16x16x64_bf16 v[80:83], v[12:15], v[88:95], v112
ds_read_b128 v[88:91], v113 offset:26624
ds_read_b128 v[92:95], v113 offset:27648
s_waitcnt lgkmcnt(12)
s_waitcnt vmcnt(5)
v_cmp_u_f32 vcc, v16, v18
v_smfmac_f32_16x16x64_bf16 v[84:87], v[12:15], v[32:39], v112
ds_read_b128 v[32:35], v113 offset:28672
ds_read_b128 v[36:39], v113 offset:29696
s_cbranch_vccnz main_kernel_c2_o4_f
main_kernel_c2_o4:
s_waitcnt lgkmcnt(12)
v_smfmac_f32_16x16x64_bf16 v[80:83], v[16:19], v[40:47], v112
ds_read_b128 v[40:43], v113 offset:30720
ds_read_b128 v[44:47], v113 offset:31744
s_waitcnt lgkmcnt(12)
s_waitcnt vmcnt(4)
v_cmp_u_f32 vcc, v20, v22
v_smfmac_f32_16x16x64_bf16 v[84:87], v[16:19], v[48:55], v112
s_cbranch_vccnz main_kernel_c2_o5_f
main_kernel_c2_o5:
s_waitcnt lgkmcnt(10)
v_smfmac_f32_16x16x64_bf16 v[80:83], v[20:23], v[56:63], v112
s_waitcnt lgkmcnt(8)
s_waitcnt vmcnt(3)
v_cmp_u_f32 vcc, v24, v26
v_smfmac_f32_16x16x64_bf16 v[84:87], v[20:23], v[64:71], v112
s_cbranch_vccnz main_kernel_c2_o6_f
main_kernel_c2_o6:
s_waitcnt lgkmcnt(6)
v_smfmac_f32_16x16x64_bf16 v[80:83], v[24:27], v[72:79], v112
s_waitcnt lgkmcnt(4)
v_smfmac_f32_16x16x64_bf16 v[84:87], v[24:27], v[88:95], v112
s_waitcnt lgkmcnt(2)
s_waitcnt vmcnt(2)
v_cmp_u_f32 vcc, v28, v30
s_cbranch_vccnz main_kernel_c2_o7_f
main_kernel_c2_o7:
v_smfmac_f32_16x16x64_bf16 v[80:83], v[28:31], v[32:39], v112
s_waitcnt lgkmcnt(0)
v_smfmac_f32_16x16x64_bf16 v[84:87], v[28:31], v[40:47], v112
s_nop 4
v_cvt_pk_bf16_f32 v80, v80, v81
v_cvt_pk_bf16_f32 v81, v82, v83
ds_write_b64 v116, v[80:81] offset:21504
v_cvt_pk_bf16_f32 v82, v84, v85
v_cvt_pk_bf16_f32 v83, v86, v87
ds_write_b64 v116, v[82:83] offset:23552
s_waitcnt lgkmcnt(0)
s_barrier
ds_read_b128 v[72:75], v116 offset:20480
ds_read_b128 v[76:79], v116 offset:21504
s_mov_b32 m0, 28672
s_cmp_lg_u32 s10, 0
s_waitcnt lgkmcnt(1)
v_mfma_f32_16x16x32_bf16 v[64:67], v[72:75], v[108:111], 0
s_waitcnt lgkmcnt(0)
v_mfma_f32_16x16x32_bf16 v[64:67], v[76:79], v[108:111], v[64:67]
s_nop 7
v_cvt_pk_f16_f32 v68, v64, v65
v_cvt_pk_f16_f32 v69, v66, v67
buffer_store_dwordx2 v[68:69], v125, s[4:7], s25 offen
s_cbranch_scc1 main_kernel_c2_kvw
main_kernel_c2_kvok:
s_nop 3
buffer_load_dwordx4 v116, s[4:7], s27 offen sc1 lds
buffer_load_dwordx4 v116, s[4:7], s27 offen offset:1024 sc1 lds
s_mov_b32 m0, 30720
s_xor_b32 s32, s27, 2048
buffer_load_dwordx4 v116, s[4:7], s32 offen offset:1024 sc1 lds
s_add_u32 s27, s27, 0x40000
s_branch main_kernel_c2_top
main_kernel_c2_kvw:
s_mov_b32 exec_lo, 0
s_mov_b32 exec_hi, 0x3f00
v_subrev_u32 v127, 128, v121
main_kernel_c2_kvp:
buffer_load_dword v126, v127, s[4:7], 0 offen sc1
s_waitcnt vmcnt(0)
v_cmp_eq_u32 vcc, 0, v126
s_cbranch_vccz main_kernel_c2_kvp_ok
s_sleep 2
s_sub_u32 s29, s29, 1
s_cbranch_scc0 main_kernel_c2_kvp
s_branch main_kernel_end
main_kernel_c2_kvp_ok:
s_mov_b64 exec, -1
s_branch main_kernel_c2_kvok
main_kernel_c2_last:
s_add_u32 s37, s37, 65536
s_add_u32 s26, s26, 65536
buffer_store_dwordx2 v[114:115], v119, s[4:7], s37 offen sc1
v_smfmac_f32_16x16x64_f16 v[88:91], v[20:23], v[168:175], v112
v_smfmac_f32_16x16x64_f16 v[88:91], v[24:27], v[176:183], v112
v_smfmac_f32_16x16x64_f16 v[88:91], v[28:31], v[184:191], v112
v_smfmac_f32_16x16x64_f16 v[88:91], v[32:35], v[192:199], v112
v_smfmac_f32_16x16x64_f16 v[88:91], v[36:39], v[200:207], v112
v_smfmac_f32_16x16x64_f16 v[88:91], v[40:43], v[208:215], v112
v_smfmac_f32_16x16x64_f16 v[88:91], v[44:47], v[216:223], v112
v_smfmac_f32_16x16x64_f16 v[88:91], v[48:51], v[224:231], v112
v_smfmac_f32_16x16x64_f16 v[88:91], v[52:55], v[232:239], v112
v_smfmac_f32_16x16x64_f16 v[88:91], v[56:59], v[240:247], v112
v_smfmac_f32_16x16x64_f16 v[88:91], v[60:63], v[248:255], v112
s_nop 7
v_permlane32_swap_b32 v88, v90
s_nop 1
v_permlane32_swap_b32 v89, v91
s_nop 1
v_pk_add_f32 v[88:89], v[88:89], v[90:91]
s_nop 1
v_cvt_pk_bf16_f32 v124, v88, v89
s_nop 1
buffer_store_dword v124, v120, s[4:7], s26 offen sc1
s_branch main_kernel_end
main_kernel_c2_m0_f:
s_waitcnt lgkmcnt(0)
buffer_load_dwordx4 v[0:3], v116, s[4:7], s18 offen sc1
buffer_load_dwordx4 v[64:67], v116, s[4:7], s19 offen sc1
s_xor_b32 s32, s18, 1024
buffer_load_dwordx4 v[16:19], v116, s[4:7], s32 offen sc1
s_xor_b32 s32, s19, 1024
buffer_load_dwordx4 v[68:71], v116, s[4:7], s32 offen sc1
s_xor_b32 s32, s18, 2048
buffer_load_dwordx4 v[32:35], v116, s[4:7], s32 offen sc1
s_xor_b32 s32, s19, 2048
buffer_load_dwordx4 v[72:75], v116, s[4:7], s32 offen sc1
s_xor_b32 s32, s18, 3072
buffer_load_dwordx4 v[48:51], v116, s[4:7], s32 offen sc1
s_xor_b32 s32, s19, 3072
buffer_load_dwordx4 v[76:79], v116, s[4:7], s32 offen sc1
s_sub_u32 s29, s29, 1
s_cbranch_scc1 main_kernel_end
s_waitcnt vmcnt(0)
v_max_u32 v126, v0, v2
v_max3_u32 v126, v126, v64, v66
v_cmp_eq_u32 vcc, -1, v126
s_cbranch_vccnz main_kernel_c2_m0_f
v_pk_add_f16 v0, v0, v64
v_pk_add_f16 v1, v1, v65
v_pk_add_f16 v2, v2, v66
v_pk_add_f16 v3, v3, v67
s_nop 0
s_branch main_kernel_c2_m0
main_kernel_c2_m1_f:
s_waitcnt lgkmcnt(0)
s_xor_b32 s32, s18, 1024
buffer_load_dwordx4 v[16:19], v116, s[4:7], s32 offen sc1
s_xor_b32 s32, s19, 1024
buffer_load_dwordx4 v[68:71], v116, s[4:7], s32 offen sc1
s_xor_b32 s32, s18, 2048
buffer_load_dwordx4 v[32:35], v116, s[4:7], s32 offen sc1
s_xor_b32 s32, s19, 2048
buffer_load_dwordx4 v[72:75], v116, s[4:7], s32 offen sc1
s_xor_b32 s32, s18, 3072
buffer_load_dwordx4 v[48:51], v116, s[4:7], s32 offen sc1
s_xor_b32 s32, s19, 3072
buffer_load_dwordx4 v[76:79], v116, s[4:7], s32 offen sc1
s_sub_u32 s29, s29, 1
s_cbranch_scc1 main_kernel_end
s_waitcnt vmcnt(0)
v_max_u32 v126, v16, v18
v_max3_u32 v126, v126, v68, v70
v_cmp_eq_u32 vcc, -1, v126
s_cbranch_vccnz main_kernel_c2_m1_f
v_pk_add_f16 v16, v16, v68
v_pk_add_f16 v17, v17, v69
v_pk_add_f16 v18, v18, v70
v_pk_add_f16 v19, v19, v71
s_nop 0
s_branch main_kernel_c2_m1
main_kernel_c2_m2_f:
s_waitcnt lgkmcnt(0)
s_xor_b32 s32, s18, 2048
buffer_load_dwordx4 v[32:35], v116, s[4:7], s32 offen sc1
s_xor_b32 s32, s19, 2048
buffer_load_dwordx4 v[72:75], v116, s[4:7], s32 offen sc1
s_xor_b32 s32, s18, 3072
buffer_load_dwordx4 v[48:51], v116, s[4:7], s32 offen sc1
s_xor_b32 s32, s19, 3072
buffer_load_dwordx4 v[76:79], v116, s[4:7], s32 offen sc1
s_sub_u32 s29, s29, 1
s_cbranch_scc1 main_kernel_end
s_waitcnt vmcnt(0)
v_max_u32 v126, v32, v34
v_max3_u32 v126, v126, v72, v74
v_cmp_eq_u32 vcc, -1, v126
s_cbranch_vccnz main_kernel_c2_m2_f
v_pk_add_f16 v32, v32, v72
v_pk_add_f16 v33, v33, v73
v_pk_add_f16 v34, v34, v74
v_pk_add_f16 v35, v35, v75
ds_write_b128 v116, v[32:35] offset:10240
s_branch main_kernel_c2_m2
main_kernel_c2_m3_f:
s_waitcnt lgkmcnt(0)
s_xor_b32 s32, s18, 3072
buffer_load_dwordx4 v[48:51], v116, s[4:7], s32 offen sc1
s_xor_b32 s32, s19, 3072
buffer_load_dwordx4 v[76:79], v116, s[4:7], s32 offen sc1
s_sub_u32 s29, s29, 1
s_cbranch_scc1 main_kernel_end
s_waitcnt vmcnt(0)
v_max_u32 v126, v48, v50
v_max3_u32 v126, v126, v76, v78
v_cmp_eq_u32 vcc, -1, v126
s_cbranch_vccnz main_kernel_c2_m3_f
v_pk_add_f16 v48, v48, v76
v_pk_add_f16 v49, v49, v77
v_pk_add_f16 v50, v50, v78
v_pk_add_f16 v51, v51, v79
ds_write_b128 v116, v[48:51] offset:14336
s_branch main_kernel_c2_m3
main_kernel_c2_z_f:
buffer_load_dwordx4 v[8:11], v116, s[4:7], s20 offen offset:0 sc1
buffer_load_dwordx4 v[12:15], v116, s[4:7], s20 offen offset:1024 sc1
s_memtime s[32:33]
ds_read_b32 v126, v116 offset:18432
s_sub_u32 s34, s19, s54
s_xor_b32 s34, s34, 0x2000
s_lshl_b32 s35, s12, 15
s_add_u32 s34, s34, s35
s_lshl_b32 s35, s13, 8
s_add_u32 s35, s35, s34
s_add_u32 s34, s34, 0x4000
s_waitcnt lgkmcnt(0)
s_sub_u32 s32, s32, 450
v_sub_u32 v127, s32, v126
buffer_store_dword v127, off, s[4:7], s34
s_sub_u32 s29, s29, 1
s_cbranch_scc1 main_kernel_end
s_waitcnt vmcnt(1)
main_kernel_c2_z_g:
v_max_u32 v126, v8, v10
v_max3_u32 v126, v126, v12, v14
v_cmp_eq_u32 vcc, -1, v126
s_cbranch_vccnz main_kernel_c2_z_h
v_mfma_f32_16x16x32_bf16 v[88:91], v[8:11], v[8:11], v[92:95]
v_mfma_f32_16x16x32_bf16 v[0:3], v[16:19], v[8:11], v[80:83]
v_mfma_f32_16x16x32_bf16 v[4:7], v[20:23], v[8:11], v[84:87]
v_mfma_f32_16x16x32_bf16 v[88:91], v[12:15], v[12:15], v[88:91]
v_mfma_f32_16x16x32_bf16 v[0:3], v[24:27], v[12:15], v[0:3]
v_mfma_f32_16x16x32_bf16 v[4:7], v[28:31], v[12:15], v[4:7]
buffer_store_dword v127, off, s[4:7], s35 offset:132 sc1
s_mov_b32 vcc_lo, 0xcccccccc
s_mov_b32 vcc_hi, 0xcccccccc
s_branch main_kernel_c2_z
main_kernel_c2_z_h:
buffer_load_dwordx4 v[8:11], v116, s[4:7], s20 offen offset:0 sc1
buffer_load_dwordx4 v[12:15], v116, s[4:7], s20 offen offset:1024 sc1
s_sub_u32 s29, s29, 1
s_cbranch_scc1 main_kernel_end
v_add_u32 v127, 300, v127
s_waitcnt vmcnt(0)
s_branch main_kernel_c2_z_g
main_kernel_c2_sm_f:
s_waitcnt vmcnt(0) lgkmcnt(0)
buffer_load_dwordx4 v[8:11], v116, s[4:7], s20 offen offset:0 sc1
buffer_load_dwordx4 v[12:15], v116, s[4:7], s20 offen offset:1024 sc1
ds_read_b128 v[0:3], v116 offset:16384
ds_read_b128 v[4:7], v116 offset:17408
ds_read_b128 v[64:67], v116 offset:24576
ds_read_b128 v[68:71], v116 offset:28672
ds_read_b128 v[72:75], v116 offset:25600
ds_read_b128 v[76:79], v116 offset:29696
ds_read_b128 v[16:19], v116 offset:26624
ds_read_b128 v[20:23], v116 offset:30720
ds_read_b128 v[24:27], v116 offset:27648
ds_read_b128 v[28:31], v116 offset:31744
s_waitcnt vmcnt(0)
s_waitcnt lgkmcnt(0)
v_mfma_f32_16x16x32_bf16 v[80:83], v[64:67], v[0:3], 0
v_mfma_f32_16x16x32_bf16 v[84:87], v[68:71], v[0:3], 0
v_mfma_f32_16x16x32_bf16 v[92:95], v[0:3], v[0:3], 0
v_mfma_f32_16x16x32_bf16 v[80:83], v[72:75], v[4:7], v[80:83]
v_mfma_f32_16x16x32_bf16 v[84:87], v[76:79], v[4:7], v[84:87]
v_mfma_f32_16x16x32_bf16 v[92:95], v[4:7], v[4:7], v[92:95]
v_mfma_f32_16x16x32_bf16 v[0:3], v[16:19], v[8:11], v[80:83]
v_mfma_f32_16x16x32_bf16 v[4:7], v[20:23], v[8:11], v[84:87]
v_mfma_f32_16x16x32_bf16 v[88:91], v[8:11], v[8:11], v[92:95]
v_mfma_f32_16x16x32_bf16 v[0:3], v[24:27], v[12:15], v[0:3]
v_mfma_f32_16x16x32_bf16 v[4:7], v[28:31], v[12:15], v[4:7]
v_mfma_f32_16x16x32_bf16 v[88:91], v[12:15], v[12:15], v[88:91]
s_nop 7
v_mov_b32 v65, 0
v_max_f32 v126, v88, v89
v_mul_f32 v126, s30, v126
v_max3_f32 v126, v126, v0, v1
v_max3_f32 v126, v126, v2, v3
v_max3_f32 v126, v126, v4, v5
v_max3_f32 v126, v126, v6, v7
v_mov_b32 v127, v126
s_nop 1
v_permlane32_swap_b32 v126, v127
v_max_f32 v126, v126, v127
v_mov_b32 v127, v126
s_nop 1
v_permlane16_swap_b32 v126, v127
v_max_f32 v126, v126, v127
v_mul_f32 v127, 0x40faf233, v126
s_mov_b32 vcc_lo, 0xcccccccc
s_mov_b32 vcc_hi, 0xcccccccc
v_sub_f32 v0, v0, v126
v_sub_f32 v1, v1, v126
v_sub_f32 v2, v2, v126
v_sub_f32 v3, v3, v126
v_sub_f32 v4, v4, v126
v_sub_f32 v5, v5, v126
v_sub_f32 v6, v6, v126
v_sub_f32 v7, v7, v126
v_sub_f32 v88, v88, v127
v_sub_f32 v89, v89, v127
s_waitcnt lgkmcnt(0)
s_nop 0
v_mul_f32 v88, s30, v88
v_mul_f32 v89, s30, v89
v_exp_f32 v88, v88
v_exp_f32 v89, v89
v_cndmask_b32_dpp v0, v2, v0, vcc quad_perm:[2,3,2,3] row_mask:0xf bank_mask:0xf
v_cvt_pk_bf16_f32 v64, v88, v89
v_cndmask_b32_dpp v1, v3, v1, vcc quad_perm:[2,3,2,3] row_mask:0xf bank_mask:0xf
v_exp_f32 v0, v0
v_mfma_f32_16x16x16_bf16 v[16:19], v[100:101], v[64:65], 0
v_exp_f32 v1, v1
v_cndmask_b32_dpp v4, v6, v4, vcc quad_perm:[2,3,2,3] row_mask:0xf bank_mask:0xf
v_mfma_f32_16x16x16_bf16 v[8:11], v[124:125], v[64:65], 0
v_cndmask_b32_dpp v5, v7, v5, vcc quad_perm:[2,3,2,3] row_mask:0xf bank_mask:0xf
v_exp_f32 v4, v4
v_exp_f32 v5, v5
v_cvt_pk_bf16_f32 v92, v0, v1
v_cvt_pk_bf16_f32 v94, v4, v5
v_mov_b32 v80, 0
v_mov_b32_dpp v93, v92 quad_perm:[0,1,0,1] row_mask:0xf bank_mask:0xf
v_mov_b32_dpp v95, v94 quad_perm:[0,1,0,1] row_mask:0xf bank_mask:0xf
v_mov_b32 v81, 0
v_mov_b32 v82, 0
v_mfma_f32_16x16x32_bf16 v[16:19], v[100:103], v[92:95], v[16:19]
v_mov_b32 v83, 0
v_mov_b32 v84, 0
v_mfma_f32_16x16x32_bf16 v[8:11], v[96:99], v[92:95], v[8:11]
s_nop 1
v_mov_b32 v85, 0
v_mov_b32 v86, 0
v_mov_b32 v87, 0
v_rcp_f32 v126, v16
v_subrev_u32 v127, 0x21800000, v16
v_cmp_lt_u32 vcc, 0x3c000000, v127
v_pk_mul_f32 v[8:9], v[8:9], v[126:127] op_sel_hi:[1,0]
v_pk_mul_f32 v[10:11], v[10:11], v[126:127] op_sel_hi:[1,0]
s_and_b32 s32, vcc_lo, 0xcccc
v_cvt_pk_bf16_f32 v126, v8, v9
v_cvt_pk_bf16_f32 v127, v10, v11
s_branch main_kernel_c2_ost
main_kernel_c2_o0_f:
s_nop 0
buffer_load_dwordx4 v[0:3], v116, s[4:7], s23 offen sc1
s_xor_b32 s32, s23, 1024
buffer_load_dwordx4 v[4:7], v116, s[4:7], s32 offen sc1
s_sub_u32 s29, s29, 1
s_cbranch_scc1 main_kernel_end
s_waitcnt vmcnt(0)
v_max_u32 v126, v0, v2
v_cmp_eq_u32 vcc, -1, v126
s_cbranch_vccnz main_kernel_c2_o0_f
s_branch main_kernel_c2_o0
main_kernel_c2_o1_f:
s_nop 0
s_xor_b32 s32, s23, 1024
buffer_load_dwordx4 v[4:7], v116, s[4:7], s32 offen sc1
s_xor_b32 s32, s23, 2048
buffer_load_dwordx4 v[8:11], v116, s[4:7], s32 offen sc1
s_sub_u32 s29, s29, 1
s_cbranch_scc1 main_kernel_end
s_waitcnt vmcnt(0)
v_max_u32 v126, v4, v6
v_cmp_eq_u32 vcc, -1, v126
s_cbranch_vccnz main_kernel_c2_o1_f
s_branch main_kernel_c2_o1
main_kernel_c2_o2_f:
s_nop 0
s_xor_b32 s32, s23, 2048
buffer_load_dwordx4 v[8:11], v116, s[4:7], s32 offen sc1
s_xor_b32 s32, s23, 3072
buffer_load_dwordx4 v[12:15], v116, s[4:7], s32 offen sc1
s_sub_u32 s29, s29, 1
s_cbranch_scc1 main_kernel_end
s_waitcnt vmcnt(0)
v_max_u32 v126, v8, v10
v_cmp_eq_u32 vcc, -1, v126
s_cbranch_vccnz main_kernel_c2_o2_f
s_branch main_kernel_c2_o2
main_kernel_c2_o3_f:
s_nop 0
s_xor_b32 s32, s23, 3072
buffer_load_dwordx4 v[12:15], v116, s[4:7], s32 offen sc1
s_xor_b32 s32, s23, 4096
buffer_load_dwordx4 v[16:19], v116, s[4:7], s32 offen sc1
s_sub_u32 s29, s29, 1
s_cbranch_scc1 main_kernel_end
s_waitcnt vmcnt(0)
v_max_u32 v126, v12, v14
v_cmp_eq_u32 vcc, -1, v126
s_cbranch_vccnz main_kernel_c2_o3_f
s_branch main_kernel_c2_o3
main_kernel_c2_o4_f:
s_nop 0
s_xor_b32 s32, s23, 4096
buffer_load_dwordx4 v[16:19], v116, s[4:7], s32 offen sc1
s_xor_b32 s32, s23, 5120
buffer_load_dwordx4 v[20:23], v116, s[4:7], s32 offen sc1
s_sub_u32 s29, s29, 1
s_cbranch_scc1 main_kernel_end
s_waitcnt vmcnt(0)
v_max_u32 v126, v16, v18
v_cmp_eq_u32 vcc, -1, v126
s_cbranch_vccnz main_kernel_c2_o4_f
s_branch main_kernel_c2_o4
main_kernel_c2_o5_f:
s_nop 0
s_xor_b32 s32, s23, 5120
buffer_load_dwordx4 v[20:23], v116, s[4:7], s32 offen sc1
s_xor_b32 s32, s23, 6144
buffer_load_dwordx4 v[24:27], v116, s[4:7], s32 offen sc1
s_sub_u32 s29, s29, 1
s_cbranch_scc1 main_kernel_end
s_waitcnt vmcnt(0)
v_max_u32 v126, v20, v22
v_cmp_eq_u32 vcc, -1, v126
s_cbranch_vccnz main_kernel_c2_o5_f
s_branch main_kernel_c2_o5
main_kernel_c2_o6_f:
s_nop 0
s_xor_b32 s32, s23, 6144
buffer_load_dwordx4 v[24:27], v116, s[4:7], s32 offen sc1
s_xor_b32 s32, s23, 7168
buffer_load_dwordx4 v[28:31], v116, s[4:7], s32 offen sc1
s_sub_u32 s29, s29, 1
s_cbranch_scc1 main_kernel_end
s_waitcnt vmcnt(0)
v_max_u32 v126, v24, v26
v_cmp_eq_u32 vcc, -1, v126
s_cbranch_vccnz main_kernel_c2_o6_f
s_branch main_kernel_c2_o6
main_kernel_c2_o7_f:
s_nop 0
s_xor_b32 s32, s23, 7168
buffer_load_dwordx4 v[28:31], v116, s[4:7], s32 offen sc1
s_sub_u32 s29, s29, 1
s_cbranch_scc1 main_kernel_end
s_waitcnt vmcnt(0)
v_max_u32 v126, v28, v30
v_cmp_eq_u32 vcc, -1, v126
s_cbranch_vccnz main_kernel_c2_o7_f
s_branch main_kernel_c2_o7
.p2align 6
main_kernel_c3_top:
s_barrier
buffer_load_dwordx4 v[0:3], v116, s[4:7], s18 offen sc1
s_add_u32 s20, s20, 0x40000
s_bitset0_b32 s20, 20
s_add_u32 s21, s21, 0x40000
s_bitset0_b32 s21, 20
s_add_u32 s22, s22, 0x40000
s_bitset0_b32 s22, 20
s_add_u32 s23, s23, 0x40000
s_bitset0_b32 s23, 20
s_xor_b32 s32, s18, 1024
buffer_load_dwordx4 v[16:19], v116, s[4:7], s32 offen sc1
s_add_u32 s3, s3, 0x40000
s_bitset0_b32 s3, 20
s_add_u32 s17, s17, 1
s_add_u32 s25, s25, 0x40000
s_bitset0_b32 s25, 20
s_nop 2
buffer_load_dwordx4 v[64:67], v116, s[4:7], s19 offen sc1
v_mov_b32 v80, 0
v_mov_b32 v81, 0
s_nop 3
s_xor_b32 s32, s19, 1024
buffer_load_dwordx4 v[68:71], v116, s[4:7], s32 offen sc1
v_mov_b32 v82, 0
v_mov_b32 v83, 0
s_nop 3
s_xor_b32 s32, s18, 2048
buffer_load_dwordx4 v[32:35], v116, s[4:7], s32 offen sc1
v_mov_b32 v84, 0
v_mov_b32 v85, 0
s_nop 3
s_xor_b32 s32, s19, 2048
buffer_load_dwordx4 v[72:75], v116, s[4:7], s32 offen sc1
v_mov_b32 v86, 0
v_mov_b32 v87, 0
s_nop 3
s_xor_b32 s32, s18, 3072
buffer_load_dwordx4 v[48:51], v116, s[4:7], s32 offen sc1
v_mov_b32 v88, 0
v_mov_b32 v89, 0
s_nop 3
s_xor_b32 s32, s19, 3072
buffer_load_dwordx4 v[76:79], v116, s[4:7], s32 offen sc1
s_memtime s[40:41]
s_memrealtime s[80:81]
s_memrealtime s[82:83]
s_memrealtime s[84:85]
s_memrealtime s[86:87]
s_memrealtime s[88:89]
s_memrealtime s[90:91]
s_memrealtime s[92:93]
s_memrealtime s[94:95]
s_memrealtime s[96:97]
s_memrealtime s[98:99]
s_memrealtime s[100:101]
s_sub_u32 s32, s15, s16
s_lshr_b32 s33, s17, 1
s_min_u32 s33, s33, 3
s_ashr_i32 s32, s32, s33
s_add_u32 s11, s11, s32
s_sub_u32 s32, s16, s27
s_sub_u32 s32, s32, s39
s_ashr_i32 s32, s32, 2
s_add_u32 s39, s39, s32
s_mov_b32 s27, s16
s_mov_b32 s2, s31
v_mov_b32 v126, s11
s_add_u32 s32, s43, 1590
v_mov_b32 v127, s32
s_waitcnt lgkmcnt(0)
ds_write_b32 v116, v126 offset:18432
s_add_u32 s80, s80, s82
s_add_u32 s80, s80, s84
s_add_u32 s80, s80, s86
s_add_u32 s80, s80, s88
s_add_u32 s80, s80, s90
s_add_u32 s80, s80, s92
s_add_u32 s80, s80, s94
s_add_u32 s80, s80, s96
s_add_u32 s80, s80, s98
s_add_u32 s80, s80, s100
s_lshl1_add_u32 s80, s80, s11
s_sub_u32 s15, s40, s80
s_add_u32 s32, s15, s39
v_mov_b32 v126, s32
buffer_store_dwordx2 v[126:127], off, s[4:7], s44 offset:128 sc1
v_mov_b32 v90, 0
v_mov_b32 v91, 0
s_waitcnt vmcnt(6)
v_pk_add_f16 v0, v0, v64
v_pk_add_f16 v1, v1, v65
v_pk_add_f16 v2, v2, v66
v_pk_add_f16 v3, v3, v67
v_cmp_u_f16 vcc, v0, v2
s_cbranch_vccnz main_kernel_c3_m0_f
main_kernel_c3_m0:
v_smfmac_f32_16x16x64_f16 v[80:83], v[0:3], a[0:7], v112
ds_write_b128 v116, v[0:3] offset:3072
v_smfmac_f32_16x16x64_f16 v[84:87], v[0:3], a[128:135], v112
buffer_load_dword v123, v121, s[4:7], 0 offen sc1
s_waitcnt vmcnt(6)
v_pk_add_f16 v16, v16, v68
v_pk_add_f16 v17, v17, v69
v_pk_add_f16 v18, v18, v70
v_pk_add_f16 v19, v19, v71
v_cmp_u_f16 vcc, v16, v18
s_waitcnt lgkmcnt(0)
s_barrier
ds_read_b128 v[4:7], v116 offset:2048
s_cbranch_vccnz main_kernel_c3_m1_f
main_kernel_c3_m1:
v_smfmac_f32_16x16x64_f16 v[80:83], v[16:19], a[8:15], v112
ds_write_b128 v116, v[16:19] offset:7168
v_smfmac_f32_16x16x64_f16 v[84:87], v[16:19], a[136:143], v112
ds_read_b128 v[8:11], v116 offset:1024
v_smfmac_f32_16x16x64_f16 v[88:91], v[0:3], v[128:135], v112
ds_read_b128 v[12:15], v116 offset:0
s_waitcnt lgkmcnt(3)
v_smfmac_f32_16x16x64_f16 v[80:83], v[4:7], a[32:39], v112
v_smfmac_f32_16x16x64_f16 v[84:87], v[4:7], a[160:167], v112
v_smfmac_f32_16x16x64_f16 v[88:91], v[4:7], v[136:143], v112
s_waitcnt lgkmcnt(2)
s_barrier
s_waitcnt lgkmcnt(1)
v_smfmac_f32_16x16x64_f16 v[80:83], v[8:11], a[64:71], v112
s_waitcnt vmcnt(4)
ds_read_b128 v[20:23], v116 offset:6144
v_pk_add_f16 v32, v32, v72
v_smfmac_f32_16x16x64_f16 v[84:87], v[8:11], a[192:199], v112
ds_read_b128 v[24:27], v116 offset:5120
s_waitcnt lgkmcnt(2)
v_pk_add_f16 v33, v33, v73
v_smfmac_f32_16x16x64_f16 v[80:83], v[12:15], a[96:103], v112
ds_read_b128 v[28:31], v116 offset:4096
v_pk_add_f16 v34, v34, v74
v_smfmac_f32_16x16x64_f16 v[84:87], v[12:15], a[224:231], v112
s_waitcnt lgkmcnt(2)
v_pk_add_f16 v35, v35, v75
v_smfmac_f32_16x16x64_f16 v[80:83], v[20:23], a[40:47], v112
v_cmp_u_f16 vcc, v32, v34
v_smfmac_f32_16x16x64_f16 v[84:87], v[20:23], a[168:175], v112
ds_write_b128 v116, v[32:35] offset:11264
s_cbranch_vccnz main_kernel_c3_m2_f
main_kernel_c3_m2:
v_smfmac_f32_16x16x64_f16 v[80:83], v[32:35], a[16:23], v112
buffer_load_dwordx4 v[96:99], v116, s[4:7], s28 offen sc1
v_smfmac_f32_16x16x64_f16 v[84:87], v[32:35], a[144:151], v112
s_add_u32 s28, s28, 0x40000
s_waitcnt lgkmcnt(2)
v_smfmac_f32_16x16x64_f16 v[80:83], v[24:27], a[72:79], v112
s_waitcnt vmcnt(3)
v_pk_add_f16 v48, v48, v76
v_smfmac_f32_16x16x64_f16 v[84:87], v[24:27], a[200:207], v112
s_waitcnt lgkmcnt(0)
s_barrier
ds_read_b128 v[36:39], v116 offset:10240
v_pk_add_f16 v49, v49, v77
v_smfmac_f32_16x16x64_f16 v[80:83], v[28:31], a[104:111], v112
ds_read_b128 v[40:43], v116 offset:9216
v_pk_add_f16 v50, v50, v78
v_smfmac_f32_16x16x64_f16 v[84:87], v[28:31], a[232:239], v112
ds_read_b128 v[44:47], v116 offset:8192
v_pk_add_f16 v51, v51, v79
v_smfmac_f32_16x16x64_f16 v[88:91], v[8:11], v[144:151], v112
s_waitcnt lgkmcnt(2)
v_cmp_u_f16 vcc, v48, v50
v_smfmac_f32_16x16x64_f16 v[80:83], v[36:39], a[48:55], v112
ds_write_b128 v116, v[48:51] offset:15360
s_cbranch_vccnz main_kernel_c3_m3_f
main_kernel_c3_m3:
v_smfmac_f32_16x16x64_f16 v[80:83], v[48:51], a[24:31], v112
v_smfmac_f32_16x16x64_f16 v[84:87], v[48:51], a[152:159], v112
v_smfmac_f32_16x16x64_f16 v[84:87], v[36:39], a[176:183], v112
s_waitcnt lgkmcnt(2)
v_smfmac_f32_16x16x64_f16 v[80:83], v[40:43], a[80:87], v112
s_waitcnt lgkmcnt(0)
s_barrier
ds_read_b128 v[52:55], v116 offset:14336
v_smfmac_f32_16x16x64_f16 v[84:87], v[40:43], a[208:215], v112
s_memtime s[40:41]
ds_read_b128 v[56:59], v116 offset:13312
v_smfmac_f32_16x16x64_f16 v[80:83], v[44:47], a[112:119], v112
s_add_u32 s19, s52, s54
ds_read_b128 v[60:63], v116 offset:12288
v_smfmac_f32_16x16x64_f16 v[84:87], v[44:47], a[240:247], v112
s_add_u32 s18, s18, 0x40000
s_waitcnt lgkmcnt(2)
v_smfmac_f32_16x16x64_f16 v[80:83], v[52:55], a[56:63], v112
s_bitset0_b32 s18, 20
s_waitcnt lgkmcnt(1)
v_smfmac_f32_16x16x64_f16 v[80:83], v[56:59], a[88:95], v112
s_cmp_eq_u32 s17, 30
s_cselect_b32 s32, s53, 0x10000
s_waitcnt lgkmcnt(0)
v_smfmac_f32_16x16x64_f16 v[80:83], v[60:63], a[120:127], v112
s_add_u32 s52, s52, s32
ds_read_b128 v[64:67], v116 offset:24576
v_smfmac_f32_16x16x64_f16 v[84:87], v[52:55], a[184:191], v112
s_sub_u32 s24, 0x20000, s32
ds_read_b128 v[68:71], v116 offset:28672
v_smfmac_f32_16x16x64_f16 v[84:87], v[56:59], a[216:223], v112
ds_read_b128 v[72:75], v116 offset:25600
s_add_u32 s55, s55, s24
v_cvt_pk_bf16_f32 v92, v80, v81
v_smfmac_f32_16x16x64_f16 v[84:87], v[60:63], a[248:255], v112
ds_read_b128 v[76:79], v116 offset:29696
s_nop 0
v_cvt_pk_bf16_f32 v93, v82, v83
v_smfmac_f32_16x16x64_f16 v[88:91], v[12:15], v[152:159], v112
s_nop 3
v_cvt_pk_bf16_f32 v94, v84, v85
v_cvt_pk_bf16_f32 v95, v86, v87
s_mov_b32 vcc_lo, 0xcccccccc
s_mov_b32 vcc_hi, 0xcccccccc
v_mfma_f32_16x16x32_bf16 v[84:87], v[92:95], v[104:107], 0
v_add_u32 v121, v121, v122
s_waitcnt lgkmcnt(0)
s_sub_u32 s31, s40, s11
v_smfmac_f32_16x16x64_f16 v[88:91], v[16:19], v[160:167], v112
s_sub_u32 s32, s31, s43
s_sub_u32 s47, 1590, s32
s_max_i32 s47, s47, 0
s_cmp_eq_u32 s17, 63
v_cvt_pk_bf16_f32 v114, v84, v85
v_cvt_pk_bf16_f32 v115, v86, v87
buffer_store_dwordx2 v[114:115], v117, s[4:7], s21 offen
s_cbranch_scc1 main_kernel_c3_last
ds_write_b64 v117, v[114:115] offset:17920
v_smfmac_f32_16x16x64_f16 v[88:91], v[20:23], v[168:175], v112
s_cmp_gt_u32 s32, 1690
s_cselect_b32 s33, 900, s47
v_smfmac_f32_16x16x64_f16 v[88:91], v[24:27], v[176:183], v112
s_add_u32 s10, s33, s31
s_andn2_b32 s42, s44, 0x1f00
v_mov_b32 v126, s15
v_smfmac_f32_16x16x64_f16 v[88:91], v[28:31], v[184:191], v112
s_add_u32 s42, s42, 0x4000
v_mov_b32 v127, s10
v_smfmac_f32_16x16x64_f16 v[88:91], v[32:35], v[192:199], v112
.p2align 3
main_kernel_c3_b21:
s_sub_u32 s47, s47, 28
s_cbranch_scc0 main_kernel_c3_b21
s_waitcnt lgkmcnt(0)
s_barrier
ds_read_b128 v[0:3], v116 offset:16384
v_smfmac_f32_16x16x64_f16 v[88:91], v[36:39], v[200:207], v112
ds_read_b128 v[4:7], v116 offset:17408
buffer_store_dwordx2 v[126:127], off, s[4:7], s46
v_smfmac_f32_16x16x64_f16 v[88:91], v[40:43], v[208:215], v112
ds_read_b128 v[16:19], v116 offset:26624
s_cmp_gt_u32 s32, 1690
s_cselect_b32 s80, s44, 0x7f000000
v_smfmac_f32_16x16x64_f16 v[88:91], v[44:47], v[216:223], v112
ds_read_b128 v[20:23], v116 offset:30720
v_writelane_b32 v121, s55, 39
v_smfmac_f32_16x16x64_f16 v[88:91], v[48:51], v[224:231], v112
ds_read_b128 v[24:27], v116 offset:27648
v_smfmac_f32_16x16x64_f16 v[88:91], v[52:55], v[232:239], v112
ds_read_b128 v[28:31], v116 offset:31744
v_smfmac_f32_16x16x64_f16 v[88:91], v[56:59], v[240:247], v112
v_smfmac_f32_16x16x64_f16 v[88:91], v[60:63], v[248:255], v112
s_waitcnt lgkmcnt(5)
v_mfma_f32_16x16x32_bf16 v[80:83], v[64:67], v[0:3], 0
v_mfma_f32_16x16x32_bf16 v[84:87], v[68:71], v[0:3], 0
buffer_load_dwordx4 v[8:11], v116, s[4:7], s20 offen offset:0 sc1
v_mfma_f32_16x16x32_bf16 v[92:95], v[0:3], v[0:3], 0
buffer_load_dwordx4 v[12:15], v116, s[4:7], s20 offen offset:1024 sc1
v_permlane32_swap_b32 v88, v90
s_waitcnt lgkmcnt(4)
v_mfma_f32_16x16x32_bf16 v[80:83], v[72:75], v[4:7], v[80:83]
v_permlane32_swap_b32 v89, v91
v_mfma_f32_16x16x32_bf16 v[84:87], v[76:79], v[4:7], v[84:87]
v_pk_add_f32 v[88:89], v[88:89], v[90:91]
v_mfma_f32_16x16x32_bf16 v[92:95], v[4:7], v[4:7], v[92:95]
v_cvt_pk_bf16_f32 v124, v88, v89
s_andn2_b32 s35, s46, 0xff
v_bfe_u32 v68, v116, 1, 8
v_mov_b32 v65, 0
buffer_load_dwordx2 v[66:67], v68, s[4:7], s35 offen sc1
buffer_store_dword v127, off, s[4:7], s80 offset:132 sc1
s_waitcnt lgkmcnt(0)
s_waitcnt vmcnt(3)
v_mfma_f32_16x16x32_bf16 v[88:91], v[8:11], v[8:11], v[92:95]
v_mfma_f32_16x16x32_bf16 v[0:3], v[16:19], v[8:11], v[80:83]
v_cmp_u_f32 s[0:1], v8, v10
v_mfma_f32_16x16x32_bf16 v[4:7], v[20:23], v[8:11], v[84:87]
s_waitcnt vmcnt(2)
v_mfma_f32_16x16x32_bf16 v[88:91], v[12:15], v[12:15], v[88:91]
v_mfma_f32_16x16x32_bf16 v[0:3], v[24:27], v[12:15], v[0:3]
v_cmp_u_f32 s[32:33], v12, v14
v_mfma_f32_16x16x32_bf16 v[4:7], v[28:31], v[12:15], v[4:7]
s_or_b64 s[0:1], s[0:1], s[32:33]
s_cbranch_scc1 main_kernel_c3_z_f
main_kernel_c3_z:
v_mul_f32 v88, s30, v88
v_mul_f32 v89, s30, v89
v_exp_f32 v88, v88
v_exp_f32 v89, v89
v_cndmask_b32_dpp v0, v2, v0, vcc quad_perm:[2,3,2,3] row_mask:0xf bank_mask:0xf
v_cvt_pk_bf16_f32 v64, v88, v89
v_cndmask_b32_dpp v1, v3, v1, vcc quad_perm:[2,3,2,3] row_mask:0xf bank_mask:0xf
v_exp_f32 v0, v0
v_mfma_f32_16x16x16_bf16 v[16:19], v[100:101], v[64:65], 0
v_exp_f32 v1, v1
v_cndmask_b32_dpp v4, v6, v4, vcc quad_perm:[2,3,2,3] row_mask:0xf bank_mask:0xf
v_mfma_f32_16x16x16_bf16 v[8:11], v[124:125], v[64:65], 0
v_cndmask_b32_dpp v5, v7, v5, vcc quad_perm:[2,3,2,3] row_mask:0xf bank_mask:0xf
v_exp_f32 v4, v4
v_exp_f32 v5, v5
v_cvt_pk_bf16_f32 v92, v0, v1
v_cvt_pk_bf16_f32 v94, v4, v5
v_mov_b32 v80, 0
v_mov_b32_dpp v93, v92 quad_perm:[0,1,0,1] row_mask:0xf bank_mask:0xf
v_mov_b32_dpp v95, v94 quad_perm:[0,1,0,1] row_mask:0xf bank_mask:0xf
v_mov_b32 v81, 0
v_mov_b32 v82, 0
v_mfma_f32_16x16x32_bf16 v[16:19], v[100:103], v[92:95], v[16:19]
v_mov_b32 v83, 0
v_mov_b32 v84, 0
v_mfma_f32_16x16x32_bf16 v[8:11], v[96:99], v[92:95], v[8:11]
s_buffer_load_dword s42, s[4:7], s42
s_nop 1
v_mov_b32 v85, 0
v_mov_b32 v86, 0
v_mov_b32 v87, 0
v_rcp_f32 v126, v16
v_subrev_u32 v127, 0x21800000, v16
v_cmp_lt_u32 vcc, 0x3c000000, v127
v_pk_mul_f32 v[8:9], v[8:9], v[126:127] op_sel_hi:[1,0]
v_pk_mul_f32 v[10:11], v[10:11], v[126:127] op_sel_hi:[1,0]
s_and_b32 s32, vcc_lo, 0xcccc
v_cvt_pk_bf16_f32 v126, v8, v9
v_cvt_pk_bf16_f32 v127, v10, v11
s_cbranch_scc1 main_kernel_c3_sm_f
main_kernel_c3_ost:
buffer_store_dwordx2 v[126:127], v118, s[4:7], s22 offen
s_waitcnt vmcnt(2)
main_kernel_c3_to0:
s_memtime s[40:41]
v_readlane_b32 s16, v66, 0
v_subrev_u32 v67, s2, v67
s_add_u32 s34, s11, s2
s_nop 0
v_max_u32_dpp v67, v67, v67 row_ror:8 row_mask:0xf bank_mask:0xf
s_nop 1
v_max_u32_dpp v67, v67, v67 row_ror:4 row_mask:0xf bank_mask:0xf
s_nop 1
v_max_u32_dpp v67, v67, v67 row_ror:2 row_mask:0xf bank_mask:0xf
s_nop 1
v_max_u32_dpp v67, v67, v67 row_ror:1 row_mask:0xf bank_mask:0xf
s_waitcnt lgkmcnt(0)
v_readlane_b32 s32, v67, 0
v_readlane_b32 s33, v67, 16
s_sub_u32 s34, s40, s34
s_max_u32 s32, s32, s33
s_add_u32 s35, s34, 1536
s_cmp_gt_u32 s32, s35
s_cbranch_scc1 main_kernel_c3_to2
main_kernel_c3_to3:
s_sub_u32 s33, s42, s2
s_cmp_le_u32 s33, s35
s_cselect_b32 s33, s33, 0
s_max_u32 s32, s32, s33
s_add_u32 s36, s32, 2850
s_add_u32 s32, s32, 1270
s_sub_u32 s47, s32, s34
s_max_i32 s47, s47, 0
.p2align 3
main_kernel_c3_to1:
s_sub_u32 s47, s47, 28
s_cbranch_scc0 main_kernel_c3_to1
s_barrier
buffer_load_dwordx4 v[0:3], v116, s[4:7], s23 offen sc1
ds_read_b128 v[32:35], v113 offset:0
ds_read_b128 v[36:39], v113 offset:1024
s_add_u32 s46, s46, 0x40000
s_bitset0_b32 s46, 20
s_add_u32 s37, s37, 65536
s_add_u32 s26, s26, 65536
s_xor_b32 s32, s23, 1024
buffer_load_dwordx4 v[4:7], v116, s[4:7], s32 offen sc1
ds_read_b128 v[40:43], v113 offset:2048
ds_read_b128 v[44:47], v113 offset:3072
s_add_u32 s44, s44, s24
s_nop 2
s_xor_b32 s32, s23, 2048
buffer_load_dwordx4 v[8:11], v116, s[4:7], s32 offen sc1
ds_read_b128 v[48:51], v113 offset:4096
ds_read_b128 v[52:55], v113 offset:5120
s_nop 3
s_xor_b32 s32, s23, 3072
buffer_load_dwordx4 v[12:15], v116, s[4:7], s32 offen sc1
ds_read_b128 v[56:59], v113 offset:6144
ds_read_b128 v[60:63], v113 offset:7168
s_nop 3
s_xor_b32 s32, s23, 4096
buffer_load_dwordx4 v[16:19], v116, s[4:7], s32 offen sc1
ds_read_b128 v[64:67], v113 offset:8192
ds_read_b128 v[68:71], v113 offset:9216
s_nop 3
s_xor_b32 s32, s23, 5120
buffer_load_dwordx4 v[20:23], v116, s[4:7], s32 offen sc1
ds_read_b128 v[72:75], v113 offset:10240
ds_read_b128 v[76:79], v113 offset:11264
s_nop 3
s_xor_b32 s32, s23, 6144
buffer_load_dwordx4 v[24:27], v116, s[4:7], s32 offen sc1
ds_read_b128 v[88:91], v113 offset:12288
ds_read_b128 v[92:95], v113 offset:13312
s_nop 3
s_xor_b32 s32, s23, 7168
buffer_load_dwordx4 v[28:31], v116, s[4:7], s32 offen sc1
v_and_b32 v127, 0x1f0, v116
v_lshlrev_b32 v127, 4, v127
s_waitcnt lgkmcnt(12)
s_waitcnt vmcnt(7)
v_cmp_u_f32 vcc, v0, v2
s_cbranch_vccnz main_kernel_c3_o0_f
main_kernel_c3_o0:
v_smfmac_f32_16x16x64_bf16 v[80:83], v[0:3], v[32:39], v112
ds_read_b128 v[32:35], v113 offset:14336
ds_read_b128 v[36:39], v113 offset:15360
buffer_load_dwordx2 v[96:97], v127, s[4:7], s45 offen offset:128 sc1
s_waitcnt lgkmcnt(12)
s_waitcnt vmcnt(7)
v_cmp_u_f32 vcc, v4, v6
v_smfmac_f32_16x16x64_bf16 v[84:87], v[0:3], v[40:47], v112
ds_read_b128 v[40:43], v113 offset:16384
ds_read_b128 v[44:47], v113 offset:17408
buffer_store_dwordx2 v[114:115], v119, s[4:7], s37 offen sc1
s_cbranch_vccnz main_kernel_c3_o1_f
main_kernel_c3_o1:
s_waitcnt lgkmcnt(12)
v_smfmac_f32_16x16x64_bf16 v[80:83], v[4:7], v[48:55], v112
ds_read_b128 v[48:51], v113 offset:18432
ds_read_b128 v[52:55], v113 offset:19456
s_waitcnt lgkmcnt(12)
s_waitcnt vmcnt(7)
v_cmp_u_f32 vcc, v8, v10
v_smfmac_f32_16x16x64_bf16 v[84:87], v[4:7], v[56:63], v112
ds_read_b128 v[56:59], v113 offset:20480
ds_read_b128 v[60:63], v113 offset:21504
buffer_store_dword v124, v120, s[4:7], s26 offen sc1
s_cbranch_vccnz main_kernel_c3_o2_f
main_kernel_c3_o2:
s_waitcnt lgkmcnt(12)
v_smfmac_f32_16x16x64_bf16 v[80:83], v[8:11], v[64:71], v112
ds_read_b128 v[64:67], v113 offset:22528
ds_read_b128 v[68:71], v113 offset:23552
s_waitcnt lgkmcnt(12)
s_waitcnt vmcnt(7)
v_cmp_u_f32 vcc, v12, v14
v_smfmac_f32_16x16x64_bf16 v[84:87], v[8:11], v[72:79], v112
ds_read_b128 v[72:75], v113 offset:24576
ds_read_b128 v[76:79], v113 offset:25600
s_cbranch_vccnz main_kernel_c3_o3_f
main_kernel_c3_o3:
s_waitcnt lgkmcnt(12)
v_smfmac_f32_16x16x64_bf16 v[80:83], v[12:15], v[88:95], v112
ds_read_b128 v[88:91], v113 offset:26624
ds_read_b128 v[92:95], v113 offset:27648
s_waitcnt lgkmcnt(12)
s_waitcnt vmcnt(6)
v_cmp_u_f32 vcc, v16, v18
v_smfmac_f32_16x16x64_bf16 v[84:87], v[12:15], v[32:39], v112
ds_read_b128 v[32:35], v113 offset:28672
ds_read_b128 v[36:39], v113 offset:29696
s_cbranch_vccnz main_kernel_c3_o4_f
main_kernel_c3_o4:
s_waitcnt lgkmcnt(12)
v_smfmac_f32_16x16x64_bf16 v[80:83], v[16:19], v[40:47], v112
ds_read_b128 v[40:43], v113 offset:30720
ds_read_b128 v[44:47], v113 offset:31744
s_waitcnt lgkmcnt(12)
s_waitcnt vmcnt(5)
v_cmp_u_f32 vcc, v20, v22
v_smfmac_f32_16x16x64_bf16 v[84:87], v[16:19], v[48:55], v112
s_cbranch_vccnz main_kernel_c3_o5_f
main_kernel_c3_o5:
s_waitcnt lgkmcnt(10)
v_smfmac_f32_16x16x64_bf16 v[80:83], v[20:23], v[56:63], v112
s_waitcnt lgkmcnt(8)
s_waitcnt vmcnt(4)
v_cmp_u_f32 vcc, v24, v26
v_smfmac_f32_16x16x64_bf16 v[84:87], v[20:23], v[64:71], v112
s_cbranch_vccnz main_kernel_c3_o6_f
main_kernel_c3_o6:
s_waitcnt lgkmcnt(6)
v_smfmac_f32_16x16x64_bf16 v[80:83], v[24:27], v[72:79], v112
s_waitcnt lgkmcnt(4)
v_smfmac_f32_16x16x64_bf16 v[84:87], v[24:27], v[88:95], v112
s_waitcnt lgkmcnt(2)
s_waitcnt vmcnt(3)
v_cmp_u_f32 vcc, v28, v30
s_cbranch_vccnz main_kernel_c3_o7_f
main_kernel_c3_o7:
v_smfmac_f32_16x16x64_bf16 v[80:83], v[28:31], v[32:39], v112
s_waitcnt lgkmcnt(0)
v_smfmac_f32_16x16x64_bf16 v[84:87], v[28:31], v[40:47], v112
s_nop 4
v_cvt_pk_bf16_f32 v80, v80, v81
v_cvt_pk_bf16_f32 v81, v82, v83
ds_write_b64 v116, v[80:81] offset:21512
v_cvt_pk_bf16_f32 v82, v84, v85
v_cvt_pk_bf16_f32 v83, v86, v87
ds_write_b64 v116, v[82:83] offset:23560
s_waitcnt lgkmcnt(0)
s_barrier
ds_read_b128 v[72:75], v116 offset:22528
ds_read_b128 v[76:79], v116 offset:23552
s_waitcnt lgkmcnt(1)
v_mfma_f32_16x16x32_bf16 v[64:67], v[72:75], v[108:111], 0
s_waitcnt lgkmcnt(0)
v_mfma_f32_16x16x32_bf16 v[64:67], v[76:79], v[108:111], v[64:67]
s_nop 7
v_cvt_pk_f16_f32 v68, v64, v65
v_cvt_pk_f16_f32 v69, v66, v67
buffer_store_dwordx2 v[68:69], v125, s[4:7], s25 offen
s_sub_u32 s0, s2, s16
s_sub_u32 s0, s0, s39
s_waitcnt vmcnt(3)
main_kernel_c3_tm0:
s_memtime s[40:41]
v_sub_u32 v97, v97, v96
v_subrev_u32 v97, s0, v97
s_add_u32 s34, s11, s2
s_nop 0
v_max_u32_dpp v97, v97, v97 row_ror:8 row_mask:0xf bank_mask:0xf
s_nop 1
v_max_u32_dpp v97, v97, v97 row_ror:4 row_mask:0xf bank_mask:0xf
s_nop 1
v_max_u32_dpp v97, v97, v97 row_ror:2 row_mask:0xf bank_mask:0xf
s_nop 1
v_max_u32_dpp v97, v97, v97 row_ror:1 row_mask:0xf bank_mask:0xf
s_waitcnt lgkmcnt(0)
v_readlane_b32 s32, v97, 0
v_readlane_b32 s33, v97, 16
s_sub_u32 s34, s40, s34
s_max_u32 s32, s32, s33
s_add_u32 s35, s34, 1536
s_cmp_gt_u32 s32, s35
s_cbranch_scc1 main_kernel_c3_tm2
main_kernel_c3_tm3:
s_add_u32 s32, s32, 2850
s_max_u32 s32, s32, s36
s_add_u32 s43, s32, s2
s_sub_u32 s47, s32, s34
s_max_i32 s47, s47, 0
.p2align 3
main_kernel_c3_tm1:
s_sub_u32 s47, s47, 28
s_cbranch_scc0 main_kernel_c3_tm1
s_add_u32 s45, s45, s24
s_branch main_kernel_c3_top
main_kernel_c3_to2:
s_mov_b32 s32, s34
s_mov_b32 s16, s15
s_cmp_gt_u32 s34, 0x40000
s_cbranch_scc1 main_kernel_c3_to3
s_andn2_b32 s35, s46, 0xff
v_bfe_u32 v68, v116, 1, 8
buffer_load_dwordx2 v[66:67], v68, s[4:7], s35 offen sc1
s_sub_u32 s29, s29, 1
s_cbranch_scc1 main_kernel_end
s_waitcnt vmcnt(0)
s_branch main_kernel_c3_to0
main_kernel_c3_tm2:
s_mov_b32 s32, s34
s_cmp_gt_u32 s34, 0x40000
s_cbranch_scc1 main_kernel_c3_tm3
v_and_b32 v127, 0x1f0, v116
v_lshlrev_b32 v127, 4, v127
buffer_load_dwordx2 v[96:97], v127, s[4:7], s45 offen offset:128 sc1
s_sub_u32 s29, s29, 1
s_cbranch_scc1 main_kernel_end
s_waitcnt vmcnt(0)
s_branch main_kernel_c3_tm0
main_kernel_c3_last:
s_add_u32 s37, s37, 65536
s_add_u32 s26, s26, 65536
buffer_store_dwordx2 v[114:115], v119, s[4:7], s37 offen sc1
v_smfmac_f32_16x16x64_f16 v[88:91], v[20:23], v[168:175], v112
v_smfmac_f32_16x16x64_f16 v[88:91], v[24:27], v[176:183], v112
v_smfmac_f32_16x16x64_f16 v[88:91], v[28:31], v[184:191], v112
v_smfmac_f32_16x16x64_f16 v[88:91], v[32:35], v[192:199], v112
v_smfmac_f32_16x16x64_f16 v[88:91], v[36:39], v[200:207], v112
v_smfmac_f32_16x16x64_f16 v[88:91], v[40:43], v[208:215], v112
v_smfmac_f32_16x16x64_f16 v[88:91], v[44:47], v[216:223], v112
v_smfmac_f32_16x16x64_f16 v[88:91], v[48:51], v[224:231], v112
v_smfmac_f32_16x16x64_f16 v[88:91], v[52:55], v[232:239], v112
v_smfmac_f32_16x16x64_f16 v[88:91], v[56:59], v[240:247], v112
v_smfmac_f32_16x16x64_f16 v[88:91], v[60:63], v[248:255], v112
s_nop 7
v_permlane32_swap_b32 v88, v90
s_nop 1
v_permlane32_swap_b32 v89, v91
s_nop 1
v_pk_add_f32 v[88:89], v[88:89], v[90:91]
s_nop 1
v_cvt_pk_bf16_f32 v124, v88, v89
s_nop 1
buffer_store_dword v124, v120, s[4:7], s26 offen sc1
s_branch main_kernel_end
main_kernel_c3_m0_f:
s_waitcnt lgkmcnt(0)
buffer_load_dwordx4 v[0:3], v116, s[4:7], s18 offen sc1
buffer_load_dwordx4 v[64:67], v116, s[4:7], s19 offen sc1
s_xor_b32 s32, s18, 1024
buffer_load_dwordx4 v[16:19], v116, s[4:7], s32 offen sc1
s_xor_b32 s32, s19, 1024
buffer_load_dwordx4 v[68:71], v116, s[4:7], s32 offen sc1
s_xor_b32 s32, s18, 2048
buffer_load_dwordx4 v[32:35], v116, s[4:7], s32 offen sc1
s_xor_b32 s32, s19, 2048
buffer_load_dwordx4 v[72:75], v116, s[4:7], s32 offen sc1
s_xor_b32 s32, s18, 3072
buffer_load_dwordx4 v[48:51], v116, s[4:7], s32 offen sc1
s_xor_b32 s32, s19, 3072
buffer_load_dwordx4 v[76:79], v116, s[4:7], s32 offen sc1
s_sub_u32 s29, s29, 1
s_cbranch_scc1 main_kernel_end
s_waitcnt vmcnt(0)
v_max_u32 v126, v0, v2
v_max3_u32 v126, v126, v64, v66
v_cmp_eq_u32 vcc, -1, v126
s_cbranch_vccnz main_kernel_c3_m0_f
v_pk_add_f16 v0, v0, v64
v_pk_add_f16 v1, v1, v65
v_pk_add_f16 v2, v2, v66
v_pk_add_f16 v3, v3, v67
s_nop 0
s_branch main_kernel_c3_m0
main_kernel_c3_m1_f:
s_waitcnt lgkmcnt(0)
s_xor_b32 s32, s18, 1024
buffer_load_dwordx4 v[16:19], v116, s[4:7], s32 offen sc1
s_xor_b32 s32, s19, 1024
buffer_load_dwordx4 v[68:71], v116, s[4:7], s32 offen sc1
s_xor_b32 s32, s18, 2048
buffer_load_dwordx4 v[32:35], v116, s[4:7], s32 offen sc1
s_xor_b32 s32, s19, 2048
buffer_load_dwordx4 v[72:75], v116, s[4:7], s32 offen sc1
s_xor_b32 s32, s18, 3072
buffer_load_dwordx4 v[48:51], v116, s[4:7], s32 offen sc1
s_xor_b32 s32, s19, 3072
buffer_load_dwordx4 v[76:79], v116, s[4:7], s32 offen sc1
s_sub_u32 s29, s29, 1
s_cbranch_scc1 main_kernel_end
s_waitcnt vmcnt(0)
v_max_u32 v126, v16, v18
v_max3_u32 v126, v126, v68, v70
v_cmp_eq_u32 vcc, -1, v126
s_cbranch_vccnz main_kernel_c3_m1_f
v_pk_add_f16 v16, v16, v68
v_pk_add_f16 v17, v17, v69
v_pk_add_f16 v18, v18, v70
v_pk_add_f16 v19, v19, v71
s_nop 0
s_branch main_kernel_c3_m1
main_kernel_c3_m2_f:
s_waitcnt lgkmcnt(0)
s_xor_b32 s32, s18, 2048
buffer_load_dwordx4 v[32:35], v116, s[4:7], s32 offen sc1
s_xor_b32 s32, s19, 2048
buffer_load_dwordx4 v[72:75], v116, s[4:7], s32 offen sc1
s_xor_b32 s32, s18, 3072
buffer_load_dwordx4 v[48:51], v116, s[4:7], s32 offen sc1
s_xor_b32 s32, s19, 3072
buffer_load_dwordx4 v[76:79], v116, s[4:7], s32 offen sc1
s_sub_u32 s29, s29, 1
s_cbranch_scc1 main_kernel_end
s_waitcnt vmcnt(0)
v_max_u32 v126, v32, v34
v_max3_u32 v126, v126, v72, v74
v_cmp_eq_u32 vcc, -1, v126
s_cbranch_vccnz main_kernel_c3_m2_f
v_pk_add_f16 v32, v32, v72
v_pk_add_f16 v33, v33, v73
v_pk_add_f16 v34, v34, v74
v_pk_add_f16 v35, v35, v75
ds_write_b128 v116, v[32:35] offset:11264
s_branch main_kernel_c3_m2
main_kernel_c3_m3_f:
s_waitcnt lgkmcnt(0)
s_xor_b32 s32, s18, 3072
buffer_load_dwordx4 v[48:51], v116, s[4:7], s32 offen sc1
s_xor_b32 s32, s19, 3072
buffer_load_dwordx4 v[76:79], v116, s[4:7], s32 offen sc1
s_sub_u32 s29, s29, 1
s_cbranch_scc1 main_kernel_end
s_waitcnt vmcnt(0)
v_max_u32 v126, v48, v50
v_max3_u32 v126, v126, v76, v78
v_cmp_eq_u32 vcc, -1, v126
s_cbranch_vccnz main_kernel_c3_m3_f
v_pk_add_f16 v48, v48, v76
v_pk_add_f16 v49, v49, v77
v_pk_add_f16 v50, v50, v78
v_pk_add_f16 v51, v51, v79
ds_write_b128 v116, v[48:51] offset:15360
s_branch main_kernel_c3_m3
main_kernel_c3_z_f:
buffer_load_dwordx4 v[8:11], v116, s[4:7], s20 offen offset:0 sc1
buffer_load_dwordx4 v[12:15], v116, s[4:7], s20 offen offset:1024 sc1
s_memtime s[32:33]
ds_read_b32 v126, v116 offset:18432
s_sub_u32 s34, s19, s54
s_xor_b32 s34, s34, 0x2000
s_lshl_b32 s35, s12, 15
s_add_u32 s34, s34, s35
s_lshl_b32 s35, s13, 8
s_add_u32 s35, s35, s34
s_add_u32 s34, s34, 0x4000
s_waitcnt lgkmcnt(0)
s_sub_u32 s32, s32, 450
v_sub_u32 v126, s32, v126
v_max_u32 v127, v126, v127
buffer_store_dword v127, off, s[4:7], s34
s_sub_u32 s29, s29, 1
s_cbranch_scc1 main_kernel_end
s_waitcnt vmcnt(1)
main_kernel_c3_z_g:
v_max_u32 v126, v8, v10
v_max3_u32 v126, v126, v12, v14
v_cmp_eq_u32 vcc, -1, v126
s_cbranch_vccnz main_kernel_c3_z_h
v_mfma_f32_16x16x32_bf16 v[88:91], v[8:11], v[8:11], v[92:95]
v_mfma_f32_16x16x32_bf16 v[0:3], v[16:19], v[8:11], v[80:83]
v_mfma_f32_16x16x32_bf16 v[4:7], v[20:23], v[8:11], v[84:87]
v_mfma_f32_16x16x32_bf16 v[88:91], v[12:15], v[12:15], v[88:91]
v_mfma_f32_16x16x32_bf16 v[0:3], v[24:27], v[12:15], v[0:3]
v_mfma_f32_16x16x32_bf16 v[4:7], v[28:31], v[12:15], v[4:7]
buffer_store_dword v127, off, s[4:7], s35 offset:132 sc1
s_mov_b32 vcc_lo, 0xcccccccc
s_mov_b32 vcc_hi, 0xcccccccc
s_branch main_kernel_c3_z
main_kernel_c3_z_h:
buffer_load_dwordx4 v[8:11], v116, s[4:7], s20 offen offset:0 sc1
buffer_load_dwordx4 v[12:15], v116, s[4:7], s20 offen offset:1024 sc1
s_sub_u32 s29, s29, 1
s_cbranch_scc1 main_kernel_end
v_add_u32 v127, 300, v127
s_waitcnt vmcnt(0)
s_branch main_kernel_c3_z_g
main_kernel_c3_sm_f:
s_waitcnt vmcnt(0) lgkmcnt(0)
buffer_load_dwordx4 v[8:11], v116, s[4:7], s20 offen offset:0 sc1
buffer_load_dwordx4 v[12:15], v116, s[4:7], s20 offen offset:1024 sc1
ds_read_b128 v[0:3], v116 offset:16384
ds_read_b128 v[4:7], v116 offset:17408
ds_read_b128 v[64:67], v116 offset:24576
ds_read_b128 v[68:71], v116 offset:28672
ds_read_b128 v[72:75], v116 offset:25600
ds_read_b128 v[76:79], v116 offset:29696
ds_read_b128 v[16:19], v116 offset:26624
ds_read_b128 v[20:23], v116 offset:30720
ds_read_b128 v[24:27], v116 offset:27648
ds_read_b128 v[28:31], v116 offset:31744
s_waitcnt vmcnt(0)
s_waitcnt lgkmcnt(0)
v_mfma_f32_16x16x32_bf16 v[80:83], v[64:67], v[0:3], 0
v_mfma_f32_16x16x32_bf16 v[84:87], v[68:71], v[0:3], 0
v_mfma_f32_16x16x32_bf16 v[92:95], v[0:3], v[0:3], 0
v_mfma_f32_16x16x32_bf16 v[80:83], v[72:75], v[4:7], v[80:83]
v_mfma_f32_16x16x32_bf16 v[84:87], v[76:79], v[4:7], v[84:87]
v_mfma_f32_16x16x32_bf16 v[92:95], v[4:7], v[4:7], v[92:95]
v_mfma_f32_16x16x32_bf16 v[0:3], v[16:19], v[8:11], v[80:83]
v_mfma_f32_16x16x32_bf16 v[4:7], v[20:23], v[8:11], v[84:87]
v_mfma_f32_16x16x32_bf16 v[88:91], v[8:11], v[8:11], v[92:95]
v_mfma_f32_16x16x32_bf16 v[0:3], v[24:27], v[12:15], v[0:3]
v_mfma_f32_16x16x32_bf16 v[4:7], v[28:31], v[12:15], v[4:7]
v_mfma_f32_16x16x32_bf16 v[88:91], v[12:15], v[12:15], v[88:91]
s_nop 7
v_mov_b32 v65, 0
v_max_f32 v126, v88, v89
v_mul_f32 v126, s30, v126
v_max3_f32 v126, v126, v0, v1
v_max3_f32 v126, v126, v2, v3
v_max3_f32 v126, v126, v4, v5
v_max3_f32 v126, v126, v6, v7
v_mov_b32 v127, v126
s_nop 1
v_permlane32_swap_b32 v126, v127
v_max_f32 v126, v126, v127
v_mov_b32 v127, v126
s_nop 1
v_permlane16_swap_b32 v126, v127
v_max_f32 v126, v126, v127
v_mul_f32 v127, 0x40faf233, v126
s_mov_b32 vcc_lo, 0xcccccccc
s_mov_b32 vcc_hi, 0xcccccccc
v_sub_f32 v0, v0, v126
v_sub_f32 v1, v1, v126
v_sub_f32 v2, v2, v126
v_sub_f32 v3, v3, v126
v_sub_f32 v4, v4, v126
v_sub_f32 v5, v5, v126
v_sub_f32 v6, v6, v126
v_sub_f32 v7, v7, v126
v_sub_f32 v88, v88, v127
v_sub_f32 v89, v89, v127
s_waitcnt lgkmcnt(0)
s_nop 0
v_mul_f32 v88, s30, v88
v_mul_f32 v89, s30, v89
v_exp_f32 v88, v88
v_exp_f32 v89, v89
v_cndmask_b32_dpp v0, v2, v0, vcc quad_perm:[2,3,2,3] row_mask:0xf bank_mask:0xf
v_cvt_pk_bf16_f32 v64, v88, v89
v_cndmask_b32_dpp v1, v3, v1, vcc quad_perm:[2,3,2,3] row_mask:0xf bank_mask:0xf
v_exp_f32 v0, v0
v_mfma_f32_16x16x16_bf16 v[16:19], v[100:101], v[64:65], 0
v_exp_f32 v1, v1
v_cndmask_b32_dpp v4, v6, v4, vcc quad_perm:[2,3,2,3] row_mask:0xf bank_mask:0xf
v_mfma_f32_16x16x16_bf16 v[8:11], v[124:125], v[64:65], 0
v_cndmask_b32_dpp v5, v7, v5, vcc quad_perm:[2,3,2,3] row_mask:0xf bank_mask:0xf
v_exp_f32 v4, v4
v_exp_f32 v5, v5
v_cvt_pk_bf16_f32 v92, v0, v1
v_cvt_pk_bf16_f32 v94, v4, v5
v_mov_b32 v80, 0
v_mov_b32_dpp v93, v92 quad_perm:[0,1,0,1] row_mask:0xf bank_mask:0xf
v_mov_b32_dpp v95, v94 quad_perm:[0,1,0,1] row_mask:0xf bank_mask:0xf
v_mov_b32 v81, 0
v_mov_b32 v82, 0
v_mfma_f32_16x16x32_bf16 v[16:19], v[100:103], v[92:95], v[16:19]
v_mov_b32 v83, 0
v_mov_b32 v84, 0
v_mfma_f32_16x16x32_bf16 v[8:11], v[96:99], v[92:95], v[8:11]
s_nop 1
v_mov_b32 v85, 0
v_mov_b32 v86, 0
v_mov_b32 v87, 0
v_rcp_f32 v126, v16
v_subrev_u32 v127, 0x21800000, v16
v_cmp_lt_u32 vcc, 0x3c000000, v127
v_pk_mul_f32 v[8:9], v[8:9], v[126:127] op_sel_hi:[1,0]
v_pk_mul_f32 v[10:11], v[10:11], v[126:127] op_sel_hi:[1,0]
s_and_b32 s32, vcc_lo, 0xcccc
v_cvt_pk_bf16_f32 v126, v8, v9
v_cvt_pk_bf16_f32 v127, v10, v11
s_andn2_b32 s35, s46, 0xff
v_bfe_u32 v68, v116, 1, 8
buffer_load_dwordx2 v[66:67], v68, s[4:7], s35 offen sc1
s_waitcnt vmcnt(0)
s_branch main_kernel_c3_ost
main_kernel_c3_o0_f:
s_nop 0
buffer_load_dwordx4 v[0:3], v116, s[4:7], s23 offen sc1
s_xor_b32 s32, s23, 1024
buffer_load_dwordx4 v[4:7], v116, s[4:7], s32 offen sc1
s_sub_u32 s29, s29, 1
s_cbranch_scc1 main_kernel_end
s_waitcnt vmcnt(0)
v_max_u32 v126, v0, v2
v_cmp_eq_u32 vcc, -1, v126
s_cbranch_vccnz main_kernel_c3_o0_f
s_branch main_kernel_c3_o0
main_kernel_c3_o1_f:
s_nop 0
s_xor_b32 s32, s23, 1024
buffer_load_dwordx4 v[4:7], v116, s[4:7], s32 offen sc1
s_xor_b32 s32, s23, 2048
buffer_load_dwordx4 v[8:11], v116, s[4:7], s32 offen sc1
s_sub_u32 s29, s29, 1
s_cbranch_scc1 main_kernel_end
s_waitcnt vmcnt(0)
v_max_u32 v126, v4, v6
v_cmp_eq_u32 vcc, -1, v126
s_cbranch_vccnz main_kernel_c3_o1_f
s_branch main_kernel_c3_o1
main_kernel_c3_o2_f:
s_nop 0
s_xor_b32 s32, s23, 2048
buffer_load_dwordx4 v[8:11], v116, s[4:7], s32 offen sc1
s_xor_b32 s32, s23, 3072
buffer_load_dwordx4 v[12:15], v116, s[4:7], s32 offen sc1
s_sub_u32 s29, s29, 1
s_cbranch_scc1 main_kernel_end
s_waitcnt vmcnt(0)
v_max_u32 v126, v8, v10
v_cmp_eq_u32 vcc, -1, v126
s_cbranch_vccnz main_kernel_c3_o2_f
s_branch main_kernel_c3_o2
main_kernel_c3_o3_f:
s_nop 0
s_xor_b32 s32, s23, 3072
buffer_load_dwordx4 v[12:15], v116, s[4:7], s32 offen sc1
s_xor_b32 s32, s23, 4096
buffer_load_dwordx4 v[16:19], v116, s[4:7], s32 offen sc1
s_sub_u32 s29, s29, 1
s_cbranch_scc1 main_kernel_end
s_waitcnt vmcnt(0)
v_max_u32 v126, v12, v14
v_cmp_eq_u32 vcc, -1, v126
s_cbranch_vccnz main_kernel_c3_o3_f
s_branch main_kernel_c3_o3
main_kernel_c3_o4_f:
s_nop 0
s_xor_b32 s32, s23, 4096
buffer_load_dwordx4 v[16:19], v116, s[4:7], s32 offen sc1
s_xor_b32 s32, s23, 5120
buffer_load_dwordx4 v[20:23], v116, s[4:7], s32 offen sc1
s_sub_u32 s29, s29, 1
s_cbranch_scc1 main_kernel_end
s_waitcnt vmcnt(0)
v_max_u32 v126, v16, v18
v_cmp_eq_u32 vcc, -1, v126
s_cbranch_vccnz main_kernel_c3_o4_f
s_branch main_kernel_c3_o4
main_kernel_c3_o5_f:
s_nop 0
s_xor_b32 s32, s23, 5120
buffer_load_dwordx4 v[20:23], v116, s[4:7], s32 offen sc1
s_xor_b32 s32, s23, 6144
buffer_load_dwordx4 v[24:27], v116, s[4:7], s32 offen sc1
s_sub_u32 s29, s29, 1
s_cbranch_scc1 main_kernel_end
s_waitcnt vmcnt(0)
v_max_u32 v126, v20, v22
v_cmp_eq_u32 vcc, -1, v126
s_cbranch_vccnz main_kernel_c3_o5_f
s_branch main_kernel_c3_o5
main_kernel_c3_o6_f:
s_nop 0
s_xor_b32 s32, s23, 6144
buffer_load_dwordx4 v[24:27], v116, s[4:7], s32 offen sc1
s_xor_b32 s32, s23, 7168
buffer_load_dwordx4 v[28:31], v116, s[4:7], s32 offen sc1
s_sub_u32 s29, s29, 1
s_cbranch_scc1 main_kernel_end
s_waitcnt vmcnt(0)
v_max_u32 v126, v24, v26
v_cmp_eq_u32 vcc, -1, v126
s_cbranch_vccnz main_kernel_c3_o6_f
s_branch main_kernel_c3_o6
main_kernel_c3_o7_f:
s_nop 0
s_xor_b32 s32, s23, 7168
buffer_load_dwordx4 v[28:31], v116, s[4:7], s32 offen sc1
s_sub_u32 s29, s29, 1
s_cbranch_scc1 main_kernel_end
s_waitcnt vmcnt(0)
v_max_u32 v126, v28, v30
v_cmp_eq_u32 vcc, -1, v126
s_cbranch_vccnz main_kernel_c3_o7_f
s_branch main_kernel_c3_o7
.p2align 6
main_kernel_c4_top:
s_barrier
buffer_load_dwordx4 v[0:3], v116, s[4:7], s18 offen sc1
s_add_u32 s20, s20, 0x40000
s_bitset0_b32 s20, 20
s_add_u32 s21, s21, 0x40000
s_bitset0_b32 s21, 20
s_add_u32 s22, s22, 0x40000
s_bitset0_b32 s22, 20
s_add_u32 s23, s23, 0x40000
s_bitset0_b32 s23, 20
s_xor_b32 s32, s18, 1024
buffer_load_dwordx4 v[16:19], v116, s[4:7], s32 offen sc1
s_add_u32 s3, s3, 0x40000
s_bitset0_b32 s3, 20
s_add_u32 s17, s17, 1
s_add_u32 s25, s52, s59
s_nop 3
buffer_load_dwordx4 v[64:67], v116, s[4:7], s19 offen sc1
v_mov_b32 v80, 0
v_mov_b32 v81, 0
s_nop 3
s_xor_b32 s32, s19, 1024
buffer_load_dwordx4 v[68:71], v116, s[4:7], s32 offen sc1
v_mov_b32 v82, 0
v_mov_b32 v83, 0
s_nop 3
s_xor_b32 s32, s18, 2048
buffer_load_dwordx4 v[32:35], v116, s[4:7], s32 offen sc1
v_mov_b32 v84, 0
v_mov_b32 v85, 0
s_nop 3
s_xor_b32 s32, s19, 2048
buffer_load_dwordx4 v[72:75], v116, s[4:7], s32 offen sc1
v_mov_b32 v86, 0
v_mov_b32 v87, 0
s_nop 3
s_xor_b32 s32, s18, 3072
buffer_load_dwordx4 v[48:51], v116, s[4:7], s32 offen sc1
v_mov_b32 v88, 0
v_mov_b32 v89, 0
s_nop 3
s_xor_b32 s32, s19, 3072
buffer_load_dwordx4 v[76:79], v116, s[4:7], s32 offen sc1
v_mov_b32 v90, 0
v_mov_b32 v91, 0
s_waitcnt vmcnt(5)
v_pk_add_f16 v0, v0, v64
v_pk_add_f16 v1, v1, v65
v_pk_add_f16 v2, v2, v66
v_pk_add_f16 v3, v3, v67
v_cmp_u_f16 vcc, v0, v2
s_cbranch_vccnz main_kernel_c4_m0_f
main_kernel_c4_m0:
v_smfmac_f32_16x16x64_f16 v[80:83], v[0:3], a[0:7], v112
ds_write_b128 v116, v[0:3] offset:0
v_smfmac_f32_16x16x64_f16 v[84:87], v[0:3], a[128:135], v112
buffer_load_dword v123, v121, s[4:7], 0 offen sc1
s_waitcnt vmcnt(5)
v_pk_add_f16 v16, v16, v68
v_pk_add_f16 v17, v17, v69
v_pk_add_f16 v18, v18, v70
v_pk_add_f16 v19, v19, v71
v_cmp_u_f16 vcc, v16, v18
s_waitcnt lgkmcnt(0)
s_barrier
ds_read_b128 v[4:7], v116 offset:1024
ds_write_b128 v116, v[16:19] offset:4096
s_cbranch_vccnz main_kernel_c4_m1_f
main_kernel_c4_m1:
v_smfmac_f32_16x16x64_f16 v[80:83], v[16:19], a[8:15], v112
v_smfmac_f32_16x16x64_f16 v[84:87], v[16:19], a[136:143], v112
ds_read_b128 v[8:11], v116 offset:2048
v_smfmac_f32_16x16x64_f16 v[88:91], v[0:3], v[128:135], v112
ds_read_b128 v[12:15], v116 offset:3072
s_waitcnt lgkmcnt(3)
v_smfmac_f32_16x16x64_f16 v[80:83], v[4:7], a[32:39], v112
v_smfmac_f32_16x16x64_f16 v[84:87], v[4:7], a[160:167], v112
v_smfmac_f32_16x16x64_f16 v[88:91], v[4:7], v[136:143], v112
s_waitcnt lgkmcnt(2)
s_barrier
s_waitcnt lgkmcnt(1)
v_smfmac_f32_16x16x64_f16 v[80:83], v[8:11], a[64:71], v112
s_waitcnt vmcnt(3)
ds_read_b128 v[20:23], v116 offset:5120
v_pk_add_f16 v32, v32, v72
v_smfmac_f32_16x16x64_f16 v[84:87], v[8:11], a[192:199], v112
ds_read_b128 v[24:27], v116 offset:6144
s_waitcnt lgkmcnt(2)
v_pk_add_f16 v33, v33, v73
v_smfmac_f32_16x16x64_f16 v[80:83], v[12:15], a[96:103], v112
ds_read_b128 v[28:31], v116 offset:7168
v_pk_add_f16 v34, v34, v74
v_smfmac_f32_16x16x64_f16 v[84:87], v[12:15], a[224:231], v112
s_waitcnt lgkmcnt(2)
v_pk_add_f16 v35, v35, v75
v_smfmac_f32_16x16x64_f16 v[80:83], v[20:23], a[40:47], v112
ds_write_b128 v116, v[32:35] offset:8192
v_cmp_u_f16 vcc, v32, v34
v_smfmac_f32_16x16x64_f16 v[84:87], v[20:23], a[168:175], v112
s_cbranch_vccnz main_kernel_c4_m2_f
main_kernel_c4_m2:
v_smfmac_f32_16x16x64_f16 v[80:83], v[32:35], a[16:23], v112
buffer_load_dwordx4 v[96:99], v116, s[4:7], s28 offen sc1
v_smfmac_f32_16x16x64_f16 v[84:87], v[32:35], a[144:151], v112
s_add_u32 s28, s28, 0x40000
s_waitcnt lgkmcnt(2)
v_smfmac_f32_16x16x64_f16 v[80:83], v[24:27], a[72:79], v112
s_waitcnt vmcnt(2)
v_pk_add_f16 v48, v48, v76
v_smfmac_f32_16x16x64_f16 v[84:87], v[24:27], a[200:207], v112
s_waitcnt lgkmcnt(0)
s_barrier
ds_read_b128 v[36:39], v116 offset:9216
v_pk_add_f16 v49, v49, v77
v_smfmac_f32_16x16x64_f16 v[80:83], v[28:31], a[104:111], v112
ds_read_b128 v[40:43], v116 offset:10240
v_pk_add_f16 v50, v50, v78
v_smfmac_f32_16x16x64_f16 v[84:87], v[28:31], a[232:239], v112
ds_read_b128 v[44:47], v116 offset:11264
v_pk_add_f16 v51, v51, v79
v_smfmac_f32_16x16x64_f16 v[88:91], v[8:11], v[144:151], v112
ds_write_b128 v116, v[48:51] offset:12288
s_waitcnt lgkmcnt(3)
v_cmp_u_f16 vcc, v48, v50
v_smfmac_f32_16x16x64_f16 v[80:83], v[36:39], a[48:55], v112
s_cbranch_vccnz main_kernel_c4_m3_f
main_kernel_c4_m3:
v_smfmac_f32_16x16x64_f16 v[80:83], v[48:51], a[24:31], v112
v_smfmac_f32_16x16x64_f16 v[84:87], v[48:51], a[152:159], v112
v_smfmac_f32_16x16x64_f16 v[84:87], v[36:39], a[176:183], v112
s_waitcnt lgkmcnt(2)
v_smfmac_f32_16x16x64_f16 v[80:83], v[40:43], a[80:87], v112
s_waitcnt lgkmcnt(0)
s_barrier
ds_read_b128 v[52:55], v116 offset:13312
v_smfmac_f32_16x16x64_f16 v[84:87], v[40:43], a[208:215], v112
s_add_u32 s19, s52, s54
ds_read_b128 v[56:59], v116 offset:14336
v_smfmac_f32_16x16x64_f16 v[80:83], v[44:47], a[112:119], v112
s_add_u32 s18, s18, 0x40000
ds_read_b128 v[60:63], v116 offset:15360
v_smfmac_f32_16x16x64_f16 v[84:87], v[44:47], a[240:247], v112
s_bitset0_b32 s18, 20
s_waitcnt lgkmcnt(2)
v_smfmac_f32_16x16x64_f16 v[80:83], v[52:55], a[56:63], v112
s_cmp_eq_u32 s17, 30
s_cselect_b32 s32, s53, 0x10000
s_waitcnt lgkmcnt(1)
v_smfmac_f32_16x16x64_f16 v[80:83], v[56:59], a[88:95], v112
s_add_u32 s52, s52, s32
s_waitcnt lgkmcnt(0)
v_smfmac_f32_16x16x64_f16 v[80:83], v[60:63], a[120:127], v112
s_sub_u32 s24, 0x20000, s32
ds_read_b128 v[64:67], v116 offset:24576
v_smfmac_f32_16x16x64_f16 v[84:87], v[52:55], a[184:191], v112
s_add_u32 s55, s55, s24
ds_read_b128 v[68:71], v116 offset:28672
v_smfmac_f32_16x16x64_f16 v[84:87], v[56:59], a[216:223], v112
ds_read_b128 v[72:75], v116 offset:25600
s_nop 0
v_cvt_pk_bf16_f32 v92, v80, v81
v_smfmac_f32_16x16x64_f16 v[84:87], v[60:63], a[248:255], v112
ds_read_b128 v[76:79], v116 offset:29696
s_nop 0
v_cvt_pk_bf16_f32 v93, v82, v83
v_smfmac_f32_16x16x64_f16 v[88:91], v[12:15], v[152:159], v112
s_nop 3
v_cvt_pk_bf16_f32 v94, v84, v85
v_cvt_pk_bf16_f32 v95, v86, v87
s_mov_b32 vcc_lo, 0xcccccccc
s_mov_b32 vcc_hi, 0xcccccccc
v_mfma_f32_16x16x32_bf16 v[84:87], v[92:95], v[104:107], 0
v_add_u32 v121, v121, v122
v_writelane_b32 v121, s55, 39
s_nop 0
v_smfmac_f32_16x16x64_f16 v[88:91], v[16:19], v[160:167], v112
s_nop 2
s_cmp_eq_u32 s17, 63
v_cvt_pk_bf16_f32 v114, v84, v85
v_cvt_pk_bf16_f32 v115, v86, v87
buffer_store_dwordx2 v[114:115], v117, s[4:7], s21 offen sc1
s_cbranch_scc1 main_kernel_c4_last
ds_write_b64 v117, v[114:115] offset:16384
v_smfmac_f32_16x16x64_f16 v[88:91], v[20:23], v[168:175], v112
v_smfmac_f32_16x16x64_f16 v[88:91], v[24:27], v[176:183], v112
v_smfmac_f32_16x16x64_f16 v[88:91], v[28:31], v[184:191], v112
v_smfmac_f32_16x16x64_f16 v[88:91], v[32:35], v[192:199], v112
s_waitcnt lgkmcnt(0)
s_barrier
ds_read_b128 v[0:3], v116 offset:16384
v_smfmac_f32_16x16x64_f16 v[88:91], v[36:39], v[200:207], v112
ds_read_b128 v[4:7], v116 offset:17408
v_smfmac_f32_16x16x64_f16 v[88:91], v[40:43], v[208:215], v112
ds_read_b128 v[16:19], v116 offset:26624
v_smfmac_f32_16x16x64_f16 v[88:91], v[44:47], v[216:223], v112
ds_read_b128 v[20:23], v116 offset:30720
v_smfmac_f32_16x16x64_f16 v[88:91], v[48:51], v[224:231], v112
ds_read_b128 v[24:27], v116 offset:27648
v_smfmac_f32_16x16x64_f16 v[88:91], v[52:55], v[232:239], v112
ds_read_b128 v[28:31], v116 offset:31744
v_smfmac_f32_16x16x64_f16 v[88:91], v[56:59], v[240:247], v112
v_smfmac_f32_16x16x64_f16 v[88:91], v[60:63], v[248:255], v112
s_waitcnt lgkmcnt(5)
v_mfma_f32_16x16x32_bf16 v[80:83], v[64:67], v[0:3], 0
v_mfma_f32_16x16x32_bf16 v[84:87], v[68:71], v[0:3], 0
buffer_load_dwordx4 v[8:11], v116, s[4:7], s20 offen offset:0 sc1
v_mfma_f32_16x16x32_bf16 v[92:95], v[0:3], v[0:3], 0
buffer_load_dwordx4 v[12:15], v116, s[4:7], s20 offen offset:1024 sc1
v_permlane32_swap_b32 v88, v90
s_waitcnt lgkmcnt(4)
v_mfma_f32_16x16x32_bf16 v[80:83], v[72:75], v[4:7], v[80:83]
v_permlane32_swap_b32 v89, v91
v_mfma_f32_16x16x32_bf16 v[84:87], v[76:79], v[4:7], v[84:87]
v_pk_add_f32 v[88:89], v[88:89], v[90:91]
v_mfma_f32_16x16x32_bf16 v[92:95], v[4:7], v[4:7], v[92:95]
v_cvt_pk_bf16_f32 v124, v88, v89
v_mov_b32 v65, 0
s_waitcnt lgkmcnt(0)
s_waitcnt vmcnt(1)
v_mfma_f32_16x16x32_bf16 v[88:91], v[8:11], v[8:11], v[92:95]
v_mfma_f32_16x16x32_bf16 v[0:3], v[16:19], v[8:11], v[80:83]
v_cmp_u_f32 s[0:1], v8, v10
v_mfma_f32_16x16x32_bf16 v[4:7], v[20:23], v[8:11], v[84:87]
s_waitcnt vmcnt(0)
v_mfma_f32_16x16x32_bf16 v[88:91], v[12:15], v[12:15], v[88:91]
v_mfma_f32_16x16x32_bf16 v[0:3], v[24:27], v[12:15], v[0:3]
v_cmp_u_f32 s[32:33], v12, v14
v_mfma_f32_16x16x32_bf16 v[4:7], v[28:31], v[12:15], v[4:7]
s_or_b64 s[0:1], s[0:1], s[32:33]
s_cbranch_scc1 main_kernel_c4_z_f
main_kernel_c4_z:
v_mul_f32 v88, s30, v88
v_mul_f32 v89, s30, v89
v_exp_f32 v88, v88
v_exp_f32 v89, v89
v_cndmask_b32_dpp v0, v2, v0, vcc quad_perm:[2,3,2,3] row_mask:0xf bank_mask:0xf
v_cvt_pk_bf16_f32 v64, v88, v89
v_cndmask_b32_dpp v1, v3, v1, vcc quad_perm:[2,3,2,3] row_mask:0xf bank_mask:0xf
v_exp_f32 v0, v0
v_mfma_f32_16x16x16_bf16 v[16:19], v[100:101], v[64:65], 0
v_exp_f32 v1, v1
v_cndmask_b32_dpp v4, v6, v4, vcc quad_perm:[2,3,2,3] row_mask:0xf bank_mask:0xf
v_mfma_f32_16x16x16_bf16 v[8:11], v[124:125], v[64:65], 0
v_cndmask_b32_dpp v5, v7, v5, vcc quad_perm:[2,3,2,3] row_mask:0xf bank_mask:0xf
v_exp_f32 v4, v4
v_exp_f32 v5, v5
v_cvt_pk_bf16_f32 v92, v0, v1
v_cvt_pk_bf16_f32 v94, v4, v5
v_mov_b32 v80, 0
v_mov_b32_dpp v93, v92 quad_perm:[0,1,0,1] row_mask:0xf bank_mask:0xf
v_mov_b32_dpp v95, v94 quad_perm:[0,1,0,1] row_mask:0xf bank_mask:0xf
v_mov_b32 v81, 0
v_mov_b32 v82, 0
v_mfma_f32_16x16x32_bf16 v[16:19], v[100:103], v[92:95], v[16:19]
v_mov_b32 v83, 0
v_mov_b32 v84, 0
v_mfma_f32_16x16x32_bf16 v[8:11], v[96:99], v[92:95], v[8:11]
s_nop 1
v_mov_b32 v85, 0
v_mov_b32 v86, 0
v_mov_b32 v87, 0
v_rcp_f32 v126, v16
v_subrev_u32 v127, 0x21800000, v16
v_cmp_lt_u32 vcc, 0x3c000000, v127
v_pk_mul_f32 v[8:9], v[8:9], v[126:127] op_sel_hi:[1,0]
v_pk_mul_f32 v[10:11], v[10:11], v[126:127] op_sel_hi:[1,0]
s_and_b32 s32, vcc_lo, 0xcccc
v_cvt_pk_bf16_f32 v126, v8, v9
v_cvt_pk_bf16_f32 v127, v10, v11
s_cbranch_scc1 main_kernel_c4_sm_f
main_kernel_c4_ost:
buffer_store_dwordx2 v[126:127], v118, s[4:7], s22 offen sc1
v_cmp_eq_u32 s[0:1], 0, v123
v_mov_b32 v24, -1
v_mov_b32 v25, -1
v_mov_b32 v26, -1
v_mov_b32 v27, -1
ds_read_b128 v[32:35], v113 offset:0
ds_read_b128 v[36:39], v113 offset:1024
ds_read_b128 v[40:43], v113 offset:2048
ds_read_b128 v[44:47], v113 offset:3072
ds_read_b128 v[48:51], v113 offset:4096
ds_read_b128 v[52:55], v113 offset:5120
s_and_b32 s10, s1, 0x3f00
buffer_store_dwordx4 v[24:27], v116, s[4:7], s3 offen sc1
s_barrier
buffer_load_dwordx4 v[0:3], v116, s[4:7], s23 offen sc1
ds_read_b128 v[56:59], v113 offset:6144
ds_read_b128 v[60:63], v113 offset:7168
s_add_u32 s37, s37, 65536
s_add_u32 s26, s26, 65536
s_nop 1
s_xor_b32 s32, s23, 1024
buffer_load_dwordx4 v[4:7], v116, s[4:7], s32 offen sc1
ds_read_b128 v[64:67], v113 offset:8192
ds_read_b128 v[68:71], v113 offset:9216
s_nop 3
s_xor_b32 s32, s23, 2048
buffer_load_dwordx4 v[8:11], v116, s[4:7], s32 offen sc1
ds_read_b128 v[72:75], v113 offset:10240
ds_read_b128 v[76:79], v113 offset:11264
s_nop 3
s_xor_b32 s32, s23, 3072
buffer_load_dwordx4 v[12:15], v116, s[4:7], s32 offen sc1
ds_read_b128 v[88:91], v113 offset:12288
ds_read_b128 v[92:95], v113 offset:13312
s_nop 3
s_xor_b32 s32, s23, 4096
buffer_load_dwordx4 v[16:19], v116, s[4:7], s32 offen sc1
s_nop 7
s_xor_b32 s32, s23, 5120
buffer_load_dwordx4 v[20:23], v116, s[4:7], s32 offen sc1
s_nop 7
s_xor_b32 s32, s23, 6144
buffer_load_dwordx4 v[24:27], v116, s[4:7], s32 offen sc1
s_nop 7
s_xor_b32 s32, s23, 7168
buffer_load_dwordx4 v[28:31], v116, s[4:7], s32 offen sc1
s_waitcnt lgkmcnt(12)
s_waitcnt vmcnt(7)
v_cmp_u_f32 vcc, v0, v2
s_cbranch_vccnz main_kernel_c4_o0_f
main_kernel_c4_o0:
v_smfmac_f32_16x16x64_bf16 v[80:83], v[0:3], v[32:39], v112
ds_read_b128 v[32:35], v113 offset:14336
ds_read_b128 v[36:39], v113 offset:15360
s_waitcnt lgkmcnt(12)
s_waitcnt vmcnt(6)
v_cmp_u_f32 vcc, v4, v6
v_smfmac_f32_16x16x64_bf16 v[84:87], v[0:3], v[40:47], v112
ds_read_b128 v[40:43], v113 offset:16384
ds_read_b128 v[44:47], v113 offset:17408
buffer_store_dwordx2 v[114:115], v119, s[4:7], s37 offen sc1
s_cbranch_vccnz main_kernel_c4_o1_f
main_kernel_c4_o1:
s_waitcnt lgkmcnt(12)
v_smfmac_f32_16x16x64_bf16 v[80:83], v[4:7], v[48:55], v112
ds_read_b128 v[48:51], v113 offset:18432
ds_read_b128 v[52:55], v113 offset:19456
s_waitcnt lgkmcnt(12)
s_waitcnt vmcnt(6)
v_cmp_u_f32 vcc, v8, v10
v_smfmac_f32_16x16x64_bf16 v[84:87], v[4:7], v[56:63], v112
ds_read_b128 v[56:59], v113 offset:20480
ds_read_b128 v[60:63], v113 offset:21504
buffer_store_dword v124, v120, s[4:7], s26 offen sc1
s_cbranch_vccnz main_kernel_c4_o2_f
main_kernel_c4_o2:
s_waitcnt lgkmcnt(12)
v_smfmac_f32_16x16x64_bf16 v[80:83], v[8:11], v[64:71], v112
ds_read_b128 v[64:67], v113 offset:22528
ds_read_b128 v[68:71], v113 offset:23552
s_waitcnt lgkmcnt(12)
s_waitcnt vmcnt(6)
v_cmp_u_f32 vcc, v12, v14
v_smfmac_f32_16x16x64_bf16 v[84:87], v[8:11], v[72:79], v112
ds_read_b128 v[72:75], v113 offset:24576
ds_read_b128 v[76:79], v113 offset:25600
s_cbranch_vccnz main_kernel_c4_o3_f
main_kernel_c4_o3:
s_waitcnt lgkmcnt(12)
v_smfmac_f32_16x16x64_bf16 v[80:83], v[12:15], v[88:95], v112
ds_read_b128 v[88:91], v113 offset:26624
ds_read_b128 v[92:95], v113 offset:27648
s_waitcnt lgkmcnt(12)
s_waitcnt vmcnt(5)
v_cmp_u_f32 vcc, v16, v18
v_smfmac_f32_16x16x64_bf16 v[84:87], v[12:15], v[32:39], v112
ds_read_b128 v[32:35], v113 offset:28672
ds_read_b128 v[36:39], v113 offset:29696
s_cbranch_vccnz main_kernel_c4_o4_f
main_kernel_c4_o4:
s_waitcnt lgkmcnt(12)
v_smfmac_f32_16x16x64_bf16 v[80:83], v[16:19], v[40:47], v112
ds_read_b128 v[40:43], v113 offset:30720
ds_read_b128 v[44:47], v113 offset:31744
s_waitcnt lgkmcnt(12)
s_waitcnt vmcnt(4)
v_cmp_u_f32 vcc, v20, v22
v_smfmac_f32_16x16x64_bf16 v[84:87], v[16:19], v[48:55], v112
s_cbranch_vccnz main_kernel_c4_o5_f
main_kernel_c4_o5:
s_waitcnt lgkmcnt(10)
v_smfmac_f32_16x16x64_bf16 v[80:83], v[20:23], v[56:63], v112
s_waitcnt lgkmcnt(8)
s_waitcnt vmcnt(3)
v_cmp_u_f32 vcc, v24, v26
v_smfmac_f32_16x16x64_bf16 v[84:87], v[20:23], v[64:71], v112
s_cbranch_vccnz main_kernel_c4_o6_f
main_kernel_c4_o6:
s_waitcnt lgkmcnt(6)
v_smfmac_f32_16x16x64_bf16 v[80:83], v[24:27], v[72:79], v112
s_waitcnt lgkmcnt(4)
v_smfmac_f32_16x16x64_bf16 v[84:87], v[24:27], v[88:95], v112
s_waitcnt lgkmcnt(2)
s_waitcnt vmcnt(2)
v_cmp_u_f32 vcc, v28, v30
s_cbranch_vccnz main_kernel_c4_o7_f
main_kernel_c4_o7:
v_smfmac_f32_16x16x64_bf16 v[80:83], v[28:31], v[32:39], v112
s_waitcnt lgkmcnt(0)
v_smfmac_f32_16x16x64_bf16 v[84:87], v[28:31], v[40:47], v112
s_nop 4
v_cvt_pk_bf16_f32 v80, v80, v81
v_cvt_pk_bf16_f32 v81, v82, v83
ds_write_b64 v116, v[80:81] offset:20480
v_cvt_pk_bf16_f32 v82, v84, v85
v_cvt_pk_bf16_f32 v83, v86, v87
ds_write_b64 v116, v[82:83] offset:22528
s_waitcnt lgkmcnt(0)
s_barrier
ds_read_b128 v[72:75], v116 offset:20480
ds_read_b128 v[76:79], v116 offset:21504
s_mov_b32 m0, 24576
s_cmp_lg_u32 s10, 0
s_waitcnt lgkmcnt(1)
v_mfma_f32_16x16x32_bf16 v[64:67], v[72:75], v[108:111], 0
s_waitcnt lgkmcnt(0)
v_mfma_f32_16x16x32_bf16 v[64:67], v[76:79], v[108:111], v[64:67]
s_nop 7
v_cvt_pk_f16_f32 v68, v64, v65
v_cvt_pk_f16_f32 v69, v66, v67
buffer_store_dwordx2 v[68:69], v125, s[4:7], s25 offen sc1
s_cbranch_scc1 main_kernel_c4_kvw
main_kernel_c4_kvok:
s_nop 3
buffer_load_dwordx4 v116, s[4:7], s27 offen sc1 lds
buffer_load_dwordx4 v116, s[4:7], s27 offen offset:1024 sc1 lds
s_add_u32 s27, s27, 0x40000
s_branch main_kernel_c4_top
main_kernel_c4_kvw:
s_mov_b32 exec_lo, 0
s_mov_b32 exec_hi, 0x3f00
v_subrev_u32 v127, 128, v121
main_kernel_c4_kvp:
buffer_load_dword v126, v127, s[4:7], 0 offen sc1
s_waitcnt vmcnt(0)
v_cmp_eq_u32 vcc, 0, v126
s_cbranch_vccz main_kernel_c4_kvp_ok
s_sleep 2
s_sub_u32 s29, s29, 1
s_cbranch_scc0 main_kernel_c4_kvp
s_branch main_kernel_end
main_kernel_c4_kvp_ok:
s_mov_b64 exec, -1
s_branch main_kernel_c4_kvok
main_kernel_c4_last:
s_add_u32 s37, s37, 65536
s_add_u32 s26, s26, 65536
buffer_store_dwordx2 v[114:115], v119, s[4:7], s37 offen sc1
v_smfmac_f32_16x16x64_f16 v[88:91], v[20:23], v[168:175], v112
v_smfmac_f32_16x16x64_f16 v[88:91], v[24:27], v[176:183], v112
v_smfmac_f32_16x16x64_f16 v[88:91], v[28:31], v[184:191], v112
v_smfmac_f32_16x16x64_f16 v[88:91], v[32:35], v[192:199], v112
v_smfmac_f32_16x16x64_f16 v[88:91], v[36:39], v[200:207], v112
v_smfmac_f32_16x16x64_f16 v[88:91], v[40:43], v[208:215], v112
v_smfmac_f32_16x16x64_f16 v[88:91], v[44:47], v[216:223], v112
v_smfmac_f32_16x16x64_f16 v[88:91], v[48:51], v[224:231], v112
v_smfmac_f32_16x16x64_f16 v[88:91], v[52:55], v[232:239], v112
v_smfmac_f32_16x16x64_f16 v[88:91], v[56:59], v[240:247], v112
v_smfmac_f32_16x16x64_f16 v[88:91], v[60:63], v[248:255], v112
s_nop 7
v_permlane32_swap_b32 v88, v90
s_nop 1
v_permlane32_swap_b32 v89, v91
s_nop 1
v_pk_add_f32 v[88:89], v[88:89], v[90:91]
s_nop 1
v_cvt_pk_bf16_f32 v124, v88, v89
s_nop 1
buffer_store_dword v124, v120, s[4:7], s26 offen sc1
s_branch main_kernel_end
main_kernel_c4_m0_f:
s_waitcnt lgkmcnt(0)
buffer_load_dwordx4 v[0:3], v116, s[4:7], s18 offen sc1
buffer_load_dwordx4 v[64:67], v116, s[4:7], s19 offen sc1
s_xor_b32 s32, s18, 1024
buffer_load_dwordx4 v[16:19], v116, s[4:7], s32 offen sc1
s_xor_b32 s32, s19, 1024
buffer_load_dwordx4 v[68:71], v116, s[4:7], s32 offen sc1
s_xor_b32 s32, s18, 2048
buffer_load_dwordx4 v[32:35], v116, s[4:7], s32 offen sc1
s_xor_b32 s32, s19, 2048
buffer_load_dwordx4 v[72:75], v116, s[4:7], s32 offen sc1
s_xor_b32 s32, s18, 3072
buffer_load_dwordx4 v[48:51], v116, s[4:7], s32 offen sc1
s_xor_b32 s32, s19, 3072
buffer_load_dwordx4 v[76:79], v116, s[4:7], s32 offen sc1
s_sub_u32 s29, s29, 1
s_cbranch_scc1 main_kernel_end
s_waitcnt vmcnt(0)
v_max_u32 v126, v0, v2
v_max3_u32 v126, v126, v64, v66
v_cmp_eq_u32 vcc, -1, v126
s_cbranch_vccnz main_kernel_c4_m0_f
v_pk_add_f16 v0, v0, v64
v_pk_add_f16 v1, v1, v65
v_pk_add_f16 v2, v2, v66
v_pk_add_f16 v3, v3, v67
s_nop 0
s_branch main_kernel_c4_m0
main_kernel_c4_m1_f:
s_waitcnt lgkmcnt(0)
s_xor_b32 s32, s18, 1024
buffer_load_dwordx4 v[16:19], v116, s[4:7], s32 offen sc1
s_xor_b32 s32, s19, 1024
buffer_load_dwordx4 v[68:71], v116, s[4:7], s32 offen sc1
s_xor_b32 s32, s18, 2048
buffer_load_dwordx4 v[32:35], v116, s[4:7], s32 offen sc1
s_xor_b32 s32, s19, 2048
buffer_load_dwordx4 v[72:75], v116, s[4:7], s32 offen sc1
s_xor_b32 s32, s18, 3072
buffer_load_dwordx4 v[48:51], v116, s[4:7], s32 offen sc1
s_xor_b32 s32, s19, 3072
buffer_load_dwordx4 v[76:79], v116, s[4:7], s32 offen sc1
s_sub_u32 s29, s29, 1
s_cbranch_scc1 main_kernel_end
s_waitcnt vmcnt(0)
v_max_u32 v126, v16, v18
v_max3_u32 v126, v126, v68, v70
v_cmp_eq_u32 vcc, -1, v126
s_cbranch_vccnz main_kernel_c4_m1_f
v_pk_add_f16 v16, v16, v68
v_pk_add_f16 v17, v17, v69
v_pk_add_f16 v18, v18, v70
v_pk_add_f16 v19, v19, v71
ds_write_b128 v116, v[16:19] offset:4096
s_branch main_kernel_c4_m1
main_kernel_c4_m2_f:
s_waitcnt lgkmcnt(0)
s_xor_b32 s32, s18, 2048
buffer_load_dwordx4 v[32:35], v116, s[4:7], s32 offen sc1
s_xor_b32 s32, s19, 2048
buffer_load_dwordx4 v[72:75], v116, s[4:7], s32 offen sc1
s_xor_b32 s32, s18, 3072
buffer_load_dwordx4 v[48:51], v116, s[4:7], s32 offen sc1
s_xor_b32 s32, s19, 3072
buffer_load_dwordx4 v[76:79], v116, s[4:7], s32 offen sc1
s_sub_u32 s29, s29, 1
s_cbranch_scc1 main_kernel_end
s_waitcnt vmcnt(0)
v_max_u32 v126, v32, v34
v_max3_u32 v126, v126, v72, v74
v_cmp_eq_u32 vcc, -1, v126
s_cbranch_vccnz main_kernel_c4_m2_f
v_pk_add_f16 v32, v32, v72
v_pk_add_f16 v33, v33, v73
v_pk_add_f16 v34, v34, v74
v_pk_add_f16 v35, v35, v75
ds_write_b128 v116, v[32:35] offset:8192
s_branch main_kernel_c4_m2
main_kernel_c4_m3_f:
s_waitcnt lgkmcnt(0)
s_xor_b32 s32, s18, 3072
buffer_load_dwordx4 v[48:51], v116, s[4:7], s32 offen sc1
s_xor_b32 s32, s19, 3072
buffer_load_dwordx4 v[76:79], v116, s[4:7], s32 offen sc1
s_sub_u32 s29, s29, 1
s_cbranch_scc1 main_kernel_end
s_waitcnt vmcnt(0)
v_max_u32 v126, v48, v50
v_max3_u32 v126, v126, v76, v78
v_cmp_eq_u32 vcc, -1, v126
s_cbranch_vccnz main_kernel_c4_m3_f
v_pk_add_f16 v48, v48, v76
v_pk_add_f16 v49, v49, v77
v_pk_add_f16 v50, v50, v78
v_pk_add_f16 v51, v51, v79
ds_write_b128 v116, v[48:51] offset:12288
s_branch main_kernel_c4_m3
main_kernel_c4_z_f:
buffer_load_dwordx4 v[8:11], v116, s[4:7], s20 offen offset:0 sc1
buffer_load_dwordx4 v[12:15], v116, s[4:7], s20 offen offset:1024 sc1
s_memtime s[32:33]
ds_read_b32 v126, v116 offset:18432
s_sub_u32 s34, s19, s54
s_xor_b32 s34, s34, 0x2000
s_lshl_b32 s35, s12, 15
s_add_u32 s34, s34, s35
s_lshl_b32 s35, s13, 8
s_add_u32 s35, s35, s34
s_add_u32 s34, s34, 0x4000
s_waitcnt lgkmcnt(0)
s_sub_u32 s32, s32, 450
v_sub_u32 v127, s32, v126
buffer_store_dword v127, off, s[4:7], s34 sc1
s_sub_u32 s29, s29, 1
s_cbranch_scc1 main_kernel_end
s_waitcnt vmcnt(1)
main_kernel_c4_z_g:
v_max_u32 v126, v8, v10
v_max3_u32 v126, v126, v12, v14
v_cmp_eq_u32 vcc, -1, v126
s_cbranch_vccnz main_kernel_c4_z_h
v_mfma_f32_16x16x32_bf16 v[88:91], v[8:11], v[8:11], v[92:95]
v_mfma_f32_16x16x32_bf16 v[0:3], v[16:19], v[8:11], v[80:83]
v_mfma_f32_16x16x32_bf16 v[4:7], v[20:23], v[8:11], v[84:87]
v_mfma_f32_16x16x32_bf16 v[88:91], v[12:15], v[12:15], v[88:91]
v_mfma_f32_16x16x32_bf16 v[0:3], v[24:27], v[12:15], v[0:3]
v_mfma_f32_16x16x32_bf16 v[4:7], v[28:31], v[12:15], v[4:7]
buffer_store_dword v127, off, s[4:7], s35 offset:132 sc1
s_mov_b32 vcc_lo, 0xcccccccc
s_mov_b32 vcc_hi, 0xcccccccc
s_branch main_kernel_c4_z
main_kernel_c4_z_h:
buffer_load_dwordx4 v[8:11], v116, s[4:7], s20 offen offset:0 sc1
buffer_load_dwordx4 v[12:15], v116, s[4:7], s20 offen offset:1024 sc1
s_sub_u32 s29, s29, 1
s_cbranch_scc1 main_kernel_end
v_add_u32 v127, 300, v127
s_waitcnt vmcnt(0)
s_branch main_kernel_c4_z_g
main_kernel_c4_sm_f:
s_waitcnt vmcnt(0) lgkmcnt(0)
buffer_load_dwordx4 v[8:11], v116, s[4:7], s20 offen offset:0 sc1
buffer_load_dwordx4 v[12:15], v116, s[4:7], s20 offen offset:1024 sc1
ds_read_b128 v[0:3], v116 offset:16384
ds_read_b128 v[4:7], v116 offset:17408
ds_read_b128 v[64:67], v116 offset:24576
ds_read_b128 v[68:71], v116 offset:28672
ds_read_b128 v[72:75], v116 offset:25600
ds_read_b128 v[76:79], v116 offset:29696
ds_read_b128 v[16:19], v116 offset:26624
ds_read_b128 v[20:23], v116 offset:30720
ds_read_b128 v[24:27], v116 offset:27648
ds_read_b128 v[28:31], v116 offset:31744
s_waitcnt vmcnt(0)
s_waitcnt lgkmcnt(0)
v_mfma_f32_16x16x32_bf16 v[80:83], v[64:67], v[0:3], 0
v_mfma_f32_16x16x32_bf16 v[84:87], v[68:71], v[0:3], 0
v_mfma_f32_16x16x32_bf16 v[92:95], v[0:3], v[0:3], 0
v_mfma_f32_16x16x32_bf16 v[80:83], v[72:75], v[4:7], v[80:83]
v_mfma_f32_16x16x32_bf16 v[84:87], v[76:79], v[4:7], v[84:87]
v_mfma_f32_16x16x32_bf16 v[92:95], v[4:7], v[4:7], v[92:95]
v_mfma_f32_16x16x32_bf16 v[0:3], v[16:19], v[8:11], v[80:83]
v_mfma_f32_16x16x32_bf16 v[4:7], v[20:23], v[8:11], v[84:87]
v_mfma_f32_16x16x32_bf16 v[88:91], v[8:11], v[8:11], v[92:95]
v_mfma_f32_16x16x32_bf16 v[0:3], v[24:27], v[12:15], v[0:3]
v_mfma_f32_16x16x32_bf16 v[4:7], v[28:31], v[12:15], v[4:7]
v_mfma_f32_16x16x32_bf16 v[88:91], v[12:15], v[12:15], v[88:91]
s_nop 7
v_mov_b32 v65, 0
v_max_f32 v126, v88, v89
v_mul_f32 v126, s30, v126
v_max3_f32 v126, v126, v0, v1
v_max3_f32 v126, v126, v2, v3
v_max3_f32 v126, v126, v4, v5
v_max3_f32 v126, v126, v6, v7
v_mov_b32 v127, v126
s_nop 1
v_permlane32_swap_b32 v126, v127
v_max_f32 v126, v126, v127
v_mov_b32 v127, v126
s_nop 1
v_permlane16_swap_b32 v126, v127
v_max_f32 v126, v126, v127
v_mul_f32 v127, 0x40faf233, v126
s_mov_b32 vcc_lo, 0xcccccccc
s_mov_b32 vcc_hi, 0xcccccccc
v_sub_f32 v0, v0, v126
v_sub_f32 v1, v1, v126
v_sub_f32 v2, v2, v126
v_sub_f32 v3, v3, v126
v_sub_f32 v4, v4, v126
v_sub_f32 v5, v5, v126
v_sub_f32 v6, v6, v126
v_sub_f32 v7, v7, v126
v_sub_f32 v88, v88, v127
v_sub_f32 v89, v89, v127
s_waitcnt lgkmcnt(0)
s_nop 0
v_mul_f32 v88, s30, v88
v_mul_f32 v89, s30, v89
v_exp_f32 v88, v88
v_exp_f32 v89, v89
v_cndmask_b32_dpp v0, v2, v0, vcc quad_perm:[2,3,2,3] row_mask:0xf bank_mask:0xf
v_cvt_pk_bf16_f32 v64, v88, v89
v_cndmask_b32_dpp v1, v3, v1, vcc quad_perm:[2,3,2,3] row_mask:0xf bank_mask:0xf
v_exp_f32 v0, v0
v_mfma_f32_16x16x16_bf16 v[16:19], v[100:101], v[64:65], 0
v_exp_f32 v1, v1
v_cndmask_b32_dpp v4, v6, v4, vcc quad_perm:[2,3,2,3] row_mask:0xf bank_mask:0xf
v_mfma_f32_16x16x16_bf16 v[8:11], v[124:125], v[64:65], 0
v_cndmask_b32_dpp v5, v7, v5, vcc quad_perm:[2,3,2,3] row_mask:0xf bank_mask:0xf
v_exp_f32 v4, v4
v_exp_f32 v5, v5
v_cvt_pk_bf16_f32 v92, v0, v1
v_cvt_pk_bf16_f32 v94, v4, v5
v_mov_b32 v80, 0
v_mov_b32_dpp v93, v92 quad_perm:[0,1,0,1] row_mask:0xf bank_mask:0xf
v_mov_b32_dpp v95, v94 quad_perm:[0,1,0,1] row_mask:0xf bank_mask:0xf
v_mov_b32 v81, 0
v_mov_b32 v82, 0
v_mfma_f32_16x16x32_bf16 v[16:19], v[100:103], v[92:95], v[16:19]
v_mov_b32 v83, 0
v_mov_b32 v84, 0
v_mfma_f32_16x16x32_bf16 v[8:11], v[96:99], v[92:95], v[8:11]
s_nop 1
v_mov_b32 v85, 0
v_mov_b32 v86, 0
v_mov_b32 v87, 0
v_rcp_f32 v126, v16
v_subrev_u32 v127, 0x21800000, v16
v_cmp_lt_u32 vcc, 0x3c000000, v127
v_pk_mul_f32 v[8:9], v[8:9], v[126:127] op_sel_hi:[1,0]
v_pk_mul_f32 v[10:11], v[10:11], v[126:127] op_sel_hi:[1,0]
s_and_b32 s32, vcc_lo, 0xcccc
v_cvt_pk_bf16_f32 v126, v8, v9
v_cvt_pk_bf16_f32 v127, v10, v11
s_branch main_kernel_c4_ost
main_kernel_c4_o0_f:
s_nop 0
buffer_load_dwordx4 v[0:3], v116, s[4:7], s23 offen sc1
s_xor_b32 s32, s23, 1024
buffer_load_dwordx4 v[4:7], v116, s[4:7], s32 offen sc1
s_sub_u32 s29, s29, 1
s_cbranch_scc1 main_kernel_end
s_waitcnt vmcnt(0)
v_max_u32 v126, v0, v2
v_cmp_eq_u32 vcc, -1, v126
s_cbranch_vccnz main_kernel_c4_o0_f
s_branch main_kernel_c4_o0
main_kernel_c4_o1_f:
s_nop 0
s_xor_b32 s32, s23, 1024
buffer_load_dwordx4 v[4:7], v116, s[4:7], s32 offen sc1
s_xor_b32 s32, s23, 2048
buffer_load_dwordx4 v[8:11], v116, s[4:7], s32 offen sc1
s_sub_u32 s29, s29, 1
s_cbranch_scc1 main_kernel_end
s_waitcnt vmcnt(0)
v_max_u32 v126, v4, v6
v_cmp_eq_u32 vcc, -1, v126
s_cbranch_vccnz main_kernel_c4_o1_f
s_branch main_kernel_c4_o1
main_kernel_c4_o2_f:
s_nop 0
s_xor_b32 s32, s23, 2048
buffer_load_dwordx4 v[8:11], v116, s[4:7], s32 offen sc1
s_xor_b32 s32, s23, 3072
buffer_load_dwordx4 v[12:15], v116, s[4:7], s32 offen sc1
s_sub_u32 s29, s29, 1
s_cbranch_scc1 main_kernel_end
s_waitcnt vmcnt(0)
v_max_u32 v126, v8, v10
v_cmp_eq_u32 vcc, -1, v126
s_cbranch_vccnz main_kernel_c4_o2_f
s_branch main_kernel_c4_o2
main_kernel_c4_o3_f:
s_nop 0
s_xor_b32 s32, s23, 3072
buffer_load_dwordx4 v[12:15], v116, s[4:7], s32 offen sc1
s_xor_b32 s32, s23, 4096
buffer_load_dwordx4 v[16:19], v116, s[4:7], s32 offen sc1
s_sub_u32 s29, s29, 1
s_cbranch_scc1 main_kernel_end
s_waitcnt vmcnt(0)
v_max_u32 v126, v12, v14
v_cmp_eq_u32 vcc, -1, v126
s_cbranch_vccnz main_kernel_c4_o3_f
s_branch main_kernel_c4_o3
main_kernel_c4_o4_f:
s_nop 0
s_xor_b32 s32, s23, 4096
buffer_load_dwordx4 v[16:19], v116, s[4:7], s32 offen sc1
s_xor_b32 s32, s23, 5120
buffer_load_dwordx4 v[20:23], v116, s[4:7], s32 offen sc1
s_sub_u32 s29, s29, 1
s_cbranch_scc1 main_kernel_end
s_waitcnt vmcnt(0)
v_max_u32 v126, v16, v18
v_cmp_eq_u32 vcc, -1, v126
s_cbranch_vccnz main_kernel_c4_o4_f
s_branch main_kernel_c4_o4
main_kernel_c4_o5_f:
s_nop 0
s_xor_b32 s32, s23, 5120
buffer_load_dwordx4 v[20:23], v116, s[4:7], s32 offen sc1
s_xor_b32 s32, s23, 6144
buffer_load_dwordx4 v[24:27], v116, s[4:7], s32 offen sc1
s_sub_u32 s29, s29, 1
s_cbranch_scc1 main_kernel_end
s_waitcnt vmcnt(0)
v_max_u32 v126, v20, v22
v_cmp_eq_u32 vcc, -1, v126
s_cbranch_vccnz main_kernel_c4_o5_f
s_branch main_kernel_c4_o5
main_kernel_c4_o6_f:
s_nop 0
s_xor_b32 s32, s23, 6144
buffer_load_dwordx4 v[24:27], v116, s[4:7], s32 offen sc1
s_xor_b32 s32, s23, 7168
buffer_load_dwordx4 v[28:31], v116, s[4:7], s32 offen sc1
s_sub_u32 s29, s29, 1
s_cbranch_scc1 main_kernel_end
s_waitcnt vmcnt(0)
v_max_u32 v126, v24, v26
v_cmp_eq_u32 vcc, -1, v126
s_cbranch_vccnz main_kernel_c4_o6_f
s_branch main_kernel_c4_o6
main_kernel_c4_o7_f:
s_nop 0
s_xor_b32 s32, s23, 7168
buffer_load_dwordx4 v[28:31], v116, s[4:7], s32 offen sc1
s_sub_u32 s29, s29, 1
s_cbranch_scc1 main_kernel_end
s_waitcnt vmcnt(0)
v_max_u32 v126, v28, v30
v_cmp_eq_u32 vcc, -1, v126
s_cbranch_vccnz main_kernel_c4_o7_f
s_branch main_kernel_c4_o7
.p2align 6
main_kernel_c5_top:
s_barrier
buffer_load_dwordx4 v[0:3], v116, s[4:7], s18 offen sc1
s_add_u32 s20, s20, 0x40000
s_bitset0_b32 s20, 20
s_add_u32 s21, s21, 0x40000
s_bitset0_b32 s21, 20
s_add_u32 s22, s22, 0x40000
s_bitset0_b32 s22, 20
s_add_u32 s23, s23, 0x40000
s_bitset0_b32 s23, 20
s_xor_b32 s32, s18, 1024
buffer_load_dwordx4 v[16:19], v116, s[4:7], s32 offen sc1
s_add_u32 s3, s3, 0x40000
s_bitset0_b32 s3, 20
s_add_u32 s17, s17, 1
s_add_u32 s25, s52, s59
s_nop 3
buffer_load_dwordx4 v[64:67], v116, s[4:7], s19 offen sc1
v_mov_b32 v80, 0
v_mov_b32 v81, 0
s_nop 3
s_xor_b32 s32, s19, 1024
buffer_load_dwordx4 v[68:71], v116, s[4:7], s32 offen sc1
v_mov_b32 v82, 0
v_mov_b32 v83, 0
s_nop 3
s_xor_b32 s32, s18, 2048
buffer_load_dwordx4 v[32:35], v116, s[4:7], s32 offen sc1
v_mov_b32 v84, 0
v_mov_b32 v85, 0
s_nop 3
s_xor_b32 s32, s19, 2048
buffer_load_dwordx4 v[72:75], v116, s[4:7], s32 offen sc1
v_mov_b32 v86, 0
v_mov_b32 v87, 0
s_nop 3
s_xor_b32 s32, s18, 3072
buffer_load_dwordx4 v[48:51], v116, s[4:7], s32 offen sc1
v_mov_b32 v88, 0
v_mov_b32 v89, 0
s_nop 3
s_xor_b32 s32, s19, 3072
buffer_load_dwordx4 v[76:79], v116, s[4:7], s32 offen sc1
v_mov_b32 v90, 0
v_mov_b32 v91, 0
s_waitcnt vmcnt(5)
v_pk_add_f16 v0, v0, v64
v_pk_add_f16 v1, v1, v65
v_pk_add_f16 v2, v2, v66
v_pk_add_f16 v3, v3, v67
v_cmp_u_f16 vcc, v0, v2
s_cbranch_vccnz main_kernel_c5_m0_f
main_kernel_c5_m0:
v_smfmac_f32_16x16x64_f16 v[80:83], v[0:3], a[0:7], v112
ds_write_b128 v116, v[0:3] offset:1024
v_smfmac_f32_16x16x64_f16 v[84:87], v[0:3], a[128:135], v112
buffer_load_dword v123, v121, s[4:7], 0 offen sc1
s_waitcnt vmcnt(5)
v_pk_add_f16 v16, v16, v68
v_pk_add_f16 v17, v17, v69
v_pk_add_f16 v18, v18, v70
v_pk_add_f16 v19, v19, v71
v_cmp_u_f16 vcc, v16, v18
s_waitcnt lgkmcnt(0)
s_barrier
ds_read_b128 v[4:7], v116 offset:0
ds_write_b128 v116, v[16:19] offset:5120
s_cbranch_vccnz main_kernel_c5_m1_f
main_kernel_c5_m1:
v_smfmac_f32_16x16x64_f16 v[80:83], v[16:19], a[8:15], v112
v_smfmac_f32_16x16x64_f16 v[84:87], v[16:19], a[136:143], v112
ds_read_b128 v[8:11], v116 offset:3072
v_smfmac_f32_16x16x64_f16 v[88:91], v[0:3], v[128:135], v112
ds_read_b128 v[12:15], v116 offset:2048
s_waitcnt lgkmcnt(3)
v_smfmac_f32_16x16x64_f16 v[80:83], v[4:7], a[32:39], v112
v_smfmac_f32_16x16x64_f16 v[84:87], v[4:7], a[160:167], v112
v_smfmac_f32_16x16x64_f16 v[88:91], v[4:7], v[136:143], v112
s_waitcnt lgkmcnt(2)
s_barrier
s_waitcnt lgkmcnt(1)
v_smfmac_f32_16x16x64_f16 v[80:83], v[8:11], a[64:71], v112
s_waitcnt vmcnt(3)
ds_read_b128 v[20:23], v116 offset:4096
v_pk_add_f16 v32, v32, v72
v_smfmac_f32_16x16x64_f16 v[84:87], v[8:11], a[192:199], v112
ds_read_b128 v[24:27], v116 offset:7168
s_waitcnt lgkmcnt(2)
v_pk_add_f16 v33, v33, v73
v_smfmac_f32_16x16x64_f16 v[80:83], v[12:15], a[96:103], v112
ds_read_b128 v[28:31], v116 offset:6144
v_pk_add_f16 v34, v34, v74
v_smfmac_f32_16x16x64_f16 v[84:87], v[12:15], a[224:231], v112
s_waitcnt lgkmcnt(2)
v_pk_add_f16 v35, v35, v75
v_smfmac_f32_16x16x64_f16 v[80:83], v[20:23], a[40:47], v112
ds_write_b128 v116, v[32:35] offset:9216
v_cmp_u_f16 vcc, v32, v34
v_smfmac_f32_16x16x64_f16 v[84:87], v[20:23], a[168:175], v112
s_cbranch_vccnz main_kernel_c5_m2_f
main_kernel_c5_m2:
v_smfmac_f32_16x16x64_f16 v[80:83], v[32:35], a[16:23], v112
buffer_load_dwordx4 v[96:99], v116, s[4:7], s28 offen sc1
v_smfmac_f32_16x16x64_f16 v[84:87], v[32:35], a[144:151], v112
s_add_u32 s28, s28, 0x40000
s_waitcnt lgkmcnt(2)
v_smfmac_f32_16x16x64_f16 v[80:83], v[24:27], a[72:79], v112
s_waitcnt vmcnt(2)
v_pk_add_f16 v48, v48, v76
v_smfmac_f32_16x16x64_f16 v[84:87], v[24:27], a[200:207], v112
s_waitcnt lgkmcnt(0)
s_barrier
ds_read_b128 v[36:39], v116 offset:8192
v_pk_add_f16 v49, v49, v77
v_smfmac_f32_16x16x64_f16 v[80:83], v[28:31], a[104:111], v112
ds_read_b128 v[40:43], v116 offset:11264
v_pk_add_f16 v50, v50, v78
v_smfmac_f32_16x16x64_f16 v[84:87], v[28:31], a[232:239], v112
ds_read_b128 v[44:47], v116 offset:10240
v_pk_add_f16 v51, v51, v79
v_smfmac_f32_16x16x64_f16 v[88:91], v[8:11], v[144:151], v112
ds_write_b128 v116, v[48:51] offset:13312
s_waitcnt lgkmcnt(3)
v_cmp_u_f16 vcc, v48, v50
v_smfmac_f32_16x16x64_f16 v[80:83], v[36:39], a[48:55], v112
s_cbranch_vccnz main_kernel_c5_m3_f
main_kernel_c5_m3:
v_smfmac_f32_16x16x64_f16 v[80:83], v[48:51], a[24:31], v112
v_smfmac_f32_16x16x64_f16 v[84:87], v[48:51], a[152:159], v112
v_smfmac_f32_16x16x64_f16 v[84:87], v[36:39], a[176:183], v112
s_waitcnt lgkmcnt(2)
v_smfmac_f32_16x16x64_f16 v[80:83], v[40:43], a[80:87], v112
s_waitcnt lgkmcnt(0)
s_barrier
ds_read_b128 v[52:55], v116 offset:12288
v_smfmac_f32_16x16x64_f16 v[84:87], v[40:43], a[208:215], v112
s_add_u32 s19, s52, s54
ds_read_b128 v[56:59], v116 offset:15360
v_smfmac_f32_16x16x64_f16 v[80:83], v[44:47], a[112:119], v112
s_add_u32 s18, s18, 0x40000
ds_read_b128 v[60:63], v116 offset:14336
v_smfmac_f32_16x16x64_f16 v[84:87], v[44:47], a[240:247], v112
s_bitset0_b32 s18, 20
s_waitcnt lgkmcnt(2)
v_smfmac_f32_16x16x64_f16 v[80:83], v[52:55], a[56:63], v112
s_cmp_eq_u32 s17, 30
s_cselect_b32 s32, s53, 0x10000
s_waitcnt lgkmcnt(1)
v_smfmac_f32_16x16x64_f16 v[80:83], v[56:59], a[88:95], v112
s_add_u32 s52, s52, s32
s_waitcnt lgkmcnt(0)
v_smfmac_f32_16x16x64_f16 v[80:83], v[60:63], a[120:127], v112
s_sub_u32 s24, 0x20000, s32
ds_read_b128 v[64:67], v116 offset:24576
v_smfmac_f32_16x16x64_f16 v[84:87], v[52:55], a[184:191], v112
s_add_u32 s55, s55, s24
ds_read_b128 v[68:71], v116 offset:28672
v_smfmac_f32_16x16x64_f16 v[84:87], v[56:59], a[216:223], v112
ds_read_b128 v[72:75], v116 offset:25600
s_nop 0
v_cvt_pk_bf16_f32 v92, v80, v81
v_smfmac_f32_16x16x64_f16 v[84:87], v[60:63], a[248:255], v112
ds_read_b128 v[76:79], v116 offset:29696
s_nop 0
v_cvt_pk_bf16_f32 v93, v82, v83
v_smfmac_f32_16x16x64_f16 v[88:91], v[12:15], v[152:159], v112
s_nop 3
v_cvt_pk_bf16_f32 v94, v84, v85
v_cvt_pk_bf16_f32 v95, v86, v87
s_mov_b32 vcc_lo, 0xcccccccc
s_mov_b32 vcc_hi, 0xcccccccc
v_mfma_f32_16x16x32_bf16 v[84:87], v[92:95], v[104:107], 0
v_add_u32 v121, v121, v122
v_writelane_b32 v121, s55, 39
s_nop 0
v_smfmac_f32_16x16x64_f16 v[88:91], v[16:19], v[160:167], v112
s_nop 2
s_cmp_eq_u32 s17, 63
v_cvt_pk_bf16_f32 v114, v84, v85
v_cvt_pk_bf16_f32 v115, v86, v87
buffer_store_dwordx2 v[114:115], v117, s[4:7], s21 offen sc1
s_cbranch_scc1 main_kernel_c5_last
ds_write_b64 v117, v[114:115] offset:16896
v_smfmac_f32_16x16x64_f16 v[88:91], v[20:23], v[168:175], v112
v_smfmac_f32_16x16x64_f16 v[88:91], v[24:27], v[176:183], v112
v_smfmac_f32_16x16x64_f16 v[88:91], v[28:31], v[184:191], v112
v_smfmac_f32_16x16x64_f16 v[88:91], v[32:35], v[192:199], v112
s_waitcnt lgkmcnt(0)
s_barrier
ds_read_b128 v[0:3], v116 offset:16384
v_smfmac_f32_16x16x64_f16 v[88:91], v[36:39], v[200:207], v112
ds_read_b128 v[4:7], v116 offset:17408
v_smfmac_f32_16x16x64_f16 v[88:91], v[40:43], v[208:215], v112
ds_read_b128 v[16:19], v116 offset:26624
v_smfmac_f32_16x16x64_f16 v[88:91], v[44:47], v[216:223], v112
ds_read_b128 v[20:23], v116 offset:30720
v_smfmac_f32_16x16x64_f16 v[88:91], v[48:51], v[224:231], v112
ds_read_b128 v[24:27], v116 offset:27648
v_smfmac_f32_16x16x64_f16 v[88:91], v[52:55], v[232:239], v112
ds_read_b128 v[28:31], v116 offset:31744
v_smfmac_f32_16x16x64_f16 v[88:91], v[56:59], v[240:247], v112
v_smfmac_f32_16x16x64_f16 v[88:91], v[60:63], v[248:255], v112
s_waitcnt lgkmcnt(5)
v_mfma_f32_16x16x32_bf16 v[80:83], v[64:67], v[0:3], 0
v_mfma_f32_16x16x32_bf16 v[84:87], v[68:71], v[0:3], 0
buffer_load_dwordx4 v[8:11], v116, s[4:7], s20 offen offset:0 sc1
v_mfma_f32_16x16x32_bf16 v[92:95], v[0:3], v[0:3], 0
buffer_load_dwordx4 v[12:15], v116, s[4:7], s20 offen offset:1024 sc1
v_permlane32_swap_b32 v88, v90
s_waitcnt lgkmcnt(4)
v_mfma_f32_16x16x32_bf16 v[80:83], v[72:75], v[4:7], v[80:83]
v_permlane32_swap_b32 v89, v91
v_mfma_f32_16x16x32_bf16 v[84:87], v[76:79], v[4:7], v[84:87]
v_pk_add_f32 v[88:89], v[88:89], v[90:91]
v_mfma_f32_16x16x32_bf16 v[92:95], v[4:7], v[4:7], v[92:95]
v_cvt_pk_bf16_f32 v124, v88, v89
v_mov_b32 v65, 0
s_waitcnt lgkmcnt(0)
s_waitcnt vmcnt(1)
v_mfma_f32_16x16x32_bf16 v[88:91], v[8:11], v[8:11], v[92:95]
v_mfma_f32_16x16x32_bf16 v[0:3], v[16:19], v[8:11], v[80:83]
v_cmp_u_f32 s[0:1], v8, v10
v_mfma_f32_16x16x32_bf16 v[4:7], v[20:23], v[8:11], v[84:87]
s_waitcnt vmcnt(0)
v_mfma_f32_16x16x32_bf16 v[88:91], v[12:15], v[12:15], v[88:91]
v_mfma_f32_16x16x32_bf16 v[0:3], v[24:27], v[12:15], v[0:3]
v_cmp_u_f32 s[32:33], v12, v14
v_mfma_f32_16x16x32_bf16 v[4:7], v[28:31], v[12:15], v[4:7]
s_or_b64 s[0:1], s[0:1], s[32:33]
s_cbranch_scc1 main_kernel_c5_z_f
main_kernel_c5_z:
v_mul_f32 v88, s30, v88
v_mul_f32 v89, s30, v89
v_exp_f32 v88, v88
v_exp_f32 v89, v89
v_cndmask_b32_dpp v0, v2, v0, vcc quad_perm:[2,3,2,3] row_mask:0xf bank_mask:0xf
v_cvt_pk_bf16_f32 v64, v88, v89
v_cndmask_b32_dpp v1, v3, v1, vcc quad_perm:[2,3,2,3] row_mask:0xf bank_mask:0xf
v_exp_f32 v0, v0
v_mfma_f32_16x16x16_bf16 v[16:19], v[100:101], v[64:65], 0
v_exp_f32 v1, v1
v_cndmask_b32_dpp v4, v6, v4, vcc quad_perm:[2,3,2,3] row_mask:0xf bank_mask:0xf
v_mfma_f32_16x16x16_bf16 v[8:11], v[124:125], v[64:65], 0
v_cndmask_b32_dpp v5, v7, v5, vcc quad_perm:[2,3,2,3] row_mask:0xf bank_mask:0xf
v_exp_f32 v4, v4
v_exp_f32 v5, v5
v_cvt_pk_bf16_f32 v92, v0, v1
v_cvt_pk_bf16_f32 v94, v4, v5
v_mov_b32 v80, 0
v_mov_b32_dpp v93, v92 quad_perm:[0,1,0,1] row_mask:0xf bank_mask:0xf
v_mov_b32_dpp v95, v94 quad_perm:[0,1,0,1] row_mask:0xf bank_mask:0xf
v_mov_b32 v81, 0
v_mov_b32 v82, 0
v_mfma_f32_16x16x32_bf16 v[16:19], v[100:103], v[92:95], v[16:19]
v_mov_b32 v83, 0
v_mov_b32 v84, 0
v_mfma_f32_16x16x32_bf16 v[8:11], v[96:99], v[92:95], v[8:11]
s_nop 1
v_mov_b32 v85, 0
v_mov_b32 v86, 0
v_mov_b32 v87, 0
v_rcp_f32 v126, v16
v_subrev_u32 v127, 0x21800000, v16
v_cmp_lt_u32 vcc, 0x3c000000, v127
v_pk_mul_f32 v[8:9], v[8:9], v[126:127] op_sel_hi:[1,0]
v_pk_mul_f32 v[10:11], v[10:11], v[126:127] op_sel_hi:[1,0]
s_and_b32 s32, vcc_lo, 0xcccc
v_cvt_pk_bf16_f32 v126, v8, v9
v_cvt_pk_bf16_f32 v127, v10, v11
s_cbranch_scc1 main_kernel_c5_sm_f
main_kernel_c5_ost:
buffer_store_dwordx2 v[126:127], v118, s[4:7], s22 offen sc1
v_cmp_eq_u32 s[0:1], 0, v123
v_mov_b32 v24, -1
v_mov_b32 v25, -1
v_mov_b32 v26, -1
v_mov_b32 v27, -1
ds_read_b128 v[32:35], v113 offset:0
ds_read_b128 v[36:39], v113 offset:1024
ds_read_b128 v[40:43], v113 offset:2048
ds_read_b128 v[44:47], v113 offset:3072
ds_read_b128 v[48:51], v113 offset:4096
ds_read_b128 v[52:55], v113 offset:5120
s_and_b32 s10, s1, 0x3f00
buffer_store_dwordx4 v[24:27], v116, s[4:7], s3 offen sc1
buffer_store_dwordx4 v[24:27], v116, s[4:7], s46 offen sc1
s_barrier
buffer_load_dwordx4 v[0:3], v116, s[4:7], s23 offen sc1
ds_read_b128 v[56:59], v113 offset:6144
ds_read_b128 v[60:63], v113 offset:7168
s_add_u32 s46, s46, 0x40000
s_bitset0_b32 s46, 20
s_add_u32 s37, s37, 65536
s_add_u32 s26, s26, 65536
s_xor_b32 s32, s23, 1024
buffer_load_dwordx4 v[4:7], v116, s[4:7], s32 offen sc1
ds_read_b128 v[64:67], v113 offset:8192
ds_read_b128 v[68:71], v113 offset:9216
s_nop 3
s_xor_b32 s32, s23, 2048
buffer_load_dwordx4 v[8:11], v116, s[4:7], s32 offen sc1
ds_read_b128 v[72:75], v113 offset:10240
ds_read_b128 v[76:79], v113 offset:11264
s_nop 3
s_xor_b32 s32, s23, 3072
buffer_load_dwordx4 v[12:15], v116, s[4:7], s32 offen sc1
ds_read_b128 v[88:91], v113 offset:12288
ds_read_b128 v[92:95], v113 offset:13312
s_nop 3
s_xor_b32 s32, s23, 4096
buffer_load_dwordx4 v[16:19], v116, s[4:7], s32 offen sc1
s_nop 7
s_xor_b32 s32, s23, 5120
buffer_load_dwordx4 v[20:23], v116, s[4:7], s32 offen sc1
s_nop 7
s_xor_b32 s32, s23, 6144
buffer_load_dwordx4 v[24:27], v116, s[4:7], s32 offen sc1
s_nop 7
s_xor_b32 s32, s23, 7168
buffer_load_dwordx4 v[28:31], v116, s[4:7], s32 offen sc1
s_waitcnt lgkmcnt(12)
s_waitcnt vmcnt(7)
v_cmp_u_f32 vcc, v0, v2
s_cbranch_vccnz main_kernel_c5_o0_f
main_kernel_c5_o0:
v_smfmac_f32_16x16x64_bf16 v[80:83], v[0:3], v[32:39], v112
ds_read_b128 v[32:35], v113 offset:14336
ds_read_b128 v[36:39], v113 offset:15360
s_waitcnt lgkmcnt(12)
s_waitcnt vmcnt(6)
v_cmp_u_f32 vcc, v4, v6
v_smfmac_f32_16x16x64_bf16 v[84:87], v[0:3], v[40:47], v112
ds_read_b128 v[40:43], v113 offset:16384
ds_read_b128 v[44:47], v113 offset:17408
buffer_store_dwordx2 v[114:115], v119, s[4:7], s37 offen sc1
s_cbranch_vccnz main_kernel_c5_o1_f
main_kernel_c5_o1:
s_waitcnt lgkmcnt(12)
v_smfmac_f32_16x16x64_bf16 v[80:83], v[4:7], v[48:55], v112
ds_read_b128 v[48:51], v113 offset:18432
ds_read_b128 v[52:55], v113 offset:19456
s_waitcnt lgkmcnt(12)
s_waitcnt vmcnt(6)
v_cmp_u_f32 vcc, v8, v10
v_smfmac_f32_16x16x64_bf16 v[84:87], v[4:7], v[56:63], v112
ds_read_b128 v[56:59], v113 offset:20480
ds_read_b128 v[60:63], v113 offset:21504
buffer_store_dword v124, v120, s[4:7], s26 offen sc1
s_cbranch_vccnz main_kernel_c5_o2_f
main_kernel_c5_o2:
s_waitcnt lgkmcnt(12)
v_smfmac_f32_16x16x64_bf16 v[80:83], v[8:11], v[64:71], v112
ds_read_b128 v[64:67], v113 offset:22528
ds_read_b128 v[68:71], v113 offset:23552
s_waitcnt lgkmcnt(12)
s_waitcnt vmcnt(6)
v_cmp_u_f32 vcc, v12, v14
v_smfmac_f32_16x16x64_bf16 v[84:87], v[8:11], v[72:79], v112
ds_read_b128 v[72:75], v113 offset:24576
ds_read_b128 v[76:79], v113 offset:25600
s_cbranch_vccnz main_kernel_c5_o3_f
main_kernel_c5_o3:
s_waitcnt lgkmcnt(12)
v_smfmac_f32_16x16x64_bf16 v[80:83], v[12:15], v[88:95], v112
ds_read_b128 v[88:91], v113 offset:26624
ds_read_b128 v[92:95], v113 offset:27648
s_waitcnt lgkmcnt(12)
s_waitcnt vmcnt(5)
v_cmp_u_f32 vcc, v16, v18
v_smfmac_f32_16x16x64_bf16 v[84:87], v[12:15], v[32:39], v112
ds_read_b128 v[32:35], v113 offset:28672
ds_read_b128 v[36:39], v113 offset:29696
s_cbranch_vccnz main_kernel_c5_o4_f
main_kernel_c5_o4:
s_waitcnt lgkmcnt(12)
v_smfmac_f32_16x16x64_bf16 v[80:83], v[16:19], v[40:47], v112
ds_read_b128 v[40:43], v113 offset:30720
ds_read_b128 v[44:47], v113 offset:31744
s_waitcnt lgkmcnt(12)
s_waitcnt vmcnt(4)
v_cmp_u_f32 vcc, v20, v22
v_smfmac_f32_16x16x64_bf16 v[84:87], v[16:19], v[48:55], v112
s_cbranch_vccnz main_kernel_c5_o5_f
main_kernel_c5_o5:
s_waitcnt lgkmcnt(10)
v_smfmac_f32_16x16x64_bf16 v[80:83], v[20:23], v[56:63], v112
s_waitcnt lgkmcnt(8)
s_waitcnt vmcnt(3)
v_cmp_u_f32 vcc, v24, v26
v_smfmac_f32_16x16x64_bf16 v[84:87], v[20:23], v[64:71], v112
s_cbranch_vccnz main_kernel_c5_o6_f
main_kernel_c5_o6:
s_waitcnt lgkmcnt(6)
v_smfmac_f32_16x16x64_bf16 v[80:83], v[24:27], v[72:79], v112
s_waitcnt lgkmcnt(4)
v_smfmac_f32_16x16x64_bf16 v[84:87], v[24:27], v[88:95], v112
s_waitcnt lgkmcnt(2)
s_waitcnt vmcnt(2)
v_cmp_u_f32 vcc, v28, v30
s_cbranch_vccnz main_kernel_c5_o7_f
main_kernel_c5_o7:
v_smfmac_f32_16x16x64_bf16 v[80:83], v[28:31], v[32:39], v112
s_waitcnt lgkmcnt(0)
v_smfmac_f32_16x16x64_bf16 v[84:87], v[28:31], v[40:47], v112
s_nop 4
v_cvt_pk_bf16_f32 v80, v80, v81
v_cvt_pk_bf16_f32 v81, v82, v83
ds_write_b64 v116, v[80:81] offset:20488
v_cvt_pk_bf16_f32 v82, v84, v85
v_cvt_pk_bf16_f32 v83, v86, v87
ds_write_b64 v116, v[82:83] offset:22536
s_waitcnt lgkmcnt(0)
s_barrier
ds_read_b128 v[72:75], v116 offset:22528
ds_read_b128 v[76:79], v116 offset:23552
s_mov_b32 m0, 26624
s_cmp_lg_u32 s10, 0
s_waitcnt lgkmcnt(1)
v_mfma_f32_16x16x32_bf16 v[64:67], v[72:75], v[108:111], 0
s_waitcnt lgkmcnt(0)
v_mfma_f32_16x16x32_bf16 v[64:67], v[76:79], v[108:111], v[64:67]
s_nop 7
v_cvt_pk_f16_f32 v68, v64, v65
v_cvt_pk_f16_f32 v69, v66, v67
buffer_store_dwordx2 v[68:69], v125, s[4:7], s25 offen sc1
s_cbranch_scc1 main_kernel_c5_kvw
main_kernel_c5_kvok:
s_nop 3
buffer_load_dwordx4 v116, s[4:7], s27 offen sc1 lds
buffer_load_dwordx4 v116, s[4:7], s27 offen offset:1024 sc1 lds
s_mov_b32 m0, 30720
s_xor_b32 s32, s27, 131072
buffer_load_dwordx4 v116, s[4:7], s32 offen offset:0 sc1 lds
s_add_u32 s27, s27, 0x40000
s_branch main_kernel_c5_top
main_kernel_c5_kvw:
s_mov_b32 exec_lo, 0
s_mov_b32 exec_hi, 0x3f00
v_subrev_u32 v127, 128, v121
main_kernel_c5_kvp:
buffer_load_dword v126, v127, s[4:7], 0 offen sc1
s_waitcnt vmcnt(0)
v_cmp_eq_u32 vcc, 0, v126
s_cbranch_vccz main_kernel_c5_kvp_ok
s_sleep 2
s_sub_u32 s29, s29, 1
s_cbranch_scc0 main_kernel_c5_kvp
s_branch main_kernel_end
main_kernel_c5_kvp_ok:
s_mov_b64 exec, -1
s_branch main_kernel_c5_kvok
main_kernel_c5_last:
s_add_u32 s37, s37, 65536
s_add_u32 s26, s26, 65536
buffer_store_dwordx2 v[114:115], v119, s[4:7], s37 offen sc1
v_smfmac_f32_16x16x64_f16 v[88:91], v[20:23], v[168:175], v112
v_smfmac_f32_16x16x64_f16 v[88:91], v[24:27], v[176:183], v112
v_smfmac_f32_16x16x64_f16 v[88:91], v[28:31], v[184:191], v112
v_smfmac_f32_16x16x64_f16 v[88:91], v[32:35], v[192:199], v112
v_smfmac_f32_16x16x64_f16 v[88:91], v[36:39], v[200:207], v112
v_smfmac_f32_16x16x64_f16 v[88:91], v[40:43], v[208:215], v112
v_smfmac_f32_16x16x64_f16 v[88:91], v[44:47], v[216:223], v112
v_smfmac_f32_16x16x64_f16 v[88:91], v[48:51], v[224:231], v112
v_smfmac_f32_16x16x64_f16 v[88:91], v[52:55], v[232:239], v112
v_smfmac_f32_16x16x64_f16 v[88:91], v[56:59], v[240:247], v112
v_smfmac_f32_16x16x64_f16 v[88:91], v[60:63], v[248:255], v112
s_nop 7
v_permlane32_swap_b32 v88, v90
s_nop 1
v_permlane32_swap_b32 v89, v91
s_nop 1
v_pk_add_f32 v[88:89], v[88:89], v[90:91]
s_nop 1
v_cvt_pk_bf16_f32 v124, v88, v89
s_nop 1
buffer_store_dword v124, v120, s[4:7], s26 offen sc1
s_branch main_kernel_end
main_kernel_c5_m0_f:
s_waitcnt lgkmcnt(0)
buffer_load_dwordx4 v[0:3], v116, s[4:7], s18 offen sc1
buffer_load_dwordx4 v[64:67], v116, s[4:7], s19 offen sc1
s_xor_b32 s32, s18, 1024
buffer_load_dwordx4 v[16:19], v116, s[4:7], s32 offen sc1
s_xor_b32 s32, s19, 1024
buffer_load_dwordx4 v[68:71], v116, s[4:7], s32 offen sc1
s_xor_b32 s32, s18, 2048
buffer_load_dwordx4 v[32:35], v116, s[4:7], s32 offen sc1
s_xor_b32 s32, s19, 2048
buffer_load_dwordx4 v[72:75], v116, s[4:7], s32 offen sc1
s_xor_b32 s32, s18, 3072
buffer_load_dwordx4 v[48:51], v116, s[4:7], s32 offen sc1
s_xor_b32 s32, s19, 3072
buffer_load_dwordx4 v[76:79], v116, s[4:7], s32 offen sc1
s_sub_u32 s29, s29, 1
s_cbranch_scc1 main_kernel_end
s_waitcnt vmcnt(0)
v_max_u32 v126, v0, v2
v_max3_u32 v126, v126, v64, v66
v_cmp_eq_u32 vcc, -1, v126
s_cbranch_vccnz main_kernel_c5_m0_f
v_pk_add_f16 v0, v0, v64
v_pk_add_f16 v1, v1, v65
v_pk_add_f16 v2, v2, v66
v_pk_add_f16 v3, v3, v67
s_nop 0
s_branch main_kernel_c5_m0
main_kernel_c5_m1_f:
s_waitcnt lgkmcnt(0)
s_xor_b32 s32, s18, 1024
buffer_load_dwordx4 v[16:19], v116, s[4:7], s32 offen sc1
s_xor_b32 s32, s19, 1024
buffer_load_dwordx4 v[68:71], v116, s[4:7], s32 offen sc1
s_xor_b32 s32, s18, 2048
buffer_load_dwordx4 v[32:35], v116, s[4:7], s32 offen sc1
s_xor_b32 s32, s19, 2048
buffer_load_dwordx4 v[72:75], v116, s[4:7], s32 offen sc1
s_xor_b32 s32, s18, 3072
buffer_load_dwordx4 v[48:51], v116, s[4:7], s32 offen sc1
s_xor_b32 s32, s19, 3072
buffer_load_dwordx4 v[76:79], v116, s[4:7], s32 offen sc1
s_sub_u32 s29, s29, 1
s_cbranch_scc1 main_kernel_end
s_waitcnt vmcnt(0)
v_max_u32 v126, v16, v18
v_max3_u32 v126, v126, v68, v70
v_cmp_eq_u32 vcc, -1, v126
s_cbranch_vccnz main_kernel_c5_m1_f
v_pk_add_f16 v16, v16, v68
v_pk_add_f16 v17, v17, v69
v_pk_add_f16 v18, v18, v70
v_pk_add_f16 v19, v19, v71
ds_write_b128 v116, v[16:19] offset:5120
s_branch main_kernel_c5_m1
main_kernel_c5_m2_f:
s_waitcnt lgkmcnt(0)
s_xor_b32 s32, s18, 2048
buffer_load_dwordx4 v[32:35], v116, s[4:7], s32 offen sc1
s_xor_b32 s32, s19, 2048
buffer_load_dwordx4 v[72:75], v116, s[4:7], s32 offen sc1
s_xor_b32 s32, s18, 3072
buffer_load_dwordx4 v[48:51], v116, s[4:7], s32 offen sc1
s_xor_b32 s32, s19, 3072
buffer_load_dwordx4 v[76:79], v116, s[4:7], s32 offen sc1
s_sub_u32 s29, s29, 1
s_cbranch_scc1 main_kernel_end
s_waitcnt vmcnt(0)
v_max_u32 v126, v32, v34
v_max3_u32 v126, v126, v72, v74
v_cmp_eq_u32 vcc, -1, v126
s_cbranch_vccnz main_kernel_c5_m2_f
v_pk_add_f16 v32, v32, v72
v_pk_add_f16 v33, v33, v73
v_pk_add_f16 v34, v34, v74
v_pk_add_f16 v35, v35, v75
ds_write_b128 v116, v[32:35] offset:9216
s_branch main_kernel_c5_m2
main_kernel_c5_m3_f:
s_waitcnt lgkmcnt(0)
s_xor_b32 s32, s18, 3072
buffer_load_dwordx4 v[48:51], v116, s[4:7], s32 offen sc1
s_xor_b32 s32, s19, 3072
buffer_load_dwordx4 v[76:79], v116, s[4:7], s32 offen sc1
s_sub_u32 s29, s29, 1
s_cbranch_scc1 main_kernel_end
s_waitcnt vmcnt(0)
v_max_u32 v126, v48, v50
v_max3_u32 v126, v126, v76, v78
v_cmp_eq_u32 vcc, -1, v126
s_cbranch_vccnz main_kernel_c5_m3_f
v_pk_add_f16 v48, v48, v76
v_pk_add_f16 v49, v49, v77
v_pk_add_f16 v50, v50, v78
v_pk_add_f16 v51, v51, v79
ds_write_b128 v116, v[48:51] offset:13312
s_branch main_kernel_c5_m3
main_kernel_c5_z_f:
buffer_load_dwordx4 v[8:11], v116, s[4:7], s20 offen offset:0 sc1
buffer_load_dwordx4 v[12:15], v116, s[4:7], s20 offen offset:1024 sc1
s_memtime s[32:33]
ds_read_b32 v126, v116 offset:18432
s_sub_u32 s34, s19, s54
s_xor_b32 s34, s34, 0x2000
s_lshl_b32 s35, s12, 15
s_add_u32 s34, s34, s35
s_lshl_b32 s35, s13, 8
s_add_u32 s35, s35, s34
s_add_u32 s34, s34, 0x4000
s_waitcnt lgkmcnt(0)
s_sub_u32 s32, s32, 450
v_sub_u32 v127, s32, v126
buffer_store_dword v127, off, s[4:7], s34 sc1
s_sub_u32 s29, s29, 1
s_cbranch_scc1 main_kernel_end
s_waitcnt vmcnt(1)
main_kernel_c5_z_g:
v_max_u32 v126, v8, v10
v_max3_u32 v126, v126, v12, v14
v_cmp_eq_u32 vcc, -1, v126
s_cbranch_vccnz main_kernel_c5_z_h
v_mfma_f32_16x16x32_bf16 v[88:91], v[8:11], v[8:11], v[92:95]
v_mfma_f32_16x16x32_bf16 v[0:3], v[16:19], v[8:11], v[80:83]
v_mfma_f32_16x16x32_bf16 v[4:7], v[20:23], v[8:11], v[84:87]
v_mfma_f32_16x16x32_bf16 v[88:91], v[12:15], v[12:15], v[88:91]
v_mfma_f32_16x16x32_bf16 v[0:3], v[24:27], v[12:15], v[0:3]
v_mfma_f32_16x16x32_bf16 v[4:7], v[28:31], v[12:15], v[4:7]
buffer_store_dword v127, off, s[4:7], s35 offset:132 sc1
s_mov_b32 vcc_lo, 0xcccccccc
s_mov_b32 vcc_hi, 0xcccccccc
s_branch main_kernel_c5_z
main_kernel_c5_z_h:
buffer_load_dwordx4 v[8:11], v116, s[4:7], s20 offen offset:0 sc1
buffer_load_dwordx4 v[12:15], v116, s[4:7], s20 offen offset:1024 sc1
s_sub_u32 s29, s29, 1
s_cbranch_scc1 main_kernel_end
v_add_u32 v127, 300, v127
s_waitcnt vmcnt(0)
s_branch main_kernel_c5_z_g
main_kernel_c5_sm_f:
s_waitcnt vmcnt(0) lgkmcnt(0)
buffer_load_dwordx4 v[8:11], v116, s[4:7], s20 offen offset:0 sc1
buffer_load_dwordx4 v[12:15], v116, s[4:7], s20 offen offset:1024 sc1
ds_read_b128 v[0:3], v116 offset:16384
ds_read_b128 v[4:7], v116 offset:17408
ds_read_b128 v[64:67], v116 offset:24576
ds_read_b128 v[68:71], v116 offset:28672
ds_read_b128 v[72:75], v116 offset:25600
ds_read_b128 v[76:79], v116 offset:29696
ds_read_b128 v[16:19], v116 offset:26624
ds_read_b128 v[20:23], v116 offset:30720
ds_read_b128 v[24:27], v116 offset:27648
ds_read_b128 v[28:31], v116 offset:31744
s_waitcnt vmcnt(0)
s_waitcnt lgkmcnt(0)
v_mfma_f32_16x16x32_bf16 v[80:83], v[64:67], v[0:3], 0
v_mfma_f32_16x16x32_bf16 v[84:87], v[68:71], v[0:3], 0
v_mfma_f32_16x16x32_bf16 v[92:95], v[0:3], v[0:3], 0
v_mfma_f32_16x16x32_bf16 v[80:83], v[72:75], v[4:7], v[80:83]
v_mfma_f32_16x16x32_bf16 v[84:87], v[76:79], v[4:7], v[84:87]
v_mfma_f32_16x16x32_bf16 v[92:95], v[4:7], v[4:7], v[92:95]
v_mfma_f32_16x16x32_bf16 v[0:3], v[16:19], v[8:11], v[80:83]
v_mfma_f32_16x16x32_bf16 v[4:7], v[20:23], v[8:11], v[84:87]
v_mfma_f32_16x16x32_bf16 v[88:91], v[8:11], v[8:11], v[92:95]
v_mfma_f32_16x16x32_bf16 v[0:3], v[24:27], v[12:15], v[0:3]
v_mfma_f32_16x16x32_bf16 v[4:7], v[28:31], v[12:15], v[4:7]
v_mfma_f32_16x16x32_bf16 v[88:91], v[12:15], v[12:15], v[88:91]
s_nop 7
v_mov_b32 v65, 0
v_max_f32 v126, v88, v89
v_mul_f32 v126, s30, v126
v_max3_f32 v126, v126, v0, v1
v_max3_f32 v126, v126, v2, v3
v_max3_f32 v126, v126, v4, v5
v_max3_f32 v126, v126, v6, v7
v_mov_b32 v127, v126
s_nop 1
v_permlane32_swap_b32 v126, v127
v_max_f32 v126, v126, v127
v_mov_b32 v127, v126
s_nop 1
v_permlane16_swap_b32 v126, v127
v_max_f32 v126, v126, v127
v_mul_f32 v127, 0x40faf233, v126
s_mov_b32 vcc_lo, 0xcccccccc
s_mov_b32 vcc_hi, 0xcccccccc
v_sub_f32 v0, v0, v126
v_sub_f32 v1, v1, v126
v_sub_f32 v2, v2, v126
v_sub_f32 v3, v3, v126
v_sub_f32 v4, v4, v126
v_sub_f32 v5, v5, v126
v_sub_f32 v6, v6, v126
v_sub_f32 v7, v7, v126
v_sub_f32 v88, v88, v127
v_sub_f32 v89, v89, v127
s_waitcnt lgkmcnt(0)
s_nop 0
v_mul_f32 v88, s30, v88
v_mul_f32 v89, s30, v89
v_exp_f32 v88, v88
v_exp_f32 v89, v89
v_cndmask_b32_dpp v0, v2, v0, vcc quad_perm:[2,3,2,3] row_mask:0xf bank_mask:0xf
v_cvt_pk_bf16_f32 v64, v88, v89
v_cndmask_b32_dpp v1, v3, v1, vcc quad_perm:[2,3,2,3] row_mask:0xf bank_mask:0xf
v_exp_f32 v0, v0
v_mfma_f32_16x16x16_bf16 v[16:19], v[100:101], v[64:65], 0
v_exp_f32 v1, v1
v_cndmask_b32_dpp v4, v6, v4, vcc quad_perm:[2,3,2,3] row_mask:0xf bank_mask:0xf
v_mfma_f32_16x16x16_bf16 v[8:11], v[124:125], v[64:65], 0
v_cndmask_b32_dpp v5, v7, v5, vcc quad_perm:[2,3,2,3] row_mask:0xf bank_mask:0xf
v_exp_f32 v4, v4
v_exp_f32 v5, v5
v_cvt_pk_bf16_f32 v92, v0, v1
v_cvt_pk_bf16_f32 v94, v4, v5
v_mov_b32 v80, 0
v_mov_b32_dpp v93, v92 quad_perm:[0,1,0,1] row_mask:0xf bank_mask:0xf
v_mov_b32_dpp v95, v94 quad_perm:[0,1,0,1] row_mask:0xf bank_mask:0xf
v_mov_b32 v81, 0
v_mov_b32 v82, 0
v_mfma_f32_16x16x32_bf16 v[16:19], v[100:103], v[92:95], v[16:19]
v_mov_b32 v83, 0
v_mov_b32 v84, 0
v_mfma_f32_16x16x32_bf16 v[8:11], v[96:99], v[92:95], v[8:11]
s_nop 1
v_mov_b32 v85, 0
v_mov_b32 v86, 0
v_mov_b32 v87, 0
v_rcp_f32 v126, v16
v_subrev_u32 v127, 0x21800000, v16
v_cmp_lt_u32 vcc, 0x3c000000, v127
v_pk_mul_f32 v[8:9], v[8:9], v[126:127] op_sel_hi:[1,0]
v_pk_mul_f32 v[10:11], v[10:11], v[126:127] op_sel_hi:[1,0]
s_and_b32 s32, vcc_lo, 0xcccc
v_cvt_pk_bf16_f32 v126, v8, v9
v_cvt_pk_bf16_f32 v127, v10, v11
s_branch main_kernel_c5_ost
main_kernel_c5_o0_f:
s_nop 0
buffer_load_dwordx4 v[0:3], v116, s[4:7], s23 offen sc1
s_xor_b32 s32, s23, 1024
buffer_load_dwordx4 v[4:7], v116, s[4:7], s32 offen sc1
s_sub_u32 s29, s29, 1
s_cbranch_scc1 main_kernel_end
s_waitcnt vmcnt(0)
v_max_u32 v126, v0, v2
v_cmp_eq_u32 vcc, -1, v126
s_cbranch_vccnz main_kernel_c5_o0_f
s_branch main_kernel_c5_o0
main_kernel_c5_o1_f:
s_nop 0
s_xor_b32 s32, s23, 1024
buffer_load_dwordx4 v[4:7], v116, s[4:7], s32 offen sc1
s_xor_b32 s32, s23, 2048
buffer_load_dwordx4 v[8:11], v116, s[4:7], s32 offen sc1
s_sub_u32 s29, s29, 1
s_cbranch_scc1 main_kernel_end
s_waitcnt vmcnt(0)
v_max_u32 v126, v4, v6
v_cmp_eq_u32 vcc, -1, v126
s_cbranch_vccnz main_kernel_c5_o1_f
s_branch main_kernel_c5_o1
main_kernel_c5_o2_f:
s_nop 0
s_xor_b32 s32, s23, 2048
buffer_load_dwordx4 v[8:11], v116, s[4:7], s32 offen sc1
s_xor_b32 s32, s23, 3072
buffer_load_dwordx4 v[12:15], v116, s[4:7], s32 offen sc1
s_sub_u32 s29, s29, 1
s_cbranch_scc1 main_kernel_end
s_waitcnt vmcnt(0)
v_max_u32 v126, v8, v10
v_cmp_eq_u32 vcc, -1, v126
s_cbranch_vccnz main_kernel_c5_o2_f
s_branch main_kernel_c5_o2
main_kernel_c5_o3_f:
s_nop 0
s_xor_b32 s32, s23, 3072
buffer_load_dwordx4 v[12:15], v116, s[4:7], s32 offen sc1
s_xor_b32 s32, s23, 4096
buffer_load_dwordx4 v[16:19], v116, s[4:7], s32 offen sc1
s_sub_u32 s29, s29, 1
s_cbranch_scc1 main_kernel_end
s_waitcnt vmcnt(0)
v_max_u32 v126, v12, v14
v_cmp_eq_u32 vcc, -1, v126
s_cbranch_vccnz main_kernel_c5_o3_f
s_branch main_kernel_c5_o3
main_kernel_c5_o4_f:
s_nop 0
s_xor_b32 s32, s23, 4096
buffer_load_dwordx4 v[16:19], v116, s[4:7], s32 offen sc1
s_xor_b32 s32, s23, 5120
buffer_load_dwordx4 v[20:23], v116, s[4:7], s32 offen sc1
s_sub_u32 s29, s29, 1
s_cbranch_scc1 main_kernel_end
s_waitcnt vmcnt(0)
v_max_u32 v126, v16, v18
v_cmp_eq_u32 vcc, -1, v126
s_cbranch_vccnz main_kernel_c5_o4_f
s_branch main_kernel_c5_o4
main_kernel_c5_o5_f:
s_nop 0
s_xor_b32 s32, s23, 5120
buffer_load_dwordx4 v[20:23], v116, s[4:7], s32 offen sc1
s_xor_b32 s32, s23, 6144
buffer_load_dwordx4 v[24:27], v116, s[4:7], s32 offen sc1
s_sub_u32 s29, s29, 1
s_cbranch_scc1 main_kernel_end
s_waitcnt vmcnt(0)
v_max_u32 v126, v20, v22
v_cmp_eq_u32 vcc, -1, v126
s_cbranch_vccnz main_kernel_c5_o5_f
s_branch main_kernel_c5_o5
main_kernel_c5_o6_f:
s_nop 0
s_xor_b32 s32, s23, 6144
buffer_load_dwordx4 v[24:27], v116, s[4:7], s32 offen sc1
s_xor_b32 s32, s23, 7168
buffer_load_dwordx4 v[28:31], v116, s[4:7], s32 offen sc1
s_sub_u32 s29, s29, 1
s_cbranch_scc1 main_kernel_end
s_waitcnt vmcnt(0)
v_max_u32 v126, v24, v26
v_cmp_eq_u32 vcc, -1, v126
s_cbranch_vccnz main_kernel_c5_o6_f
s_branch main_kernel_c5_o6
main_kernel_c5_o7_f:
s_nop 0
s_xor_b32 s32, s23, 7168
buffer_load_dwordx4 v[28:31], v116, s[4:7], s32 offen sc1
s_sub_u32 s29, s29, 1
s_cbranch_scc1 main_kernel_end
s_waitcnt vmcnt(0)
v_max_u32 v126, v28, v30
v_cmp_eq_u32 vcc, -1, v126
s_cbranch_vccnz main_kernel_c5_o7_f
s_branch main_kernel_c5_o7
.p2align 6
main_kernel_c6_top:
s_barrier
buffer_load_dwordx4 v[0:3], v116, s[4:7], s18 offen sc1
s_add_u32 s20, s20, 0x40000
s_bitset0_b32 s20, 20
s_add_u32 s21, s21, 0x40000
s_bitset0_b32 s21, 20
s_add_u32 s22, s22, 0x40000
s_bitset0_b32 s22, 20
s_add_u32 s23, s23, 0x40000
s_bitset0_b32 s23, 20
s_xor_b32 s32, s18, 1024
buffer_load_dwordx4 v[16:19], v116, s[4:7], s32 offen sc1
s_add_u32 s3, s3, 0x40000
s_bitset0_b32 s3, 20
s_add_u32 s17, s17, 1
s_add_u32 s25, s25, 0x40000
s_bitset0_b32 s25, 20
s_nop 2
buffer_load_dwordx4 v[64:67], v116, s[4:7], s19 offen sc1
v_mov_b32 v80, 0
v_mov_b32 v81, 0
s_nop 3
s_xor_b32 s32, s19, 1024
buffer_load_dwordx4 v[68:71], v116, s[4:7], s32 offen sc1
v_mov_b32 v82, 0
v_mov_b32 v83, 0
s_nop 3
s_xor_b32 s32, s18, 2048
buffer_load_dwordx4 v[32:35], v116, s[4:7], s32 offen sc1
v_mov_b32 v84, 0
v_mov_b32 v85, 0
s_nop 3
s_xor_b32 s32, s19, 2048
buffer_load_dwordx4 v[72:75], v116, s[4:7], s32 offen sc1
v_mov_b32 v86, 0
v_mov_b32 v87, 0
s_nop 3
s_xor_b32 s32, s18, 3072
buffer_load_dwordx4 v[48:51], v116, s[4:7], s32 offen sc1
v_mov_b32 v88, 0
v_mov_b32 v89, 0
s_nop 3
s_xor_b32 s32, s19, 3072
buffer_load_dwordx4 v[76:79], v116, s[4:7], s32 offen sc1
v_mov_b32 v90, 0
v_mov_b32 v91, 0
s_waitcnt vmcnt(5)
v_pk_add_f16 v0, v0, v64
v_pk_add_f16 v1, v1, v65
v_pk_add_f16 v2, v2, v66
v_pk_add_f16 v3, v3, v67
v_cmp_u_f16 vcc, v0, v2
s_cbranch_vccnz main_kernel_c6_m0_f
main_kernel_c6_m0:
v_smfmac_f32_16x16x64_f16 v[80:83], v[0:3], a[0:7], v112
ds_write_b128 v116, v[0:3] offset:2048
v_smfmac_f32_16x16x64_f16 v[84:87], v[0:3], a[128:135], v112
buffer_load_dword v123, v121, s[4:7], 0 offen sc1
s_waitcnt vmcnt(5)
v_pk_add_f16 v16, v16, v68
v_pk_add_f16 v17, v17, v69
v_pk_add_f16 v18, v18, v70
v_pk_add_f16 v19, v19, v71
v_cmp_u_f16 vcc, v16, v18
s_waitcnt lgkmcnt(0)
s_barrier
ds_read_b128 v[4:7], v116 offset:3072
s_cbranch_vccnz main_kernel_c6_m1_f
main_kernel_c6_m1:
v_smfmac_f32_16x16x64_f16 v[80:83], v[16:19], a[8:15], v112
ds_write_b128 v116, v[16:19] offset:6144
v_smfmac_f32_16x16x64_f16 v[84:87], v[16:19], a[136:143], v112
ds_read_b128 v[8:11], v116 offset:0
v_smfmac_f32_16x16x64_f16 v[88:91], v[0:3], v[128:135], v112
ds_read_b128 v[12:15], v116 offset:1024
s_waitcnt lgkmcnt(3)
v_smfmac_f32_16x16x64_f16 v[80:83], v[4:7], a[32:39], v112
v_smfmac_f32_16x16x64_f16 v[84:87], v[4:7], a[160:167], v112
v_smfmac_f32_16x16x64_f16 v[88:91], v[4:7], v[136:143], v112
s_waitcnt lgkmcnt(2)
s_barrier
s_waitcnt lgkmcnt(1)
v_smfmac_f32_16x16x64_f16 v[80:83], v[8:11], a[64:71], v112
s_waitcnt vmcnt(3)
ds_read_b128 v[20:23], v116 offset:7168
v_pk_add_f16 v32, v32, v72
v_smfmac_f32_16x16x64_f16 v[84:87], v[8:11], a[192:199], v112
ds_read_b128 v[24:27], v116 offset:4096
s_waitcnt lgkmcnt(2)
v_pk_add_f16 v33, v33, v73
v_smfmac_f32_16x16x64_f16 v[80:83], v[12:15], a[96:103], v112
ds_read_b128 v[28:31], v116 offset:5120
v_pk_add_f16 v34, v34, v74
v_smfmac_f32_16x16x64_f16 v[84:87], v[12:15], a[224:231], v112
s_waitcnt lgkmcnt(2)
v_pk_add_f16 v35, v35, v75
v_smfmac_f32_16x16x64_f16 v[80:83], v[20:23], a[40:47], v112
v_cmp_u_f16 vcc, v32, v34
v_smfmac_f32_16x16x64_f16 v[84:87], v[20:23], a[168:175], v112
ds_write_b128 v116, v[32:35] offset:10240
s_cbranch_vccnz main_kernel_c6_m2_f
main_kernel_c6_m2:
v_smfmac_f32_16x16x64_f16 v[80:83], v[32:35], a[16:23], v112
buffer_load_dwordx4 v[96:99], v116, s[4:7], s28 offen sc1
v_smfmac_f32_16x16x64_f16 v[84:87], v[32:35], a[144:151], v112
s_add_u32 s28, s28, 0x40000
s_waitcnt lgkmcnt(2)
v_smfmac_f32_16x16x64_f16 v[80:83], v[24:27], a[72:79], v112
s_waitcnt vmcnt(2)
v_pk_add_f16 v48, v48, v76
v_smfmac_f32_16x16x64_f16 v[84:87], v[24:27], a[200:207], v112
s_waitcnt lgkmcnt(0)
s_barrier
ds_read_b128 v[36:39], v116 offset:11264
v_pk_add_f16 v49, v49, v77
v_smfmac_f32_16x16x64_f16 v[80:83], v[28:31], a[104:111], v112
ds_read_b128 v[40:43], v116 offset:8192
v_pk_add_f16 v50, v50, v78
v_smfmac_f32_16x16x64_f16 v[84:87], v[28:31], a[232:239], v112
ds_read_b128 v[44:47], v116 offset:9216
v_pk_add_f16 v51, v51, v79
v_smfmac_f32_16x16x64_f16 v[88:91], v[8:11], v[144:151], v112
s_waitcnt lgkmcnt(2)
v_cmp_u_f16 vcc, v48, v50
v_smfmac_f32_16x16x64_f16 v[80:83], v[36:39], a[48:55], v112
ds_write_b128 v116, v[48:51] offset:14336
s_cbranch_vccnz main_kernel_c6_m3_f
main_kernel_c6_m3:
v_smfmac_f32_16x16x64_f16 v[80:83], v[48:51], a[24:31], v112
v_smfmac_f32_16x16x64_f16 v[84:87], v[48:51], a[152:159], v112
v_smfmac_f32_16x16x64_f16 v[84:87], v[36:39], a[176:183], v112
s_waitcnt lgkmcnt(2)
v_smfmac_f32_16x16x64_f16 v[80:83], v[40:43], a[80:87], v112
s_waitcnt lgkmcnt(0)
s_barrier
ds_read_b128 v[52:55], v116 offset:15360
v_smfmac_f32_16x16x64_f16 v[84:87], v[40:43], a[208:215], v112
s_add_u32 s19, s52, s54
ds_read_b128 v[56:59], v116 offset:12288
v_smfmac_f32_16x16x64_f16 v[80:83], v[44:47], a[112:119], v112
s_add_u32 s18, s18, 0x40000
ds_read_b128 v[60:63], v116 offset:13312
v_smfmac_f32_16x16x64_f16 v[84:87], v[44:47], a[240:247], v112
s_bitset0_b32 s18, 20
s_waitcnt lgkmcnt(2)
v_smfmac_f32_16x16x64_f16 v[80:83], v[52:55], a[56:63], v112
s_cmp_eq_u32 s17, 30
s_cselect_b32 s32, s53, 0x10000
s_waitcnt lgkmcnt(1)
v_smfmac_f32_16x16x64_f16 v[80:83], v[56:59], a[88:95], v112
s_add_u32 s52, s52, s32
s_waitcnt lgkmcnt(0)
v_smfmac_f32_16x16x64_f16 v[80:83], v[60:63], a[120:127], v112
s_sub_u32 s24, 0x20000, s32
ds_read_b128 v[64:67], v116 offset:24576
v_smfmac_f32_16x16x64_f16 v[84:87], v[52:55], a[184:191], v112
s_add_u32 s55, s55, s24
ds_read_b128 v[68:71], v116 offset:28672
v_smfmac_f32_16x16x64_f16 v[84:87], v[56:59], a[216:223], v112
ds_read_b128 v[72:75], v116 offset:25600
s_nop 0
v_cvt_pk_bf16_f32 v92, v80, v81
v_smfmac_f32_16x16x64_f16 v[84:87], v[60:63], a[248:255], v112
ds_read_b128 v[76:79], v116 offset:29696
s_nop 0
v_cvt_pk_bf16_f32 v93, v82, v83
v_smfmac_f32_16x16x64_f16 v[88:91], v[12:15], v[152:159], v112
s_nop 3
v_cvt_pk_bf16_f32 v94, v84, v85
v_cvt_pk_bf16_f32 v95, v86, v87
s_mov_b32 vcc_lo, 0xcccccccc
s_mov_b32 vcc_hi, 0xcccccccc
v_mfma_f32_16x16x32_bf16 v[84:87], v[92:95], v[104:107], 0
v_add_u32 v121, v121, v122
v_writelane_b32 v121, s55, 39
s_nop 0
v_smfmac_f32_16x16x64_f16 v[88:91], v[16:19], v[160:167], v112
s_nop 2
s_cmp_eq_u32 s17, 63
v_cvt_pk_bf16_f32 v114, v84, v85
v_cvt_pk_bf16_f32 v115, v86, v87
buffer_store_dwordx2 v[114:115], v117, s[4:7], s21 offen sc1
s_cbranch_scc1 main_kernel_c6_last
ds_write_b64 v117, v[114:115] offset:17408
v_smfmac_f32_16x16x64_f16 v[88:91], v[20:23], v[168:175], v112
v_smfmac_f32_16x16x64_f16 v[88:91], v[24:27], v[176:183], v112
v_smfmac_f32_16x16x64_f16 v[88:91], v[28:31], v[184:191], v112
v_smfmac_f32_16x16x64_f16 v[88:91], v[32:35], v[192:199], v112
s_waitcnt lgkmcnt(0)
s_barrier
ds_read_b128 v[0:3], v116 offset:16384
v_smfmac_f32_16x16x64_f16 v[88:91], v[36:39], v[200:207], v112
ds_read_b128 v[4:7], v116 offset:17408
v_smfmac_f32_16x16x64_f16 v[88:91], v[40:43], v[208:215], v112
ds_read_b128 v[16:19], v116 offset:26624
v_smfmac_f32_16x16x64_f16 v[88:91], v[44:47], v[216:223], v112
ds_read_b128 v[20:23], v116 offset:30720
v_smfmac_f32_16x16x64_f16 v[88:91], v[48:51], v[224:231], v112
ds_read_b128 v[24:27], v116 offset:27648
v_smfmac_f32_16x16x64_f16 v[88:91], v[52:55], v[232:239], v112
ds_read_b128 v[28:31], v116 offset:31744
v_smfmac_f32_16x16x64_f16 v[88:91], v[56:59], v[240:247], v112
v_smfmac_f32_16x16x64_f16 v[88:91], v[60:63], v[248:255], v112
s_waitcnt lgkmcnt(5)
v_mfma_f32_16x16x32_bf16 v[80:83], v[64:67], v[0:3], 0
v_mfma_f32_16x16x32_bf16 v[84:87], v[68:71], v[0:3], 0
buffer_load_dwordx4 v[8:11], v116, s[4:7], s20 offen offset:0 sc1
v_mfma_f32_16x16x32_bf16 v[92:95], v[0:3], v[0:3], 0
buffer_load_dwordx4 v[12:15], v116, s[4:7], s20 offen offset:1024 sc1
v_permlane32_swap_b32 v88, v90
s_waitcnt lgkmcnt(4)
v_mfma_f32_16x16x32_bf16 v[80:83], v[72:75], v[4:7], v[80:83]
v_permlane32_swap_b32 v89, v91
v_mfma_f32_16x16x32_bf16 v[84:87], v[76:79], v[4:7], v[84:87]
v_pk_add_f32 v[88:89], v[88:89], v[90:91]
v_mfma_f32_16x16x32_bf16 v[92:95], v[4:7], v[4:7], v[92:95]
v_cvt_pk_bf16_f32 v124, v88, v89
v_mov_b32 v65, 0
s_waitcnt lgkmcnt(0)
s_waitcnt vmcnt(1)
v_mfma_f32_16x16x32_bf16 v[88:91], v[8:11], v[8:11], v[92:95]
v_mfma_f32_16x16x32_bf16 v[0:3], v[16:19], v[8:11], v[80:83]
v_cmp_u_f32 s[0:1], v8, v10
v_mfma_f32_16x16x32_bf16 v[4:7], v[20:23], v[8:11], v[84:87]
s_waitcnt vmcnt(0)
v_mfma_f32_16x16x32_bf16 v[88:91], v[12:15], v[12:15], v[88:91]
v_mfma_f32_16x16x32_bf16 v[0:3], v[24:27], v[12:15], v[0:3]
v_cmp_u_f32 s[32:33], v12, v14
v_mfma_f32_16x16x32_bf16 v[4:7], v[28:31], v[12:15], v[4:7]
s_or_b64 s[0:1], s[0:1], s[32:33]
s_cbranch_scc1 main_kernel_c6_z_f
main_kernel_c6_z:
v_mul_f32 v88, s30, v88
v_mul_f32 v89, s30, v89
v_exp_f32 v88, v88
v_exp_f32 v89, v89
v_cndmask_b32_dpp v0, v2, v0, vcc quad_perm:[2,3,2,3] row_mask:0xf bank_mask:0xf
v_cvt_pk_bf16_f32 v64, v88, v89
v_cndmask_b32_dpp v1, v3, v1, vcc quad_perm:[2,3,2,3] row_mask:0xf bank_mask:0xf
v_exp_f32 v0, v0
v_mfma_f32_16x16x16_bf16 v[16:19], v[100:101], v[64:65], 0
v_exp_f32 v1, v1
v_cndmask_b32_dpp v4, v6, v4, vcc quad_perm:[2,3,2,3] row_mask:0xf bank_mask:0xf
v_mfma_f32_16x16x16_bf16 v[8:11], v[124:125], v[64:65], 0
v_cndmask_b32_dpp v5, v7, v5, vcc quad_perm:[2,3,2,3] row_mask:0xf bank_mask:0xf
v_exp_f32 v4, v4
v_exp_f32 v5, v5
v_cvt_pk_bf16_f32 v92, v0, v1
v_cvt_pk_bf16_f32 v94, v4, v5
v_mov_b32 v80, 0
v_mov_b32_dpp v93, v92 quad_perm:[0,1,0,1] row_mask:0xf bank_mask:0xf
v_mov_b32_dpp v95, v94 quad_perm:[0,1,0,1] row_mask:0xf bank_mask:0xf
v_mov_b32 v81, 0
v_mov_b32 v82, 0
v_mfma_f32_16x16x32_bf16 v[16:19], v[100:103], v[92:95], v[16:19]
v_mov_b32 v83, 0
v_mov_b32 v84, 0
v_mfma_f32_16x16x32_bf16 v[8:11], v[96:99], v[92:95], v[8:11]
s_nop 1
v_mov_b32 v85, 0
v_mov_b32 v86, 0
v_mov_b32 v87, 0
v_rcp_f32 v126, v16
v_subrev_u32 v127, 0x21800000, v16
v_cmp_lt_u32 vcc, 0x3c000000, v127
v_pk_mul_f32 v[8:9], v[8:9], v[126:127] op_sel_hi:[1,0]
v_pk_mul_f32 v[10:11], v[10:11], v[126:127] op_sel_hi:[1,0]
s_and_b32 s32, vcc_lo, 0xcccc
v_cvt_pk_bf16_f32 v126, v8, v9
v_cvt_pk_bf16_f32 v127, v10, v11
s_cbranch_scc1 main_kernel_c6_sm_f
main_kernel_c6_ost:
buffer_store_dwordx2 v[126:127], v118, s[4:7], s22 offen sc1
v_cmp_eq_u32 s[0:1], 0, v123
v_mov_b32 v24, -1
v_mov_b32 v25, -1
v_mov_b32 v26, -1
v_mov_b32 v27, -1
ds_read_b128 v[32:35], v113 offset:0
ds_read_b128 v[36:39], v113 offset:1024
ds_read_b128 v[40:43], v113 offset:2048
ds_read_b128 v[44:47], v113 offset:3072
ds_read_b128 v[48:51], v113 offset:4096
ds_read_b128 v[52:55], v113 offset:5120
s_and_b32 s10, s1, 0x3f00
buffer_store_dwordx4 v[24:27], v116, s[4:7], s3 offen sc1
s_barrier
buffer_load_dwordx4 v[0:3], v116, s[4:7], s23 offen sc1
ds_read_b128 v[56:59], v113 offset:6144
ds_read_b128 v[60:63], v113 offset:7168
s_add_u32 s37, s37, 65536
s_add_u32 s26, s26, 65536
s_nop 1
s_xor_b32 s32, s23, 1024
buffer_load_dwordx4 v[4:7], v116, s[4:7], s32 offen sc1
ds_read_b128 v[64:67], v113 offset:8192
ds_read_b128 v[68:71], v113 offset:9216
s_nop 3
s_xor_b32 s32, s23, 2048
buffer_load_dwordx4 v[8:11], v116, s[4:7], s32 offen sc1
ds_read_b128 v[72:75], v113 offset:10240
ds_read_b128 v[76:79], v113 offset:11264
s_nop 3
s_xor_b32 s32, s23, 3072
buffer_load_dwordx4 v[12:15], v116, s[4:7], s32 offen sc1
ds_read_b128 v[88:91], v113 offset:12288
ds_read_b128 v[92:95], v113 offset:13312
s_nop 3
s_xor_b32 s32, s23, 4096
buffer_load_dwordx4 v[16:19], v116, s[4:7], s32 offen sc1
s_nop 7
s_xor_b32 s32, s23, 5120
buffer_load_dwordx4 v[20:23], v116, s[4:7], s32 offen sc1
s_nop 7
s_xor_b32 s32, s23, 6144
buffer_load_dwordx4 v[24:27], v116, s[4:7], s32 offen sc1
s_nop 7
s_xor_b32 s32, s23, 7168
buffer_load_dwordx4 v[28:31], v116, s[4:7], s32 offen sc1
s_waitcnt lgkmcnt(12)
s_waitcnt vmcnt(7)
v_cmp_u_f32 vcc, v0, v2
s_cbranch_vccnz main_kernel_c6_o0_f
main_kernel_c6_o0:
v_smfmac_f32_16x16x64_bf16 v[80:83], v[0:3], v[32:39], v112
ds_read_b128 v[32:35], v113 offset:14336
ds_read_b128 v[36:39], v113 offset:15360
s_waitcnt lgkmcnt(12)
s_waitcnt vmcnt(6)
v_cmp_u_f32 vcc, v4, v6
v_smfmac_f32_16x16x64_bf16 v[84:87], v[0:3], v[40:47], v112
ds_read_b128 v[40:43], v113 offset:16384
ds_read_b128 v[44:47], v113 offset:17408
buffer_store_dwordx2 v[114:115], v119, s[4:7], s37 offen sc1
s_cbranch_vccnz main_kernel_c6_o1_f
main_kernel_c6_o1:
s_waitcnt lgkmcnt(12)
v_smfmac_f32_16x16x64_bf16 v[80:83], v[4:7], v[48:55], v112
ds_read_b128 v[48:51], v113 offset:18432
ds_read_b128 v[52:55], v113 offset:19456
s_waitcnt lgkmcnt(12)
s_waitcnt vmcnt(6)
v_cmp_u_f32 vcc, v8, v10
v_smfmac_f32_16x16x64_bf16 v[84:87], v[4:7], v[56:63], v112
ds_read_b128 v[56:59], v113 offset:20480
ds_read_b128 v[60:63], v113 offset:21504
buffer_store_dword v124, v120, s[4:7], s26 offen sc1
s_cbranch_vccnz main_kernel_c6_o2_f
main_kernel_c6_o2:
s_waitcnt lgkmcnt(12)
v_smfmac_f32_16x16x64_bf16 v[80:83], v[8:11], v[64:71], v112
ds_read_b128 v[64:67], v113 offset:22528
ds_read_b128 v[68:71], v113 offset:23552
s_waitcnt lgkmcnt(12)
s_waitcnt vmcnt(6)
v_cmp_u_f32 vcc, v12, v14
v_smfmac_f32_16x16x64_bf16 v[84:87], v[8:11], v[72:79], v112
ds_read_b128 v[72:75], v113 offset:24576
ds_read_b128 v[76:79], v113 offset:25600
s_cbranch_vccnz main_kernel_c6_o3_f
main_kernel_c6_o3:
s_waitcnt lgkmcnt(12)
v_smfmac_f32_16x16x64_bf16 v[80:83], v[12:15], v[88:95], v112
ds_read_b128 v[88:91], v113 offset:26624
ds_read_b128 v[92:95], v113 offset:27648
s_waitcnt lgkmcnt(12)
s_waitcnt vmcnt(5)
v_cmp_u_f32 vcc, v16, v18
v_smfmac_f32_16x16x64_bf16 v[84:87], v[12:15], v[32:39], v112
ds_read_b128 v[32:35], v113 offset:28672
ds_read_b128 v[36:39], v113 offset:29696
s_cbranch_vccnz main_kernel_c6_o4_f
main_kernel_c6_o4:
s_waitcnt lgkmcnt(12)
v_smfmac_f32_16x16x64_bf16 v[80:83], v[16:19], v[40:47], v112
ds_read_b128 v[40:43], v113 offset:30720
ds_read_b128 v[44:47], v113 offset:31744
s_waitcnt lgkmcnt(12)
s_waitcnt vmcnt(4)
v_cmp_u_f32 vcc, v20, v22
v_smfmac_f32_16x16x64_bf16 v[84:87], v[16:19], v[48:55], v112
s_cbranch_vccnz main_kernel_c6_o5_f
main_kernel_c6_o5:
s_waitcnt lgkmcnt(10)
v_smfmac_f32_16x16x64_bf16 v[80:83], v[20:23], v[56:63], v112
s_waitcnt lgkmcnt(8)
s_waitcnt vmcnt(3)
v_cmp_u_f32 vcc, v24, v26
v_smfmac_f32_16x16x64_bf16 v[84:87], v[20:23], v[64:71], v112
s_cbranch_vccnz main_kernel_c6_o6_f
main_kernel_c6_o6:
s_waitcnt lgkmcnt(6)
v_smfmac_f32_16x16x64_bf16 v[80:83], v[24:27], v[72:79], v112
s_waitcnt lgkmcnt(4)
v_smfmac_f32_16x16x64_bf16 v[84:87], v[24:27], v[88:95], v112
s_waitcnt lgkmcnt(2)
s_waitcnt vmcnt(2)
v_cmp_u_f32 vcc, v28, v30
s_cbranch_vccnz main_kernel_c6_o7_f
main_kernel_c6_o7:
v_smfmac_f32_16x16x64_bf16 v[80:83], v[28:31], v[32:39], v112
s_waitcnt lgkmcnt(0)
v_smfmac_f32_16x16x64_bf16 v[84:87], v[28:31], v[40:47], v112
s_nop 4
v_cvt_pk_bf16_f32 v80, v80, v81
v_cvt_pk_bf16_f32 v81, v82, v83
ds_write_b64 v116, v[80:81] offset:21504
v_cvt_pk_bf16_f32 v82, v84, v85
v_cvt_pk_bf16_f32 v83, v86, v87
ds_write_b64 v116, v[82:83] offset:23552
s_waitcnt lgkmcnt(0)
s_barrier
ds_read_b128 v[72:75], v116 offset:20480
ds_read_b128 v[76:79], v116 offset:21504
s_mov_b32 m0, 28672
s_cmp_lg_u32 s10, 0
s_waitcnt lgkmcnt(1)
v_mfma_f32_16x16x32_bf16 v[64:67], v[72:75], v[108:111], 0
s_waitcnt lgkmcnt(0)
v_mfma_f32_16x16x32_bf16 v[64:67], v[76:79], v[108:111], v[64:67]
s_nop 7
v_cvt_pk_f16_f32 v68, v64, v65
v_cvt_pk_f16_f32 v69, v66, v67
buffer_store_dwordx2 v[68:69], v125, s[4:7], s25 offen sc1
s_cbranch_scc1 main_kernel_c6_kvw
main_kernel_c6_kvok:
s_nop 3
buffer_load_dwordx4 v116, s[4:7], s27 offen sc1 lds
buffer_load_dwordx4 v116, s[4:7], s27 offen offset:1024 sc1 lds
s_mov_b32 m0, 30720
s_xor_b32 s32, s27, 2048
buffer_load_dwordx4 v116, s[4:7], s32 offen offset:1024 sc1 lds
s_add_u32 s27, s27, 0x40000
s_branch main_kernel_c6_top
main_kernel_c6_kvw:
s_mov_b32 exec_lo, 0
s_mov_b32 exec_hi, 0x3f00
v_subrev_u32 v127, 128, v121
main_kernel_c6_kvp:
buffer_load_dword v126, v127, s[4:7], 0 offen sc1
s_waitcnt vmcnt(0)
v_cmp_eq_u32 vcc, 0, v126
s_cbranch_vccz main_kernel_c6_kvp_ok
s_sleep 2
s_sub_u32 s29, s29, 1
s_cbranch_scc0 main_kernel_c6_kvp
s_branch main_kernel_end
main_kernel_c6_kvp_ok:
s_mov_b64 exec, -1
s_branch main_kernel_c6_kvok
main_kernel_c6_last:
s_add_u32 s37, s37, 65536
s_add_u32 s26, s26, 65536
buffer_store_dwordx2 v[114:115], v119, s[4:7], s37 offen sc1
v_smfmac_f32_16x16x64_f16 v[88:91], v[20:23], v[168:175], v112
v_smfmac_f32_16x16x64_f16 v[88:91], v[24:27], v[176:183], v112
v_smfmac_f32_16x16x64_f16 v[88:91], v[28:31], v[184:191], v112
v_smfmac_f32_16x16x64_f16 v[88:91], v[32:35], v[192:199], v112
v_smfmac_f32_16x16x64_f16 v[88:91], v[36:39], v[200:207], v112
v_smfmac_f32_16x16x64_f16 v[88:91], v[40:43], v[208:215], v112
v_smfmac_f32_16x16x64_f16 v[88:91], v[44:47], v[216:223], v112
v_smfmac_f32_16x16x64_f16 v[88:91], v[48:51], v[224:231], v112
v_smfmac_f32_16x16x64_f16 v[88:91], v[52:55], v[232:239], v112
v_smfmac_f32_16x16x64_f16 v[88:91], v[56:59], v[240:247], v112
v_smfmac_f32_16x16x64_f16 v[88:91], v[60:63], v[248:255], v112
s_nop 7
v_permlane32_swap_b32 v88, v90
s_nop 1
v_permlane32_swap_b32 v89, v91
s_nop 1
v_pk_add_f32 v[88:89], v[88:89], v[90:91]
s_nop 1
v_cvt_pk_bf16_f32 v124, v88, v89
s_nop 1
buffer_store_dword v124, v120, s[4:7], s26 offen sc1
s_branch main_kernel_end
main_kernel_c6_m0_f:
s_waitcnt lgkmcnt(0)
buffer_load_dwordx4 v[0:3], v116, s[4:7], s18 offen sc1
buffer_load_dwordx4 v[64:67], v116, s[4:7], s19 offen sc1
s_xor_b32 s32, s18, 1024
buffer_load_dwordx4 v[16:19], v116, s[4:7], s32 offen sc1
s_xor_b32 s32, s19, 1024
buffer_load_dwordx4 v[68:71], v116, s[4:7], s32 offen sc1
s_xor_b32 s32, s18, 2048
buffer_load_dwordx4 v[32:35], v116, s[4:7], s32 offen sc1
s_xor_b32 s32, s19, 2048
buffer_load_dwordx4 v[72:75], v116, s[4:7], s32 offen sc1
s_xor_b32 s32, s18, 3072
buffer_load_dwordx4 v[48:51], v116, s[4:7], s32 offen sc1
s_xor_b32 s32, s19, 3072
buffer_load_dwordx4 v[76:79], v116, s[4:7], s32 offen sc1
s_sub_u32 s29, s29, 1
s_cbranch_scc1 main_kernel_end
s_waitcnt vmcnt(0)
v_max_u32 v126, v0, v2
v_max3_u32 v126, v126, v64, v66
v_cmp_eq_u32 vcc, -1, v126
s_cbranch_vccnz main_kernel_c6_m0_f
v_pk_add_f16 v0, v0, v64
v_pk_add_f16 v1, v1, v65
v_pk_add_f16 v2, v2, v66
v_pk_add_f16 v3, v3, v67
s_nop 0
s_branch main_kernel_c6_m0
main_kernel_c6_m1_f:
s_waitcnt lgkmcnt(0)
s_xor_b32 s32, s18, 1024
buffer_load_dwordx4 v[16:19], v116, s[4:7], s32 offen sc1
s_xor_b32 s32, s19, 1024
buffer_load_dwordx4 v[68:71], v116, s[4:7], s32 offen sc1
s_xor_b32 s32, s18, 2048
buffer_load_dwordx4 v[32:35], v116, s[4:7], s32 offen sc1
s_xor_b32 s32, s19, 2048
buffer_load_dwordx4 v[72:75], v116, s[4:7], s32 offen sc1
s_xor_b32 s32, s18, 3072
buffer_load_dwordx4 v[48:51], v116, s[4:7], s32 offen sc1
s_xor_b32 s32, s19, 3072
buffer_load_dwordx4 v[76:79], v116, s[4:7], s32 offen sc1
s_sub_u32 s29, s29, 1
s_cbranch_scc1 main_kernel_end
s_waitcnt vmcnt(0)
v_max_u32 v126, v16, v18
v_max3_u32 v126, v126, v68, v70
v_cmp_eq_u32 vcc, -1, v126
s_cbranch_vccnz main_kernel_c6_m1_f
v_pk_add_f16 v16, v16, v68
v_pk_add_f16 v17, v17, v69
v_pk_add_f16 v18, v18, v70
v_pk_add_f16 v19, v19, v71
s_nop 0
s_branch main_kernel_c6_m1
main_kernel_c6_m2_f:
s_waitcnt lgkmcnt(0)
s_xor_b32 s32, s18, 2048
buffer_load_dwordx4 v[32:35], v116, s[4:7], s32 offen sc1
s_xor_b32 s32, s19, 2048
buffer_load_dwordx4 v[72:75], v116, s[4:7], s32 offen sc1
s_xor_b32 s32, s18, 3072
buffer_load_dwordx4 v[48:51], v116, s[4:7], s32 offen sc1
s_xor_b32 s32, s19, 3072
buffer_load_dwordx4 v[76:79], v116, s[4:7], s32 offen sc1
s_sub_u32 s29, s29, 1
s_cbranch_scc1 main_kernel_end
s_waitcnt vmcnt(0)
v_max_u32 v126, v32, v34
v_max3_u32 v126, v126, v72, v74
v_cmp_eq_u32 vcc, -1, v126
s_cbranch_vccnz main_kernel_c6_m2_f
v_pk_add_f16 v32, v32, v72
v_pk_add_f16 v33, v33, v73
v_pk_add_f16 v34, v34, v74
v_pk_add_f16 v35, v35, v75
ds_write_b128 v116, v[32:35] offset:10240
s_branch main_kernel_c6_m2
main_kernel_c6_m3_f:
s_waitcnt lgkmcnt(0)
s_xor_b32 s32, s18, 3072
buffer_load_dwordx4 v[48:51], v116, s[4:7], s32 offen sc1
s_xor_b32 s32, s19, 3072
buffer_load_dwordx4 v[76:79], v116, s[4:7], s32 offen sc1
s_sub_u32 s29, s29, 1
s_cbranch_scc1 main_kernel_end
s_waitcnt vmcnt(0)
v_max_u32 v126, v48, v50
v_max3_u32 v126, v126, v76, v78
v_cmp_eq_u32 vcc, -1, v126
s_cbranch_vccnz main_kernel_c6_m3_f
v_pk_add_f16 v48, v48, v76
v_pk_add_f16 v49, v49, v77
v_pk_add_f16 v50, v50, v78
v_pk_add_f16 v51, v51, v79
ds_write_b128 v116, v[48:51] offset:14336
s_branch main_kernel_c6_m3
main_kernel_c6_z_f:
buffer_load_dwordx4 v[8:11], v116, s[4:7], s20 offen offset:0 sc1
buffer_load_dwordx4 v[12:15], v116, s[4:7], s20 offen offset:1024 sc1
s_memtime s[32:33]
ds_read_b32 v126, v116 offset:18432
s_sub_u32 s34, s19, s54
s_xor_b32 s34, s34, 0x2000
s_lshl_b32 s35, s12, 15
s_add_u32 s34, s34, s35
s_lshl_b32 s35, s13, 8
s_add_u32 s35, s35, s34
s_add_u32 s34, s34, 0x4000
s_waitcnt lgkmcnt(0)
s_sub_u32 s32, s32, 450
v_sub_u32 v127, s32, v126
buffer_store_dword v127, off, s[4:7], s34 sc1
s_sub_u32 s29, s29, 1
s_cbranch_scc1 main_kernel_end
s_waitcnt vmcnt(1)
main_kernel_c6_z_g:
v_max_u32 v126, v8, v10
v_max3_u32 v126, v126, v12, v14
v_cmp_eq_u32 vcc, -1, v126
s_cbranch_vccnz main_kernel_c6_z_h
v_mfma_f32_16x16x32_bf16 v[88:91], v[8:11], v[8:11], v[92:95]
v_mfma_f32_16x16x32_bf16 v[0:3], v[16:19], v[8:11], v[80:83]
v_mfma_f32_16x16x32_bf16 v[4:7], v[20:23], v[8:11], v[84:87]
v_mfma_f32_16x16x32_bf16 v[88:91], v[12:15], v[12:15], v[88:91]
v_mfma_f32_16x16x32_bf16 v[0:3], v[24:27], v[12:15], v[0:3]
v_mfma_f32_16x16x32_bf16 v[4:7], v[28:31], v[12:15], v[4:7]
buffer_store_dword v127, off, s[4:7], s35 offset:132 sc1
s_mov_b32 vcc_lo, 0xcccccccc
s_mov_b32 vcc_hi, 0xcccccccc
s_branch main_kernel_c6_z
main_kernel_c6_z_h:
buffer_load_dwordx4 v[8:11], v116, s[4:7], s20 offen offset:0 sc1
buffer_load_dwordx4 v[12:15], v116, s[4:7], s20 offen offset:1024 sc1
s_sub_u32 s29, s29, 1
s_cbranch_scc1 main_kernel_end
v_add_u32 v127, 300, v127
s_waitcnt vmcnt(0)
s_branch main_kernel_c6_z_g
main_kernel_c6_sm_f:
s_waitcnt vmcnt(0) lgkmcnt(0)
buffer_load_dwordx4 v[8:11], v116, s[4:7], s20 offen offset:0 sc1
buffer_load_dwordx4 v[12:15], v116, s[4:7], s20 offen offset:1024 sc1
ds_read_b128 v[0:3], v116 offset:16384
ds_read_b128 v[4:7], v116 offset:17408
ds_read_b128 v[64:67], v116 offset:24576
ds_read_b128 v[68:71], v116 offset:28672
ds_read_b128 v[72:75], v116 offset:25600
ds_read_b128 v[76:79], v116 offset:29696
ds_read_b128 v[16:19], v116 offset:26624
ds_read_b128 v[20:23], v116 offset:30720
ds_read_b128 v[24:27], v116 offset:27648
ds_read_b128 v[28:31], v116 offset:31744
s_waitcnt vmcnt(0)
s_waitcnt lgkmcnt(0)
v_mfma_f32_16x16x32_bf16 v[80:83], v[64:67], v[0:3], 0
v_mfma_f32_16x16x32_bf16 v[84:87], v[68:71], v[0:3], 0
v_mfma_f32_16x16x32_bf16 v[92:95], v[0:3], v[0:3], 0
v_mfma_f32_16x16x32_bf16 v[80:83], v[72:75], v[4:7], v[80:83]
v_mfma_f32_16x16x32_bf16 v[84:87], v[76:79], v[4:7], v[84:87]
v_mfma_f32_16x16x32_bf16 v[92:95], v[4:7], v[4:7], v[92:95]
v_mfma_f32_16x16x32_bf16 v[0:3], v[16:19], v[8:11], v[80:83]
v_mfma_f32_16x16x32_bf16 v[4:7], v[20:23], v[8:11], v[84:87]
v_mfma_f32_16x16x32_bf16 v[88:91], v[8:11], v[8:11], v[92:95]
v_mfma_f32_16x16x32_bf16 v[0:3], v[24:27], v[12:15], v[0:3]
v_mfma_f32_16x16x32_bf16 v[4:7], v[28:31], v[12:15], v[4:7]
v_mfma_f32_16x16x32_bf16 v[88:91], v[12:15], v[12:15], v[88:91]
s_nop 7
v_mov_b32 v65, 0
v_max_f32 v126, v88, v89
v_mul_f32 v126, s30, v126
v_max3_f32 v126, v126, v0, v1
v_max3_f32 v126, v126, v2, v3
v_max3_f32 v126, v126, v4, v5
v_max3_f32 v126, v126, v6, v7
v_mov_b32 v127, v126
s_nop 1
v_permlane32_swap_b32 v126, v127
v_max_f32 v126, v126, v127
v_mov_b32 v127, v126
s_nop 1
v_permlane16_swap_b32 v126, v127
v_max_f32 v126, v126, v127
v_mul_f32 v127, 0x40faf233, v126
s_mov_b32 vcc_lo, 0xcccccccc
s_mov_b32 vcc_hi, 0xcccccccc
v_sub_f32 v0, v0, v126
v_sub_f32 v1, v1, v126
v_sub_f32 v2, v2, v126
v_sub_f32 v3, v3, v126
v_sub_f32 v4, v4, v126
v_sub_f32 v5, v5, v126
v_sub_f32 v6, v6, v126
v_sub_f32 v7, v7, v126
v_sub_f32 v88, v88, v127
v_sub_f32 v89, v89, v127
s_waitcnt lgkmcnt(0)
s_nop 0
v_mul_f32 v88, s30, v88
v_mul_f32 v89, s30, v89
v_exp_f32 v88, v88
v_exp_f32 v89, v89
v_cndmask_b32_dpp v0, v2, v0, vcc quad_perm:[2,3,2,3] row_mask:0xf bank_mask:0xf
v_cvt_pk_bf16_f32 v64, v88, v89
v_cndmask_b32_dpp v1, v3, v1, vcc quad_perm:[2,3,2,3] row_mask:0xf bank_mask:0xf
v_exp_f32 v0, v0
v_mfma_f32_16x16x16_bf16 v[16:19], v[100:101], v[64:65], 0
v_exp_f32 v1, v1
v_cndmask_b32_dpp v4, v6, v4, vcc quad_perm:[2,3,2,3] row_mask:0xf bank_mask:0xf
v_mfma_f32_16x16x16_bf16 v[8:11], v[124:125], v[64:65], 0
v_cndmask_b32_dpp v5, v7, v5, vcc quad_perm:[2,3,2,3] row_mask:0xf bank_mask:0xf
v_exp_f32 v4, v4
v_exp_f32 v5, v5
v_cvt_pk_bf16_f32 v92, v0, v1
v_cvt_pk_bf16_f32 v94, v4, v5
v_mov_b32 v80, 0
v_mov_b32_dpp v93, v92 quad_perm:[0,1,0,1] row_mask:0xf bank_mask:0xf
v_mov_b32_dpp v95, v94 quad_perm:[0,1,0,1] row_mask:0xf bank_mask:0xf
v_mov_b32 v81, 0
v_mov_b32 v82, 0
v_mfma_f32_16x16x32_bf16 v[16:19], v[100:103], v[92:95], v[16:19]
v_mov_b32 v83, 0
v_mov_b32 v84, 0
v_mfma_f32_16x16x32_bf16 v[8:11], v[96:99], v[92:95], v[8:11]
s_nop 1
v_mov_b32 v85, 0
v_mov_b32 v86, 0
v_mov_b32 v87, 0
v_rcp_f32 v126, v16
v_subrev_u32 v127, 0x21800000, v16
v_cmp_lt_u32 vcc, 0x3c000000, v127
v_pk_mul_f32 v[8:9], v[8:9], v[126:127] op_sel_hi:[1,0]
v_pk_mul_f32 v[10:11], v[10:11], v[126:127] op_sel_hi:[1,0]
s_and_b32 s32, vcc_lo, 0xcccc
v_cvt_pk_bf16_f32 v126, v8, v9
v_cvt_pk_bf16_f32 v127, v10, v11
s_branch main_kernel_c6_ost
main_kernel_c6_o0_f:
s_nop 0
buffer_load_dwordx4 v[0:3], v116, s[4:7], s23 offen sc1
s_xor_b32 s32, s23, 1024
buffer_load_dwordx4 v[4:7], v116, s[4:7], s32 offen sc1
s_sub_u32 s29, s29, 1
s_cbranch_scc1 main_kernel_end
s_waitcnt vmcnt(0)
v_max_u32 v126, v0, v2
v_cmp_eq_u32 vcc, -1, v126
s_cbranch_vccnz main_kernel_c6_o0_f
s_branch main_kernel_c6_o0
main_kernel_c6_o1_f:
s_nop 0
s_xor_b32 s32, s23, 1024
buffer_load_dwordx4 v[4:7], v116, s[4:7], s32 offen sc1
s_xor_b32 s32, s23, 2048
buffer_load_dwordx4 v[8:11], v116, s[4:7], s32 offen sc1
s_sub_u32 s29, s29, 1
s_cbranch_scc1 main_kernel_end
s_waitcnt vmcnt(0)
v_max_u32 v126, v4, v6
v_cmp_eq_u32 vcc, -1, v126
s_cbranch_vccnz main_kernel_c6_o1_f
s_branch main_kernel_c6_o1
main_kernel_c6_o2_f:
s_nop 0
s_xor_b32 s32, s23, 2048
buffer_load_dwordx4 v[8:11], v116, s[4:7], s32 offen sc1
s_xor_b32 s32, s23, 3072
buffer_load_dwordx4 v[12:15], v116, s[4:7], s32 offen sc1
s_sub_u32 s29, s29, 1
s_cbranch_scc1 main_kernel_end
s_waitcnt vmcnt(0)
v_max_u32 v126, v8, v10
v_cmp_eq_u32 vcc, -1, v126
s_cbranch_vccnz main_kernel_c6_o2_f
s_branch main_kernel_c6_o2
main_kernel_c6_o3_f:
s_nop 0
s_xor_b32 s32, s23, 3072
buffer_load_dwordx4 v[12:15], v116, s[4:7], s32 offen sc1
s_xor_b32 s32, s23, 4096
buffer_load_dwordx4 v[16:19], v116, s[4:7], s32 offen sc1
s_sub_u32 s29, s29, 1
s_cbranch_scc1 main_kernel_end
s_waitcnt vmcnt(0)
v_max_u32 v126, v12, v14
v_cmp_eq_u32 vcc, -1, v126
s_cbranch_vccnz main_kernel_c6_o3_f
s_branch main_kernel_c6_o3
main_kernel_c6_o4_f:
s_nop 0
s_xor_b32 s32, s23, 4096
buffer_load_dwordx4 v[16:19], v116, s[4:7], s32 offen sc1
s_xor_b32 s32, s23, 5120
buffer_load_dwordx4 v[20:23], v116, s[4:7], s32 offen sc1
s_sub_u32 s29, s29, 1
s_cbranch_scc1 main_kernel_end
s_waitcnt vmcnt(0)
v_max_u32 v126, v16, v18
v_cmp_eq_u32 vcc, -1, v126
s_cbranch_vccnz main_kernel_c6_o4_f
s_branch main_kernel_c6_o4
main_kernel_c6_o5_f:
s_nop 0
s_xor_b32 s32, s23, 5120
buffer_load_dwordx4 v[20:23], v116, s[4:7], s32 offen sc1
s_xor_b32 s32, s23, 6144
buffer_load_dwordx4 v[24:27], v116, s[4:7], s32 offen sc1
s_sub_u32 s29, s29, 1
s_cbranch_scc1 main_kernel_end
s_waitcnt vmcnt(0)
v_max_u32 v126, v20, v22
v_cmp_eq_u32 vcc, -1, v126
s_cbranch_vccnz main_kernel_c6_o5_f
s_branch main_kernel_c6_o5
main_kernel_c6_o6_f:
s_nop 0
s_xor_b32 s32, s23, 6144
buffer_load_dwordx4 v[24:27], v116, s[4:7], s32 offen sc1
s_xor_b32 s32, s23, 7168
buffer_load_dwordx4 v[28:31], v116, s[4:7], s32 offen sc1
s_sub_u32 s29, s29, 1
s_cbranch_scc1 main_kernel_end
s_waitcnt vmcnt(0)
v_max_u32 v126, v24, v26
v_cmp_eq_u32 vcc, -1, v126
s_cbranch_vccnz main_kernel_c6_o6_f
s_branch main_kernel_c6_o6
main_kernel_c6_o7_f:
s_nop 0
s_xor_b32 s32, s23, 7168
buffer_load_dwordx4 v[28:31], v116, s[4:7], s32 offen sc1
s_sub_u32 s29, s29, 1
s_cbranch_scc1 main_kernel_end
s_waitcnt vmcnt(0)
v_max_u32 v126, v28, v30
v_cmp_eq_u32 vcc, -1, v126
s_cbranch_vccnz main_kernel_c6_o7_f
s_branch main_kernel_c6_o7
.p2align 6
main_kernel_c7_top:
s_barrier
buffer_load_dwordx4 v[0:3], v116, s[4:7], s18 offen sc1
s_add_u32 s20, s20, 0x40000
s_bitset0_b32 s20, 20
s_add_u32 s21, s21, 0x40000
s_bitset0_b32 s21, 20
s_add_u32 s22, s22, 0x40000
s_bitset0_b32 s22, 20
s_add_u32 s23, s23, 0x40000
s_bitset0_b32 s23, 20
s_xor_b32 s32, s18, 1024
buffer_load_dwordx4 v[16:19], v116, s[4:7], s32 offen sc1
s_add_u32 s3, s3, 0x40000
s_bitset0_b32 s3, 20
s_add_u32 s17, s17, 1
s_add_u32 s25, s25, 0x40000
s_bitset0_b32 s25, 20
s_nop 2
buffer_load_dwordx4 v[64:67], v116, s[4:7], s19 offen sc1
v_mov_b32 v80, 0
v_mov_b32 v81, 0
s_nop 3
s_xor_b32 s32, s19, 1024
buffer_load_dwordx4 v[68:71], v116, s[4:7], s32 offen sc1
v_mov_b32 v82, 0
v_mov_b32 v83, 0
s_nop 3
s_xor_b32 s32, s18, 2048
buffer_load_dwordx4 v[32:35], v116, s[4:7], s32 offen sc1
v_mov_b32 v84, 0
v_mov_b32 v85, 0
s_nop 3
s_xor_b32 s32, s19, 2048
buffer_load_dwordx4 v[72:75], v116, s[4:7], s32 offen sc1
v_mov_b32 v86, 0
v_mov_b32 v87, 0
s_nop 3
s_xor_b32 s32, s18, 3072
buffer_load_dwordx4 v[48:51], v116, s[4:7], s32 offen sc1
v_mov_b32 v88, 0
v_mov_b32 v89, 0
s_nop 3
s_xor_b32 s32, s19, 3072
buffer_load_dwordx4 v[76:79], v116, s[4:7], s32 offen sc1
s_memtime s[40:41]
s_memrealtime s[80:81]
s_memrealtime s[82:83]
s_memrealtime s[84:85]
s_memrealtime s[86:87]
s_memrealtime s[88:89]
s_memrealtime s[90:91]
s_memrealtime s[92:93]
s_memrealtime s[94:95]
s_memrealtime s[96:97]
s_memrealtime s[98:99]
s_memrealtime s[100:101]
s_sub_u32 s32, s15, s16
s_lshr_b32 s33, s17, 1
s_min_u32 s33, s33, 3
s_ashr_i32 s32, s32, s33
s_add_u32 s11, s11, s32
s_sub_u32 s32, s16, s27
s_sub_u32 s32, s32, s39
s_ashr_i32 s32, s32, 2
s_add_u32 s39, s39, s32
s_mov_b32 s27, s16
s_mov_b32 s2, s31
v_mov_b32 v126, s11
s_add_u32 s32, s43, 1590
v_mov_b32 v127, s32
s_waitcnt lgkmcnt(0)
ds_write_b32 v116, v126 offset:18432
s_add_u32 s80, s80, s82
s_add_u32 s80, s80, s84
s_add_u32 s80, s80, s86
s_add_u32 s80, s80, s88
s_add_u32 s80, s80, s90
s_add_u32 s80, s80, s92
s_add_u32 s80, s80, s94
s_add_u32 s80, s80, s96
s_add_u32 s80, s80, s98
s_add_u32 s80, s80, s100
s_lshl1_add_u32 s80, s80, s11
s_sub_u32 s15, s40, s80
s_add_u32 s32, s15, s39
v_mov_b32 v126, s32
buffer_store_dwordx2 v[126:127], off, s[4:7], s44 offset:128 sc1
v_mov_b32 v90, 0
v_mov_b32 v91, 0
s_waitcnt vmcnt(6)
v_pk_add_f16 v0, v0, v64
v_pk_add_f16 v1, v1, v65
v_pk_add_f16 v2, v2, v66
v_pk_add_f16 v3, v3, v67
v_cmp_u_f16 vcc, v0, v2
s_cbranch_vccnz main_kernel_c7_m0_f
main_kernel_c7_m0:
v_smfmac_f32_16x16x64_f16 v[80:83], v[0:3], a[0:7], v112
ds_write_b128 v116, v[0:3] offset:3072
v_smfmac_f32_16x16x64_f16 v[84:87], v[0:3], a[128:135], v112
buffer_load_dword v123, v121, s[4:7], 0 offen sc1
s_waitcnt vmcnt(6)
v_pk_add_f16 v16, v16, v68
v_pk_add_f16 v17, v17, v69
v_pk_add_f16 v18, v18, v70
v_pk_add_f16 v19, v19, v71
v_cmp_u_f16 vcc, v16, v18
s_waitcnt lgkmcnt(0)
s_barrier
ds_read_b128 v[4:7], v116 offset:2048
s_cbranch_vccnz main_kernel_c7_m1_f
main_kernel_c7_m1:
v_smfmac_f32_16x16x64_f16 v[80:83], v[16:19], a[8:15], v112
ds_write_b128 v116, v[16:19] offset:7168
v_smfmac_f32_16x16x64_f16 v[84:87], v[16:19], a[136:143], v112
ds_read_b128 v[8:11], v116 offset:1024
v_smfmac_f32_16x16x64_f16 v[88:91], v[0:3], v[128:135], v112
ds_read_b128 v[12:15], v116 offset:0
s_waitcnt lgkmcnt(3)
v_smfmac_f32_16x16x64_f16 v[80:83], v[4:7], a[32:39], v112
v_smfmac_f32_16x16x64_f16 v[84:87], v[4:7], a[160:167], v112
v_smfmac_f32_16x16x64_f16 v[88:91], v[4:7], v[136:143], v112
s_waitcnt lgkmcnt(2)
s_barrier
s_waitcnt lgkmcnt(1)
v_smfmac_f32_16x16x64_f16 v[80:83], v[8:11], a[64:71], v112
s_waitcnt vmcnt(4)
ds_read_b128 v[20:23], v116 offset:6144
v_pk_add_f16 v32, v32, v72
v_smfmac_f32_16x16x64_f16 v[84:87], v[8:11], a[192:199], v112
ds_read_b128 v[24:27], v116 offset:5120
s_waitcnt lgkmcnt(2)
v_pk_add_f16 v33, v33, v73
v_smfmac_f32_16x16x64_f16 v[80:83], v[12:15], a[96:103], v112
ds_read_b128 v[28:31], v116 offset:4096
v_pk_add_f16 v34, v34, v74
v_smfmac_f32_16x16x64_f16 v[84:87], v[12:15], a[224:231], v112
s_waitcnt lgkmcnt(2)
v_pk_add_f16 v35, v35, v75
v_smfmac_f32_16x16x64_f16 v[80:83], v[20:23], a[40:47], v112
v_cmp_u_f16 vcc, v32, v34
v_smfmac_f32_16x16x64_f16 v[84:87], v[20:23], a[168:175], v112
ds_write_b128 v116, v[32:35] offset:11264
s_cbranch_vccnz main_kernel_c7_m2_f
main_kernel_c7_m2:
v_smfmac_f32_16x16x64_f16 v[80:83], v[32:35], a[16:23], v112
buffer_load_dwordx4 v[96:99], v116, s[4:7], s28 offen sc1
v_smfmac_f32_16x16x64_f16 v[84:87], v[32:35], a[144:151], v112
s_add_u32 s28, s28, 0x40000
s_waitcnt lgkmcnt(2)
v_smfmac_f32_16x16x64_f16 v[80:83], v[24:27], a[72:79], v112
s_waitcnt vmcnt(3)
v_pk_add_f16 v48, v48, v76
v_smfmac_f32_16x16x64_f16 v[84:87], v[24:27], a[200:207], v112
s_waitcnt lgkmcnt(0)
s_barrier
ds_read_b128 v[36:39], v116 offset:10240
v_pk_add_f16 v49, v49, v77
v_smfmac_f32_16x16x64_f16 v[80:83], v[28:31], a[104:111], v112
ds_read_b128 v[40:43], v116 offset:9216
v_pk_add_f16 v50, v50, v78
v_smfmac_f32_16x16x64_f16 v[84:87], v[28:31], a[232:239], v112
ds_read_b128 v[44:47], v116 offset:8192
v_pk_add_f16 v51, v51, v79
v_smfmac_f32_16x16x64_f16 v[88:91], v[8:11], v[144:151], v112
s_waitcnt lgkmcnt(2)
v_cmp_u_f16 vcc, v48, v50
v_smfmac_f32_16x16x64_f16 v[80:83], v[36:39], a[48:55], v112
ds_write_b128 v116, v[48:51] offset:15360
s_cbranch_vccnz main_kernel_c7_m3_f
main_kernel_c7_m3:
v_smfmac_f32_16x16x64_f16 v[80:83], v[48:51], a[24:31], v112
v_smfmac_f32_16x16x64_f16 v[84:87], v[48:51], a[152:159], v112
v_smfmac_f32_16x16x64_f16 v[84:87], v[36:39], a[176:183], v112
s_waitcnt lgkmcnt(2)
v_smfmac_f32_16x16x64_f16 v[80:83], v[40:43], a[80:87], v112
s_waitcnt lgkmcnt(0)
s_barrier
ds_read_b128 v[52:55], v116 offset:14336
v_smfmac_f32_16x16x64_f16 v[84:87], v[40:43], a[208:215], v112
s_memtime s[40:41]
ds_read_b128 v[56:59], v116 offset:13312
v_smfmac_f32_16x16x64_f16 v[80:83], v[44:47], a[112:119], v112
s_add_u32 s19, s52, s54
ds_read_b128 v[60:63], v116 offset:12288
v_smfmac_f32_16x16x64_f16 v[84:87], v[44:47], a[240:247], v112
s_add_u32 s18, s18, 0x40000
s_waitcnt lgkmcnt(2)
v_smfmac_f32_16x16x64_f16 v[80:83], v[52:55], a[56:63], v112
s_bitset0_b32 s18, 20
s_waitcnt lgkmcnt(1)
v_smfmac_f32_16x16x64_f16 v[80:83], v[56:59], a[88:95], v112
s_cmp_eq_u32 s17, 30
s_cselect_b32 s32, s53, 0x10000
s_waitcnt lgkmcnt(0)
v_smfmac_f32_16x16x64_f16 v[80:83], v[60:63], a[120:127], v112
s_add_u32 s52, s52, s32
ds_read_b128 v[64:67], v116 offset:24576
v_smfmac_f32_16x16x64_f16 v[84:87], v[52:55], a[184:191], v112
s_sub_u32 s24, 0x20000, s32
ds_read_b128 v[68:71], v116 offset:28672
v_smfmac_f32_16x16x64_f16 v[84:87], v[56:59], a[216:223], v112
ds_read_b128 v[72:75], v116 offset:25600
s_add_u32 s55, s55, s24
v_cvt_pk_bf16_f32 v92, v80, v81
v_smfmac_f32_16x16x64_f16 v[84:87], v[60:63], a[248:255], v112
ds_read_b128 v[76:79], v116 offset:29696
s_nop 0
v_cvt_pk_bf16_f32 v93, v82, v83
v_smfmac_f32_16x16x64_f16 v[88:91], v[12:15], v[152:159], v112
s_nop 3
v_cvt_pk_bf16_f32 v94, v84, v85
v_cvt_pk_bf16_f32 v95, v86, v87
s_mov_b32 vcc_lo, 0xcccccccc
s_mov_b32 vcc_hi, 0xcccccccc
v_mfma_f32_16x16x32_bf16 v[84:87], v[92:95], v[104:107], 0
v_add_u32 v121, v121, v122
s_waitcnt lgkmcnt(0)
s_sub_u32 s31, s40, s11
v_smfmac_f32_16x16x64_f16 v[88:91], v[16:19], v[160:167], v112
s_sub_u32 s32, s31, s43
s_sub_u32 s47, 1590, s32
s_max_i32 s47, s47, 0
s_cmp_eq_u32 s17, 63
v_cvt_pk_bf16_f32 v114, v84, v85
v_cvt_pk_bf16_f32 v115, v86, v87
buffer_store_dwordx2 v[114:115], v117, s[4:7], s21 offen sc1
s_cbranch_scc1 main_kernel_c7_last
ds_write_b64 v117, v[114:115] offset:17920
v_smfmac_f32_16x16x64_f16 v[88:91], v[20:23], v[168:175], v112
s_cmp_gt_u32 s32, 1690
s_cselect_b32 s33, 900, s47
v_smfmac_f32_16x16x64_f16 v[88:91], v[24:27], v[176:183], v112
s_add_u32 s10, s33, s31
s_andn2_b32 s42, s44, 0x1f00
v_mov_b32 v126, s15
v_smfmac_f32_16x16x64_f16 v[88:91], v[28:31], v[184:191], v112
s_add_u32 s42, s42, 0x4000
v_mov_b32 v127, s10
v_smfmac_f32_16x16x64_f16 v[88:91], v[32:35], v[192:199], v112
.p2align 3
main_kernel_c7_b21:
s_sub_u32 s47, s47, 28
s_cbranch_scc0 main_kernel_c7_b21
s_waitcnt lgkmcnt(0)
s_barrier
ds_read_b128 v[0:3], v116 offset:16384
v_smfmac_f32_16x16x64_f16 v[88:91], v[36:39], v[200:207], v112
ds_read_b128 v[4:7], v116 offset:17408
buffer_store_dwordx2 v[126:127], off, s[4:7], s46 sc1
v_smfmac_f32_16x16x64_f16 v[88:91], v[40:43], v[208:215], v112
ds_read_b128 v[16:19], v116 offset:26624
s_cmp_gt_u32 s32, 1690
s_cselect_b32 s80, s44, 0x7f000000
v_smfmac_f32_16x16x64_f16 v[88:91], v[44:47], v[216:223], v112
ds_read_b128 v[20:23], v116 offset:30720
v_writelane_b32 v121, s55, 39
v_smfmac_f32_16x16x64_f16 v[88:91], v[48:51], v[224:231], v112
ds_read_b128 v[24:27], v116 offset:27648
v_smfmac_f32_16x16x64_f16 v[88:91], v[52:55], v[232:239], v112
ds_read_b128 v[28:31], v116 offset:31744
v_smfmac_f32_16x16x64_f16 v[88:91], v[56:59], v[240:247], v112
v_smfmac_f32_16x16x64_f16 v[88:91], v[60:63], v[248:255], v112
s_waitcnt lgkmcnt(5)
v_mfma_f32_16x16x32_bf16 v[80:83], v[64:67], v[0:3], 0
v_mfma_f32_16x16x32_bf16 v[84:87], v[68:71], v[0:3], 0
buffer_load_dwordx4 v[8:11], v116, s[4:7], s20 offen offset:0 sc1
v_mfma_f32_16x16x32_bf16 v[92:95], v[0:3], v[0:3], 0
buffer_load_dwordx4 v[12:15], v116, s[4:7], s20 offen offset:1024 sc1
v_permlane32_swap_b32 v88, v90
s_waitcnt lgkmcnt(4)
v_mfma_f32_16x16x32_bf16 v[80:83], v[72:75], v[4:7], v[80:83]
v_permlane32_swap_b32 v89, v91
v_mfma_f32_16x16x32_bf16 v[84:87], v[76:79], v[4:7], v[84:87]
v_pk_add_f32 v[88:89], v[88:89], v[90:91]
v_mfma_f32_16x16x32_bf16 v[92:95], v[4:7], v[4:7], v[92:95]
v_cvt_pk_bf16_f32 v124, v88, v89
s_andn2_b32 s35, s46, 0xff
v_bfe_u32 v68, v116, 1, 8
v_mov_b32 v65, 0
buffer_load_dwordx2 v[66:67], v68, s[4:7], s35 offen sc1
buffer_store_dword v127, off, s[4:7], s80 offset:132 sc1
s_waitcnt lgkmcnt(0)
s_waitcnt vmcnt(3)
v_mfma_f32_16x16x32_bf16 v[88:91], v[8:11], v[8:11], v[92:95]
v_mfma_f32_16x16x32_bf16 v[0:3], v[16:19], v[8:11], v[80:83]
v_cmp_u_f32 s[0:1], v8, v10
v_mfma_f32_16x16x32_bf16 v[4:7], v[20:23], v[8:11], v[84:87]
s_waitcnt vmcnt(2)
v_mfma_f32_16x16x32_bf16 v[88:91], v[12:15], v[12:15], v[88:91]
v_mfma_f32_16x16x32_bf16 v[0:3], v[24:27], v[12:15], v[0:3]
v_cmp_u_f32 s[32:33], v12, v14
v_mfma_f32_16x16x32_bf16 v[4:7], v[28:31], v[12:15], v[4:7]
s_or_b64 s[0:1], s[0:1], s[32:33]
s_cbranch_scc1 main_kernel_c7_z_f
main_kernel_c7_z:
v_mul_f32 v88, s30, v88
v_mul_f32 v89, s30, v89
v_exp_f32 v88, v88
v_exp_f32 v89, v89
v_cndmask_b32_dpp v0, v2, v0, vcc quad_perm:[2,3,2,3] row_mask:0xf bank_mask:0xf
v_cvt_pk_bf16_f32 v64, v88, v89
v_cndmask_b32_dpp v1, v3, v1, vcc quad_perm:[2,3,2,3] row_mask:0xf bank_mask:0xf
v_exp_f32 v0, v0
v_mfma_f32_16x16x16_bf16 v[16:19], v[100:101], v[64:65], 0
v_exp_f32 v1, v1
v_cndmask_b32_dpp v4, v6, v4, vcc quad_perm:[2,3,2,3] row_mask:0xf bank_mask:0xf
v_mfma_f32_16x16x16_bf16 v[8:11], v[124:125], v[64:65], 0
v_cndmask_b32_dpp v5, v7, v5, vcc quad_perm:[2,3,2,3] row_mask:0xf bank_mask:0xf
v_exp_f32 v4, v4
v_exp_f32 v5, v5
v_cvt_pk_bf16_f32 v92, v0, v1
v_cvt_pk_bf16_f32 v94, v4, v5
v_mov_b32 v80, 0
v_mov_b32_dpp v93, v92 quad_perm:[0,1,0,1] row_mask:0xf bank_mask:0xf
v_mov_b32_dpp v95, v94 quad_perm:[0,1,0,1] row_mask:0xf bank_mask:0xf
v_mov_b32 v81, 0
v_mov_b32 v82, 0
v_mfma_f32_16x16x32_bf16 v[16:19], v[100:103], v[92:95], v[16:19]
v_mov_b32 v83, 0
v_mov_b32 v84, 0
v_mfma_f32_16x16x32_bf16 v[8:11], v[96:99], v[92:95], v[8:11]
s_buffer_load_dword s42, s[4:7], s42
s_nop 1
v_mov_b32 v85, 0
v_mov_b32 v86, 0
v_mov_b32 v87, 0
v_rcp_f32 v126, v16
v_subrev_u32 v127, 0x21800000, v16
v_cmp_lt_u32 vcc, 0x3c000000, v127
v_pk_mul_f32 v[8:9], v[8:9], v[126:127] op_sel_hi:[1,0]
v_pk_mul_f32 v[10:11], v[10:11], v[126:127] op_sel_hi:[1,0]
s_and_b32 s32, vcc_lo, 0xcccc
v_cvt_pk_bf16_f32 v126, v8, v9
v_cvt_pk_bf16_f32 v127, v10, v11
s_cbranch_scc1 main_kernel_c7_sm_f
main_kernel_c7_ost:
buffer_store_dwordx2 v[126:127], v118, s[4:7], s22 offen sc1
s_waitcnt vmcnt(2)
main_kernel_c7_to0:
s_memtime s[40:41]
v_readlane_b32 s16, v66, 0
v_subrev_u32 v67, s2, v67
s_add_u32 s34, s11, s2
s_nop 0
v_max_u32_dpp v67, v67, v67 row_ror:8 row_mask:0xf bank_mask:0xf
s_nop 1
v_max_u32_dpp v67, v67, v67 row_ror:4 row_mask:0xf bank_mask:0xf
s_nop 1
v_max_u32_dpp v67, v67, v67 row_ror:2 row_mask:0xf bank_mask:0xf
s_nop 1
v_max_u32_dpp v67, v67, v67 row_ror:1 row_mask:0xf bank_mask:0xf
s_waitcnt lgkmcnt(0)
v_readlane_b32 s32, v67, 0
v_readlane_b32 s33, v67, 16
s_sub_u32 s34, s40, s34
s_max_u32 s32, s32, s33
s_add_u32 s35, s34, 1536
s_cmp_gt_u32 s32, s35
s_cbranch_scc1 main_kernel_c7_to2
main_kernel_c7_to3:
s_sub_u32 s33, s42, s2
s_cmp_le_u32 s33, s35
s_cselect_b32 s33, s33, 0
s_max_u32 s32, s32, s33
s_add_u32 s36, s32, 2850
s_add_u32 s32, s32, 1270
s_sub_u32 s47, s32, s34
s_max_i32 s47, s47, 0
.p2align 3
main_kernel_c7_to1:
s_sub_u32 s47, s47, 28
s_cbranch_scc0 main_kernel_c7_to1
s_barrier
buffer_load_dwordx4 v[0:3], v116, s[4:7], s23 offen sc1
ds_read_b128 v[32:35], v113 offset:0
ds_read_b128 v[36:39], v113 offset:1024
s_add_u32 s46, s46, 0x40000
s_bitset0_b32 s46, 20
s_add_u32 s37, s37, 65536
s_add_u32 s26, s26, 65536
s_xor_b32 s32, s23, 1024
buffer_load_dwordx4 v[4:7], v116, s[4:7], s32 offen sc1
ds_read_b128 v[40:43], v113 offset:2048
ds_read_b128 v[44:47], v113 offset:3072
s_add_u32 s44, s44, s24
s_nop 2
s_xor_b32 s32, s23, 2048
buffer_load_dwordx4 v[8:11], v116, s[4:7], s32 offen sc1
ds_read_b128 v[48:51], v113 offset:4096
ds_read_b128 v[52:55], v113 offset:5120
s_nop 3
s_xor_b32 s32, s23, 3072
buffer_load_dwordx4 v[12:15], v116, s[4:7], s32 offen sc1
ds_read_b128 v[56:59], v113 offset:6144
ds_read_b128 v[60:63], v113 offset:7168
s_nop 3
s_xor_b32 s32, s23, 4096
buffer_load_dwordx4 v[16:19], v116, s[4:7], s32 offen sc1
ds_read_b128 v[64:67], v113 offset:8192
ds_read_b128 v[68:71], v113 offset:9216
s_nop 3
s_xor_b32 s32, s23, 5120
buffer_load_dwordx4 v[20:23], v116, s[4:7], s32 offen sc1
ds_read_b128 v[72:75], v113 offset:10240
ds_read_b128 v[76:79], v113 offset:11264
s_nop 3
s_xor_b32 s32, s23, 6144
buffer_load_dwordx4 v[24:27], v116, s[4:7], s32 offen sc1
ds_read_b128 v[88:91], v113 offset:12288
ds_read_b128 v[92:95], v113 offset:13312
s_nop 3
s_xor_b32 s32, s23, 7168
buffer_load_dwordx4 v[28:31], v116, s[4:7], s32 offen sc1
v_and_b32 v127, 0x1f0, v116
v_lshlrev_b32 v127, 4, v127
s_waitcnt lgkmcnt(12)
s_waitcnt vmcnt(7)
v_cmp_u_f32 vcc, v0, v2
s_cbranch_vccnz main_kernel_c7_o0_f
main_kernel_c7_o0:
v_smfmac_f32_16x16x64_bf16 v[80:83], v[0:3], v[32:39], v112
ds_read_b128 v[32:35], v113 offset:14336
ds_read_b128 v[36:39], v113 offset:15360
buffer_load_dwordx2 v[96:97], v127, s[4:7], s45 offen offset:128 sc1
s_waitcnt lgkmcnt(12)
s_waitcnt vmcnt(7)
v_cmp_u_f32 vcc, v4, v6
v_smfmac_f32_16x16x64_bf16 v[84:87], v[0:3], v[40:47], v112
ds_read_b128 v[40:43], v113 offset:16384
ds_read_b128 v[44:47], v113 offset:17408
buffer_store_dwordx2 v[114:115], v119, s[4:7], s37 offen sc1
s_cbranch_vccnz main_kernel_c7_o1_f
main_kernel_c7_o1:
s_waitcnt lgkmcnt(12)
v_smfmac_f32_16x16x64_bf16 v[80:83], v[4:7], v[48:55], v112
ds_read_b128 v[48:51], v113 offset:18432
ds_read_b128 v[52:55], v113 offset:19456
s_waitcnt lgkmcnt(12)
s_waitcnt vmcnt(7)
v_cmp_u_f32 vcc, v8, v10
v_smfmac_f32_16x16x64_bf16 v[84:87], v[4:7], v[56:63], v112
ds_read_b128 v[56:59], v113 offset:20480
ds_read_b128 v[60:63], v113 offset:21504
buffer_store_dword v124, v120, s[4:7], s26 offen sc1
s_cbranch_vccnz main_kernel_c7_o2_f
main_kernel_c7_o2:
s_waitcnt lgkmcnt(12)
v_smfmac_f32_16x16x64_bf16 v[80:83], v[8:11], v[64:71], v112
ds_read_b128 v[64:67], v113 offset:22528
ds_read_b128 v[68:71], v113 offset:23552
s_waitcnt lgkmcnt(12)
s_waitcnt vmcnt(7)
v_cmp_u_f32 vcc, v12, v14
v_smfmac_f32_16x16x64_bf16 v[84:87], v[8:11], v[72:79], v112
ds_read_b128 v[72:75], v113 offset:24576
ds_read_b128 v[76:79], v113 offset:25600
s_cbranch_vccnz main_kernel_c7_o3_f
main_kernel_c7_o3:
s_waitcnt lgkmcnt(12)
v_smfmac_f32_16x16x64_bf16 v[80:83], v[12:15], v[88:95], v112
ds_read_b128 v[88:91], v113 offset:26624
ds_read_b128 v[92:95], v113 offset:27648
s_waitcnt lgkmcnt(12)
s_waitcnt vmcnt(6)
v_cmp_u_f32 vcc, v16, v18
v_smfmac_f32_16x16x64_bf16 v[84:87], v[12:15], v[32:39], v112
ds_read_b128 v[32:35], v113 offset:28672
ds_read_b128 v[36:39], v113 offset:29696
s_cbranch_vccnz main_kernel_c7_o4_f
main_kernel_c7_o4:
s_waitcnt lgkmcnt(12)
v_smfmac_f32_16x16x64_bf16 v[80:83], v[16:19], v[40:47], v112
ds_read_b128 v[40:43], v113 offset:30720
ds_read_b128 v[44:47], v113 offset:31744
s_waitcnt lgkmcnt(12)
s_waitcnt vmcnt(5)
v_cmp_u_f32 vcc, v20, v22
v_smfmac_f32_16x16x64_bf16 v[84:87], v[16:19], v[48:55], v112
s_cbranch_vccnz main_kernel_c7_o5_f
main_kernel_c7_o5:
s_waitcnt lgkmcnt(10)
v_smfmac_f32_16x16x64_bf16 v[80:83], v[20:23], v[56:63], v112
s_waitcnt lgkmcnt(8)
s_waitcnt vmcnt(4)
v_cmp_u_f32 vcc, v24, v26
v_smfmac_f32_16x16x64_bf16 v[84:87], v[20:23], v[64:71], v112
s_cbranch_vccnz main_kernel_c7_o6_f
main_kernel_c7_o6:
s_waitcnt lgkmcnt(6)
v_smfmac_f32_16x16x64_bf16 v[80:83], v[24:27], v[72:79], v112
s_waitcnt lgkmcnt(4)
v_smfmac_f32_16x16x64_bf16 v[84:87], v[24:27], v[88:95], v112
s_waitcnt lgkmcnt(2)
s_waitcnt vmcnt(3)
v_cmp_u_f32 vcc, v28, v30
s_cbranch_vccnz main_kernel_c7_o7_f
main_kernel_c7_o7:
v_smfmac_f32_16x16x64_bf16 v[80:83], v[28:31], v[32:39], v112
s_waitcnt lgkmcnt(0)
v_smfmac_f32_16x16x64_bf16 v[84:87], v[28:31], v[40:47], v112
s_nop 4
v_cvt_pk_bf16_f32 v80, v80, v81
v_cvt_pk_bf16_f32 v81, v82, v83
ds_write_b64 v116, v[80:81] offset:21512
v_cvt_pk_bf16_f32 v82, v84, v85
v_cvt_pk_bf16_f32 v83, v86, v87
ds_write_b64 v116, v[82:83] offset:23560
s_waitcnt lgkmcnt(0)
s_barrier
ds_read_b128 v[72:75], v116 offset:22528
ds_read_b128 v[76:79], v116 offset:23552
s_waitcnt lgkmcnt(1)
v_mfma_f32_16x16x32_bf16 v[64:67], v[72:75], v[108:111], 0
s_waitcnt lgkmcnt(0)
v_mfma_f32_16x16x32_bf16 v[64:67], v[76:79], v[108:111], v[64:67]
s_nop 7
v_cvt_pk_f16_f32 v68, v64, v65
v_cvt_pk_f16_f32 v69, v66, v67
buffer_store_dwordx2 v[68:69], v125, s[4:7], s25 offen sc1
s_sub_u32 s0, s2, s16
s_sub_u32 s0, s0, s39
s_waitcnt vmcnt(3)
main_kernel_c7_tm0:
s_memtime s[40:41]
v_sub_u32 v97, v97, v96
v_subrev_u32 v97, s0, v97
s_add_u32 s34, s11, s2
s_nop 0
v_max_u32_dpp v97, v97, v97 row_ror:8 row_mask:0xf bank_mask:0xf
s_nop 1
v_max_u32_dpp v97, v97, v97 row_ror:4 row_mask:0xf bank_mask:0xf
s_nop 1
v_max_u32_dpp v97, v97, v97 row_ror:2 row_mask:0xf bank_mask:0xf
s_nop 1
v_max_u32_dpp v97, v97, v97 row_ror:1 row_mask:0xf bank_mask:0xf
s_waitcnt lgkmcnt(0)
v_readlane_b32 s32, v97, 0
v_readlane_b32 s33, v97, 16
s_sub_u32 s34, s40, s34
s_max_u32 s32, s32, s33
s_add_u32 s35, s34, 1536
s_cmp_gt_u32 s32, s35
s_cbranch_scc1 main_kernel_c7_tm2
main_kernel_c7_tm3:
s_add_u32 s32, s32, 2850
s_max_u32 s32, s32, s36
s_add_u32 s43, s32, s2
s_sub_u32 s47, s32, s34
s_max_i32 s47, s47, 0
.p2align 3
main_kernel_c7_tm1:
s_sub_u32 s47, s47, 28
s_cbranch_scc0 main_kernel_c7_tm1
s_add_u32 s45, s45, s24
s_branch main_kernel_c7_top
main_kernel_c7_to2:
s_mov_b32 s32, s34
s_mov_b32 s16, s15
s_cmp_gt_u32 s34, 0x40000
s_cbranch_scc1 main_kernel_c7_to3
s_andn2_b32 s35, s46, 0xff
v_bfe_u32 v68, v116, 1, 8
buffer_load_dwordx2 v[66:67], v68, s[4:7], s35 offen sc1
s_sub_u32 s29, s29, 1
s_cbranch_scc1 main_kernel_end
s_waitcnt vmcnt(0)
s_branch main_kernel_c7_to0
main_kernel_c7_tm2:
s_mov_b32 s32, s34
s_cmp_gt_u32 s34, 0x40000
s_cbranch_scc1 main_kernel_c7_tm3
v_and_b32 v127, 0x1f0, v116
v_lshlrev_b32 v127, 4, v127
buffer_load_dwordx2 v[96:97], v127, s[4:7], s45 offen offset:128 sc1
s_sub_u32 s29, s29, 1
s_cbranch_scc1 main_kernel_end
s_waitcnt vmcnt(0)
s_branch main_kernel_c7_tm0
main_kernel_c7_last:
s_add_u32 s37, s37, 65536
s_add_u32 s26, s26, 65536
buffer_store_dwordx2 v[114:115], v119, s[4:7], s37 offen sc1
v_smfmac_f32_16x16x64_f16 v[88:91], v[20:23], v[168:175], v112
v_smfmac_f32_16x16x64_f16 v[88:91], v[24:27], v[176:183], v112
v_smfmac_f32_16x16x64_f16 v[88:91], v[28:31], v[184:191], v112
v_smfmac_f32_16x16x64_f16 v[88:91], v[32:35], v[192:199], v112
v_smfmac_f32_16x16x64_f16 v[88:91], v[36:39], v[200:207], v112
v_smfmac_f32_16x16x64_f16 v[88:91], v[40:43], v[208:215], v112
v_smfmac_f32_16x16x64_f16 v[88:91], v[44:47], v[216:223], v112
v_smfmac_f32_16x16x64_f16 v[88:91], v[48:51], v[224:231], v112
v_smfmac_f32_16x16x64_f16 v[88:91], v[52:55], v[232:239], v112
v_smfmac_f32_16x16x64_f16 v[88:91], v[56:59], v[240:247], v112
v_smfmac_f32_16x16x64_f16 v[88:91], v[60:63], v[248:255], v112
s_nop 7
v_permlane32_swap_b32 v88, v90
s_nop 1
v_permlane32_swap_b32 v89, v91
s_nop 1
v_pk_add_f32 v[88:89], v[88:89], v[90:91]
s_nop 1
v_cvt_pk_bf16_f32 v124, v88, v89
s_nop 1
buffer_store_dword v124, v120, s[4:7], s26 offen sc1
s_branch main_kernel_end
main_kernel_c7_m0_f:
s_waitcnt lgkmcnt(0)
buffer_load_dwordx4 v[0:3], v116, s[4:7], s18 offen sc1
buffer_load_dwordx4 v[64:67], v116, s[4:7], s19 offen sc1
s_xor_b32 s32, s18, 1024
buffer_load_dwordx4 v[16:19], v116, s[4:7], s32 offen sc1
s_xor_b32 s32, s19, 1024
buffer_load_dwordx4 v[68:71], v116, s[4:7], s32 offen sc1
s_xor_b32 s32, s18, 2048
buffer_load_dwordx4 v[32:35], v116, s[4:7], s32 offen sc1
s_xor_b32 s32, s19, 2048
buffer_load_dwordx4 v[72:75], v116, s[4:7], s32 offen sc1
s_xor_b32 s32, s18, 3072
buffer_load_dwordx4 v[48:51], v116, s[4:7], s32 offen sc1
s_xor_b32 s32, s19, 3072
buffer_load_dwordx4 v[76:79], v116, s[4:7], s32 offen sc1
s_sub_u32 s29, s29, 1
s_cbranch_scc1 main_kernel_end
s_waitcnt vmcnt(0)
v_max_u32 v126, v0, v2
v_max3_u32 v126, v126, v64, v66
v_cmp_eq_u32 vcc, -1, v126
s_cbranch_vccnz main_kernel_c7_m0_f
v_pk_add_f16 v0, v0, v64
v_pk_add_f16 v1, v1, v65
v_pk_add_f16 v2, v2, v66
v_pk_add_f16 v3, v3, v67
s_nop 0
s_branch main_kernel_c7_m0
main_kernel_c7_m1_f:
s_waitcnt lgkmcnt(0)
s_xor_b32 s32, s18, 1024
buffer_load_dwordx4 v[16:19], v116, s[4:7], s32 offen sc1
s_xor_b32 s32, s19, 1024
buffer_load_dwordx4 v[68:71], v116, s[4:7], s32 offen sc1
s_xor_b32 s32, s18, 2048
buffer_load_dwordx4 v[32:35], v116, s[4:7], s32 offen sc1
s_xor_b32 s32, s19, 2048
buffer_load_dwordx4 v[72:75], v116, s[4:7], s32 offen sc1
s_xor_b32 s32, s18, 3072
buffer_load_dwordx4 v[48:51], v116, s[4:7], s32 offen sc1
s_xor_b32 s32, s19, 3072
buffer_load_dwordx4 v[76:79], v116, s[4:7], s32 offen sc1
s_sub_u32 s29, s29, 1
s_cbranch_scc1 main_kernel_end
s_waitcnt vmcnt(0)
v_max_u32 v126, v16, v18
v_max3_u32 v126, v126, v68, v70
v_cmp_eq_u32 vcc, -1, v126
s_cbranch_vccnz main_kernel_c7_m1_f
v_pk_add_f16 v16, v16, v68
v_pk_add_f16 v17, v17, v69
v_pk_add_f16 v18, v18, v70
v_pk_add_f16 v19, v19, v71
s_nop 0
s_branch main_kernel_c7_m1
main_kernel_c7_m2_f:
s_waitcnt lgkmcnt(0)
s_xor_b32 s32, s18, 2048
buffer_load_dwordx4 v[32:35], v116, s[4:7], s32 offen sc1
s_xor_b32 s32, s19, 2048
buffer_load_dwordx4 v[72:75], v116, s[4:7], s32 offen sc1
s_xor_b32 s32, s18, 3072
buffer_load_dwordx4 v[48:51], v116, s[4:7], s32 offen sc1
s_xor_b32 s32, s19, 3072
buffer_load_dwordx4 v[76:79], v116, s[4:7], s32 offen sc1
s_sub_u32 s29, s29, 1
s_cbranch_scc1 main_kernel_end
s_waitcnt vmcnt(0)
v_max_u32 v126, v32, v34
v_max3_u32 v126, v126, v72, v74
v_cmp_eq_u32 vcc, -1, v126
s_cbranch_vccnz main_kernel_c7_m2_f
v_pk_add_f16 v32, v32, v72
v_pk_add_f16 v33, v33, v73
v_pk_add_f16 v34, v34, v74
v_pk_add_f16 v35, v35, v75
ds_write_b128 v116, v[32:35] offset:11264
s_branch main_kernel_c7_m2
main_kernel_c7_m3_f:
s_waitcnt lgkmcnt(0)
s_xor_b32 s32, s18, 3072
buffer_load_dwordx4 v[48:51], v116, s[4:7], s32 offen sc1
s_xor_b32 s32, s19, 3072
buffer_load_dwordx4 v[76:79], v116, s[4:7], s32 offen sc1
s_sub_u32 s29, s29, 1
s_cbranch_scc1 main_kernel_end
s_waitcnt vmcnt(0)
v_max_u32 v126, v48, v50
v_max3_u32 v126, v126, v76, v78
v_cmp_eq_u32 vcc, -1, v126
s_cbranch_vccnz main_kernel_c7_m3_f
v_pk_add_f16 v48, v48, v76
v_pk_add_f16 v49, v49, v77
v_pk_add_f16 v50, v50, v78
v_pk_add_f16 v51, v51, v79
ds_write_b128 v116, v[48:51] offset:15360
s_branch main_kernel_c7_m3
main_kernel_c7_z_f:
buffer_load_dwordx4 v[8:11], v116, s[4:7], s20 offen offset:0 sc1
buffer_load_dwordx4 v[12:15], v116, s[4:7], s20 offen offset:1024 sc1
s_memtime s[32:33]
ds_read_b32 v126, v116 offset:18432
s_sub_u32 s34, s19, s54
s_xor_b32 s34, s34, 0x2000
s_lshl_b32 s35, s12, 15
s_add_u32 s34, s34, s35
s_lshl_b32 s35, s13, 8
s_add_u32 s35, s35, s34
s_add_u32 s34, s34, 0x4000
s_waitcnt lgkmcnt(0)
s_sub_u32 s32, s32, 450
v_sub_u32 v126, s32, v126
v_max_u32 v127, v126, v127
buffer_store_dword v127, off, s[4:7], s34 sc1
s_sub_u32 s29, s29, 1
s_cbranch_scc1 main_kernel_end
s_waitcnt vmcnt(1)
main_kernel_c7_z_g:
v_max_u32 v126, v8, v10
v_max3_u32 v126, v126, v12, v14
v_cmp_eq_u32 vcc, -1, v126
s_cbranch_vccnz main_kernel_c7_z_h
v_mfma_f32_16x16x32_bf16 v[88:91], v[8:11], v[8:11], v[92:95]
v_mfma_f32_16x16x32_bf16 v[0:3], v[16:19], v[8:11], v[80:83]
v_mfma_f32_16x16x32_bf16 v[4:7], v[20:23], v[8:11], v[84:87]
v_mfma_f32_16x16x32_bf16 v[88:91], v[12:15], v[12:15], v[88:91]
v_mfma_f32_16x16x32_bf16 v[0:3], v[24:27], v[12:15], v[0:3]
v_mfma_f32_16x16x32_bf16 v[4:7], v[28:31], v[12:15], v[4:7]
buffer_store_dword v127, off, s[4:7], s35 offset:132 sc1
s_mov_b32 vcc_lo, 0xcccccccc
s_mov_b32 vcc_hi, 0xcccccccc
s_branch main_kernel_c7_z
main_kernel_c7_z_h:
buffer_load_dwordx4 v[8:11], v116, s[4:7], s20 offen offset:0 sc1
buffer_load_dwordx4 v[12:15], v116, s[4:7], s20 offen offset:1024 sc1
s_sub_u32 s29, s29, 1
s_cbranch_scc1 main_kernel_end
v_add_u32 v127, 300, v127
s_waitcnt vmcnt(0)
s_branch main_kernel_c7_z_g
main_kernel_c7_sm_f:
s_waitcnt vmcnt(0) lgkmcnt(0)
buffer_load_dwordx4 v[8:11], v116, s[4:7], s20 offen offset:0 sc1
buffer_load_dwordx4 v[12:15], v116, s[4:7], s20 offen offset:1024 sc1
ds_read_b128 v[0:3], v116 offset:16384
ds_read_b128 v[4:7], v116 offset:17408
ds_read_b128 v[64:67], v116 offset:24576
ds_read_b128 v[68:71], v116 offset:28672
ds_read_b128 v[72:75], v116 offset:25600
ds_read_b128 v[76:79], v116 offset:29696
ds_read_b128 v[16:19], v116 offset:26624
ds_read_b128 v[20:23], v116 offset:30720
ds_read_b128 v[24:27], v116 offset:27648
ds_read_b128 v[28:31], v116 offset:31744
s_waitcnt vmcnt(0)
s_waitcnt lgkmcnt(0)
v_mfma_f32_16x16x32_bf16 v[80:83], v[64:67], v[0:3], 0
v_mfma_f32_16x16x32_bf16 v[84:87], v[68:71], v[0:3], 0
v_mfma_f32_16x16x32_bf16 v[92:95], v[0:3], v[0:3], 0
v_mfma_f32_16x16x32_bf16 v[80:83], v[72:75], v[4:7], v[80:83]
v_mfma_f32_16x16x32_bf16 v[84:87], v[76:79], v[4:7], v[84:87]
v_mfma_f32_16x16x32_bf16 v[92:95], v[4:7], v[4:7], v[92:95]
v_mfma_f32_16x16x32_bf16 v[0:3], v[16:19], v[8:11], v[80:83]
v_mfma_f32_16x16x32_bf16 v[4:7], v[20:23], v[8:11], v[84:87]
v_mfma_f32_16x16x32_bf16 v[88:91], v[8:11], v[8:11], v[92:95]
v_mfma_f32_16x16x32_bf16 v[0:3], v[24:27], v[12:15], v[0:3]
v_mfma_f32_16x16x32_bf16 v[4:7], v[28:31], v[12:15], v[4:7]
v_mfma_f32_16x16x32_bf16 v[88:91], v[12:15], v[12:15], v[88:91]
s_nop 7
v_mov_b32 v65, 0
v_max_f32 v126, v88, v89
v_mul_f32 v126, s30, v126
v_max3_f32 v126, v126, v0, v1
v_max3_f32 v126, v126, v2, v3
v_max3_f32 v126, v126, v4, v5
v_max3_f32 v126, v126, v6, v7
v_mov_b32 v127, v126
s_nop 1
v_permlane32_swap_b32 v126, v127
v_max_f32 v126, v126, v127
v_mov_b32 v127, v126
s_nop 1
v_permlane16_swap_b32 v126, v127
v_max_f32 v126, v126, v127
v_mul_f32 v127, 0x40faf233, v126
s_mov_b32 vcc_lo, 0xcccccccc
s_mov_b32 vcc_hi, 0xcccccccc
v_sub_f32 v0, v0, v126
v_sub_f32 v1, v1, v126
v_sub_f32 v2, v2, v126
v_sub_f32 v3, v3, v126
v_sub_f32 v4, v4, v126
v_sub_f32 v5, v5, v126
v_sub_f32 v6, v6, v126
v_sub_f32 v7, v7, v126
v_sub_f32 v88, v88, v127
v_sub_f32 v89, v89, v127
s_waitcnt lgkmcnt(0)
s_nop 0
v_mul_f32 v88, s30, v88
v_mul_f32 v89, s30, v89
v_exp_f32 v88, v88
v_exp_f32 v89, v89
v_cndmask_b32_dpp v0, v2, v0, vcc quad_perm:[2,3,2,3] row_mask:0xf bank_mask:0xf
v_cvt_pk_bf16_f32 v64, v88, v89
v_cndmask_b32_dpp v1, v3, v1, vcc quad_perm:[2,3,2,3] row_mask:0xf bank_mask:0xf
v_exp_f32 v0, v0
v_mfma_f32_16x16x16_bf16 v[16:19], v[100:101], v[64:65], 0
v_exp_f32 v1, v1
v_cndmask_b32_dpp v4, v6, v4, vcc quad_perm:[2,3,2,3] row_mask:0xf bank_mask:0xf
v_mfma_f32_16x16x16_bf16 v[8:11], v[124:125], v[64:65], 0
v_cndmask_b32_dpp v5, v7, v5, vcc quad_perm:[2,3,2,3] row_mask:0xf bank_mask:0xf
v_exp_f32 v4, v4
v_exp_f32 v5, v5
v_cvt_pk_bf16_f32 v92, v0, v1
v_cvt_pk_bf16_f32 v94, v4, v5
v_mov_b32 v80, 0
v_mov_b32_dpp v93, v92 quad_perm:[0,1,0,1] row_mask:0xf bank_mask:0xf
v_mov_b32_dpp v95, v94 quad_perm:[0,1,0,1] row_mask:0xf bank_mask:0xf
v_mov_b32 v81, 0
v_mov_b32 v82, 0
v_mfma_f32_16x16x32_bf16 v[16:19], v[100:103], v[92:95], v[16:19]
v_mov_b32 v83, 0
v_mov_b32 v84, 0
v_mfma_f32_16x16x32_bf16 v[8:11], v[96:99], v[92:95], v[8:11]
s_nop 1
v_mov_b32 v85, 0
v_mov_b32 v86, 0
v_mov_b32 v87, 0
v_rcp_f32 v126, v16
v_subrev_u32 v127, 0x21800000, v16
v_cmp_lt_u32 vcc, 0x3c000000, v127
v_pk_mul_f32 v[8:9], v[8:9], v[126:127] op_sel_hi:[1,0]
v_pk_mul_f32 v[10:11], v[10:11], v[126:127] op_sel_hi:[1,0]
s_and_b32 s32, vcc_lo, 0xcccc
v_cvt_pk_bf16_f32 v126, v8, v9
v_cvt_pk_bf16_f32 v127, v10, v11
s_andn2_b32 s35, s46, 0xff
v_bfe_u32 v68, v116, 1, 8
buffer_load_dwordx2 v[66:67], v68, s[4:7], s35 offen sc1
s_waitcnt vmcnt(0)
s_branch main_kernel_c7_ost
main_kernel_c7_o0_f:
s_nop 0
buffer_load_dwordx4 v[0:3], v116, s[4:7], s23 offen sc1
s_xor_b32 s32, s23, 1024
buffer_load_dwordx4 v[4:7], v116, s[4:7], s32 offen sc1
s_sub_u32 s29, s29, 1
s_cbranch_scc1 main_kernel_end
s_waitcnt vmcnt(0)
v_max_u32 v126, v0, v2
v_cmp_eq_u32 vcc, -1, v126
s_cbranch_vccnz main_kernel_c7_o0_f
s_branch main_kernel_c7_o0
main_kernel_c7_o1_f:
s_nop 0
s_xor_b32 s32, s23, 1024
buffer_load_dwordx4 v[4:7], v116, s[4:7], s32 offen sc1
s_xor_b32 s32, s23, 2048
buffer_load_dwordx4 v[8:11], v116, s[4:7], s32 offen sc1
s_sub_u32 s29, s29, 1
s_cbranch_scc1 main_kernel_end
s_waitcnt vmcnt(0)
v_max_u32 v126, v4, v6
v_cmp_eq_u32 vcc, -1, v126
s_cbranch_vccnz main_kernel_c7_o1_f
s_branch main_kernel_c7_o1
main_kernel_c7_o2_f:
s_nop 0
s_xor_b32 s32, s23, 2048
buffer_load_dwordx4 v[8:11], v116, s[4:7], s32 offen sc1
s_xor_b32 s32, s23, 3072
buffer_load_dwordx4 v[12:15], v116, s[4:7], s32 offen sc1
s_sub_u32 s29, s29, 1
s_cbranch_scc1 main_kernel_end
s_waitcnt vmcnt(0)
v_max_u32 v126, v8, v10
v_cmp_eq_u32 vcc, -1, v126
s_cbranch_vccnz main_kernel_c7_o2_f
s_branch main_kernel_c7_o2
main_kernel_c7_o3_f:
s_nop 0
s_xor_b32 s32, s23, 3072
buffer_load_dwordx4 v[12:15], v116, s[4:7], s32 offen sc1
s_xor_b32 s32, s23, 4096
buffer_load_dwordx4 v[16:19], v116, s[4:7], s32 offen sc1
s_sub_u32 s29, s29, 1
s_cbranch_scc1 main_kernel_end
s_waitcnt vmcnt(0)
v_max_u32 v126, v12, v14
v_cmp_eq_u32 vcc, -1, v126
s_cbranch_vccnz main_kernel_c7_o3_f
s_branch main_kernel_c7_o3
main_kernel_c7_o4_f:
s_nop 0
s_xor_b32 s32, s23, 4096
buffer_load_dwordx4 v[16:19], v116, s[4:7], s32 offen sc1
s_xor_b32 s32, s23, 5120
buffer_load_dwordx4 v[20:23], v116, s[4:7], s32 offen sc1
s_sub_u32 s29, s29, 1
s_cbranch_scc1 main_kernel_end
s_waitcnt vmcnt(0)
v_max_u32 v126, v16, v18
v_cmp_eq_u32 vcc, -1, v126
s_cbranch_vccnz main_kernel_c7_o4_f
s_branch main_kernel_c7_o4
main_kernel_c7_o5_f:
s_nop 0
s_xor_b32 s32, s23, 5120
buffer_load_dwordx4 v[20:23], v116, s[4:7], s32 offen sc1
s_xor_b32 s32, s23, 6144
buffer_load_dwordx4 v[24:27], v116, s[4:7], s32 offen sc1
s_sub_u32 s29, s29, 1
s_cbranch_scc1 main_kernel_end
s_waitcnt vmcnt(0)
v_max_u32 v126, v20, v22
v_cmp_eq_u32 vcc, -1, v126
s_cbranch_vccnz main_kernel_c7_o5_f
s_branch main_kernel_c7_o5
main_kernel_c7_o6_f:
s_nop 0
s_xor_b32 s32, s23, 6144
buffer_load_dwordx4 v[24:27], v116, s[4:7], s32 offen sc1
s_xor_b32 s32, s23, 7168
buffer_load_dwordx4 v[28:31], v116, s[4:7], s32 offen sc1
s_sub_u32 s29, s29, 1
s_cbranch_scc1 main_kernel_end
s_waitcnt vmcnt(0)
v_max_u32 v126, v24, v26
v_cmp_eq_u32 vcc, -1, v126
s_cbranch_vccnz main_kernel_c7_o6_f
s_branch main_kernel_c7_o6
main_kernel_c7_o7_f:
s_nop 0
s_xor_b32 s32, s23, 7168
buffer_load_dwordx4 v[28:31], v116, s[4:7], s32 offen sc1
s_sub_u32 s29, s29, 1
s_cbranch_scc1 main_kernel_end
s_waitcnt vmcnt(0)
v_max_u32 v126, v28, v30
v_cmp_eq_u32 vcc, -1, v126
s_cbranch_vccnz main_kernel_c7_o7_f
s_branch main_kernel_c7_o7
main_kernel_att:
s_cmp_gt_u32 s13, 1
s_cbranch_scc1 main_kernel_p_end
s_cmp_lg_u32 s14, 0
s_cbranch_scc1 main_kernel_p_bar
s_lshl_b32 s32, s13, 21
s_add_u32 s32, s32, 0x8c00000
v_lshlrev_b32 v2, 2, v250
v_mov_b32 v3, -1
s_mov_b64 s[20:21], -1
s_mov_b32 s34, 12
s_mov_b32 exec_hi, 0
s_waitcnt vmcnt(0)
main_kernel_p_lp:
s_memtime s[16:17]
s_waitcnt lgkmcnt(0)
buffer_store_dword v3, v2, s[4:7], s32 offen sc1
s_waitcnt vmcnt(0)
s_memtime s[18:19]
s_xor_b32 s32, s32, 0x2000
s_waitcnt lgkmcnt(0)
s_sub_u32 s33, s18, s16
s_min_u32 s20, s20, s33
s_memtime s[16:17]
s_waitcnt lgkmcnt(0)
buffer_store_dword v3, v2, s[4:7], s32 offen sc1
s_waitcnt vmcnt(0)
s_memtime s[18:19]
s_xor_b32 s32, s32, 0x2000
s_waitcnt lgkmcnt(0)
s_sub_u32 s33, s18, s16
s_min_u32 s21, s21, s33
s_add_u32 s32, s32, 128
s_sub_u32 s34, s34, 1
s_cmp_lg_u32 s34, 0
s_cbranch_scc1 main_kernel_p_lp
s_cmp_lt_u32 s21, s20
s_cselect_b32 s32, 3, 2
s_lshl_b32 s33, s13, 2
v_mov_b32 v3, s32
s_mov_b64 exec, 1
buffer_store_dword v3, off, s[60:63], s33 offset:16 sc1
s_mov_b64 exec, -1
main_kernel_p_bar:
s_barrier
main_kernel_p_end:
s_mov_b32 s8, s64
s_and_b32 s9, s65, 0xffff
s_mov_b32 s10, 0x200000
s_mov_b32 s11, 0x20000
s_mul_i32 s35, s13, 131072
buffer_load_dword v14, v12, s[8:11], s35 offen
s_add_u32 s35, s35, 32768
buffer_load_dword v14, v12, s[8:11], s35 offen
s_add_u32 s35, s35, 32768
buffer_load_dword v14, v12, s[8:11], s35 offen
s_add_u32 s35, s35, 32768
buffer_load_dword v14, v12, s[8:11], s35 offen
s_add_u32 s35, s35, 32768
s_mov_b32 s8, s66
s_and_b32 s9, s67, 0xffff
s_mov_b32 s10, 0x200000
s_mov_b32 s11, 0x20000
s_mul_i32 s35, s13, 131072
buffer_load_dword v14, v12, s[8:11], s35 offen
s_add_u32 s35, s35, 32768
buffer_load_dword v14, v12, s[8:11], s35 offen
s_add_u32 s35, s35, 32768
buffer_load_dword v14, v12, s[8:11], s35 offen
s_add_u32 s35, s35, 32768
buffer_load_dword v14, v12, s[8:11], s35 offen
s_add_u32 s35, s35, 32768
v_lshlrev_b32 v0, 2, v250
s_mov_b32 s32, 0x841f000
main_kernel_awf:
buffer_load_dword v2, v0, s[4:7], s32 offen sc1
s_waitcnt vmcnt(0)
v_cmp_eq_u32 vcc, 0, v2
s_cbranch_vccz main_kernel_awf_ok
s_sleep 4
s_sub_u32 s29, s29, 1
s_cbranch_scc0 main_kernel_awf
s_branch main_kernel_end
main_kernel_awf_ok:
main_kernel_att2:
s_lshl_b32 s28, s13, 1
s_lshr_b32 s31, s14, 1
s_add_u32 s28, s28, s31
s_and_b32 s30, s14, 1
v_lshlrev_b32 v204, 4, v250
v_and_b32 v200, 15, v250
v_lshrrev_b32 v201, 4, v250
v_and_b32 v202, 7, v250
v_lshl_add_u32 v202, v201, 3, v202
v_lshlrev_b32 v205, 4, v202
v_bfe_u32 v206, v204, 1, 8
v_min_u32 v207, 2, v250
v_lshlrev_b32 v207, 13, v207
s_lshl_b32 s31, s28, 2
s_sub_u32 s31, 82416, s31
s_cmp_eq_u32 s12, 7
s_cselect_b32 s25, 61, 0
s_cselect_b32 s32, 512, 0
s_sub_u32 s31, s31, s32
s_mov_b64 exec, 0xf0
v_lshl_add_u32 v207, v250, 2, s31
s_mov_b64 exec, -1
v_mov_b32 v208, 1
v_mov_b32 v209, 0
s_lshl_b32 s31, s30, 4
v_add_u32 v200, s31, v200
v_lshlrev_b32 v202, 2, v201
v_sub_u32 v200, v200, v202
v_mov_b32 v202, 0xf149f2ca
v_cmp_le_i32 vcc, 0, v200
s_nop 1
v_cndmask_b32 v124, v202, 0, vcc
v_cmp_le_i32 vcc, 1, v200
s_nop 1
v_cndmask_b32 v125, v202, 0, vcc
v_cmp_le_i32 vcc, 2, v200
s_nop 1
v_cndmask_b32 v126, v202, 0, vcc
v_cmp_le_i32 vcc, 3, v200
s_nop 1
v_cndmask_b32 v127, v202, 0, vcc
v_cmp_le_i32 vcc, 16, v200
s_nop 1
v_cndmask_b32 v128, v202, 0, vcc
v_cmp_le_i32 vcc, 17, v200
s_nop 1
v_cndmask_b32 v129, v202, 0, vcc
v_cmp_le_i32 vcc, 18, v200
s_nop 1
v_cndmask_b32 v130, v202, 0, vcc
v_cmp_le_i32 vcc, 19, v200
s_nop 1
v_cndmask_b32 v131, v202, 0, vcc
v_cmp_le_u32 vcc, 2, v201
s_nop 1
v_cndmask_b32 v132, v202, 0, vcc
v_mov_b32 v180, 0x3f803f80
v_cndmask_b32 v133, v202, 0, vcc
v_mov_b32 v181, 0x3f803f80
v_cndmask_b32 v134, v202, 0, vcc
v_mov_b32 v182, 0x3f803f80
v_cndmask_b32 v135, v202, 0, vcc
v_mov_b32 v183, 0x3f803f80
s_mov_b32 s26, 0x3e0293ee
s_mov_b32 s27, 0xbe0293ee
s_lshl_b32 s31, s28, 12
s_add_u32 s16, s31, 0x1800000
s_add_u32 s17, s16, 131072
s_lshl_b32 s32, s30, 17
s_add_u32 s31, s31, s32
s_add_u32 s15, s31, 0x800000
s_add_u32 s22, s31, 0x3800000
s_lshl_b32 s31, s28, 13
s_add_u32 s18, s31, 0x2800000
s_add_u32 s19, s18, 4096
s_lshl_b32 s31, s28, 11
s_add_u32 s20, s31, 0x8000000
s_add_u32 s21, s31, 0x6e00000
s_lshl_b32 s31, s28, 2
s_add_u32 s23, s31, 0x8404000
s_lshl_b32 s31, s28, 3
s_lshl_b32 s32, s30, 2
s_add_u32 s31, s31, s32
s_add_u32 s24, s31, 0x8400000
s_lshl_b32 s31, s30, 7
v_and_b32 v210, 7, v250
v_lshl_add_u32 v210, v210, 8, s31
s_mov_b32 s33, 0x841ec00
s_lshl_b32 s31, s25, 18
s_add_u32 s15, s15, s31
s_add_u32 s16, s16, s31
s_add_u32 s17, s17, s31
s_add_u32 s18, s18, s31
s_add_u32 s19, s19, s31
s_add_u32 s22, s22, s31
s_lshl_b32 s31, s25, 16
s_add_u32 s20, s20, s31
s_add_u32 s21, s21, s31
s_lshl_b32 s31, s25, 8
s_add_u32 s24, s24, s31
s_lshl_b32 s31, s25, 2
s_add_u32 s33, s33, s31
s_lshl_b32 s31, s25, 7
s_add_u32 s23, s23, s31
s_cmp_eq_u32 s25, 0
s_cbranch_scc1 main_kernel_a_fp
s_sub_u32 s32, s24, 1280
main_kernel_a_gp:
buffer_load_dword v200, v209, s[4:7], s32 offen sc1
s_waitcnt vmcnt(0)
v_cmp_eq_u32 vcc, 0, v200
s_and_b32 s31, vcc_lo, 1
s_cbranch_scc0 main_kernel_a_fp
s_sleep 32
s_sub_u32 s29, s29, 1
s_cbranch_scc0 main_kernel_a_gp
s_branch main_kernel_end
main_kernel_a_fp:
buffer_load_dword v200, v207, s[4:7], s23 offen sc1
s_waitcnt vmcnt(0)
v_cmp_eq_u32 vcc, 0, v200
s_and_b32 s31, vcc_lo, -1
s_cbranch_scc0 main_kernel_a_fok
s_sleep 8
s_sub_u32 s29, s29, 1
s_cbranch_scc0 main_kernel_a_fp
s_branch main_kernel_end
main_kernel_a_fok:
buffer_load_dwordx4 v[0:3], v204, s[4:7], s15 offen offset:0 sc1
buffer_load_dwordx4 v[16:19], v204, s[4:7], s16 offen offset:0 sc1
buffer_load_dwordx4 v[32:35], v204, s[4:7], s17 offen offset:0 sc1
buffer_load_dwordx4 v[4:7], v204, s[4:7], s15 offen offset:1024 sc1
buffer_load_dwordx4 v[20:23], v204, s[4:7], s16 offen offset:1024 sc1
buffer_load_dwordx4 v[36:39], v204, s[4:7], s17 offen offset:1024 sc1
buffer_load_dwordx4 v[8:11], v204, s[4:7], s15 offen offset:2048 sc1
buffer_load_dwordx4 v[24:27], v204, s[4:7], s16 offen offset:2048 sc1
buffer_load_dwordx4 v[40:43], v204, s[4:7], s17 offen offset:2048 sc1
buffer_load_dwordx4 v[12:15], v204, s[4:7], s15 offen offset:3072 sc1
buffer_load_dwordx4 v[28:31], v204, s[4:7], s16 offen offset:3072 sc1
buffer_load_dwordx4 v[44:47], v204, s[4:7], s17 offen offset:3072 sc1
v_mov_b32 v211, 0
s_mov_b64 exec, 255
buffer_atomic_add v211, v210, s[4:7], s21 offen sc0 sc1
s_mov_b64 exec, -1
buffer_load_dwordx4 v[48:51], v204, s[4:7], s18 offen offset:0 sc1
buffer_load_dwordx4 v[52:55], v204, s[4:7], s18 offen offset:1024 sc1
buffer_load_dwordx4 v[56:59], v204, s[4:7], s18 offen offset:2048 sc1
buffer_load_dwordx4 v[60:63], v204, s[4:7], s18 offen offset:3072 sc1
buffer_load_dwordx4 v[64:67], v204, s[4:7], s19 offen offset:0 sc1
buffer_load_dwordx4 v[68:71], v204, s[4:7], s19 offen offset:1024 sc1
buffer_load_dwordx4 v[72:75], v204, s[4:7], s19 offen offset:2048 sc1
buffer_load_dwordx4 v[76:79], v204, s[4:7], s19 offen offset:3072 sc1
s_waitcnt vmcnt(0)
main_kernel_a_top:
s_cmp_ge_u32 s25, 60
s_cselect_b32 s38, 2, 1
s_lshl_b32 s34, s38, 18
s_lshl_b32 s35, s38, 16
s_lshl_b32 s36, s38, 8
s_lshl_b32 s37, s38, 2
s_lshl_b32 s39, s38, 7
s_waitcnt vmcnt(19)
v_mfma_f32_16x16x32_bf16 v[112:115], v[16:19], v[0:3], v[124:127]
v_mfma_f32_16x16x32_bf16 v[116:119], v[32:35], v[0:3], v[128:131]
s_waitcnt vmcnt(16)
v_mfma_f32_16x16x32_bf16 v[112:115], v[20:23], v[4:7], v[112:115]
v_mfma_f32_16x16x32_bf16 v[116:119], v[36:39], v[4:7], v[116:119]
s_waitcnt vmcnt(13)
v_mfma_f32_16x16x32_bf16 v[112:115], v[24:27], v[8:11], v[112:115]
v_mfma_f32_16x16x32_bf16 v[116:119], v[40:43], v[8:11], v[116:119]
s_waitcnt vmcnt(10)
v_mfma_f32_16x16x32_bf16 v[112:115], v[28:31], v[12:15], v[112:115]
v_mfma_f32_16x16x32_bf16 v[116:119], v[44:47], v[12:15], v[116:119]
s_add_u32 s15, s15, s34
s_add_u32 s16, s16, s34
s_add_u32 s17, s17, s34
s_add_u32 s18, s18, s34
s_add_u32 s19, s19, s34
s_add_u32 s23, s23, s39
s_waitcnt vmcnt(9)
v_cmp_eq_u32 vcc, -1, v211
s_nop 0
v_max3_f32 v202, v112, v113, v114
s_nop 1
v_max3_f32 v202, v202, v115, v116
v_max3_f32 v202, v202, v117, v118
v_max_f32 v202, v202, v119
s_cbranch_vccz main_kernel_a_mp
s_cmp_eq_u32 s25, 99
s_cbranch_scc1 main_kernel_a_mp
main_kernel_a_pp:
v_mov_b32 v211, 0
s_mov_b64 exec, 255
buffer_atomic_add v211, v210, s[4:7], s21 offen sc0 sc1
s_mov_b64 exec, -1
s_sub_u32 s29, s29, 1
s_cbranch_scc1 main_kernel_end
s_waitcnt vmcnt(0)
v_cmp_eq_u32 vcc, -1, v211
s_cbranch_vccnz main_kernel_a_pp
main_kernel_a_mp:
buffer_load_dwordx4 v[80:83], v205, s[4:7], s20 offen offset:0 sc1
buffer_load_dwordx4 v[84:87], v205, s[4:7], s20 offen offset:512 sc1
buffer_load_dwordx4 v[88:91], v205, s[4:7], s20 offen offset:1024 sc1
buffer_load_dwordx4 v[92:95], v205, s[4:7], s20 offen offset:1536 sc1
buffer_load_dwordx2 v[96:97], v206, s[4:7], s21 offen offset:0 sc1
buffer_load_dwordx2 v[98:99], v206, s[4:7], s21 offen offset:256 sc1
buffer_load_dwordx2 v[100:101], v206, s[4:7], s21 offen offset:512 sc1
buffer_load_dwordx2 v[102:103], v206, s[4:7], s21 offen offset:768 sc1
buffer_load_dwordx2 v[104:105], v206, s[4:7], s21 offen offset:1024 sc1
buffer_load_dwordx2 v[106:107], v206, s[4:7], s21 offen offset:1280 sc1
buffer_load_dwordx2 v[108:109], v206, s[4:7], s21 offen offset:1536 sc1
buffer_load_dwordx2 v[110:111], v206, s[4:7], s21 offen offset:1792 sc1
buffer_load_dword v211, v207, s[4:7], s23 offen sc1
s_waitcnt vmcnt(12)
v_mfma_f32_16x16x32_bf16 v[120:123], v[80:83], v[0:3], v[132:135]
v_max3_u32 v200, v80, v81, v82
v_max_u32 v200, v200, v83
s_waitcnt vmcnt(11)
v_mfma_f32_16x16x32_bf16 v[120:123], v[84:87], v[4:7], v[120:123]
v_max3_u32 v200, v200, v84, v85
v_max3_u32 v200, v200, v86, v87
s_waitcnt vmcnt(10)
v_mfma_f32_16x16x32_bf16 v[120:123], v[88:91], v[8:11], v[120:123]
v_max3_u32 v200, v200, v88, v89
v_max3_u32 v200, v200, v90, v91
s_waitcnt vmcnt(9)
v_mfma_f32_16x16x32_bf16 v[120:123], v[92:95], v[12:15], v[120:123]
v_max3_u32 v200, v200, v92, v93
v_max3_u32 v200, v200, v94, v95
s_waitcnt vmcnt(7)
v_max3_u32 v200, v200, v96, v97
v_max3_u32 v200, v200, v98, v99
s_waitcnt vmcnt(5)
v_max3_u32 v200, v200, v100, v101
v_max3_u32 v200, v200, v102, v103
s_waitcnt vmcnt(3)
v_max3_u32 v200, v200, v104, v105
v_max3_u32 v200, v200, v106, v107
s_waitcnt vmcnt(1)
v_max3_u32 v200, v200, v108, v109
v_max3_u32 v200, v200, v110, v111
v_cmp_eq_u32 vcc, -1, v200
s_cbranch_vccz main_kernel_a_mok
s_sleep 1
s_sub_u32 s29, s29, 1
s_cbranch_scc0 main_kernel_a_mp
s_branch main_kernel_end
main_kernel_a_mok:
v_mul_f32 v120, s26, v120
v_mul_f32 v121, s26, v121
v_mul_f32 v122, s26, v122
v_mul_f32 v123, s26, v123
v_max3_f32 v200, v202, v120, v121
v_max3_f32 v200, v200, v122, v123
v_mov_b32 v201, v200
s_add_u32 s20, s20, s35
s_add_u32 s21, s21, s35
v_permlane32_swap_b32 v200, v201
v_max_f32 v200, v200, v201
v_mov_b32 v201, v200
s_nop 1
v_permlane16_swap_b32 v200, v201
v_max_f32 v200, v200, v201
v_sub_f32 v112, v112, v200
v_sub_f32 v113, v113, v200
v_sub_f32 v114, v114, v200
v_sub_f32 v115, v115, v200
v_sub_f32 v116, v116, v200
v_sub_f32 v117, v117, v200
v_sub_f32 v118, v118, v200
v_sub_f32 v119, v119, v200
v_sub_f32 v120, v120, v200
v_sub_f32 v121, v121, v200
v_sub_f32 v122, v122, v200
v_sub_f32 v123, v123, v200
v_exp_f32 v112, v112
v_exp_f32 v113, v113
v_exp_f32 v114, v114
v_cvt_pk_bf16_f32 v136, v112, v113
v_exp_f32 v115, v115
v_exp_f32 v116, v116
v_cvt_pk_bf16_f32 v137, v114, v115
v_exp_f32 v117, v117
v_exp_f32 v118, v118
v_cvt_pk_bf16_f32 v138, v116, v117
v_exp_f32 v119, v119
v_exp_f32 v120, v120
v_cvt_pk_bf16_f32 v139, v118, v119
v_exp_f32 v121, v121
v_exp_f32 v122, v122
v_cvt_pk_bf16_f32 v140, v120, v121
v_exp_f32 v123, v123
s_nop 0
v_cvt_pk_bf16_f32 v141, v122, v123
v_mfma_f32_16x16x32_bf16 v[144:147], v[180:183], v[136:139], 0
v_mfma_f32_16x16x32_bf16 v[148:151], v[48:51], v[136:139], 0
v_mfma_f32_16x16x16_bf16 v[144:147], v[180:181], v[140:141], v[144:147]
v_mfma_f32_16x16x32_bf16 v[152:155], v[52:55], v[136:139], 0
v_mfma_f32_16x16x32_bf16 v[156:159], v[56:59], v[136:139], 0
v_mfma_f32_16x16x32_bf16 v[160:163], v[60:63], v[136:139], 0
v_mfma_f32_16x16x32_bf16 v[164:167], v[64:67], v[136:139], 0
v_mfma_f32_16x16x32_bf16 v[168:171], v[68:71], v[136:139], 0
v_mfma_f32_16x16x32_bf16 v[172:175], v[72:75], v[136:139], 0
v_mfma_f32_16x16x32_bf16 v[176:179], v[76:79], v[136:139], 0
v_rcp_f32 v200, v144
v_mfma_f32_16x16x16_bf16 v[148:151], v[96:97], v[140:141], v[148:151]
v_mfma_f32_16x16x16_bf16 v[152:155], v[98:99], v[140:141], v[152:155]
v_mfma_f32_16x16x16_bf16 v[156:159], v[100:101], v[140:141], v[156:159]
v_mfma_f32_16x16x16_bf16 v[160:163], v[102:103], v[140:141], v[160:163]
v_mfma_f32_16x16x16_bf16 v[164:167], v[104:105], v[140:141], v[164:167]
v_mfma_f32_16x16x16_bf16 v[168:171], v[106:107], v[140:141], v[168:171]
v_mfma_f32_16x16x16_bf16 v[172:175], v[108:109], v[140:141], v[172:175]
v_mfma_f32_16x16x16_bf16 v[176:179], v[110:111], v[140:141], v[176:179]
v_mov_b32 v201, v200
s_waitcnt vmcnt(0)
v_cmp_eq_u32 vcc, 0, v211
v_pk_mul_f32 v[148:149], v[148:149], v[200:201]
v_pk_mul_f32 v[150:151], v[150:151], v[200:201]
v_pk_mul_f32 v[152:153], v[152:153], v[200:201]
v_pk_mul_f32 v[154:155], v[154:155], v[200:201]
v_cvt_pk_bf16_f32 v184, v148, v149
v_cvt_pk_bf16_f32 v185, v150, v151
v_cvt_pk_bf16_f32 v186, v152, v153
v_cvt_pk_bf16_f32 v187, v154, v155
buffer_store_dwordx4 v[184:187], v204, s[4:7], s22 offen offset:0 sc1
v_pk_mul_f32 v[156:157], v[156:157], v[200:201]
v_pk_mul_f32 v[158:159], v[158:159], v[200:201]
v_pk_mul_f32 v[160:161], v[160:161], v[200:201]
v_pk_mul_f32 v[162:163], v[162:163], v[200:201]
v_cvt_pk_bf16_f32 v188, v156, v157
v_cvt_pk_bf16_f32 v189, v158, v159
v_cvt_pk_bf16_f32 v190, v160, v161
v_cvt_pk_bf16_f32 v191, v162, v163
buffer_store_dwordx4 v[188:191], v204, s[4:7], s22 offen offset:1024 sc1
v_pk_mul_f32 v[164:165], v[164:165], v[200:201]
v_pk_mul_f32 v[166:167], v[166:167], v[200:201]
v_pk_mul_f32 v[168:169], v[168:169], v[200:201]
v_pk_mul_f32 v[170:171], v[170:171], v[200:201]
v_cvt_pk_bf16_f32 v192, v164, v165
v_cvt_pk_bf16_f32 v193, v166, v167
v_cvt_pk_bf16_f32 v194, v168, v169
v_cvt_pk_bf16_f32 v195, v170, v171
buffer_store_dwordx4 v[192:195], v204, s[4:7], s22 offen offset:2048 sc1
s_nop 0
v_pk_mul_f32 v[172:173], v[172:173], v[200:201]
v_pk_mul_f32 v[174:175], v[174:175], v[200:201]
v_pk_mul_f32 v[176:177], v[176:177], v[200:201]
v_pk_mul_f32 v[178:179], v[178:179], v[200:201]
v_cvt_pk_bf16_f32 v196, v172, v173
v_cvt_pk_bf16_f32 v197, v174, v175
v_cvt_pk_bf16_f32 v198, v176, v177
v_cvt_pk_bf16_f32 v199, v178, v179
buffer_store_dwordx4 v[196:199], v204, s[4:7], s22 offen offset:3072 sc1
s_add_u32 s22, s22, s34
s_add_u32 s33, s33, s37
s_add_u32 s25, s25, s38
s_cmp_ge_u32 s25, 64
s_cbranch_scc1 main_kernel_a_last
s_cbranch_vccnz main_kernel_a_slow
s_cmp_gt_u32 s25, 60
s_cbranch_scc1 main_kernel_a_slow
buffer_load_dwordx4 v[0:3], v204, s[4:7], s15 offen offset:0 sc1
buffer_load_dwordx4 v[16:19], v204, s[4:7], s16 offen offset:0 sc1
buffer_load_dwordx4 v[32:35], v204, s[4:7], s17 offen offset:0 sc1
buffer_load_dwordx4 v[4:7], v204, s[4:7], s15 offen offset:1024 sc1
buffer_load_dwordx4 v[20:23], v204, s[4:7], s16 offen offset:1024 sc1
buffer_load_dwordx4 v[36:39], v204, s[4:7], s17 offen offset:1024 sc1
buffer_load_dwordx4 v[8:11], v204, s[4:7], s15 offen offset:2048 sc1
buffer_load_dwordx4 v[24:27], v204, s[4:7], s16 offen offset:2048 sc1
buffer_load_dwordx4 v[40:43], v204, s[4:7], s17 offen offset:2048 sc1
buffer_load_dwordx4 v[12:15], v204, s[4:7], s15 offen offset:3072 sc1
buffer_load_dwordx4 v[28:31], v204, s[4:7], s16 offen offset:3072 sc1
buffer_load_dwordx4 v[44:47], v204, s[4:7], s17 offen offset:3072 sc1
v_mov_b32 v211, 0
s_mov_b64 exec, 255
buffer_atomic_add v211, v210, s[4:7], s21 offen sc0 sc1
s_mov_b64 exec, -1
buffer_load_dwordx4 v[48:51], v204, s[4:7], s18 offen offset:0 sc1
buffer_load_dwordx4 v[52:55], v204, s[4:7], s18 offen offset:1024 sc1
buffer_load_dwordx4 v[56:59], v204, s[4:7], s18 offen offset:2048 sc1
buffer_load_dwordx4 v[60:63], v204, s[4:7], s18 offen offset:3072 sc1
buffer_load_dwordx4 v[64:67], v204, s[4:7], s19 offen offset:0 sc1
buffer_load_dwordx4 v[68:71], v204, s[4:7], s19 offen offset:1024 sc1
buffer_load_dwordx4 v[72:75], v204, s[4:7], s19 offen offset:2048 sc1
buffer_load_dwordx4 v[76:79], v204, s[4:7], s19 offen offset:3072 sc1
s_waitcnt vmcnt(21)
s_mov_b64 exec, 1
buffer_store_dword v208, v209, s[4:7], s24 offen sc1
s_mov_b64 exec, -1
s_add_u32 s24, s24, s36
s_branch main_kernel_a_top
main_kernel_a_slow:
s_waitcnt vmcnt(0)
s_mov_b64 exec, 1
buffer_store_dword v208, v209, s[4:7], s24 offen sc1
s_mov_b64 exec, -1
s_add_u32 s24, s24, s36
s_branch main_kernel_a_fp
main_kernel_a_last:
s_waitcnt vmcnt(0)
s_mov_b64 exec, 1
buffer_store_dword v208, v209, s[4:7], s24 offen sc1
s_mov_b64 exec, -1
s_add_u32 s24, s24, s36
s_branch main_kernel_end
main_kernel_wo:
s_mov_b32 s8, s46
s_and_b32 s9, s47, 0xffff
s_mov_b32 s10, 0x800000
s_mov_b32 s11, 0x20000
v_lshlrev_b32 v170, 4, v250
s_lshr_b32 s23, s12, 2
s_sub_u32 s21, s12, 5
s_cselect_b32 s23, s23, s21
s_cselect_b32 s18, 44, 63
v_lshrrev_b32 v178, 2, v250
v_and_b32 v179, 3, v250
v_lshlrev_b32 v0, 11, v178
v_lshl_add_u32 v0, v179, 4, v0
s_lshl_b32 s19, s14, 15
v_lshl_add_u32 v1, v178, 6, s19
v_lshl_add_u32 v1, v179, 3, v1
s_lshl_b32 s20, s14, 21
s_lshl_b32 s21, s13, 6
s_add_u32 s20, s20, s21
s_add_u32 s21, s20, 0x0
s_add_u32 m0, s19, 0
s_nop 0
buffer_load_dwordx4 v0, s[8:11], s21 offen lds
s_add_u32 s21, s20, 0x8000
s_add_u32 m0, s19, 1024
s_nop 0
buffer_load_dwordx4 v0, s[8:11], s21 offen lds
s_add_u32 s21, s20, 0x10000
s_add_u32 m0, s19, 2048
s_nop 0
buffer_load_dwordx4 v0, s[8:11], s21 offen lds
s_add_u32 s21, s20, 0x18000
s_add_u32 m0, s19, 3072
s_nop 0
buffer_load_dwordx4 v0, s[8:11], s21 offen lds
s_add_u32 s21, s20, 0x20000
s_add_u32 m0, s19, 4096
s_nop 0
buffer_load_dwordx4 v0, s[8:11], s21 offen lds
s_add_u32 s21, s20, 0x28000
s_add_u32 m0, s19, 5120
s_nop 0
buffer_load_dwordx4 v0, s[8:11], s21 offen lds
s_add_u32 s21, s20, 0x30000
s_add_u32 m0, s19, 6144
s_nop 0
buffer_load_dwordx4 v0, s[8:11], s21 offen lds
s_add_u32 s21, s20, 0x38000
s_add_u32 m0, s19, 7168
s_nop 0
buffer_load_dwordx4 v0, s[8:11], s21 offen lds
s_add_u32 s21, s20, 0x40000
s_add_u32 m0, s19, 8192
s_nop 0
buffer_load_dwordx4 v0, s[8:11], s21 offen lds
s_add_u32 s21, s20, 0x48000
s_add_u32 m0, s19, 9216
s_nop 0
buffer_load_dwordx4 v0, s[8:11], s21 offen lds
s_add_u32 s21, s20, 0x50000
s_add_u32 m0, s19, 10240
s_nop 0
buffer_load_dwordx4 v0, s[8:11], s21 offen lds
s_add_u32 s21, s20, 0x58000
s_add_u32 m0, s19, 11264
s_nop 0
buffer_load_dwordx4 v0, s[8:11], s21 offen lds
s_add_u32 s21, s20, 0x60000
s_add_u32 m0, s19, 12288
s_nop 0
buffer_load_dwordx4 v0, s[8:11], s21 offen lds
s_add_u32 s21, s20, 0x68000
s_add_u32 m0, s19, 13312
s_nop 0
buffer_load_dwordx4 v0, s[8:11], s21 offen lds
s_add_u32 s21, s20, 0x70000
s_add_u32 m0, s19, 14336
s_nop 0
buffer_load_dwordx4 v0, s[8:11], s21 offen lds
s_add_u32 s21, s20, 0x78000
s_add_u32 m0, s19, 15360
s_nop 0
buffer_load_dwordx4 v0, s[8:11], s21 offen lds
s_add_u32 s21, s20, 0x80000
s_add_u32 m0, s19, 16384
s_nop 0
buffer_load_dwordx4 v0, s[8:11], s21 offen lds
s_add_u32 s21, s20, 0x88000
s_add_u32 m0, s19, 17408
s_nop 0
buffer_load_dwordx4 v0, s[8:11], s21 offen lds
s_add_u32 s21, s20, 0x90000
s_add_u32 m0, s19, 18432
s_nop 0
buffer_load_dwordx4 v0, s[8:11], s21 offen lds
s_add_u32 s21, s20, 0x98000
s_add_u32 m0, s19, 19456
s_nop 0
buffer_load_dwordx4 v0, s[8:11], s21 offen lds
s_add_u32 s21, s20, 0xa0000
s_add_u32 m0, s19, 20480
s_nop 0
buffer_load_dwordx4 v0, s[8:11], s21 offen lds
s_add_u32 s21, s20, 0xa8000
s_add_u32 m0, s19, 21504
s_nop 0
buffer_load_dwordx4 v0, s[8:11], s21 offen lds
s_add_u32 s21, s20, 0xb0000
s_add_u32 m0, s19, 22528
s_nop 0
buffer_load_dwordx4 v0, s[8:11], s21 offen lds
s_add_u32 s21, s20, 0xb8000
s_add_u32 m0, s19, 23552
s_nop 0
buffer_load_dwordx4 v0, s[8:11], s21 offen lds
s_add_u32 s21, s20, 0xc0000
s_add_u32 m0, s19, 24576
s_nop 0
buffer_load_dwordx4 v0, s[8:11], s21 offen lds
s_add_u32 s21, s20, 0xc8000
s_add_u32 m0, s19, 25600
s_nop 0
buffer_load_dwordx4 v0, s[8:11], s21 offen lds
s_add_u32 s21, s20, 0xd0000
s_add_u32 m0, s19, 26624
s_nop 0
buffer_load_dwordx4 v0, s[8:11], s21 offen lds
s_add_u32 s21, s20, 0xd8000
s_add_u32 m0, s19, 27648
s_nop 0
buffer_load_dwordx4 v0, s[8:11], s21 offen lds
s_add_u32 s21, s20, 0xe0000
s_add_u32 m0, s19, 28672
s_nop 0
buffer_load_dwordx4 v0, s[8:11], s21 offen lds
s_add_u32 s21, s20, 0xe8000
s_add_u32 m0, s19, 29696
s_nop 0
buffer_load_dwordx4 v0, s[8:11], s21 offen lds
s_add_u32 s21, s20, 0xf0000
s_add_u32 m0, s19, 30720
s_nop 0
buffer_load_dwordx4 v0, s[8:11], s21 offen lds
s_add_u32 s21, s20, 0xf8000
s_add_u32 m0, s19, 31744
s_nop 0
buffer_load_dwordx4 v0, s[8:11], s21 offen lds
v_and_b32 v178, 15, v250
v_lshrrev_b32 v179, 4, v250
v_lshlrev_b32 v175, 11, v178
v_lshl_add_u32 v175, v179, 3, v175
s_lshl_b32 s21, s14, 11
s_add_u32 s21, s21, 131072
v_add_u32 v176, s21, v170
s_lshl_b32 s21, s14, 10
s_add_u32 s21, s21, 131072
v_add_u32 v177, s21, v170
s_lshr_b32 s21, s13, 2
s_lshl_b32 s21, s21, 2
s_add_u32 s21, s21, 0x8412000
s_lshl_b32 s22, s18, 7
s_add_u32 s21, s22, s21
v_mov_b32 v172, s21
v_mov_b32 v173, 128
s_lshl_b32 s21, s14, 4
s_add_u32 s21, s21, s23
s_lshl_b32 s21, s21, 2
s_add_u32 s21, s21, 0x8400000
s_lshl_b32 s22, s18, 8
s_add_u32 s21, s21, s22
s_mov_b64 exec, 0xff
v_lshl_add_u32 v172, v250, 3, s21
v_mov_b32 v173, 0x100
s_mov_b64 exec, -1
s_lshl_b32 s15, s14, 15
s_lshl_b32 s21, s23, 17
s_add_u32 s15, s15, s21
s_add_u32 s15, s15, 0x3800000
s_lshl_b32 s21, s18, 18
s_add_u32 s15, s15, s21
s_lshl_b32 s21, s23, 15
s_lshl_b32 s22, s18, 16
s_add_u32 s21, s21, s22
s_and_b32 s22, s14, 1
s_lshl_b32 s16, s13, 1
s_add_u32 s16, s16, s22
s_lshl_b32 s16, s16, 5
s_add_u32 s16, s16, s21
s_lshl_b32 s17, s13, 7
s_add_u32 s17, s17, s22
s_lshl_b32 s17, s17, 3
s_add_u32 s17, s17, s21
s_add_u32 s17, s17, 0x6400000
s_waitcnt vmcnt(24)
ds_read_b64_tr_b16 a[0:1], v1 offset:0
ds_read_b64_tr_b16 a[2:3], v1 offset:1024
ds_read_b64_tr_b16 a[128:129], v1 offset:32
ds_read_b64_tr_b16 a[130:131], v1 offset:1056
ds_read_b64_tr_b16 a[4:5], v1 offset:2048
ds_read_b64_tr_b16 a[6:7], v1 offset:3072
ds_read_b64_tr_b16 a[132:133], v1 offset:2080
ds_read_b64_tr_b16 a[134:135], v1 offset:3104
ds_read_b64_tr_b16 a[8:9], v1 offset:4096
ds_read_b64_tr_b16 a[10:11], v1 offset:5120
ds_read_b64_tr_b16 a[136:137], v1 offset:4128
ds_read_b64_tr_b16 a[138:139], v1 offset:5152
ds_read_b64_tr_b16 a[12:13], v1 offset:6144
ds_read_b64_tr_b16 a[14:15], v1 offset:7168
ds_read_b64_tr_b16 a[140:141], v1 offset:6176
ds_read_b64_tr_b16 a[142:143], v1 offset:7200
s_waitcnt lgkmcnt(0)
s_add_u32 s21, s20, 0x100000
s_add_u32 m0, s19, 0
s_nop 0
buffer_load_dwordx4 v0, s[8:11], s21 offen lds
s_add_u32 s21, s20, 0x108000
s_add_u32 m0, s19, 1024
s_nop 0
buffer_load_dwordx4 v0, s[8:11], s21 offen lds
s_add_u32 s21, s20, 0x110000
s_add_u32 m0, s19, 2048
s_nop 0
buffer_load_dwordx4 v0, s[8:11], s21 offen lds
s_add_u32 s21, s20, 0x118000
s_add_u32 m0, s19, 3072
s_nop 0
buffer_load_dwordx4 v0, s[8:11], s21 offen lds
s_add_u32 s21, s20, 0x120000
s_add_u32 m0, s19, 4096
s_nop 0
buffer_load_dwordx4 v0, s[8:11], s21 offen lds
s_add_u32 s21, s20, 0x128000
s_add_u32 m0, s19, 5120
s_nop 0
buffer_load_dwordx4 v0, s[8:11], s21 offen lds
s_add_u32 s21, s20, 0x130000
s_add_u32 m0, s19, 6144
s_nop 0
buffer_load_dwordx4 v0, s[8:11], s21 offen lds
s_add_u32 s21, s20, 0x138000
s_add_u32 m0, s19, 7168
s_nop 0
buffer_load_dwordx4 v0, s[8:11], s21 offen lds
s_waitcnt vmcnt(24)
ds_read_b64_tr_b16 a[16:17], v1 offset:8192
ds_read_b64_tr_b16 a[18:19], v1 offset:9216
ds_read_b64_tr_b16 a[144:145], v1 offset:8224
ds_read_b64_tr_b16 a[146:147], v1 offset:9248
ds_read_b64_tr_b16 a[20:21], v1 offset:10240
ds_read_b64_tr_b16 a[22:23], v1 offset:11264
ds_read_b64_tr_b16 a[148:149], v1 offset:10272
ds_read_b64_tr_b16 a[150:151], v1 offset:11296
ds_read_b64_tr_b16 a[24:25], v1 offset:12288
ds_read_b64_tr_b16 a[26:27], v1 offset:13312
ds_read_b64_tr_b16 a[152:153], v1 offset:12320
ds_read_b64_tr_b16 a[154:155], v1 offset:13344
ds_read_b64_tr_b16 a[28:29], v1 offset:14336
ds_read_b64_tr_b16 a[30:31], v1 offset:15360
ds_read_b64_tr_b16 a[156:157], v1 offset:14368
ds_read_b64_tr_b16 a[158:159], v1 offset:15392
s_waitcnt lgkmcnt(0)
s_add_u32 s21, s20, 0x140000
s_add_u32 m0, s19, 8192
s_nop 0
buffer_load_dwordx4 v0, s[8:11], s21 offen lds
s_add_u32 s21, s20, 0x148000
s_add_u32 m0, s19, 9216
s_nop 0
buffer_load_dwordx4 v0, s[8:11], s21 offen lds
s_add_u32 s21, s20, 0x150000
s_add_u32 m0, s19, 10240
s_nop 0
buffer_load_dwordx4 v0, s[8:11], s21 offen lds
s_add_u32 s21, s20, 0x158000
s_add_u32 m0, s19, 11264
s_nop 0
buffer_load_dwordx4 v0, s[8:11], s21 offen lds
s_add_u32 s21, s20, 0x160000
s_add_u32 m0, s19, 12288
s_nop 0
buffer_load_dwordx4 v0, s[8:11], s21 offen lds
s_add_u32 s21, s20, 0x168000
s_add_u32 m0, s19, 13312
s_nop 0
buffer_load_dwordx4 v0, s[8:11], s21 offen lds
s_add_u32 s21, s20, 0x170000
s_add_u32 m0, s19, 14336
s_nop 0
buffer_load_dwordx4 v0, s[8:11], s21 offen lds
s_add_u32 s21, s20, 0x178000
s_add_u32 m0, s19, 15360
s_nop 0
buffer_load_dwordx4 v0, s[8:11], s21 offen lds
s_waitcnt vmcnt(24)
ds_read_b64_tr_b16 a[32:33], v1 offset:16384
ds_read_b64_tr_b16 a[34:35], v1 offset:17408
ds_read_b64_tr_b16 a[160:161], v1 offset:16416
ds_read_b64_tr_b16 a[162:163], v1 offset:17440
ds_read_b64_tr_b16 a[36:37], v1 offset:18432
ds_read_b64_tr_b16 a[38:39], v1 offset:19456
ds_read_b64_tr_b16 a[164:165], v1 offset:18464
ds_read_b64_tr_b16 a[166:167], v1 offset:19488
ds_read_b64_tr_b16 a[40:41], v1 offset:20480
ds_read_b64_tr_b16 a[42:43], v1 offset:21504
ds_read_b64_tr_b16 a[168:169], v1 offset:20512
ds_read_b64_tr_b16 a[170:171], v1 offset:21536
ds_read_b64_tr_b16 a[44:45], v1 offset:22528
ds_read_b64_tr_b16 a[46:47], v1 offset:23552
ds_read_b64_tr_b16 a[172:173], v1 offset:22560
ds_read_b64_tr_b16 a[174:175], v1 offset:23584
s_waitcnt lgkmcnt(0)
s_add_u32 s21, s20, 0x180000
s_add_u32 m0, s19, 16384
s_nop 0
buffer_load_dwordx4 v0, s[8:11], s21 offen lds
s_add_u32 s21, s20, 0x188000
s_add_u32 m0, s19, 17408
s_nop 0
buffer_load_dwordx4 v0, s[8:11], s21 offen lds
s_add_u32 s21, s20, 0x190000
s_add_u32 m0, s19, 18432
s_nop 0
buffer_load_dwordx4 v0, s[8:11], s21 offen lds
s_add_u32 s21, s20, 0x198000
s_add_u32 m0, s19, 19456
s_nop 0
buffer_load_dwordx4 v0, s[8:11], s21 offen lds
s_add_u32 s21, s20, 0x1a0000
s_add_u32 m0, s19, 20480
s_nop 0
buffer_load_dwordx4 v0, s[8:11], s21 offen lds
s_add_u32 s21, s20, 0x1a8000
s_add_u32 m0, s19, 21504
s_nop 0
buffer_load_dwordx4 v0, s[8:11], s21 offen lds
s_add_u32 s21, s20, 0x1b0000
s_add_u32 m0, s19, 22528
s_nop 0
buffer_load_dwordx4 v0, s[8:11], s21 offen lds
s_add_u32 s21, s20, 0x1b8000
s_add_u32 m0, s19, 23552
s_nop 0
buffer_load_dwordx4 v0, s[8:11], s21 offen lds
s_waitcnt vmcnt(24)
ds_read_b64_tr_b16 a[48:49], v1 offset:24576
ds_read_b64_tr_b16 a[50:51], v1 offset:25600
ds_read_b64_tr_b16 a[176:177], v1 offset:24608
ds_read_b64_tr_b16 a[178:179], v1 offset:25632
ds_read_b64_tr_b16 a[52:53], v1 offset:26624
ds_read_b64_tr_b16 a[54:55], v1 offset:27648
ds_read_b64_tr_b16 a[180:181], v1 offset:26656
ds_read_b64_tr_b16 a[182:183], v1 offset:27680
ds_read_b64_tr_b16 a[56:57], v1 offset:28672
ds_read_b64_tr_b16 a[58:59], v1 offset:29696
ds_read_b64_tr_b16 a[184:185], v1 offset:28704
ds_read_b64_tr_b16 a[186:187], v1 offset:29728
ds_read_b64_tr_b16 a[60:61], v1 offset:30720
ds_read_b64_tr_b16 a[62:63], v1 offset:31744
ds_read_b64_tr_b16 a[188:189], v1 offset:30752
ds_read_b64_tr_b16 a[190:191], v1 offset:31776
s_waitcnt lgkmcnt(0)
s_add_u32 s21, s20, 0x1c0000
s_add_u32 m0, s19, 24576
s_nop 0
buffer_load_dwordx4 v0, s[8:11], s21 offen lds
s_add_u32 s21, s20, 0x1c8000
s_add_u32 m0, s19, 25600
s_nop 0
buffer_load_dwordx4 v0, s[8:11], s21 offen lds
s_add_u32 s21, s20, 0x1d0000
s_add_u32 m0, s19, 26624
s_nop 0
buffer_load_dwordx4 v0, s[8:11], s21 offen lds
s_add_u32 s21, s20, 0x1d8000
s_add_u32 m0, s19, 27648
s_nop 0
buffer_load_dwordx4 v0, s[8:11], s21 offen lds
s_add_u32 s21, s20, 0x1e0000
s_add_u32 m0, s19, 28672
s_nop 0
buffer_load_dwordx4 v0, s[8:11], s21 offen lds
s_add_u32 s21, s20, 0x1e8000
s_add_u32 m0, s19, 29696
s_nop 0
buffer_load_dwordx4 v0, s[8:11], s21 offen lds
s_add_u32 s21, s20, 0x1f0000
s_add_u32 m0, s19, 30720
s_nop 0
buffer_load_dwordx4 v0, s[8:11], s21 offen lds
s_add_u32 s21, s20, 0x1f8000
s_add_u32 m0, s19, 31744
s_nop 0
buffer_load_dwordx4 v0, s[8:11], s21 offen lds
s_waitcnt vmcnt(24)
ds_read_b64_tr_b16 a[64:65], v1 offset:0
ds_read_b64_tr_b16 a[66:67], v1 offset:1024
ds_read_b64_tr_b16 a[192:193], v1 offset:32
ds_read_b64_tr_b16 a[194:195], v1 offset:1056
ds_read_b64_tr_b16 a[68:69], v1 offset:2048
ds_read_b64_tr_b16 a[70:71], v1 offset:3072
ds_read_b64_tr_b16 a[196:197], v1 offset:2080
ds_read_b64_tr_b16 a[198:199], v1 offset:3104
ds_read_b64_tr_b16 a[72:73], v1 offset:4096
ds_read_b64_tr_b16 a[74:75], v1 offset:5120
ds_read_b64_tr_b16 a[200:201], v1 offset:4128
ds_read_b64_tr_b16 a[202:203], v1 offset:5152
ds_read_b64_tr_b16 a[76:77], v1 offset:6144
ds_read_b64_tr_b16 a[78:79], v1 offset:7168
ds_read_b64_tr_b16 a[204:205], v1 offset:6176
ds_read_b64_tr_b16 a[206:207], v1 offset:7200
s_waitcnt lgkmcnt(0)
s_waitcnt vmcnt(16)
ds_read_b64_tr_b16 a[80:81], v1 offset:8192
ds_read_b64_tr_b16 a[82:83], v1 offset:9216
ds_read_b64_tr_b16 a[208:209], v1 offset:8224
ds_read_b64_tr_b16 a[210:211], v1 offset:9248
ds_read_b64_tr_b16 a[84:85], v1 offset:10240
ds_read_b64_tr_b16 a[86:87], v1 offset:11264
ds_read_b64_tr_b16 a[212:213], v1 offset:10272
ds_read_b64_tr_b16 a[214:215], v1 offset:11296
ds_read_b64_tr_b16 a[88:89], v1 offset:12288
ds_read_b64_tr_b16 a[90:91], v1 offset:13312
ds_read_b64_tr_b16 a[216:217], v1 offset:12320
ds_read_b64_tr_b16 a[218:219], v1 offset:13344
ds_read_b64_tr_b16 a[92:93], v1 offset:14336
ds_read_b64_tr_b16 a[94:95], v1 offset:15360
ds_read_b64_tr_b16 a[220:221], v1 offset:14368
ds_read_b64_tr_b16 a[222:223], v1 offset:15392
s_waitcnt lgkmcnt(0)
s_waitcnt vmcnt(8)
ds_read_b64_tr_b16 a[96:97], v1 offset:16384
ds_read_b64_tr_b16 a[98:99], v1 offset:17408
ds_read_b64_tr_b16 a[224:225], v1 offset:16416
ds_read_b64_tr_b16 a[226:227], v1 offset:17440
ds_read_b64_tr_b16 a[100:101], v1 offset:18432
ds_read_b64_tr_b16 a[102:103], v1 offset:19456
ds_read_b64_tr_b16 a[228:229], v1 offset:18464
ds_read_b64_tr_b16 a[230:231], v1 offset:19488
ds_read_b64_tr_b16 a[104:105], v1 offset:20480
ds_read_b64_tr_b16 a[106:107], v1 offset:21504
ds_read_b64_tr_b16 a[232:233], v1 offset:20512
ds_read_b64_tr_b16 a[234:235], v1 offset:21536
ds_read_b64_tr_b16 a[108:109], v1 offset:22528
ds_read_b64_tr_b16 a[110:111], v1 offset:23552
ds_read_b64_tr_b16 a[236:237], v1 offset:22560
ds_read_b64_tr_b16 a[238:239], v1 offset:23584
s_waitcnt lgkmcnt(0)
s_waitcnt vmcnt(0)
ds_read_b64_tr_b16 a[112:113], v1 offset:24576
ds_read_b64_tr_b16 a[114:115], v1 offset:25600
ds_read_b64_tr_b16 a[240:241], v1 offset:24608
ds_read_b64_tr_b16 a[242:243], v1 offset:25632
ds_read_b64_tr_b16 a[116:117], v1 offset:26624
ds_read_b64_tr_b16 a[118:119], v1 offset:27648
ds_read_b64_tr_b16 a[244:245], v1 offset:26656
ds_read_b64_tr_b16 a[246:247], v1 offset:27680
ds_read_b64_tr_b16 a[120:121], v1 offset:28672
ds_read_b64_tr_b16 a[122:123], v1 offset:29696
ds_read_b64_tr_b16 a[248:249], v1 offset:28704
ds_read_b64_tr_b16 a[250:251], v1 offset:29728
ds_read_b64_tr_b16 a[124:125], v1 offset:30720
ds_read_b64_tr_b16 a[126:127], v1 offset:31744
ds_read_b64_tr_b16 a[252:253], v1 offset:30752
ds_read_b64_tr_b16 a[254:255], v1 offset:31776
s_waitcnt lgkmcnt(0)
s_cmp_lt_u32 s12, 5
s_cbranch_scc1 main_kernel_o_top
v_mul_u32_u24 v178, 2, v173
v_sub_u32 v171, v172, v178
main_kernel_o_gp:
buffer_load_dword v174, v171, s[4:7], 0 offen sc1
s_waitcnt vmcnt(0)
v_cmp_eq_u32 vcc, 0, v174
s_cbranch_vccz main_kernel_o_top
s_sleep 32
s_sub_u32 s29, s29, 1
s_cbranch_scc0 main_kernel_o_gp
s_branch main_kernel_end
main_kernel_o_top:
buffer_load_dword v174, v172, s[4:7], 0 offen sc1
s_waitcnt vmcnt(0)
v_cmp_eq_u32 vcc, 0, v174
s_cbranch_vccz main_kernel_o_go
s_sleep 1
s_sub_u32 s29, s29, 1
s_cbranch_scc0 main_kernel_o_top
s_branch main_kernel_end
main_kernel_o_go:
buffer_load_dwordx4 v[0:3], v170, s[4:7], s15 offen offset:0 sc1
buffer_load_dwordx4 v[4:7], v170, s[4:7], s15 offen offset:1024 sc1
buffer_load_dwordx4 v[8:11], v170, s[4:7], s15 offen offset:2048 sc1
buffer_load_dwordx4 v[12:15], v170, s[4:7], s15 offen offset:3072 sc1
s_add_u32 s15, s15, 4096
buffer_load_dwordx4 v[16:19], v170, s[4:7], s15 offen offset:0 sc1
buffer_load_dwordx4 v[20:23], v170, s[4:7], s15 offen offset:1024 sc1
buffer_load_dwordx4 v[24:27], v170, s[4:7], s15 offen offset:2048 sc1
buffer_load_dwordx4 v[28:31], v170, s[4:7], s15 offen offset:3072 sc1
s_add_u32 s15, s15, 4096
buffer_load_dwordx4 v[32:35], v170, s[4:7], s15 offen offset:0 sc1
buffer_load_dwordx4 v[36:39], v170, s[4:7], s15 offen offset:1024 sc1
buffer_load_dwordx4 v[40:43], v170, s[4:7], s15 offen offset:2048 sc1
buffer_load_dwordx4 v[44:47], v170, s[4:7], s15 offen offset:3072 sc1
s_add_u32 s15, s15, 4096
buffer_load_dwordx4 v[48:51], v170, s[4:7], s15 offen offset:0 sc1
buffer_load_dwordx4 v[52:55], v170, s[4:7], s15 offen offset:1024 sc1
buffer_load_dwordx4 v[56:59], v170, s[4:7], s15 offen offset:2048 sc1
buffer_load_dwordx4 v[60:63], v170, s[4:7], s15 offen offset:3072 sc1
s_add_u32 s15, s15, 4096
buffer_load_dwordx2 v[160:161], v175, s[96:99], s16 offen
buffer_load_dwordx2 v[162:163], v170, s[4:7], s17 offen sc1
buffer_load_dwordx4 v[64:67], v170, s[4:7], s15 offen offset:0 sc1
buffer_load_dwordx4 v[68:71], v170, s[4:7], s15 offen offset:1024 sc1
buffer_load_dwordx4 v[72:75], v170, s[4:7], s15 offen offset:2048 sc1
buffer_load_dwordx4 v[76:79], v170, s[4:7], s15 offen offset:3072 sc1
s_add_u32 s15, s15, 4096
buffer_load_dwordx4 v[80:83], v170, s[4:7], s15 offen offset:0 sc1
buffer_load_dwordx4 v[84:87], v170, s[4:7], s15 offen offset:1024 sc1
buffer_load_dwordx4 v[88:91], v170, s[4:7], s15 offen offset:2048 sc1
buffer_load_dwordx4 v[92:95], v170, s[4:7], s15 offen offset:3072 sc1
s_add_u32 s15, s15, 4096
buffer_load_dwordx4 v[96:99], v170, s[4:7], s15 offen offset:0 sc1
buffer_load_dwordx4 v[100:103], v170, s[4:7], s15 offen offset:1024 sc1
buffer_load_dwordx4 v[104:107], v170, s[4:7], s15 offen offset:2048 sc1
buffer_load_dwordx4 v[108:111], v170, s[4:7], s15 offen offset:3072 sc1
s_add_u32 s15, s15, 4096
buffer_load_dwordx4 v[112:115], v170, s[4:7], s15 offen offset:0 sc1
buffer_load_dwordx4 v[116:119], v170, s[4:7], s15 offen offset:1024 sc1
buffer_load_dwordx4 v[120:123], v170, s[4:7], s15 offen offset:2048 sc1
buffer_load_dwordx4 v[124:127], v170, s[4:7], s15 offen offset:3072 sc1
s_add_u32 s15, s15, 233472
v_add_u32 v172, v172, v173
s_add_u32 s17, s17, 65536
s_add_u32 s18, s18, 1
s_waitcnt vmcnt(33)
v_mfma_f32_16x16x32_bf16 v[128:131], a[0:3], v[0:3], 0
v_mfma_f32_16x16x32_bf16 v[132:135], a[128:131], v[0:3], 0
s_waitcnt vmcnt(32)
v_mfma_f32_16x16x32_bf16 v[128:131], a[4:7], v[4:7], v[128:131]
v_mfma_f32_16x16x32_bf16 v[132:135], a[132:135], v[4:7], v[132:135]
s_waitcnt vmcnt(31)
v_mfma_f32_16x16x32_bf16 v[128:131], a[8:11], v[8:11], v[128:131]
v_mfma_f32_16x16x32_bf16 v[132:135], a[136:139], v[8:11], v[132:135]
s_waitcnt vmcnt(30)
v_mfma_f32_16x16x32_bf16 v[128:131], a[12:15], v[12:15], v[128:131]
v_mfma_f32_16x16x32_bf16 v[132:135], a[140:143], v[12:15], v[132:135]
s_waitcnt vmcnt(29)
v_mfma_f32_16x16x32_bf16 v[128:131], a[16:19], v[16:19], v[128:131]
v_mfma_f32_16x16x32_bf16 v[132:135], a[144:147], v[16:19], v[132:135]
s_waitcnt vmcnt(28)
v_mfma_f32_16x16x32_bf16 v[128:131], a[20:23], v[20:23], v[128:131]
v_mfma_f32_16x16x32_bf16 v[132:135], a[148:151], v[20:23], v[132:135]
s_waitcnt vmcnt(27)
v_mfma_f32_16x16x32_bf16 v[128:131], a[24:27], v[24:27], v[128:131]
v_mfma_f32_16x16x32_bf16 v[132:135], a[152:155], v[24:27], v[132:135]
s_waitcnt vmcnt(26)
v_mfma_f32_16x16x32_bf16 v[128:131], a[28:31], v[28:31], v[128:131]
v_mfma_f32_16x16x32_bf16 v[132:135], a[156:159], v[28:31], v[132:135]
s_waitcnt vmcnt(25)
v_mfma_f32_16x16x32_bf16 v[128:131], a[32:35], v[32:35], v[128:131]
v_mfma_f32_16x16x32_bf16 v[132:135], a[160:163], v[32:35], v[132:135]
s_waitcnt vmcnt(24)
v_mfma_f32_16x16x32_bf16 v[128:131], a[36:39], v[36:39], v[128:131]
v_mfma_f32_16x16x32_bf16 v[132:135], a[164:167], v[36:39], v[132:135]
s_waitcnt vmcnt(23)
v_mfma_f32_16x16x32_bf16 v[128:131], a[40:43], v[40:43], v[128:131]
v_mfma_f32_16x16x32_bf16 v[132:135], a[168:171], v[40:43], v[132:135]
s_waitcnt vmcnt(22)
v_mfma_f32_16x16x32_bf16 v[128:131], a[44:47], v[44:47], v[128:131]
v_mfma_f32_16x16x32_bf16 v[132:135], a[172:175], v[44:47], v[132:135]
s_waitcnt vmcnt(21)
v_mfma_f32_16x16x32_bf16 v[128:131], a[48:51], v[48:51], v[128:131]
v_mfma_f32_16x16x32_bf16 v[132:135], a[176:179], v[48:51], v[132:135]
s_waitcnt vmcnt(20)
v_mfma_f32_16x16x32_bf16 v[128:131], a[52:55], v[52:55], v[128:131]
v_mfma_f32_16x16x32_bf16 v[132:135], a[180:183], v[52:55], v[132:135]
s_waitcnt vmcnt(19)
v_mfma_f32_16x16x32_bf16 v[128:131], a[56:59], v[56:59], v[128:131]
v_mfma_f32_16x16x32_bf16 v[132:135], a[184:187], v[56:59], v[132:135]
s_waitcnt vmcnt(18)
v_mfma_f32_16x16x32_bf16 v[128:131], a[60:63], v[60:63], v[128:131]
v_mfma_f32_16x16x32_bf16 v[132:135], a[188:191], v[60:63], v[132:135]
s_waitcnt vmcnt(15)
v_mfma_f32_16x16x32_bf16 v[128:131], a[64:67], v[64:67], v[128:131]
v_mfma_f32_16x16x32_bf16 v[132:135], a[192:195], v[64:67], v[132:135]
s_waitcnt vmcnt(14)
v_mfma_f32_16x16x32_bf16 v[128:131], a[68:71], v[68:71], v[128:131]
v_mfma_f32_16x16x32_bf16 v[132:135], a[196:199], v[68:71], v[132:135]
s_waitcnt vmcnt(13)
v_mfma_f32_16x16x32_bf16 v[128:131], a[72:75], v[72:75], v[128:131]
v_mfma_f32_16x16x32_bf16 v[132:135], a[200:203], v[72:75], v[132:135]
s_waitcnt vmcnt(12)
v_mfma_f32_16x16x32_bf16 v[128:131], a[76:79], v[76:79], v[128:131]
v_mfma_f32_16x16x32_bf16 v[132:135], a[204:207], v[76:79], v[132:135]
s_waitcnt vmcnt(11)
v_mfma_f32_16x16x32_bf16 v[128:131], a[80:83], v[80:83], v[128:131]
v_mfma_f32_16x16x32_bf16 v[132:135], a[208:211], v[80:83], v[132:135]
v_lshlrev_b32 v164, 16, v160
v_and_b32 v165, 0xffff0000, v160
v_lshlrev_b32 v166, 16, v161
v_and_b32 v167, 0xffff0000, v161
v_lshlrev_b32 v160, 16, v162
v_and_b32 v161, 0xffff0000, v162
v_lshlrev_b32 v162, 16, v163
v_and_b32 v163, 0xffff0000, v163
s_waitcnt vmcnt(10)
v_mfma_f32_16x16x32_bf16 v[128:131], a[84:87], v[84:87], v[128:131]
v_mfma_f32_16x16x32_bf16 v[132:135], a[212:215], v[84:87], v[132:135]
s_waitcnt vmcnt(9)
v_mfma_f32_16x16x32_bf16 v[128:131], a[88:91], v[88:91], v[128:131]
v_mfma_f32_16x16x32_bf16 v[132:135], a[216:219], v[88:91], v[132:135]
s_waitcnt vmcnt(8)
v_mfma_f32_16x16x32_bf16 v[128:131], a[92:95], v[92:95], v[128:131]
v_mfma_f32_16x16x32_bf16 v[132:135], a[220:223], v[92:95], v[132:135]
s_waitcnt vmcnt(7)
v_mfma_f32_16x16x32_bf16 v[128:131], a[96:99], v[96:99], v[128:131]
v_mfma_f32_16x16x32_bf16 v[132:135], a[224:227], v[96:99], v[132:135]
s_waitcnt vmcnt(6)
v_mfma_f32_16x16x32_bf16 v[128:131], a[100:103], v[100:103], v[128:131]
v_mfma_f32_16x16x32_bf16 v[132:135], a[228:231], v[100:103], v[132:135]
s_waitcnt vmcnt(5)
v_mfma_f32_16x16x32_bf16 v[128:131], a[104:107], v[104:107], v[128:131]
v_mfma_f32_16x16x32_bf16 v[132:135], a[232:235], v[104:107], v[132:135]
s_waitcnt vmcnt(4)
v_mfma_f32_16x16x32_bf16 v[128:131], a[108:111], v[108:111], v[128:131]
v_mfma_f32_16x16x32_bf16 v[132:135], a[236:239], v[108:111], v[132:135]
s_waitcnt vmcnt(3)
v_mfma_f32_16x16x32_bf16 v[128:131], a[112:115], v[112:115], v[128:131]
v_mfma_f32_16x16x32_bf16 v[132:135], a[240:243], v[112:115], v[132:135]
s_waitcnt vmcnt(2)
v_mfma_f32_16x16x32_bf16 v[128:131], a[116:119], v[116:119], v[128:131]
v_mfma_f32_16x16x32_bf16 v[132:135], a[244:247], v[116:119], v[132:135]
s_waitcnt vmcnt(1)
v_mfma_f32_16x16x32_bf16 v[128:131], a[120:123], v[120:123], v[128:131]
v_mfma_f32_16x16x32_bf16 v[132:135], a[248:251], v[120:123], v[132:135]
s_waitcnt vmcnt(0)
v_mfma_f32_16x16x32_bf16 v[128:131], a[124:127], v[124:127], v[128:131]
v_mfma_f32_16x16x32_bf16 v[132:135], a[252:255], v[124:127], v[132:135]
s_cmp_ge_u32 s14, 2
s_nop 5
ds_write_b128 v176, v[128:131] offset:0
ds_write_b128 v176, v[132:135] offset:1024
v_xor_b32 v176, 0x4000, v176
s_waitcnt lgkmcnt(0)
s_barrier
s_cbranch_scc1 main_kernel_o_nx
ds_read_b128 v[144:147], v177 offset:0
ds_read_b128 v[148:151], v177 offset:2048
ds_read_b128 v[152:155], v177 offset:4096
ds_read_b128 v[156:159], v177 offset:6144
v_xor_b32 v177, 0x4000, v177
s_waitcnt lgkmcnt(2)
v_pk_add_f32 v[144:145], v[144:145], v[148:149]
v_pk_add_f32 v[146:147], v[146:147], v[150:151]
s_waitcnt lgkmcnt(0)
v_pk_add_f32 v[152:153], v[152:153], v[156:157]
v_pk_add_f32 v[154:155], v[154:155], v[158:159]
v_pk_add_f32 v[144:145], v[144:145], v[152:153]
v_pk_add_f32 v[146:147], v[146:147], v[154:155]
v_pk_fma_f32 v[144:145], v[144:145], v[160:161], v[164:165]
v_pk_fma_f32 v[146:147], v[146:147], v[162:163], v[166:167]
v_cvt_pk_bf16_f32 v148, v144, v145
v_cvt_pk_bf16_f32 v149, v146, v147
buffer_store_dwordx2 v[148:149], v175, s[92:95], s16 offen
main_kernel_o_nx:
s_add_u32 s16, s16, 65536
s_cmp_le_u32 s18, 62
s_cbranch_scc1 main_kernel_o_top
v_add_u32 v172, v172, v173
s_add_u32 s17, s17, 65536
s_add_u32 s16, s16, 65536
s_add_u32 s15, s15, 262144
s_add_u32 s18, s18, 1
s_cmp_lt_u32 s18, 64
s_cbranch_scc1 main_kernel_o_top
s_branch main_kernel_end
main_kernel_end2:
s_endpgm
main_kernel_worker:
v_lshlrev_b32 v251, 4, v250
v_mov_b32 v240, 0xc0135761
v_mov_b32 v241, 0xc0135761
v_mov_b32 v242, 0xbdd2d3e8
v_mov_b32 v243, 0xbdd2d3e8
v_mov_b32 v244, 0x3f800000
v_mov_b32 v245, 0x3f800000
v_mov_b32 v246, 0xbfb8aa3b
v_mov_b32 v247, 0xbfb8aa3b
s_lshr_b32 s37, s14, 1
s_and_b32 s38, s14, 1
v_mov_b32 v252, 0
v_mov_b32 v224, 0
v_mov_b32 v225, 0
v_mov_b32 v226, 0
v_mov_b32 v227, 0
v_mov_b32 v228, 0
v_mov_b32 v229, 0
v_mov_b32 v230, 0
v_mov_b32 v231, 0
v_mov_b32 v232, 0
v_mov_b32 v233, 0
v_mov_b32 v234, 0
v_mov_b32 v235, 0
v_mov_b32 v249, 0
v_mov_b32 v248, 0
v_mov_b32 v128, 0
v_mov_b32 v129, 0
v_mov_b32 v130, 0
v_mov_b32 v131, 0
v_mov_b32 v132, 0
v_mov_b32 v133, 0
v_mov_b32 v134, 0
v_mov_b32 v135, 0
v_mov_b32 v136, 0
v_mov_b32 v137, 0
v_mov_b32 v138, 0
v_mov_b32 v139, 0
v_mov_b32 v140, 0
v_mov_b32 v141, 0
v_mov_b32 v142, 0
v_mov_b32 v143, 0
v_mov_b32 v144, 0
v_mov_b32 v145, 0
v_mov_b32 v146, 0
v_mov_b32 v147, 0
v_mov_b32 v148, 0
v_mov_b32 v149, 0
v_mov_b32 v150, 0
v_mov_b32 v151, 0
v_mov_b32 v152, 0
v_mov_b32 v153, 0
v_mov_b32 v154, 0
s_cmp_eq_u32 s14, 0
s_cselect_b64 s[100:101], -1, 0
s_mov_b32 s21, 0
s_mov_b32 s22, 0
s_mov_b32 s26, 0
s_mov_b32 s0, 0
s_mov_b32 s1, 0
s_mov_b32 s2, 0
s_mov_b32 s3, 0
s_mov_b32 s59, 0
s_mov_b32 s60, 0
s_mov_b32 s39, 0
s_mov_b32 s8, s40
s_and_b32 s9, s41, 0xffff
s_mov_b32 s10, 0x0
s_mov_b32 s11, 0x20000
s_cmp_lg_u32 s14, 0
s_cbranch_scc1 main_kernel_w_bar
main_kernel_w_selq:
s_lshl_b32 s32, s27, 8
s_add_u32 s32, s32, 0x841e000
s_mov_b64 exec, 1
v_mov_b32 v249, 1
buffer_atomic_add v249, off, s[4:7], s32 sc0 sc1
s_mov_b64 exec, -1
v_mov_b32 v230, 0x7fff
s_cmp_lg_u32 s27, 0
s_cbranch_scc1 main_kernel_w_q1
s_mov_b32 s32, 0x45800
v_writelane_b32 v230, s32, 0
s_mov_b32 s32, 0x6580e
v_writelane_b32 v230, s32, 1
s_mov_b32 s32, 0x404501c
v_writelane_b32 v230, s32, 2
s_mov_b32 s32, 0x49088024
v_writelane_b32 v230, s32, 3
s_mov_b32 s32, 0x49088834
v_writelane_b32 v230, s32, 4
s_mov_b32 s32, 0x48088044
v_writelane_b32 v230, s32, 5
s_mov_b32 s32, 0x40c2054
v_writelane_b32 v230, s32, 6
s_mov_b32 s32, 0x4102064
v_writelane_b32 v230, s32, 7
s_mov_b32 s32, 0x4182074
v_writelane_b32 v230, s32, 8
s_mov_b32 s32, 0x8082884
v_writelane_b32 v230, s32, 9
s_mov_b32 s32, 0x49108094
v_writelane_b32 v230, s32, 10
s_mov_b32 s32, 0x4a00b0a4
v_writelane_b32 v230, s32, 11
s_mov_b32 s32, 0x4a08b0b0
v_writelane_b32 v230, s32, 12
s_mov_b32 s32, 0x4800b0bc
v_writelane_b32 v230, s32, 13
s_mov_b32 s32, 0x4918b0cc
v_writelane_b32 v230, s32, 14
s_mov_b32 s32, 0x4a1888dc
v_writelane_b32 v230, s32, 15
s_mov_b32 s32, 0x81850ec
v_writelane_b32 v230, s32, 16
s_mov_b32 s32, 0x40838fc
v_writelane_b32 v230, s32, 17
s_mov_b32 s32, 0x4918910c
v_writelane_b32 v230, s32, 18
s_mov_b32 s32, 0x410391c
v_writelane_b32 v230, s32, 19
s_mov_b32 s32, 0x414392c
v_writelane_b32 v230, s32, 20
s_mov_b32 s32, 0x4b18813c
v_writelane_b32 v230, s32, 21
s_mov_b32 s32, 0x41c394c
v_writelane_b32 v230, s32, 22
s_mov_b32 s32, 0x795c
v_writelane_b32 v230, s32, 23
s_branch main_kernel_w_qe
main_kernel_w_q1:
s_cmp_lg_u32 s27, 1
s_cbranch_scc1 main_kernel_w_q2
s_mov_b32 s32, 0x25000
v_writelane_b32 v230, s32, 0
s_mov_b32 s32, 0x40069004
v_writelane_b32 v230, s32, 1
s_mov_b32 s32, 0x4206880c
v_writelane_b32 v230, s32, 2
s_mov_b32 s32, 0x7814
v_writelane_b32 v230, s32, 3
s_branch main_kernel_w_qe
main_kernel_w_q2:
s_cmp_lg_u32 s27, 2
s_cbranch_scc1 main_kernel_w_q3
s_mov_b32 s32, 0x800
v_writelane_b32 v230, s32, 0
s_mov_b32 s32, 0x1008
v_writelane_b32 v230, s32, 1
s_mov_b32 s32, 0x44028810
v_writelane_b32 v230, s32, 2
s_mov_b32 s32, 0x44029018
v_writelane_b32 v230, s32, 3
s_mov_b32 s32, 0x48109820
v_writelane_b32 v230, s32, 4
s_mov_b32 s32, 0x46008030
v_writelane_b32 v230, s32, 5
s_mov_b32 s32, 0x46048040
v_writelane_b32 v230, s32, 6
s_mov_b32 s32, 0x4a088850
v_writelane_b32 v230, s32, 7
s_mov_b32 s32, 0x48088860
v_writelane_b32 v230, s32, 8
s_mov_b32 s32, 0x4b109070
v_writelane_b32 v230, s32, 9
s_mov_b32 s32, 0x41c2080
v_writelane_b32 v230, s32, 10
s_mov_b32 s32, 0x4b108890
v_writelane_b32 v230, s32, 11
s_mov_b32 s32, 0x81050a0
v_writelane_b32 v230, s32, 12
s_mov_b32 s32, 0x4a1088b0
v_writelane_b32 v230, s32, 13
s_mov_b32 s32, 0x491088c0
v_writelane_b32 v230, s32, 14
s_mov_b32 s32, 0x481088d0
v_writelane_b32 v230, s32, 15
s_mov_b32 s32, 0x4908b0e0
v_writelane_b32 v230, s32, 16
s_mov_b32 s32, 0x4a1080f0
v_writelane_b32 v230, s32, 17
s_mov_b32 s32, 0x4ac0b100
v_writelane_b32 v230, s32, 18
s_mov_b32 s32, 0x4810b10c
v_writelane_b32 v230, s32, 19
s_mov_b32 s32, 0x4818b11c
v_writelane_b32 v230, s32, 20
s_mov_b32 s32, 0x4818892c
v_writelane_b32 v230, s32, 21
s_mov_b32 s32, 0x40c393c
v_writelane_b32 v230, s32, 22
s_mov_b32 s32, 0x404394c
v_writelane_b32 v230, s32, 23
s_mov_b32 s32, 0x4b18895c
v_writelane_b32 v230, s32, 24
s_mov_b32 s32, 0x796c
v_writelane_b32 v230, s32, 25
s_branch main_kernel_w_qe
main_kernel_w_q3:
s_cmp_lg_u32 s27, 3
s_cbranch_scc1 main_kernel_w_q4
s_mov_b32 s32, 0x1000800
v_writelane_b32 v230, s32, 0
s_mov_b32 s32, 0x1001008
v_writelane_b32 v230, s32, 1
s_mov_b32 s32, 0x45028810
v_writelane_b32 v230, s32, 2
s_mov_b32 s32, 0x45029018
v_writelane_b32 v230, s32, 3
s_mov_b32 s32, 0x48009820
v_writelane_b32 v230, s32, 4
s_mov_b32 s32, 0x44048030
v_writelane_b32 v230, s32, 5
s_mov_b32 s32, 0x4a089040
v_writelane_b32 v230, s32, 6
s_mov_b32 s32, 0x4b089050
v_writelane_b32 v230, s32, 7
s_mov_b32 s32, 0x4142060
v_writelane_b32 v230, s32, 8
s_mov_b32 s32, 0x4002070
v_writelane_b32 v230, s32, 9
s_mov_b32 s32, 0x4a109080
v_writelane_b32 v230, s32, 10
s_mov_b32 s32, 0x8102890
v_writelane_b32 v230, s32, 11
s_mov_b32 s32, 0x81828a0
v_writelane_b32 v230, s32, 12
s_mov_b32 s32, 0x4ac8b0b0
v_writelane_b32 v230, s32, 13
s_mov_b32 s32, 0x4910b0bc
v_writelane_b32 v230, s32, 14
s_mov_b32 s32, 0x4a10b0cc
v_writelane_b32 v230, s32, 15
s_mov_b32 s32, 0x4ad0b0d8
v_writelane_b32 v230, s32, 16
s_mov_b32 s32, 0x4ad8b0e4
v_writelane_b32 v230, s32, 17
s_mov_b32 s32, 0x4b1890f0
v_writelane_b32 v230, s32, 18
s_mov_b32 s32, 0x4a189100
v_writelane_b32 v230, s32, 19
s_mov_b32 s32, 0x48188110
v_writelane_b32 v230, s32, 20
s_mov_b32 s32, 0x4a188120
v_writelane_b32 v230, s32, 21
s_mov_b32 s32, 0x64130
v_writelane_b32 v230, s32, 22
s_mov_b32 s32, 0xe4138
v_writelane_b32 v230, s32, 23
s_mov_b32 s32, 0x44140
v_writelane_b32 v230, s32, 24
s_mov_b32 s32, 0x4148
v_writelane_b32 v230, s32, 25
s_mov_b32 s32, 0xa4150
v_writelane_b32 v230, s32, 26
s_mov_b32 s32, 0x84158
v_writelane_b32 v230, s32, 27
s_mov_b32 s32, 0x7960
v_writelane_b32 v230, s32, 28
s_branch main_kernel_w_qe
main_kernel_w_q4:
s_cmp_lg_u32 s27, 4
s_cbranch_scc1 main_kernel_w_q5
s_mov_b32 s32, 0x2000800
v_writelane_b32 v230, s32, 0
s_mov_b32 s32, 0x2001008
v_writelane_b32 v230, s32, 1
s_mov_b32 s32, 0x46028810
v_writelane_b32 v230, s32, 2
s_mov_b32 s32, 0x46029018
v_writelane_b32 v230, s32, 3
s_mov_b32 s32, 0x48089820
v_writelane_b32 v230, s32, 4
s_mov_b32 s32, 0x40068830
v_writelane_b32 v230, s32, 5
s_mov_b32 s32, 0x42069038
v_writelane_b32 v230, s32, 6
s_mov_b32 s32, 0x4b088840
v_writelane_b32 v230, s32, 7
s_mov_b32 s32, 0x49089050
v_writelane_b32 v230, s32, 8
s_mov_b32 s32, 0x4b088060
v_writelane_b32 v230, s32, 9
s_mov_b32 s32, 0x4a088070
v_writelane_b32 v230, s32, 10
s_mov_b32 s32, 0x49188880
v_writelane_b32 v230, s32, 11
s_mov_b32 s32, 0x8002890
v_writelane_b32 v230, s32, 12
s_mov_b32 s32, 0x4808b0a0
v_writelane_b32 v230, s32, 13
s_mov_b32 s32, 0x4900b0b0
v_writelane_b32 v230, s32, 14
s_mov_b32 s32, 0x481890c0
v_writelane_b32 v230, s32, 15
s_mov_b32 s32, 0x491880d0
v_writelane_b32 v230, s32, 16
s_mov_b32 s32, 0x40038e0
v_writelane_b32 v230, s32, 17
s_mov_b32 s32, 0x41838f0
v_writelane_b32 v230, s32, 18
s_mov_b32 s32, 0x124100
v_writelane_b32 v230, s32, 19
s_mov_b32 s32, 0x104108
v_writelane_b32 v230, s32, 20
s_mov_b32 s32, 0x24110
v_writelane_b32 v230, s32, 21
s_mov_b32 s32, 0xc4118
v_writelane_b32 v230, s32, 22
s_mov_b32 s32, 0x144120
v_writelane_b32 v230, s32, 23
s_mov_b32 s32, 0x7928
v_writelane_b32 v230, s32, 24
s_branch main_kernel_w_qe
main_kernel_w_q5:
s_mov_b32 s32, 0x3000800
v_writelane_b32 v230, s32, 0
s_mov_b32 s32, 0x3001008
v_writelane_b32 v230, s32, 1
s_mov_b32 s32, 0x47028810
v_writelane_b32 v230, s32, 2
s_mov_b32 s32, 0x47029018
v_writelane_b32 v230, s32, 3
s_mov_b32 s32, 0x8085020
v_writelane_b32 v230, s32, 4
s_mov_b32 s32, 0x48189830
v_writelane_b32 v230, s32, 5
s_mov_b32 s32, 0x44008040
v_writelane_b32 v230, s32, 6
s_mov_b32 s32, 0x48089050
v_writelane_b32 v230, s32, 7
s_mov_b32 s32, 0x4082060
v_writelane_b32 v230, s32, 8
s_mov_b32 s32, 0x4042070
v_writelane_b32 v230, s32, 9
s_mov_b32 s32, 0x48108080
v_writelane_b32 v230, s32, 10
s_mov_b32 s32, 0x49109090
v_writelane_b32 v230, s32, 11
s_mov_b32 s32, 0x481090a0
v_writelane_b32 v230, s32, 12
s_mov_b32 s32, 0x4b1080b0
v_writelane_b32 v230, s32, 13
s_mov_b32 s32, 0x4a18b0c0
v_writelane_b32 v230, s32, 14
s_mov_b32 s32, 0x78cc
v_writelane_b32 v230, s32, 15
main_kernel_w_qe:
v_and_b32 v229, 0x7ff, v230
main_kernel_w_dec:
s_waitcnt vmcnt(0)
v_readfirstlane_b32 s28, v249
s_nop 1
v_cmp_ge_u32 vcc, s28, v229
s_nop 1
s_bcnt1_i32_b64 s32, vcc
s_sub_u32 s32, s32, 1
v_readlane_b32 s36, v230, s32
s_nop 1
s_and_b32 s32, s36, 0x7ff
s_sub_u32 s28, s28, s32
s_bfe_u32 s32, s36, 0x3001a
s_lshr_b32 s25, s28, s32
s_lshl_b32 s33, s25, s32
s_sub_u32 s24, s28, s33
s_bfe_u32 s34, s36, 0x1001d
s_lshl_b32 s24, s24, s34
s_bfe_u32 s35, s36, 0x1001e
s_lshl_b32 s25, s25, s35
s_bfe_u32 s32, s36, 0x40011
s_add_u32 s24, s24, s32
s_bfe_u32 s32, s36, 0x50015
s_add_u32 s25, s25, s32
s_bfe_u32 s23, s36, 0x4000b
s_bfe_u32 s36, s36, 0x6000b
s_lshl_b32 s32, s24, 8
s_or_b32 s36, s36, s32
s_lshl_b32 s32, s25, 16
s_or_b32 s36, s36, s32
s_cmp_eq_u32 s23, 4
s_cselect_b32 s32, 1, 0
s_sub_u32 s48, s24, s32
s_max_i32 s48, s48, 0
s_add_u32 s49, s24, s34
s_add_u32 s49, s49, s32
s_min_u32 s49, s49, 15
s_cmp_eq_u32 s23, 6
s_cselect_b32 s51, 3, 7
s_cmp_eq_u32 s23, 7
s_cselect_b32 s51, 27, s51
s_cselect_b32 s50, 5, 4
s_add_u32 s33, s25, s35
s_lshl_b32 s34, s24, 9
s_cmp_eq_u32 s23, 8
s_cselect_b32 s51, 0, s51
s_cselect_b32 s48, s25, s48
s_cselect_b32 s49, s33, s49
s_cmp_eq_u32 s23, 8
s_cselect_b32 s63, 2, 9
s_cselect_b32 s61, 0, 0x7f000000
s_cselect_b32 s34, s34, 0
v_lshrrev_b32 v228, s50, v250
v_lshlrev_b32 v254, s50, v228
v_sub_u32 v254, v250, v254
s_cmp_lt_u32 s23, 4
s_cselect_b32 s39, 10, s23
v_min_u32 v254, s51, v254
s_lshl_b32 s39, s39, 13
s_cmp_eq_u32 s23, 3
s_cselect_b32 s34, 4, s34
v_add_u32 v228, s48, v228
s_add_u32 s39, s39, s34
s_add_u32 s39, s39, 0x8402000
v_min_u32 v228, s49, v228
s_lshl_b32 s60, s24, 10
s_add_u32 s60, s60, 0x8400000
v_lshlrev_b32 v228, s63, v228
v_lshl_add_u32 v228, v254, 4, v228
v_or_b32 v146, s61, v251
main_kernel_w_chk:
s_and_b32 s23, s36, 15
s_cmp_lg_u32 s23, 15
s_cbranch_scc1 main_kernel_w_got
s_add_u32 s27, s27, 1
s_cmp_ge_u32 s27, 6
s_cselect_b32 s27, 0, s27
s_add_u32 s52, s52, 1
s_mov_b32 s36, -1
s_lshl_b32 s32, 1, s12
s_and_b32 s32, s32, 116
s_cselect_b32 s36, -2, -1
s_cbranch_scc1 main_kernel_w_pub
s_cmp_lt_u32 s52, 6
s_cbranch_scc1 main_kernel_w_selq
s_lshl_b32 s32, s12, 5
s_add_u32 s32, s32, s13
s_sub_u32 s32, s32, 160
s_cmp_lt_u32 s32, 80
s_cselect_b32 s36, -3, -1
s_cmp_lt_u32 s32, 64
s_cselect_b32 s36, -2, s36
s_branch main_kernel_w_pub
main_kernel_w_got:
s_cmp_ge_u32 s23, 10
s_cbranch_scc1 main_kernel_w_pub
main_kernel_w_poll:
buffer_load_dword v231, v228, s[4:7], s39 offen sc1
buffer_load_dwordx4 v[232:235], v146, s[4:7], s60 offen sc1
s_waitcnt vmcnt(0)
v_min3_u32 v253, v232, v233, v234
v_min_u32 v253, v253, v235
v_or_b32 v253, s61, v253
v_min_u32 v253, v253, v231
v_cmp_eq_u32 vcc, 0, v253
s_cbranch_vccz main_kernel_w_pub
s_sleep 8
s_sub_u32 s29, s29, 1
s_cbranch_scc0 main_kernel_w_poll
s_mov_b32 s36, -1
main_kernel_w_pub:
v_mov_b32 v253, 131072
v_mov_b32 v254, s36
ds_write_b32 v253, v254
s_waitcnt lgkmcnt(0)
main_kernel_w_bar:
s_barrier
v_mov_b32 v253, 131072
ds_read_b32 v254, v253
s_mov_b32 s56, 0
s_mov_b32 s73, -1
s_mov_b32 s58, -2
s_waitcnt lgkmcnt(0)
v_readfirstlane_b32 s62, v254
s_nop 3
s_cmp_eq_u32 s62, -1
s_cbranch_scc1 main_kernel_end2
s_cmp_eq_u32 s62, -2
s_cbranch_scc1 main_kernel_wo
s_cmp_eq_u32 s62, -3
s_cbranch_scc1 main_kernel_att2
s_and_b32 s23, s62, 15
s_bfe_u32 s54, s62, 0x20004
s_bfe_u32 s24, s62, 0x80008
s_lshr_b32 s25, s62, 16
s_cmp_eq_u32 s23, 5
s_cbranch_scc1 main_kernel_w_ln2
s_cmp_eq_u32 s23, 10
s_cbranch_scc1 main_kernel_w_fill
s_cmp_eq_u32 s23, 11
s_cbranch_scc1 main_kernel_w_pref
main_kernel_w_gemm:
s_cmp_eq_u32 s54, 1
s_cbranch_scc1 main_kernel_w_c1_task
main_kernel_w_c0_task:
s_cmp_eq_u32 s23, 1
s_cbranch_scc1 main_kernel_w_c0_set1
s_cmp_eq_u32 s23, 2
s_cbranch_scc1 main_kernel_w_c0_set2
s_cmp_eq_u32 s23, 4
s_cbranch_scc1 main_kernel_w_c0_set4
s_cmp_eq_u32 s23, 7
s_cbranch_scc1 main_kernel_w_c0_set7
s_cmp_eq_u32 s23, 8
s_cbranch_scc1 main_kernel_w_c0_set8
s_branch main_kernel_end2
main_kernel_w_c0_set1:
s_mov_b32 s57, 1
s_lshl_b32 s32, s25, 8
s_add_u32 s8, s42, s32
s_addc_u32 s9, s43, 0
s_and_b32 s9, s9, 0xffff
s_sub_u32 s10, 0x800000, s32
s_mov_b32 s11, 0x20000
s_mov_b32 s30, 8192
s_mov_b32 s31, 32768
s_mul_i32 s16, s24, 262144
s_add_u32 s16, s16, 0x0
s_mov_b32 s18, 3
s_lshl_b32 s32, s24, 3
s_mul_i32 s33, s38, 4
s_add_u32 s32, s32, s33
s_mul_i32 s32, s32, 131072
s_lshl_b32 s33, s25, 12
s_add_u32 s32, s32, s33
s_mul_i32 s33, s37, 2048
s_add_u32 s32, s32, s33
s_add_u32 s21, s32, 0x1800000
s_mov_b32 s22, 131072
s_mov_b32 s26, 0x7f000000
s_branch main_kernel_w_c0_go
main_kernel_w_c0_set2:
s_mov_b32 s57, 2
s_lshl_b32 s32, s25, 8
s_add_u32 s8, s44, s32
s_addc_u32 s9, s45, 0
s_and_b32 s9, s9, 0xffff
s_sub_u32 s10, 0x800000, s32
s_mov_b32 s11, 0x20000
s_mov_b32 s30, 8192
s_mov_b32 s31, 32768
s_mul_i32 s16, s24, 262144
s_add_u32 s16, s16, 0x0
s_mov_b32 s18, 3
s_lshl_b32 s32, s24, 2
s_mul_i32 s33, s38, 2
s_add_u32 s32, s32, s33
s_lshl_b32 s32, s32, 18
s_lshl_b32 s33, s25, 13
s_add_u32 s32, s32, s33
s_mul_i32 s33, s37, 4096
s_add_u32 s32, s32, s33
s_add_u32 s21, s32, 0x2800000
s_branch main_kernel_w_c0_gov
main_kernel_w_c0_set4:
s_mov_b32 s57, 3
s_lshl_b32 s32, s25, 8
s_add_u32 s8, s66, s32
s_addc_u32 s9, s67, 0
s_and_b32 s9, s9, 0xffff
s_sub_u32 s10, 0x200000, s32
s_mov_b32 s11, 0x20000
s_mov_b32 s30, 2048
s_mov_b32 s31, 32768
s_mul_i32 s16, s24, 262144
s_add_u32 s16, s16, 0x4808000
s_mov_b32 s18, 3
s_lshl_b32 s32, s24, 3
s_mul_i32 s33, s38, 4
s_add_u32 s32, s32, s33
s_mul_i32 s32, s32, 32768
s_lshl_b32 s33, s25, 12
s_add_u32 s32, s32, s33
s_mul_i32 s33, s37, 2048
s_add_u32 s32, s32, s33
s_add_u32 s21, s32, 0x5000000
s_mov_b32 s22, 32768
s_add_u32 s26, s32, 0x0
s_branch main_kernel_w_c0_go
main_kernel_w_c0_set7:
s_mov_b32 s57, 4
s_lshl_b32 s32, s25, 8
s_add_u32 s8, s70, s32
s_addc_u32 s9, s71, 0
s_and_b32 s9, s9, 0xffff
s_sub_u32 s10, 0x700000, s32
s_mov_b32 s11, 0x20000
s_mov_b32 s30, 2048
s_mov_b32 s31, 114688
s_mul_i32 s16, s24, 917504
s_add_u32 s16, s16, 0x5400000
s_mov_b32 s18, 13
s_lshl_b32 s32, s24, 3
s_mul_i32 s33, s38, 4
s_add_u32 s32, s32, s33
s_mul_i32 s32, s32, 32768
s_lshl_b32 s33, s25, 12
s_add_u32 s32, s32, s33
s_mul_i32 s33, s37, 2048
s_add_u32 s32, s32, s33
s_add_u32 s21, s32, 0x6400000
s_mov_b32 s22, 32768
s_add_u32 s26, s32, 0x5000000
s_branch main_kernel_w_c0_go
main_kernel_w_c0_set8:
s_mov_b32 s57, 5
s_lshl_b32 s32, s25, 8
s_add_u32 s8, s46, s32
s_addc_u32 s9, s47, 0
s_and_b32 s9, s9, 0xffff
s_sub_u32 s10, 0x800000, s32
s_mov_b32 s11, 0x20000
s_mov_b32 s30, 2048
s_mov_b32 s31, 131072
s_mul_i32 s16, s24, 1048576
s_add_u32 s16, s16, 0x3800000
s_mov_b32 s18, 15
s_lshl_b32 s32, s24, 3
s_mul_i32 s33, s38, 4
s_add_u32 s32, s32, s33
s_mul_i32 s32, s32, 32768
s_lshl_b32 s33, s25, 8
s_add_u32 s34, s32, s33
s_mul_i32 s33, s37, 128
s_add_u32 s34, s34, s33
s_lshl_b32 s33, s25, 12
s_add_u32 s32, s32, s33
s_mul_i32 s33, s37, 2048
s_add_u32 s32, s32, s33
s_add_u32 s21, s32, 0x0
s_mov_b32 s22, 32768
s_add_u32 s26, s32, 0x6400000
s_mov_b32 s21, s34
v_and_b32 v253, 15, v250
v_and_b32 v254, 48, v250
v_lshl_add_u32 v252, v253, 11, v254
s_branch main_kernel_w_c0_go
main_kernel_w_c0_str:
s_mul_i32 s32, s14, 2
s_mul_i32 s32, s32, s31
v_mad_u32_u24 v137, v147, s30, v151
v_mad_u32_u24 v138, v148, s30, v152
v_mad_u32_u24 v139, v149, s30, v153
v_mad_u32_u24 v140, v150, s30, v154
v_add_u32 v141, s32, v251
s_add_u32 s32, s32, s31
s_sub_u32 s32, s32, 2048
v_add_u32 v142, s32, v251
s_mul_i32 s17, s30, 64
s_mov_b32 s15, 0
s_mov_b32 s18, 1
s_cmp_eq_u32 s73, 0
s_cbranch_scc1 main_kernel_w_c0_n_mid
s_branch main_kernel_w_c0_v_mid
main_kernel_w_c0_go:
s_mov_b32 s58, 0
s_mov_b32 s72, s18
s_cmp_lg_u32 s73, -1
s_cbranch_scc1 main_kernel_w_c0_str
s_waitcnt lgkmcnt(0)
v_lshrrev_b32 v0, 4, v250
v_bfe_u32 v1, v250, 2, 2
v_lshl_add_u32 v4, v0, 2, v1
v_and_b32 v5, 7, v4
v_mul_u32_u24 v4, 256, v4
v_and_b32 v6, 3, v250
v_lshl_add_u32 v4, v6, 3, v4
s_mul_i32 s32, s37, 4
v_xor_b32 v5, s32, v5
v_lshl_add_u32 v128, v5, 5, v4
v_xor_b32 v129, 32, v128
v_xor_b32 v130, 64, v128
v_xor_b32 v131, 96, v128
s_mul_i32 s32, s38, 8192
s_add_u32 s32, s32, 65536
v_add_u32 v136, s32, v251
v_lshrrev_b32 v2, 4, v250
v_and_b32 v3, 15, v250
s_mul_i32 s32, s14, 16
v_add_u32 v147, s32, v2
v_and_b32 v6, 7, v147
v_lshlrev_b32 v6, 1, v6
v_xor_b32 v6, v6, v3
v_lshlrev_b32 v151, 4, v6
v_add_u32 v148, 4, v147
v_and_b32 v6, 7, v148
v_lshlrev_b32 v6, 1, v6
v_xor_b32 v6, v6, v3
v_lshlrev_b32 v152, 4, v6
v_subrev_u32 v152, 1024, v152
v_add_u32 v149, 8, v147
v_and_b32 v6, 7, v149
v_lshlrev_b32 v6, 1, v6
v_xor_b32 v6, v6, v3
v_lshlrev_b32 v153, 4, v6
v_subrev_u32 v153, 2048, v153
v_add_u32 v150, 12, v147
v_and_b32 v6, 7, v150
v_lshlrev_b32 v6, 1, v6
v_xor_b32 v6, v6, v3
v_lshlrev_b32 v154, 4, v6
v_subrev_u32 v154, 3072, v154
s_mul_i32 s19, s14, 4096
s_mul_i32 s20, s14, 4096
s_add_u32 s20, s20, 65536
s_mul_i32 s32, s14, 2
s_mul_i32 s32, s32, s31
v_mad_u32_u24 v137, v147, s30, v151
v_mad_u32_u24 v138, v148, s30, v152
v_mad_u32_u24 v139, v149, s30, v153
v_mad_u32_u24 v140, v150, s30, v154
v_add_u32 v141, s32, v251
s_add_u32 s32, s32, s31
s_sub_u32 s32, s32, 2048
v_add_u32 v142, s32, v251
s_mul_i32 s17, s30, 64
s_mov_b32 s15, 0
s_waitcnt vmcnt(0)
s_add_u32 m0, s20, 0
s_nop 0
buffer_load_dwordx4 v141, s[4:7], s16 offen offset:0 sc1 lds
buffer_load_dwordx4 v141, s[4:7], s16 offen offset:1024 sc1 lds
buffer_load_dwordx4 v142, s[4:7], s16 offen offset:2048 sc1 lds
buffer_load_dwordx4 v142, s[4:7], s16 offen offset:3072 sc1 lds
s_add_u32 s16, s16, 2048
s_add_u32 m0, s19, 0
s_nop 0
buffer_load_dwordx4 v137, s[8:11], s15 offen offset:0 lds
buffer_load_dwordx4 v138, s[8:11], s15 offen offset:1024 lds
buffer_load_dwordx4 v139, s[8:11], s15 offen offset:2048 lds
buffer_load_dwordx4 v140, s[8:11], s15 offen offset:3072 lds
s_add_u32 s15, s15, s17
s_add_u32 m0, s20, 16384
s_nop 0
buffer_load_dwordx4 v141, s[4:7], s16 offen offset:0 sc1 lds
buffer_load_dwordx4 v141, s[4:7], s16 offen offset:1024 sc1 lds
buffer_load_dwordx4 v142, s[4:7], s16 offen offset:2048 sc1 lds
buffer_load_dwordx4 v142, s[4:7], s16 offen offset:3072 sc1 lds
s_add_u32 s16, s16, 2048
s_add_u32 m0, s19, 16384
s_nop 0
buffer_load_dwordx4 v137, s[8:11], s15 offen offset:0 lds
buffer_load_dwordx4 v138, s[8:11], s15 offen offset:1024 lds
buffer_load_dwordx4 v139, s[8:11], s15 offen offset:2048 lds
buffer_load_dwordx4 v140, s[8:11], s15 offen offset:3072 lds
s_add_u32 s15, s15, s17
s_add_u32 m0, s20, 32768
s_nop 0
buffer_load_dwordx4 v141, s[4:7], s16 offen offset:0 sc1 lds
buffer_load_dwordx4 v141, s[4:7], s16 offen offset:1024 sc1 lds
buffer_load_dwordx4 v142, s[4:7], s16 offen offset:2048 sc1 lds
buffer_load_dwordx4 v142, s[4:7], s16 offen offset:3072 sc1 lds
s_add_u32 s16, s16, 2048
s_add_u32 m0, s19, 32768
s_nop 0
buffer_load_dwordx4 v137, s[8:11], s15 offen offset:0 lds
buffer_load_dwordx4 v138, s[8:11], s15 offen offset:1024 lds
buffer_load_dwordx4 v139, s[8:11], s15 offen offset:2048 lds
buffer_load_dwordx4 v140, s[8:11], s15 offen offset:3072 lds
s_add_u32 s15, s15, s17
s_add_u32 m0, s20, 49152
s_nop 0
buffer_load_dwordx4 v141, s[4:7], s16 offen offset:0 sc1 lds
buffer_load_dwordx4 v141, s[4:7], s16 offen offset:1024 sc1 lds
buffer_load_dwordx4 v142, s[4:7], s16 offen offset:2048 sc1 lds
buffer_load_dwordx4 v142, s[4:7], s16 offen offset:3072 sc1 lds
s_add_u32 s16, s16, 2048
s_cmp_lg_u32 s56, 0
s_cbranch_scc1 main_kernel_w_epi
main_kernel_w_c0_n_ent:
v_mfma_f32_32x32x16_bf16 v[64:79], v[224:227], v[224:227], 0
s_waitcnt vmcnt(20)
s_barrier
ds_read_b128 v[16:19], v136 offset:0
ds_read_b64_tr_b16 v[0:1], v128 offset:0
ds_read_b64_tr_b16 v[2:3], v128 offset:4096
v_mfma_f32_32x32x16_bf16 v[80:95], v[224:227], v[224:227], 0
ds_read_b64_tr_b16 v[4:5], v129 offset:0
ds_read_b64_tr_b16 v[6:7], v129 offset:4096
ds_read_b64_tr_b16 v[8:9], v130 offset:0
v_mfma_f32_32x32x16_bf16 v[96:111], v[224:227], v[224:227], 0
ds_read_b64_tr_b16 v[10:11], v130 offset:4096
ds_read_b64_tr_b16 v[12:13], v131 offset:0
ds_read_b64_tr_b16 v[14:15], v131 offset:4096
v_mfma_f32_32x32x16_bf16 v[112:127], v[224:227], v[224:227], 0
ds_read_b128 v[20:23], v136 offset:2048
ds_read_b128 v[24:27], v136 offset:4096
ds_read_b128 v[28:31], v136 offset:6144
s_sub_u32 s18, s72, 1
s_sub_u32 s55, s72, 2
s_orn2_b32 s55, s55, s100
s_mov_b32 s73, -1
s_nop 0
main_kernel_w_c0_n_loop:
s_waitcnt lgkmcnt(0)
ds_read_b128 v[48:51], v136 offset:1024
s_add_u32 m0, s19, 49152
s_nop 0
v_mfma_f32_16x16x32_bf16 v[64:67], v[0:3], v[16:19], v[64:67]
ds_read_b64_tr_b16 v[32:33], v128 offset:8192
v_mfma_f32_16x16x32_bf16 v[68:71], v[4:7], v[16:19], v[68:71]
ds_read_b64_tr_b16 v[34:35], v128 offset:12288
buffer_load_dwordx4 v137, s[8:11], s15 offen offset:0 lds
v_mfma_f32_16x16x32_bf16 v[72:75], v[8:11], v[16:19], v[72:75]
ds_read_b64_tr_b16 v[36:37], v129 offset:8192
v_mfma_f32_16x16x32_bf16 v[76:79], v[12:15], v[16:19], v[76:79]
ds_read_b64_tr_b16 v[38:39], v129 offset:12288
v_mfma_f32_16x16x32_bf16 v[80:83], v[0:3], v[20:23], v[80:83]
ds_read_b64_tr_b16 v[40:41], v130 offset:8192
buffer_load_dwordx4 v138, s[8:11], s15 offen offset:1024 lds
v_mfma_f32_16x16x32_bf16 v[84:87], v[4:7], v[20:23], v[84:87]
ds_read_b64_tr_b16 v[42:43], v130 offset:12288
v_mfma_f32_16x16x32_bf16 v[88:91], v[8:11], v[20:23], v[88:91]
ds_read_b64_tr_b16 v[44:45], v131 offset:8192
v_mfma_f32_16x16x32_bf16 v[92:95], v[12:15], v[20:23], v[92:95]
ds_read_b64_tr_b16 v[46:47], v131 offset:12288
buffer_load_dwordx4 v139, s[8:11], s15 offen offset:2048 lds
v_mfma_f32_16x16x32_bf16 v[96:99], v[0:3], v[24:27], v[96:99]
ds_read_b128 v[52:55], v136 offset:3072
v_mfma_f32_16x16x32_bf16 v[100:103], v[4:7], v[24:27], v[100:103]
ds_read_b128 v[56:59], v136 offset:5120
buffer_load_dwordx4 v140, s[8:11], s15 offen offset:3072 lds
v_mfma_f32_16x16x32_bf16 v[104:107], v[8:11], v[24:27], v[104:107]
ds_read_b128 v[60:63], v136 offset:7168
v_mfma_f32_16x16x32_bf16 v[108:111], v[12:15], v[24:27], v[108:111]
v_mfma_f32_16x16x32_bf16 v[112:115], v[0:3], v[28:31], v[112:115]
s_add_u32 s15, s15, s17
v_mfma_f32_16x16x32_bf16 v[116:119], v[4:7], v[28:31], v[116:119]
v_mfma_f32_16x16x32_bf16 v[120:123], v[8:11], v[28:31], v[120:123]
v_mfma_f32_16x16x32_bf16 v[124:127], v[12:15], v[28:31], v[124:127]
main_kernel_w_c0_n_mid:
s_waitcnt lgkmcnt(0)
v_mfma_f32_16x16x32_bf16 v[64:67], v[32:35], v[48:51], v[64:67]
s_waitcnt vmcnt(16)
s_barrier
ds_read_b128 v[16:19], v136 offset:16384
s_add_u32 m0, s20, 0
s_nop 0
v_mfma_f32_16x16x32_bf16 v[68:71], v[36:39], v[48:51], v[68:71]
ds_read_b64_tr_b16 v[0:1], v128 offset:16384
v_mfma_f32_16x16x32_bf16 v[72:75], v[40:43], v[48:51], v[72:75]
ds_read_b64_tr_b16 v[2:3], v128 offset:20480
buffer_load_dwordx4 v141, s[4:7], s16 offen offset:0 sc1 lds
v_mfma_f32_16x16x32_bf16 v[76:79], v[44:47], v[48:51], v[76:79]
ds_read_b64_tr_b16 v[4:5], v129 offset:16384
v_mfma_f32_16x16x32_bf16 v[80:83], v[32:35], v[52:55], v[80:83]
ds_read_b64_tr_b16 v[6:7], v129 offset:20480
v_mfma_f32_16x16x32_bf16 v[84:87], v[36:39], v[52:55], v[84:87]
ds_read_b64_tr_b16 v[8:9], v130 offset:16384
buffer_load_dwordx4 v141, s[4:7], s16 offen offset:1024 sc1 lds
v_mfma_f32_16x16x32_bf16 v[88:91], v[40:43], v[52:55], v[88:91]
ds_read_b64_tr_b16 v[10:11], v130 offset:20480
v_mfma_f32_16x16x32_bf16 v[92:95], v[44:47], v[52:55], v[92:95]
ds_read_b64_tr_b16 v[12:13], v131 offset:16384
buffer_load_dwordx4 v142, s[4:7], s16 offen offset:2048 sc1 lds
v_mfma_f32_16x16x32_bf16 v[96:99], v[32:35], v[56:59], v[96:99]
ds_read_b64_tr_b16 v[14:15], v131 offset:20480
v_mfma_f32_16x16x32_bf16 v[100:103], v[36:39], v[56:59], v[100:103]
ds_read_b128 v[20:23], v136 offset:18432
v_mfma_f32_16x16x32_bf16 v[104:107], v[40:43], v[56:59], v[104:107]
ds_read_b128 v[24:27], v136 offset:20480
buffer_load_dwordx4 v142, s[4:7], s16 offen offset:3072 sc1 lds
v_mfma_f32_16x16x32_bf16 v[108:111], v[44:47], v[56:59], v[108:111]
ds_read_b128 v[28:31], v136 offset:22528
v_mfma_f32_16x16x32_bf16 v[112:115], v[32:35], v[60:63], v[112:115]
s_add_u32 s16, s16, 2048
v_mfma_f32_16x16x32_bf16 v[116:119], v[36:39], v[60:63], v[116:119]
v_mfma_f32_16x16x32_bf16 v[120:123], v[40:43], v[60:63], v[120:123]
v_mfma_f32_16x16x32_bf16 v[124:127], v[44:47], v[60:63], v[124:127]
s_waitcnt lgkmcnt(0)
ds_read_b128 v[48:51], v136 offset:17408
s_add_u32 m0, s19, 0
s_nop 0
v_mfma_f32_16x16x32_bf16 v[64:67], v[0:3], v[16:19], v[64:67]
ds_read_b64_tr_b16 v[32:33], v128 offset:24576
v_mfma_f32_16x16x32_bf16 v[68:71], v[4:7], v[16:19], v[68:71]
ds_read_b64_tr_b16 v[34:35], v128 offset:28672
buffer_load_dwordx4 v137, s[8:11], s15 offen offset:0 lds
v_mfma_f32_16x16x32_bf16 v[72:75], v[8:11], v[16:19], v[72:75]
ds_read_b64_tr_b16 v[36:37], v129 offset:24576
v_mfma_f32_16x16x32_bf16 v[76:79], v[12:15], v[16:19], v[76:79]
ds_read_b64_tr_b16 v[38:39], v129 offset:28672
v_mfma_f32_16x16x32_bf16 v[80:83], v[0:3], v[20:23], v[80:83]
ds_read_b64_tr_b16 v[40:41], v130 offset:24576
buffer_load_dwordx4 v138, s[8:11], s15 offen offset:1024 lds
v_mfma_f32_16x16x32_bf16 v[84:87], v[4:7], v[20:23], v[84:87]
ds_read_b64_tr_b16 v[42:43], v130 offset:28672
v_mfma_f32_16x16x32_bf16 v[88:91], v[8:11], v[20:23], v[88:91]
ds_read_b64_tr_b16 v[44:45], v131 offset:24576
v_mfma_f32_16x16x32_bf16 v[92:95], v[12:15], v[20:23], v[92:95]
ds_read_b64_tr_b16 v[46:47], v131 offset:28672
buffer_load_dwordx4 v139, s[8:11], s15 offen offset:2048 lds
v_mfma_f32_16x16x32_bf16 v[96:99], v[0:3], v[24:27], v[96:99]
ds_read_b128 v[52:55], v136 offset:19456
v_mfma_f32_16x16x32_bf16 v[100:103], v[4:7], v[24:27], v[100:103]
ds_read_b128 v[56:59], v136 offset:21504
buffer_load_dwordx4 v140, s[8:11], s15 offen offset:3072 lds
v_mfma_f32_16x16x32_bf16 v[104:107], v[8:11], v[24:27], v[104:107]
ds_read_b128 v[60:63], v136 offset:23552
v_mfma_f32_16x16x32_bf16 v[108:111], v[12:15], v[24:27], v[108:111]
v_mfma_f32_16x16x32_bf16 v[112:115], v[0:3], v[28:31], v[112:115]
s_add_u32 s15, s15, s17
v_mfma_f32_16x16x32_bf16 v[116:119], v[4:7], v[28:31], v[116:119]
v_mfma_f32_16x16x32_bf16 v[120:123], v[8:11], v[28:31], v[120:123]
v_mfma_f32_16x16x32_bf16 v[124:127], v[12:15], v[28:31], v[124:127]
s_waitcnt lgkmcnt(0)
v_mfma_f32_16x16x32_bf16 v[64:67], v[32:35], v[48:51], v[64:67]
s_waitcnt vmcnt(16)
s_barrier
ds_read_b128 v[16:19], v136 offset:32768
s_add_u32 m0, s20, 16384
s_nop 0
v_mfma_f32_16x16x32_bf16 v[68:71], v[36:39], v[48:51], v[68:71]
ds_read_b64_tr_b16 v[0:1], v128 offset:32768
v_mfma_f32_16x16x32_bf16 v[72:75], v[40:43], v[48:51], v[72:75]
ds_read_b64_tr_b16 v[2:3], v128 offset:36864
buffer_load_dwordx4 v141, s[4:7], s16 offen offset:0 sc1 lds
v_mfma_f32_16x16x32_bf16 v[76:79], v[44:47], v[48:51], v[76:79]
ds_read_b64_tr_b16 v[4:5], v129 offset:32768
v_mfma_f32_16x16x32_bf16 v[80:83], v[32:35], v[52:55], v[80:83]
ds_read_b64_tr_b16 v[6:7], v129 offset:36864
v_mfma_f32_16x16x32_bf16 v[84:87], v[36:39], v[52:55], v[84:87]
ds_read_b64_tr_b16 v[8:9], v130 offset:32768
buffer_load_dwordx4 v141, s[4:7], s16 offen offset:1024 sc1 lds
v_mfma_f32_16x16x32_bf16 v[88:91], v[40:43], v[52:55], v[88:91]
ds_read_b64_tr_b16 v[10:11], v130 offset:36864
v_mfma_f32_16x16x32_bf16 v[92:95], v[44:47], v[52:55], v[92:95]
ds_read_b64_tr_b16 v[12:13], v131 offset:32768
buffer_load_dwordx4 v142, s[4:7], s16 offen offset:2048 sc1 lds
v_mfma_f32_16x16x32_bf16 v[96:99], v[32:35], v[56:59], v[96:99]
ds_read_b64_tr_b16 v[14:15], v131 offset:36864
v_mfma_f32_16x16x32_bf16 v[100:103], v[36:39], v[56:59], v[100:103]
ds_read_b128 v[20:23], v136 offset:34816
v_mfma_f32_16x16x32_bf16 v[104:107], v[40:43], v[56:59], v[104:107]
ds_read_b128 v[24:27], v136 offset:36864
buffer_load_dwordx4 v142, s[4:7], s16 offen offset:3072 sc1 lds
v_mfma_f32_16x16x32_bf16 v[108:111], v[44:47], v[56:59], v[108:111]
ds_read_b128 v[28:31], v136 offset:38912
v_mfma_f32_16x16x32_bf16 v[112:115], v[32:35], v[60:63], v[112:115]
s_add_u32 s16, s16, 2048
v_mfma_f32_16x16x32_bf16 v[116:119], v[36:39], v[60:63], v[116:119]
v_mfma_f32_16x16x32_bf16 v[120:123], v[40:43], v[60:63], v[120:123]
v_mfma_f32_16x16x32_bf16 v[124:127], v[44:47], v[60:63], v[124:127]
s_waitcnt lgkmcnt(0)
ds_read_b128 v[48:51], v136 offset:33792
s_add_u32 m0, s19, 16384
s_nop 0
v_mfma_f32_16x16x32_bf16 v[64:67], v[0:3], v[16:19], v[64:67]
ds_read_b64_tr_b16 v[32:33], v128 offset:40960
v_mfma_f32_16x16x32_bf16 v[68:71], v[4:7], v[16:19], v[68:71]
ds_read_b64_tr_b16 v[34:35], v128 offset:45056
buffer_load_dwordx4 v137, s[8:11], s15 offen offset:0 lds
v_mfma_f32_16x16x32_bf16 v[72:75], v[8:11], v[16:19], v[72:75]
ds_read_b64_tr_b16 v[36:37], v129 offset:40960
v_mfma_f32_16x16x32_bf16 v[76:79], v[12:15], v[16:19], v[76:79]
ds_read_b64_tr_b16 v[38:39], v129 offset:45056
v_mfma_f32_16x16x32_bf16 v[80:83], v[0:3], v[20:23], v[80:83]
ds_read_b64_tr_b16 v[40:41], v130 offset:40960
buffer_load_dwordx4 v138, s[8:11], s15 offen offset:1024 lds
v_mfma_f32_16x16x32_bf16 v[84:87], v[4:7], v[20:23], v[84:87]
ds_read_b64_tr_b16 v[42:43], v130 offset:45056
v_mfma_f32_16x16x32_bf16 v[88:91], v[8:11], v[20:23], v[88:91]
ds_read_b64_tr_b16 v[44:45], v131 offset:40960
v_mfma_f32_16x16x32_bf16 v[92:95], v[12:15], v[20:23], v[92:95]
ds_read_b64_tr_b16 v[46:47], v131 offset:45056
buffer_load_dwordx4 v139, s[8:11], s15 offen offset:2048 lds
v_mfma_f32_16x16x32_bf16 v[96:99], v[0:3], v[24:27], v[96:99]
ds_read_b128 v[52:55], v136 offset:35840
v_mfma_f32_16x16x32_bf16 v[100:103], v[4:7], v[24:27], v[100:103]
ds_read_b128 v[56:59], v136 offset:37888
buffer_load_dwordx4 v140, s[8:11], s15 offen offset:3072 lds
v_mfma_f32_16x16x32_bf16 v[104:107], v[8:11], v[24:27], v[104:107]
ds_read_b128 v[60:63], v136 offset:39936
v_mfma_f32_16x16x32_bf16 v[108:111], v[12:15], v[24:27], v[108:111]
v_mfma_f32_16x16x32_bf16 v[112:115], v[0:3], v[28:31], v[112:115]
s_add_u32 s15, s15, s17
v_mfma_f32_16x16x32_bf16 v[116:119], v[4:7], v[28:31], v[116:119]
v_mfma_f32_16x16x32_bf16 v[120:123], v[8:11], v[28:31], v[120:123]
v_mfma_f32_16x16x32_bf16 v[124:127], v[12:15], v[28:31], v[124:127]
s_waitcnt lgkmcnt(0)
v_mfma_f32_16x16x32_bf16 v[64:67], v[32:35], v[48:51], v[64:67]
s_waitcnt vmcnt(16)
s_barrier
ds_read_b128 v[16:19], v136 offset:49152
s_add_u32 m0, s20, 32768
s_nop 0
v_mfma_f32_16x16x32_bf16 v[68:71], v[36:39], v[48:51], v[68:71]
ds_read_b64_tr_b16 v[0:1], v128 offset:49152
v_mfma_f32_16x16x32_bf16 v[72:75], v[40:43], v[48:51], v[72:75]
ds_read_b64_tr_b16 v[2:3], v128 offset:53248
buffer_load_dwordx4 v141, s[4:7], s16 offen offset:0 sc1 lds
v_mfma_f32_16x16x32_bf16 v[76:79], v[44:47], v[48:51], v[76:79]
ds_read_b64_tr_b16 v[4:5], v129 offset:49152
v_mfma_f32_16x16x32_bf16 v[80:83], v[32:35], v[52:55], v[80:83]
ds_read_b64_tr_b16 v[6:7], v129 offset:53248
v_mfma_f32_16x16x32_bf16 v[84:87], v[36:39], v[52:55], v[84:87]
ds_read_b64_tr_b16 v[8:9], v130 offset:49152
buffer_load_dwordx4 v141, s[4:7], s16 offen offset:1024 sc1 lds
v_mfma_f32_16x16x32_bf16 v[88:91], v[40:43], v[52:55], v[88:91]
ds_read_b64_tr_b16 v[10:11], v130 offset:53248
v_mfma_f32_16x16x32_bf16 v[92:95], v[44:47], v[52:55], v[92:95]
ds_read_b64_tr_b16 v[12:13], v131 offset:49152
buffer_load_dwordx4 v142, s[4:7], s16 offen offset:2048 sc1 lds
v_mfma_f32_16x16x32_bf16 v[96:99], v[32:35], v[56:59], v[96:99]
ds_read_b64_tr_b16 v[14:15], v131 offset:53248
v_mfma_f32_16x16x32_bf16 v[100:103], v[36:39], v[56:59], v[100:103]
ds_read_b128 v[20:23], v136 offset:51200
v_mfma_f32_16x16x32_bf16 v[104:107], v[40:43], v[56:59], v[104:107]
ds_read_b128 v[24:27], v136 offset:53248
buffer_load_dwordx4 v142, s[4:7], s16 offen offset:3072 sc1 lds
v_mfma_f32_16x16x32_bf16 v[108:111], v[44:47], v[56:59], v[108:111]
ds_read_b128 v[28:31], v136 offset:55296
v_mfma_f32_16x16x32_bf16 v[112:115], v[32:35], v[60:63], v[112:115]
s_add_u32 s16, s16, 2048
v_mfma_f32_16x16x32_bf16 v[116:119], v[36:39], v[60:63], v[116:119]
v_mfma_f32_16x16x32_bf16 v[120:123], v[40:43], v[60:63], v[120:123]
v_mfma_f32_16x16x32_bf16 v[124:127], v[44:47], v[60:63], v[124:127]
s_waitcnt lgkmcnt(0)
ds_read_b128 v[48:51], v136 offset:50176
s_add_u32 m0, s19, 32768
s_nop 0
v_mfma_f32_16x16x32_bf16 v[64:67], v[0:3], v[16:19], v[64:67]
ds_read_b64_tr_b16 v[32:33], v128 offset:57344
v_mfma_f32_16x16x32_bf16 v[68:71], v[4:7], v[16:19], v[68:71]
ds_read_b64_tr_b16 v[34:35], v128 offset:61440
buffer_load_dwordx4 v137, s[8:11], s15 offen offset:0 lds
v_mfma_f32_16x16x32_bf16 v[72:75], v[8:11], v[16:19], v[72:75]
ds_read_b64_tr_b16 v[36:37], v129 offset:57344
v_mfma_f32_16x16x32_bf16 v[76:79], v[12:15], v[16:19], v[76:79]
ds_read_b64_tr_b16 v[38:39], v129 offset:61440
v_mfma_f32_16x16x32_bf16 v[80:83], v[0:3], v[20:23], v[80:83]
ds_read_b64_tr_b16 v[40:41], v130 offset:57344
buffer_load_dwordx4 v138, s[8:11], s15 offen offset:1024 lds
v_mfma_f32_16x16x32_bf16 v[84:87], v[4:7], v[20:23], v[84:87]
ds_read_b64_tr_b16 v[42:43], v130 offset:61440
v_mfma_f32_16x16x32_bf16 v[88:91], v[8:11], v[20:23], v[88:91]
ds_read_b64_tr_b16 v[44:45], v131 offset:57344
v_mfma_f32_16x16x32_bf16 v[92:95], v[12:15], v[20:23], v[92:95]
ds_read_b64_tr_b16 v[46:47], v131 offset:61440
buffer_load_dwordx4 v139, s[8:11], s15 offen offset:2048 lds
v_mfma_f32_16x16x32_bf16 v[96:99], v[0:3], v[24:27], v[96:99]
ds_read_b128 v[52:55], v136 offset:52224
v_mfma_f32_16x16x32_bf16 v[100:103], v[4:7], v[24:27], v[100:103]
ds_read_b128 v[56:59], v136 offset:54272
buffer_load_dwordx4 v140, s[8:11], s15 offen offset:3072 lds
v_mfma_f32_16x16x32_bf16 v[104:107], v[8:11], v[24:27], v[104:107]
ds_read_b128 v[60:63], v136 offset:56320
v_mfma_f32_16x16x32_bf16 v[108:111], v[12:15], v[24:27], v[108:111]
v_mfma_f32_16x16x32_bf16 v[112:115], v[0:3], v[28:31], v[112:115]
s_add_u32 s15, s15, s17
v_mfma_f32_16x16x32_bf16 v[116:119], v[4:7], v[28:31], v[116:119]
v_mfma_f32_16x16x32_bf16 v[120:123], v[8:11], v[28:31], v[120:123]
v_mfma_f32_16x16x32_bf16 v[124:127], v[12:15], v[28:31], v[124:127]
s_waitcnt lgkmcnt(0)
v_mfma_f32_16x16x32_bf16 v[64:67], v[32:35], v[48:51], v[64:67]
s_waitcnt vmcnt(16)
s_barrier
ds_read_b128 v[16:19], v136 offset:0
s_add_u32 m0, s20, 49152
s_nop 0
v_mfma_f32_16x16x32_bf16 v[68:71], v[36:39], v[48:51], v[68:71]
ds_read_b64_tr_b16 v[0:1], v128 offset:0
v_mfma_f32_16x16x32_bf16 v[72:75], v[40:43], v[48:51], v[72:75]
ds_read_b64_tr_b16 v[2:3], v128 offset:4096
buffer_load_dwordx4 v141, s[4:7], s16 offen offset:0 sc1 lds
v_mfma_f32_16x16x32_bf16 v[76:79], v[44:47], v[48:51], v[76:79]
ds_read_b64_tr_b16 v[4:5], v129 offset:0
v_mfma_f32_16x16x32_bf16 v[80:83], v[32:35], v[52:55], v[80:83]
ds_read_b64_tr_b16 v[6:7], v129 offset:4096
v_mfma_f32_16x16x32_bf16 v[84:87], v[36:39], v[52:55], v[84:87]
ds_read_b64_tr_b16 v[8:9], v130 offset:0
buffer_load_dwordx4 v141, s[4:7], s16 offen offset:1024 sc1 lds
v_mfma_f32_16x16x32_bf16 v[88:91], v[40:43], v[52:55], v[88:91]
ds_read_b64_tr_b16 v[10:11], v130 offset:4096
v_mfma_f32_16x16x32_bf16 v[92:95], v[44:47], v[52:55], v[92:95]
ds_read_b64_tr_b16 v[12:13], v131 offset:0
buffer_load_dwordx4 v142, s[4:7], s16 offen offset:2048 sc1 lds
v_mfma_f32_16x16x32_bf16 v[96:99], v[32:35], v[56:59], v[96:99]
ds_read_b64_tr_b16 v[14:15], v131 offset:4096
v_mfma_f32_16x16x32_bf16 v[100:103], v[36:39], v[56:59], v[100:103]
ds_read_b128 v[20:23], v136 offset:2048
v_mfma_f32_16x16x32_bf16 v[104:107], v[40:43], v[56:59], v[104:107]
ds_read_b128 v[24:27], v136 offset:4096
buffer_load_dwordx4 v142, s[4:7], s16 offen offset:3072 sc1 lds
v_mfma_f32_16x16x32_bf16 v[108:111], v[44:47], v[56:59], v[108:111]
ds_read_b128 v[28:31], v136 offset:6144
v_mfma_f32_16x16x32_bf16 v[112:115], v[32:35], v[60:63], v[112:115]
s_add_u32 s16, s16, 2048
v_mfma_f32_16x16x32_bf16 v[116:119], v[36:39], v[60:63], v[116:119]
v_mfma_f32_16x16x32_bf16 v[120:123], v[40:43], v[60:63], v[120:123]
v_mfma_f32_16x16x32_bf16 v[124:127], v[44:47], v[60:63], v[124:127]
s_sub_u32 s18, s18, 1
s_cmp_eq_u32 s18, s55
s_cbranch_scc1 main_kernel_w_c0_n_ev
s_cmp_lg_u32 s18, 0
s_cbranch_scc1 main_kernel_w_c0_n_loop
s_cmp_lg_u32 s73, -1
s_cbranch_scc1 main_kernel_w_epn
s_waitcnt lgkmcnt(0)
ds_read_b128 v[48:51], v136 offset:1024
s_add_u32 m0, s19, 49152
s_nop 0
v_mfma_f32_16x16x32_bf16 v[64:67], v[0:3], v[16:19], v[64:67]
ds_read_b64_tr_b16 v[32:33], v128 offset:8192
s_add_u32 s32, s23, 1
s_bitcmp0_b32 s32, 2
s_cselect_b32 s34, 7, 2
s_cselect_b32 s35, 2, 4
s_lshl_b32 s59, s23, 13
s_add_u32 s59, s59, 0x8404000
v_mfma_f32_16x16x32_bf16 v[68:71], v[4:7], v[16:19], v[68:71]
ds_read_b64_tr_b16 v[34:35], v128 offset:12288
buffer_load_dwordx4 v137, s[8:11], s15 offen offset:0 lds
v_lshrrev_b32 v253, 3, v250
v_add_lshl_u32 v253, s24, v253, 9
v_mfma_f32_16x16x32_bf16 v[72:75], v[8:11], v[16:19], v[72:75]
ds_read_b64_tr_b16 v[36:37], v129 offset:8192
v_and_b32 v254, 3, v250
v_lshl_add_u32 v253, v254, s34, v253
v_mfma_f32_16x16x32_bf16 v[76:79], v[12:15], v[16:19], v[76:79]
ds_read_b64_tr_b16 v[38:39], v129 offset:12288
v_bfe_u32 v254, v250, 2, 1
v_add_u32 v254, s25, v254
v_lshl_add_u32 v248, v254, s35, v253
v_mfma_f32_16x16x32_bf16 v[80:83], v[0:3], v[20:23], v[80:83]
ds_read_b64_tr_b16 v[40:41], v130 offset:8192
buffer_load_dwordx4 v138, s[8:11], s15 offen offset:1024 lds
s_lshl_b32 s0, 4, s54
v_readfirstlane_b32 s28, v249
v_mfma_f32_16x16x32_bf16 v[84:87], v[4:7], v[20:23], v[84:87]
ds_read_b64_tr_b16 v[42:43], v130 offset:12288
s_nop 1
v_cmp_ge_u32 vcc, s28, v229
v_mfma_f32_16x16x32_bf16 v[88:91], v[8:11], v[20:23], v[88:91]
ds_read_b64_tr_b16 v[44:45], v131 offset:8192
s_nop 1
s_bcnt1_i32_b64 s32, vcc
v_mfma_f32_16x16x32_bf16 v[92:95], v[12:15], v[20:23], v[92:95]
ds_read_b64_tr_b16 v[46:47], v131 offset:12288
buffer_load_dwordx4 v139, s[8:11], s15 offen offset:2048 lds
s_sub_u32 s32, s32, 1
v_readlane_b32 s36, v230, s32
s_nop 1
v_mfma_f32_16x16x32_bf16 v[96:99], v[0:3], v[24:27], v[96:99]
ds_read_b128 v[52:55], v136 offset:3072
s_and_b32 s32, s36, 0x7ff
s_sub_u32 s28, s28, s32
v_mfma_f32_16x16x32_bf16 v[100:103], v[4:7], v[24:27], v[100:103]
ds_read_b128 v[56:59], v136 offset:5120
buffer_load_dwordx4 v140, s[8:11], s15 offen offset:3072 lds
s_bfe_u32 s32, s36, 0x3001a
s_lshr_b32 s25, s28, s32
v_mfma_f32_16x16x32_bf16 v[104:107], v[8:11], v[24:27], v[104:107]
ds_read_b128 v[60:63], v136 offset:7168
s_lshl_b32 s33, s25, s32
s_sub_u32 s24, s28, s33
v_mfma_f32_16x16x32_bf16 v[108:111], v[12:15], v[24:27], v[108:111]
s_bfe_u32 s34, s36, 0x1001d
s_lshl_b32 s24, s24, s34
s_bfe_u32 s35, s36, 0x1001e
v_mfma_f32_16x16x32_bf16 v[112:115], v[0:3], v[28:31], v[112:115]
s_add_u32 s15, s15, s17
s_lshl_b32 s25, s25, s35
s_bfe_u32 s32, s36, 0x40011
v_mfma_f32_16x16x32_bf16 v[116:119], v[4:7], v[28:31], v[116:119]
s_add_u32 s24, s24, s32
s_bfe_u32 s32, s36, 0x50015
v_mfma_f32_16x16x32_bf16 v[120:123], v[8:11], v[28:31], v[120:123]
s_add_u32 s25, s25, s32
s_bfe_u32 s23, s36, 0x4000b
v_mfma_f32_16x16x32_bf16 v[124:127], v[12:15], v[28:31], v[124:127]
s_waitcnt lgkmcnt(0)
v_mfma_f32_16x16x32_bf16 v[64:67], v[32:35], v[48:51], v[64:67]
s_waitcnt vmcnt(16)
s_barrier
ds_read_b128 v[16:19], v136 offset:16384
s_add_u32 m0, s20, 0
s_nop 0
s_bfe_u32 s36, s36, 0x6000b
s_lshl_b32 s32, s24, 8
s_or_b32 s36, s36, s32
v_mfma_f32_16x16x32_bf16 v[68:71], v[36:39], v[48:51], v[68:71]
ds_read_b64_tr_b16 v[0:1], v128 offset:16384
s_lshl_b32 s32, s25, 16
s_or_b32 s36, s36, s32
v_mfma_f32_16x16x32_bf16 v[72:75], v[40:43], v[48:51], v[72:75]
ds_read_b64_tr_b16 v[2:3], v128 offset:20480
buffer_load_dwordx4 v141, s[4:7], s16 offen offset:0 sc1 lds
s_cmp_eq_u32 s23, 4
s_cselect_b32 s32, 1, 0
s_sub_u32 s48, s24, s32
v_mfma_f32_16x16x32_bf16 v[76:79], v[44:47], v[48:51], v[76:79]
ds_read_b64_tr_b16 v[4:5], v129 offset:16384
s_max_i32 s48, s48, 0
s_add_u32 s49, s24, s34
s_add_u32 s49, s49, s32
v_mfma_f32_16x16x32_bf16 v[80:83], v[32:35], v[52:55], v[80:83]
ds_read_b64_tr_b16 v[6:7], v129 offset:20480
s_min_u32 s49, s49, 15
s_cmp_eq_u32 s23, 6
s_cselect_b32 s51, 3, 7
v_mfma_f32_16x16x32_bf16 v[84:87], v[36:39], v[52:55], v[84:87]
ds_read_b64_tr_b16 v[8:9], v130 offset:16384
buffer_load_dwordx4 v141, s[4:7], s16 offen offset:1024 sc1 lds
s_cmp_eq_u32 s23, 7
s_cselect_b32 s51, 27, s51
s_cselect_b32 s50, 5, 4
s_add_u32 s33, s25, s35
v_mfma_f32_16x16x32_bf16 v[88:91], v[40:43], v[52:55], v[88:91]
ds_read_b64_tr_b16 v[10:11], v130 offset:20480
s_lshl_b32 s34, s24, 9
s_cmp_eq_u32 s23, 8
s_cselect_b32 s51, 0, s51
s_cselect_b32 s48, s25, s48
s_cselect_b32 s49, s33, s49
v_mfma_f32_16x16x32_bf16 v[92:95], v[44:47], v[52:55], v[92:95]
ds_read_b64_tr_b16 v[12:13], v131 offset:16384
buffer_load_dwordx4 v142, s[4:7], s16 offen offset:2048 sc1 lds
s_cmp_eq_u32 s23, 8
s_cselect_b32 s63, 2, 9
s_cselect_b32 s61, 0, 0x7f000000
s_cselect_b32 s34, s34, 0
v_lshrrev_b32 v228, s50, v250
v_lshlrev_b32 v254, s50, v228
v_mfma_f32_16x16x32_bf16 v[96:99], v[32:35], v[56:59], v[96:99]
ds_read_b64_tr_b16 v[14:15], v131 offset:20480
v_sub_u32 v254, v250, v254
s_cmp_lt_u32 s23, 4
s_cselect_b32 s39, 10, s23
v_mfma_f32_16x16x32_bf16 v[100:103], v[36:39], v[56:59], v[100:103]
ds_read_b128 v[20:23], v136 offset:18432
v_min_u32 v254, s51, v254
s_lshl_b32 s39, s39, 13
v_mfma_f32_16x16x32_bf16 v[104:107], v[40:43], v[56:59], v[104:107]
ds_read_b128 v[24:27], v136 offset:20480
buffer_load_dwordx4 v142, s[4:7], s16 offen offset:3072 sc1 lds
s_cmp_eq_u32 s23, 3
s_cselect_b32 s34, 4, s34
v_add_u32 v228, s48, v228
v_mfma_f32_16x16x32_bf16 v[108:111], v[44:47], v[56:59], v[108:111]
ds_read_b128 v[28:31], v136 offset:22528
s_add_u32 s39, s39, s34
s_add_u32 s39, s39, 0x8402000
v_min_u32 v228, s49, v228
v_mfma_f32_16x16x32_bf16 v[112:115], v[32:35], v[60:63], v[112:115]
s_add_u32 s16, s16, 2048
s_lshl_b32 s60, s24, 10
s_add_u32 s60, s60, 0x8400000
v_mfma_f32_16x16x32_bf16 v[116:119], v[36:39], v[60:63], v[116:119]
v_lshlrev_b32 v228, s63, v228
v_lshl_add_u32 v228, v254, 4, v228
v_mfma_f32_16x16x32_bf16 v[120:123], v[40:43], v[60:63], v[120:123]
v_or_b32 v146, s61, v251
s_mov_b64 exec, s[100:101]
buffer_load_dword v231, v228, s[4:7], s39 offen sc1
buffer_load_dwordx4 v[232:235], v146, s[4:7], s60 offen sc1
s_mov_b64 exec, -1
v_mfma_f32_16x16x32_bf16 v[124:127], v[44:47], v[60:63], v[124:127]
s_waitcnt lgkmcnt(0)
ds_read_b128 v[48:51], v136 offset:17408
s_add_u32 m0, s19, 0
s_nop 0
v_mfma_f32_16x16x32_bf16 v[64:67], v[0:3], v[16:19], v[64:67]
ds_read_b64_tr_b16 v[32:33], v128 offset:24576
s_mov_b32 s1, s21
v_mfma_f32_16x16x32_bf16 v[68:71], v[4:7], v[16:19], v[68:71]
ds_read_b64_tr_b16 v[34:35], v128 offset:28672
buffer_load_dwordx4 v137, s[8:11], s15 offen offset:0 lds
s_mov_b32 s2, s22
v_mfma_f32_16x16x32_bf16 v[72:75], v[8:11], v[16:19], v[72:75]
ds_read_b64_tr_b16 v[36:37], v129 offset:24576
s_mov_b32 s3, s26
v_mfma_f32_16x16x32_bf16 v[76:79], v[12:15], v[16:19], v[76:79]
ds_read_b64_tr_b16 v[38:39], v129 offset:28672
s_mov_b32 s56, s57
v_mfma_f32_16x16x32_bf16 v[80:83], v[0:3], v[20:23], v[80:83]
ds_read_b64_tr_b16 v[40:41], v130 offset:24576
buffer_load_dwordx4 v138, s[8:11], s15 offen offset:1024 lds
v_mfma_f32_16x16x32_bf16 v[84:87], v[4:7], v[20:23], v[84:87]
ds_read_b64_tr_b16 v[42:43], v130 offset:28672
v_mov_b32 v145, v252
v_mfma_f32_16x16x32_bf16 v[88:91], v[8:11], v[20:23], v[88:91]
ds_read_b64_tr_b16 v[44:45], v131 offset:24576
v_mov_b32 v255, 131072
v_mfma_f32_16x16x32_bf16 v[92:95], v[12:15], v[20:23], v[92:95]
ds_read_b64_tr_b16 v[46:47], v131 offset:28672
buffer_load_dwordx4 v139, s[8:11], s15 offen offset:2048 lds
s_add_u32 s32, s3, 0
v_mfma_f32_16x16x32_bf16 v[96:99], v[0:3], v[24:27], v[96:99]
ds_read_b128 v[52:55], v136 offset:19456
buffer_load_dwordx4 v[192:195], v251, s[4:7], s32 offen offset:0 sc1
v_mfma_f32_16x16x32_bf16 v[100:103], v[4:7], v[24:27], v[100:103]
ds_read_b128 v[56:59], v136 offset:21504
buffer_load_dwordx4 v140, s[8:11], s15 offen offset:3072 lds
v_mfma_f32_16x16x32_bf16 v[104:107], v[8:11], v[24:27], v[104:107]
ds_read_b128 v[60:63], v136 offset:23552
buffer_load_dwordx4 v[196:199], v251, s[4:7], s32 offen offset:1024 sc1
v_mfma_f32_16x16x32_bf16 v[108:111], v[12:15], v[24:27], v[108:111]
s_add_u32 s32, s3, 32768
v_mfma_f32_16x16x32_bf16 v[112:115], v[0:3], v[28:31], v[112:115]
s_add_u32 s15, s15, s17
buffer_load_dwordx4 v[200:203], v251, s[4:7], s32 offen offset:0 sc1
v_mfma_f32_16x16x32_bf16 v[116:119], v[4:7], v[28:31], v[116:119]
buffer_load_dwordx4 v[204:207], v251, s[4:7], s32 offen offset:1024 sc1
v_mfma_f32_16x16x32_bf16 v[120:123], v[8:11], v[28:31], v[120:123]
v_mfma_f32_16x16x32_bf16 v[124:127], v[12:15], v[28:31], v[124:127]
s_waitcnt lgkmcnt(0)
v_mfma_f32_16x16x32_bf16 v[64:67], v[32:35], v[48:51], v[64:67]
s_waitcnt vmcnt(20)
s_barrier
ds_read_b128 v[16:19], v136 offset:32768
s_add_u32 m0, s20, 16384
s_nop 0
s_add_u32 s32, s3, 65536
v_mfma_f32_16x16x32_bf16 v[68:71], v[36:39], v[48:51], v[68:71]
ds_read_b64_tr_b16 v[0:1], v128 offset:32768
v_mfma_f32_16x16x32_bf16 v[72:75], v[40:43], v[48:51], v[72:75]
ds_read_b64_tr_b16 v[2:3], v128 offset:36864
buffer_load_dwordx4 v141, s[4:7], s16 offen offset:0 sc1 lds
buffer_load_dwordx4 v[208:211], v251, s[4:7], s32 offen offset:0 sc1
v_mfma_f32_16x16x32_bf16 v[76:79], v[44:47], v[48:51], v[76:79]
ds_read_b64_tr_b16 v[4:5], v129 offset:32768
v_mfma_f32_16x16x32_bf16 v[80:83], v[32:35], v[52:55], v[80:83]
ds_read_b64_tr_b16 v[6:7], v129 offset:36864
v_mfma_f32_16x16x32_bf16 v[84:87], v[36:39], v[52:55], v[84:87]
ds_read_b64_tr_b16 v[8:9], v130 offset:32768
buffer_load_dwordx4 v141, s[4:7], s16 offen offset:1024 sc1 lds
buffer_load_dwordx4 v[212:215], v251, s[4:7], s32 offen offset:1024 sc1
v_mfma_f32_16x16x32_bf16 v[88:91], v[40:43], v[52:55], v[88:91]
ds_read_b64_tr_b16 v[10:11], v130 offset:36864
v_mfma_f32_16x16x32_bf16 v[92:95], v[44:47], v[52:55], v[92:95]
ds_read_b64_tr_b16 v[12:13], v131 offset:32768
buffer_load_dwordx4 v142, s[4:7], s16 offen offset:2048 sc1 lds
s_add_u32 s32, s3, 98304
v_mfma_f32_16x16x32_bf16 v[96:99], v[32:35], v[56:59], v[96:99]
ds_read_b64_tr_b16 v[14:15], v131 offset:36864
v_mfma_f32_16x16x32_bf16 v[100:103], v[36:39], v[56:59], v[100:103]
ds_read_b128 v[20:23], v136 offset:34816
v_mfma_f32_16x16x32_bf16 v[104:107], v[40:43], v[56:59], v[104:107]
ds_read_b128 v[24:27], v136 offset:36864
buffer_load_dwordx4 v142, s[4:7], s16 offen offset:3072 sc1 lds
buffer_load_dwordx4 v[216:219], v251, s[4:7], s32 offen offset:0 sc1
v_mfma_f32_16x16x32_bf16 v[108:111], v[44:47], v[56:59], v[108:111]
ds_read_b128 v[28:31], v136 offset:38912
v_mfma_f32_16x16x32_bf16 v[112:115], v[32:35], v[60:63], v[112:115]
s_add_u32 s16, s16, 2048
buffer_load_dwordx4 v[220:223], v251, s[4:7], s32 offen offset:1024 sc1
v_mfma_f32_16x16x32_bf16 v[116:119], v[36:39], v[60:63], v[116:119]
v_mfma_f32_16x16x32_bf16 v[120:123], v[40:43], v[60:63], v[120:123]
v_mfma_f32_16x16x32_bf16 v[124:127], v[44:47], v[60:63], v[124:127]
s_cmp_lg_u32 s56, 5
s_cbranch_scc1 main_kernel_w_c0_n_nox
s_add_u32 s32, s1, 0
buffer_load_dwordx4 v[160:163], v145, s[96:99], s32 offen offset:0
buffer_load_dwordx4 v[164:167], v145, s[96:99], s32 offen offset:64
s_add_u32 s32, s1, 32768
buffer_load_dwordx4 v[168:171], v145, s[96:99], s32 offen offset:0
buffer_load_dwordx4 v[172:175], v145, s[96:99], s32 offen offset:64
s_add_u32 s32, s1, 65536
buffer_load_dwordx4 v[176:179], v145, s[96:99], s32 offen offset:0
buffer_load_dwordx4 v[180:183], v145, s[96:99], s32 offen offset:64
s_add_u32 s32, s1, 98304
buffer_load_dwordx4 v[184:187], v145, s[96:99], s32 offen offset:0
buffer_load_dwordx4 v[188:191], v145, s[96:99], s32 offen offset:64
main_kernel_w_c0_n_nox:
s_waitcnt lgkmcnt(0)
ds_read_b128 v[48:51], v136 offset:33792
s_add_u32 m0, s19, 16384
s_nop 0
v_mfma_f32_16x16x32_bf16 v[64:67], v[0:3], v[16:19], v[64:67]
ds_read_b64_tr_b16 v[32:33], v128 offset:40960
v_mfma_f32_16x16x32_bf16 v[68:71], v[4:7], v[16:19], v[68:71]
ds_read_b64_tr_b16 v[34:35], v128 offset:45056
buffer_load_dwordx4 v137, s[8:11], s15 offen offset:0 lds
v_mfma_f32_16x16x32_bf16 v[72:75], v[8:11], v[16:19], v[72:75]
ds_read_b64_tr_b16 v[36:37], v129 offset:40960
v_mfma_f32_16x16x32_bf16 v[76:79], v[12:15], v[16:19], v[76:79]
ds_read_b64_tr_b16 v[38:39], v129 offset:45056
v_mfma_f32_16x16x32_bf16 v[80:83], v[0:3], v[20:23], v[80:83]
ds_read_b64_tr_b16 v[40:41], v130 offset:40960
buffer_load_dwordx4 v138, s[8:11], s15 offen offset:1024 lds
v_mfma_f32_16x16x32_bf16 v[84:87], v[4:7], v[20:23], v[84:87]
ds_read_b64_tr_b16 v[42:43], v130 offset:45056
v_mfma_f32_16x16x32_bf16 v[88:91], v[8:11], v[20:23], v[88:91]
ds_read_b64_tr_b16 v[44:45], v131 offset:40960
v_mfma_f32_16x16x32_bf16 v[92:95], v[12:15], v[20:23], v[92:95]
ds_read_b64_tr_b16 v[46:47], v131 offset:45056
buffer_load_dwordx4 v139, s[8:11], s15 offen offset:2048 lds
v_mfma_f32_16x16x32_bf16 v[96:99], v[0:3], v[24:27], v[96:99]
ds_read_b128 v[52:55], v136 offset:35840
v_mfma_f32_16x16x32_bf16 v[100:103], v[4:7], v[24:27], v[100:103]
ds_read_b128 v[56:59], v136 offset:37888
buffer_load_dwordx4 v140, s[8:11], s15 offen offset:3072 lds
v_mfma_f32_16x16x32_bf16 v[104:107], v[8:11], v[24:27], v[104:107]
ds_read_b128 v[60:63], v136 offset:39936
v_mfma_f32_16x16x32_bf16 v[108:111], v[12:15], v[24:27], v[108:111]
v_mfma_f32_16x16x32_bf16 v[112:115], v[0:3], v[28:31], v[112:115]
s_add_u32 s15, s15, s17
v_mfma_f32_16x16x32_bf16 v[116:119], v[4:7], v[28:31], v[116:119]
v_mfma_f32_16x16x32_bf16 v[120:123], v[8:11], v[28:31], v[120:123]
v_mfma_f32_16x16x32_bf16 v[124:127], v[12:15], v[28:31], v[124:127]
s_waitcnt lgkmcnt(0)
v_mfma_f32_16x16x32_bf16 v[64:67], v[32:35], v[48:51], v[64:67]
s_waitcnt vmcnt(24)
s_barrier
ds_read_b128 v[16:19], v136 offset:49152
s_add_u32 m0, s20, 32768
s_nop 0
v_mfma_f32_16x16x32_bf16 v[68:71], v[36:39], v[48:51], v[68:71]
ds_read_b64_tr_b16 v[0:1], v128 offset:49152
v_mfma_f32_16x16x32_bf16 v[72:75], v[40:43], v[48:51], v[72:75]
ds_read_b64_tr_b16 v[2:3], v128 offset:53248
buffer_load_dwordx4 v141, s[4:7], s16 offen offset:0 sc1 lds
v_mfma_f32_16x16x32_bf16 v[76:79], v[44:47], v[48:51], v[76:79]
ds_read_b64_tr_b16 v[4:5], v129 offset:49152
v_mfma_f32_16x16x32_bf16 v[80:83], v[32:35], v[52:55], v[80:83]
ds_read_b64_tr_b16 v[6:7], v129 offset:53248
s_waitcnt vmcnt(21)
v_mfma_f32_16x16x32_bf16 v[84:87], v[36:39], v[52:55], v[84:87]
ds_read_b64_tr_b16 v[8:9], v130 offset:49152
buffer_load_dwordx4 v141, s[4:7], s16 offen offset:1024 sc1 lds
v_min3_u32 v253, v232, v233, v234
v_mfma_f32_16x16x32_bf16 v[88:91], v[40:43], v[52:55], v[88:91]
ds_read_b64_tr_b16 v[10:11], v130 offset:53248
v_min_u32 v253, v253, v235
v_mfma_f32_16x16x32_bf16 v[92:95], v[44:47], v[52:55], v[92:95]
ds_read_b64_tr_b16 v[12:13], v131 offset:49152
buffer_load_dwordx4 v142, s[4:7], s16 offen offset:2048 sc1 lds
v_or_b32 v253, s61, v253
v_mfma_f32_16x16x32_bf16 v[96:99], v[32:35], v[56:59], v[96:99]
ds_read_b64_tr_b16 v[14:15], v131 offset:53248
v_min_u32 v253, v253, v231
v_mfma_f32_16x16x32_bf16 v[100:103], v[36:39], v[56:59], v[100:103]
ds_read_b128 v[20:23], v136 offset:51200
v_cmp_eq_u32 vcc, 0, v253
v_mfma_f32_16x16x32_bf16 v[104:107], v[40:43], v[56:59], v[104:107]
ds_read_b128 v[24:27], v136 offset:53248
buffer_load_dwordx4 v142, s[4:7], s16 offen offset:3072 sc1 lds
s_nop 1
v_mfma_f32_16x16x32_bf16 v[108:111], v[44:47], v[56:59], v[108:111]
ds_read_b128 v[28:31], v136 offset:55296
s_cmp_eq_u64 vcc, 0
s_cselect_b32 s32, s36, -4
v_mfma_f32_16x16x32_bf16 v[112:115], v[32:35], v[60:63], v[112:115]
s_add_u32 s16, s16, 2048
s_bitcmp1_b32 0x1df, s23
s_cselect_b32 s32, s32, -4
v_mfma_f32_16x16x32_bf16 v[116:119], v[36:39], v[60:63], v[116:119]
v_mov_b32 v254, s32
v_mfma_f32_16x16x32_bf16 v[120:123], v[40:43], v[60:63], v[120:123]
s_mov_b64 exec, s[100:101]
ds_write_b32 v255, v254
s_mov_b64 exec, -1
v_mfma_f32_16x16x32_bf16 v[124:127], v[44:47], v[60:63], v[124:127]
s_waitcnt lgkmcnt(0)
ds_read_b128 v[48:51], v136 offset:50176
s_add_u32 m0, s19, 32768
s_nop 0
v_mfma_f32_16x16x32_bf16 v[64:67], v[0:3], v[16:19], v[64:67]
ds_read_b64_tr_b16 v[32:33], v128 offset:57344
v_mfma_f32_16x16x32_bf16 v[68:71], v[4:7], v[16:19], v[68:71]
ds_read_b64_tr_b16 v[34:35], v128 offset:61440
buffer_load_dwordx4 v137, s[8:11], s15 offen offset:0 lds
v_mfma_f32_16x16x32_bf16 v[72:75], v[8:11], v[16:19], v[72:75]
ds_read_b64_tr_b16 v[36:37], v129 offset:57344
v_mfma_f32_16x16x32_bf16 v[76:79], v[12:15], v[16:19], v[76:79]
ds_read_b64_tr_b16 v[38:39], v129 offset:61440
v_mfma_f32_16x16x32_bf16 v[80:83], v[0:3], v[20:23], v[80:83]
ds_read_b64_tr_b16 v[40:41], v130 offset:57344
buffer_load_dwordx4 v138, s[8:11], s15 offen offset:1024 lds
v_mfma_f32_16x16x32_bf16 v[84:87], v[4:7], v[20:23], v[84:87]
ds_read_b64_tr_b16 v[42:43], v130 offset:61440
v_mfma_f32_16x16x32_bf16 v[88:91], v[8:11], v[20:23], v[88:91]
ds_read_b64_tr_b16 v[44:45], v131 offset:57344
v_mfma_f32_16x16x32_bf16 v[92:95], v[12:15], v[20:23], v[92:95]
ds_read_b64_tr_b16 v[46:47], v131 offset:61440
buffer_load_dwordx4 v139, s[8:11], s15 offen offset:2048 lds
v_mfma_f32_16x16x32_bf16 v[96:99], v[0:3], v[24:27], v[96:99]
ds_read_b128 v[52:55], v136 offset:52224
v_mfma_f32_16x16x32_bf16 v[100:103], v[4:7], v[24:27], v[100:103]
ds_read_b128 v[56:59], v136 offset:54272
buffer_load_dwordx4 v140, s[8:11], s15 offen offset:3072 lds
v_mfma_f32_16x16x32_bf16 v[104:107], v[8:11], v[24:27], v[104:107]
ds_read_b128 v[60:63], v136 offset:56320
v_mfma_f32_16x16x32_bf16 v[108:111], v[12:15], v[24:27], v[108:111]
v_mfma_f32_16x16x32_bf16 v[112:115], v[0:3], v[28:31], v[112:115]
s_add_u32 s15, s15, s17
v_mfma_f32_16x16x32_bf16 v[116:119], v[4:7], v[28:31], v[116:119]
v_mfma_f32_16x16x32_bf16 v[120:123], v[8:11], v[28:31], v[120:123]
v_mfma_f32_16x16x32_bf16 v[124:127], v[12:15], v[28:31], v[124:127]
s_waitcnt lgkmcnt(0)
v_mfma_f32_16x16x32_bf16 v[64:67], v[32:35], v[48:51], v[64:67]
s_waitcnt vmcnt(23)
s_barrier
ds_read_b128 v[16:19], v136 offset:0
s_add_u32 m0, s20, 49152
s_nop 0
ds_read_b32 v254, v255
v_mfma_f32_16x16x32_bf16 v[68:71], v[36:39], v[48:51], v[68:71]
ds_read_b64_tr_b16 v[0:1], v128 offset:0
v_mfma_f32_16x16x32_bf16 v[72:75], v[40:43], v[48:51], v[72:75]
ds_read_b64_tr_b16 v[2:3], v128 offset:4096
buffer_load_dwordx4 v141, s[4:7], s16 offen offset:0 sc1 lds
v_mfma_f32_16x16x32_bf16 v[76:79], v[44:47], v[48:51], v[76:79]
ds_read_b64_tr_b16 v[4:5], v129 offset:0
v_mfma_f32_16x16x32_bf16 v[80:83], v[32:35], v[52:55], v[80:83]
ds_read_b64_tr_b16 v[6:7], v129 offset:4096
v_mfma_f32_16x16x32_bf16 v[84:87], v[36:39], v[52:55], v[84:87]
ds_read_b64_tr_b16 v[8:9], v130 offset:0
buffer_load_dwordx4 v141, s[4:7], s16 offen offset:1024 sc1 lds
v_mfma_f32_16x16x32_bf16 v[88:91], v[40:43], v[52:55], v[88:91]
ds_read_b64_tr_b16 v[10:11], v130 offset:4096
v_mfma_f32_16x16x32_bf16 v[92:95], v[44:47], v[52:55], v[92:95]
ds_read_b64_tr_b16 v[12:13], v131 offset:0
buffer_load_dwordx4 v142, s[4:7], s16 offen offset:2048 sc1 lds
v_mfma_f32_16x16x32_bf16 v[96:99], v[32:35], v[56:59], v[96:99]
ds_read_b64_tr_b16 v[14:15], v131 offset:4096
v_mfma_f32_16x16x32_bf16 v[100:103], v[36:39], v[56:59], v[100:103]
ds_read_b128 v[20:23], v136 offset:2048
v_mfma_f32_16x16x32_bf16 v[104:107], v[40:43], v[56:59], v[104:107]
ds_read_b128 v[24:27], v136 offset:4096
buffer_load_dwordx4 v142, s[4:7], s16 offen offset:3072 sc1 lds
v_mfma_f32_16x16x32_bf16 v[108:111], v[44:47], v[56:59], v[108:111]
ds_read_b128 v[28:31], v136 offset:6144
v_mfma_f32_16x16x32_bf16 v[112:115], v[32:35], v[60:63], v[112:115]
s_add_u32 s16, s16, 2048
v_mfma_f32_16x16x32_bf16 v[116:119], v[36:39], v[60:63], v[116:119]
v_mfma_f32_16x16x32_bf16 v[120:123], v[40:43], v[60:63], v[120:123]
v_mfma_f32_16x16x32_bf16 v[124:127], v[44:47], v[60:63], v[124:127]
s_waitcnt lgkmcnt(0)
ds_read_b128 v[48:51], v136 offset:1024
s_add_u32 m0, s19, 49152
s_nop 0
v_mfma_f32_16x16x32_bf16 v[64:67], v[0:3], v[16:19], v[64:67]
ds_read_b64_tr_b16 v[32:33], v128 offset:8192
v_readfirstlane_b32 s62, v254
v_mfma_f32_16x16x32_bf16 v[68:71], v[4:7], v[16:19], v[68:71]
ds_read_b64_tr_b16 v[34:35], v128 offset:12288
buffer_load_dwordx4 v137, s[8:11], s15 offen offset:0 lds
v_mfma_f32_16x16x32_bf16 v[72:75], v[8:11], v[16:19], v[72:75]
ds_read_b64_tr_b16 v[36:37], v129 offset:8192
s_nop 1
v_mfma_f32_16x16x32_bf16 v[76:79], v[12:15], v[16:19], v[76:79]
ds_read_b64_tr_b16 v[38:39], v129 offset:12288
v_mfma_f32_16x16x32_bf16 v[80:83], v[0:3], v[20:23], v[80:83]
ds_read_b64_tr_b16 v[40:41], v130 offset:8192
buffer_load_dwordx4 v138, s[8:11], s15 offen offset:1024 lds
v_mfma_f32_16x16x32_bf16 v[84:87], v[4:7], v[20:23], v[84:87]
ds_read_b64_tr_b16 v[42:43], v130 offset:12288
s_and_b32 s23, s62, 15
v_mfma_f32_16x16x32_bf16 v[88:91], v[8:11], v[20:23], v[88:91]
ds_read_b64_tr_b16 v[44:45], v131 offset:8192
v_mfma_f32_16x16x32_bf16 v[92:95], v[12:15], v[20:23], v[92:95]
ds_read_b64_tr_b16 v[46:47], v131 offset:12288
buffer_load_dwordx4 v139, s[8:11], s15 offen offset:2048 lds
s_bfe_u32 s54, s62, 0x20004
v_mfma_f32_16x16x32_bf16 v[96:99], v[0:3], v[24:27], v[96:99]
ds_read_b128 v[52:55], v136 offset:3072
v_mfma_f32_16x16x32_bf16 v[100:103], v[4:7], v[24:27], v[100:103]
ds_read_b128 v[56:59], v136 offset:5120
buffer_load_dwordx4 v140, s[8:11], s15 offen offset:3072 lds
v_mfma_f32_16x16x32_bf16 v[104:107], v[8:11], v[24:27], v[104:107]
ds_read_b128 v[60:63], v136 offset:7168
s_bfe_u32 s24, s62, 0x80008
v_mfma_f32_16x16x32_bf16 v[108:111], v[12:15], v[24:27], v[108:111]
v_mfma_f32_16x16x32_bf16 v[112:115], v[0:3], v[28:31], v[112:115]
s_add_u32 s15, s15, s17
s_lshr_b32 s25, s62, 16
v_mfma_f32_16x16x32_bf16 v[116:119], v[4:7], v[28:31], v[116:119]
v_mfma_f32_16x16x32_bf16 v[120:123], v[8:11], v[28:31], v[120:123]
v_mfma_f32_16x16x32_bf16 v[124:127], v[12:15], v[28:31], v[124:127]
s_cmp_eq_u32 s54, 0
s_cselect_b32 s73, 0, -1
s_cbranch_scc1 main_kernel_w_c0_task
s_waitcnt lgkmcnt(0)
v_mfma_f32_16x16x32_bf16 v[64:67], v[32:35], v[48:51], v[64:67]
s_waitcnt vmcnt(16)
s_barrier
ds_read_b128 v[16:19], v136 offset:16384
v_mfma_f32_16x16x32_bf16 v[68:71], v[36:39], v[48:51], v[68:71]
ds_read_b64_tr_b16 v[0:1], v128 offset:16384
v_mfma_f32_16x16x32_bf16 v[72:75], v[40:43], v[48:51], v[72:75]
ds_read_b64_tr_b16 v[2:3], v128 offset:20480
v_mfma_f32_16x16x32_bf16 v[76:79], v[44:47], v[48:51], v[76:79]
ds_read_b64_tr_b16 v[4:5], v129 offset:16384
v_mfma_f32_16x16x32_bf16 v[80:83], v[32:35], v[52:55], v[80:83]
ds_read_b64_tr_b16 v[6:7], v129 offset:20480
v_mfma_f32_16x16x32_bf16 v[84:87], v[36:39], v[52:55], v[84:87]
ds_read_b64_tr_b16 v[8:9], v130 offset:16384
v_mfma_f32_16x16x32_bf16 v[88:91], v[40:43], v[52:55], v[88:91]
ds_read_b64_tr_b16 v[10:11], v130 offset:20480
v_mfma_f32_16x16x32_bf16 v[92:95], v[44:47], v[52:55], v[92:95]
ds_read_b64_tr_b16 v[12:13], v131 offset:16384
v_mfma_f32_16x16x32_bf16 v[96:99], v[32:35], v[56:59], v[96:99]
ds_read_b64_tr_b16 v[14:15], v131 offset:20480
v_mfma_f32_16x16x32_bf16 v[100:103], v[36:39], v[56:59], v[100:103]
ds_read_b128 v[20:23], v136 offset:18432
v_mfma_f32_16x16x32_bf16 v[104:107], v[40:43], v[56:59], v[104:107]
ds_read_b128 v[24:27], v136 offset:20480
v_mfma_f32_16x16x32_bf16 v[108:111], v[44:47], v[56:59], v[108:111]
ds_read_b128 v[28:31], v136 offset:22528
v_mfma_f32_16x16x32_bf16 v[112:115], v[32:35], v[60:63], v[112:115]
v_mfma_f32_16x16x32_bf16 v[116:119], v[36:39], v[60:63], v[116:119]
v_mfma_f32_16x16x32_bf16 v[120:123], v[40:43], v[60:63], v[120:123]
v_mfma_f32_16x16x32_bf16 v[124:127], v[44:47], v[60:63], v[124:127]
s_waitcnt lgkmcnt(0)
ds_read_b128 v[48:51], v136 offset:17408
v_mfma_f32_16x16x32_bf16 v[64:67], v[0:3], v[16:19], v[64:67]
ds_read_b64_tr_b16 v[32:33], v128 offset:24576
v_mfma_f32_16x16x32_bf16 v[68:71], v[4:7], v[16:19], v[68:71]
ds_read_b64_tr_b16 v[34:35], v128 offset:28672
v_mfma_f32_16x16x32_bf16 v[72:75], v[8:11], v[16:19], v[72:75]
ds_read_b64_tr_b16 v[36:37], v129 offset:24576
v_mfma_f32_16x16x32_bf16 v[76:79], v[12:15], v[16:19], v[76:79]
ds_read_b64_tr_b16 v[38:39], v129 offset:28672
v_mfma_f32_16x16x32_bf16 v[80:83], v[0:3], v[20:23], v[80:83]
ds_read_b64_tr_b16 v[40:41], v130 offset:24576
v_mfma_f32_16x16x32_bf16 v[84:87], v[4:7], v[20:23], v[84:87]
ds_read_b64_tr_b16 v[42:43], v130 offset:28672
v_mfma_f32_16x16x32_bf16 v[88:91], v[8:11], v[20:23], v[88:91]
ds_read_b64_tr_b16 v[44:45], v131 offset:24576
v_mfma_f32_16x16x32_bf16 v[92:95], v[12:15], v[20:23], v[92:95]
ds_read_b64_tr_b16 v[46:47], v131 offset:28672
v_mfma_f32_16x16x32_bf16 v[96:99], v[0:3], v[24:27], v[96:99]
ds_read_b128 v[52:55], v136 offset:19456
v_mfma_f32_16x16x32_bf16 v[100:103], v[4:7], v[24:27], v[100:103]
ds_read_b128 v[56:59], v136 offset:21504
v_mfma_f32_16x16x32_bf16 v[104:107], v[8:11], v[24:27], v[104:107]
ds_read_b128 v[60:63], v136 offset:23552
v_mfma_f32_16x16x32_bf16 v[108:111], v[12:15], v[24:27], v[108:111]
v_mfma_f32_16x16x32_bf16 v[112:115], v[0:3], v[28:31], v[112:115]
v_mfma_f32_16x16x32_bf16 v[116:119], v[4:7], v[28:31], v[116:119]
v_mfma_f32_16x16x32_bf16 v[120:123], v[8:11], v[28:31], v[120:123]
v_mfma_f32_16x16x32_bf16 v[124:127], v[12:15], v[28:31], v[124:127]
s_waitcnt lgkmcnt(0)
v_mfma_f32_16x16x32_bf16 v[64:67], v[32:35], v[48:51], v[64:67]
s_waitcnt vmcnt(8)
s_barrier
ds_read_b128 v[16:19], v136 offset:32768
v_mfma_f32_16x16x32_bf16 v[68:71], v[36:39], v[48:51], v[68:71]
ds_read_b64_tr_b16 v[0:1], v128 offset:32768
v_mfma_f32_16x16x32_bf16 v[72:75], v[40:43], v[48:51], v[72:75]
ds_read_b64_tr_b16 v[2:3], v128 offset:36864
v_mfma_f32_16x16x32_bf16 v[76:79], v[44:47], v[48:51], v[76:79]
ds_read_b64_tr_b16 v[4:5], v129 offset:32768
v_mfma_f32_16x16x32_bf16 v[80:83], v[32:35], v[52:55], v[80:83]
ds_read_b64_tr_b16 v[6:7], v129 offset:36864
v_mfma_f32_16x16x32_bf16 v[84:87], v[36:39], v[52:55], v[84:87]
ds_read_b64_tr_b16 v[8:9], v130 offset:32768
v_mfma_f32_16x16x32_bf16 v[88:91], v[40:43], v[52:55], v[88:91]
ds_read_b64_tr_b16 v[10:11], v130 offset:36864
v_mfma_f32_16x16x32_bf16 v[92:95], v[44:47], v[52:55], v[92:95]
ds_read_b64_tr_b16 v[12:13], v131 offset:32768
v_mfma_f32_16x16x32_bf16 v[96:99], v[32:35], v[56:59], v[96:99]
ds_read_b64_tr_b16 v[14:15], v131 offset:36864
v_mfma_f32_16x16x32_bf16 v[100:103], v[36:39], v[56:59], v[100:103]
ds_read_b128 v[20:23], v136 offset:34816
v_mfma_f32_16x16x32_bf16 v[104:107], v[40:43], v[56:59], v[104:107]
ds_read_b128 v[24:27], v136 offset:36864
v_mfma_f32_16x16x32_bf16 v[108:111], v[44:47], v[56:59], v[108:111]
ds_read_b128 v[28:31], v136 offset:38912
v_mfma_f32_16x16x32_bf16 v[112:115], v[32:35], v[60:63], v[112:115]
v_mfma_f32_16x16x32_bf16 v[116:119], v[36:39], v[60:63], v[116:119]
v_mfma_f32_16x16x32_bf16 v[120:123], v[40:43], v[60:63], v[120:123]
v_mfma_f32_16x16x32_bf16 v[124:127], v[44:47], v[60:63], v[124:127]
s_waitcnt lgkmcnt(0)
ds_read_b128 v[48:51], v136 offset:33792
v_mfma_f32_16x16x32_bf16 v[64:67], v[0:3], v[16:19], v[64:67]
ds_read_b64_tr_b16 v[32:33], v128 offset:40960
v_mfma_f32_16x16x32_bf16 v[68:71], v[4:7], v[16:19], v[68:71]
ds_read_b64_tr_b16 v[34:35], v128 offset:45056
v_mfma_f32_16x16x32_bf16 v[72:75], v[8:11], v[16:19], v[72:75]
ds_read_b64_tr_b16 v[36:37], v129 offset:40960
v_mfma_f32_16x16x32_bf16 v[76:79], v[12:15], v[16:19], v[76:79]
ds_read_b64_tr_b16 v[38:39], v129 offset:45056
v_mfma_f32_16x16x32_bf16 v[80:83], v[0:3], v[20:23], v[80:83]
ds_read_b64_tr_b16 v[40:41], v130 offset:40960
v_mfma_f32_16x16x32_bf16 v[84:87], v[4:7], v[20:23], v[84:87]
ds_read_b64_tr_b16 v[42:43], v130 offset:45056
v_mfma_f32_16x16x32_bf16 v[88:91], v[8:11], v[20:23], v[88:91]
ds_read_b64_tr_b16 v[44:45], v131 offset:40960
v_mfma_f32_16x16x32_bf16 v[92:95], v[12:15], v[20:23], v[92:95]
ds_read_b64_tr_b16 v[46:47], v131 offset:45056
v_mfma_f32_16x16x32_bf16 v[96:99], v[0:3], v[24:27], v[96:99]
ds_read_b128 v[52:55], v136 offset:35840
v_mfma_f32_16x16x32_bf16 v[100:103], v[4:7], v[24:27], v[100:103]
ds_read_b128 v[56:59], v136 offset:37888
v_mfma_f32_16x16x32_bf16 v[104:107], v[8:11], v[24:27], v[104:107]
ds_read_b128 v[60:63], v136 offset:39936
v_mfma_f32_16x16x32_bf16 v[108:111], v[12:15], v[24:27], v[108:111]
v_mfma_f32_16x16x32_bf16 v[112:115], v[0:3], v[28:31], v[112:115]
v_mfma_f32_16x16x32_bf16 v[116:119], v[4:7], v[28:31], v[116:119]
v_mfma_f32_16x16x32_bf16 v[120:123], v[8:11], v[28:31], v[120:123]
v_mfma_f32_16x16x32_bf16 v[124:127], v[12:15], v[28:31], v[124:127]
s_waitcnt lgkmcnt(0)
v_mfma_f32_16x16x32_bf16 v[64:67], v[32:35], v[48:51], v[64:67]
s_waitcnt vmcnt(0)
s_barrier
ds_read_b128 v[16:19], v136 offset:49152
v_mfma_f32_16x16x32_bf16 v[68:71], v[36:39], v[48:51], v[68:71]
ds_read_b64_tr_b16 v[0:1], v128 offset:49152
v_mfma_f32_16x16x32_bf16 v[72:75], v[40:43], v[48:51], v[72:75]
ds_read_b64_tr_b16 v[2:3], v128 offset:53248
v_mfma_f32_16x16x32_bf16 v[76:79], v[44:47], v[48:51], v[76:79]
ds_read_b64_tr_b16 v[4:5], v129 offset:49152
v_mfma_f32_16x16x32_bf16 v[80:83], v[32:35], v[52:55], v[80:83]
ds_read_b64_tr_b16 v[6:7], v129 offset:53248
v_mfma_f32_16x16x32_bf16 v[84:87], v[36:39], v[52:55], v[84:87]
ds_read_b64_tr_b16 v[8:9], v130 offset:49152
v_mfma_f32_16x16x32_bf16 v[88:91], v[40:43], v[52:55], v[88:91]
ds_read_b64_tr_b16 v[10:11], v130 offset:53248
v_mfma_f32_16x16x32_bf16 v[92:95], v[44:47], v[52:55], v[92:95]
ds_read_b64_tr_b16 v[12:13], v131 offset:49152
v_mfma_f32_16x16x32_bf16 v[96:99], v[32:35], v[56:59], v[96:99]
ds_read_b64_tr_b16 v[14:15], v131 offset:53248
v_mfma_f32_16x16x32_bf16 v[100:103], v[36:39], v[56:59], v[100:103]
ds_read_b128 v[20:23], v136 offset:51200
v_mfma_f32_16x16x32_bf16 v[104:107], v[40:43], v[56:59], v[104:107]
ds_read_b128 v[24:27], v136 offset:53248
v_mfma_f32_16x16x32_bf16 v[108:111], v[44:47], v[56:59], v[108:111]
ds_read_b128 v[28:31], v136 offset:55296
v_mfma_f32_16x16x32_bf16 v[112:115], v[32:35], v[60:63], v[112:115]
v_mfma_f32_16x16x32_bf16 v[116:119], v[36:39], v[60:63], v[116:119]
v_mfma_f32_16x16x32_bf16 v[120:123], v[40:43], v[60:63], v[120:123]
v_mfma_f32_16x16x32_bf16 v[124:127], v[44:47], v[60:63], v[124:127]
s_waitcnt lgkmcnt(0)
ds_read_b128 v[48:51], v136 offset:50176
v_mfma_f32_16x16x32_bf16 v[64:67], v[0:3], v[16:19], v[64:67]
ds_read_b64_tr_b16 v[32:33], v128 offset:57344
v_mfma_f32_16x16x32_bf16 v[68:71], v[4:7], v[16:19], v[68:71]
ds_read_b64_tr_b16 v[34:35], v128 offset:61440
v_mfma_f32_16x16x32_bf16 v[72:75], v[8:11], v[16:19], v[72:75]
ds_read_b64_tr_b16 v[36:37], v129 offset:57344
v_mfma_f32_16x16x32_bf16 v[76:79], v[12:15], v[16:19], v[76:79]
ds_read_b64_tr_b16 v[38:39], v129 offset:61440
v_mfma_f32_16x16x32_bf16 v[80:83], v[0:3], v[20:23], v[80:83]
ds_read_b64_tr_b16 v[40:41], v130 offset:57344
v_mfma_f32_16x16x32_bf16 v[84:87], v[4:7], v[20:23], v[84:87]
ds_read_b64_tr_b16 v[42:43], v130 offset:61440
v_mfma_f32_16x16x32_bf16 v[88:91], v[8:11], v[20:23], v[88:91]
ds_read_b64_tr_b16 v[44:45], v131 offset:57344
v_mfma_f32_16x16x32_bf16 v[92:95], v[12:15], v[20:23], v[92:95]
ds_read_b64_tr_b16 v[46:47], v131 offset:61440
v_mfma_f32_16x16x32_bf16 v[96:99], v[0:3], v[24:27], v[96:99]
ds_read_b128 v[52:55], v136 offset:52224
v_mfma_f32_16x16x32_bf16 v[100:103], v[4:7], v[24:27], v[100:103]
ds_read_b128 v[56:59], v136 offset:54272
v_mfma_f32_16x16x32_bf16 v[104:107], v[8:11], v[24:27], v[104:107]
ds_read_b128 v[60:63], v136 offset:56320
v_mfma_f32_16x16x32_bf16 v[108:111], v[12:15], v[24:27], v[108:111]
v_mfma_f32_16x16x32_bf16 v[112:115], v[0:3], v[28:31], v[112:115]
v_mfma_f32_16x16x32_bf16 v[116:119], v[4:7], v[28:31], v[116:119]
v_mfma_f32_16x16x32_bf16 v[120:123], v[8:11], v[28:31], v[120:123]
v_mfma_f32_16x16x32_bf16 v[124:127], v[12:15], v[28:31], v[124:127]
s_waitcnt lgkmcnt(0)
v_mfma_f32_16x16x32_bf16 v[64:67], v[32:35], v[48:51], v[64:67]
s_barrier
v_mfma_f32_16x16x32_bf16 v[68:71], v[36:39], v[48:51], v[68:71]
v_mfma_f32_16x16x32_bf16 v[72:75], v[40:43], v[48:51], v[72:75]
v_mfma_f32_16x16x32_bf16 v[76:79], v[44:47], v[48:51], v[76:79]
v_mfma_f32_16x16x32_bf16 v[80:83], v[32:35], v[52:55], v[80:83]
v_mfma_f32_16x16x32_bf16 v[84:87], v[36:39], v[52:55], v[84:87]
v_mfma_f32_16x16x32_bf16 v[88:91], v[40:43], v[52:55], v[88:91]
v_mfma_f32_16x16x32_bf16 v[92:95], v[44:47], v[52:55], v[92:95]
v_mfma_f32_16x16x32_bf16 v[96:99], v[32:35], v[56:59], v[96:99]
v_mfma_f32_16x16x32_bf16 v[100:103], v[36:39], v[56:59], v[100:103]
v_mfma_f32_16x16x32_bf16 v[104:107], v[40:43], v[56:59], v[104:107]
v_mfma_f32_16x16x32_bf16 v[108:111], v[44:47], v[56:59], v[108:111]
v_mfma_f32_16x16x32_bf16 v[112:115], v[32:35], v[60:63], v[112:115]
v_mfma_f32_16x16x32_bf16 v[116:119], v[36:39], v[60:63], v[116:119]
v_mfma_f32_16x16x32_bf16 v[120:123], v[40:43], v[60:63], v[120:123]
v_mfma_f32_16x16x32_bf16 v[124:127], v[44:47], v[60:63], v[124:127]
s_cmp_lg_u32 s62, -4
s_cbranch_scc1 main_kernel_w_gemm
s_branch main_kernel_w_slow
main_kernel_w_c0_n_ev:
s_mov_b32 s55, 1
s_cmp_eq_u32 s56, 0
s_cbranch_scc1 main_kernel_w_c0_n_et
s_bfm_b64 exec, s0, 0
buffer_store_dword v244, v248, s[4:7], s59 offen sc1
s_mov_b64 exec, -1
s_mov_b32 s56, 0
main_kernel_w_c0_n_et:
s_cmp_lg_u32 s18, 1
s_cbranch_scc1 main_kernel_w_c0_n_loop
s_lshl_b32 s32, s27, 8
s_add_u32 s32, s32, 0x841e000
s_mov_b64 exec, 1
v_mov_b32 v249, 1
buffer_atomic_add v249, off, s[4:7], s32 sc0 sc1
s_mov_b64 exec, -1
s_branch main_kernel_w_c0_n_loop
main_kernel_w_c0_gov:
s_mov_b32 s58, 1
s_mov_b32 s72, s18
s_cmp_lg_u32 s73, -1
s_cbranch_scc1 main_kernel_w_c0_str
s_waitcnt lgkmcnt(0)
v_lshrrev_b32 v0, 4, v250
v_bfe_u32 v1, v250, 2, 2
v_lshl_add_u32 v4, v0, 2, v1
v_and_b32 v5, 7, v4
v_mul_u32_u24 v4, 256, v4
v_and_b32 v6, 3, v250
v_lshl_add_u32 v4, v6, 3, v4
s_mul_i32 s32, s37, 4
v_xor_b32 v5, s32, v5
v_lshl_add_u32 v128, v5, 5, v4
v_xor_b32 v129, 32, v128
v_xor_b32 v130, 64, v128
v_xor_b32 v131, 96, v128
s_mul_i32 s32, s38, 8192
s_add_u32 s32, s32, 65536
v_add_u32 v136, s32, v251
v_lshrrev_b32 v2, 4, v250
v_and_b32 v3, 15, v250
s_mul_i32 s32, s14, 16
v_add_u32 v147, s32, v2
v_and_b32 v6, 7, v147
v_lshlrev_b32 v6, 1, v6
v_xor_b32 v6, v6, v3
v_lshlrev_b32 v151, 4, v6
v_add_u32 v148, 4, v147
v_and_b32 v6, 7, v148
v_lshlrev_b32 v6, 1, v6
v_xor_b32 v6, v6, v3
v_lshlrev_b32 v152, 4, v6
v_subrev_u32 v152, 1024, v152
v_add_u32 v149, 8, v147
v_and_b32 v6, 7, v149
v_lshlrev_b32 v6, 1, v6
v_xor_b32 v6, v6, v3
v_lshlrev_b32 v153, 4, v6
v_subrev_u32 v153, 2048, v153
v_add_u32 v150, 12, v147
v_and_b32 v6, 7, v150
v_lshlrev_b32 v6, 1, v6
v_xor_b32 v6, v6, v3
v_lshlrev_b32 v154, 4, v6
v_subrev_u32 v154, 3072, v154
s_mul_i32 s19, s14, 4096
s_mul_i32 s20, s14, 4096
s_add_u32 s20, s20, 65536
s_mul_i32 s32, s14, 2
s_mul_i32 s32, s32, s31
v_mad_u32_u24 v137, v147, s30, v151
v_mad_u32_u24 v138, v148, s30, v152
v_mad_u32_u24 v139, v149, s30, v153
v_mad_u32_u24 v140, v150, s30, v154
v_add_u32 v141, s32, v251
s_add_u32 s32, s32, s31
s_sub_u32 s32, s32, 2048
v_add_u32 v142, s32, v251
s_mul_i32 s17, s30, 64
s_mov_b32 s15, 0
s_waitcnt vmcnt(0)
s_add_u32 m0, s20, 0
s_nop 0
buffer_load_dwordx4 v141, s[4:7], s16 offen offset:0 sc1 lds
buffer_load_dwordx4 v141, s[4:7], s16 offen offset:1024 sc1 lds
buffer_load_dwordx4 v142, s[4:7], s16 offen offset:2048 sc1 lds
buffer_load_dwordx4 v142, s[4:7], s16 offen offset:3072 sc1 lds
s_add_u32 s16, s16, 2048
s_add_u32 m0, s19, 0
s_nop 0
buffer_load_dwordx4 v137, s[8:11], s15 offen offset:0 lds
buffer_load_dwordx4 v138, s[8:11], s15 offen offset:1024 lds
buffer_load_dwordx4 v139, s[8:11], s15 offen offset:2048 lds
buffer_load_dwordx4 v140, s[8:11], s15 offen offset:3072 lds
s_add_u32 s15, s15, s17
s_add_u32 m0, s20, 16384
s_nop 0
buffer_load_dwordx4 v141, s[4:7], s16 offen offset:0 sc1 lds
buffer_load_dwordx4 v141, s[4:7], s16 offen offset:1024 sc1 lds
buffer_load_dwordx4 v142, s[4:7], s16 offen offset:2048 sc1 lds
buffer_load_dwordx4 v142, s[4:7], s16 offen offset:3072 sc1 lds
s_add_u32 s16, s16, 2048
s_add_u32 m0, s19, 16384
s_nop 0
buffer_load_dwordx4 v137, s[8:11], s15 offen offset:0 lds
buffer_load_dwordx4 v138, s[8:11], s15 offen offset:1024 lds
buffer_load_dwordx4 v139, s[8:11], s15 offen offset:2048 lds
buffer_load_dwordx4 v140, s[8:11], s15 offen offset:3072 lds
s_add_u32 s15, s15, s17
s_add_u32 m0, s20, 32768
s_nop 0
buffer_load_dwordx4 v141, s[4:7], s16 offen offset:0 sc1 lds
buffer_load_dwordx4 v141, s[4:7], s16 offen offset:1024 sc1 lds
buffer_load_dwordx4 v142, s[4:7], s16 offen offset:2048 sc1 lds
buffer_load_dwordx4 v142, s[4:7], s16 offen offset:3072 sc1 lds
s_add_u32 s16, s16, 2048
s_add_u32 m0, s19, 32768
s_nop 0
buffer_load_dwordx4 v137, s[8:11], s15 offen offset:0 lds
buffer_load_dwordx4 v138, s[8:11], s15 offen offset:1024 lds
buffer_load_dwordx4 v139, s[8:11], s15 offen offset:2048 lds
buffer_load_dwordx4 v140, s[8:11], s15 offen offset:3072 lds
s_add_u32 s15, s15, s17
s_add_u32 m0, s20, 49152
s_nop 0
buffer_load_dwordx4 v141, s[4:7], s16 offen offset:0 sc1 lds
buffer_load_dwordx4 v141, s[4:7], s16 offen offset:1024 sc1 lds
buffer_load_dwordx4 v142, s[4:7], s16 offen offset:2048 sc1 lds
buffer_load_dwordx4 v142, s[4:7], s16 offen offset:3072 sc1 lds
s_add_u32 s16, s16, 2048
s_cmp_lg_u32 s56, 0
s_cbranch_scc1 main_kernel_w_epi
main_kernel_w_c0_v_ent:
v_mfma_f32_32x32x16_bf16 v[64:79], v[224:227], v[224:227], 0
s_waitcnt vmcnt(20)
s_barrier
ds_read_b128 v[16:19], v136 offset:0
ds_read_b64_tr_b16 v[0:1], v128 offset:0
ds_read_b64_tr_b16 v[2:3], v128 offset:4096
v_mfma_f32_32x32x16_bf16 v[80:95], v[224:227], v[224:227], 0
ds_read_b64_tr_b16 v[4:5], v129 offset:0
ds_read_b64_tr_b16 v[6:7], v129 offset:4096
ds_read_b64_tr_b16 v[8:9], v130 offset:0
v_mfma_f32_32x32x16_bf16 v[96:111], v[224:227], v[224:227], 0
ds_read_b64_tr_b16 v[10:11], v130 offset:4096
ds_read_b64_tr_b16 v[12:13], v131 offset:0
ds_read_b64_tr_b16 v[14:15], v131 offset:4096
v_mfma_f32_32x32x16_bf16 v[112:127], v[224:227], v[224:227], 0
ds_read_b128 v[20:23], v136 offset:2048
ds_read_b128 v[24:27], v136 offset:4096
ds_read_b128 v[28:31], v136 offset:6144
s_sub_u32 s18, s72, 1
s_sub_u32 s55, s72, 2
s_orn2_b32 s55, s55, s100
s_mov_b32 s73, -1
s_nop 0
main_kernel_w_c0_v_loop:
s_waitcnt lgkmcnt(0)
ds_read_b128 v[48:51], v136 offset:1024
s_add_u32 m0, s19, 49152
s_nop 0
v_mfma_f32_16x16x32_bf16 v[64:67], v[16:19], v[0:3], v[64:67]
ds_read_b64_tr_b16 v[32:33], v128 offset:8192
v_mfma_f32_16x16x32_bf16 v[68:71], v[16:19], v[4:7], v[68:71]
ds_read_b64_tr_b16 v[34:35], v128 offset:12288
buffer_load_dwordx4 v137, s[8:11], s15 offen offset:0 lds
v_mfma_f32_16x16x32_bf16 v[72:75], v[16:19], v[8:11], v[72:75]
ds_read_b64_tr_b16 v[36:37], v129 offset:8192
v_mfma_f32_16x16x32_bf16 v[76:79], v[16:19], v[12:15], v[76:79]
ds_read_b64_tr_b16 v[38:39], v129 offset:12288
v_mfma_f32_16x16x32_bf16 v[80:83], v[20:23], v[0:3], v[80:83]
ds_read_b64_tr_b16 v[40:41], v130 offset:8192
buffer_load_dwordx4 v138, s[8:11], s15 offen offset:1024 lds
v_mfma_f32_16x16x32_bf16 v[84:87], v[20:23], v[4:7], v[84:87]
ds_read_b64_tr_b16 v[42:43], v130 offset:12288
v_mfma_f32_16x16x32_bf16 v[88:91], v[20:23], v[8:11], v[88:91]
ds_read_b64_tr_b16 v[44:45], v131 offset:8192
v_mfma_f32_16x16x32_bf16 v[92:95], v[20:23], v[12:15], v[92:95]
ds_read_b64_tr_b16 v[46:47], v131 offset:12288
buffer_load_dwordx4 v139, s[8:11], s15 offen offset:2048 lds
v_mfma_f32_16x16x32_bf16 v[96:99], v[24:27], v[0:3], v[96:99]
ds_read_b128 v[52:55], v136 offset:3072
v_mfma_f32_16x16x32_bf16 v[100:103], v[24:27], v[4:7], v[100:103]
ds_read_b128 v[56:59], v136 offset:5120
buffer_load_dwordx4 v140, s[8:11], s15 offen offset:3072 lds
v_mfma_f32_16x16x32_bf16 v[104:107], v[24:27], v[8:11], v[104:107]
ds_read_b128 v[60:63], v136 offset:7168
v_mfma_f32_16x16x32_bf16 v[108:111], v[24:27], v[12:15], v[108:111]
v_mfma_f32_16x16x32_bf16 v[112:115], v[28:31], v[0:3], v[112:115]
s_add_u32 s15, s15, s17
v_mfma_f32_16x16x32_bf16 v[116:119], v[28:31], v[4:7], v[116:119]
v_mfma_f32_16x16x32_bf16 v[120:123], v[28:31], v[8:11], v[120:123]
v_mfma_f32_16x16x32_bf16 v[124:127], v[28:31], v[12:15], v[124:127]
main_kernel_w_c0_v_mid:
s_waitcnt lgkmcnt(0)
v_mfma_f32_16x16x32_bf16 v[64:67], v[48:51], v[32:35], v[64:67]
s_waitcnt vmcnt(16)
s_barrier
ds_read_b128 v[16:19], v136 offset:16384
s_add_u32 m0, s20, 0
s_nop 0
v_mfma_f32_16x16x32_bf16 v[68:71], v[48:51], v[36:39], v[68:71]
ds_read_b64_tr_b16 v[0:1], v128 offset:16384
v_mfma_f32_16x16x32_bf16 v[72:75], v[48:51], v[40:43], v[72:75]
ds_read_b64_tr_b16 v[2:3], v128 offset:20480
buffer_load_dwordx4 v141, s[4:7], s16 offen offset:0 sc1 lds
v_mfma_f32_16x16x32_bf16 v[76:79], v[48:51], v[44:47], v[76:79]
ds_read_b64_tr_b16 v[4:5], v129 offset:16384
v_mfma_f32_16x16x32_bf16 v[80:83], v[52:55], v[32:35], v[80:83]
ds_read_b64_tr_b16 v[6:7], v129 offset:20480
v_mfma_f32_16x16x32_bf16 v[84:87], v[52:55], v[36:39], v[84:87]
ds_read_b64_tr_b16 v[8:9], v130 offset:16384
buffer_load_dwordx4 v141, s[4:7], s16 offen offset:1024 sc1 lds
v_mfma_f32_16x16x32_bf16 v[88:91], v[52:55], v[40:43], v[88:91]
ds_read_b64_tr_b16 v[10:11], v130 offset:20480
v_mfma_f32_16x16x32_bf16 v[92:95], v[52:55], v[44:47], v[92:95]
ds_read_b64_tr_b16 v[12:13], v131 offset:16384
buffer_load_dwordx4 v142, s[4:7], s16 offen offset:2048 sc1 lds
v_mfma_f32_16x16x32_bf16 v[96:99], v[56:59], v[32:35], v[96:99]
ds_read_b64_tr_b16 v[14:15], v131 offset:20480
v_mfma_f32_16x16x32_bf16 v[100:103], v[56:59], v[36:39], v[100:103]
ds_read_b128 v[20:23], v136 offset:18432
v_mfma_f32_16x16x32_bf16 v[104:107], v[56:59], v[40:43], v[104:107]
ds_read_b128 v[24:27], v136 offset:20480
buffer_load_dwordx4 v142, s[4:7], s16 offen offset:3072 sc1 lds
v_mfma_f32_16x16x32_bf16 v[108:111], v[56:59], v[44:47], v[108:111]
ds_read_b128 v[28:31], v136 offset:22528
v_mfma_f32_16x16x32_bf16 v[112:115], v[60:63], v[32:35], v[112:115]
s_add_u32 s16, s16, 2048
v_mfma_f32_16x16x32_bf16 v[116:119], v[60:63], v[36:39], v[116:119]
v_mfma_f32_16x16x32_bf16 v[120:123], v[60:63], v[40:43], v[120:123]
v_mfma_f32_16x16x32_bf16 v[124:127], v[60:63], v[44:47], v[124:127]
s_waitcnt lgkmcnt(0)
ds_read_b128 v[48:51], v136 offset:17408
s_add_u32 m0, s19, 0
s_nop 0
v_mfma_f32_16x16x32_bf16 v[64:67], v[16:19], v[0:3], v[64:67]
ds_read_b64_tr_b16 v[32:33], v128 offset:24576
v_mfma_f32_16x16x32_bf16 v[68:71], v[16:19], v[4:7], v[68:71]
ds_read_b64_tr_b16 v[34:35], v128 offset:28672
buffer_load_dwordx4 v137, s[8:11], s15 offen offset:0 lds
v_mfma_f32_16x16x32_bf16 v[72:75], v[16:19], v[8:11], v[72:75]
ds_read_b64_tr_b16 v[36:37], v129 offset:24576
v_mfma_f32_16x16x32_bf16 v[76:79], v[16:19], v[12:15], v[76:79]
ds_read_b64_tr_b16 v[38:39], v129 offset:28672
v_mfma_f32_16x16x32_bf16 v[80:83], v[20:23], v[0:3], v[80:83]
ds_read_b64_tr_b16 v[40:41], v130 offset:24576
buffer_load_dwordx4 v138, s[8:11], s15 offen offset:1024 lds
v_mfma_f32_16x16x32_bf16 v[84:87], v[20:23], v[4:7], v[84:87]
ds_read_b64_tr_b16 v[42:43], v130 offset:28672
v_mfma_f32_16x16x32_bf16 v[88:91], v[20:23], v[8:11], v[88:91]
ds_read_b64_tr_b16 v[44:45], v131 offset:24576
v_mfma_f32_16x16x32_bf16 v[92:95], v[20:23], v[12:15], v[92:95]
ds_read_b64_tr_b16 v[46:47], v131 offset:28672
buffer_load_dwordx4 v139, s[8:11], s15 offen offset:2048 lds
v_mfma_f32_16x16x32_bf16 v[96:99], v[24:27], v[0:3], v[96:99]
ds_read_b128 v[52:55], v136 offset:19456
v_mfma_f32_16x16x32_bf16 v[100:103], v[24:27], v[4:7], v[100:103]
ds_read_b128 v[56:59], v136 offset:21504
buffer_load_dwordx4 v140, s[8:11], s15 offen offset:3072 lds
v_mfma_f32_16x16x32_bf16 v[104:107], v[24:27], v[8:11], v[104:107]
ds_read_b128 v[60:63], v136 offset:23552
v_mfma_f32_16x16x32_bf16 v[108:111], v[24:27], v[12:15], v[108:111]
v_mfma_f32_16x16x32_bf16 v[112:115], v[28:31], v[0:3], v[112:115]
s_add_u32 s15, s15, s17
v_mfma_f32_16x16x32_bf16 v[116:119], v[28:31], v[4:7], v[116:119]
v_mfma_f32_16x16x32_bf16 v[120:123], v[28:31], v[8:11], v[120:123]
v_mfma_f32_16x16x32_bf16 v[124:127], v[28:31], v[12:15], v[124:127]
s_waitcnt lgkmcnt(0)
v_mfma_f32_16x16x32_bf16 v[64:67], v[48:51], v[32:35], v[64:67]
s_waitcnt vmcnt(16)
s_barrier
ds_read_b128 v[16:19], v136 offset:32768
s_add_u32 m0, s20, 16384
s_nop 0
v_mfma_f32_16x16x32_bf16 v[68:71], v[48:51], v[36:39], v[68:71]
ds_read_b64_tr_b16 v[0:1], v128 offset:32768
v_mfma_f32_16x16x32_bf16 v[72:75], v[48:51], v[40:43], v[72:75]
ds_read_b64_tr_b16 v[2:3], v128 offset:36864
buffer_load_dwordx4 v141, s[4:7], s16 offen offset:0 sc1 lds
v_mfma_f32_16x16x32_bf16 v[76:79], v[48:51], v[44:47], v[76:79]
ds_read_b64_tr_b16 v[4:5], v129 offset:32768
v_mfma_f32_16x16x32_bf16 v[80:83], v[52:55], v[32:35], v[80:83]
ds_read_b64_tr_b16 v[6:7], v129 offset:36864
v_mfma_f32_16x16x32_bf16 v[84:87], v[52:55], v[36:39], v[84:87]
ds_read_b64_tr_b16 v[8:9], v130 offset:32768
buffer_load_dwordx4 v141, s[4:7], s16 offen offset:1024 sc1 lds
v_mfma_f32_16x16x32_bf16 v[88:91], v[52:55], v[40:43], v[88:91]
ds_read_b64_tr_b16 v[10:11], v130 offset:36864
v_mfma_f32_16x16x32_bf16 v[92:95], v[52:55], v[44:47], v[92:95]
ds_read_b64_tr_b16 v[12:13], v131 offset:32768
buffer_load_dwordx4 v142, s[4:7], s16 offen offset:2048 sc1 lds
v_mfma_f32_16x16x32_bf16 v[96:99], v[56:59], v[32:35], v[96:99]
ds_read_b64_tr_b16 v[14:15], v131 offset:36864
v_mfma_f32_16x16x32_bf16 v[100:103], v[56:59], v[36:39], v[100:103]
ds_read_b128 v[20:23], v136 offset:34816
v_mfma_f32_16x16x32_bf16 v[104:107], v[56:59], v[40:43], v[104:107]
ds_read_b128 v[24:27], v136 offset:36864
buffer_load_dwordx4 v142, s[4:7], s16 offen offset:3072 sc1 lds
v_mfma_f32_16x16x32_bf16 v[108:111], v[56:59], v[44:47], v[108:111]
ds_read_b128 v[28:31], v136 offset:38912
v_mfma_f32_16x16x32_bf16 v[112:115], v[60:63], v[32:35], v[112:115]
s_add_u32 s16, s16, 2048
v_mfma_f32_16x16x32_bf16 v[116:119], v[60:63], v[36:39], v[116:119]
v_mfma_f32_16x16x32_bf16 v[120:123], v[60:63], v[40:43], v[120:123]
v_mfma_f32_16x16x32_bf16 v[124:127], v[60:63], v[44:47], v[124:127]
s_waitcnt lgkmcnt(0)
ds_read_b128 v[48:51], v136 offset:33792
s_add_u32 m0, s19, 16384
s_nop 0
v_mfma_f32_16x16x32_bf16 v[64:67], v[16:19], v[0:3], v[64:67]
ds_read_b64_tr_b16 v[32:33], v128 offset:40960
v_mfma_f32_16x16x32_bf16 v[68:71], v[16:19], v[4:7], v[68:71]
ds_read_b64_tr_b16 v[34:35], v128 offset:45056
buffer_load_dwordx4 v137, s[8:11], s15 offen offset:0 lds
v_mfma_f32_16x16x32_bf16 v[72:75], v[16:19], v[8:11], v[72:75]
ds_read_b64_tr_b16 v[36:37], v129 offset:40960
v_mfma_f32_16x16x32_bf16 v[76:79], v[16:19], v[12:15], v[76:79]
ds_read_b64_tr_b16 v[38:39], v129 offset:45056
v_mfma_f32_16x16x32_bf16 v[80:83], v[20:23], v[0:3], v[80:83]
ds_read_b64_tr_b16 v[40:41], v130 offset:40960
buffer_load_dwordx4 v138, s[8:11], s15 offen offset:1024 lds
v_mfma_f32_16x16x32_bf16 v[84:87], v[20:23], v[4:7], v[84:87]
ds_read_b64_tr_b16 v[42:43], v130 offset:45056
v_mfma_f32_16x16x32_bf16 v[88:91], v[20:23], v[8:11], v[88:91]
ds_read_b64_tr_b16 v[44:45], v131 offset:40960
v_mfma_f32_16x16x32_bf16 v[92:95], v[20:23], v[12:15], v[92:95]
ds_read_b64_tr_b16 v[46:47], v131 offset:45056
buffer_load_dwordx4 v139, s[8:11], s15 offen offset:2048 lds
v_mfma_f32_16x16x32_bf16 v[96:99], v[24:27], v[0:3], v[96:99]
ds_read_b128 v[52:55], v136 offset:35840
v_mfma_f32_16x16x32_bf16 v[100:103], v[24:27], v[4:7], v[100:103]
ds_read_b128 v[56:59], v136 offset:37888
buffer_load_dwordx4 v140, s[8:11], s15 offen offset:3072 lds
v_mfma_f32_16x16x32_bf16 v[104:107], v[24:27], v[8:11], v[104:107]
ds_read_b128 v[60:63], v136 offset:39936
v_mfma_f32_16x16x32_bf16 v[108:111], v[24:27], v[12:15], v[108:111]
v_mfma_f32_16x16x32_bf16 v[112:115], v[28:31], v[0:3], v[112:115]
s_add_u32 s15, s15, s17
v_mfma_f32_16x16x32_bf16 v[116:119], v[28:31], v[4:7], v[116:119]
v_mfma_f32_16x16x32_bf16 v[120:123], v[28:31], v[8:11], v[120:123]
v_mfma_f32_16x16x32_bf16 v[124:127], v[28:31], v[12:15], v[124:127]
s_waitcnt lgkmcnt(0)
v_mfma_f32_16x16x32_bf16 v[64:67], v[48:51], v[32:35], v[64:67]
s_waitcnt vmcnt(16)
s_barrier
ds_read_b128 v[16:19], v136 offset:49152
s_add_u32 m0, s20, 32768
s_nop 0
v_mfma_f32_16x16x32_bf16 v[68:71], v[48:51], v[36:39], v[68:71]
ds_read_b64_tr_b16 v[0:1], v128 offset:49152
v_mfma_f32_16x16x32_bf16 v[72:75], v[48:51], v[40:43], v[72:75]
ds_read_b64_tr_b16 v[2:3], v128 offset:53248
buffer_load_dwordx4 v141, s[4:7], s16 offen offset:0 sc1 lds
v_mfma_f32_16x16x32_bf16 v[76:79], v[48:51], v[44:47], v[76:79]
ds_read_b64_tr_b16 v[4:5], v129 offset:49152
v_mfma_f32_16x16x32_bf16 v[80:83], v[52:55], v[32:35], v[80:83]
ds_read_b64_tr_b16 v[6:7], v129 offset:53248
v_mfma_f32_16x16x32_bf16 v[84:87], v[52:55], v[36:39], v[84:87]
ds_read_b64_tr_b16 v[8:9], v130 offset:49152
buffer_load_dwordx4 v141, s[4:7], s16 offen offset:1024 sc1 lds
v_mfma_f32_16x16x32_bf16 v[88:91], v[52:55], v[40:43], v[88:91]
ds_read_b64_tr_b16 v[10:11], v130 offset:53248
v_mfma_f32_16x16x32_bf16 v[92:95], v[52:55], v[44:47], v[92:95]
ds_read_b64_tr_b16 v[12:13], v131 offset:49152
buffer_load_dwordx4 v142, s[4:7], s16 offen offset:2048 sc1 lds
v_mfma_f32_16x16x32_bf16 v[96:99], v[56:59], v[32:35], v[96:99]
ds_read_b64_tr_b16 v[14:15], v131 offset:53248
v_mfma_f32_16x16x32_bf16 v[100:103], v[56:59], v[36:39], v[100:103]
ds_read_b128 v[20:23], v136 offset:51200
v_mfma_f32_16x16x32_bf16 v[104:107], v[56:59], v[40:43], v[104:107]
ds_read_b128 v[24:27], v136 offset:53248
buffer_load_dwordx4 v142, s[4:7], s16 offen offset:3072 sc1 lds
v_mfma_f32_16x16x32_bf16 v[108:111], v[56:59], v[44:47], v[108:111]
ds_read_b128 v[28:31], v136 offset:55296
v_mfma_f32_16x16x32_bf16 v[112:115], v[60:63], v[32:35], v[112:115]
s_add_u32 s16, s16, 2048
v_mfma_f32_16x16x32_bf16 v[116:119], v[60:63], v[36:39], v[116:119]
v_mfma_f32_16x16x32_bf16 v[120:123], v[60:63], v[40:43], v[120:123]
v_mfma_f32_16x16x32_bf16 v[124:127], v[60:63], v[44:47], v[124:127]
s_waitcnt lgkmcnt(0)
ds_read_b128 v[48:51], v136 offset:50176
s_add_u32 m0, s19, 32768
s_nop 0
v_mfma_f32_16x16x32_bf16 v[64:67], v[16:19], v[0:3], v[64:67]
ds_read_b64_tr_b16 v[32:33], v128 offset:57344
v_mfma_f32_16x16x32_bf16 v[68:71], v[16:19], v[4:7], v[68:71]
ds_read_b64_tr_b16 v[34:35], v128 offset:61440
buffer_load_dwordx4 v137, s[8:11], s15 offen offset:0 lds
v_mfma_f32_16x16x32_bf16 v[72:75], v[16:19], v[8:11], v[72:75]
ds_read_b64_tr_b16 v[36:37], v129 offset:57344
v_mfma_f32_16x16x32_bf16 v[76:79], v[16:19], v[12:15], v[76:79]
ds_read_b64_tr_b16 v[38:39], v129 offset:61440
v_mfma_f32_16x16x32_bf16 v[80:83], v[20:23], v[0:3], v[80:83]
ds_read_b64_tr_b16 v[40:41], v130 offset:57344
buffer_load_dwordx4 v138, s[8:11], s15 offen offset:1024 lds
v_mfma_f32_16x16x32_bf16 v[84:87], v[20:23], v[4:7], v[84:87]
ds_read_b64_tr_b16 v[42:43], v130 offset:61440
v_mfma_f32_16x16x32_bf16 v[88:91], v[20:23], v[8:11], v[88:91]
ds_read_b64_tr_b16 v[44:45], v131 offset:57344
v_mfma_f32_16x16x32_bf16 v[92:95], v[20:23], v[12:15], v[92:95]
ds_read_b64_tr_b16 v[46:47], v131 offset:61440
buffer_load_dwordx4 v139, s[8:11], s15 offen offset:2048 lds
v_mfma_f32_16x16x32_bf16 v[96:99], v[24:27], v[0:3], v[96:99]
ds_read_b128 v[52:55], v136 offset:52224
v_mfma_f32_16x16x32_bf16 v[100:103], v[24:27], v[4:7], v[100:103]
ds_read_b128 v[56:59], v136 offset:54272
buffer_load_dwordx4 v140, s[8:11], s15 offen offset:3072 lds
v_mfma_f32_16x16x32_bf16 v[104:107], v[24:27], v[8:11], v[104:107]
ds_read_b128 v[60:63], v136 offset:56320
v_mfma_f32_16x16x32_bf16 v[108:111], v[24:27], v[12:15], v[108:111]
v_mfma_f32_16x16x32_bf16 v[112:115], v[28:31], v[0:3], v[112:115]
s_add_u32 s15, s15, s17
v_mfma_f32_16x16x32_bf16 v[116:119], v[28:31], v[4:7], v[116:119]
v_mfma_f32_16x16x32_bf16 v[120:123], v[28:31], v[8:11], v[120:123]
v_mfma_f32_16x16x32_bf16 v[124:127], v[28:31], v[12:15], v[124:127]
s_waitcnt lgkmcnt(0)
v_mfma_f32_16x16x32_bf16 v[64:67], v[48:51], v[32:35], v[64:67]
s_waitcnt vmcnt(16)
s_barrier
ds_read_b128 v[16:19], v136 offset:0
s_add_u32 m0, s20, 49152
s_nop 0
v_mfma_f32_16x16x32_bf16 v[68:71], v[48:51], v[36:39], v[68:71]
ds_read_b64_tr_b16 v[0:1], v128 offset:0
v_mfma_f32_16x16x32_bf16 v[72:75], v[48:51], v[40:43], v[72:75]
ds_read_b64_tr_b16 v[2:3], v128 offset:4096
buffer_load_dwordx4 v141, s[4:7], s16 offen offset:0 sc1 lds
v_mfma_f32_16x16x32_bf16 v[76:79], v[48:51], v[44:47], v[76:79]
ds_read_b64_tr_b16 v[4:5], v129 offset:0
v_mfma_f32_16x16x32_bf16 v[80:83], v[52:55], v[32:35], v[80:83]
ds_read_b64_tr_b16 v[6:7], v129 offset:4096
v_mfma_f32_16x16x32_bf16 v[84:87], v[52:55], v[36:39], v[84:87]
ds_read_b64_tr_b16 v[8:9], v130 offset:0
buffer_load_dwordx4 v141, s[4:7], s16 offen offset:1024 sc1 lds
v_mfma_f32_16x16x32_bf16 v[88:91], v[52:55], v[40:43], v[88:91]
ds_read_b64_tr_b16 v[10:11], v130 offset:4096
v_mfma_f32_16x16x32_bf16 v[92:95], v[52:55], v[44:47], v[92:95]
ds_read_b64_tr_b16 v[12:13], v131 offset:0
buffer_load_dwordx4 v142, s[4:7], s16 offen offset:2048 sc1 lds
v_mfma_f32_16x16x32_bf16 v[96:99], v[56:59], v[32:35], v[96:99]
ds_read_b64_tr_b16 v[14:15], v131 offset:4096
v_mfma_f32_16x16x32_bf16 v[100:103], v[56:59], v[36:39], v[100:103]
ds_read_b128 v[20:23], v136 offset:2048
v_mfma_f32_16x16x32_bf16 v[104:107], v[56:59], v[40:43], v[104:107]
ds_read_b128 v[24:27], v136 offset:4096
buffer_load_dwordx4 v142, s[4:7], s16 offen offset:3072 sc1 lds
v_mfma_f32_16x16x32_bf16 v[108:111], v[56:59], v[44:47], v[108:111]
ds_read_b128 v[28:31], v136 offset:6144
v_mfma_f32_16x16x32_bf16 v[112:115], v[60:63], v[32:35], v[112:115]
s_add_u32 s16, s16, 2048
v_mfma_f32_16x16x32_bf16 v[116:119], v[60:63], v[36:39], v[116:119]
v_mfma_f32_16x16x32_bf16 v[120:123], v[60:63], v[40:43], v[120:123]
v_mfma_f32_16x16x32_bf16 v[124:127], v[60:63], v[44:47], v[124:127]
s_sub_u32 s18, s18, 1
s_cmp_eq_u32 s18, s55
s_cbranch_scc1 main_kernel_w_c0_v_ev
s_cmp_lg_u32 s18, 0
s_cbranch_scc1 main_kernel_w_c0_v_loop
s_cmp_lg_u32 s73, -1
s_cbranch_scc1 main_kernel_w_epn
s_waitcnt lgkmcnt(0)
ds_read_b128 v[48:51], v136 offset:1024
s_add_u32 m0, s19, 49152
s_nop 0
v_mfma_f32_16x16x32_bf16 v[64:67], v[16:19], v[0:3], v[64:67]
ds_read_b64_tr_b16 v[32:33], v128 offset:8192
s_add_u32 s32, s23, 1
s_bitcmp0_b32 s32, 2
s_cselect_b32 s34, 7, 2
s_cselect_b32 s35, 2, 4
s_lshl_b32 s59, s23, 13
s_add_u32 s59, s59, 0x8404000
v_mfma_f32_16x16x32_bf16 v[68:71], v[16:19], v[4:7], v[68:71]
ds_read_b64_tr_b16 v[34:35], v128 offset:12288
buffer_load_dwordx4 v137, s[8:11], s15 offen offset:0 lds
v_lshrrev_b32 v253, 3, v250
v_add_lshl_u32 v253, s24, v253, 9
v_mfma_f32_16x16x32_bf16 v[72:75], v[16:19], v[8:11], v[72:75]
ds_read_b64_tr_b16 v[36:37], v129 offset:8192
v_and_b32 v254, 3, v250
v_lshl_add_u32 v253, v254, s34, v253
v_mfma_f32_16x16x32_bf16 v[76:79], v[16:19], v[12:15], v[76:79]
ds_read_b64_tr_b16 v[38:39], v129 offset:12288
v_bfe_u32 v254, v250, 2, 1
v_add_u32 v254, s25, v254
v_lshl_add_u32 v248, v254, s35, v253
v_mfma_f32_16x16x32_bf16 v[80:83], v[20:23], v[0:3], v[80:83]
ds_read_b64_tr_b16 v[40:41], v130 offset:8192
buffer_load_dwordx4 v138, s[8:11], s15 offen offset:1024 lds
s_lshl_b32 s0, 4, s54
v_readfirstlane_b32 s28, v249
v_mfma_f32_16x16x32_bf16 v[84:87], v[20:23], v[4:7], v[84:87]
ds_read_b64_tr_b16 v[42:43], v130 offset:12288
s_nop 1
v_cmp_ge_u32 vcc, s28, v229
v_mfma_f32_16x16x32_bf16 v[88:91], v[20:23], v[8:11], v[88:91]
ds_read_b64_tr_b16 v[44:45], v131 offset:8192
s_nop 1
s_bcnt1_i32_b64 s32, vcc
v_mfma_f32_16x16x32_bf16 v[92:95], v[20:23], v[12:15], v[92:95]
ds_read_b64_tr_b16 v[46:47], v131 offset:12288
buffer_load_dwordx4 v139, s[8:11], s15 offen offset:2048 lds
s_sub_u32 s32, s32, 1
v_readlane_b32 s36, v230, s32
s_nop 1
v_mfma_f32_16x16x32_bf16 v[96:99], v[24:27], v[0:3], v[96:99]
ds_read_b128 v[52:55], v136 offset:3072
s_and_b32 s32, s36, 0x7ff
s_sub_u32 s28, s28, s32
v_mfma_f32_16x16x32_bf16 v[100:103], v[24:27], v[4:7], v[100:103]
ds_read_b128 v[56:59], v136 offset:5120
buffer_load_dwordx4 v140, s[8:11], s15 offen offset:3072 lds
s_bfe_u32 s32, s36, 0x3001a
s_lshr_b32 s25, s28, s32
v_mfma_f32_16x16x32_bf16 v[104:107], v[24:27], v[8:11], v[104:107]
ds_read_b128 v[60:63], v136 offset:7168
s_lshl_b32 s33, s25, s32
s_sub_u32 s24, s28, s33
v_mfma_f32_16x16x32_bf16 v[108:111], v[24:27], v[12:15], v[108:111]
s_bfe_u32 s34, s36, 0x1001d
s_lshl_b32 s24, s24, s34
s_bfe_u32 s35, s36, 0x1001e
v_mfma_f32_16x16x32_bf16 v[112:115], v[28:31], v[0:3], v[112:115]
s_add_u32 s15, s15, s17
s_lshl_b32 s25, s25, s35
s_bfe_u32 s32, s36, 0x40011
v_mfma_f32_16x16x32_bf16 v[116:119], v[28:31], v[4:7], v[116:119]
s_add_u32 s24, s24, s32
s_bfe_u32 s32, s36, 0x50015
v_mfma_f32_16x16x32_bf16 v[120:123], v[28:31], v[8:11], v[120:123]
s_add_u32 s25, s25, s32
s_bfe_u32 s23, s36, 0x4000b
v_mfma_f32_16x16x32_bf16 v[124:127], v[28:31], v[12:15], v[124:127]
s_waitcnt lgkmcnt(0)
v_mfma_f32_16x16x32_bf16 v[64:67], v[48:51], v[32:35], v[64:67]
s_waitcnt vmcnt(16)
s_barrier
ds_read_b128 v[16:19], v136 offset:16384
s_add_u32 m0, s20, 0
s_nop 0
s_bfe_u32 s36, s36, 0x6000b
s_lshl_b32 s32, s24, 8
s_or_b32 s36, s36, s32
v_mfma_f32_16x16x32_bf16 v[68:71], v[48:51], v[36:39], v[68:71]
ds_read_b64_tr_b16 v[0:1], v128 offset:16384
s_lshl_b32 s32, s25, 16
s_or_b32 s36, s36, s32
v_mfma_f32_16x16x32_bf16 v[72:75], v[48:51], v[40:43], v[72:75]
ds_read_b64_tr_b16 v[2:3], v128 offset:20480
buffer_load_dwordx4 v141, s[4:7], s16 offen offset:0 sc1 lds
s_cmp_eq_u32 s23, 4
s_cselect_b32 s32, 1, 0
s_sub_u32 s48, s24, s32
v_mfma_f32_16x16x32_bf16 v[76:79], v[48:51], v[44:47], v[76:79]
ds_read_b64_tr_b16 v[4:5], v129 offset:16384
s_max_i32 s48, s48, 0
s_add_u32 s49, s24, s34
s_add_u32 s49, s49, s32
v_mfma_f32_16x16x32_bf16 v[80:83], v[52:55], v[32:35], v[80:83]
ds_read_b64_tr_b16 v[6:7], v129 offset:20480
s_min_u32 s49, s49, 15
s_cmp_eq_u32 s23, 6
s_cselect_b32 s51, 3, 7
v_mfma_f32_16x16x32_bf16 v[84:87], v[52:55], v[36:39], v[84:87]
ds_read_b64_tr_b16 v[8:9], v130 offset:16384
buffer_load_dwordx4 v141, s[4:7], s16 offen offset:1024 sc1 lds
s_cmp_eq_u32 s23, 7
s_cselect_b32 s51, 27, s51
s_cselect_b32 s50, 5, 4
s_add_u32 s33, s25, s35
v_mfma_f32_16x16x32_bf16 v[88:91], v[52:55], v[40:43], v[88:91]
ds_read_b64_tr_b16 v[10:11], v130 offset:20480
s_lshl_b32 s34, s24, 9
s_cmp_eq_u32 s23, 8
s_cselect_b32 s51, 0, s51
s_cselect_b32 s48, s25, s48
s_cselect_b32 s49, s33, s49
v_mfma_f32_16x16x32_bf16 v[92:95], v[52:55], v[44:47], v[92:95]
ds_read_b64_tr_b16 v[12:13], v131 offset:16384
buffer_load_dwordx4 v142, s[4:7], s16 offen offset:2048 sc1 lds
s_cmp_eq_u32 s23, 8
s_cselect_b32 s63, 2, 9
s_cselect_b32 s61, 0, 0x7f000000
s_cselect_b32 s34, s34, 0
v_lshrrev_b32 v228, s50, v250
v_lshlrev_b32 v254, s50, v228
v_mfma_f32_16x16x32_bf16 v[96:99], v[56:59], v[32:35], v[96:99]
ds_read_b64_tr_b16 v[14:15], v131 offset:20480
v_sub_u32 v254, v250, v254
s_cmp_lt_u32 s23, 4
s_cselect_b32 s39, 10, s23
v_mfma_f32_16x16x32_bf16 v[100:103], v[56:59], v[36:39], v[100:103]
ds_read_b128 v[20:23], v136 offset:18432
v_min_u32 v254, s51, v254
s_lshl_b32 s39, s39, 13
v_mfma_f32_16x16x32_bf16 v[104:107], v[56:59], v[40:43], v[104:107]
ds_read_b128 v[24:27], v136 offset:20480
buffer_load_dwordx4 v142, s[4:7], s16 offen offset:3072 sc1 lds
s_cmp_eq_u32 s23, 3
s_cselect_b32 s34, 4, s34
v_add_u32 v228, s48, v228
v_mfma_f32_16x16x32_bf16 v[108:111], v[56:59], v[44:47], v[108:111]
ds_read_b128 v[28:31], v136 offset:22528
s_add_u32 s39, s39, s34
s_add_u32 s39, s39, 0x8402000
v_min_u32 v228, s49, v228
v_mfma_f32_16x16x32_bf16 v[112:115], v[60:63], v[32:35], v[112:115]
s_add_u32 s16, s16, 2048
s_lshl_b32 s60, s24, 10
s_add_u32 s60, s60, 0x8400000
v_mfma_f32_16x16x32_bf16 v[116:119], v[60:63], v[36:39], v[116:119]
v_lshlrev_b32 v228, s63, v228
v_lshl_add_u32 v228, v254, 4, v228
v_mfma_f32_16x16x32_bf16 v[120:123], v[60:63], v[40:43], v[120:123]
v_or_b32 v146, s61, v251
s_mov_b64 exec, s[100:101]
buffer_load_dword v231, v228, s[4:7], s39 offen sc1
buffer_load_dwordx4 v[232:235], v146, s[4:7], s60 offen sc1
s_mov_b64 exec, -1
v_mfma_f32_16x16x32_bf16 v[124:127], v[60:63], v[44:47], v[124:127]
s_waitcnt lgkmcnt(0)
ds_read_b128 v[48:51], v136 offset:17408
s_add_u32 m0, s19, 0
s_nop 0
v_mfma_f32_16x16x32_bf16 v[64:67], v[16:19], v[0:3], v[64:67]
ds_read_b64_tr_b16 v[32:33], v128 offset:24576
s_mov_b32 s1, s21
v_mfma_f32_16x16x32_bf16 v[68:71], v[16:19], v[4:7], v[68:71]
ds_read_b64_tr_b16 v[34:35], v128 offset:28672
buffer_load_dwordx4 v137, s[8:11], s15 offen offset:0 lds
v_mfma_f32_16x16x32_bf16 v[72:75], v[16:19], v[8:11], v[72:75]
ds_read_b64_tr_b16 v[36:37], v129 offset:24576
v_mfma_f32_16x16x32_bf16 v[76:79], v[16:19], v[12:15], v[76:79]
ds_read_b64_tr_b16 v[38:39], v129 offset:28672
s_mov_b32 s2, s22
v_mfma_f32_16x16x32_bf16 v[80:83], v[20:23], v[0:3], v[80:83]
ds_read_b64_tr_b16 v[40:41], v130 offset:24576
buffer_load_dwordx4 v138, s[8:11], s15 offen offset:1024 lds
v_mfma_f32_16x16x32_bf16 v[84:87], v[20:23], v[4:7], v[84:87]
ds_read_b64_tr_b16 v[42:43], v130 offset:28672
v_mfma_f32_16x16x32_bf16 v[88:91], v[20:23], v[8:11], v[88:91]
ds_read_b64_tr_b16 v[44:45], v131 offset:24576
v_mfma_f32_16x16x32_bf16 v[92:95], v[20:23], v[12:15], v[92:95]
ds_read_b64_tr_b16 v[46:47], v131 offset:28672
buffer_load_dwordx4 v139, s[8:11], s15 offen offset:2048 lds
s_mov_b32 s3, s26
v_mfma_f32_16x16x32_bf16 v[96:99], v[24:27], v[0:3], v[96:99]
ds_read_b128 v[52:55], v136 offset:19456
v_mfma_f32_16x16x32_bf16 v[100:103], v[24:27], v[4:7], v[100:103]
ds_read_b128 v[56:59], v136 offset:21504
buffer_load_dwordx4 v140, s[8:11], s15 offen offset:3072 lds
v_mfma_f32_16x16x32_bf16 v[104:107], v[24:27], v[8:11], v[104:107]
ds_read_b128 v[60:63], v136 offset:23552
v_mfma_f32_16x16x32_bf16 v[108:111], v[24:27], v[12:15], v[108:111]
s_mov_b32 s56, s57
v_mfma_f32_16x16x32_bf16 v[112:115], v[28:31], v[0:3], v[112:115]
s_add_u32 s15, s15, s17
v_mfma_f32_16x16x32_bf16 v[116:119], v[28:31], v[4:7], v[116:119]
v_mfma_f32_16x16x32_bf16 v[120:123], v[28:31], v[8:11], v[120:123]
v_mfma_f32_16x16x32_bf16 v[124:127], v[28:31], v[12:15], v[124:127]
s_waitcnt lgkmcnt(0)
v_mfma_f32_16x16x32_bf16 v[64:67], v[48:51], v[32:35], v[64:67]
s_waitcnt vmcnt(16)
s_barrier
ds_read_b128 v[16:19], v136 offset:32768
s_add_u32 m0, s20, 16384
s_nop 0
v_mov_b32 v145, v252
v_mfma_f32_16x16x32_bf16 v[68:71], v[48:51], v[36:39], v[68:71]
ds_read_b64_tr_b16 v[0:1], v128 offset:32768
v_mfma_f32_16x16x32_bf16 v[72:75], v[48:51], v[40:43], v[72:75]
ds_read_b64_tr_b16 v[2:3], v128 offset:36864
buffer_load_dwordx4 v141, s[4:7], s16 offen offset:0 sc1 lds
v_mfma_f32_16x16x32_bf16 v[76:79], v[48:51], v[44:47], v[76:79]
ds_read_b64_tr_b16 v[4:5], v129 offset:32768
v_mfma_f32_16x16x32_bf16 v[80:83], v[52:55], v[32:35], v[80:83]
ds_read_b64_tr_b16 v[6:7], v129 offset:36864
v_mfma_f32_16x16x32_bf16 v[84:87], v[52:55], v[36:39], v[84:87]
ds_read_b64_tr_b16 v[8:9], v130 offset:32768
buffer_load_dwordx4 v141, s[4:7], s16 offen offset:1024 sc1 lds
v_mfma_f32_16x16x32_bf16 v[88:91], v[52:55], v[40:43], v[88:91]
ds_read_b64_tr_b16 v[10:11], v130 offset:36864
v_mfma_f32_16x16x32_bf16 v[92:95], v[52:55], v[44:47], v[92:95]
ds_read_b64_tr_b16 v[12:13], v131 offset:32768
buffer_load_dwordx4 v142, s[4:7], s16 offen offset:2048 sc1 lds
v_mov_b32 v255, 131072
v_mfma_f32_16x16x32_bf16 v[96:99], v[56:59], v[32:35], v[96:99]
ds_read_b64_tr_b16 v[14:15], v131 offset:36864
v_mfma_f32_16x16x32_bf16 v[100:103], v[56:59], v[36:39], v[100:103]
ds_read_b128 v[20:23], v136 offset:34816
v_mfma_f32_16x16x32_bf16 v[104:107], v[56:59], v[40:43], v[104:107]
ds_read_b128 v[24:27], v136 offset:36864
buffer_load_dwordx4 v142, s[4:7], s16 offen offset:3072 sc1 lds
v_mfma_f32_16x16x32_bf16 v[108:111], v[56:59], v[44:47], v[108:111]
ds_read_b128 v[28:31], v136 offset:38912
v_mfma_f32_16x16x32_bf16 v[112:115], v[60:63], v[32:35], v[112:115]
s_add_u32 s16, s16, 2048
v_mfma_f32_16x16x32_bf16 v[116:119], v[60:63], v[36:39], v[116:119]
v_mfma_f32_16x16x32_bf16 v[120:123], v[60:63], v[40:43], v[120:123]
v_mfma_f32_16x16x32_bf16 v[124:127], v[60:63], v[44:47], v[124:127]
s_waitcnt lgkmcnt(0)
ds_read_b128 v[48:51], v136 offset:33792
s_add_u32 m0, s19, 16384
s_nop 0
v_mfma_f32_16x16x32_bf16 v[64:67], v[16:19], v[0:3], v[64:67]
ds_read_b64_tr_b16 v[32:33], v128 offset:40960
v_mfma_f32_16x16x32_bf16 v[68:71], v[16:19], v[4:7], v[68:71]
ds_read_b64_tr_b16 v[34:35], v128 offset:45056
buffer_load_dwordx4 v137, s[8:11], s15 offen offset:0 lds
v_mfma_f32_16x16x32_bf16 v[72:75], v[16:19], v[8:11], v[72:75]
ds_read_b64_tr_b16 v[36:37], v129 offset:40960
v_mfma_f32_16x16x32_bf16 v[76:79], v[16:19], v[12:15], v[76:79]
ds_read_b64_tr_b16 v[38:39], v129 offset:45056
v_mfma_f32_16x16x32_bf16 v[80:83], v[20:23], v[0:3], v[80:83]
ds_read_b64_tr_b16 v[40:41], v130 offset:40960
buffer_load_dwordx4 v138, s[8:11], s15 offen offset:1024 lds
v_mfma_f32_16x16x32_bf16 v[84:87], v[20:23], v[4:7], v[84:87]
ds_read_b64_tr_b16 v[42:43], v130 offset:45056
v_mfma_f32_16x16x32_bf16 v[88:91], v[20:23], v[8:11], v[88:91]
ds_read_b64_tr_b16 v[44:45], v131 offset:40960
v_mfma_f32_16x16x32_bf16 v[92:95], v[20:23], v[12:15], v[92:95]
ds_read_b64_tr_b16 v[46:47], v131 offset:45056
buffer_load_dwordx4 v139, s[8:11], s15 offen offset:2048 lds
v_mfma_f32_16x16x32_bf16 v[96:99], v[24:27], v[0:3], v[96:99]
ds_read_b128 v[52:55], v136 offset:35840
v_mfma_f32_16x16x32_bf16 v[100:103], v[24:27], v[4:7], v[100:103]
ds_read_b128 v[56:59], v136 offset:37888
buffer_load_dwordx4 v140, s[8:11], s15 offen offset:3072 lds
v_mfma_f32_16x16x32_bf16 v[104:107], v[24:27], v[8:11], v[104:107]
ds_read_b128 v[60:63], v136 offset:39936
v_mfma_f32_16x16x32_bf16 v[108:111], v[24:27], v[12:15], v[108:111]
v_mfma_f32_16x16x32_bf16 v[112:115], v[28:31], v[0:3], v[112:115]
s_add_u32 s15, s15, s17
v_mfma_f32_16x16x32_bf16 v[116:119], v[28:31], v[4:7], v[116:119]
v_mfma_f32_16x16x32_bf16 v[120:123], v[28:31], v[8:11], v[120:123]
v_mfma_f32_16x16x32_bf16 v[124:127], v[28:31], v[12:15], v[124:127]
s_waitcnt lgkmcnt(0)
v_mfma_f32_16x16x32_bf16 v[64:67], v[48:51], v[32:35], v[64:67]
s_waitcnt vmcnt(16)
s_barrier
ds_read_b128 v[16:19], v136 offset:49152
s_add_u32 m0, s20, 32768
s_nop 0
v_mfma_f32_16x16x32_bf16 v[68:71], v[48:51], v[36:39], v[68:71]
ds_read_b64_tr_b16 v[0:1], v128 offset:49152
v_mfma_f32_16x16x32_bf16 v[72:75], v[48:51], v[40:43], v[72:75]
ds_read_b64_tr_b16 v[2:3], v128 offset:53248
buffer_load_dwordx4 v141, s[4:7], s16 offen offset:0 sc1 lds
v_mfma_f32_16x16x32_bf16 v[76:79], v[48:51], v[44:47], v[76:79]
ds_read_b64_tr_b16 v[4:5], v129 offset:49152
v_mfma_f32_16x16x32_bf16 v[80:83], v[52:55], v[32:35], v[80:83]
ds_read_b64_tr_b16 v[6:7], v129 offset:53248
s_waitcnt vmcnt(13)
v_mfma_f32_16x16x32_bf16 v[84:87], v[52:55], v[36:39], v[84:87]
ds_read_b64_tr_b16 v[8:9], v130 offset:49152
buffer_load_dwordx4 v141, s[4:7], s16 offen offset:1024 sc1 lds
v_min3_u32 v253, v232, v233, v234
v_mfma_f32_16x16x32_bf16 v[88:91], v[52:55], v[40:43], v[88:91]
ds_read_b64_tr_b16 v[10:11], v130 offset:53248
v_min_u32 v253, v253, v235
v_mfma_f32_16x16x32_bf16 v[92:95], v[52:55], v[44:47], v[92:95]
ds_read_b64_tr_b16 v[12:13], v131 offset:49152
buffer_load_dwordx4 v142, s[4:7], s16 offen offset:2048 sc1 lds
v_or_b32 v253, s61, v253
v_mfma_f32_16x16x32_bf16 v[96:99], v[56:59], v[32:35], v[96:99]
ds_read_b64_tr_b16 v[14:15], v131 offset:53248
v_min_u32 v253, v253, v231
v_mfma_f32_16x16x32_bf16 v[100:103], v[56:59], v[36:39], v[100:103]
ds_read_b128 v[20:23], v136 offset:51200
v_cmp_eq_u32 vcc, 0, v253
v_mfma_f32_16x16x32_bf16 v[104:107], v[56:59], v[40:43], v[104:107]
ds_read_b128 v[24:27], v136 offset:53248
buffer_load_dwordx4 v142, s[4:7], s16 offen offset:3072 sc1 lds
s_nop 1
v_mfma_f32_16x16x32_bf16 v[108:111], v[56:59], v[44:47], v[108:111]
ds_read_b128 v[28:31], v136 offset:55296
s_cmp_eq_u64 vcc, 0
s_cselect_b32 s32, s36, -4
v_mfma_f32_16x16x32_bf16 v[112:115], v[60:63], v[32:35], v[112:115]
s_add_u32 s16, s16, 2048
s_bitcmp1_b32 0x1df, s23
s_cselect_b32 s32, s32, -4
v_mfma_f32_16x16x32_bf16 v[116:119], v[60:63], v[36:39], v[116:119]
v_mov_b32 v254, s32
v_mfma_f32_16x16x32_bf16 v[120:123], v[60:63], v[40:43], v[120:123]
s_mov_b64 exec, s[100:101]
ds_write_b32 v255, v254
s_mov_b64 exec, -1
v_mfma_f32_16x16x32_bf16 v[124:127], v[60:63], v[44:47], v[124:127]
s_waitcnt lgkmcnt(0)
ds_read_b128 v[48:51], v136 offset:50176
s_add_u32 m0, s19, 32768
s_nop 0
v_mfma_f32_16x16x32_bf16 v[64:67], v[16:19], v[0:3], v[64:67]
ds_read_b64_tr_b16 v[32:33], v128 offset:57344
v_mfma_f32_16x16x32_bf16 v[68:71], v[16:19], v[4:7], v[68:71]
ds_read_b64_tr_b16 v[34:35], v128 offset:61440
buffer_load_dwordx4 v137, s[8:11], s15 offen offset:0 lds
v_mfma_f32_16x16x32_bf16 v[72:75], v[16:19], v[8:11], v[72:75]
ds_read_b64_tr_b16 v[36:37], v129 offset:57344
v_mfma_f32_16x16x32_bf16 v[76:79], v[16:19], v[12:15], v[76:79]
ds_read_b64_tr_b16 v[38:39], v129 offset:61440
v_mfma_f32_16x16x32_bf16 v[80:83], v[20:23], v[0:3], v[80:83]
ds_read_b64_tr_b16 v[40:41], v130 offset:57344
buffer_load_dwordx4 v138, s[8:11], s15 offen offset:1024 lds
v_mfma_f32_16x16x32_bf16 v[84:87], v[20:23], v[4:7], v[84:87]
ds_read_b64_tr_b16 v[42:43], v130 offset:61440
v_mfma_f32_16x16x32_bf16 v[88:91], v[20:23], v[8:11], v[88:91]
ds_read_b64_tr_b16 v[44:45], v131 offset:57344
v_mfma_f32_16x16x32_bf16 v[92:95], v[20:23], v[12:15], v[92:95]
ds_read_b64_tr_b16 v[46:47], v131 offset:61440
buffer_load_dwordx4 v139, s[8:11], s15 offen offset:2048 lds
v_mfma_f32_16x16x32_bf16 v[96:99], v[24:27], v[0:3], v[96:99]
ds_read_b128 v[52:55], v136 offset:52224
v_mfma_f32_16x16x32_bf16 v[100:103], v[24:27], v[4:7], v[100:103]
ds_read_b128 v[56:59], v136 offset:54272
buffer_load_dwordx4 v140, s[8:11], s15 offen offset:3072 lds
v_mfma_f32_16x16x32_bf16 v[104:107], v[24:27], v[8:11], v[104:107]
ds_read_b128 v[60:63], v136 offset:56320
v_mfma_f32_16x16x32_bf16 v[108:111], v[24:27], v[12:15], v[108:111]
v_mfma_f32_16x16x32_bf16 v[112:115], v[28:31], v[0:3], v[112:115]
s_add_u32 s15, s15, s17
v_mfma_f32_16x16x32_bf16 v[116:119], v[28:31], v[4:7], v[116:119]
v_mfma_f32_16x16x32_bf16 v[120:123], v[28:31], v[8:11], v[120:123]
v_mfma_f32_16x16x32_bf16 v[124:127], v[28:31], v[12:15], v[124:127]
s_waitcnt lgkmcnt(0)
v_mfma_f32_16x16x32_bf16 v[64:67], v[48:51], v[32:35], v[64:67]
s_waitcnt vmcnt(16)
s_barrier
ds_read_b128 v[16:19], v136 offset:0
s_add_u32 m0, s20, 49152
s_nop 0
ds_read_b32 v254, v255
v_mfma_f32_16x16x32_bf16 v[68:71], v[48:51], v[36:39], v[68:71]
ds_read_b64_tr_b16 v[0:1], v128 offset:0
v_mfma_f32_16x16x32_bf16 v[72:75], v[48:51], v[40:43], v[72:75]
ds_read_b64_tr_b16 v[2:3], v128 offset:4096
buffer_load_dwordx4 v141, s[4:7], s16 offen offset:0 sc1 lds
v_mfma_f32_16x16x32_bf16 v[76:79], v[48:51], v[44:47], v[76:79]
ds_read_b64_tr_b16 v[4:5], v129 offset:0
v_mfma_f32_16x16x32_bf16 v[80:83], v[52:55], v[32:35], v[80:83]
ds_read_b64_tr_b16 v[6:7], v129 offset:4096
v_mfma_f32_16x16x32_bf16 v[84:87], v[52:55], v[36:39], v[84:87]
ds_read_b64_tr_b16 v[8:9], v130 offset:0
buffer_load_dwordx4 v141, s[4:7], s16 offen offset:1024 sc1 lds
v_mfma_f32_16x16x32_bf16 v[88:91], v[52:55], v[40:43], v[88:91]
ds_read_b64_tr_b16 v[10:11], v130 offset:4096
v_mfma_f32_16x16x32_bf16 v[92:95], v[52:55], v[44:47], v[92:95]
ds_read_b64_tr_b16 v[12:13], v131 offset:0
buffer_load_dwordx4 v142, s[4:7], s16 offen offset:2048 sc1 lds
v_mfma_f32_16x16x32_bf16 v[96:99], v[56:59], v[32:35], v[96:99]
ds_read_b64_tr_b16 v[14:15], v131 offset:4096
v_mfma_f32_16x16x32_bf16 v[100:103], v[56:59], v[36:39], v[100:103]
ds_read_b128 v[20:23], v136 offset:2048
v_mfma_f32_16x16x32_bf16 v[104:107], v[56:59], v[40:43], v[104:107]
ds_read_b128 v[24:27], v136 offset:4096
buffer_load_dwordx4 v142, s[4:7], s16 offen offset:3072 sc1 lds
v_mfma_f32_16x16x32_bf16 v[108:111], v[56:59], v[44:47], v[108:111]
ds_read_b128 v[28:31], v136 offset:6144
v_mfma_f32_16x16x32_bf16 v[112:115], v[60:63], v[32:35], v[112:115]
s_add_u32 s16, s16, 2048
v_mfma_f32_16x16x32_bf16 v[116:119], v[60:63], v[36:39], v[116:119]
v_mfma_f32_16x16x32_bf16 v[120:123], v[60:63], v[40:43], v[120:123]
v_mfma_f32_16x16x32_bf16 v[124:127], v[60:63], v[44:47], v[124:127]
s_waitcnt lgkmcnt(0)
ds_read_b128 v[48:51], v136 offset:1024
s_add_u32 m0, s19, 49152
s_nop 0
v_mfma_f32_16x16x32_bf16 v[64:67], v[16:19], v[0:3], v[64:67]
ds_read_b64_tr_b16 v[32:33], v128 offset:8192
v_readfirstlane_b32 s62, v254
v_mfma_f32_16x16x32_bf16 v[68:71], v[16:19], v[4:7], v[68:71]
ds_read_b64_tr_b16 v[34:35], v128 offset:12288
buffer_load_dwordx4 v137, s[8:11], s15 offen offset:0 lds
v_mfma_f32_16x16x32_bf16 v[72:75], v[16:19], v[8:11], v[72:75]
ds_read_b64_tr_b16 v[36:37], v129 offset:8192
s_nop 1
v_mfma_f32_16x16x32_bf16 v[76:79], v[16:19], v[12:15], v[76:79]
ds_read_b64_tr_b16 v[38:39], v129 offset:12288
v_mfma_f32_16x16x32_bf16 v[80:83], v[20:23], v[0:3], v[80:83]
ds_read_b64_tr_b16 v[40:41], v130 offset:8192
buffer_load_dwordx4 v138, s[8:11], s15 offen offset:1024 lds
v_mfma_f32_16x16x32_bf16 v[84:87], v[20:23], v[4:7], v[84:87]
ds_read_b64_tr_b16 v[42:43], v130 offset:12288
s_and_b32 s23, s62, 15
v_mfma_f32_16x16x32_bf16 v[88:91], v[20:23], v[8:11], v[88:91]
ds_read_b64_tr_b16 v[44:45], v131 offset:8192
v_mfma_f32_16x16x32_bf16 v[92:95], v[20:23], v[12:15], v[92:95]
ds_read_b64_tr_b16 v[46:47], v131 offset:12288
buffer_load_dwordx4 v139, s[8:11], s15 offen offset:2048 lds
s_bfe_u32 s54, s62, 0x20004
v_mfma_f32_16x16x32_bf16 v[96:99], v[24:27], v[0:3], v[96:99]
ds_read_b128 v[52:55], v136 offset:3072
v_mfma_f32_16x16x32_bf16 v[100:103], v[24:27], v[4:7], v[100:103]
ds_read_b128 v[56:59], v136 offset:5120
buffer_load_dwordx4 v140, s[8:11], s15 offen offset:3072 lds
v_mfma_f32_16x16x32_bf16 v[104:107], v[24:27], v[8:11], v[104:107]
ds_read_b128 v[60:63], v136 offset:7168
s_bfe_u32 s24, s62, 0x80008
v_mfma_f32_16x16x32_bf16 v[108:111], v[24:27], v[12:15], v[108:111]
v_mfma_f32_16x16x32_bf16 v[112:115], v[28:31], v[0:3], v[112:115]
s_add_u32 s15, s15, s17
s_lshr_b32 s25, s62, 16
v_mfma_f32_16x16x32_bf16 v[116:119], v[28:31], v[4:7], v[116:119]
v_mfma_f32_16x16x32_bf16 v[120:123], v[28:31], v[8:11], v[120:123]
v_mfma_f32_16x16x32_bf16 v[124:127], v[28:31], v[12:15], v[124:127]
s_cmp_eq_u32 s54, 0
s_cselect_b32 s73, 1, -1
s_cbranch_scc1 main_kernel_w_c0_task
s_waitcnt lgkmcnt(0)
v_mfma_f32_16x16x32_bf16 v[64:67], v[48:51], v[32:35], v[64:67]
s_waitcnt vmcnt(16)
s_barrier
ds_read_b128 v[16:19], v136 offset:16384
v_mfma_f32_16x16x32_bf16 v[68:71], v[48:51], v[36:39], v[68:71]
ds_read_b64_tr_b16 v[0:1], v128 offset:16384
v_mfma_f32_16x16x32_bf16 v[72:75], v[48:51], v[40:43], v[72:75]
ds_read_b64_tr_b16 v[2:3], v128 offset:20480
v_mfma_f32_16x16x32_bf16 v[76:79], v[48:51], v[44:47], v[76:79]
ds_read_b64_tr_b16 v[4:5], v129 offset:16384
v_mfma_f32_16x16x32_bf16 v[80:83], v[52:55], v[32:35], v[80:83]
ds_read_b64_tr_b16 v[6:7], v129 offset:20480
v_mfma_f32_16x16x32_bf16 v[84:87], v[52:55], v[36:39], v[84:87]
ds_read_b64_tr_b16 v[8:9], v130 offset:16384
v_mfma_f32_16x16x32_bf16 v[88:91], v[52:55], v[40:43], v[88:91]
ds_read_b64_tr_b16 v[10:11], v130 offset:20480
v_mfma_f32_16x16x32_bf16 v[92:95], v[52:55], v[44:47], v[92:95]
ds_read_b64_tr_b16 v[12:13], v131 offset:16384
v_mfma_f32_16x16x32_bf16 v[96:99], v[56:59], v[32:35], v[96:99]
ds_read_b64_tr_b16 v[14:15], v131 offset:20480
v_mfma_f32_16x16x32_bf16 v[100:103], v[56:59], v[36:39], v[100:103]
ds_read_b128 v[20:23], v136 offset:18432
v_mfma_f32_16x16x32_bf16 v[104:107], v[56:59], v[40:43], v[104:107]
ds_read_b128 v[24:27], v136 offset:20480
v_mfma_f32_16x16x32_bf16 v[108:111], v[56:59], v[44:47], v[108:111]
ds_read_b128 v[28:31], v136 offset:22528
v_mfma_f32_16x16x32_bf16 v[112:115], v[60:63], v[32:35], v[112:115]
v_mfma_f32_16x16x32_bf16 v[116:119], v[60:63], v[36:39], v[116:119]
v_mfma_f32_16x16x32_bf16 v[120:123], v[60:63], v[40:43], v[120:123]
v_mfma_f32_16x16x32_bf16 v[124:127], v[60:63], v[44:47], v[124:127]
s_waitcnt lgkmcnt(0)
ds_read_b128 v[48:51], v136 offset:17408
v_mfma_f32_16x16x32_bf16 v[64:67], v[16:19], v[0:3], v[64:67]
ds_read_b64_tr_b16 v[32:33], v128 offset:24576
v_mfma_f32_16x16x32_bf16 v[68:71], v[16:19], v[4:7], v[68:71]
ds_read_b64_tr_b16 v[34:35], v128 offset:28672
v_mfma_f32_16x16x32_bf16 v[72:75], v[16:19], v[8:11], v[72:75]
ds_read_b64_tr_b16 v[36:37], v129 offset:24576
v_mfma_f32_16x16x32_bf16 v[76:79], v[16:19], v[12:15], v[76:79]
ds_read_b64_tr_b16 v[38:39], v129 offset:28672
v_mfma_f32_16x16x32_bf16 v[80:83], v[20:23], v[0:3], v[80:83]
ds_read_b64_tr_b16 v[40:41], v130 offset:24576
v_mfma_f32_16x16x32_bf16 v[84:87], v[20:23], v[4:7], v[84:87]
ds_read_b64_tr_b16 v[42:43], v130 offset:28672
v_mfma_f32_16x16x32_bf16 v[88:91], v[20:23], v[8:11], v[88:91]
ds_read_b64_tr_b16 v[44:45], v131 offset:24576
v_mfma_f32_16x16x32_bf16 v[92:95], v[20:23], v[12:15], v[92:95]
ds_read_b64_tr_b16 v[46:47], v131 offset:28672
v_mfma_f32_16x16x32_bf16 v[96:99], v[24:27], v[0:3], v[96:99]
ds_read_b128 v[52:55], v136 offset:19456
v_mfma_f32_16x16x32_bf16 v[100:103], v[24:27], v[4:7], v[100:103]
ds_read_b128 v[56:59], v136 offset:21504
v_mfma_f32_16x16x32_bf16 v[104:107], v[24:27], v[8:11], v[104:107]
ds_read_b128 v[60:63], v136 offset:23552
v_mfma_f32_16x16x32_bf16 v[108:111], v[24:27], v[12:15], v[108:111]
v_mfma_f32_16x16x32_bf16 v[112:115], v[28:31], v[0:3], v[112:115]
v_mfma_f32_16x16x32_bf16 v[116:119], v[28:31], v[4:7], v[116:119]
v_mfma_f32_16x16x32_bf16 v[120:123], v[28:31], v[8:11], v[120:123]
v_mfma_f32_16x16x32_bf16 v[124:127], v[28:31], v[12:15], v[124:127]
s_waitcnt lgkmcnt(0)
v_mfma_f32_16x16x32_bf16 v[64:67], v[48:51], v[32:35], v[64:67]
s_waitcnt vmcnt(8)
s_barrier
ds_read_b128 v[16:19], v136 offset:32768
v_mfma_f32_16x16x32_bf16 v[68:71], v[48:51], v[36:39], v[68:71]
ds_read_b64_tr_b16 v[0:1], v128 offset:32768
v_mfma_f32_16x16x32_bf16 v[72:75], v[48:51], v[40:43], v[72:75]
ds_read_b64_tr_b16 v[2:3], v128 offset:36864
v_mfma_f32_16x16x32_bf16 v[76:79], v[48:51], v[44:47], v[76:79]
ds_read_b64_tr_b16 v[4:5], v129 offset:32768
v_mfma_f32_16x16x32_bf16 v[80:83], v[52:55], v[32:35], v[80:83]
ds_read_b64_tr_b16 v[6:7], v129 offset:36864
v_mfma_f32_16x16x32_bf16 v[84:87], v[52:55], v[36:39], v[84:87]
ds_read_b64_tr_b16 v[8:9], v130 offset:32768
v_mfma_f32_16x16x32_bf16 v[88:91], v[52:55], v[40:43], v[88:91]
ds_read_b64_tr_b16 v[10:11], v130 offset:36864
v_mfma_f32_16x16x32_bf16 v[92:95], v[52:55], v[44:47], v[92:95]
ds_read_b64_tr_b16 v[12:13], v131 offset:32768
v_mfma_f32_16x16x32_bf16 v[96:99], v[56:59], v[32:35], v[96:99]
ds_read_b64_tr_b16 v[14:15], v131 offset:36864
v_mfma_f32_16x16x32_bf16 v[100:103], v[56:59], v[36:39], v[100:103]
ds_read_b128 v[20:23], v136 offset:34816
v_mfma_f32_16x16x32_bf16 v[104:107], v[56:59], v[40:43], v[104:107]
ds_read_b128 v[24:27], v136 offset:36864
v_mfma_f32_16x16x32_bf16 v[108:111], v[56:59], v[44:47], v[108:111]
ds_read_b128 v[28:31], v136 offset:38912
v_mfma_f32_16x16x32_bf16 v[112:115], v[60:63], v[32:35], v[112:115]
v_mfma_f32_16x16x32_bf16 v[116:119], v[60:63], v[36:39], v[116:119]
v_mfma_f32_16x16x32_bf16 v[120:123], v[60:63], v[40:43], v[120:123]
v_mfma_f32_16x16x32_bf16 v[124:127], v[60:63], v[44:47], v[124:127]
s_waitcnt lgkmcnt(0)
ds_read_b128 v[48:51], v136 offset:33792
v_mfma_f32_16x16x32_bf16 v[64:67], v[16:19], v[0:3], v[64:67]
ds_read_b64_tr_b16 v[32:33], v128 offset:40960
v_mfma_f32_16x16x32_bf16 v[68:71], v[16:19], v[4:7], v[68:71]
ds_read_b64_tr_b16 v[34:35], v128 offset:45056
v_mfma_f32_16x16x32_bf16 v[72:75], v[16:19], v[8:11], v[72:75]
ds_read_b64_tr_b16 v[36:37], v129 offset:40960
v_mfma_f32_16x16x32_bf16 v[76:79], v[16:19], v[12:15], v[76:79]
ds_read_b64_tr_b16 v[38:39], v129 offset:45056
v_mfma_f32_16x16x32_bf16 v[80:83], v[20:23], v[0:3], v[80:83]
ds_read_b64_tr_b16 v[40:41], v130 offset:40960
v_mfma_f32_16x16x32_bf16 v[84:87], v[20:23], v[4:7], v[84:87]
ds_read_b64_tr_b16 v[42:43], v130 offset:45056
v_mfma_f32_16x16x32_bf16 v[88:91], v[20:23], v[8:11], v[88:91]
ds_read_b64_tr_b16 v[44:45], v131 offset:40960
v_mfma_f32_16x16x32_bf16 v[92:95], v[20:23], v[12:15], v[92:95]
ds_read_b64_tr_b16 v[46:47], v131 offset:45056
v_mfma_f32_16x16x32_bf16 v[96:99], v[24:27], v[0:3], v[96:99]
ds_read_b128 v[52:55], v136 offset:35840
v_mfma_f32_16x16x32_bf16 v[100:103], v[24:27], v[4:7], v[100:103]
ds_read_b128 v[56:59], v136 offset:37888
v_mfma_f32_16x16x32_bf16 v[104:107], v[24:27], v[8:11], v[104:107]
ds_read_b128 v[60:63], v136 offset:39936
v_mfma_f32_16x16x32_bf16 v[108:111], v[24:27], v[12:15], v[108:111]
v_mfma_f32_16x16x32_bf16 v[112:115], v[28:31], v[0:3], v[112:115]
v_mfma_f32_16x16x32_bf16 v[116:119], v[28:31], v[4:7], v[116:119]
v_mfma_f32_16x16x32_bf16 v[120:123], v[28:31], v[8:11], v[120:123]
v_mfma_f32_16x16x32_bf16 v[124:127], v[28:31], v[12:15], v[124:127]
s_waitcnt lgkmcnt(0)
v_mfma_f32_16x16x32_bf16 v[64:67], v[48:51], v[32:35], v[64:67]
s_waitcnt vmcnt(0)
s_barrier
ds_read_b128 v[16:19], v136 offset:49152
v_mfma_f32_16x16x32_bf16 v[68:71], v[48:51], v[36:39], v[68:71]
ds_read_b64_tr_b16 v[0:1], v128 offset:49152
v_mfma_f32_16x16x32_bf16 v[72:75], v[48:51], v[40:43], v[72:75]
ds_read_b64_tr_b16 v[2:3], v128 offset:53248
v_mfma_f32_16x16x32_bf16 v[76:79], v[48:51], v[44:47], v[76:79]
ds_read_b64_tr_b16 v[4:5], v129 offset:49152
v_mfma_f32_16x16x32_bf16 v[80:83], v[52:55], v[32:35], v[80:83]
ds_read_b64_tr_b16 v[6:7], v129 offset:53248
v_mfma_f32_16x16x32_bf16 v[84:87], v[52:55], v[36:39], v[84:87]
ds_read_b64_tr_b16 v[8:9], v130 offset:49152
v_mfma_f32_16x16x32_bf16 v[88:91], v[52:55], v[40:43], v[88:91]
ds_read_b64_tr_b16 v[10:11], v130 offset:53248
v_mfma_f32_16x16x32_bf16 v[92:95], v[52:55], v[44:47], v[92:95]
ds_read_b64_tr_b16 v[12:13], v131 offset:49152
v_mfma_f32_16x16x32_bf16 v[96:99], v[56:59], v[32:35], v[96:99]
ds_read_b64_tr_b16 v[14:15], v131 offset:53248
v_mfma_f32_16x16x32_bf16 v[100:103], v[56:59], v[36:39], v[100:103]
ds_read_b128 v[20:23], v136 offset:51200
v_mfma_f32_16x16x32_bf16 v[104:107], v[56:59], v[40:43], v[104:107]
ds_read_b128 v[24:27], v136 offset:53248
v_mfma_f32_16x16x32_bf16 v[108:111], v[56:59], v[44:47], v[108:111]
ds_read_b128 v[28:31], v136 offset:55296
v_mfma_f32_16x16x32_bf16 v[112:115], v[60:63], v[32:35], v[112:115]
v_mfma_f32_16x16x32_bf16 v[116:119], v[60:63], v[36:39], v[116:119]
v_mfma_f32_16x16x32_bf16 v[120:123], v[60:63], v[40:43], v[120:123]
v_mfma_f32_16x16x32_bf16 v[124:127], v[60:63], v[44:47], v[124:127]
s_waitcnt lgkmcnt(0)
ds_read_b128 v[48:51], v136 offset:50176
v_mfma_f32_16x16x32_bf16 v[64:67], v[16:19], v[0:3], v[64:67]
ds_read_b64_tr_b16 v[32:33], v128 offset:57344
v_mfma_f32_16x16x32_bf16 v[68:71], v[16:19], v[4:7], v[68:71]
ds_read_b64_tr_b16 v[34:35], v128 offset:61440
v_mfma_f32_16x16x32_bf16 v[72:75], v[16:19], v[8:11], v[72:75]
ds_read_b64_tr_b16 v[36:37], v129 offset:57344
v_mfma_f32_16x16x32_bf16 v[76:79], v[16:19], v[12:15], v[76:79]
ds_read_b64_tr_b16 v[38:39], v129 offset:61440
v_mfma_f32_16x16x32_bf16 v[80:83], v[20:23], v[0:3], v[80:83]
ds_read_b64_tr_b16 v[40:41], v130 offset:57344
v_mfma_f32_16x16x32_bf16 v[84:87], v[20:23], v[4:7], v[84:87]
ds_read_b64_tr_b16 v[42:43], v130 offset:61440
v_mfma_f32_16x16x32_bf16 v[88:91], v[20:23], v[8:11], v[88:91]
ds_read_b64_tr_b16 v[44:45], v131 offset:57344
v_mfma_f32_16x16x32_bf16 v[92:95], v[20:23], v[12:15], v[92:95]
ds_read_b64_tr_b16 v[46:47], v131 offset:61440
v_mfma_f32_16x16x32_bf16 v[96:99], v[24:27], v[0:3], v[96:99]
ds_read_b128 v[52:55], v136 offset:52224
v_mfma_f32_16x16x32_bf16 v[100:103], v[24:27], v[4:7], v[100:103]
ds_read_b128 v[56:59], v136 offset:54272
v_mfma_f32_16x16x32_bf16 v[104:107], v[24:27], v[8:11], v[104:107]
ds_read_b128 v[60:63], v136 offset:56320
v_mfma_f32_16x16x32_bf16 v[108:111], v[24:27], v[12:15], v[108:111]
v_mfma_f32_16x16x32_bf16 v[112:115], v[28:31], v[0:3], v[112:115]
v_mfma_f32_16x16x32_bf16 v[116:119], v[28:31], v[4:7], v[116:119]
v_mfma_f32_16x16x32_bf16 v[120:123], v[28:31], v[8:11], v[120:123]
v_mfma_f32_16x16x32_bf16 v[124:127], v[28:31], v[12:15], v[124:127]
s_waitcnt lgkmcnt(0)
v_mfma_f32_16x16x32_bf16 v[64:67], v[48:51], v[32:35], v[64:67]
s_barrier
v_mfma_f32_16x16x32_bf16 v[68:71], v[48:51], v[36:39], v[68:71]
v_mfma_f32_16x16x32_bf16 v[72:75], v[48:51], v[40:43], v[72:75]
v_mfma_f32_16x16x32_bf16 v[76:79], v[48:51], v[44:47], v[76:79]
v_mfma_f32_16x16x32_bf16 v[80:83], v[52:55], v[32:35], v[80:83]
v_mfma_f32_16x16x32_bf16 v[84:87], v[52:55], v[36:39], v[84:87]
v_mfma_f32_16x16x32_bf16 v[88:91], v[52:55], v[40:43], v[88:91]
v_mfma_f32_16x16x32_bf16 v[92:95], v[52:55], v[44:47], v[92:95]
v_mfma_f32_16x16x32_bf16 v[96:99], v[56:59], v[32:35], v[96:99]
v_mfma_f32_16x16x32_bf16 v[100:103], v[56:59], v[36:39], v[100:103]
v_mfma_f32_16x16x32_bf16 v[104:107], v[56:59], v[40:43], v[104:107]
v_mfma_f32_16x16x32_bf16 v[108:111], v[56:59], v[44:47], v[108:111]
v_mfma_f32_16x16x32_bf16 v[112:115], v[60:63], v[32:35], v[112:115]
v_mfma_f32_16x16x32_bf16 v[116:119], v[60:63], v[36:39], v[116:119]
v_mfma_f32_16x16x32_bf16 v[120:123], v[60:63], v[40:43], v[120:123]
v_mfma_f32_16x16x32_bf16 v[124:127], v[60:63], v[44:47], v[124:127]
s_cmp_lg_u32 s62, -4
s_cbranch_scc1 main_kernel_w_gemm
s_branch main_kernel_w_slow
main_kernel_w_c0_v_ev:
s_mov_b32 s55, 1
s_cmp_eq_u32 s56, 0
s_cbranch_scc1 main_kernel_w_c0_v_et
s_bfm_b64 exec, s0, 0
buffer_store_dword v244, v248, s[4:7], s59 offen sc1
s_mov_b64 exec, -1
s_mov_b32 s56, 0
main_kernel_w_c0_v_et:
s_cmp_lg_u32 s18, 1
s_cbranch_scc1 main_kernel_w_c0_v_loop
s_lshl_b32 s32, s27, 8
s_add_u32 s32, s32, 0x841e000
s_mov_b64 exec, 1
v_mov_b32 v249, 1
buffer_atomic_add v249, off, s[4:7], s32 sc0 sc1
s_mov_b64 exec, -1
s_branch main_kernel_w_c0_v_loop
main_kernel_w_c1_task:
s_cmp_eq_u32 s23, 0
s_cbranch_scc1 main_kernel_w_c1_set0
s_cmp_eq_u32 s23, 1
s_cbranch_scc1 main_kernel_w_c1_set1
s_cmp_eq_u32 s23, 2
s_cbranch_scc1 main_kernel_w_c1_set2
s_cmp_eq_u32 s23, 3
s_cbranch_scc1 main_kernel_w_c1_set3
s_cmp_eq_u32 s23, 6
s_cbranch_scc1 main_kernel_w_c1_set6
s_branch main_kernel_end2
main_kernel_w_c1_set0:
s_mov_b32 s57, 6
s_lshl_b32 s32, s25, 8
s_add_u32 s8, s40, s32
s_addc_u32 s9, s41, 0
s_and_b32 s9, s9, 0xffff
s_sub_u32 s10, 0x800000, s32
s_mov_b32 s11, 0x20000
s_mov_b32 s30, 8192
s_mov_b32 s31, 32768
s_mul_i32 s16, s24, 262144
s_add_u32 s16, s16, 0x0
s_mov_b32 s18, 7
s_lshl_b32 s32, s24, 3
s_mul_i32 s33, s38, 4
s_add_u32 s32, s32, s33
s_mul_i32 s32, s32, 131072
s_lshl_b32 s33, s25, 12
s_add_u32 s32, s32, s33
s_mul_i32 s33, s37, 4096
s_add_u32 s32, s32, s33
s_add_u32 s21, s32, 0x800000
s_mov_b32 s22, 131072
s_mov_b32 s26, 0x7f000000
s_branch main_kernel_w_c1_go
main_kernel_w_c1_set1:
s_mov_b32 s57, 7
s_lshl_b32 s32, s25, 8
s_add_u32 s8, s42, s32
s_addc_u32 s9, s43, 0
s_and_b32 s9, s9, 0xffff
s_sub_u32 s10, 0x800000, s32
s_mov_b32 s11, 0x20000
s_mov_b32 s30, 8192
s_mov_b32 s31, 32768
s_mul_i32 s16, s24, 262144
s_add_u32 s16, s16, 0x0
s_mov_b32 s18, 7
s_lshl_b32 s32, s24, 3
s_mul_i32 s33, s38, 4
s_add_u32 s32, s32, s33
s_mul_i32 s32, s32, 131072
s_lshl_b32 s33, s25, 12
s_add_u32 s32, s32, s33
s_mul_i32 s33, s37, 4096
s_add_u32 s32, s32, s33
s_add_u32 s21, s32, 0x1800000
s_mov_b32 s22, 131072
s_mov_b32 s26, 0x7f000000
s_branch main_kernel_w_c1_go
main_kernel_w_c1_set2:
s_mov_b32 s57, 8
s_lshl_b32 s32, s25, 8
s_add_u32 s8, s44, s32
s_addc_u32 s9, s45, 0
s_and_b32 s9, s9, 0xffff
s_sub_u32 s10, 0x800000, s32
s_mov_b32 s11, 0x20000
s_mov_b32 s30, 8192
s_mov_b32 s31, 32768
s_mul_i32 s16, s24, 262144
s_add_u32 s16, s16, 0x0
s_mov_b32 s18, 7
s_lshl_b32 s32, s24, 2
s_mul_i32 s33, s38, 2
s_add_u32 s32, s32, s33
s_lshl_b32 s32, s32, 18
s_lshl_b32 s33, s25, 13
s_add_u32 s32, s32, s33
s_mul_i32 s33, s37, 8192
s_add_u32 s32, s32, s33
s_add_u32 s21, s32, 0x2800000
s_branch main_kernel_w_c1_gov
main_kernel_w_c1_set3:
s_mov_b32 s57, 9
s_lshl_b32 s32, s25, 8
s_add_u32 s8, s64, s32
s_addc_u32 s9, s65, 0
s_and_b32 s9, s9, 0xffff
s_sub_u32 s10, 0x200000, s32
s_mov_b32 s11, 0x20000
s_mov_b32 s30, 2048
s_mov_b32 s31, 32768
s_mul_i32 s16, s24, 262144
s_add_u32 s16, s16, 0x400000
s_mov_b32 s18, 7
s_lshl_b32 s32, s24, 3
s_mul_i32 s33, s38, 4
s_add_u32 s32, s32, s33
s_mul_i32 s32, s32, 32768
s_lshl_b32 s33, s25, 12
s_add_u32 s32, s32, s33
s_mul_i32 s33, s37, 4096
s_add_u32 s32, s32, s33
s_add_u32 s21, s32, 0x4800000
s_mov_b32 s22, 32768
s_mov_b32 s26, 0x7f000000
s_lshr_b32 s32, s25, 2
s_add_u32 s32, s32, 1
s_sub_u32 s33, 0, s32
s_bitcmp1_b32 s25, 1
s_cselect_b32 s32, s33, s32
s_add_u32 s32, s32, 16
v_and_b32 v253, 15, v250
v_add_u32 v253, s32, v253
v_lshrrev_b32 v254, 4, v253
v_lshlrev_b32 v254, 15, v254
v_and_b32 v253, 15, v253
v_lshl_add_u32 v254, v253, 4, v254
v_and_b32 v253, 0x300, v251
v_add_u32 v252, v253, v254
s_branch main_kernel_w_c1_go
main_kernel_w_c1_set6:
s_mov_b32 s57, 10
s_lshl_b32 s32, s25, 8
s_add_u32 s8, s68, s32
s_addc_u32 s9, s69, 0
s_and_b32 s9, s9, 0xffff
s_sub_u32 s10, 0x700000, s32
s_mov_b32 s11, 0x20000
s_mov_b32 s30, 7168
s_mov_b32 s31, 32768
s_mul_i32 s16, s24, 262144
s_add_u32 s16, s16, 0x6800000
s_mov_b32 s18, 7
s_lshl_b32 s32, s24, 3
s_mul_i32 s33, s38, 4
s_add_u32 s32, s32, s33
s_mul_i32 s32, s32, 114688
s_lshl_b32 s33, s25, 12
s_add_u32 s32, s32, s33
s_mul_i32 s33, s37, 4096
s_add_u32 s32, s32, s33
s_add_u32 s21, s32, 0x5400000
s_mov_b32 s22, 114688
s_mov_b32 s26, 0x7f000000
s_branch main_kernel_w_c1_go
main_kernel_w_c1_str:
s_mul_i32 s32, s14, 2
s_mul_i32 s32, s32, s31
v_mad_u32_u24 v137, v147, s30, v151
v_mad_u32_u24 v138, v148, s30, v152
v_mad_u32_u24 v139, v149, s30, v153
v_mad_u32_u24 v140, v150, s30, v154
v_add_u32 v141, s32, v251
s_add_u32 s32, s32, s31
s_sub_u32 s32, s32, 1024
v_add_u32 v142, s32, v251
s_mul_i32 s17, s30, 32
s_mov_b32 s15, 0
s_mov_b32 s18, 1
s_cmp_eq_u32 s73, 2
s_cbranch_scc1 main_kernel_w_c1_n_mid
s_branch main_kernel_w_c1_v_mid
main_kernel_w_c1_go:
s_mov_b32 s58, 2
s_mov_b32 s72, s18
s_cmp_lg_u32 s73, -1
s_cbranch_scc1 main_kernel_w_c1_str
s_waitcnt lgkmcnt(0)
v_lshrrev_b32 v0, 4, v250
v_bfe_u32 v1, v250, 2, 2
v_lshl_add_u32 v4, v0, 2, v1
v_and_b32 v5, 7, v4
v_mul_u32_u24 v4, 512, v4
v_and_b32 v6, 3, v250
v_lshl_add_u32 v4, v6, 3, v4
s_mul_i32 s32, s37, 8
v_xor_b32 v5, s32, v5
v_lshl_add_u32 v128, v5, 5, v4
v_xor_b32 v129, 32, v128
v_xor_b32 v130, 64, v128
v_xor_b32 v131, 96, v128
v_xor_b32 v132, 128, v128
v_xor_b32 v133, 160, v128
v_xor_b32 v134, 192, v128
v_xor_b32 v135, 224, v128
s_mul_i32 s32, s38, 4096
s_add_u32 s32, s32, 65536
v_add_u32 v136, s32, v251
v_lshrrev_b32 v2, 5, v250
v_and_b32 v3, 31, v250
s_mul_i32 s32, s14, 8
v_add_u32 v147, s32, v2
v_and_b32 v6, 7, v147
v_lshlrev_b32 v6, 1, v6
v_xor_b32 v6, v6, v3
v_lshlrev_b32 v151, 4, v6
v_add_u32 v148, 2, v147
v_and_b32 v6, 7, v148
v_lshlrev_b32 v6, 1, v6
v_xor_b32 v6, v6, v3
v_lshlrev_b32 v152, 4, v6
v_subrev_u32 v152, 1024, v152
v_add_u32 v149, 4, v147
v_and_b32 v6, 7, v149
v_lshlrev_b32 v6, 1, v6
v_xor_b32 v6, v6, v3
v_lshlrev_b32 v153, 4, v6
v_subrev_u32 v153, 2048, v153
v_add_u32 v150, 6, v147
v_and_b32 v6, 7, v150
v_lshlrev_b32 v6, 1, v6
v_xor_b32 v6, v6, v3
v_lshlrev_b32 v154, 4, v6
v_subrev_u32 v154, 3072, v154
s_mul_i32 s19, s14, 4096
s_mul_i32 s20, s14, 2048
s_add_u32 s20, s20, 65536
s_mul_i32 s32, s14, 2
s_mul_i32 s32, s32, s31
v_mad_u32_u24 v137, v147, s30, v151
v_mad_u32_u24 v138, v148, s30, v152
v_mad_u32_u24 v139, v149, s30, v153
v_mad_u32_u24 v140, v150, s30, v154
v_add_u32 v141, s32, v251
s_add_u32 s32, s32, s31
s_sub_u32 s32, s32, 1024
v_add_u32 v142, s32, v251
s_mul_i32 s17, s30, 32
s_mov_b32 s15, 0
s_waitcnt vmcnt(0)
s_add_u32 m0, s20, 0
s_nop 0
buffer_load_dwordx4 v141, s[4:7], s16 offen offset:0 sc1 lds
buffer_load_dwordx4 v142, s[4:7], s16 offen offset:1024 sc1 lds
s_add_u32 s16, s16, 1024
s_add_u32 m0, s19, 0
s_nop 0
buffer_load_dwordx4 v137, s[8:11], s15 offen offset:0 lds
buffer_load_dwordx4 v138, s[8:11], s15 offen offset:1024 lds
buffer_load_dwordx4 v139, s[8:11], s15 offen offset:2048 lds
buffer_load_dwordx4 v140, s[8:11], s15 offen offset:3072 lds
s_add_u32 s15, s15, s17
s_add_u32 m0, s20, 8192
s_nop 0
buffer_load_dwordx4 v141, s[4:7], s16 offen offset:0 sc1 lds
buffer_load_dwordx4 v142, s[4:7], s16 offen offset:1024 sc1 lds
s_add_u32 s16, s16, 1024
s_add_u32 m0, s19, 16384
s_nop 0
buffer_load_dwordx4 v137, s[8:11], s15 offen offset:0 lds
buffer_load_dwordx4 v138, s[8:11], s15 offen offset:1024 lds
buffer_load_dwordx4 v139, s[8:11], s15 offen offset:2048 lds
buffer_load_dwordx4 v140, s[8:11], s15 offen offset:3072 lds
s_add_u32 s15, s15, s17
s_add_u32 m0, s20, 16384
s_nop 0
buffer_load_dwordx4 v141, s[4:7], s16 offen offset:0 sc1 lds
buffer_load_dwordx4 v142, s[4:7], s16 offen offset:1024 sc1 lds
s_add_u32 s16, s16, 1024
s_add_u32 m0, s19, 32768
s_nop 0
buffer_load_dwordx4 v137, s[8:11], s15 offen offset:0 lds
buffer_load_dwordx4 v138, s[8:11], s15 offen offset:1024 lds
buffer_load_dwordx4 v139, s[8:11], s15 offen offset:2048 lds
buffer_load_dwordx4 v140, s[8:11], s15 offen offset:3072 lds
s_add_u32 s15, s15, s17
s_add_u32 m0, s20, 24576
s_nop 0
buffer_load_dwordx4 v141, s[4:7], s16 offen offset:0 sc1 lds
buffer_load_dwordx4 v142, s[4:7], s16 offen offset:1024 sc1 lds
s_add_u32 s16, s16, 1024
s_add_u32 m0, s19, 49152
s_nop 0
buffer_load_dwordx4 v137, s[8:11], s15 offen offset:0 lds
buffer_load_dwordx4 v138, s[8:11], s15 offen offset:1024 lds
buffer_load_dwordx4 v139, s[8:11], s15 offen offset:2048 lds
buffer_load_dwordx4 v140, s[8:11], s15 offen offset:3072 lds
s_add_u32 s15, s15, s17
s_cmp_lg_u32 s56, 0
s_cbranch_scc1 main_kernel_w_epi
main_kernel_w_c1_n_ent:
v_mfma_f32_32x32x16_bf16 a[0:15], v[224:227], v[224:227], 0
s_waitcnt vmcnt(18)
s_barrier
ds_read_b128 v[32:35], v136 offset:0
ds_read_b64_tr_b16 v[0:1], v128 offset:0
ds_read_b64_tr_b16 v[2:3], v128 offset:8192
v_mfma_f32_32x32x16_bf16 a[16:31], v[224:227], v[224:227], 0
ds_read_b64_tr_b16 v[4:5], v129 offset:0
ds_read_b64_tr_b16 v[6:7], v129 offset:8192
ds_read_b64_tr_b16 v[8:9], v130 offset:0
v_mfma_f32_32x32x16_bf16 a[32:47], v[224:227], v[224:227], 0
ds_read_b64_tr_b16 v[10:11], v130 offset:8192
ds_read_b64_tr_b16 v[12:13], v131 offset:0
ds_read_b64_tr_b16 v[14:15], v131 offset:8192
v_mfma_f32_32x32x16_bf16 a[48:63], v[224:227], v[224:227], 0
ds_read_b64_tr_b16 v[16:17], v132 offset:0
ds_read_b64_tr_b16 v[18:19], v132 offset:8192
ds_read_b64_tr_b16 v[20:21], v133 offset:0
v_mfma_f32_32x32x16_bf16 a[64:79], v[224:227], v[224:227], 0
ds_read_b64_tr_b16 v[22:23], v133 offset:8192
ds_read_b64_tr_b16 v[24:25], v134 offset:0
ds_read_b64_tr_b16 v[26:27], v134 offset:8192
v_mfma_f32_32x32x16_bf16 a[80:95], v[224:227], v[224:227], 0
ds_read_b64_tr_b16 v[28:29], v135 offset:0
ds_read_b64_tr_b16 v[30:31], v135 offset:8192
ds_read_b128 v[36:39], v136 offset:1024
v_mfma_f32_32x32x16_bf16 a[96:111], v[224:227], v[224:227], 0
ds_read_b128 v[40:43], v136 offset:2048
ds_read_b128 v[44:47], v136 offset:3072
v_mfma_f32_32x32x16_bf16 a[112:127], v[224:227], v[224:227], 0
s_sub_u32 s18, s72, 1
s_sub_u32 s55, s72, 2
s_orn2_b32 s55, s55, s100
s_mov_b32 s73, -1
s_nop 0
main_kernel_w_c1_n_loop:
main_kernel_w_c1_n_mid:
s_waitcnt lgkmcnt(0)
v_mfma_f32_16x16x32_bf16 a[0:3], v[0:3], v[32:35], a[0:3]
s_waitcnt vmcnt(12)
s_barrier
ds_read_b128 v[80:83], v136 offset:8192
s_add_u32 m0, s20, 0
s_nop 0
v_mfma_f32_16x16x32_bf16 a[4:7], v[4:7], v[32:35], a[4:7]
ds_read_b64_tr_b16 v[48:49], v128 offset:16384
v_mfma_f32_16x16x32_bf16 a[8:11], v[8:11], v[32:35], a[8:11]
ds_read_b64_tr_b16 v[50:51], v128 offset:24576
v_mfma_f32_16x16x32_bf16 a[12:15], v[12:15], v[32:35], a[12:15]
ds_read_b64_tr_b16 v[52:53], v129 offset:16384
buffer_load_dwordx4 v141, s[4:7], s16 offen offset:0 sc1 lds
v_mfma_f32_16x16x32_bf16 a[16:19], v[16:19], v[32:35], a[16:19]
ds_read_b64_tr_b16 v[54:55], v129 offset:24576
v_mfma_f32_16x16x32_bf16 a[20:23], v[20:23], v[32:35], a[20:23]
ds_read_b64_tr_b16 v[56:57], v130 offset:16384
v_mfma_f32_16x16x32_bf16 a[24:27], v[24:27], v[32:35], a[24:27]
ds_read_b64_tr_b16 v[58:59], v130 offset:24576
buffer_load_dwordx4 v142, s[4:7], s16 offen offset:1024 sc1 lds
v_mfma_f32_16x16x32_bf16 a[28:31], v[28:31], v[32:35], a[28:31]
ds_read_b64_tr_b16 v[60:61], v131 offset:16384
v_mfma_f32_16x16x32_bf16 a[32:35], v[0:3], v[36:39], a[32:35]
ds_read_b64_tr_b16 v[62:63], v131 offset:24576
v_mfma_f32_16x16x32_bf16 a[36:39], v[4:7], v[36:39], a[36:39]
ds_read_b64_tr_b16 v[64:65], v132 offset:16384
s_add_u32 s16, s16, 1024
v_mfma_f32_16x16x32_bf16 a[40:43], v[8:11], v[36:39], a[40:43]
ds_read_b64_tr_b16 v[66:67], v132 offset:24576
v_mfma_f32_16x16x32_bf16 a[44:47], v[12:15], v[36:39], a[44:47]
ds_read_b64_tr_b16 v[68:69], v133 offset:16384
v_mfma_f32_16x16x32_bf16 a[48:51], v[16:19], v[36:39], a[48:51]
ds_read_b64_tr_b16 v[70:71], v133 offset:24576
s_add_u32 m0, s19, 0
s_nop 0
v_mfma_f32_16x16x32_bf16 a[52:55], v[20:23], v[36:39], a[52:55]
ds_read_b64_tr_b16 v[72:73], v134 offset:16384
v_mfma_f32_16x16x32_bf16 a[56:59], v[24:27], v[36:39], a[56:59]
ds_read_b64_tr_b16 v[74:75], v134 offset:24576
v_mfma_f32_16x16x32_bf16 a[60:63], v[28:31], v[36:39], a[60:63]
ds_read_b64_tr_b16 v[76:77], v135 offset:16384
buffer_load_dwordx4 v137, s[8:11], s15 offen offset:0 lds
v_mfma_f32_16x16x32_bf16 a[64:67], v[0:3], v[40:43], a[64:67]
ds_read_b64_tr_b16 v[78:79], v135 offset:24576
v_mfma_f32_16x16x32_bf16 a[68:71], v[4:7], v[40:43], a[68:71]
ds_read_b128 v[84:87], v136 offset:9216
v_mfma_f32_16x16x32_bf16 a[72:75], v[8:11], v[40:43], a[72:75]
ds_read_b128 v[88:91], v136 offset:10240
buffer_load_dwordx4 v138, s[8:11], s15 offen offset:1024 lds
v_mfma_f32_16x16x32_bf16 a[76:79], v[12:15], v[40:43], a[76:79]
ds_read_b128 v[92:95], v136 offset:11264
v_mfma_f32_16x16x32_bf16 a[80:83], v[16:19], v[40:43], a[80:83]
v_mfma_f32_16x16x32_bf16 a[84:87], v[20:23], v[40:43], a[84:87]
buffer_load_dwordx4 v139, s[8:11], s15 offen offset:2048 lds
v_mfma_f32_16x16x32_bf16 a[88:91], v[24:27], v[40:43], a[88:91]
v_mfma_f32_16x16x32_bf16 a[92:95], v[28:31], v[40:43], a[92:95]
v_mfma_f32_16x16x32_bf16 a[96:99], v[0:3], v[44:47], a[96:99]
buffer_load_dwordx4 v140, s[8:11], s15 offen offset:3072 lds
v_mfma_f32_16x16x32_bf16 a[100:103], v[4:7], v[44:47], a[100:103]
v_mfma_f32_16x16x32_bf16 a[104:107], v[8:11], v[44:47], a[104:107]
v_mfma_f32_16x16x32_bf16 a[108:111], v[12:15], v[44:47], a[108:111]
s_add_u32 s15, s15, s17
v_mfma_f32_16x16x32_bf16 a[112:115], v[16:19], v[44:47], a[112:115]
v_mfma_f32_16x16x32_bf16 a[116:119], v[20:23], v[44:47], a[116:119]
v_mfma_f32_16x16x32_bf16 a[120:123], v[24:27], v[44:47], a[120:123]
v_mfma_f32_16x16x32_bf16 a[124:127], v[28:31], v[44:47], a[124:127]
s_waitcnt lgkmcnt(0)
v_mfma_f32_16x16x32_bf16 a[0:3], v[48:51], v[80:83], a[0:3]
s_waitcnt vmcnt(12)
s_barrier
ds_read_b128 v[32:35], v136 offset:16384
s_add_u32 m0, s20, 8192
s_nop 0
v_mfma_f32_16x16x32_bf16 a[4:7], v[52:55], v[80:83], a[4:7]
ds_read_b64_tr_b16 v[0:1], v128 offset:32768
v_mfma_f32_16x16x32_bf16 a[8:11], v[56:59], v[80:83], a[8:11]
ds_read_b64_tr_b16 v[2:3], v128 offset:40960
v_mfma_f32_16x16x32_bf16 a[12:15], v[60:63], v[80:83], a[12:15]
ds_read_b64_tr_b16 v[4:5], v129 offset:32768
buffer_load_dwordx4 v141, s[4:7], s16 offen offset:0 sc1 lds
v_mfma_f32_16x16x32_bf16 a[16:19], v[64:67], v[80:83], a[16:19]
ds_read_b64_tr_b16 v[6:7], v129 offset:40960
v_mfma_f32_16x16x32_bf16 a[20:23], v[68:71], v[80:83], a[20:23]
ds_read_b64_tr_b16 v[8:9], v130 offset:32768
v_mfma_f32_16x16x32_bf16 a[24:27], v[72:75], v[80:83], a[24:27]
ds_read_b64_tr_b16 v[10:11], v130 offset:40960
buffer_load_dwordx4 v142, s[4:7], s16 offen offset:1024 sc1 lds
v_mfma_f32_16x16x32_bf16 a[28:31], v[76:79], v[80:83], a[28:31]
ds_read_b64_tr_b16 v[12:13], v131 offset:32768
v_mfma_f32_16x16x32_bf16 a[32:35], v[48:51], v[84:87], a[32:35]
ds_read_b64_tr_b16 v[14:15], v131 offset:40960
v_mfma_f32_16x16x32_bf16 a[36:39], v[52:55], v[84:87], a[36:39]
ds_read_b64_tr_b16 v[16:17], v132 offset:32768
s_add_u32 s16, s16, 1024
v_mfma_f32_16x16x32_bf16 a[40:43], v[56:59], v[84:87], a[40:43]
ds_read_b64_tr_b16 v[18:19], v132 offset:40960
v_mfma_f32_16x16x32_bf16 a[44:47], v[60:63], v[84:87], a[44:47]
ds_read_b64_tr_b16 v[20:21], v133 offset:32768
v_mfma_f32_16x16x32_bf16 a[48:51], v[64:67], v[84:87], a[48:51]
ds_read_b64_tr_b16 v[22:23], v133 offset:40960
s_add_u32 m0, s19, 16384
s_nop 0
v_mfma_f32_16x16x32_bf16 a[52:55], v[68:71], v[84:87], a[52:55]
ds_read_b64_tr_b16 v[24:25], v134 offset:32768
v_mfma_f32_16x16x32_bf16 a[56:59], v[72:75], v[84:87], a[56:59]
ds_read_b64_tr_b16 v[26:27], v134 offset:40960
v_mfma_f32_16x16x32_bf16 a[60:63], v[76:79], v[84:87], a[60:63]
ds_read_b64_tr_b16 v[28:29], v135 offset:32768
buffer_load_dwordx4 v137, s[8:11], s15 offen offset:0 lds
v_mfma_f32_16x16x32_bf16 a[64:67], v[48:51], v[88:91], a[64:67]
ds_read_b64_tr_b16 v[30:31], v135 offset:40960
v_mfma_f32_16x16x32_bf16 a[68:71], v[52:55], v[88:91], a[68:71]
ds_read_b128 v[36:39], v136 offset:17408
v_mfma_f32_16x16x32_bf16 a[72:75], v[56:59], v[88:91], a[72:75]
ds_read_b128 v[40:43], v136 offset:18432
buffer_load_dwordx4 v138, s[8:11], s15 offen offset:1024 lds
v_mfma_f32_16x16x32_bf16 a[76:79], v[60:63], v[88:91], a[76:79]
ds_read_b128 v[44:47], v136 offset:19456
v_mfma_f32_16x16x32_bf16 a[80:83], v[64:67], v[88:91], a[80:83]
v_mfma_f32_16x16x32_bf16 a[84:87], v[68:71], v[88:91], a[84:87]
buffer_load_dwordx4 v139, s[8:11], s15 offen offset:2048 lds
v_mfma_f32_16x16x32_bf16 a[88:91], v[72:75], v[88:91], a[88:91]
v_mfma_f32_16x16x32_bf16 a[92:95], v[76:79], v[88:91], a[92:95]
v_mfma_f32_16x16x32_bf16 a[96:99], v[48:51], v[92:95], a[96:99]
buffer_load_dwordx4 v140, s[8:11], s15 offen offset:3072 lds
v_mfma_f32_16x16x32_bf16 a[100:103], v[52:55], v[92:95], a[100:103]
v_mfma_f32_16x16x32_bf16 a[104:107], v[56:59], v[92:95], a[104:107]
v_mfma_f32_16x16x32_bf16 a[108:111], v[60:63], v[92:95], a[108:111]
s_add_u32 s15, s15, s17
v_mfma_f32_16x16x32_bf16 a[112:115], v[64:67], v[92:95], a[112:115]
v_mfma_f32_16x16x32_bf16 a[116:119], v[68:71], v[92:95], a[116:119]
v_mfma_f32_16x16x32_bf16 a[120:123], v[72:75], v[92:95], a[120:123]
v_mfma_f32_16x16x32_bf16 a[124:127], v[76:79], v[92:95], a[124:127]
s_waitcnt lgkmcnt(0)
v_mfma_f32_16x16x32_bf16 a[0:3], v[0:3], v[32:35], a[0:3]
s_waitcnt vmcnt(12)
s_barrier
ds_read_b128 v[80:83], v136 offset:24576
s_add_u32 m0, s20, 16384
s_nop 0
v_mfma_f32_16x16x32_bf16 a[4:7], v[4:7], v[32:35], a[4:7]
ds_read_b64_tr_b16 v[48:49], v128 offset:49152
v_mfma_f32_16x16x32_bf16 a[8:11], v[8:11], v[32:35], a[8:11]
ds_read_b64_tr_b16 v[50:51], v128 offset:57344
v_mfma_f32_16x16x32_bf16 a[12:15], v[12:15], v[32:35], a[12:15]
ds_read_b64_tr_b16 v[52:53], v129 offset:49152
buffer_load_dwordx4 v141, s[4:7], s16 offen offset:0 sc1 lds
v_mfma_f32_16x16x32_bf16 a[16:19], v[16:19], v[32:35], a[16:19]
ds_read_b64_tr_b16 v[54:55], v129 offset:57344
v_mfma_f32_16x16x32_bf16 a[20:23], v[20:23], v[32:35], a[20:23]
ds_read_b64_tr_b16 v[56:57], v130 offset:49152
v_mfma_f32_16x16x32_bf16 a[24:27], v[24:27], v[32:35], a[24:27]
ds_read_b64_tr_b16 v[58:59], v130 offset:57344
buffer_load_dwordx4 v142, s[4:7], s16 offen offset:1024 sc1 lds
v_mfma_f32_16x16x32_bf16 a[28:31], v[28:31], v[32:35], a[28:31]
ds_read_b64_tr_b16 v[60:61], v131 offset:49152
v_mfma_f32_16x16x32_bf16 a[32:35], v[0:3], v[36:39], a[32:35]
ds_read_b64_tr_b16 v[62:63], v131 offset:57344
v_mfma_f32_16x16x32_bf16 a[36:39], v[4:7], v[36:39], a[36:39]
ds_read_b64_tr_b16 v[64:65], v132 offset:49152
s_add_u32 s16, s16, 1024
v_mfma_f32_16x16x32_bf16 a[40:43], v[8:11], v[36:39], a[40:43]
ds_read_b64_tr_b16 v[66:67], v132 offset:57344
v_mfma_f32_16x16x32_bf16 a[44:47], v[12:15], v[36:39], a[44:47]
ds_read_b64_tr_b16 v[68:69], v133 offset:49152
v_mfma_f32_16x16x32_bf16 a[48:51], v[16:19], v[36:39], a[48:51]
ds_read_b64_tr_b16 v[70:71], v133 offset:57344
s_add_u32 m0, s19, 32768
s_nop 0
v_mfma_f32_16x16x32_bf16 a[52:55], v[20:23], v[36:39], a[52:55]
ds_read_b64_tr_b16 v[72:73], v134 offset:49152
v_mfma_f32_16x16x32_bf16 a[56:59], v[24:27], v[36:39], a[56:59]
ds_read_b64_tr_b16 v[74:75], v134 offset:57344
v_mfma_f32_16x16x32_bf16 a[60:63], v[28:31], v[36:39], a[60:63]
ds_read_b64_tr_b16 v[76:77], v135 offset:49152
buffer_load_dwordx4 v137, s[8:11], s15 offen offset:0 lds
v_mfma_f32_16x16x32_bf16 a[64:67], v[0:3], v[40:43], a[64:67]
ds_read_b64_tr_b16 v[78:79], v135 offset:57344
v_mfma_f32_16x16x32_bf16 a[68:71], v[4:7], v[40:43], a[68:71]
ds_read_b128 v[84:87], v136 offset:25600
v_mfma_f32_16x16x32_bf16 a[72:75], v[8:11], v[40:43], a[72:75]
ds_read_b128 v[88:91], v136 offset:26624
buffer_load_dwordx4 v138, s[8:11], s15 offen offset:1024 lds
v_mfma_f32_16x16x32_bf16 a[76:79], v[12:15], v[40:43], a[76:79]
ds_read_b128 v[92:95], v136 offset:27648
v_mfma_f32_16x16x32_bf16 a[80:83], v[16:19], v[40:43], a[80:83]
v_mfma_f32_16x16x32_bf16 a[84:87], v[20:23], v[40:43], a[84:87]
buffer_load_dwordx4 v139, s[8:11], s15 offen offset:2048 lds
v_mfma_f32_16x16x32_bf16 a[88:91], v[24:27], v[40:43], a[88:91]
v_mfma_f32_16x16x32_bf16 a[92:95], v[28:31], v[40:43], a[92:95]
v_mfma_f32_16x16x32_bf16 a[96:99], v[0:3], v[44:47], a[96:99]
buffer_load_dwordx4 v140, s[8:11], s15 offen offset:3072 lds
v_mfma_f32_16x16x32_bf16 a[100:103], v[4:7], v[44:47], a[100:103]
v_mfma_f32_16x16x32_bf16 a[104:107], v[8:11], v[44:47], a[104:107]
v_mfma_f32_16x16x32_bf16 a[108:111], v[12:15], v[44:47], a[108:111]
s_add_u32 s15, s15, s17
v_mfma_f32_16x16x32_bf16 a[112:115], v[16:19], v[44:47], a[112:115]
v_mfma_f32_16x16x32_bf16 a[116:119], v[20:23], v[44:47], a[116:119]
v_mfma_f32_16x16x32_bf16 a[120:123], v[24:27], v[44:47], a[120:123]
v_mfma_f32_16x16x32_bf16 a[124:127], v[28:31], v[44:47], a[124:127]
s_waitcnt lgkmcnt(0)
v_mfma_f32_16x16x32_bf16 a[0:3], v[48:51], v[80:83], a[0:3]
s_waitcnt vmcnt(12)
s_barrier
ds_read_b128 v[32:35], v136 offset:0
s_add_u32 m0, s20, 24576
s_nop 0
v_mfma_f32_16x16x32_bf16 a[4:7], v[52:55], v[80:83], a[4:7]
ds_read_b64_tr_b16 v[0:1], v128 offset:0
v_mfma_f32_16x16x32_bf16 a[8:11], v[56:59], v[80:83], a[8:11]
ds_read_b64_tr_b16 v[2:3], v128 offset:8192
v_mfma_f32_16x16x32_bf16 a[12:15], v[60:63], v[80:83], a[12:15]
ds_read_b64_tr_b16 v[4:5], v129 offset:0
buffer_load_dwordx4 v141, s[4:7], s16 offen offset:0 sc1 lds
v_mfma_f32_16x16x32_bf16 a[16:19], v[64:67], v[80:83], a[16:19]
ds_read_b64_tr_b16 v[6:7], v129 offset:8192
v_mfma_f32_16x16x32_bf16 a[20:23], v[68:71], v[80:83], a[20:23]
ds_read_b64_tr_b16 v[8:9], v130 offset:0
v_mfma_f32_16x16x32_bf16 a[24:27], v[72:75], v[80:83], a[24:27]
ds_read_b64_tr_b16 v[10:11], v130 offset:8192
buffer_load_dwordx4 v142, s[4:7], s16 offen offset:1024 sc1 lds
v_mfma_f32_16x16x32_bf16 a[28:31], v[76:79], v[80:83], a[28:31]
ds_read_b64_tr_b16 v[12:13], v131 offset:0
v_mfma_f32_16x16x32_bf16 a[32:35], v[48:51], v[84:87], a[32:35]
ds_read_b64_tr_b16 v[14:15], v131 offset:8192
v_mfma_f32_16x16x32_bf16 a[36:39], v[52:55], v[84:87], a[36:39]
ds_read_b64_tr_b16 v[16:17], v132 offset:0
s_add_u32 s16, s16, 1024
v_mfma_f32_16x16x32_bf16 a[40:43], v[56:59], v[84:87], a[40:43]
ds_read_b64_tr_b16 v[18:19], v132 offset:8192
v_mfma_f32_16x16x32_bf16 a[44:47], v[60:63], v[84:87], a[44:47]
ds_read_b64_tr_b16 v[20:21], v133 offset:0
v_mfma_f32_16x16x32_bf16 a[48:51], v[64:67], v[84:87], a[48:51]
ds_read_b64_tr_b16 v[22:23], v133 offset:8192
s_add_u32 m0, s19, 49152
s_nop 0
v_mfma_f32_16x16x32_bf16 a[52:55], v[68:71], v[84:87], a[52:55]
ds_read_b64_tr_b16 v[24:25], v134 offset:0
v_mfma_f32_16x16x32_bf16 a[56:59], v[72:75], v[84:87], a[56:59]
ds_read_b64_tr_b16 v[26:27], v134 offset:8192
v_mfma_f32_16x16x32_bf16 a[60:63], v[76:79], v[84:87], a[60:63]
ds_read_b64_tr_b16 v[28:29], v135 offset:0
buffer_load_dwordx4 v137, s[8:11], s15 offen offset:0 lds
v_mfma_f32_16x16x32_bf16 a[64:67], v[48:51], v[88:91], a[64:67]
ds_read_b64_tr_b16 v[30:31], v135 offset:8192
v_mfma_f32_16x16x32_bf16 a[68:71], v[52:55], v[88:91], a[68:71]
ds_read_b128 v[36:39], v136 offset:1024
v_mfma_f32_16x16x32_bf16 a[72:75], v[56:59], v[88:91], a[72:75]
ds_read_b128 v[40:43], v136 offset:2048
buffer_load_dwordx4 v138, s[8:11], s15 offen offset:1024 lds
v_mfma_f32_16x16x32_bf16 a[76:79], v[60:63], v[88:91], a[76:79]
ds_read_b128 v[44:47], v136 offset:3072
v_mfma_f32_16x16x32_bf16 a[80:83], v[64:67], v[88:91], a[80:83]
v_mfma_f32_16x16x32_bf16 a[84:87], v[68:71], v[88:91], a[84:87]
buffer_load_dwordx4 v139, s[8:11], s15 offen offset:2048 lds
v_mfma_f32_16x16x32_bf16 a[88:91], v[72:75], v[88:91], a[88:91]
v_mfma_f32_16x16x32_bf16 a[92:95], v[76:79], v[88:91], a[92:95]
v_mfma_f32_16x16x32_bf16 a[96:99], v[48:51], v[92:95], a[96:99]
buffer_load_dwordx4 v140, s[8:11], s15 offen offset:3072 lds
v_mfma_f32_16x16x32_bf16 a[100:103], v[52:55], v[92:95], a[100:103]
v_mfma_f32_16x16x32_bf16 a[104:107], v[56:59], v[92:95], a[104:107]
v_mfma_f32_16x16x32_bf16 a[108:111], v[60:63], v[92:95], a[108:111]
s_add_u32 s15, s15, s17
v_mfma_f32_16x16x32_bf16 a[112:115], v[64:67], v[92:95], a[112:115]
v_mfma_f32_16x16x32_bf16 a[116:119], v[68:71], v[92:95], a[116:119]
v_mfma_f32_16x16x32_bf16 a[120:123], v[72:75], v[92:95], a[120:123]
v_mfma_f32_16x16x32_bf16 a[124:127], v[76:79], v[92:95], a[124:127]
s_sub_u32 s18, s18, 1
s_cmp_eq_u32 s18, s55
s_cbranch_scc1 main_kernel_w_c1_n_ev
s_cmp_lg_u32 s18, 0
s_cbranch_scc1 main_kernel_w_c1_n_loop
s_cmp_lg_u32 s73, -1
s_cbranch_scc1 main_kernel_w_epn
s_waitcnt lgkmcnt(0)
v_mfma_f32_16x16x32_bf16 a[0:3], v[0:3], v[32:35], a[0:3]
s_waitcnt vmcnt(12)
s_barrier
ds_read_b128 v[80:83], v136 offset:8192
s_add_u32 m0, s20, 0
s_nop 0
s_add_u32 s32, s23, 1
s_bitcmp0_b32 s32, 2
s_cselect_b32 s34, 7, 2
s_cselect_b32 s35, 2, 4
s_lshl_b32 s59, s23, 13
s_add_u32 s59, s59, 0x8404000
v_mfma_f32_16x16x32_bf16 a[4:7], v[4:7], v[32:35], a[4:7]
ds_read_b64_tr_b16 v[48:49], v128 offset:16384
v_lshrrev_b32 v253, 3, v250
v_add_lshl_u32 v253, s24, v253, 9
v_mfma_f32_16x16x32_bf16 a[8:11], v[8:11], v[32:35], a[8:11]
ds_read_b64_tr_b16 v[50:51], v128 offset:24576
v_and_b32 v254, 3, v250
v_lshl_add_u32 v253, v254, s34, v253
v_mfma_f32_16x16x32_bf16 a[12:15], v[12:15], v[32:35], a[12:15]
ds_read_b64_tr_b16 v[52:53], v129 offset:16384
buffer_load_dwordx4 v141, s[4:7], s16 offen offset:0 sc1 lds
v_bfe_u32 v254, v250, 2, 1
v_add_u32 v254, s25, v254
v_mfma_f32_16x16x32_bf16 a[16:19], v[16:19], v[32:35], a[16:19]
ds_read_b64_tr_b16 v[54:55], v129 offset:24576
v_lshl_add_u32 v248, v254, s35, v253
s_lshl_b32 s0, 4, s54
v_mfma_f32_16x16x32_bf16 a[20:23], v[20:23], v[32:35], a[20:23]
ds_read_b64_tr_b16 v[56:57], v130 offset:16384
v_readfirstlane_b32 s28, v249
s_nop 1
v_cmp_ge_u32 vcc, s28, v229
v_mfma_f32_16x16x32_bf16 a[24:27], v[24:27], v[32:35], a[24:27]
ds_read_b64_tr_b16 v[58:59], v130 offset:24576
buffer_load_dwordx4 v142, s[4:7], s16 offen offset:1024 sc1 lds
s_nop 1
s_bcnt1_i32_b64 s32, vcc
v_mfma_f32_16x16x32_bf16 a[28:31], v[28:31], v[32:35], a[28:31]
ds_read_b64_tr_b16 v[60:61], v131 offset:16384
s_sub_u32 s32, s32, 1
v_readlane_b32 s36, v230, s32
v_mfma_f32_16x16x32_bf16 a[32:35], v[0:3], v[36:39], a[32:35]
ds_read_b64_tr_b16 v[62:63], v131 offset:24576
s_nop 1
s_and_b32 s32, s36, 0x7ff
v_mfma_f32_16x16x32_bf16 a[36:39], v[4:7], v[36:39], a[36:39]
ds_read_b64_tr_b16 v[64:65], v132 offset:16384
s_add_u32 s16, s16, 1024
s_sub_u32 s28, s28, s32
s_bfe_u32 s32, s36, 0x3001a
v_mfma_f32_16x16x32_bf16 a[40:43], v[8:11], v[36:39], a[40:43]
ds_read_b64_tr_b16 v[66:67], v132 offset:24576
s_lshr_b32 s25, s28, s32
s_lshl_b32 s33, s25, s32
s_sub_u32 s24, s28, s33
v_mfma_f32_16x16x32_bf16 a[44:47], v[12:15], v[36:39], a[44:47]
ds_read_b64_tr_b16 v[68:69], v133 offset:16384
s_bfe_u32 s34, s36, 0x1001d
s_lshl_b32 s24, s24, s34
v_mfma_f32_16x16x32_bf16 a[48:51], v[16:19], v[36:39], a[48:51]
ds_read_b64_tr_b16 v[70:71], v133 offset:24576
s_add_u32 m0, s19, 0
s_nop 0
s_bfe_u32 s35, s36, 0x1001e
s_lshl_b32 s25, s25, s35
v_mfma_f32_16x16x32_bf16 a[52:55], v[20:23], v[36:39], a[52:55]
ds_read_b64_tr_b16 v[72:73], v134 offset:16384
s_bfe_u32 s32, s36, 0x40011
s_add_u32 s24, s24, s32
v_mfma_f32_16x16x32_bf16 a[56:59], v[24:27], v[36:39], a[56:59]
ds_read_b64_tr_b16 v[74:75], v134 offset:24576
s_bfe_u32 s32, s36, 0x50015
s_add_u32 s25, s25, s32
v_mfma_f32_16x16x32_bf16 a[60:63], v[28:31], v[36:39], a[60:63]
ds_read_b64_tr_b16 v[76:77], v135 offset:16384
buffer_load_dwordx4 v137, s[8:11], s15 offen offset:0 lds
s_bfe_u32 s23, s36, 0x4000b
s_bfe_u32 s36, s36, 0x6000b
s_lshl_b32 s32, s24, 8
v_mfma_f32_16x16x32_bf16 a[64:67], v[0:3], v[40:43], a[64:67]
ds_read_b64_tr_b16 v[78:79], v135 offset:24576
s_or_b32 s36, s36, s32
s_lshl_b32 s32, s25, 16
v_mfma_f32_16x16x32_bf16 a[68:71], v[4:7], v[40:43], a[68:71]
ds_read_b128 v[84:87], v136 offset:9216
s_or_b32 s36, s36, s32
s_cmp_eq_u32 s23, 4
s_cselect_b32 s32, 1, 0
v_mfma_f32_16x16x32_bf16 a[72:75], v[8:11], v[40:43], a[72:75]
ds_read_b128 v[88:91], v136 offset:10240
buffer_load_dwordx4 v138, s[8:11], s15 offen offset:1024 lds
s_sub_u32 s48, s24, s32
s_max_i32 s48, s48, 0
v_mfma_f32_16x16x32_bf16 a[76:79], v[12:15], v[40:43], a[76:79]
ds_read_b128 v[92:95], v136 offset:11264
s_add_u32 s49, s24, s34
s_add_u32 s49, s49, s32
v_mfma_f32_16x16x32_bf16 a[80:83], v[16:19], v[40:43], a[80:83]
s_min_u32 s49, s49, 15
s_cmp_eq_u32 s23, 6
s_cselect_b32 s51, 3, 7
s_cmp_eq_u32 s23, 7
s_cselect_b32 s51, 27, s51
s_cselect_b32 s50, 5, 4
v_mfma_f32_16x16x32_bf16 a[84:87], v[20:23], v[40:43], a[84:87]
buffer_load_dwordx4 v139, s[8:11], s15 offen offset:2048 lds
s_add_u32 s33, s25, s35
s_lshl_b32 s34, s24, 9
v_mfma_f32_16x16x32_bf16 a[88:91], v[24:27], v[40:43], a[88:91]
s_cmp_eq_u32 s23, 8
s_cselect_b32 s51, 0, s51
s_cselect_b32 s48, s25, s48
s_cselect_b32 s49, s33, s49
s_cmp_eq_u32 s23, 8
s_cselect_b32 s63, 2, 9
s_cselect_b32 s61, 0, 0x7f000000
s_cselect_b32 s34, s34, 0
v_mfma_f32_16x16x32_bf16 a[92:95], v[28:31], v[40:43], a[92:95]
v_lshrrev_b32 v228, s50, v250
v_lshlrev_b32 v254, s50, v228
v_mfma_f32_16x16x32_bf16 a[96:99], v[0:3], v[44:47], a[96:99]
buffer_load_dwordx4 v140, s[8:11], s15 offen offset:3072 lds
v_sub_u32 v254, v250, v254
s_cmp_lt_u32 s23, 4
s_cselect_b32 s39, 10, s23
v_mfma_f32_16x16x32_bf16 a[100:103], v[4:7], v[44:47], a[100:103]
v_min_u32 v254, s51, v254
s_lshl_b32 s39, s39, 13
s_cmp_eq_u32 s23, 3
s_cselect_b32 s34, 4, s34
v_mfma_f32_16x16x32_bf16 a[104:107], v[8:11], v[44:47], a[104:107]
v_add_u32 v228, s48, v228
s_add_u32 s39, s39, s34
v_mfma_f32_16x16x32_bf16 a[108:111], v[12:15], v[44:47], a[108:111]
s_add_u32 s15, s15, s17
s_add_u32 s39, s39, 0x8402000
v_min_u32 v228, s49, v228
v_mfma_f32_16x16x32_bf16 a[112:115], v[16:19], v[44:47], a[112:115]
s_lshl_b32 s60, s24, 10
s_add_u32 s60, s60, 0x8400000
v_mfma_f32_16x16x32_bf16 a[116:119], v[20:23], v[44:47], a[116:119]
v_lshlrev_b32 v228, s63, v228
v_lshl_add_u32 v228, v254, 4, v228
v_mfma_f32_16x16x32_bf16 a[120:123], v[24:27], v[44:47], a[120:123]
v_or_b32 v146, s61, v251
s_mov_b64 exec, s[100:101]
buffer_load_dword v231, v228, s[4:7], s39 offen sc1
buffer_load_dwordx4 v[232:235], v146, s[4:7], s60 offen sc1
s_mov_b64 exec, -1
v_mfma_f32_16x16x32_bf16 a[124:127], v[28:31], v[44:47], a[124:127]
s_waitcnt lgkmcnt(0)
v_mfma_f32_16x16x32_bf16 a[0:3], v[48:51], v[80:83], a[0:3]
s_waitcnt vmcnt(12)
s_barrier
ds_read_b128 v[32:35], v136 offset:16384
s_add_u32 m0, s20, 8192
s_nop 0
s_mov_b32 s1, s21
v_mfma_f32_16x16x32_bf16 a[4:7], v[52:55], v[80:83], a[4:7]
ds_read_b64_tr_b16 v[0:1], v128 offset:32768
v_mfma_f32_16x16x32_bf16 a[8:11], v[56:59], v[80:83], a[8:11]
ds_read_b64_tr_b16 v[2:3], v128 offset:40960
v_mfma_f32_16x16x32_bf16 a[12:15], v[60:63], v[80:83], a[12:15]
ds_read_b64_tr_b16 v[4:5], v129 offset:32768
buffer_load_dwordx4 v141, s[4:7], s16 offen offset:0 sc1 lds
v_mfma_f32_16x16x32_bf16 a[16:19], v[64:67], v[80:83], a[16:19]
ds_read_b64_tr_b16 v[6:7], v129 offset:40960
v_mfma_f32_16x16x32_bf16 a[20:23], v[68:71], v[80:83], a[20:23]
ds_read_b64_tr_b16 v[8:9], v130 offset:32768
s_mov_b32 s2, s22
v_mfma_f32_16x16x32_bf16 a[24:27], v[72:75], v[80:83], a[24:27]
ds_read_b64_tr_b16 v[10:11], v130 offset:40960
buffer_load_dwordx4 v142, s[4:7], s16 offen offset:1024 sc1 lds
v_mfma_f32_16x16x32_bf16 a[28:31], v[76:79], v[80:83], a[28:31]
ds_read_b64_tr_b16 v[12:13], v131 offset:32768
v_mfma_f32_16x16x32_bf16 a[32:35], v[48:51], v[84:87], a[32:35]
ds_read_b64_tr_b16 v[14:15], v131 offset:40960
v_mfma_f32_16x16x32_bf16 a[36:39], v[52:55], v[84:87], a[36:39]
ds_read_b64_tr_b16 v[16:17], v132 offset:32768
s_add_u32 s16, s16, 1024
v_mfma_f32_16x16x32_bf16 a[40:43], v[56:59], v[84:87], a[40:43]
ds_read_b64_tr_b16 v[18:19], v132 offset:40960
s_mov_b32 s3, s26
v_mfma_f32_16x16x32_bf16 a[44:47], v[60:63], v[84:87], a[44:47]
ds_read_b64_tr_b16 v[20:21], v133 offset:32768
v_mfma_f32_16x16x32_bf16 a[48:51], v[64:67], v[84:87], a[48:51]
ds_read_b64_tr_b16 v[22:23], v133 offset:40960
s_add_u32 m0, s19, 16384
s_nop 0
v_mfma_f32_16x16x32_bf16 a[52:55], v[68:71], v[84:87], a[52:55]
ds_read_b64_tr_b16 v[24:25], v134 offset:32768
v_mfma_f32_16x16x32_bf16 a[56:59], v[72:75], v[84:87], a[56:59]
ds_read_b64_tr_b16 v[26:27], v134 offset:40960
v_mfma_f32_16x16x32_bf16 a[60:63], v[76:79], v[84:87], a[60:63]
ds_read_b64_tr_b16 v[28:29], v135 offset:32768
buffer_load_dwordx4 v137, s[8:11], s15 offen offset:0 lds
s_mov_b32 s56, s57
v_mfma_f32_16x16x32_bf16 a[64:67], v[48:51], v[88:91], a[64:67]
ds_read_b64_tr_b16 v[30:31], v135 offset:40960
v_mfma_f32_16x16x32_bf16 a[68:71], v[52:55], v[88:91], a[68:71]
ds_read_b128 v[36:39], v136 offset:17408
v_mfma_f32_16x16x32_bf16 a[72:75], v[56:59], v[88:91], a[72:75]
ds_read_b128 v[40:43], v136 offset:18432
buffer_load_dwordx4 v138, s[8:11], s15 offen offset:1024 lds
v_mfma_f32_16x16x32_bf16 a[76:79], v[60:63], v[88:91], a[76:79]
ds_read_b128 v[44:47], v136 offset:19456
v_mfma_f32_16x16x32_bf16 a[80:83], v[64:67], v[88:91], a[80:83]
v_mov_b32 v145, v252
v_mfma_f32_16x16x32_bf16 a[84:87], v[68:71], v[88:91], a[84:87]
buffer_load_dwordx4 v139, s[8:11], s15 offen offset:2048 lds
v_mfma_f32_16x16x32_bf16 a[88:91], v[72:75], v[88:91], a[88:91]
v_mfma_f32_16x16x32_bf16 a[92:95], v[76:79], v[88:91], a[92:95]
v_mfma_f32_16x16x32_bf16 a[96:99], v[48:51], v[92:95], a[96:99]
buffer_load_dwordx4 v140, s[8:11], s15 offen offset:3072 lds
v_mfma_f32_16x16x32_bf16 a[100:103], v[52:55], v[92:95], a[100:103]
v_mov_b32 v255, 131072
v_mfma_f32_16x16x32_bf16 a[104:107], v[56:59], v[92:95], a[104:107]
v_mfma_f32_16x16x32_bf16 a[108:111], v[60:63], v[92:95], a[108:111]
s_add_u32 s15, s15, s17
v_mfma_f32_16x16x32_bf16 a[112:115], v[64:67], v[92:95], a[112:115]
v_mfma_f32_16x16x32_bf16 a[116:119], v[68:71], v[92:95], a[116:119]
v_mfma_f32_16x16x32_bf16 a[120:123], v[72:75], v[92:95], a[120:123]
v_mfma_f32_16x16x32_bf16 a[124:127], v[76:79], v[92:95], a[124:127]
s_waitcnt lgkmcnt(0)
v_mfma_f32_16x16x32_bf16 a[0:3], v[0:3], v[32:35], a[0:3]
s_waitcnt vmcnt(12)
s_barrier
ds_read_b128 v[80:83], v136 offset:24576
s_add_u32 m0, s20, 16384
s_nop 0
v_mfma_f32_16x16x32_bf16 a[4:7], v[4:7], v[32:35], a[4:7]
ds_read_b64_tr_b16 v[48:49], v128 offset:49152
v_mfma_f32_16x16x32_bf16 a[8:11], v[8:11], v[32:35], a[8:11]
ds_read_b64_tr_b16 v[50:51], v128 offset:57344
v_mfma_f32_16x16x32_bf16 a[12:15], v[12:15], v[32:35], a[12:15]
ds_read_b64_tr_b16 v[52:53], v129 offset:49152
buffer_load_dwordx4 v141, s[4:7], s16 offen offset:0 sc1 lds
v_mfma_f32_16x16x32_bf16 a[16:19], v[16:19], v[32:35], a[16:19]
ds_read_b64_tr_b16 v[54:55], v129 offset:57344
v_mfma_f32_16x16x32_bf16 a[20:23], v[20:23], v[32:35], a[20:23]
ds_read_b64_tr_b16 v[56:57], v130 offset:49152
v_mfma_f32_16x16x32_bf16 a[24:27], v[24:27], v[32:35], a[24:27]
ds_read_b64_tr_b16 v[58:59], v130 offset:57344
buffer_load_dwordx4 v142, s[4:7], s16 offen offset:1024 sc1 lds
v_mfma_f32_16x16x32_bf16 a[28:31], v[28:31], v[32:35], a[28:31]
ds_read_b64_tr_b16 v[60:61], v131 offset:49152
v_mfma_f32_16x16x32_bf16 a[32:35], v[0:3], v[36:39], a[32:35]
ds_read_b64_tr_b16 v[62:63], v131 offset:57344
v_mfma_f32_16x16x32_bf16 a[36:39], v[4:7], v[36:39], a[36:39]
ds_read_b64_tr_b16 v[64:65], v132 offset:49152
s_add_u32 s16, s16, 1024
v_mfma_f32_16x16x32_bf16 a[40:43], v[8:11], v[36:39], a[40:43]
ds_read_b64_tr_b16 v[66:67], v132 offset:57344
v_mfma_f32_16x16x32_bf16 a[44:47], v[12:15], v[36:39], a[44:47]
ds_read_b64_tr_b16 v[68:69], v133 offset:49152
v_mfma_f32_16x16x32_bf16 a[48:51], v[16:19], v[36:39], a[48:51]
ds_read_b64_tr_b16 v[70:71], v133 offset:57344
s_add_u32 m0, s19, 32768
s_nop 0
v_mfma_f32_16x16x32_bf16 a[52:55], v[20:23], v[36:39], a[52:55]
ds_read_b64_tr_b16 v[72:73], v134 offset:49152
v_mfma_f32_16x16x32_bf16 a[56:59], v[24:27], v[36:39], a[56:59]
ds_read_b64_tr_b16 v[74:75], v134 offset:57344
v_mfma_f32_16x16x32_bf16 a[60:63], v[28:31], v[36:39], a[60:63]
ds_read_b64_tr_b16 v[76:77], v135 offset:49152
buffer_load_dwordx4 v137, s[8:11], s15 offen offset:0 lds
v_mfma_f32_16x16x32_bf16 a[64:67], v[0:3], v[40:43], a[64:67]
ds_read_b64_tr_b16 v[78:79], v135 offset:57344
v_mfma_f32_16x16x32_bf16 a[68:71], v[4:7], v[40:43], a[68:71]
ds_read_b128 v[84:87], v136 offset:25600
v_mfma_f32_16x16x32_bf16 a[72:75], v[8:11], v[40:43], a[72:75]
ds_read_b128 v[88:91], v136 offset:26624
buffer_load_dwordx4 v138, s[8:11], s15 offen offset:1024 lds
v_mfma_f32_16x16x32_bf16 a[76:79], v[12:15], v[40:43], a[76:79]
ds_read_b128 v[92:95], v136 offset:27648
v_mfma_f32_16x16x32_bf16 a[80:83], v[16:19], v[40:43], a[80:83]
s_waitcnt vmcnt(10)
v_mfma_f32_16x16x32_bf16 a[84:87], v[20:23], v[40:43], a[84:87]
buffer_load_dwordx4 v139, s[8:11], s15 offen offset:2048 lds
v_min3_u32 v253, v232, v233, v234
v_mfma_f32_16x16x32_bf16 a[88:91], v[24:27], v[40:43], a[88:91]
v_min_u32 v253, v253, v235
v_mfma_f32_16x16x32_bf16 a[92:95], v[28:31], v[40:43], a[92:95]
v_or_b32 v253, s61, v253
v_mfma_f32_16x16x32_bf16 a[96:99], v[0:3], v[44:47], a[96:99]
buffer_load_dwordx4 v140, s[8:11], s15 offen offset:3072 lds
v_min_u32 v253, v253, v231
v_mfma_f32_16x16x32_bf16 a[100:103], v[4:7], v[44:47], a[100:103]
v_cmp_eq_u32 vcc, 0, v253
v_mfma_f32_16x16x32_bf16 a[104:107], v[8:11], v[44:47], a[104:107]
s_nop 1
v_mfma_f32_16x16x32_bf16 a[108:111], v[12:15], v[44:47], a[108:111]
s_add_u32 s15, s15, s17
s_cmp_eq_u64 vcc, 0
s_cselect_b32 s32, s36, -4
v_mfma_f32_16x16x32_bf16 a[112:115], v[16:19], v[44:47], a[112:115]
s_bitcmp1_b32 0x1df, s23
s_cselect_b32 s32, s32, -4
v_mfma_f32_16x16x32_bf16 a[116:119], v[20:23], v[44:47], a[116:119]
v_mov_b32 v254, s32
v_mfma_f32_16x16x32_bf16 a[120:123], v[24:27], v[44:47], a[120:123]
s_mov_b64 exec, s[100:101]
ds_write_b32 v255, v254
s_mov_b64 exec, -1
v_mfma_f32_16x16x32_bf16 a[124:127], v[28:31], v[44:47], a[124:127]
s_waitcnt lgkmcnt(0)
v_mfma_f32_16x16x32_bf16 a[0:3], v[48:51], v[80:83], a[0:3]
s_waitcnt vmcnt(12)
s_barrier
ds_read_b128 v[32:35], v136 offset:0
s_add_u32 m0, s20, 24576
s_nop 0
ds_read_b32 v254, v255
v_mfma_f32_16x16x32_bf16 a[4:7], v[52:55], v[80:83], a[4:7]
ds_read_b64_tr_b16 v[0:1], v128 offset:0
v_mfma_f32_16x16x32_bf16 a[8:11], v[56:59], v[80:83], a[8:11]
ds_read_b64_tr_b16 v[2:3], v128 offset:8192
v_mfma_f32_16x16x32_bf16 a[12:15], v[60:63], v[80:83], a[12:15]
ds_read_b64_tr_b16 v[4:5], v129 offset:0
buffer_load_dwordx4 v141, s[4:7], s16 offen offset:0 sc1 lds
v_mfma_f32_16x16x32_bf16 a[16:19], v[64:67], v[80:83], a[16:19]
ds_read_b64_tr_b16 v[6:7], v129 offset:8192
v_mfma_f32_16x16x32_bf16 a[20:23], v[68:71], v[80:83], a[20:23]
ds_read_b64_tr_b16 v[8:9], v130 offset:0
v_mfma_f32_16x16x32_bf16 a[24:27], v[72:75], v[80:83], a[24:27]
ds_read_b64_tr_b16 v[10:11], v130 offset:8192
buffer_load_dwordx4 v142, s[4:7], s16 offen offset:1024 sc1 lds
v_mfma_f32_16x16x32_bf16 a[28:31], v[76:79], v[80:83], a[28:31]
ds_read_b64_tr_b16 v[12:13], v131 offset:0
v_mfma_f32_16x16x32_bf16 a[32:35], v[48:51], v[84:87], a[32:35]
ds_read_b64_tr_b16 v[14:15], v131 offset:8192
v_mfma_f32_16x16x32_bf16 a[36:39], v[52:55], v[84:87], a[36:39]
ds_read_b64_tr_b16 v[16:17], v132 offset:0
s_add_u32 s16, s16, 1024
v_mfma_f32_16x16x32_bf16 a[40:43], v[56:59], v[84:87], a[40:43]
ds_read_b64_tr_b16 v[18:19], v132 offset:8192
v_mfma_f32_16x16x32_bf16 a[44:47], v[60:63], v[84:87], a[44:47]
ds_read_b64_tr_b16 v[20:21], v133 offset:0
v_mfma_f32_16x16x32_bf16 a[48:51], v[64:67], v[84:87], a[48:51]
ds_read_b64_tr_b16 v[22:23], v133 offset:8192
s_add_u32 m0, s19, 49152
s_nop 0
v_mfma_f32_16x16x32_bf16 a[52:55], v[68:71], v[84:87], a[52:55]
ds_read_b64_tr_b16 v[24:25], v134 offset:0
v_mfma_f32_16x16x32_bf16 a[56:59], v[72:75], v[84:87], a[56:59]
ds_read_b64_tr_b16 v[26:27], v134 offset:8192
v_mfma_f32_16x16x32_bf16 a[60:63], v[76:79], v[84:87], a[60:63]
ds_read_b64_tr_b16 v[28:29], v135 offset:0
buffer_load_dwordx4 v137, s[8:11], s15 offen offset:0 lds
v_mfma_f32_16x16x32_bf16 a[64:67], v[48:51], v[88:91], a[64:67]
ds_read_b64_tr_b16 v[30:31], v135 offset:8192
v_mfma_f32_16x16x32_bf16 a[68:71], v[52:55], v[88:91], a[68:71]
ds_read_b128 v[36:39], v136 offset:1024
v_mfma_f32_16x16x32_bf16 a[72:75], v[56:59], v[88:91], a[72:75]
ds_read_b128 v[40:43], v136 offset:2048
buffer_load_dwordx4 v138, s[8:11], s15 offen offset:1024 lds
v_mfma_f32_16x16x32_bf16 a[76:79], v[60:63], v[88:91], a[76:79]
ds_read_b128 v[44:47], v136 offset:3072
v_mfma_f32_16x16x32_bf16 a[80:83], v[64:67], v[88:91], a[80:83]
s_waitcnt lgkmcnt(8)
v_mfma_f32_16x16x32_bf16 a[84:87], v[68:71], v[88:91], a[84:87]
buffer_load_dwordx4 v139, s[8:11], s15 offen offset:2048 lds
v_readfirstlane_b32 s62, v254
v_mfma_f32_16x16x32_bf16 a[88:91], v[72:75], v[88:91], a[88:91]
v_mfma_f32_16x16x32_bf16 a[92:95], v[76:79], v[88:91], a[92:95]
s_nop 1
v_mfma_f32_16x16x32_bf16 a[96:99], v[48:51], v[92:95], a[96:99]
buffer_load_dwordx4 v140, s[8:11], s15 offen offset:3072 lds
s_and_b32 s23, s62, 15
v_mfma_f32_16x16x32_bf16 a[100:103], v[52:55], v[92:95], a[100:103]
v_mfma_f32_16x16x32_bf16 a[104:107], v[56:59], v[92:95], a[104:107]
s_bfe_u32 s54, s62, 0x20004
v_mfma_f32_16x16x32_bf16 a[108:111], v[60:63], v[92:95], a[108:111]
s_add_u32 s15, s15, s17
s_bfe_u32 s24, s62, 0x80008
v_mfma_f32_16x16x32_bf16 a[112:115], v[64:67], v[92:95], a[112:115]
v_mfma_f32_16x16x32_bf16 a[116:119], v[68:71], v[92:95], a[116:119]
s_lshr_b32 s25, s62, 16
v_mfma_f32_16x16x32_bf16 a[120:123], v[72:75], v[92:95], a[120:123]
v_mfma_f32_16x16x32_bf16 a[124:127], v[76:79], v[92:95], a[124:127]
s_cmp_eq_u32 s54, 1
s_cselect_b32 s73, 2, -1
s_cbranch_scc1 main_kernel_w_c1_task
s_waitcnt lgkmcnt(0)
v_mfma_f32_16x16x32_bf16 a[0:3], v[0:3], v[32:35], a[0:3]
s_waitcnt vmcnt(12)
s_barrier
ds_read_b128 v[80:83], v136 offset:8192
v_mfma_f32_16x16x32_bf16 a[4:7], v[4:7], v[32:35], a[4:7]
ds_read_b64_tr_b16 v[48:49], v128 offset:16384
v_mfma_f32_16x16x32_bf16 a[8:11], v[8:11], v[32:35], a[8:11]
ds_read_b64_tr_b16 v[50:51], v128 offset:24576
v_mfma_f32_16x16x32_bf16 a[12:15], v[12:15], v[32:35], a[12:15]
ds_read_b64_tr_b16 v[52:53], v129 offset:16384
v_mfma_f32_16x16x32_bf16 a[16:19], v[16:19], v[32:35], a[16:19]
ds_read_b64_tr_b16 v[54:55], v129 offset:24576
v_mfma_f32_16x16x32_bf16 a[20:23], v[20:23], v[32:35], a[20:23]
ds_read_b64_tr_b16 v[56:57], v130 offset:16384
v_mfma_f32_16x16x32_bf16 a[24:27], v[24:27], v[32:35], a[24:27]
ds_read_b64_tr_b16 v[58:59], v130 offset:24576
v_mfma_f32_16x16x32_bf16 a[28:31], v[28:31], v[32:35], a[28:31]
ds_read_b64_tr_b16 v[60:61], v131 offset:16384
v_mfma_f32_16x16x32_bf16 a[32:35], v[0:3], v[36:39], a[32:35]
ds_read_b64_tr_b16 v[62:63], v131 offset:24576
v_mfma_f32_16x16x32_bf16 a[36:39], v[4:7], v[36:39], a[36:39]
ds_read_b64_tr_b16 v[64:65], v132 offset:16384
v_mfma_f32_16x16x32_bf16 a[40:43], v[8:11], v[36:39], a[40:43]
ds_read_b64_tr_b16 v[66:67], v132 offset:24576
v_mfma_f32_16x16x32_bf16 a[44:47], v[12:15], v[36:39], a[44:47]
ds_read_b64_tr_b16 v[68:69], v133 offset:16384
v_mfma_f32_16x16x32_bf16 a[48:51], v[16:19], v[36:39], a[48:51]
ds_read_b64_tr_b16 v[70:71], v133 offset:24576
v_mfma_f32_16x16x32_bf16 a[52:55], v[20:23], v[36:39], a[52:55]
ds_read_b64_tr_b16 v[72:73], v134 offset:16384
v_mfma_f32_16x16x32_bf16 a[56:59], v[24:27], v[36:39], a[56:59]
ds_read_b64_tr_b16 v[74:75], v134 offset:24576
v_mfma_f32_16x16x32_bf16 a[60:63], v[28:31], v[36:39], a[60:63]
ds_read_b64_tr_b16 v[76:77], v135 offset:16384
v_mfma_f32_16x16x32_bf16 a[64:67], v[0:3], v[40:43], a[64:67]
ds_read_b64_tr_b16 v[78:79], v135 offset:24576
v_mfma_f32_16x16x32_bf16 a[68:71], v[4:7], v[40:43], a[68:71]
ds_read_b128 v[84:87], v136 offset:9216
v_mfma_f32_16x16x32_bf16 a[72:75], v[8:11], v[40:43], a[72:75]
ds_read_b128 v[88:91], v136 offset:10240
v_mfma_f32_16x16x32_bf16 a[76:79], v[12:15], v[40:43], a[76:79]
ds_read_b128 v[92:95], v136 offset:11264
v_mfma_f32_16x16x32_bf16 a[80:83], v[16:19], v[40:43], a[80:83]
v_mfma_f32_16x16x32_bf16 a[84:87], v[20:23], v[40:43], a[84:87]
v_mfma_f32_16x16x32_bf16 a[88:91], v[24:27], v[40:43], a[88:91]
v_mfma_f32_16x16x32_bf16 a[92:95], v[28:31], v[40:43], a[92:95]
v_mfma_f32_16x16x32_bf16 a[96:99], v[0:3], v[44:47], a[96:99]
v_mfma_f32_16x16x32_bf16 a[100:103], v[4:7], v[44:47], a[100:103]
v_mfma_f32_16x16x32_bf16 a[104:107], v[8:11], v[44:47], a[104:107]
v_mfma_f32_16x16x32_bf16 a[108:111], v[12:15], v[44:47], a[108:111]
v_mfma_f32_16x16x32_bf16 a[112:115], v[16:19], v[44:47], a[112:115]
v_mfma_f32_16x16x32_bf16 a[116:119], v[20:23], v[44:47], a[116:119]
v_mfma_f32_16x16x32_bf16 a[120:123], v[24:27], v[44:47], a[120:123]
v_mfma_f32_16x16x32_bf16 a[124:127], v[28:31], v[44:47], a[124:127]
s_waitcnt lgkmcnt(0)
v_mfma_f32_16x16x32_bf16 a[0:3], v[48:51], v[80:83], a[0:3]
s_waitcnt vmcnt(6)
s_barrier
ds_read_b128 v[32:35], v136 offset:16384
v_mfma_f32_16x16x32_bf16 a[4:7], v[52:55], v[80:83], a[4:7]
ds_read_b64_tr_b16 v[0:1], v128 offset:32768
v_mfma_f32_16x16x32_bf16 a[8:11], v[56:59], v[80:83], a[8:11]
ds_read_b64_tr_b16 v[2:3], v128 offset:40960
v_mfma_f32_16x16x32_bf16 a[12:15], v[60:63], v[80:83], a[12:15]
ds_read_b64_tr_b16 v[4:5], v129 offset:32768
v_mfma_f32_16x16x32_bf16 a[16:19], v[64:67], v[80:83], a[16:19]
ds_read_b64_tr_b16 v[6:7], v129 offset:40960
v_mfma_f32_16x16x32_bf16 a[20:23], v[68:71], v[80:83], a[20:23]
ds_read_b64_tr_b16 v[8:9], v130 offset:32768
v_mfma_f32_16x16x32_bf16 a[24:27], v[72:75], v[80:83], a[24:27]
ds_read_b64_tr_b16 v[10:11], v130 offset:40960
v_mfma_f32_16x16x32_bf16 a[28:31], v[76:79], v[80:83], a[28:31]
ds_read_b64_tr_b16 v[12:13], v131 offset:32768
v_mfma_f32_16x16x32_bf16 a[32:35], v[48:51], v[84:87], a[32:35]
ds_read_b64_tr_b16 v[14:15], v131 offset:40960
v_mfma_f32_16x16x32_bf16 a[36:39], v[52:55], v[84:87], a[36:39]
ds_read_b64_tr_b16 v[16:17], v132 offset:32768
v_mfma_f32_16x16x32_bf16 a[40:43], v[56:59], v[84:87], a[40:43]
ds_read_b64_tr_b16 v[18:19], v132 offset:40960
v_mfma_f32_16x16x32_bf16 a[44:47], v[60:63], v[84:87], a[44:47]
ds_read_b64_tr_b16 v[20:21], v133 offset:32768
v_mfma_f32_16x16x32_bf16 a[48:51], v[64:67], v[84:87], a[48:51]
ds_read_b64_tr_b16 v[22:23], v133 offset:40960
v_mfma_f32_16x16x32_bf16 a[52:55], v[68:71], v[84:87], a[52:55]
ds_read_b64_tr_b16 v[24:25], v134 offset:32768
v_mfma_f32_16x16x32_bf16 a[56:59], v[72:75], v[84:87], a[56:59]
ds_read_b64_tr_b16 v[26:27], v134 offset:40960
v_mfma_f32_16x16x32_bf16 a[60:63], v[76:79], v[84:87], a[60:63]
ds_read_b64_tr_b16 v[28:29], v135 offset:32768
v_mfma_f32_16x16x32_bf16 a[64:67], v[48:51], v[88:91], a[64:67]
ds_read_b64_tr_b16 v[30:31], v135 offset:40960
v_mfma_f32_16x16x32_bf16 a[68:71], v[52:55], v[88:91], a[68:71]
ds_read_b128 v[36:39], v136 offset:17408
v_mfma_f32_16x16x32_bf16 a[72:75], v[56:59], v[88:91], a[72:75]
ds_read_b128 v[40:43], v136 offset:18432
v_mfma_f32_16x16x32_bf16 a[76:79], v[60:63], v[88:91], a[76:79]
ds_read_b128 v[44:47], v136 offset:19456
v_mfma_f32_16x16x32_bf16 a[80:83], v[64:67], v[88:91], a[80:83]
v_mfma_f32_16x16x32_bf16 a[84:87], v[68:71], v[88:91], a[84:87]
v_mfma_f32_16x16x32_bf16 a[88:91], v[72:75], v[88:91], a[88:91]
v_mfma_f32_16x16x32_bf16 a[92:95], v[76:79], v[88:91], a[92:95]
v_mfma_f32_16x16x32_bf16 a[96:99], v[48:51], v[92:95], a[96:99]
v_mfma_f32_16x16x32_bf16 a[100:103], v[52:55], v[92:95], a[100:103]
v_mfma_f32_16x16x32_bf16 a[104:107], v[56:59], v[92:95], a[104:107]
v_mfma_f32_16x16x32_bf16 a[108:111], v[60:63], v[92:95], a[108:111]
v_mfma_f32_16x16x32_bf16 a[112:115], v[64:67], v[92:95], a[112:115]
v_mfma_f32_16x16x32_bf16 a[116:119], v[68:71], v[92:95], a[116:119]
v_mfma_f32_16x16x32_bf16 a[120:123], v[72:75], v[92:95], a[120:123]
v_mfma_f32_16x16x32_bf16 a[124:127], v[76:79], v[92:95], a[124:127]
s_waitcnt lgkmcnt(0)
v_mfma_f32_16x16x32_bf16 a[0:3], v[0:3], v[32:35], a[0:3]
s_waitcnt vmcnt(0)
s_barrier
ds_read_b128 v[80:83], v136 offset:24576
v_mfma_f32_16x16x32_bf16 a[4:7], v[4:7], v[32:35], a[4:7]
ds_read_b64_tr_b16 v[48:49], v128 offset:49152
v_mfma_f32_16x16x32_bf16 a[8:11], v[8:11], v[32:35], a[8:11]
ds_read_b64_tr_b16 v[50:51], v128 offset:57344
v_mfma_f32_16x16x32_bf16 a[12:15], v[12:15], v[32:35], a[12:15]
ds_read_b64_tr_b16 v[52:53], v129 offset:49152
v_mfma_f32_16x16x32_bf16 a[16:19], v[16:19], v[32:35], a[16:19]
ds_read_b64_tr_b16 v[54:55], v129 offset:57344
v_mfma_f32_16x16x32_bf16 a[20:23], v[20:23], v[32:35], a[20:23]
ds_read_b64_tr_b16 v[56:57], v130 offset:49152
v_mfma_f32_16x16x32_bf16 a[24:27], v[24:27], v[32:35], a[24:27]
ds_read_b64_tr_b16 v[58:59], v130 offset:57344
v_mfma_f32_16x16x32_bf16 a[28:31], v[28:31], v[32:35], a[28:31]
ds_read_b64_tr_b16 v[60:61], v131 offset:49152
v_mfma_f32_16x16x32_bf16 a[32:35], v[0:3], v[36:39], a[32:35]
ds_read_b64_tr_b16 v[62:63], v131 offset:57344
v_mfma_f32_16x16x32_bf16 a[36:39], v[4:7], v[36:39], a[36:39]
ds_read_b64_tr_b16 v[64:65], v132 offset:49152
v_mfma_f32_16x16x32_bf16 a[40:43], v[8:11], v[36:39], a[40:43]
ds_read_b64_tr_b16 v[66:67], v132 offset:57344
v_mfma_f32_16x16x32_bf16 a[44:47], v[12:15], v[36:39], a[44:47]
ds_read_b64_tr_b16 v[68:69], v133 offset:49152
v_mfma_f32_16x16x32_bf16 a[48:51], v[16:19], v[36:39], a[48:51]
ds_read_b64_tr_b16 v[70:71], v133 offset:57344
v_mfma_f32_16x16x32_bf16 a[52:55], v[20:23], v[36:39], a[52:55]
ds_read_b64_tr_b16 v[72:73], v134 offset:49152
v_mfma_f32_16x16x32_bf16 a[56:59], v[24:27], v[36:39], a[56:59]
ds_read_b64_tr_b16 v[74:75], v134 offset:57344
v_mfma_f32_16x16x32_bf16 a[60:63], v[28:31], v[36:39], a[60:63]
ds_read_b64_tr_b16 v[76:77], v135 offset:49152
v_mfma_f32_16x16x32_bf16 a[64:67], v[0:3], v[40:43], a[64:67]
ds_read_b64_tr_b16 v[78:79], v135 offset:57344
v_mfma_f32_16x16x32_bf16 a[68:71], v[4:7], v[40:43], a[68:71]
ds_read_b128 v[84:87], v136 offset:25600
v_mfma_f32_16x16x32_bf16 a[72:75], v[8:11], v[40:43], a[72:75]
ds_read_b128 v[88:91], v136 offset:26624
v_mfma_f32_16x16x32_bf16 a[76:79], v[12:15], v[40:43], a[76:79]
ds_read_b128 v[92:95], v136 offset:27648
v_mfma_f32_16x16x32_bf16 a[80:83], v[16:19], v[40:43], a[80:83]
v_mfma_f32_16x16x32_bf16 a[84:87], v[20:23], v[40:43], a[84:87]
v_mfma_f32_16x16x32_bf16 a[88:91], v[24:27], v[40:43], a[88:91]
v_mfma_f32_16x16x32_bf16 a[92:95], v[28:31], v[40:43], a[92:95]
v_mfma_f32_16x16x32_bf16 a[96:99], v[0:3], v[44:47], a[96:99]
v_mfma_f32_16x16x32_bf16 a[100:103], v[4:7], v[44:47], a[100:103]
v_mfma_f32_16x16x32_bf16 a[104:107], v[8:11], v[44:47], a[104:107]
v_mfma_f32_16x16x32_bf16 a[108:111], v[12:15], v[44:47], a[108:111]
v_mfma_f32_16x16x32_bf16 a[112:115], v[16:19], v[44:47], a[112:115]
v_mfma_f32_16x16x32_bf16 a[116:119], v[20:23], v[44:47], a[116:119]
v_mfma_f32_16x16x32_bf16 a[120:123], v[24:27], v[44:47], a[120:123]
v_mfma_f32_16x16x32_bf16 a[124:127], v[28:31], v[44:47], a[124:127]
s_waitcnt lgkmcnt(0)
v_mfma_f32_16x16x32_bf16 a[0:3], v[48:51], v[80:83], a[0:3]
s_barrier
v_mfma_f32_16x16x32_bf16 a[4:7], v[52:55], v[80:83], a[4:7]
v_mfma_f32_16x16x32_bf16 a[8:11], v[56:59], v[80:83], a[8:11]
v_mfma_f32_16x16x32_bf16 a[12:15], v[60:63], v[80:83], a[12:15]
v_mfma_f32_16x16x32_bf16 a[16:19], v[64:67], v[80:83], a[16:19]
v_mfma_f32_16x16x32_bf16 a[20:23], v[68:71], v[80:83], a[20:23]
v_mfma_f32_16x16x32_bf16 a[24:27], v[72:75], v[80:83], a[24:27]
v_mfma_f32_16x16x32_bf16 a[28:31], v[76:79], v[80:83], a[28:31]
v_mfma_f32_16x16x32_bf16 a[32:35], v[48:51], v[84:87], a[32:35]
v_mfma_f32_16x16x32_bf16 a[36:39], v[52:55], v[84:87], a[36:39]
v_mfma_f32_16x16x32_bf16 a[40:43], v[56:59], v[84:87], a[40:43]
v_mfma_f32_16x16x32_bf16 a[44:47], v[60:63], v[84:87], a[44:47]
v_mfma_f32_16x16x32_bf16 a[48:51], v[64:67], v[84:87], a[48:51]
v_mfma_f32_16x16x32_bf16 a[52:55], v[68:71], v[84:87], a[52:55]
v_mfma_f32_16x16x32_bf16 a[56:59], v[72:75], v[84:87], a[56:59]
v_mfma_f32_16x16x32_bf16 a[60:63], v[76:79], v[84:87], a[60:63]
v_mfma_f32_16x16x32_bf16 a[64:67], v[48:51], v[88:91], a[64:67]
v_mfma_f32_16x16x32_bf16 a[68:71], v[52:55], v[88:91], a[68:71]
v_mfma_f32_16x16x32_bf16 a[72:75], v[56:59], v[88:91], a[72:75]
v_mfma_f32_16x16x32_bf16 a[76:79], v[60:63], v[88:91], a[76:79]
v_mfma_f32_16x16x32_bf16 a[80:83], v[64:67], v[88:91], a[80:83]
v_mfma_f32_16x16x32_bf16 a[84:87], v[68:71], v[88:91], a[84:87]
v_mfma_f32_16x16x32_bf16 a[88:91], v[72:75], v[88:91], a[88:91]
v_mfma_f32_16x16x32_bf16 a[92:95], v[76:79], v[88:91], a[92:95]
v_mfma_f32_16x16x32_bf16 a[96:99], v[48:51], v[92:95], a[96:99]
v_mfma_f32_16x16x32_bf16 a[100:103], v[52:55], v[92:95], a[100:103]
v_mfma_f32_16x16x32_bf16 a[104:107], v[56:59], v[92:95], a[104:107]
v_mfma_f32_16x16x32_bf16 a[108:111], v[60:63], v[92:95], a[108:111]
v_mfma_f32_16x16x32_bf16 a[112:115], v[64:67], v[92:95], a[112:115]
v_mfma_f32_16x16x32_bf16 a[116:119], v[68:71], v[92:95], a[116:119]
v_mfma_f32_16x16x32_bf16 a[120:123], v[72:75], v[92:95], a[120:123]
v_mfma_f32_16x16x32_bf16 a[124:127], v[76:79], v[92:95], a[124:127]
s_cmp_lg_u32 s62, -4
s_cbranch_scc1 main_kernel_w_gemm
s_branch main_kernel_w_slow
main_kernel_w_c1_n_ev:
s_mov_b32 s55, 1
s_cmp_eq_u32 s56, 0
s_cbranch_scc1 main_kernel_w_c1_n_et
s_bfm_b64 exec, s0, 0
buffer_store_dword v244, v248, s[4:7], s59 offen sc1
s_mov_b64 exec, -1
s_mov_b32 s56, 0
main_kernel_w_c1_n_et:
s_cmp_lg_u32 s18, 1
s_cbranch_scc1 main_kernel_w_c1_n_loop
s_lshl_b32 s32, s27, 8
s_add_u32 s32, s32, 0x841e000
s_mov_b64 exec, 1
v_mov_b32 v249, 1
buffer_atomic_add v249, off, s[4:7], s32 sc0 sc1
s_mov_b64 exec, -1
s_branch main_kernel_w_c1_n_loop
main_kernel_w_c1_gov:
s_mov_b32 s58, 3
s_mov_b32 s72, s18
s_cmp_lg_u32 s73, -1
s_cbranch_scc1 main_kernel_w_c1_str
s_waitcnt lgkmcnt(0)
v_lshrrev_b32 v0, 4, v250
v_bfe_u32 v1, v250, 2, 2
v_lshl_add_u32 v4, v0, 2, v1
v_and_b32 v5, 7, v4
v_mul_u32_u24 v4, 512, v4
v_and_b32 v6, 3, v250
v_lshl_add_u32 v4, v6, 3, v4
s_mul_i32 s32, s37, 8
v_xor_b32 v5, s32, v5
v_lshl_add_u32 v128, v5, 5, v4
v_xor_b32 v129, 32, v128
v_xor_b32 v130, 64, v128
v_xor_b32 v131, 96, v128
v_xor_b32 v132, 128, v128
v_xor_b32 v133, 160, v128
v_xor_b32 v134, 192, v128
v_xor_b32 v135, 224, v128
s_mul_i32 s32, s38, 4096
s_add_u32 s32, s32, 65536
v_add_u32 v136, s32, v251
v_lshrrev_b32 v2, 5, v250
v_and_b32 v3, 31, v250
s_mul_i32 s32, s14, 8
v_add_u32 v147, s32, v2
v_and_b32 v6, 7, v147
v_lshlrev_b32 v6, 1, v6
v_xor_b32 v6, v6, v3
v_lshlrev_b32 v151, 4, v6
v_add_u32 v148, 2, v147
v_and_b32 v6, 7, v148
v_lshlrev_b32 v6, 1, v6
v_xor_b32 v6, v6, v3
v_lshlrev_b32 v152, 4, v6
v_subrev_u32 v152, 1024, v152
v_add_u32 v149, 4, v147
v_and_b32 v6, 7, v149
v_lshlrev_b32 v6, 1, v6
v_xor_b32 v6, v6, v3
v_lshlrev_b32 v153, 4, v6
v_subrev_u32 v153, 2048, v153
v_add_u32 v150, 6, v147
v_and_b32 v6, 7, v150
v_lshlrev_b32 v6, 1, v6
v_xor_b32 v6, v6, v3
v_lshlrev_b32 v154, 4, v6
v_subrev_u32 v154, 3072, v154
s_mul_i32 s19, s14, 4096
s_mul_i32 s20, s14, 2048
s_add_u32 s20, s20, 65536
s_mul_i32 s32, s14, 2
s_mul_i32 s32, s32, s31
v_mad_u32_u24 v137, v147, s30, v151
v_mad_u32_u24 v138, v148, s30, v152
v_mad_u32_u24 v139, v149, s30, v153
v_mad_u32_u24 v140, v150, s30, v154
v_add_u32 v141, s32, v251
s_add_u32 s32, s32, s31
s_sub_u32 s32, s32, 1024
v_add_u32 v142, s32, v251
s_mul_i32 s17, s30, 32
s_mov_b32 s15, 0
s_waitcnt vmcnt(0)
s_add_u32 m0, s20, 0
s_nop 0
buffer_load_dwordx4 v141, s[4:7], s16 offen offset:0 sc1 lds
buffer_load_dwordx4 v142, s[4:7], s16 offen offset:1024 sc1 lds
s_add_u32 s16, s16, 1024
s_add_u32 m0, s19, 0
s_nop 0
buffer_load_dwordx4 v137, s[8:11], s15 offen offset:0 lds
buffer_load_dwordx4 v138, s[8:11], s15 offen offset:1024 lds
buffer_load_dwordx4 v139, s[8:11], s15 offen offset:2048 lds
buffer_load_dwordx4 v140, s[8:11], s15 offen offset:3072 lds
s_add_u32 s15, s15, s17
s_add_u32 m0, s20, 8192
s_nop 0
buffer_load_dwordx4 v141, s[4:7], s16 offen offset:0 sc1 lds
buffer_load_dwordx4 v142, s[4:7], s16 offen offset:1024 sc1 lds
s_add_u32 s16, s16, 1024
s_add_u32 m0, s19, 16384
s_nop 0
buffer_load_dwordx4 v137, s[8:11], s15 offen offset:0 lds
buffer_load_dwordx4 v138, s[8:11], s15 offen offset:1024 lds
buffer_load_dwordx4 v139, s[8:11], s15 offen offset:2048 lds
buffer_load_dwordx4 v140, s[8:11], s15 offen offset:3072 lds
s_add_u32 s15, s15, s17
s_add_u32 m0, s20, 16384
s_nop 0
buffer_load_dwordx4 v141, s[4:7], s16 offen offset:0 sc1 lds
buffer_load_dwordx4 v142, s[4:7], s16 offen offset:1024 sc1 lds
s_add_u32 s16, s16, 1024
s_add_u32 m0, s19, 32768
s_nop 0
buffer_load_dwordx4 v137, s[8:11], s15 offen offset:0 lds
buffer_load_dwordx4 v138, s[8:11], s15 offen offset:1024 lds
buffer_load_dwordx4 v139, s[8:11], s15 offen offset:2048 lds
buffer_load_dwordx4 v140, s[8:11], s15 offen offset:3072 lds
s_add_u32 s15, s15, s17
s_add_u32 m0, s20, 24576
s_nop 0
buffer_load_dwordx4 v141, s[4:7], s16 offen offset:0 sc1 lds
buffer_load_dwordx4 v142, s[4:7], s16 offen offset:1024 sc1 lds
s_add_u32 s16, s16, 1024
s_add_u32 m0, s19, 49152
s_nop 0
buffer_load_dwordx4 v137, s[8:11], s15 offen offset:0 lds
buffer_load_dwordx4 v138, s[8:11], s15 offen offset:1024 lds
buffer_load_dwordx4 v139, s[8:11], s15 offen offset:2048 lds
buffer_load_dwordx4 v140, s[8:11], s15 offen offset:3072 lds
s_add_u32 s15, s15, s17
s_cmp_lg_u32 s56, 0
s_cbranch_scc1 main_kernel_w_epi
main_kernel_w_c1_v_ent:
v_mfma_f32_32x32x16_bf16 a[0:15], v[224:227], v[224:227], 0
s_waitcnt vmcnt(18)
s_barrier
ds_read_b128 v[32:35], v136 offset:0
ds_read_b64_tr_b16 v[0:1], v128 offset:0
ds_read_b64_tr_b16 v[2:3], v128 offset:8192
v_mfma_f32_32x32x16_bf16 a[16:31], v[224:227], v[224:227], 0
ds_read_b64_tr_b16 v[4:5], v129 offset:0
ds_read_b64_tr_b16 v[6:7], v129 offset:8192
ds_read_b64_tr_b16 v[8:9], v130 offset:0
v_mfma_f32_32x32x16_bf16 a[32:47], v[224:227], v[224:227], 0
ds_read_b64_tr_b16 v[10:11], v130 offset:8192
ds_read_b64_tr_b16 v[12:13], v131 offset:0
ds_read_b64_tr_b16 v[14:15], v131 offset:8192
v_mfma_f32_32x32x16_bf16 a[48:63], v[224:227], v[224:227], 0
ds_read_b64_tr_b16 v[16:17], v132 offset:0
ds_read_b64_tr_b16 v[18:19], v132 offset:8192
ds_read_b64_tr_b16 v[20:21], v133 offset:0
v_mfma_f32_32x32x16_bf16 a[64:79], v[224:227], v[224:227], 0
ds_read_b64_tr_b16 v[22:23], v133 offset:8192
ds_read_b64_tr_b16 v[24:25], v134 offset:0
ds_read_b64_tr_b16 v[26:27], v134 offset:8192
v_mfma_f32_32x32x16_bf16 a[80:95], v[224:227], v[224:227], 0
ds_read_b64_tr_b16 v[28:29], v135 offset:0
ds_read_b64_tr_b16 v[30:31], v135 offset:8192
ds_read_b128 v[36:39], v136 offset:1024
v_mfma_f32_32x32x16_bf16 a[96:111], v[224:227], v[224:227], 0
ds_read_b128 v[40:43], v136 offset:2048
ds_read_b128 v[44:47], v136 offset:3072
v_mfma_f32_32x32x16_bf16 a[112:127], v[224:227], v[224:227], 0
s_sub_u32 s18, s72, 1
s_sub_u32 s55, s72, 2
s_orn2_b32 s55, s55, s100
s_mov_b32 s73, -1
s_nop 0
main_kernel_w_c1_v_loop:
main_kernel_w_c1_v_mid:
s_waitcnt lgkmcnt(0)
v_mfma_f32_16x16x32_bf16 a[0:3], v[32:35], v[0:3], a[0:3]
s_waitcnt vmcnt(12)
s_barrier
ds_read_b128 v[80:83], v136 offset:8192
s_add_u32 m0, s20, 0
s_nop 0
v_mfma_f32_16x16x32_bf16 a[4:7], v[32:35], v[4:7], a[4:7]
ds_read_b64_tr_b16 v[48:49], v128 offset:16384
v_mfma_f32_16x16x32_bf16 a[8:11], v[32:35], v[8:11], a[8:11]
ds_read_b64_tr_b16 v[50:51], v128 offset:24576
v_mfma_f32_16x16x32_bf16 a[12:15], v[32:35], v[12:15], a[12:15]
ds_read_b64_tr_b16 v[52:53], v129 offset:16384
buffer_load_dwordx4 v141, s[4:7], s16 offen offset:0 sc1 lds
v_mfma_f32_16x16x32_bf16 a[16:19], v[32:35], v[16:19], a[16:19]
ds_read_b64_tr_b16 v[54:55], v129 offset:24576
v_mfma_f32_16x16x32_bf16 a[20:23], v[32:35], v[20:23], a[20:23]
ds_read_b64_tr_b16 v[56:57], v130 offset:16384
v_mfma_f32_16x16x32_bf16 a[24:27], v[32:35], v[24:27], a[24:27]
ds_read_b64_tr_b16 v[58:59], v130 offset:24576
buffer_load_dwordx4 v142, s[4:7], s16 offen offset:1024 sc1 lds
v_mfma_f32_16x16x32_bf16 a[28:31], v[32:35], v[28:31], a[28:31]
ds_read_b64_tr_b16 v[60:61], v131 offset:16384
v_mfma_f32_16x16x32_bf16 a[32:35], v[36:39], v[0:3], a[32:35]
ds_read_b64_tr_b16 v[62:63], v131 offset:24576
v_mfma_f32_16x16x32_bf16 a[36:39], v[36:39], v[4:7], a[36:39]
ds_read_b64_tr_b16 v[64:65], v132 offset:16384
s_add_u32 s16, s16, 1024
v_mfma_f32_16x16x32_bf16 a[40:43], v[36:39], v[8:11], a[40:43]
ds_read_b64_tr_b16 v[66:67], v132 offset:24576
v_mfma_f32_16x16x32_bf16 a[44:47], v[36:39], v[12:15], a[44:47]
ds_read_b64_tr_b16 v[68:69], v133 offset:16384
v_mfma_f32_16x16x32_bf16 a[48:51], v[36:39], v[16:19], a[48:51]
ds_read_b64_tr_b16 v[70:71], v133 offset:24576
s_add_u32 m0, s19, 0
s_nop 0
v_mfma_f32_16x16x32_bf16 a[52:55], v[36:39], v[20:23], a[52:55]
ds_read_b64_tr_b16 v[72:73], v134 offset:16384
v_mfma_f32_16x16x32_bf16 a[56:59], v[36:39], v[24:27], a[56:59]
ds_read_b64_tr_b16 v[74:75], v134 offset:24576
v_mfma_f32_16x16x32_bf16 a[60:63], v[36:39], v[28:31], a[60:63]
ds_read_b64_tr_b16 v[76:77], v135 offset:16384
buffer_load_dwordx4 v137, s[8:11], s15 offen offset:0 lds
v_mfma_f32_16x16x32_bf16 a[64:67], v[40:43], v[0:3], a[64:67]
ds_read_b64_tr_b16 v[78:79], v135 offset:24576
v_mfma_f32_16x16x32_bf16 a[68:71], v[40:43], v[4:7], a[68:71]
ds_read_b128 v[84:87], v136 offset:9216
v_mfma_f32_16x16x32_bf16 a[72:75], v[40:43], v[8:11], a[72:75]
ds_read_b128 v[88:91], v136 offset:10240
buffer_load_dwordx4 v138, s[8:11], s15 offen offset:1024 lds
v_mfma_f32_16x16x32_bf16 a[76:79], v[40:43], v[12:15], a[76:79]
ds_read_b128 v[92:95], v136 offset:11264
v_mfma_f32_16x16x32_bf16 a[80:83], v[40:43], v[16:19], a[80:83]
v_mfma_f32_16x16x32_bf16 a[84:87], v[40:43], v[20:23], a[84:87]
buffer_load_dwordx4 v139, s[8:11], s15 offen offset:2048 lds
v_mfma_f32_16x16x32_bf16 a[88:91], v[40:43], v[24:27], a[88:91]
v_mfma_f32_16x16x32_bf16 a[92:95], v[40:43], v[28:31], a[92:95]
v_mfma_f32_16x16x32_bf16 a[96:99], v[44:47], v[0:3], a[96:99]
buffer_load_dwordx4 v140, s[8:11], s15 offen offset:3072 lds
v_mfma_f32_16x16x32_bf16 a[100:103], v[44:47], v[4:7], a[100:103]
v_mfma_f32_16x16x32_bf16 a[104:107], v[44:47], v[8:11], a[104:107]
v_mfma_f32_16x16x32_bf16 a[108:111], v[44:47], v[12:15], a[108:111]
s_add_u32 s15, s15, s17
v_mfma_f32_16x16x32_bf16 a[112:115], v[44:47], v[16:19], a[112:115]
v_mfma_f32_16x16x32_bf16 a[116:119], v[44:47], v[20:23], a[116:119]
v_mfma_f32_16x16x32_bf16 a[120:123], v[44:47], v[24:27], a[120:123]
v_mfma_f32_16x16x32_bf16 a[124:127], v[44:47], v[28:31], a[124:127]
s_waitcnt lgkmcnt(0)
v_mfma_f32_16x16x32_bf16 a[0:3], v[80:83], v[48:51], a[0:3]
s_waitcnt vmcnt(12)
s_barrier
ds_read_b128 v[32:35], v136 offset:16384
s_add_u32 m0, s20, 8192
s_nop 0
v_mfma_f32_16x16x32_bf16 a[4:7], v[80:83], v[52:55], a[4:7]
ds_read_b64_tr_b16 v[0:1], v128 offset:32768
v_mfma_f32_16x16x32_bf16 a[8:11], v[80:83], v[56:59], a[8:11]
ds_read_b64_tr_b16 v[2:3], v128 offset:40960
v_mfma_f32_16x16x32_bf16 a[12:15], v[80:83], v[60:63], a[12:15]
ds_read_b64_tr_b16 v[4:5], v129 offset:32768
buffer_load_dwordx4 v141, s[4:7], s16 offen offset:0 sc1 lds
v_mfma_f32_16x16x32_bf16 a[16:19], v[80:83], v[64:67], a[16:19]
ds_read_b64_tr_b16 v[6:7], v129 offset:40960
v_mfma_f32_16x16x32_bf16 a[20:23], v[80:83], v[68:71], a[20:23]
ds_read_b64_tr_b16 v[8:9], v130 offset:32768
v_mfma_f32_16x16x32_bf16 a[24:27], v[80:83], v[72:75], a[24:27]
ds_read_b64_tr_b16 v[10:11], v130 offset:40960
buffer_load_dwordx4 v142, s[4:7], s16 offen offset:1024 sc1 lds
v_mfma_f32_16x16x32_bf16 a[28:31], v[80:83], v[76:79], a[28:31]
ds_read_b64_tr_b16 v[12:13], v131 offset:32768
v_mfma_f32_16x16x32_bf16 a[32:35], v[84:87], v[48:51], a[32:35]
ds_read_b64_tr_b16 v[14:15], v131 offset:40960
v_mfma_f32_16x16x32_bf16 a[36:39], v[84:87], v[52:55], a[36:39]
ds_read_b64_tr_b16 v[16:17], v132 offset:32768
s_add_u32 s16, s16, 1024
v_mfma_f32_16x16x32_bf16 a[40:43], v[84:87], v[56:59], a[40:43]
ds_read_b64_tr_b16 v[18:19], v132 offset:40960
v_mfma_f32_16x16x32_bf16 a[44:47], v[84:87], v[60:63], a[44:47]
ds_read_b64_tr_b16 v[20:21], v133 offset:32768
v_mfma_f32_16x16x32_bf16 a[48:51], v[84:87], v[64:67], a[48:51]
ds_read_b64_tr_b16 v[22:23], v133 offset:40960
s_add_u32 m0, s19, 16384
s_nop 0
v_mfma_f32_16x16x32_bf16 a[52:55], v[84:87], v[68:71], a[52:55]
ds_read_b64_tr_b16 v[24:25], v134 offset:32768
v_mfma_f32_16x16x32_bf16 a[56:59], v[84:87], v[72:75], a[56:59]
ds_read_b64_tr_b16 v[26:27], v134 offset:40960
v_mfma_f32_16x16x32_bf16 a[60:63], v[84:87], v[76:79], a[60:63]
ds_read_b64_tr_b16 v[28:29], v135 offset:32768
buffer_load_dwordx4 v137, s[8:11], s15 offen offset:0 lds
v_mfma_f32_16x16x32_bf16 a[64:67], v[88:91], v[48:51], a[64:67]
ds_read_b64_tr_b16 v[30:31], v135 offset:40960
v_mfma_f32_16x16x32_bf16 a[68:71], v[88:91], v[52:55], a[68:71]
ds_read_b128 v[36:39], v136 offset:17408
v_mfma_f32_16x16x32_bf16 a[72:75], v[88:91], v[56:59], a[72:75]
ds_read_b128 v[40:43], v136 offset:18432
buffer_load_dwordx4 v138, s[8:11], s15 offen offset:1024 lds
v_mfma_f32_16x16x32_bf16 a[76:79], v[88:91], v[60:63], a[76:79]
ds_read_b128 v[44:47], v136 offset:19456
v_mfma_f32_16x16x32_bf16 a[80:83], v[88:91], v[64:67], a[80:83]
v_mfma_f32_16x16x32_bf16 a[84:87], v[88:91], v[68:71], a[84:87]
buffer_load_dwordx4 v139, s[8:11], s15 offen offset:2048 lds
v_mfma_f32_16x16x32_bf16 a[88:91], v[88:91], v[72:75], a[88:91]
v_mfma_f32_16x16x32_bf16 a[92:95], v[88:91], v[76:79], a[92:95]
v_mfma_f32_16x16x32_bf16 a[96:99], v[92:95], v[48:51], a[96:99]
buffer_load_dwordx4 v140, s[8:11], s15 offen offset:3072 lds
v_mfma_f32_16x16x32_bf16 a[100:103], v[92:95], v[52:55], a[100:103]
v_mfma_f32_16x16x32_bf16 a[104:107], v[92:95], v[56:59], a[104:107]
v_mfma_f32_16x16x32_bf16 a[108:111], v[92:95], v[60:63], a[108:111]
s_add_u32 s15, s15, s17
v_mfma_f32_16x16x32_bf16 a[112:115], v[92:95], v[64:67], a[112:115]
v_mfma_f32_16x16x32_bf16 a[116:119], v[92:95], v[68:71], a[116:119]
v_mfma_f32_16x16x32_bf16 a[120:123], v[92:95], v[72:75], a[120:123]
v_mfma_f32_16x16x32_bf16 a[124:127], v[92:95], v[76:79], a[124:127]
s_waitcnt lgkmcnt(0)
v_mfma_f32_16x16x32_bf16 a[0:3], v[32:35], v[0:3], a[0:3]
s_waitcnt vmcnt(12)
s_barrier
ds_read_b128 v[80:83], v136 offset:24576
s_add_u32 m0, s20, 16384
s_nop 0
v_mfma_f32_16x16x32_bf16 a[4:7], v[32:35], v[4:7], a[4:7]
ds_read_b64_tr_b16 v[48:49], v128 offset:49152
v_mfma_f32_16x16x32_bf16 a[8:11], v[32:35], v[8:11], a[8:11]
ds_read_b64_tr_b16 v[50:51], v128 offset:57344
v_mfma_f32_16x16x32_bf16 a[12:15], v[32:35], v[12:15], a[12:15]
ds_read_b64_tr_b16 v[52:53], v129 offset:49152
buffer_load_dwordx4 v141, s[4:7], s16 offen offset:0 sc1 lds
v_mfma_f32_16x16x32_bf16 a[16:19], v[32:35], v[16:19], a[16:19]
ds_read_b64_tr_b16 v[54:55], v129 offset:57344
v_mfma_f32_16x16x32_bf16 a[20:23], v[32:35], v[20:23], a[20:23]
ds_read_b64_tr_b16 v[56:57], v130 offset:49152
v_mfma_f32_16x16x32_bf16 a[24:27], v[32:35], v[24:27], a[24:27]
ds_read_b64_tr_b16 v[58:59], v130 offset:57344
buffer_load_dwordx4 v142, s[4:7], s16 offen offset:1024 sc1 lds
v_mfma_f32_16x16x32_bf16 a[28:31], v[32:35], v[28:31], a[28:31]
ds_read_b64_tr_b16 v[60:61], v131 offset:49152
v_mfma_f32_16x16x32_bf16 a[32:35], v[36:39], v[0:3], a[32:35]
ds_read_b64_tr_b16 v[62:63], v131 offset:57344
v_mfma_f32_16x16x32_bf16 a[36:39], v[36:39], v[4:7], a[36:39]
ds_read_b64_tr_b16 v[64:65], v132 offset:49152
s_add_u32 s16, s16, 1024
v_mfma_f32_16x16x32_bf16 a[40:43], v[36:39], v[8:11], a[40:43]
ds_read_b64_tr_b16 v[66:67], v132 offset:57344
v_mfma_f32_16x16x32_bf16 a[44:47], v[36:39], v[12:15], a[44:47]
ds_read_b64_tr_b16 v[68:69], v133 offset:49152
v_mfma_f32_16x16x32_bf16 a[48:51], v[36:39], v[16:19], a[48:51]
ds_read_b64_tr_b16 v[70:71], v133 offset:57344
s_add_u32 m0, s19, 32768
s_nop 0
v_mfma_f32_16x16x32_bf16 a[52:55], v[36:39], v[20:23], a[52:55]
ds_read_b64_tr_b16 v[72:73], v134 offset:49152
v_mfma_f32_16x16x32_bf16 a[56:59], v[36:39], v[24:27], a[56:59]
ds_read_b64_tr_b16 v[74:75], v134 offset:57344
v_mfma_f32_16x16x32_bf16 a[60:63], v[36:39], v[28:31], a[60:63]
ds_read_b64_tr_b16 v[76:77], v135 offset:49152
buffer_load_dwordx4 v137, s[8:11], s15 offen offset:0 lds
v_mfma_f32_16x16x32_bf16 a[64:67], v[40:43], v[0:3], a[64:67]
ds_read_b64_tr_b16 v[78:79], v135 offset:57344
v_mfma_f32_16x16x32_bf16 a[68:71], v[40:43], v[4:7], a[68:71]
ds_read_b128 v[84:87], v136 offset:25600
v_mfma_f32_16x16x32_bf16 a[72:75], v[40:43], v[8:11], a[72:75]
ds_read_b128 v[88:91], v136 offset:26624
buffer_load_dwordx4 v138, s[8:11], s15 offen offset:1024 lds
v_mfma_f32_16x16x32_bf16 a[76:79], v[40:43], v[12:15], a[76:79]
ds_read_b128 v[92:95], v136 offset:27648
v_mfma_f32_16x16x32_bf16 a[80:83], v[40:43], v[16:19], a[80:83]
v_mfma_f32_16x16x32_bf16 a[84:87], v[40:43], v[20:23], a[84:87]
buffer_load_dwordx4 v139, s[8:11], s15 offen offset:2048 lds
v_mfma_f32_16x16x32_bf16 a[88:91], v[40:43], v[24:27], a[88:91]
v_mfma_f32_16x16x32_bf16 a[92:95], v[40:43], v[28:31], a[92:95]
v_mfma_f32_16x16x32_bf16 a[96:99], v[44:47], v[0:3], a[96:99]
buffer_load_dwordx4 v140, s[8:11], s15 offen offset:3072 lds
v_mfma_f32_16x16x32_bf16 a[100:103], v[44:47], v[4:7], a[100:103]
v_mfma_f32_16x16x32_bf16 a[104:107], v[44:47], v[8:11], a[104:107]
v_mfma_f32_16x16x32_bf16 a[108:111], v[44:47], v[12:15], a[108:111]
s_add_u32 s15, s15, s17
v_mfma_f32_16x16x32_bf16 a[112:115], v[44:47], v[16:19], a[112:115]
v_mfma_f32_16x16x32_bf16 a[116:119], v[44:47], v[20:23], a[116:119]
v_mfma_f32_16x16x32_bf16 a[120:123], v[44:47], v[24:27], a[120:123]
v_mfma_f32_16x16x32_bf16 a[124:127], v[44:47], v[28:31], a[124:127]
s_waitcnt lgkmcnt(0)
v_mfma_f32_16x16x32_bf16 a[0:3], v[80:83], v[48:51], a[0:3]
s_waitcnt vmcnt(12)
s_barrier
ds_read_b128 v[32:35], v136 offset:0
s_add_u32 m0, s20, 24576
s_nop 0
v_mfma_f32_16x16x32_bf16 a[4:7], v[80:83], v[52:55], a[4:7]
ds_read_b64_tr_b16 v[0:1], v128 offset:0
v_mfma_f32_16x16x32_bf16 a[8:11], v[80:83], v[56:59], a[8:11]
ds_read_b64_tr_b16 v[2:3], v128 offset:8192
v_mfma_f32_16x16x32_bf16 a[12:15], v[80:83], v[60:63], a[12:15]
ds_read_b64_tr_b16 v[4:5], v129 offset:0
buffer_load_dwordx4 v141, s[4:7], s16 offen offset:0 sc1 lds
v_mfma_f32_16x16x32_bf16 a[16:19], v[80:83], v[64:67], a[16:19]
ds_read_b64_tr_b16 v[6:7], v129 offset:8192
v_mfma_f32_16x16x32_bf16 a[20:23], v[80:83], v[68:71], a[20:23]
ds_read_b64_tr_b16 v[8:9], v130 offset:0
v_mfma_f32_16x16x32_bf16 a[24:27], v[80:83], v[72:75], a[24:27]
ds_read_b64_tr_b16 v[10:11], v130 offset:8192
buffer_load_dwordx4 v142, s[4:7], s16 offen offset:1024 sc1 lds
v_mfma_f32_16x16x32_bf16 a[28:31], v[80:83], v[76:79], a[28:31]
ds_read_b64_tr_b16 v[12:13], v131 offset:0
v_mfma_f32_16x16x32_bf16 a[32:35], v[84:87], v[48:51], a[32:35]
ds_read_b64_tr_b16 v[14:15], v131 offset:8192
v_mfma_f32_16x16x32_bf16 a[36:39], v[84:87], v[52:55], a[36:39]
ds_read_b64_tr_b16 v[16:17], v132 offset:0
s_add_u32 s16, s16, 1024
v_mfma_f32_16x16x32_bf16 a[40:43], v[84:87], v[56:59], a[40:43]
ds_read_b64_tr_b16 v[18:19], v132 offset:8192
v_mfma_f32_16x16x32_bf16 a[44:47], v[84:87], v[60:63], a[44:47]
ds_read_b64_tr_b16 v[20:21], v133 offset:0
v_mfma_f32_16x16x32_bf16 a[48:51], v[84:87], v[64:67], a[48:51]
ds_read_b64_tr_b16 v[22:23], v133 offset:8192
s_add_u32 m0, s19, 49152
s_nop 0
v_mfma_f32_16x16x32_bf16 a[52:55], v[84:87], v[68:71], a[52:55]
ds_read_b64_tr_b16 v[24:25], v134 offset:0
v_mfma_f32_16x16x32_bf16 a[56:59], v[84:87], v[72:75], a[56:59]
ds_read_b64_tr_b16 v[26:27], v134 offset:8192
v_mfma_f32_16x16x32_bf16 a[60:63], v[84:87], v[76:79], a[60:63]
ds_read_b64_tr_b16 v[28:29], v135 offset:0
buffer_load_dwordx4 v137, s[8:11], s15 offen offset:0 lds
v_mfma_f32_16x16x32_bf16 a[64:67], v[88:91], v[48:51], a[64:67]
ds_read_b64_tr_b16 v[30:31], v135 offset:8192
v_mfma_f32_16x16x32_bf16 a[68:71], v[88:91], v[52:55], a[68:71]
ds_read_b128 v[36:39], v136 offset:1024
v_mfma_f32_16x16x32_bf16 a[72:75], v[88:91], v[56:59], a[72:75]
ds_read_b128 v[40:43], v136 offset:2048
buffer_load_dwordx4 v138, s[8:11], s15 offen offset:1024 lds
v_mfma_f32_16x16x32_bf16 a[76:79], v[88:91], v[60:63], a[76:79]
ds_read_b128 v[44:47], v136 offset:3072
v_mfma_f32_16x16x32_bf16 a[80:83], v[88:91], v[64:67], a[80:83]
v_mfma_f32_16x16x32_bf16 a[84:87], v[88:91], v[68:71], a[84:87]
buffer_load_dwordx4 v139, s[8:11], s15 offen offset:2048 lds
v_mfma_f32_16x16x32_bf16 a[88:91], v[88:91], v[72:75], a[88:91]
v_mfma_f32_16x16x32_bf16 a[92:95], v[88:91], v[76:79], a[92:95]
v_mfma_f32_16x16x32_bf16 a[96:99], v[92:95], v[48:51], a[96:99]
buffer_load_dwordx4 v140, s[8:11], s15 offen offset:3072 lds
v_mfma_f32_16x16x32_bf16 a[100:103], v[92:95], v[52:55], a[100:103]
v_mfma_f32_16x16x32_bf16 a[104:107], v[92:95], v[56:59], a[104:107]
v_mfma_f32_16x16x32_bf16 a[108:111], v[92:95], v[60:63], a[108:111]
s_add_u32 s15, s15, s17
v_mfma_f32_16x16x32_bf16 a[112:115], v[92:95], v[64:67], a[112:115]
v_mfma_f32_16x16x32_bf16 a[116:119], v[92:95], v[68:71], a[116:119]
v_mfma_f32_16x16x32_bf16 a[120:123], v[92:95], v[72:75], a[120:123]
v_mfma_f32_16x16x32_bf16 a[124:127], v[92:95], v[76:79], a[124:127]
s_sub_u32 s18, s18, 1
s_cmp_eq_u32 s18, s55
s_cbranch_scc1 main_kernel_w_c1_v_ev
s_cmp_lg_u32 s18, 0
s_cbranch_scc1 main_kernel_w_c1_v_loop
s_cmp_lg_u32 s73, -1
s_cbranch_scc1 main_kernel_w_epn
s_waitcnt lgkmcnt(0)
v_mfma_f32_16x16x32_bf16 a[0:3], v[32:35], v[0:3], a[0:3]
s_waitcnt vmcnt(12)
s_barrier
ds_read_b128 v[80:83], v136 offset:8192
s_add_u32 m0, s20, 0
s_nop 0
s_add_u32 s32, s23, 1
s_bitcmp0_b32 s32, 2
s_cselect_b32 s34, 7, 2
s_cselect_b32 s35, 2, 4
s_lshl_b32 s59, s23, 13
s_add_u32 s59, s59, 0x8404000
v_mfma_f32_16x16x32_bf16 a[4:7], v[32:35], v[4:7], a[4:7]
ds_read_b64_tr_b16 v[48:49], v128 offset:16384
v_lshrrev_b32 v253, 3, v250
v_add_lshl_u32 v253, s24, v253, 9
v_mfma_f32_16x16x32_bf16 a[8:11], v[32:35], v[8:11], a[8:11]
ds_read_b64_tr_b16 v[50:51], v128 offset:24576
v_and_b32 v254, 3, v250
v_lshl_add_u32 v253, v254, s34, v253
v_mfma_f32_16x16x32_bf16 a[12:15], v[32:35], v[12:15], a[12:15]
ds_read_b64_tr_b16 v[52:53], v129 offset:16384
buffer_load_dwordx4 v141, s[4:7], s16 offen offset:0 sc1 lds
v_bfe_u32 v254, v250, 2, 1
v_add_u32 v254, s25, v254
v_mfma_f32_16x16x32_bf16 a[16:19], v[32:35], v[16:19], a[16:19]
ds_read_b64_tr_b16 v[54:55], v129 offset:24576
v_lshl_add_u32 v248, v254, s35, v253
s_lshl_b32 s0, 4, s54
v_mfma_f32_16x16x32_bf16 a[20:23], v[32:35], v[20:23], a[20:23]
ds_read_b64_tr_b16 v[56:57], v130 offset:16384
v_readfirstlane_b32 s28, v249
s_nop 1
v_cmp_ge_u32 vcc, s28, v229
v_mfma_f32_16x16x32_bf16 a[24:27], v[32:35], v[24:27], a[24:27]
ds_read_b64_tr_b16 v[58:59], v130 offset:24576
buffer_load_dwordx4 v142, s[4:7], s16 offen offset:1024 sc1 lds
s_nop 1
s_bcnt1_i32_b64 s32, vcc
v_mfma_f32_16x16x32_bf16 a[28:31], v[32:35], v[28:31], a[28:31]
ds_read_b64_tr_b16 v[60:61], v131 offset:16384
s_sub_u32 s32, s32, 1
v_readlane_b32 s36, v230, s32
v_mfma_f32_16x16x32_bf16 a[32:35], v[36:39], v[0:3], a[32:35]
ds_read_b64_tr_b16 v[62:63], v131 offset:24576
s_nop 1
s_and_b32 s32, s36, 0x7ff
v_mfma_f32_16x16x32_bf16 a[36:39], v[36:39], v[4:7], a[36:39]
ds_read_b64_tr_b16 v[64:65], v132 offset:16384
s_add_u32 s16, s16, 1024
s_sub_u32 s28, s28, s32
s_bfe_u32 s32, s36, 0x3001a
v_mfma_f32_16x16x32_bf16 a[40:43], v[36:39], v[8:11], a[40:43]
ds_read_b64_tr_b16 v[66:67], v132 offset:24576
s_lshr_b32 s25, s28, s32
s_lshl_b32 s33, s25, s32
s_sub_u32 s24, s28, s33
v_mfma_f32_16x16x32_bf16 a[44:47], v[36:39], v[12:15], a[44:47]
ds_read_b64_tr_b16 v[68:69], v133 offset:16384
s_bfe_u32 s34, s36, 0x1001d
s_lshl_b32 s24, s24, s34
v_mfma_f32_16x16x32_bf16 a[48:51], v[36:39], v[16:19], a[48:51]
ds_read_b64_tr_b16 v[70:71], v133 offset:24576
s_add_u32 m0, s19, 0
s_nop 0
s_bfe_u32 s35, s36, 0x1001e
s_lshl_b32 s25, s25, s35
v_mfma_f32_16x16x32_bf16 a[52:55], v[36:39], v[20:23], a[52:55]
ds_read_b64_tr_b16 v[72:73], v134 offset:16384
s_bfe_u32 s32, s36, 0x40011
s_add_u32 s24, s24, s32
v_mfma_f32_16x16x32_bf16 a[56:59], v[36:39], v[24:27], a[56:59]
ds_read_b64_tr_b16 v[74:75], v134 offset:24576
s_bfe_u32 s32, s36, 0x50015
s_add_u32 s25, s25, s32
v_mfma_f32_16x16x32_bf16 a[60:63], v[36:39], v[28:31], a[60:63]
ds_read_b64_tr_b16 v[76:77], v135 offset:16384
buffer_load_dwordx4 v137, s[8:11], s15 offen offset:0 lds
s_bfe_u32 s23, s36, 0x4000b
s_bfe_u32 s36, s36, 0x6000b
s_lshl_b32 s32, s24, 8
v_mfma_f32_16x16x32_bf16 a[64:67], v[40:43], v[0:3], a[64:67]
ds_read_b64_tr_b16 v[78:79], v135 offset:24576
s_or_b32 s36, s36, s32
s_lshl_b32 s32, s25, 16
v_mfma_f32_16x16x32_bf16 a[68:71], v[40:43], v[4:7], a[68:71]
ds_read_b128 v[84:87], v136 offset:9216
s_or_b32 s36, s36, s32
s_cmp_eq_u32 s23, 4
s_cselect_b32 s32, 1, 0
v_mfma_f32_16x16x32_bf16 a[72:75], v[40:43], v[8:11], a[72:75]
ds_read_b128 v[88:91], v136 offset:10240
buffer_load_dwordx4 v138, s[8:11], s15 offen offset:1024 lds
s_sub_u32 s48, s24, s32
s_max_i32 s48, s48, 0
v_mfma_f32_16x16x32_bf16 a[76:79], v[40:43], v[12:15], a[76:79]
ds_read_b128 v[92:95], v136 offset:11264
s_add_u32 s49, s24, s34
s_add_u32 s49, s49, s32
v_mfma_f32_16x16x32_bf16 a[80:83], v[40:43], v[16:19], a[80:83]
s_min_u32 s49, s49, 15
s_cmp_eq_u32 s23, 6
s_cselect_b32 s51, 3, 7
s_cmp_eq_u32 s23, 7
s_cselect_b32 s51, 27, s51
s_cselect_b32 s50, 5, 4
v_mfma_f32_16x16x32_bf16 a[84:87], v[40:43], v[20:23], a[84:87]
buffer_load_dwordx4 v139, s[8:11], s15 offen offset:2048 lds
s_add_u32 s33, s25, s35
s_lshl_b32 s34, s24, 9
v_mfma_f32_16x16x32_bf16 a[88:91], v[40:43], v[24:27], a[88:91]
s_cmp_eq_u32 s23, 8
s_cselect_b32 s51, 0, s51
s_cselect_b32 s48, s25, s48
s_cselect_b32 s49, s33, s49
s_cmp_eq_u32 s23, 8
s_cselect_b32 s63, 2, 9
s_cselect_b32 s61, 0, 0x7f000000
s_cselect_b32 s34, s34, 0
v_mfma_f32_16x16x32_bf16 a[92:95], v[40:43], v[28:31], a[92:95]
v_lshrrev_b32 v228, s50, v250
v_lshlrev_b32 v254, s50, v228
v_mfma_f32_16x16x32_bf16 a[96:99], v[44:47], v[0:3], a[96:99]
buffer_load_dwordx4 v140, s[8:11], s15 offen offset:3072 lds
v_sub_u32 v254, v250, v254
s_cmp_lt_u32 s23, 4
s_cselect_b32 s39, 10, s23
v_mfma_f32_16x16x32_bf16 a[100:103], v[44:47], v[4:7], a[100:103]
v_min_u32 v254, s51, v254
s_lshl_b32 s39, s39, 13
s_cmp_eq_u32 s23, 3
s_cselect_b32 s34, 4, s34
v_mfma_f32_16x16x32_bf16 a[104:107], v[44:47], v[8:11], a[104:107]
v_add_u32 v228, s48, v228
s_add_u32 s39, s39, s34
v_mfma_f32_16x16x32_bf16 a[108:111], v[44:47], v[12:15], a[108:111]
s_add_u32 s15, s15, s17
s_add_u32 s39, s39, 0x8402000
v_min_u32 v228, s49, v228
v_mfma_f32_16x16x32_bf16 a[112:115], v[44:47], v[16:19], a[112:115]
s_lshl_b32 s60, s24, 10
s_add_u32 s60, s60, 0x8400000
v_mfma_f32_16x16x32_bf16 a[116:119], v[44:47], v[20:23], a[116:119]
v_lshlrev_b32 v228, s63, v228
v_lshl_add_u32 v228, v254, 4, v228
v_mfma_f32_16x16x32_bf16 a[120:123], v[44:47], v[24:27], a[120:123]
v_or_b32 v146, s61, v251
s_mov_b64 exec, s[100:101]
buffer_load_dword v231, v228, s[4:7], s39 offen sc1
buffer_load_dwordx4 v[232:235], v146, s[4:7], s60 offen sc1
s_mov_b64 exec, -1
v_mfma_f32_16x16x32_bf16 a[124:127], v[44:47], v[28:31], a[124:127]
s_waitcnt lgkmcnt(0)
v_mfma_f32_16x16x32_bf16 a[0:3], v[80:83], v[48:51], a[0:3]
s_waitcnt vmcnt(12)
s_barrier
ds_read_b128 v[32:35], v136 offset:16384
s_add_u32 m0, s20, 8192
s_nop 0
s_mov_b32 s1, s21
v_mfma_f32_16x16x32_bf16 a[4:7], v[80:83], v[52:55], a[4:7]
ds_read_b64_tr_b16 v[0:1], v128 offset:32768
v_mfma_f32_16x16x32_bf16 a[8:11], v[80:83], v[56:59], a[8:11]
ds_read_b64_tr_b16 v[2:3], v128 offset:40960
v_mfma_f32_16x16x32_bf16 a[12:15], v[80:83], v[60:63], a[12:15]
ds_read_b64_tr_b16 v[4:5], v129 offset:32768
buffer_load_dwordx4 v141, s[4:7], s16 offen offset:0 sc1 lds
v_mfma_f32_16x16x32_bf16 a[16:19], v[80:83], v[64:67], a[16:19]
ds_read_b64_tr_b16 v[6:7], v129 offset:40960
v_mfma_f32_16x16x32_bf16 a[20:23], v[80:83], v[68:71], a[20:23]
ds_read_b64_tr_b16 v[8:9], v130 offset:32768
s_mov_b32 s2, s22
v_mfma_f32_16x16x32_bf16 a[24:27], v[80:83], v[72:75], a[24:27]
ds_read_b64_tr_b16 v[10:11], v130 offset:40960
buffer_load_dwordx4 v142, s[4:7], s16 offen offset:1024 sc1 lds
v_mfma_f32_16x16x32_bf16 a[28:31], v[80:83], v[76:79], a[28:31]
ds_read_b64_tr_b16 v[12:13], v131 offset:32768
v_mfma_f32_16x16x32_bf16 a[32:35], v[84:87], v[48:51], a[32:35]
ds_read_b64_tr_b16 v[14:15], v131 offset:40960
v_mfma_f32_16x16x32_bf16 a[36:39], v[84:87], v[52:55], a[36:39]
ds_read_b64_tr_b16 v[16:17], v132 offset:32768
s_add_u32 s16, s16, 1024
v_mfma_f32_16x16x32_bf16 a[40:43], v[84:87], v[56:59], a[40:43]
ds_read_b64_tr_b16 v[18:19], v132 offset:40960
s_mov_b32 s3, s26
v_mfma_f32_16x16x32_bf16 a[44:47], v[84:87], v[60:63], a[44:47]
ds_read_b64_tr_b16 v[20:21], v133 offset:32768
v_mfma_f32_16x16x32_bf16 a[48:51], v[84:87], v[64:67], a[48:51]
ds_read_b64_tr_b16 v[22:23], v133 offset:40960
s_add_u32 m0, s19, 16384
s_nop 0
v_mfma_f32_16x16x32_bf16 a[52:55], v[84:87], v[68:71], a[52:55]
ds_read_b64_tr_b16 v[24:25], v134 offset:32768
v_mfma_f32_16x16x32_bf16 a[56:59], v[84:87], v[72:75], a[56:59]
ds_read_b64_tr_b16 v[26:27], v134 offset:40960
v_mfma_f32_16x16x32_bf16 a[60:63], v[84:87], v[76:79], a[60:63]
ds_read_b64_tr_b16 v[28:29], v135 offset:32768
buffer_load_dwordx4 v137, s[8:11], s15 offen offset:0 lds
s_mov_b32 s56, s57
v_mfma_f32_16x16x32_bf16 a[64:67], v[88:91], v[48:51], a[64:67]
ds_read_b64_tr_b16 v[30:31], v135 offset:40960
v_mfma_f32_16x16x32_bf16 a[68:71], v[88:91], v[52:55], a[68:71]
ds_read_b128 v[36:39], v136 offset:17408
v_mfma_f32_16x16x32_bf16 a[72:75], v[88:91], v[56:59], a[72:75]
ds_read_b128 v[40:43], v136 offset:18432
buffer_load_dwordx4 v138, s[8:11], s15 offen offset:1024 lds
v_mfma_f32_16x16x32_bf16 a[76:79], v[88:91], v[60:63], a[76:79]
ds_read_b128 v[44:47], v136 offset:19456
v_mfma_f32_16x16x32_bf16 a[80:83], v[88:91], v[64:67], a[80:83]
v_mov_b32 v145, v252
v_mfma_f32_16x16x32_bf16 a[84:87], v[88:91], v[68:71], a[84:87]
buffer_load_dwordx4 v139, s[8:11], s15 offen offset:2048 lds
v_mfma_f32_16x16x32_bf16 a[88:91], v[88:91], v[72:75], a[88:91]
v_mfma_f32_16x16x32_bf16 a[92:95], v[88:91], v[76:79], a[92:95]
v_mfma_f32_16x16x32_bf16 a[96:99], v[92:95], v[48:51], a[96:99]
buffer_load_dwordx4 v140, s[8:11], s15 offen offset:3072 lds
v_mfma_f32_16x16x32_bf16 a[100:103], v[92:95], v[52:55], a[100:103]
v_mov_b32 v255, 131072
v_mfma_f32_16x16x32_bf16 a[104:107], v[92:95], v[56:59], a[104:107]
v_mfma_f32_16x16x32_bf16 a[108:111], v[92:95], v[60:63], a[108:111]
s_add_u32 s15, s15, s17
v_mfma_f32_16x16x32_bf16 a[112:115], v[92:95], v[64:67], a[112:115]
v_mfma_f32_16x16x32_bf16 a[116:119], v[92:95], v[68:71], a[116:119]
v_mfma_f32_16x16x32_bf16 a[120:123], v[92:95], v[72:75], a[120:123]
v_mfma_f32_16x16x32_bf16 a[124:127], v[92:95], v[76:79], a[124:127]
s_waitcnt lgkmcnt(0)
v_mfma_f32_16x16x32_bf16 a[0:3], v[32:35], v[0:3], a[0:3]
s_waitcnt vmcnt(12)
s_barrier
ds_read_b128 v[80:83], v136 offset:24576
s_add_u32 m0, s20, 16384
s_nop 0
v_mfma_f32_16x16x32_bf16 a[4:7], v[32:35], v[4:7], a[4:7]
ds_read_b64_tr_b16 v[48:49], v128 offset:49152
v_mfma_f32_16x16x32_bf16 a[8:11], v[32:35], v[8:11], a[8:11]
ds_read_b64_tr_b16 v[50:51], v128 offset:57344
v_mfma_f32_16x16x32_bf16 a[12:15], v[32:35], v[12:15], a[12:15]
ds_read_b64_tr_b16 v[52:53], v129 offset:49152
buffer_load_dwordx4 v141, s[4:7], s16 offen offset:0 sc1 lds
v_mfma_f32_16x16x32_bf16 a[16:19], v[32:35], v[16:19], a[16:19]
ds_read_b64_tr_b16 v[54:55], v129 offset:57344
v_mfma_f32_16x16x32_bf16 a[20:23], v[32:35], v[20:23], a[20:23]
ds_read_b64_tr_b16 v[56:57], v130 offset:49152
v_mfma_f32_16x16x32_bf16 a[24:27], v[32:35], v[24:27], a[24:27]
ds_read_b64_tr_b16 v[58:59], v130 offset:57344
buffer_load_dwordx4 v142, s[4:7], s16 offen offset:1024 sc1 lds
v_mfma_f32_16x16x32_bf16 a[28:31], v[32:35], v[28:31], a[28:31]
ds_read_b64_tr_b16 v[60:61], v131 offset:49152
v_mfma_f32_16x16x32_bf16 a[32:35], v[36:39], v[0:3], a[32:35]
ds_read_b64_tr_b16 v[62:63], v131 offset:57344
v_mfma_f32_16x16x32_bf16 a[36:39], v[36:39], v[4:7], a[36:39]
ds_read_b64_tr_b16 v[64:65], v132 offset:49152
s_add_u32 s16, s16, 1024
v_mfma_f32_16x16x32_bf16 a[40:43], v[36:39], v[8:11], a[40:43]
ds_read_b64_tr_b16 v[66:67], v132 offset:57344
v_mfma_f32_16x16x32_bf16 a[44:47], v[36:39], v[12:15], a[44:47]
ds_read_b64_tr_b16 v[68:69], v133 offset:49152
v_mfma_f32_16x16x32_bf16 a[48:51], v[36:39], v[16:19], a[48:51]
ds_read_b64_tr_b16 v[70:71], v133 offset:57344
s_add_u32 m0, s19, 32768
s_nop 0
v_mfma_f32_16x16x32_bf16 a[52:55], v[36:39], v[20:23], a[52:55]
ds_read_b64_tr_b16 v[72:73], v134 offset:49152
v_mfma_f32_16x16x32_bf16 a[56:59], v[36:39], v[24:27], a[56:59]
ds_read_b64_tr_b16 v[74:75], v134 offset:57344
v_mfma_f32_16x16x32_bf16 a[60:63], v[36:39], v[28:31], a[60:63]
ds_read_b64_tr_b16 v[76:77], v135 offset:49152
buffer_load_dwordx4 v137, s[8:11], s15 offen offset:0 lds
v_mfma_f32_16x16x32_bf16 a[64:67], v[40:43], v[0:3], a[64:67]
ds_read_b64_tr_b16 v[78:79], v135 offset:57344
v_mfma_f32_16x16x32_bf16 a[68:71], v[40:43], v[4:7], a[68:71]
ds_read_b128 v[84:87], v136 offset:25600
v_mfma_f32_16x16x32_bf16 a[72:75], v[40:43], v[8:11], a[72:75]
ds_read_b128 v[88:91], v136 offset:26624
buffer_load_dwordx4 v138, s[8:11], s15 offen offset:1024 lds
v_mfma_f32_16x16x32_bf16 a[76:79], v[40:43], v[12:15], a[76:79]
ds_read_b128 v[92:95], v136 offset:27648
v_mfma_f32_16x16x32_bf16 a[80:83], v[40:43], v[16:19], a[80:83]
s_waitcnt vmcnt(10)
v_mfma_f32_16x16x32_bf16 a[84:87], v[40:43], v[20:23], a[84:87]
buffer_load_dwordx4 v139, s[8:11], s15 offen offset:2048 lds
v_min3_u32 v253, v232, v233, v234
v_mfma_f32_16x16x32_bf16 a[88:91], v[40:43], v[24:27], a[88:91]
v_min_u32 v253, v253, v235
v_mfma_f32_16x16x32_bf16 a[92:95], v[40:43], v[28:31], a[92:95]
v_or_b32 v253, s61, v253
v_mfma_f32_16x16x32_bf16 a[96:99], v[44:47], v[0:3], a[96:99]
buffer_load_dwordx4 v140, s[8:11], s15 offen offset:3072 lds
v_min_u32 v253, v253, v231
v_mfma_f32_16x16x32_bf16 a[100:103], v[44:47], v[4:7], a[100:103]
v_cmp_eq_u32 vcc, 0, v253
v_mfma_f32_16x16x32_bf16 a[104:107], v[44:47], v[8:11], a[104:107]
s_nop 1
v_mfma_f32_16x16x32_bf16 a[108:111], v[44:47], v[12:15], a[108:111]
s_add_u32 s15, s15, s17
s_cmp_eq_u64 vcc, 0
s_cselect_b32 s32, s36, -4
v_mfma_f32_16x16x32_bf16 a[112:115], v[44:47], v[16:19], a[112:115]
s_bitcmp1_b32 0x1df, s23
s_cselect_b32 s32, s32, -4
v_mfma_f32_16x16x32_bf16 a[116:119], v[44:47], v[20:23], a[116:119]
v_mov_b32 v254, s32
v_mfma_f32_16x16x32_bf16 a[120:123], v[44:47], v[24:27], a[120:123]
s_mov_b64 exec, s[100:101]
ds_write_b32 v255, v254
s_mov_b64 exec, -1
v_mfma_f32_16x16x32_bf16 a[124:127], v[44:47], v[28:31], a[124:127]
s_waitcnt lgkmcnt(0)
v_mfma_f32_16x16x32_bf16 a[0:3], v[80:83], v[48:51], a[0:3]
s_waitcnt vmcnt(12)
s_barrier
ds_read_b128 v[32:35], v136 offset:0
s_add_u32 m0, s20, 24576
s_nop 0
ds_read_b32 v254, v255
v_mfma_f32_16x16x32_bf16 a[4:7], v[80:83], v[52:55], a[4:7]
ds_read_b64_tr_b16 v[0:1], v128 offset:0
v_mfma_f32_16x16x32_bf16 a[8:11], v[80:83], v[56:59], a[8:11]
ds_read_b64_tr_b16 v[2:3], v128 offset:8192
v_mfma_f32_16x16x32_bf16 a[12:15], v[80:83], v[60:63], a[12:15]
ds_read_b64_tr_b16 v[4:5], v129 offset:0
buffer_load_dwordx4 v141, s[4:7], s16 offen offset:0 sc1 lds
v_mfma_f32_16x16x32_bf16 a[16:19], v[80:83], v[64:67], a[16:19]
ds_read_b64_tr_b16 v[6:7], v129 offset:8192
v_mfma_f32_16x16x32_bf16 a[20:23], v[80:83], v[68:71], a[20:23]
ds_read_b64_tr_b16 v[8:9], v130 offset:0
v_mfma_f32_16x16x32_bf16 a[24:27], v[80:83], v[72:75], a[24:27]
ds_read_b64_tr_b16 v[10:11], v130 offset:8192
buffer_load_dwordx4 v142, s[4:7], s16 offen offset:1024 sc1 lds
v_mfma_f32_16x16x32_bf16 a[28:31], v[80:83], v[76:79], a[28:31]
ds_read_b64_tr_b16 v[12:13], v131 offset:0
v_mfma_f32_16x16x32_bf16 a[32:35], v[84:87], v[48:51], a[32:35]
ds_read_b64_tr_b16 v[14:15], v131 offset:8192
v_mfma_f32_16x16x32_bf16 a[36:39], v[84:87], v[52:55], a[36:39]
ds_read_b64_tr_b16 v[16:17], v132 offset:0
s_add_u32 s16, s16, 1024
v_mfma_f32_16x16x32_bf16 a[40:43], v[84:87], v[56:59], a[40:43]
ds_read_b64_tr_b16 v[18:19], v132 offset:8192
v_mfma_f32_16x16x32_bf16 a[44:47], v[84:87], v[60:63], a[44:47]
ds_read_b64_tr_b16 v[20:21], v133 offset:0
v_mfma_f32_16x16x32_bf16 a[48:51], v[84:87], v[64:67], a[48:51]
ds_read_b64_tr_b16 v[22:23], v133 offset:8192
s_add_u32 m0, s19, 49152
s_nop 0
v_mfma_f32_16x16x32_bf16 a[52:55], v[84:87], v[68:71], a[52:55]
ds_read_b64_tr_b16 v[24:25], v134 offset:0
v_mfma_f32_16x16x32_bf16 a[56:59], v[84:87], v[72:75], a[56:59]
ds_read_b64_tr_b16 v[26:27], v134 offset:8192
v_mfma_f32_16x16x32_bf16 a[60:63], v[84:87], v[76:79], a[60:63]
ds_read_b64_tr_b16 v[28:29], v135 offset:0
buffer_load_dwordx4 v137, s[8:11], s15 offen offset:0 lds
v_mfma_f32_16x16x32_bf16 a[64:67], v[88:91], v[48:51], a[64:67]
ds_read_b64_tr_b16 v[30:31], v135 offset:8192
v_mfma_f32_16x16x32_bf16 a[68:71], v[88:91], v[52:55], a[68:71]
ds_read_b128 v[36:39], v136 offset:1024
v_mfma_f32_16x16x32_bf16 a[72:75], v[88:91], v[56:59], a[72:75]
ds_read_b128 v[40:43], v136 offset:2048
buffer_load_dwordx4 v138, s[8:11], s15 offen offset:1024 lds
v_mfma_f32_16x16x32_bf16 a[76:79], v[88:91], v[60:63], a[76:79]
ds_read_b128 v[44:47], v136 offset:3072
v_mfma_f32_16x16x32_bf16 a[80:83], v[88:91], v[64:67], a[80:83]
s_waitcnt lgkmcnt(8)
v_mfma_f32_16x16x32_bf16 a[84:87], v[88:91], v[68:71], a[84:87]
buffer_load_dwordx4 v139, s[8:11], s15 offen offset:2048 lds
v_readfirstlane_b32 s62, v254
v_mfma_f32_16x16x32_bf16 a[88:91], v[88:91], v[72:75], a[88:91]
v_mfma_f32_16x16x32_bf16 a[92:95], v[88:91], v[76:79], a[92:95]
s_nop 1
v_mfma_f32_16x16x32_bf16 a[96:99], v[92:95], v[48:51], a[96:99]
buffer_load_dwordx4 v140, s[8:11], s15 offen offset:3072 lds
s_and_b32 s23, s62, 15
v_mfma_f32_16x16x32_bf16 a[100:103], v[92:95], v[52:55], a[100:103]
v_mfma_f32_16x16x32_bf16 a[104:107], v[92:95], v[56:59], a[104:107]
s_bfe_u32 s54, s62, 0x20004
v_mfma_f32_16x16x32_bf16 a[108:111], v[92:95], v[60:63], a[108:111]
s_add_u32 s15, s15, s17
s_bfe_u32 s24, s62, 0x80008
v_mfma_f32_16x16x32_bf16 a[112:115], v[92:95], v[64:67], a[112:115]
v_mfma_f32_16x16x32_bf16 a[116:119], v[92:95], v[68:71], a[116:119]
s_lshr_b32 s25, s62, 16
v_mfma_f32_16x16x32_bf16 a[120:123], v[92:95], v[72:75], a[120:123]
v_mfma_f32_16x16x32_bf16 a[124:127], v[92:95], v[76:79], a[124:127]
s_cmp_eq_u32 s54, 1
s_cselect_b32 s73, 3, -1
s_cbranch_scc1 main_kernel_w_c1_task
s_waitcnt lgkmcnt(0)
v_mfma_f32_16x16x32_bf16 a[0:3], v[32:35], v[0:3], a[0:3]
s_waitcnt vmcnt(12)
s_barrier
ds_read_b128 v[80:83], v136 offset:8192
v_mfma_f32_16x16x32_bf16 a[4:7], v[32:35], v[4:7], a[4:7]
ds_read_b64_tr_b16 v[48:49], v128 offset:16384
v_mfma_f32_16x16x32_bf16 a[8:11], v[32:35], v[8:11], a[8:11]
ds_read_b64_tr_b16 v[50:51], v128 offset:24576
v_mfma_f32_16x16x32_bf16 a[12:15], v[32:35], v[12:15], a[12:15]
ds_read_b64_tr_b16 v[52:53], v129 offset:16384
v_mfma_f32_16x16x32_bf16 a[16:19], v[32:35], v[16:19], a[16:19]
ds_read_b64_tr_b16 v[54:55], v129 offset:24576
v_mfma_f32_16x16x32_bf16 a[20:23], v[32:35], v[20:23], a[20:23]
ds_read_b64_tr_b16 v[56:57], v130 offset:16384
v_mfma_f32_16x16x32_bf16 a[24:27], v[32:35], v[24:27], a[24:27]
ds_read_b64_tr_b16 v[58:59], v130 offset:24576
v_mfma_f32_16x16x32_bf16 a[28:31], v[32:35], v[28:31], a[28:31]
ds_read_b64_tr_b16 v[60:61], v131 offset:16384
v_mfma_f32_16x16x32_bf16 a[32:35], v[36:39], v[0:3], a[32:35]
ds_read_b64_tr_b16 v[62:63], v131 offset:24576
v_mfma_f32_16x16x32_bf16 a[36:39], v[36:39], v[4:7], a[36:39]
ds_read_b64_tr_b16 v[64:65], v132 offset:16384
v_mfma_f32_16x16x32_bf16 a[40:43], v[36:39], v[8:11], a[40:43]
ds_read_b64_tr_b16 v[66:67], v132 offset:24576
v_mfma_f32_16x16x32_bf16 a[44:47], v[36:39], v[12:15], a[44:47]
ds_read_b64_tr_b16 v[68:69], v133 offset:16384
v_mfma_f32_16x16x32_bf16 a[48:51], v[36:39], v[16:19], a[48:51]
ds_read_b64_tr_b16 v[70:71], v133 offset:24576
v_mfma_f32_16x16x32_bf16 a[52:55], v[36:39], v[20:23], a[52:55]
ds_read_b64_tr_b16 v[72:73], v134 offset:16384
v_mfma_f32_16x16x32_bf16 a[56:59], v[36:39], v[24:27], a[56:59]
ds_read_b64_tr_b16 v[74:75], v134 offset:24576
v_mfma_f32_16x16x32_bf16 a[60:63], v[36:39], v[28:31], a[60:63]
ds_read_b64_tr_b16 v[76:77], v135 offset:16384
v_mfma_f32_16x16x32_bf16 a[64:67], v[40:43], v[0:3], a[64:67]
ds_read_b64_tr_b16 v[78:79], v135 offset:24576
v_mfma_f32_16x16x32_bf16 a[68:71], v[40:43], v[4:7], a[68:71]
ds_read_b128 v[84:87], v136 offset:9216
v_mfma_f32_16x16x32_bf16 a[72:75], v[40:43], v[8:11], a[72:75]
ds_read_b128 v[88:91], v136 offset:10240
v_mfma_f32_16x16x32_bf16 a[76:79], v[40:43], v[12:15], a[76:79]
ds_read_b128 v[92:95], v136 offset:11264
v_mfma_f32_16x16x32_bf16 a[80:83], v[40:43], v[16:19], a[80:83]
v_mfma_f32_16x16x32_bf16 a[84:87], v[40:43], v[20:23], a[84:87]
v_mfma_f32_16x16x32_bf16 a[88:91], v[40:43], v[24:27], a[88:91]
v_mfma_f32_16x16x32_bf16 a[92:95], v[40:43], v[28:31], a[92:95]
v_mfma_f32_16x16x32_bf16 a[96:99], v[44:47], v[0:3], a[96:99]
v_mfma_f32_16x16x32_bf16 a[100:103], v[44:47], v[4:7], a[100:103]
v_mfma_f32_16x16x32_bf16 a[104:107], v[44:47], v[8:11], a[104:107]
v_mfma_f32_16x16x32_bf16 a[108:111], v[44:47], v[12:15], a[108:111]
v_mfma_f32_16x16x32_bf16 a[112:115], v[44:47], v[16:19], a[112:115]
v_mfma_f32_16x16x32_bf16 a[116:119], v[44:47], v[20:23], a[116:119]
v_mfma_f32_16x16x32_bf16 a[120:123], v[44:47], v[24:27], a[120:123]
v_mfma_f32_16x16x32_bf16 a[124:127], v[44:47], v[28:31], a[124:127]
s_waitcnt lgkmcnt(0)
v_mfma_f32_16x16x32_bf16 a[0:3], v[80:83], v[48:51], a[0:3]
s_waitcnt vmcnt(6)
s_barrier
ds_read_b128 v[32:35], v136 offset:16384
v_mfma_f32_16x16x32_bf16 a[4:7], v[80:83], v[52:55], a[4:7]
ds_read_b64_tr_b16 v[0:1], v128 offset:32768
v_mfma_f32_16x16x32_bf16 a[8:11], v[80:83], v[56:59], a[8:11]
ds_read_b64_tr_b16 v[2:3], v128 offset:40960
v_mfma_f32_16x16x32_bf16 a[12:15], v[80:83], v[60:63], a[12:15]
ds_read_b64_tr_b16 v[4:5], v129 offset:32768
v_mfma_f32_16x16x32_bf16 a[16:19], v[80:83], v[64:67], a[16:19]
ds_read_b64_tr_b16 v[6:7], v129 offset:40960
v_mfma_f32_16x16x32_bf16 a[20:23], v[80:83], v[68:71], a[20:23]
ds_read_b64_tr_b16 v[8:9], v130 offset:32768
v_mfma_f32_16x16x32_bf16 a[24:27], v[80:83], v[72:75], a[24:27]
ds_read_b64_tr_b16 v[10:11], v130 offset:40960
v_mfma_f32_16x16x32_bf16 a[28:31], v[80:83], v[76:79], a[28:31]
ds_read_b64_tr_b16 v[12:13], v131 offset:32768
v_mfma_f32_16x16x32_bf16 a[32:35], v[84:87], v[48:51], a[32:35]
ds_read_b64_tr_b16 v[14:15], v131 offset:40960
v_mfma_f32_16x16x32_bf16 a[36:39], v[84:87], v[52:55], a[36:39]
ds_read_b64_tr_b16 v[16:17], v132 offset:32768
v_mfma_f32_16x16x32_bf16 a[40:43], v[84:87], v[56:59], a[40:43]
ds_read_b64_tr_b16 v[18:19], v132 offset:40960
v_mfma_f32_16x16x32_bf16 a[44:47], v[84:87], v[60:63], a[44:47]
ds_read_b64_tr_b16 v[20:21], v133 offset:32768
v_mfma_f32_16x16x32_bf16 a[48:51], v[84:87], v[64:67], a[48:51]
ds_read_b64_tr_b16 v[22:23], v133 offset:40960
v_mfma_f32_16x16x32_bf16 a[52:55], v[84:87], v[68:71], a[52:55]
ds_read_b64_tr_b16 v[24:25], v134 offset:32768
v_mfma_f32_16x16x32_bf16 a[56:59], v[84:87], v[72:75], a[56:59]
ds_read_b64_tr_b16 v[26:27], v134 offset:40960
v_mfma_f32_16x16x32_bf16 a[60:63], v[84:87], v[76:79], a[60:63]
ds_read_b64_tr_b16 v[28:29], v135 offset:32768
v_mfma_f32_16x16x32_bf16 a[64:67], v[88:91], v[48:51], a[64:67]
ds_read_b64_tr_b16 v[30:31], v135 offset:40960
v_mfma_f32_16x16x32_bf16 a[68:71], v[88:91], v[52:55], a[68:71]
ds_read_b128 v[36:39], v136 offset:17408
v_mfma_f32_16x16x32_bf16 a[72:75], v[88:91], v[56:59], a[72:75]
ds_read_b128 v[40:43], v136 offset:18432
v_mfma_f32_16x16x32_bf16 a[76:79], v[88:91], v[60:63], a[76:79]
ds_read_b128 v[44:47], v136 offset:19456
v_mfma_f32_16x16x32_bf16 a[80:83], v[88:91], v[64:67], a[80:83]
v_mfma_f32_16x16x32_bf16 a[84:87], v[88:91], v[68:71], a[84:87]
v_mfma_f32_16x16x32_bf16 a[88:91], v[88:91], v[72:75], a[88:91]
v_mfma_f32_16x16x32_bf16 a[92:95], v[88:91], v[76:79], a[92:95]
v_mfma_f32_16x16x32_bf16 a[96:99], v[92:95], v[48:51], a[96:99]
v_mfma_f32_16x16x32_bf16 a[100:103], v[92:95], v[52:55], a[100:103]
v_mfma_f32_16x16x32_bf16 a[104:107], v[92:95], v[56:59], a[104:107]
v_mfma_f32_16x16x32_bf16 a[108:111], v[92:95], v[60:63], a[108:111]
v_mfma_f32_16x16x32_bf16 a[112:115], v[92:95], v[64:67], a[112:115]
v_mfma_f32_16x16x32_bf16 a[116:119], v[92:95], v[68:71], a[116:119]
v_mfma_f32_16x16x32_bf16 a[120:123], v[92:95], v[72:75], a[120:123]
v_mfma_f32_16x16x32_bf16 a[124:127], v[92:95], v[76:79], a[124:127]
s_waitcnt lgkmcnt(0)
v_mfma_f32_16x16x32_bf16 a[0:3], v[32:35], v[0:3], a[0:3]
s_waitcnt vmcnt(0)
s_barrier
ds_read_b128 v[80:83], v136 offset:24576
v_mfma_f32_16x16x32_bf16 a[4:7], v[32:35], v[4:7], a[4:7]
ds_read_b64_tr_b16 v[48:49], v128 offset:49152
v_mfma_f32_16x16x32_bf16 a[8:11], v[32:35], v[8:11], a[8:11]
ds_read_b64_tr_b16 v[50:51], v128 offset:57344
v_mfma_f32_16x16x32_bf16 a[12:15], v[32:35], v[12:15], a[12:15]
ds_read_b64_tr_b16 v[52:53], v129 offset:49152
v_mfma_f32_16x16x32_bf16 a[16:19], v[32:35], v[16:19], a[16:19]
ds_read_b64_tr_b16 v[54:55], v129 offset:57344
v_mfma_f32_16x16x32_bf16 a[20:23], v[32:35], v[20:23], a[20:23]
ds_read_b64_tr_b16 v[56:57], v130 offset:49152
v_mfma_f32_16x16x32_bf16 a[24:27], v[32:35], v[24:27], a[24:27]
ds_read_b64_tr_b16 v[58:59], v130 offset:57344
v_mfma_f32_16x16x32_bf16 a[28:31], v[32:35], v[28:31], a[28:31]
ds_read_b64_tr_b16 v[60:61], v131 offset:49152
v_mfma_f32_16x16x32_bf16 a[32:35], v[36:39], v[0:3], a[32:35]
ds_read_b64_tr_b16 v[62:63], v131 offset:57344
v_mfma_f32_16x16x32_bf16 a[36:39], v[36:39], v[4:7], a[36:39]
ds_read_b64_tr_b16 v[64:65], v132 offset:49152
v_mfma_f32_16x16x32_bf16 a[40:43], v[36:39], v[8:11], a[40:43]
ds_read_b64_tr_b16 v[66:67], v132 offset:57344
v_mfma_f32_16x16x32_bf16 a[44:47], v[36:39], v[12:15], a[44:47]
ds_read_b64_tr_b16 v[68:69], v133 offset:49152
v_mfma_f32_16x16x32_bf16 a[48:51], v[36:39], v[16:19], a[48:51]
ds_read_b64_tr_b16 v[70:71], v133 offset:57344
v_mfma_f32_16x16x32_bf16 a[52:55], v[36:39], v[20:23], a[52:55]
ds_read_b64_tr_b16 v[72:73], v134 offset:49152
v_mfma_f32_16x16x32_bf16 a[56:59], v[36:39], v[24:27], a[56:59]
ds_read_b64_tr_b16 v[74:75], v134 offset:57344
v_mfma_f32_16x16x32_bf16 a[60:63], v[36:39], v[28:31], a[60:63]
ds_read_b64_tr_b16 v[76:77], v135 offset:49152
v_mfma_f32_16x16x32_bf16 a[64:67], v[40:43], v[0:3], a[64:67]
ds_read_b64_tr_b16 v[78:79], v135 offset:57344
v_mfma_f32_16x16x32_bf16 a[68:71], v[40:43], v[4:7], a[68:71]
ds_read_b128 v[84:87], v136 offset:25600
v_mfma_f32_16x16x32_bf16 a[72:75], v[40:43], v[8:11], a[72:75]
ds_read_b128 v[88:91], v136 offset:26624
v_mfma_f32_16x16x32_bf16 a[76:79], v[40:43], v[12:15], a[76:79]
ds_read_b128 v[92:95], v136 offset:27648
v_mfma_f32_16x16x32_bf16 a[80:83], v[40:43], v[16:19], a[80:83]
v_mfma_f32_16x16x32_bf16 a[84:87], v[40:43], v[20:23], a[84:87]
v_mfma_f32_16x16x32_bf16 a[88:91], v[40:43], v[24:27], a[88:91]
v_mfma_f32_16x16x32_bf16 a[92:95], v[40:43], v[28:31], a[92:95]
v_mfma_f32_16x16x32_bf16 a[96:99], v[44:47], v[0:3], a[96:99]
v_mfma_f32_16x16x32_bf16 a[100:103], v[44:47], v[4:7], a[100:103]
v_mfma_f32_16x16x32_bf16 a[104:107], v[44:47], v[8:11], a[104:107]
v_mfma_f32_16x16x32_bf16 a[108:111], v[44:47], v[12:15], a[108:111]
v_mfma_f32_16x16x32_bf16 a[112:115], v[44:47], v[16:19], a[112:115]
v_mfma_f32_16x16x32_bf16 a[116:119], v[44:47], v[20:23], a[116:119]
v_mfma_f32_16x16x32_bf16 a[120:123], v[44:47], v[24:27], a[120:123]
v_mfma_f32_16x16x32_bf16 a[124:127], v[44:47], v[28:31], a[124:127]
s_waitcnt lgkmcnt(0)
v_mfma_f32_16x16x32_bf16 a[0:3], v[80:83], v[48:51], a[0:3]
s_barrier
v_mfma_f32_16x16x32_bf16 a[4:7], v[80:83], v[52:55], a[4:7]
v_mfma_f32_16x16x32_bf16 a[8:11], v[80:83], v[56:59], a[8:11]
v_mfma_f32_16x16x32_bf16 a[12:15], v[80:83], v[60:63], a[12:15]
v_mfma_f32_16x16x32_bf16 a[16:19], v[80:83], v[64:67], a[16:19]
v_mfma_f32_16x16x32_bf16 a[20:23], v[80:83], v[68:71], a[20:23]
v_mfma_f32_16x16x32_bf16 a[24:27], v[80:83], v[72:75], a[24:27]
v_mfma_f32_16x16x32_bf16 a[28:31], v[80:83], v[76:79], a[28:31]
v_mfma_f32_16x16x32_bf16 a[32:35], v[84:87], v[48:51], a[32:35]
v_mfma_f32_16x16x32_bf16 a[36:39], v[84:87], v[52:55], a[36:39]
v_mfma_f32_16x16x32_bf16 a[40:43], v[84:87], v[56:59], a[40:43]
v_mfma_f32_16x16x32_bf16 a[44:47], v[84:87], v[60:63], a[44:47]
v_mfma_f32_16x16x32_bf16 a[48:51], v[84:87], v[64:67], a[48:51]
v_mfma_f32_16x16x32_bf16 a[52:55], v[84:87], v[68:71], a[52:55]
v_mfma_f32_16x16x32_bf16 a[56:59], v[84:87], v[72:75], a[56:59]
v_mfma_f32_16x16x32_bf16 a[60:63], v[84:87], v[76:79], a[60:63]
v_mfma_f32_16x16x32_bf16 a[64:67], v[88:91], v[48:51], a[64:67]
v_mfma_f32_16x16x32_bf16 a[68:71], v[88:91], v[52:55], a[68:71]
v_mfma_f32_16x16x32_bf16 a[72:75], v[88:91], v[56:59], a[72:75]
v_mfma_f32_16x16x32_bf16 a[76:79], v[88:91], v[60:63], a[76:79]
v_mfma_f32_16x16x32_bf16 a[80:83], v[88:91], v[64:67], a[80:83]
v_mfma_f32_16x16x32_bf16 a[84:87], v[88:91], v[68:71], a[84:87]
v_mfma_f32_16x16x32_bf16 a[88:91], v[88:91], v[72:75], a[88:91]
v_mfma_f32_16x16x32_bf16 a[92:95], v[88:91], v[76:79], a[92:95]
v_mfma_f32_16x16x32_bf16 a[96:99], v[92:95], v[48:51], a[96:99]
v_mfma_f32_16x16x32_bf16 a[100:103], v[92:95], v[52:55], a[100:103]
v_mfma_f32_16x16x32_bf16 a[104:107], v[92:95], v[56:59], a[104:107]
v_mfma_f32_16x16x32_bf16 a[108:111], v[92:95], v[60:63], a[108:111]
v_mfma_f32_16x16x32_bf16 a[112:115], v[92:95], v[64:67], a[112:115]
v_mfma_f32_16x16x32_bf16 a[116:119], v[92:95], v[68:71], a[116:119]
v_mfma_f32_16x16x32_bf16 a[120:123], v[92:95], v[72:75], a[120:123]
v_mfma_f32_16x16x32_bf16 a[124:127], v[92:95], v[76:79], a[124:127]
s_cmp_lg_u32 s62, -4
s_cbranch_scc1 main_kernel_w_gemm
s_branch main_kernel_w_slow
main_kernel_w_c1_v_ev:
s_mov_b32 s55, 1
s_cmp_eq_u32 s56, 0
s_cbranch_scc1 main_kernel_w_c1_v_et
s_bfm_b64 exec, s0, 0
buffer_store_dword v244, v248, s[4:7], s59 offen sc1
s_mov_b64 exec, -1
s_mov_b32 s56, 0
main_kernel_w_c1_v_et:
s_cmp_lg_u32 s18, 1
s_cbranch_scc1 main_kernel_w_c1_v_loop
s_lshl_b32 s32, s27, 8
s_add_u32 s32, s32, 0x841e000
s_mov_b64 exec, 1
v_mov_b32 v249, 1
buffer_atomic_add v249, off, s[4:7], s32 sc0 sc1
s_mov_b64 exec, -1
s_branch main_kernel_w_c1_v_loop
main_kernel_w_epn:
s_waitcnt lgkmcnt(0)
s_branch main_kernel_w_epw
main_kernel_w_slow:
s_mov_b32 s58, -1
main_kernel_w_epw:
s_nop 5
main_kernel_w_epi:
s_cmp_eq_u32 s56, 2
s_cbranch_scc1 main_kernel_w_e2
s_cmp_eq_u32 s56, 3
s_cbranch_scc1 main_kernel_w_e3
s_cmp_eq_u32 s56, 4
s_cbranch_scc1 main_kernel_w_e4
s_cmp_eq_u32 s56, 5
s_cbranch_scc1 main_kernel_w_e5
s_cmp_eq_u32 s56, 6
s_cbranch_scc1 main_kernel_w_e6
s_cmp_eq_u32 s56, 7
s_cbranch_scc1 main_kernel_w_e7
s_cmp_eq_u32 s56, 8
s_cbranch_scc1 main_kernel_w_e8
s_cmp_eq_u32 s56, 9
s_cbranch_scc1 main_kernel_w_e9
s_cmp_eq_u32 s56, 10
s_cbranch_scc1 main_kernel_w_e10
main_kernel_w_e1:
s_mov_b32 s53, s1
v_mul_f32 v64, 0x3e0293ee, v64
v_mul_f32 v65, 0x3e0293ee, v65
v_mul_f32 v66, 0x3e0293ee, v66
v_mul_f32 v67, 0x3e0293ee, v67
v_mul_f32 v68, 0x3e0293ee, v68
v_mul_f32 v69, 0x3e0293ee, v69
v_mul_f32 v70, 0x3e0293ee, v70
v_mul_f32 v71, 0x3e0293ee, v71
v_cvt_pk_bf16_f32 v16, v64, v65
v_cvt_pk_bf16_f32 v17, v66, v67
v_cvt_pk_bf16_f32 v18, v68, v69
v_cvt_pk_bf16_f32 v19, v70, v71
buffer_store_dwordx4 v[16:19], v251, s[4:7], s53 offen offset:0 sc1
v_mul_f32 v72, 0x3e0293ee, v72
v_mul_f32 v73, 0x3e0293ee, v73
v_mul_f32 v74, 0x3e0293ee, v74
v_mul_f32 v75, 0x3e0293ee, v75
v_mul_f32 v76, 0x3e0293ee, v76
v_mul_f32 v77, 0x3e0293ee, v77
v_mul_f32 v78, 0x3e0293ee, v78
v_mul_f32 v79, 0x3e0293ee, v79
v_cvt_pk_bf16_f32 v36, v72, v73
v_cvt_pk_bf16_f32 v37, v74, v75
v_cvt_pk_bf16_f32 v38, v76, v77
v_cvt_pk_bf16_f32 v39, v78, v79
buffer_store_dwordx4 v[36:39], v251, s[4:7], s53 offen offset:1024 sc1
s_add_u32 s53, s53, s2
v_mul_f32 v80, 0x3e0293ee, v80
v_mul_f32 v81, 0x3e0293ee, v81
v_mul_f32 v82, 0x3e0293ee, v82
v_mul_f32 v83, 0x3e0293ee, v83
v_mul_f32 v84, 0x3e0293ee, v84
v_mul_f32 v85, 0x3e0293ee, v85
v_mul_f32 v86, 0x3e0293ee, v86
v_mul_f32 v87, 0x3e0293ee, v87
v_cvt_pk_bf16_f32 v56, v80, v81
v_cvt_pk_bf16_f32 v57, v82, v83
v_cvt_pk_bf16_f32 v58, v84, v85
v_cvt_pk_bf16_f32 v59, v86, v87
buffer_store_dwordx4 v[56:59], v251, s[4:7], s53 offen offset:0 sc1
v_mul_f32 v88, 0x3e0293ee, v88
v_mul_f32 v89, 0x3e0293ee, v89
v_mul_f32 v90, 0x3e0293ee, v90
v_mul_f32 v91, 0x3e0293ee, v91
v_mul_f32 v92, 0x3e0293ee, v92
v_mul_f32 v93, 0x3e0293ee, v93
v_mul_f32 v94, 0x3e0293ee, v94
v_mul_f32 v95, 0x3e0293ee, v95
v_cvt_pk_bf16_f32 v16, v88, v89
v_cvt_pk_bf16_f32 v17, v90, v91
v_cvt_pk_bf16_f32 v18, v92, v93
v_cvt_pk_bf16_f32 v19, v94, v95
buffer_store_dwordx4 v[16:19], v251, s[4:7], s53 offen offset:1024 sc1
s_add_u32 s53, s53, s2
v_mul_f32 v96, 0x3e0293ee, v96
v_mul_f32 v97, 0x3e0293ee, v97
v_mul_f32 v98, 0x3e0293ee, v98
v_mul_f32 v99, 0x3e0293ee, v99
v_mul_f32 v100, 0x3e0293ee, v100
v_mul_f32 v101, 0x3e0293ee, v101
v_mul_f32 v102, 0x3e0293ee, v102
v_mul_f32 v103, 0x3e0293ee, v103
v_cvt_pk_bf16_f32 v36, v96, v97
v_cvt_pk_bf16_f32 v37, v98, v99
v_cvt_pk_bf16_f32 v38, v100, v101
v_cvt_pk_bf16_f32 v39, v102, v103
buffer_store_dwordx4 v[36:39], v251, s[4:7], s53 offen offset:0 sc1
v_mul_f32 v104, 0x3e0293ee, v104
v_mul_f32 v105, 0x3e0293ee, v105
v_mul_f32 v106, 0x3e0293ee, v106
v_mul_f32 v107, 0x3e0293ee, v107
v_mul_f32 v108, 0x3e0293ee, v108
v_mul_f32 v109, 0x3e0293ee, v109
v_mul_f32 v110, 0x3e0293ee, v110
v_mul_f32 v111, 0x3e0293ee, v111
v_cvt_pk_bf16_f32 v56, v104, v105
v_cvt_pk_bf16_f32 v57, v106, v107
v_cvt_pk_bf16_f32 v58, v108, v109
v_cvt_pk_bf16_f32 v59, v110, v111
buffer_store_dwordx4 v[56:59], v251, s[4:7], s53 offen offset:1024 sc1
s_add_u32 s53, s53, s2
v_mul_f32 v112, 0x3e0293ee, v112
v_mul_f32 v113, 0x3e0293ee, v113
v_mul_f32 v114, 0x3e0293ee, v114
v_mul_f32 v115, 0x3e0293ee, v115
v_mul_f32 v116, 0x3e0293ee, v116
v_mul_f32 v117, 0x3e0293ee, v117
v_mul_f32 v118, 0x3e0293ee, v118
v_mul_f32 v119, 0x3e0293ee, v119
v_cvt_pk_bf16_f32 v16, v112, v113
v_cvt_pk_bf16_f32 v17, v114, v115
v_cvt_pk_bf16_f32 v18, v116, v117
v_cvt_pk_bf16_f32 v19, v118, v119
buffer_store_dwordx4 v[16:19], v251, s[4:7], s53 offen offset:0 sc1
v_mul_f32 v120, 0x3e0293ee, v120
v_mul_f32 v121, 0x3e0293ee, v121
v_mul_f32 v122, 0x3e0293ee, v122
v_mul_f32 v123, 0x3e0293ee, v123
v_mul_f32 v124, 0x3e0293ee, v124
v_mul_f32 v125, 0x3e0293ee, v125
v_mul_f32 v126, 0x3e0293ee, v126
v_mul_f32 v127, 0x3e0293ee, v127
v_cvt_pk_bf16_f32 v36, v120, v121
v_cvt_pk_bf16_f32 v37, v122, v123
v_cvt_pk_bf16_f32 v38, v124, v125
v_cvt_pk_bf16_f32 v39, v126, v127
buffer_store_dwordx4 v[36:39], v251, s[4:7], s53 offen offset:1024 sc1
s_branch main_kernel_w_ee
main_kernel_w_e2:
s_mov_b32 s53, s1
v_cvt_pk_bf16_f32 v8, v64, v65
v_cvt_pk_bf16_f32 v9, v66, v67
v_cvt_pk_bf16_f32 v10, v80, v81
v_cvt_pk_bf16_f32 v11, v82, v83
buffer_store_dwordx4 v[8:11], v251, s[4:7], s53 offen offset:0 sc1
v_cvt_pk_bf16_f32 v24, v68, v69
v_cvt_pk_bf16_f32 v25, v70, v71
v_cvt_pk_bf16_f32 v26, v84, v85
v_cvt_pk_bf16_f32 v27, v86, v87
buffer_store_dwordx4 v[24:27], v251, s[4:7], s53 offen offset:1024 sc1
v_cvt_pk_bf16_f32 v40, v72, v73
v_cvt_pk_bf16_f32 v41, v74, v75
v_cvt_pk_bf16_f32 v42, v88, v89
v_cvt_pk_bf16_f32 v43, v90, v91
buffer_store_dwordx4 v[40:43], v251, s[4:7], s53 offen offset:2048 sc1
v_cvt_pk_bf16_f32 v56, v76, v77
v_cvt_pk_bf16_f32 v57, v78, v79
v_cvt_pk_bf16_f32 v58, v92, v93
v_cvt_pk_bf16_f32 v59, v94, v95
buffer_store_dwordx4 v[56:59], v251, s[4:7], s53 offen offset:3072 sc1
s_add_u32 s53, s53, 262144
v_cvt_pk_bf16_f32 v8, v96, v97
v_cvt_pk_bf16_f32 v9, v98, v99
v_cvt_pk_bf16_f32 v10, v112, v113
v_cvt_pk_bf16_f32 v11, v114, v115
buffer_store_dwordx4 v[8:11], v251, s[4:7], s53 offen offset:0 sc1
v_cvt_pk_bf16_f32 v24, v100, v101
v_cvt_pk_bf16_f32 v25, v102, v103
v_cvt_pk_bf16_f32 v26, v116, v117
v_cvt_pk_bf16_f32 v27, v118, v119
buffer_store_dwordx4 v[24:27], v251, s[4:7], s53 offen offset:1024 sc1
v_cvt_pk_bf16_f32 v40, v104, v105
v_cvt_pk_bf16_f32 v41, v106, v107
v_cvt_pk_bf16_f32 v42, v120, v121
v_cvt_pk_bf16_f32 v43, v122, v123
buffer_store_dwordx4 v[40:43], v251, s[4:7], s53 offen offset:2048 sc1
v_cvt_pk_bf16_f32 v56, v108, v109
v_cvt_pk_bf16_f32 v57, v110, v111
v_cvt_pk_bf16_f32 v58, v124, v125
v_cvt_pk_bf16_f32 v59, v126, v127
buffer_store_dwordx4 v[56:59], v251, s[4:7], s53 offen offset:3072 sc1
s_add_u32 s53, s53, 262144
s_branch main_kernel_w_ee
main_kernel_w_e3:
s_mov_b32 s53, s1
v_lshlrev_b32 v8, 16, v192
v_and_b32 v9, 0xffff0000, v192
v_lshlrev_b32 v10, 16, v193
v_and_b32 v11, 0xffff0000, v193
v_lshlrev_b32 v12, 16, v194
v_and_b32 v13, 0xffff0000, v194
v_lshlrev_b32 v14, 16, v195
v_and_b32 v15, 0xffff0000, v195
v_pk_add_f32 v[64:65], v[64:65], v[8:9]
v_pk_add_f32 v[66:67], v[66:67], v[10:11]
v_pk_add_f32 v[68:69], v[68:69], v[12:13]
v_pk_add_f32 v[70:71], v[70:71], v[14:15]
v_cvt_pk_bf16_f32 v16, v64, v65
v_cvt_pk_bf16_f32 v17, v66, v67
v_cvt_pk_bf16_f32 v18, v68, v69
v_cvt_pk_bf16_f32 v19, v70, v71
buffer_store_dwordx4 v[16:19], v251, s[4:7], s53 offen offset:0 sc1
v_lshlrev_b32 v28, 16, v196
v_and_b32 v29, 0xffff0000, v196
v_lshlrev_b32 v30, 16, v197
v_and_b32 v31, 0xffff0000, v197
v_lshlrev_b32 v32, 16, v198
v_and_b32 v33, 0xffff0000, v198
v_lshlrev_b32 v34, 16, v199
v_and_b32 v35, 0xffff0000, v199
v_pk_add_f32 v[72:73], v[72:73], v[28:29]
v_pk_add_f32 v[74:75], v[74:75], v[30:31]
v_pk_add_f32 v[76:77], v[76:77], v[32:33]
v_pk_add_f32 v[78:79], v[78:79], v[34:35]
v_cvt_pk_bf16_f32 v36, v72, v73
v_cvt_pk_bf16_f32 v37, v74, v75
v_cvt_pk_bf16_f32 v38, v76, v77
v_cvt_pk_bf16_f32 v39, v78, v79
buffer_store_dwordx4 v[36:39], v251, s[4:7], s53 offen offset:1024 sc1
s_add_u32 s53, s53, s2
v_lshlrev_b32 v48, 16, v200
v_and_b32 v49, 0xffff0000, v200
v_lshlrev_b32 v50, 16, v201
v_and_b32 v51, 0xffff0000, v201
v_lshlrev_b32 v52, 16, v202
v_and_b32 v53, 0xffff0000, v202
v_lshlrev_b32 v54, 16, v203
v_and_b32 v55, 0xffff0000, v203
v_pk_add_f32 v[80:81], v[80:81], v[48:49]
v_pk_add_f32 v[82:83], v[82:83], v[50:51]
v_pk_add_f32 v[84:85], v[84:85], v[52:53]
v_pk_add_f32 v[86:87], v[86:87], v[54:55]
v_cvt_pk_bf16_f32 v56, v80, v81
v_cvt_pk_bf16_f32 v57, v82, v83
v_cvt_pk_bf16_f32 v58, v84, v85
v_cvt_pk_bf16_f32 v59, v86, v87
buffer_store_dwordx4 v[56:59], v251, s[4:7], s53 offen offset:0 sc1
v_lshlrev_b32 v8, 16, v204
v_and_b32 v9, 0xffff0000, v204
v_lshlrev_b32 v10, 16, v205
v_and_b32 v11, 0xffff0000, v205
v_lshlrev_b32 v12, 16, v206
v_and_b32 v13, 0xffff0000, v206
v_lshlrev_b32 v14, 16, v207
v_and_b32 v15, 0xffff0000, v207
v_pk_add_f32 v[88:89], v[88:89], v[8:9]
v_pk_add_f32 v[90:91], v[90:91], v[10:11]
v_pk_add_f32 v[92:93], v[92:93], v[12:13]
v_pk_add_f32 v[94:95], v[94:95], v[14:15]
v_cvt_pk_bf16_f32 v16, v88, v89
v_cvt_pk_bf16_f32 v17, v90, v91
v_cvt_pk_bf16_f32 v18, v92, v93
v_cvt_pk_bf16_f32 v19, v94, v95
buffer_store_dwordx4 v[16:19], v251, s[4:7], s53 offen offset:1024 sc1
s_add_u32 s53, s53, s2
v_lshlrev_b32 v28, 16, v208
v_and_b32 v29, 0xffff0000, v208
v_lshlrev_b32 v30, 16, v209
v_and_b32 v31, 0xffff0000, v209
v_lshlrev_b32 v32, 16, v210
v_and_b32 v33, 0xffff0000, v210
v_lshlrev_b32 v34, 16, v211
v_and_b32 v35, 0xffff0000, v211
v_pk_add_f32 v[96:97], v[96:97], v[28:29]
v_pk_add_f32 v[98:99], v[98:99], v[30:31]
v_pk_add_f32 v[100:101], v[100:101], v[32:33]
v_pk_add_f32 v[102:103], v[102:103], v[34:35]
v_cvt_pk_bf16_f32 v36, v96, v97
v_cvt_pk_bf16_f32 v37, v98, v99
v_cvt_pk_bf16_f32 v38, v100, v101
v_cvt_pk_bf16_f32 v39, v102, v103
buffer_store_dwordx4 v[36:39], v251, s[4:7], s53 offen offset:0 sc1
v_lshlrev_b32 v48, 16, v212
v_and_b32 v49, 0xffff0000, v212
v_lshlrev_b32 v50, 16, v213
v_and_b32 v51, 0xffff0000, v213
v_lshlrev_b32 v52, 16, v214
v_and_b32 v53, 0xffff0000, v214
v_lshlrev_b32 v54, 16, v215
v_and_b32 v55, 0xffff0000, v215
v_pk_add_f32 v[104:105], v[104:105], v[48:49]
v_pk_add_f32 v[106:107], v[106:107], v[50:51]
v_pk_add_f32 v[108:109], v[108:109], v[52:53]
v_pk_add_f32 v[110:111], v[110:111], v[54:55]
v_cvt_pk_bf16_f32 v56, v104, v105
v_cvt_pk_bf16_f32 v57, v106, v107
v_cvt_pk_bf16_f32 v58, v108, v109
v_cvt_pk_bf16_f32 v59, v110, v111
buffer_store_dwordx4 v[56:59], v251, s[4:7], s53 offen offset:1024 sc1
s_add_u32 s53, s53, s2
v_lshlrev_b32 v8, 16, v216
v_and_b32 v9, 0xffff0000, v216
v_lshlrev_b32 v10, 16, v217
v_and_b32 v11, 0xffff0000, v217
v_lshlrev_b32 v12, 16, v218
v_and_b32 v13, 0xffff0000, v218
v_lshlrev_b32 v14, 16, v219
v_and_b32 v15, 0xffff0000, v219
v_pk_add_f32 v[112:113], v[112:113], v[8:9]
v_pk_add_f32 v[114:115], v[114:115], v[10:11]
v_pk_add_f32 v[116:117], v[116:117], v[12:13]
v_pk_add_f32 v[118:119], v[118:119], v[14:15]
v_cvt_pk_bf16_f32 v16, v112, v113
v_cvt_pk_bf16_f32 v17, v114, v115
v_cvt_pk_bf16_f32 v18, v116, v117
v_cvt_pk_bf16_f32 v19, v118, v119
buffer_store_dwordx4 v[16:19], v251, s[4:7], s53 offen offset:0 sc1
v_lshlrev_b32 v28, 16, v220
v_and_b32 v29, 0xffff0000, v220
v_lshlrev_b32 v30, 16, v221
v_and_b32 v31, 0xffff0000, v221
v_lshlrev_b32 v32, 16, v222
v_and_b32 v33, 0xffff0000, v222
v_lshlrev_b32 v34, 16, v223
v_and_b32 v35, 0xffff0000, v223
v_pk_add_f32 v[120:121], v[120:121], v[28:29]
v_pk_add_f32 v[122:123], v[122:123], v[30:31]
v_pk_add_f32 v[124:125], v[124:125], v[32:33]
v_pk_add_f32 v[126:127], v[126:127], v[34:35]
v_cvt_pk_bf16_f32 v36, v120, v121
v_cvt_pk_bf16_f32 v37, v122, v123
v_cvt_pk_bf16_f32 v38, v124, v125
v_cvt_pk_bf16_f32 v39, v126, v127
buffer_store_dwordx4 v[36:39], v251, s[4:7], s53 offen offset:1024 sc1
s_branch main_kernel_w_ee
main_kernel_w_e4:
s_mov_b32 s53, s1
v_lshlrev_b32 v8, 16, v192
v_and_b32 v9, 0xffff0000, v192
v_lshlrev_b32 v10, 16, v193
v_and_b32 v11, 0xffff0000, v193
v_lshlrev_b32 v12, 16, v194
v_and_b32 v13, 0xffff0000, v194
v_lshlrev_b32 v14, 16, v195
v_and_b32 v15, 0xffff0000, v195
v_pk_add_f32 v[64:65], v[64:65], v[8:9]
v_pk_add_f32 v[66:67], v[66:67], v[10:11]
v_pk_add_f32 v[68:69], v[68:69], v[12:13]
v_pk_add_f32 v[70:71], v[70:71], v[14:15]
v_pk_mul_f32 v[8:9], v[64:65], v[246:247]
v_pk_mul_f32 v[10:11], v[66:67], v[246:247]
v_pk_mul_f32 v[12:13], v[68:69], v[246:247]
v_pk_mul_f32 v[14:15], v[70:71], v[246:247]
v_exp_f32 v8, v8
v_exp_f32 v9, v9
v_exp_f32 v10, v10
v_exp_f32 v11, v11
v_exp_f32 v12, v12
v_exp_f32 v13, v13
v_exp_f32 v14, v14
v_exp_f32 v15, v15
v_pk_add_f32 v[8:9], v[8:9], v[244:245]
v_pk_add_f32 v[10:11], v[10:11], v[244:245]
v_pk_add_f32 v[12:13], v[12:13], v[244:245]
v_pk_add_f32 v[14:15], v[14:15], v[244:245]
v_rcp_f32 v8, v8
v_rcp_f32 v9, v9
v_rcp_f32 v10, v10
v_rcp_f32 v11, v11
v_rcp_f32 v12, v12
v_rcp_f32 v13, v13
v_rcp_f32 v14, v14
v_rcp_f32 v15, v15
v_pk_mul_f32 v[64:65], v[8:9], v[64:65]
v_pk_mul_f32 v[66:67], v[10:11], v[66:67]
v_pk_mul_f32 v[68:69], v[12:13], v[68:69]
v_pk_mul_f32 v[70:71], v[14:15], v[70:71]
v_cvt_pk_bf16_f32 v16, v64, v65
v_cvt_pk_bf16_f32 v17, v66, v67
v_cvt_pk_bf16_f32 v18, v68, v69
v_cvt_pk_bf16_f32 v19, v70, v71
buffer_store_dwordx4 v[16:19], v251, s[4:7], s53 offen offset:0 sc1
v_lshlrev_b32 v28, 16, v196
v_and_b32 v29, 0xffff0000, v196
v_lshlrev_b32 v30, 16, v197
v_and_b32 v31, 0xffff0000, v197
v_lshlrev_b32 v32, 16, v198
v_and_b32 v33, 0xffff0000, v198
v_lshlrev_b32 v34, 16, v199
v_and_b32 v35, 0xffff0000, v199
v_pk_add_f32 v[72:73], v[72:73], v[28:29]
v_pk_add_f32 v[74:75], v[74:75], v[30:31]
v_pk_add_f32 v[76:77], v[76:77], v[32:33]
v_pk_add_f32 v[78:79], v[78:79], v[34:35]
v_pk_mul_f32 v[28:29], v[72:73], v[246:247]
v_pk_mul_f32 v[30:31], v[74:75], v[246:247]
v_pk_mul_f32 v[32:33], v[76:77], v[246:247]
v_pk_mul_f32 v[34:35], v[78:79], v[246:247]
v_exp_f32 v28, v28
v_exp_f32 v29, v29
v_exp_f32 v30, v30
v_exp_f32 v31, v31
v_exp_f32 v32, v32
v_exp_f32 v33, v33
v_exp_f32 v34, v34
v_exp_f32 v35, v35
v_pk_add_f32 v[28:29], v[28:29], v[244:245]
v_pk_add_f32 v[30:31], v[30:31], v[244:245]
v_pk_add_f32 v[32:33], v[32:33], v[244:245]
v_pk_add_f32 v[34:35], v[34:35], v[244:245]
v_rcp_f32 v28, v28
v_rcp_f32 v29, v29
v_rcp_f32 v30, v30
v_rcp_f32 v31, v31
v_rcp_f32 v32, v32
v_rcp_f32 v33, v33
v_rcp_f32 v34, v34
v_rcp_f32 v35, v35
v_pk_mul_f32 v[72:73], v[28:29], v[72:73]
v_pk_mul_f32 v[74:75], v[30:31], v[74:75]
v_pk_mul_f32 v[76:77], v[32:33], v[76:77]
v_pk_mul_f32 v[78:79], v[34:35], v[78:79]
v_cvt_pk_bf16_f32 v36, v72, v73
v_cvt_pk_bf16_f32 v37, v74, v75
v_cvt_pk_bf16_f32 v38, v76, v77
v_cvt_pk_bf16_f32 v39, v78, v79
buffer_store_dwordx4 v[36:39], v251, s[4:7], s53 offen offset:1024 sc1
s_add_u32 s53, s53, s2
v_lshlrev_b32 v48, 16, v200
v_and_b32 v49, 0xffff0000, v200
v_lshlrev_b32 v50, 16, v201
v_and_b32 v51, 0xffff0000, v201
v_lshlrev_b32 v52, 16, v202
v_and_b32 v53, 0xffff0000, v202
v_lshlrev_b32 v54, 16, v203
v_and_b32 v55, 0xffff0000, v203
v_pk_add_f32 v[80:81], v[80:81], v[48:49]
v_pk_add_f32 v[82:83], v[82:83], v[50:51]
v_pk_add_f32 v[84:85], v[84:85], v[52:53]
v_pk_add_f32 v[86:87], v[86:87], v[54:55]
v_pk_mul_f32 v[48:49], v[80:81], v[246:247]
v_pk_mul_f32 v[50:51], v[82:83], v[246:247]
v_pk_mul_f32 v[52:53], v[84:85], v[246:247]
v_pk_mul_f32 v[54:55], v[86:87], v[246:247]
v_exp_f32 v48, v48
v_exp_f32 v49, v49
v_exp_f32 v50, v50
v_exp_f32 v51, v51
v_exp_f32 v52, v52
v_exp_f32 v53, v53
v_exp_f32 v54, v54
v_exp_f32 v55, v55
v_pk_add_f32 v[48:49], v[48:49], v[244:245]
v_pk_add_f32 v[50:51], v[50:51], v[244:245]
v_pk_add_f32 v[52:53], v[52:53], v[244:245]
v_pk_add_f32 v[54:55], v[54:55], v[244:245]
v_rcp_f32 v48, v48
v_rcp_f32 v49, v49
v_rcp_f32 v50, v50
v_rcp_f32 v51, v51
v_rcp_f32 v52, v52
v_rcp_f32 v53, v53
v_rcp_f32 v54, v54
v_rcp_f32 v55, v55
v_pk_mul_f32 v[80:81], v[48:49], v[80:81]
v_pk_mul_f32 v[82:83], v[50:51], v[82:83]
v_pk_mul_f32 v[84:85], v[52:53], v[84:85]
v_pk_mul_f32 v[86:87], v[54:55], v[86:87]
v_cvt_pk_bf16_f32 v56, v80, v81
v_cvt_pk_bf16_f32 v57, v82, v83
v_cvt_pk_bf16_f32 v58, v84, v85
v_cvt_pk_bf16_f32 v59, v86, v87
buffer_store_dwordx4 v[56:59], v251, s[4:7], s53 offen offset:0 sc1
v_lshlrev_b32 v8, 16, v204
v_and_b32 v9, 0xffff0000, v204
v_lshlrev_b32 v10, 16, v205
v_and_b32 v11, 0xffff0000, v205
v_lshlrev_b32 v12, 16, v206
v_and_b32 v13, 0xffff0000, v206
v_lshlrev_b32 v14, 16, v207
v_and_b32 v15, 0xffff0000, v207
v_pk_add_f32 v[88:89], v[88:89], v[8:9]
v_pk_add_f32 v[90:91], v[90:91], v[10:11]
v_pk_add_f32 v[92:93], v[92:93], v[12:13]
v_pk_add_f32 v[94:95], v[94:95], v[14:15]
v_pk_mul_f32 v[8:9], v[88:89], v[246:247]
v_pk_mul_f32 v[10:11], v[90:91], v[246:247]
v_pk_mul_f32 v[12:13], v[92:93], v[246:247]
v_pk_mul_f32 v[14:15], v[94:95], v[246:247]
v_exp_f32 v8, v8
v_exp_f32 v9, v9
v_exp_f32 v10, v10
v_exp_f32 v11, v11
v_exp_f32 v12, v12
v_exp_f32 v13, v13
v_exp_f32 v14, v14
v_exp_f32 v15, v15
v_pk_add_f32 v[8:9], v[8:9], v[244:245]
v_pk_add_f32 v[10:11], v[10:11], v[244:245]
v_pk_add_f32 v[12:13], v[12:13], v[244:245]
v_pk_add_f32 v[14:15], v[14:15], v[244:245]
v_rcp_f32 v8, v8
v_rcp_f32 v9, v9
v_rcp_f32 v10, v10
v_rcp_f32 v11, v11
v_rcp_f32 v12, v12
v_rcp_f32 v13, v13
v_rcp_f32 v14, v14
v_rcp_f32 v15, v15
v_pk_mul_f32 v[88:89], v[8:9], v[88:89]
v_pk_mul_f32 v[90:91], v[10:11], v[90:91]
v_pk_mul_f32 v[92:93], v[12:13], v[92:93]
v_pk_mul_f32 v[94:95], v[14:15], v[94:95]
v_cvt_pk_bf16_f32 v16, v88, v89
v_cvt_pk_bf16_f32 v17, v90, v91
v_cvt_pk_bf16_f32 v18, v92, v93
v_cvt_pk_bf16_f32 v19, v94, v95
buffer_store_dwordx4 v[16:19], v251, s[4:7], s53 offen offset:1024 sc1
s_add_u32 s53, s53, s2
v_lshlrev_b32 v28, 16, v208
v_and_b32 v29, 0xffff0000, v208
v_lshlrev_b32 v30, 16, v209
v_and_b32 v31, 0xffff0000, v209
v_lshlrev_b32 v32, 16, v210
v_and_b32 v33, 0xffff0000, v210
v_lshlrev_b32 v34, 16, v211
v_and_b32 v35, 0xffff0000, v211
v_pk_add_f32 v[96:97], v[96:97], v[28:29]
v_pk_add_f32 v[98:99], v[98:99], v[30:31]
v_pk_add_f32 v[100:101], v[100:101], v[32:33]
v_pk_add_f32 v[102:103], v[102:103], v[34:35]
v_pk_mul_f32 v[28:29], v[96:97], v[246:247]
v_pk_mul_f32 v[30:31], v[98:99], v[246:247]
v_pk_mul_f32 v[32:33], v[100:101], v[246:247]
v_pk_mul_f32 v[34:35], v[102:103], v[246:247]
v_exp_f32 v28, v28
v_exp_f32 v29, v29
v_exp_f32 v30, v30
v_exp_f32 v31, v31
v_exp_f32 v32, v32
v_exp_f32 v33, v33
v_exp_f32 v34, v34
v_exp_f32 v35, v35
v_pk_add_f32 v[28:29], v[28:29], v[244:245]
v_pk_add_f32 v[30:31], v[30:31], v[244:245]
v_pk_add_f32 v[32:33], v[32:33], v[244:245]
v_pk_add_f32 v[34:35], v[34:35], v[244:245]
v_rcp_f32 v28, v28
v_rcp_f32 v29, v29
v_rcp_f32 v30, v30
v_rcp_f32 v31, v31
v_rcp_f32 v32, v32
v_rcp_f32 v33, v33
v_rcp_f32 v34, v34
v_rcp_f32 v35, v35
v_pk_mul_f32 v[96:97], v[28:29], v[96:97]
v_pk_mul_f32 v[98:99], v[30:31], v[98:99]
v_pk_mul_f32 v[100:101], v[32:33], v[100:101]
v_pk_mul_f32 v[102:103], v[34:35], v[102:103]
v_cvt_pk_bf16_f32 v36, v96, v97
v_cvt_pk_bf16_f32 v37, v98, v99
v_cvt_pk_bf16_f32 v38, v100, v101
v_cvt_pk_bf16_f32 v39, v102, v103
buffer_store_dwordx4 v[36:39], v251, s[4:7], s53 offen offset:0 sc1
v_lshlrev_b32 v48, 16, v212
v_and_b32 v49, 0xffff0000, v212
v_lshlrev_b32 v50, 16, v213
v_and_b32 v51, 0xffff0000, v213
v_lshlrev_b32 v52, 16, v214
v_and_b32 v53, 0xffff0000, v214
v_lshlrev_b32 v54, 16, v215
v_and_b32 v55, 0xffff0000, v215
v_pk_add_f32 v[104:105], v[104:105], v[48:49]
v_pk_add_f32 v[106:107], v[106:107], v[50:51]
v_pk_add_f32 v[108:109], v[108:109], v[52:53]
v_pk_add_f32 v[110:111], v[110:111], v[54:55]
v_pk_mul_f32 v[48:49], v[104:105], v[246:247]
v_pk_mul_f32 v[50:51], v[106:107], v[246:247]
v_pk_mul_f32 v[52:53], v[108:109], v[246:247]
v_pk_mul_f32 v[54:55], v[110:111], v[246:247]
v_exp_f32 v48, v48
v_exp_f32 v49, v49
v_exp_f32 v50, v50
v_exp_f32 v51, v51
v_exp_f32 v52, v52
v_exp_f32 v53, v53
v_exp_f32 v54, v54
v_exp_f32 v55, v55
v_pk_add_f32 v[48:49], v[48:49], v[244:245]
v_pk_add_f32 v[50:51], v[50:51], v[244:245]
v_pk_add_f32 v[52:53], v[52:53], v[244:245]
v_pk_add_f32 v[54:55], v[54:55], v[244:245]
v_rcp_f32 v48, v48
v_rcp_f32 v49, v49
v_rcp_f32 v50, v50
v_rcp_f32 v51, v51
v_rcp_f32 v52, v52
v_rcp_f32 v53, v53
v_rcp_f32 v54, v54
v_rcp_f32 v55, v55
v_pk_mul_f32 v[104:105], v[48:49], v[104:105]
v_pk_mul_f32 v[106:107], v[50:51], v[106:107]
v_pk_mul_f32 v[108:109], v[52:53], v[108:109]
v_pk_mul_f32 v[110:111], v[54:55], v[110:111]
v_cvt_pk_bf16_f32 v56, v104, v105
v_cvt_pk_bf16_f32 v57, v106, v107
v_cvt_pk_bf16_f32 v58, v108, v109
v_cvt_pk_bf16_f32 v59, v110, v111
buffer_store_dwordx4 v[56:59], v251, s[4:7], s53 offen offset:1024 sc1
s_add_u32 s53, s53, s2
v_lshlrev_b32 v8, 16, v216
v_and_b32 v9, 0xffff0000, v216
v_lshlrev_b32 v10, 16, v217
v_and_b32 v11, 0xffff0000, v217
v_lshlrev_b32 v12, 16, v218
v_and_b32 v13, 0xffff0000, v218
v_lshlrev_b32 v14, 16, v219
v_and_b32 v15, 0xffff0000, v219
v_pk_add_f32 v[112:113], v[112:113], v[8:9]
v_pk_add_f32 v[114:115], v[114:115], v[10:11]
v_pk_add_f32 v[116:117], v[116:117], v[12:13]
v_pk_add_f32 v[118:119], v[118:119], v[14:15]
v_pk_mul_f32 v[8:9], v[112:113], v[246:247]
v_pk_mul_f32 v[10:11], v[114:115], v[246:247]
v_pk_mul_f32 v[12:13], v[116:117], v[246:247]
v_pk_mul_f32 v[14:15], v[118:119], v[246:247]
v_exp_f32 v8, v8
v_exp_f32 v9, v9
v_exp_f32 v10, v10
v_exp_f32 v11, v11
v_exp_f32 v12, v12
v_exp_f32 v13, v13
v_exp_f32 v14, v14
v_exp_f32 v15, v15
v_pk_add_f32 v[8:9], v[8:9], v[244:245]
v_pk_add_f32 v[10:11], v[10:11], v[244:245]
v_pk_add_f32 v[12:13], v[12:13], v[244:245]
v_pk_add_f32 v[14:15], v[14:15], v[244:245]
v_rcp_f32 v8, v8
v_rcp_f32 v9, v9
v_rcp_f32 v10, v10
v_rcp_f32 v11, v11
v_rcp_f32 v12, v12
v_rcp_f32 v13, v13
v_rcp_f32 v14, v14
v_rcp_f32 v15, v15
v_pk_mul_f32 v[112:113], v[8:9], v[112:113]
v_pk_mul_f32 v[114:115], v[10:11], v[114:115]
v_pk_mul_f32 v[116:117], v[12:13], v[116:117]
v_pk_mul_f32 v[118:119], v[14:15], v[118:119]
v_cvt_pk_bf16_f32 v16, v112, v113
v_cvt_pk_bf16_f32 v17, v114, v115
v_cvt_pk_bf16_f32 v18, v116, v117
v_cvt_pk_bf16_f32 v19, v118, v119
buffer_store_dwordx4 v[16:19], v251, s[4:7], s53 offen offset:0 sc1
v_lshlrev_b32 v28, 16, v220
v_and_b32 v29, 0xffff0000, v220
v_lshlrev_b32 v30, 16, v221
v_and_b32 v31, 0xffff0000, v221
v_lshlrev_b32 v32, 16, v222
v_and_b32 v33, 0xffff0000, v222
v_lshlrev_b32 v34, 16, v223
v_and_b32 v35, 0xffff0000, v223
v_pk_add_f32 v[120:121], v[120:121], v[28:29]
v_pk_add_f32 v[122:123], v[122:123], v[30:31]
v_pk_add_f32 v[124:125], v[124:125], v[32:33]
v_pk_add_f32 v[126:127], v[126:127], v[34:35]
v_pk_mul_f32 v[28:29], v[120:121], v[246:247]
v_pk_mul_f32 v[30:31], v[122:123], v[246:247]
v_pk_mul_f32 v[32:33], v[124:125], v[246:247]
v_pk_mul_f32 v[34:35], v[126:127], v[246:247]
v_exp_f32 v28, v28
v_exp_f32 v29, v29
v_exp_f32 v30, v30
v_exp_f32 v31, v31
v_exp_f32 v32, v32
v_exp_f32 v33, v33
v_exp_f32 v34, v34
v_exp_f32 v35, v35
v_pk_add_f32 v[28:29], v[28:29], v[244:245]
v_pk_add_f32 v[30:31], v[30:31], v[244:245]
v_pk_add_f32 v[32:33], v[32:33], v[244:245]
v_pk_add_f32 v[34:35], v[34:35], v[244:245]
v_rcp_f32 v28, v28
v_rcp_f32 v29, v29
v_rcp_f32 v30, v30
v_rcp_f32 v31, v31
v_rcp_f32 v32, v32
v_rcp_f32 v33, v33
v_rcp_f32 v34, v34
v_rcp_f32 v35, v35
v_pk_mul_f32 v[120:121], v[28:29], v[120:121]
v_pk_mul_f32 v[122:123], v[30:31], v[122:123]
v_pk_mul_f32 v[124:125], v[32:33], v[124:125]
v_pk_mul_f32 v[126:127], v[34:35], v[126:127]
v_cvt_pk_bf16_f32 v36, v120, v121
v_cvt_pk_bf16_f32 v37, v122, v123
v_cvt_pk_bf16_f32 v38, v124, v125
v_cvt_pk_bf16_f32 v39, v126, v127
buffer_store_dwordx4 v[36:39], v251, s[4:7], s53 offen offset:1024 sc1
s_branch main_kernel_w_ee
main_kernel_w_e5:
s_mov_b32 s53, s1
v_permlane16_swap_b32 v160, v162
v_permlane16_swap_b32 v161, v163
v_lshlrev_b32 v8, 16, v192
v_and_b32 v9, 0xffff0000, v192
v_lshlrev_b32 v10, 16, v193
v_and_b32 v11, 0xffff0000, v193
v_lshlrev_b32 v12, 16, v194
v_and_b32 v13, 0xffff0000, v194
v_lshlrev_b32 v14, 16, v195
v_and_b32 v15, 0xffff0000, v195
v_permlane32_swap_b32 v160, v162
v_permlane32_swap_b32 v161, v163
v_lshlrev_b32 v16, 16, v160
v_and_b32 v17, 0xffff0000, v160
v_lshlrev_b32 v18, 16, v161
v_and_b32 v19, 0xffff0000, v161
v_lshlrev_b32 v20, 16, v162
v_and_b32 v21, 0xffff0000, v162
v_lshlrev_b32 v22, 16, v163
v_and_b32 v23, 0xffff0000, v163
v_pk_fma_f32 v[8:9], v[64:65], v[8:9], v[16:17]
v_pk_fma_f32 v[10:11], v[66:67], v[10:11], v[18:19]
v_pk_fma_f32 v[12:13], v[68:69], v[12:13], v[20:21]
v_pk_fma_f32 v[14:15], v[70:71], v[14:15], v[22:23]
v_cvt_pk_bf16_f32 v24, v8, v9
v_cvt_pk_bf16_f32 v25, v10, v11
v_cvt_pk_bf16_f32 v26, v12, v13
v_cvt_pk_bf16_f32 v27, v14, v15
s_nop 0
v_permlane32_swap_b32 v24, v26
v_permlane32_swap_b32 v25, v27
s_nop 0
v_permlane16_swap_b32 v24, v26
v_permlane16_swap_b32 v25, v27
buffer_store_dwordx4 v[24:27], v145, s[92:95], s53 offen offset:0
v_permlane16_swap_b32 v164, v166
v_permlane16_swap_b32 v165, v167
v_lshlrev_b32 v36, 16, v196
v_and_b32 v37, 0xffff0000, v196
v_lshlrev_b32 v38, 16, v197
v_and_b32 v39, 0xffff0000, v197
v_lshlrev_b32 v40, 16, v198
v_and_b32 v41, 0xffff0000, v198
v_lshlrev_b32 v42, 16, v199
v_and_b32 v43, 0xffff0000, v199
v_permlane32_swap_b32 v164, v166
v_permlane32_swap_b32 v165, v167
v_lshlrev_b32 v44, 16, v164
v_and_b32 v45, 0xffff0000, v164
v_lshlrev_b32 v46, 16, v165
v_and_b32 v47, 0xffff0000, v165
v_lshlrev_b32 v48, 16, v166
v_and_b32 v49, 0xffff0000, v166
v_lshlrev_b32 v50, 16, v167
v_and_b32 v51, 0xffff0000, v167
v_pk_fma_f32 v[36:37], v[72:73], v[36:37], v[44:45]
v_pk_fma_f32 v[38:39], v[74:75], v[38:39], v[46:47]
v_pk_fma_f32 v[40:41], v[76:77], v[40:41], v[48:49]
v_pk_fma_f32 v[42:43], v[78:79], v[42:43], v[50:51]
v_cvt_pk_bf16_f32 v52, v36, v37
v_cvt_pk_bf16_f32 v53, v38, v39
v_cvt_pk_bf16_f32 v54, v40, v41
v_cvt_pk_bf16_f32 v55, v42, v43
s_nop 0
v_permlane32_swap_b32 v52, v54
v_permlane32_swap_b32 v53, v55
s_nop 0
v_permlane16_swap_b32 v52, v54
v_permlane16_swap_b32 v53, v55
buffer_store_dwordx4 v[52:55], v145, s[92:95], s53 offen offset:64
s_add_u32 s53, s53, 32768
v_permlane16_swap_b32 v168, v170
v_permlane16_swap_b32 v169, v171
v_lshlrev_b32 v8, 16, v200
v_and_b32 v9, 0xffff0000, v200
v_lshlrev_b32 v10, 16, v201
v_and_b32 v11, 0xffff0000, v201
v_lshlrev_b32 v12, 16, v202
v_and_b32 v13, 0xffff0000, v202
v_lshlrev_b32 v14, 16, v203
v_and_b32 v15, 0xffff0000, v203
v_permlane32_swap_b32 v168, v170
v_permlane32_swap_b32 v169, v171
v_lshlrev_b32 v16, 16, v168
v_and_b32 v17, 0xffff0000, v168
v_lshlrev_b32 v18, 16, v169
v_and_b32 v19, 0xffff0000, v169
v_lshlrev_b32 v20, 16, v170
v_and_b32 v21, 0xffff0000, v170
v_lshlrev_b32 v22, 16, v171
v_and_b32 v23, 0xffff0000, v171
v_pk_fma_f32 v[8:9], v[80:81], v[8:9], v[16:17]
v_pk_fma_f32 v[10:11], v[82:83], v[10:11], v[18:19]
v_pk_fma_f32 v[12:13], v[84:85], v[12:13], v[20:21]
v_pk_fma_f32 v[14:15], v[86:87], v[14:15], v[22:23]
v_cvt_pk_bf16_f32 v24, v8, v9
v_cvt_pk_bf16_f32 v25, v10, v11
v_cvt_pk_bf16_f32 v26, v12, v13
v_cvt_pk_bf16_f32 v27, v14, v15
s_nop 0
v_permlane32_swap_b32 v24, v26
v_permlane32_swap_b32 v25, v27
s_nop 0
v_permlane16_swap_b32 v24, v26
v_permlane16_swap_b32 v25, v27
buffer_store_dwordx4 v[24:27], v145, s[92:95], s53 offen offset:0
v_permlane16_swap_b32 v172, v174
v_permlane16_swap_b32 v173, v175
v_lshlrev_b32 v36, 16, v204
v_and_b32 v37, 0xffff0000, v204
v_lshlrev_b32 v38, 16, v205
v_and_b32 v39, 0xffff0000, v205
v_lshlrev_b32 v40, 16, v206
v_and_b32 v41, 0xffff0000, v206
v_lshlrev_b32 v42, 16, v207
v_and_b32 v43, 0xffff0000, v207
v_permlane32_swap_b32 v172, v174
v_permlane32_swap_b32 v173, v175
v_lshlrev_b32 v44, 16, v172
v_and_b32 v45, 0xffff0000, v172
v_lshlrev_b32 v46, 16, v173
v_and_b32 v47, 0xffff0000, v173
v_lshlrev_b32 v48, 16, v174
v_and_b32 v49, 0xffff0000, v174
v_lshlrev_b32 v50, 16, v175
v_and_b32 v51, 0xffff0000, v175
v_pk_fma_f32 v[36:37], v[88:89], v[36:37], v[44:45]
v_pk_fma_f32 v[38:39], v[90:91], v[38:39], v[46:47]
v_pk_fma_f32 v[40:41], v[92:93], v[40:41], v[48:49]
v_pk_fma_f32 v[42:43], v[94:95], v[42:43], v[50:51]
v_cvt_pk_bf16_f32 v52, v36, v37
v_cvt_pk_bf16_f32 v53, v38, v39
v_cvt_pk_bf16_f32 v54, v40, v41
v_cvt_pk_bf16_f32 v55, v42, v43
s_nop 0
v_permlane32_swap_b32 v52, v54
v_permlane32_swap_b32 v53, v55
s_nop 0
v_permlane16_swap_b32 v52, v54
v_permlane16_swap_b32 v53, v55
buffer_store_dwordx4 v[52:55], v145, s[92:95], s53 offen offset:64
s_add_u32 s53, s53, 32768
v_permlane16_swap_b32 v176, v178
v_permlane16_swap_b32 v177, v179
v_lshlrev_b32 v8, 16, v208
v_and_b32 v9, 0xffff0000, v208
v_lshlrev_b32 v10, 16, v209
v_and_b32 v11, 0xffff0000, v209
v_lshlrev_b32 v12, 16, v210
v_and_b32 v13, 0xffff0000, v210
v_lshlrev_b32 v14, 16, v211
v_and_b32 v15, 0xffff0000, v211
v_permlane32_swap_b32 v176, v178
v_permlane32_swap_b32 v177, v179
v_lshlrev_b32 v16, 16, v176
v_and_b32 v17, 0xffff0000, v176
v_lshlrev_b32 v18, 16, v177
v_and_b32 v19, 0xffff0000, v177
v_lshlrev_b32 v20, 16, v178
v_and_b32 v21, 0xffff0000, v178
v_lshlrev_b32 v22, 16, v179
v_and_b32 v23, 0xffff0000, v179
v_pk_fma_f32 v[8:9], v[96:97], v[8:9], v[16:17]
v_pk_fma_f32 v[10:11], v[98:99], v[10:11], v[18:19]
v_pk_fma_f32 v[12:13], v[100:101], v[12:13], v[20:21]
v_pk_fma_f32 v[14:15], v[102:103], v[14:15], v[22:23]
v_cvt_pk_bf16_f32 v24, v8, v9
v_cvt_pk_bf16_f32 v25, v10, v11
v_cvt_pk_bf16_f32 v26, v12, v13
v_cvt_pk_bf16_f32 v27, v14, v15
s_nop 0
v_permlane32_swap_b32 v24, v26
v_permlane32_swap_b32 v25, v27
s_nop 0
v_permlane16_swap_b32 v24, v26
v_permlane16_swap_b32 v25, v27
buffer_store_dwordx4 v[24:27], v145, s[92:95], s53 offen offset:0
v_permlane16_swap_b32 v180, v182
v_permlane16_swap_b32 v181, v183
v_lshlrev_b32 v36, 16, v212
v_and_b32 v37, 0xffff0000, v212
v_lshlrev_b32 v38, 16, v213
v_and_b32 v39, 0xffff0000, v213
v_lshlrev_b32 v40, 16, v214
v_and_b32 v41, 0xffff0000, v214
v_lshlrev_b32 v42, 16, v215
v_and_b32 v43, 0xffff0000, v215
v_permlane32_swap_b32 v180, v182
v_permlane32_swap_b32 v181, v183
v_lshlrev_b32 v44, 16, v180
v_and_b32 v45, 0xffff0000, v180
v_lshlrev_b32 v46, 16, v181
v_and_b32 v47, 0xffff0000, v181
v_lshlrev_b32 v48, 16, v182
v_and_b32 v49, 0xffff0000, v182
v_lshlrev_b32 v50, 16, v183
v_and_b32 v51, 0xffff0000, v183
v_pk_fma_f32 v[36:37], v[104:105], v[36:37], v[44:45]
v_pk_fma_f32 v[38:39], v[106:107], v[38:39], v[46:47]
v_pk_fma_f32 v[40:41], v[108:109], v[40:41], v[48:49]
v_pk_fma_f32 v[42:43], v[110:111], v[42:43], v[50:51]
v_cvt_pk_bf16_f32 v52, v36, v37
v_cvt_pk_bf16_f32 v53, v38, v39
v_cvt_pk_bf16_f32 v54, v40, v41
v_cvt_pk_bf16_f32 v55, v42, v43
s_nop 0
v_permlane32_swap_b32 v52, v54
v_permlane32_swap_b32 v53, v55
s_nop 0
v_permlane16_swap_b32 v52, v54
v_permlane16_swap_b32 v53, v55
buffer_store_dwordx4 v[52:55], v145, s[92:95], s53 offen offset:64
s_add_u32 s53, s53, 32768
v_permlane16_swap_b32 v184, v186
v_permlane16_swap_b32 v185, v187
v_lshlrev_b32 v8, 16, v216
v_and_b32 v9, 0xffff0000, v216
v_lshlrev_b32 v10, 16, v217
v_and_b32 v11, 0xffff0000, v217
v_lshlrev_b32 v12, 16, v218
v_and_b32 v13, 0xffff0000, v218
v_lshlrev_b32 v14, 16, v219
v_and_b32 v15, 0xffff0000, v219
v_permlane32_swap_b32 v184, v186
v_permlane32_swap_b32 v185, v187
v_lshlrev_b32 v16, 16, v184
v_and_b32 v17, 0xffff0000, v184
v_lshlrev_b32 v18, 16, v185
v_and_b32 v19, 0xffff0000, v185
v_lshlrev_b32 v20, 16, v186
v_and_b32 v21, 0xffff0000, v186
v_lshlrev_b32 v22, 16, v187
v_and_b32 v23, 0xffff0000, v187
v_pk_fma_f32 v[8:9], v[112:113], v[8:9], v[16:17]
v_pk_fma_f32 v[10:11], v[114:115], v[10:11], v[18:19]
v_pk_fma_f32 v[12:13], v[116:117], v[12:13], v[20:21]
v_pk_fma_f32 v[14:15], v[118:119], v[14:15], v[22:23]
v_cvt_pk_bf16_f32 v24, v8, v9
v_cvt_pk_bf16_f32 v25, v10, v11
v_cvt_pk_bf16_f32 v26, v12, v13
v_cvt_pk_bf16_f32 v27, v14, v15
s_nop 0
v_permlane32_swap_b32 v24, v26
v_permlane32_swap_b32 v25, v27
s_nop 0
v_permlane16_swap_b32 v24, v26
v_permlane16_swap_b32 v25, v27
buffer_store_dwordx4 v[24:27], v145, s[92:95], s53 offen offset:0
v_permlane16_swap_b32 v188, v190
v_permlane16_swap_b32 v189, v191
v_lshlrev_b32 v36, 16, v220
v_and_b32 v37, 0xffff0000, v220
v_lshlrev_b32 v38, 16, v221
v_and_b32 v39, 0xffff0000, v221
v_lshlrev_b32 v40, 16, v222
v_and_b32 v41, 0xffff0000, v222
v_lshlrev_b32 v42, 16, v223
v_and_b32 v43, 0xffff0000, v223
v_permlane32_swap_b32 v188, v190
v_permlane32_swap_b32 v189, v191
v_lshlrev_b32 v44, 16, v188
v_and_b32 v45, 0xffff0000, v188
v_lshlrev_b32 v46, 16, v189
v_and_b32 v47, 0xffff0000, v189
v_lshlrev_b32 v48, 16, v190
v_and_b32 v49, 0xffff0000, v190
v_lshlrev_b32 v50, 16, v191
v_and_b32 v51, 0xffff0000, v191
v_pk_fma_f32 v[36:37], v[120:121], v[36:37], v[44:45]
v_pk_fma_f32 v[38:39], v[122:123], v[38:39], v[46:47]
v_pk_fma_f32 v[40:41], v[124:125], v[40:41], v[48:49]
v_pk_fma_f32 v[42:43], v[126:127], v[42:43], v[50:51]
v_cvt_pk_bf16_f32 v52, v36, v37
v_cvt_pk_bf16_f32 v53, v38, v39
v_cvt_pk_bf16_f32 v54, v40, v41
v_cvt_pk_bf16_f32 v55, v42, v43
s_nop 0
v_permlane32_swap_b32 v52, v54
v_permlane32_swap_b32 v53, v55
s_nop 0
v_permlane16_swap_b32 v52, v54
v_permlane16_swap_b32 v53, v55
buffer_store_dwordx4 v[52:55], v145, s[92:95], s53 offen offset:64
s_branch main_kernel_w_ee
main_kernel_w_e6:
s_mov_b32 s53, s1
v_accvgpr_read_b32 v0, a0
v_accvgpr_read_b32 v1, a1
v_accvgpr_read_b32 v2, a2
v_accvgpr_read_b32 v3, a3
v_accvgpr_read_b32 v4, a4
v_accvgpr_read_b32 v5, a5
v_accvgpr_read_b32 v6, a6
v_accvgpr_read_b32 v7, a7
v_cvt_pk_bf16_f32 v16, v0, v1
v_cvt_pk_bf16_f32 v17, v2, v3
v_cvt_pk_bf16_f32 v18, v4, v5
v_cvt_pk_bf16_f32 v19, v6, v7
buffer_store_dwordx4 v[16:19], v251, s[4:7], s53 offen offset:0 sc1
v_accvgpr_read_b32 v20, a8
v_accvgpr_read_b32 v21, a9
v_accvgpr_read_b32 v22, a10
v_accvgpr_read_b32 v23, a11
v_accvgpr_read_b32 v24, a12
v_accvgpr_read_b32 v25, a13
v_accvgpr_read_b32 v26, a14
v_accvgpr_read_b32 v27, a15
v_cvt_pk_bf16_f32 v36, v20, v21
v_cvt_pk_bf16_f32 v37, v22, v23
v_cvt_pk_bf16_f32 v38, v24, v25
v_cvt_pk_bf16_f32 v39, v26, v27
buffer_store_dwordx4 v[36:39], v251, s[4:7], s53 offen offset:1024 sc1
v_accvgpr_read_b32 v40, a16
v_accvgpr_read_b32 v41, a17
v_accvgpr_read_b32 v42, a18
v_accvgpr_read_b32 v43, a19
v_accvgpr_read_b32 v44, a20
v_accvgpr_read_b32 v45, a21
v_accvgpr_read_b32 v46, a22
v_accvgpr_read_b32 v47, a23
v_cvt_pk_bf16_f32 v56, v40, v41
v_cvt_pk_bf16_f32 v57, v42, v43
v_cvt_pk_bf16_f32 v58, v44, v45
v_cvt_pk_bf16_f32 v59, v46, v47
buffer_store_dwordx4 v[56:59], v251, s[4:7], s53 offen offset:2048 sc1
v_accvgpr_read_b32 v0, a24
v_accvgpr_read_b32 v1, a25
v_accvgpr_read_b32 v2, a26
v_accvgpr_read_b32 v3, a27
v_accvgpr_read_b32 v4, a28
v_accvgpr_read_b32 v5, a29
v_accvgpr_read_b32 v6, a30
v_accvgpr_read_b32 v7, a31
v_cvt_pk_bf16_f32 v16, v0, v1
v_cvt_pk_bf16_f32 v17, v2, v3
v_cvt_pk_bf16_f32 v18, v4, v5
v_cvt_pk_bf16_f32 v19, v6, v7
buffer_store_dwordx4 v[16:19], v251, s[4:7], s53 offen offset:3072 sc1
s_add_u32 s53, s53, s2
v_accvgpr_read_b32 v20, a32
v_accvgpr_read_b32 v21, a33
v_accvgpr_read_b32 v22, a34
v_accvgpr_read_b32 v23, a35
v_accvgpr_read_b32 v24, a36
v_accvgpr_read_b32 v25, a37
v_accvgpr_read_b32 v26, a38
v_accvgpr_read_b32 v27, a39
v_cvt_pk_bf16_f32 v36, v20, v21
v_cvt_pk_bf16_f32 v37, v22, v23
v_cvt_pk_bf16_f32 v38, v24, v25
v_cvt_pk_bf16_f32 v39, v26, v27
buffer_store_dwordx4 v[36:39], v251, s[4:7], s53 offen offset:0 sc1
v_accvgpr_read_b32 v40, a40
v_accvgpr_read_b32 v41, a41
v_accvgpr_read_b32 v42, a42
v_accvgpr_read_b32 v43, a43
v_accvgpr_read_b32 v44, a44
v_accvgpr_read_b32 v45, a45
v_accvgpr_read_b32 v46, a46
v_accvgpr_read_b32 v47, a47
v_cvt_pk_bf16_f32 v56, v40, v41
v_cvt_pk_bf16_f32 v57, v42, v43
v_cvt_pk_bf16_f32 v58, v44, v45
v_cvt_pk_bf16_f32 v59, v46, v47
buffer_store_dwordx4 v[56:59], v251, s[4:7], s53 offen offset:1024 sc1
v_accvgpr_read_b32 v0, a48
v_accvgpr_read_b32 v1, a49
v_accvgpr_read_b32 v2, a50
v_accvgpr_read_b32 v3, a51
v_accvgpr_read_b32 v4, a52
v_accvgpr_read_b32 v5, a53
v_accvgpr_read_b32 v6, a54
v_accvgpr_read_b32 v7, a55
v_cvt_pk_bf16_f32 v16, v0, v1
v_cvt_pk_bf16_f32 v17, v2, v3
v_cvt_pk_bf16_f32 v18, v4, v5
v_cvt_pk_bf16_f32 v19, v6, v7
buffer_store_dwordx4 v[16:19], v251, s[4:7], s53 offen offset:2048 sc1
v_accvgpr_read_b32 v20, a56
v_accvgpr_read_b32 v21, a57
v_accvgpr_read_b32 v22, a58
v_accvgpr_read_b32 v23, a59
v_accvgpr_read_b32 v24, a60
v_accvgpr_read_b32 v25, a61
v_accvgpr_read_b32 v26, a62
v_accvgpr_read_b32 v27, a63
v_cvt_pk_bf16_f32 v36, v20, v21
v_cvt_pk_bf16_f32 v37, v22, v23
v_cvt_pk_bf16_f32 v38, v24, v25
v_cvt_pk_bf16_f32 v39, v26, v27
buffer_store_dwordx4 v[36:39], v251, s[4:7], s53 offen offset:3072 sc1
s_add_u32 s53, s53, s2
v_accvgpr_read_b32 v40, a64
v_accvgpr_read_b32 v41, a65
v_accvgpr_read_b32 v42, a66
v_accvgpr_read_b32 v43, a67
v_accvgpr_read_b32 v44, a68
v_accvgpr_read_b32 v45, a69
v_accvgpr_read_b32 v46, a70
v_accvgpr_read_b32 v47, a71
v_cvt_pk_bf16_f32 v56, v40, v41
v_cvt_pk_bf16_f32 v57, v42, v43
v_cvt_pk_bf16_f32 v58, v44, v45
v_cvt_pk_bf16_f32 v59, v46, v47
buffer_store_dwordx4 v[56:59], v251, s[4:7], s53 offen offset:0 sc1
v_accvgpr_read_b32 v0, a72
v_accvgpr_read_b32 v1, a73
v_accvgpr_read_b32 v2, a74
v_accvgpr_read_b32 v3, a75
v_accvgpr_read_b32 v4, a76
v_accvgpr_read_b32 v5, a77
v_accvgpr_read_b32 v6, a78
v_accvgpr_read_b32 v7, a79
v_cvt_pk_bf16_f32 v16, v0, v1
v_cvt_pk_bf16_f32 v17, v2, v3
v_cvt_pk_bf16_f32 v18, v4, v5
v_cvt_pk_bf16_f32 v19, v6, v7
buffer_store_dwordx4 v[16:19], v251, s[4:7], s53 offen offset:1024 sc1
v_accvgpr_read_b32 v20, a80
v_accvgpr_read_b32 v21, a81
v_accvgpr_read_b32 v22, a82
v_accvgpr_read_b32 v23, a83
v_accvgpr_read_b32 v24, a84
v_accvgpr_read_b32 v25, a85
v_accvgpr_read_b32 v26, a86
v_accvgpr_read_b32 v27, a87
v_cvt_pk_bf16_f32 v36, v20, v21
v_cvt_pk_bf16_f32 v37, v22, v23
v_cvt_pk_bf16_f32 v38, v24, v25
v_cvt_pk_bf16_f32 v39, v26, v27
buffer_store_dwordx4 v[36:39], v251, s[4:7], s53 offen offset:2048 sc1
v_accvgpr_read_b32 v40, a88
v_accvgpr_read_b32 v41, a89
v_accvgpr_read_b32 v42, a90
v_accvgpr_read_b32 v43, a91
v_accvgpr_read_b32 v44, a92
v_accvgpr_read_b32 v45, a93
v_accvgpr_read_b32 v46, a94
v_accvgpr_read_b32 v47, a95
v_cvt_pk_bf16_f32 v56, v40, v41
v_cvt_pk_bf16_f32 v57, v42, v43
v_cvt_pk_bf16_f32 v58, v44, v45
v_cvt_pk_bf16_f32 v59, v46, v47
buffer_store_dwordx4 v[56:59], v251, s[4:7], s53 offen offset:3072 sc1
s_add_u32 s53, s53, s2
v_accvgpr_read_b32 v0, a96
v_accvgpr_read_b32 v1, a97
v_accvgpr_read_b32 v2, a98
v_accvgpr_read_b32 v3, a99
v_accvgpr_read_b32 v4, a100
v_accvgpr_read_b32 v5, a101
v_accvgpr_read_b32 v6, a102
v_accvgpr_read_b32 v7, a103
v_cvt_pk_bf16_f32 v16, v0, v1
v_cvt_pk_bf16_f32 v17, v2, v3
v_cvt_pk_bf16_f32 v18, v4, v5
v_cvt_pk_bf16_f32 v19, v6, v7
buffer_store_dwordx4 v[16:19], v251, s[4:7], s53 offen offset:0 sc1
v_accvgpr_read_b32 v20, a104
v_accvgpr_read_b32 v21, a105
v_accvgpr_read_b32 v22, a106
v_accvgpr_read_b32 v23, a107
v_accvgpr_read_b32 v24, a108
v_accvgpr_read_b32 v25, a109
v_accvgpr_read_b32 v26, a110
v_accvgpr_read_b32 v27, a111
v_cvt_pk_bf16_f32 v36, v20, v21
v_cvt_pk_bf16_f32 v37, v22, v23
v_cvt_pk_bf16_f32 v38, v24, v25
v_cvt_pk_bf16_f32 v39, v26, v27
buffer_store_dwordx4 v[36:39], v251, s[4:7], s53 offen offset:1024 sc1
v_accvgpr_read_b32 v40, a112
v_accvgpr_read_b32 v41, a113
v_accvgpr_read_b32 v42, a114
v_accvgpr_read_b32 v43, a115
v_accvgpr_read_b32 v44, a116
v_accvgpr_read_b32 v45, a117
v_accvgpr_read_b32 v46, a118
v_accvgpr_read_b32 v47, a119
v_cvt_pk_bf16_f32 v56, v40, v41
v_cvt_pk_bf16_f32 v57, v42, v43
v_cvt_pk_bf16_f32 v58, v44, v45
v_cvt_pk_bf16_f32 v59, v46, v47
buffer_store_dwordx4 v[56:59], v251, s[4:7], s53 offen offset:2048 sc1
v_accvgpr_read_b32 v0, a120
v_accvgpr_read_b32 v1, a121
v_accvgpr_read_b32 v2, a122
v_accvgpr_read_b32 v3, a123
v_accvgpr_read_b32 v4, a124
v_accvgpr_read_b32 v5, a125
v_accvgpr_read_b32 v6, a126
v_accvgpr_read_b32 v7, a127
v_cvt_pk_bf16_f32 v16, v0, v1
v_cvt_pk_bf16_f32 v17, v2, v3
v_cvt_pk_bf16_f32 v18, v4, v5
v_cvt_pk_bf16_f32 v19, v6, v7
buffer_store_dwordx4 v[16:19], v251, s[4:7], s53 offen offset:3072 sc1
s_branch main_kernel_w_ee
main_kernel_w_e7:
s_mov_b32 s53, s1
v_accvgpr_read_b32 v0, a0
v_accvgpr_read_b32 v1, a1
v_accvgpr_read_b32 v2, a2
v_accvgpr_read_b32 v3, a3
v_accvgpr_read_b32 v4, a4
v_accvgpr_read_b32 v5, a5
v_accvgpr_read_b32 v6, a6
v_accvgpr_read_b32 v7, a7
v_mul_f32 v0, 0x3e0293ee, v0
v_mul_f32 v1, 0x3e0293ee, v1
v_mul_f32 v2, 0x3e0293ee, v2
v_mul_f32 v3, 0x3e0293ee, v3
v_mul_f32 v4, 0x3e0293ee, v4
v_mul_f32 v5, 0x3e0293ee, v5
v_mul_f32 v6, 0x3e0293ee, v6
v_mul_f32 v7, 0x3e0293ee, v7
v_cvt_pk_bf16_f32 v16, v0, v1
v_cvt_pk_bf16_f32 v17, v2, v3
v_cvt_pk_bf16_f32 v18, v4, v5
v_cvt_pk_bf16_f32 v19, v6, v7
buffer_store_dwordx4 v[16:19], v251, s[4:7], s53 offen offset:0 sc1
v_accvgpr_read_b32 v20, a8
v_accvgpr_read_b32 v21, a9
v_accvgpr_read_b32 v22, a10
v_accvgpr_read_b32 v23, a11
v_accvgpr_read_b32 v24, a12
v_accvgpr_read_b32 v25, a13
v_accvgpr_read_b32 v26, a14
v_accvgpr_read_b32 v27, a15
v_mul_f32 v20, 0x3e0293ee, v20
v_mul_f32 v21, 0x3e0293ee, v21
v_mul_f32 v22, 0x3e0293ee, v22
v_mul_f32 v23, 0x3e0293ee, v23
v_mul_f32 v24, 0x3e0293ee, v24
v_mul_f32 v25, 0x3e0293ee, v25
v_mul_f32 v26, 0x3e0293ee, v26
v_mul_f32 v27, 0x3e0293ee, v27
v_cvt_pk_bf16_f32 v36, v20, v21
v_cvt_pk_bf16_f32 v37, v22, v23
v_cvt_pk_bf16_f32 v38, v24, v25
v_cvt_pk_bf16_f32 v39, v26, v27
buffer_store_dwordx4 v[36:39], v251, s[4:7], s53 offen offset:1024 sc1
v_accvgpr_read_b32 v40, a16
v_accvgpr_read_b32 v41, a17
v_accvgpr_read_b32 v42, a18
v_accvgpr_read_b32 v43, a19
v_accvgpr_read_b32 v44, a20
v_accvgpr_read_b32 v45, a21
v_accvgpr_read_b32 v46, a22
v_accvgpr_read_b32 v47, a23
v_mul_f32 v40, 0x3e0293ee, v40
v_mul_f32 v41, 0x3e0293ee, v41
v_mul_f32 v42, 0x3e0293ee, v42
v_mul_f32 v43, 0x3e0293ee, v43
v_mul_f32 v44, 0x3e0293ee, v44
v_mul_f32 v45, 0x3e0293ee, v45
v_mul_f32 v46, 0x3e0293ee, v46
v_mul_f32 v47, 0x3e0293ee, v47
v_cvt_pk_bf16_f32 v56, v40, v41
v_cvt_pk_bf16_f32 v57, v42, v43
v_cvt_pk_bf16_f32 v58, v44, v45
v_cvt_pk_bf16_f32 v59, v46, v47
buffer_store_dwordx4 v[56:59], v251, s[4:7], s53 offen offset:2048 sc1
v_accvgpr_read_b32 v0, a24
v_accvgpr_read_b32 v1, a25
v_accvgpr_read_b32 v2, a26
v_accvgpr_read_b32 v3, a27
v_accvgpr_read_b32 v4, a28
v_accvgpr_read_b32 v5, a29
v_accvgpr_read_b32 v6, a30
v_accvgpr_read_b32 v7, a31
v_mul_f32 v0, 0x3e0293ee, v0
v_mul_f32 v1, 0x3e0293ee, v1
v_mul_f32 v2, 0x3e0293ee, v2
v_mul_f32 v3, 0x3e0293ee, v3
v_mul_f32 v4, 0x3e0293ee, v4
v_mul_f32 v5, 0x3e0293ee, v5
v_mul_f32 v6, 0x3e0293ee, v6
v_mul_f32 v7, 0x3e0293ee, v7
v_cvt_pk_bf16_f32 v16, v0, v1
v_cvt_pk_bf16_f32 v17, v2, v3
v_cvt_pk_bf16_f32 v18, v4, v5
v_cvt_pk_bf16_f32 v19, v6, v7
buffer_store_dwordx4 v[16:19], v251, s[4:7], s53 offen offset:3072 sc1
s_add_u32 s53, s53, s2
v_accvgpr_read_b32 v20, a32
v_accvgpr_read_b32 v21, a33
v_accvgpr_read_b32 v22, a34
v_accvgpr_read_b32 v23, a35
v_accvgpr_read_b32 v24, a36
v_accvgpr_read_b32 v25, a37
v_accvgpr_read_b32 v26, a38
v_accvgpr_read_b32 v27, a39
v_mul_f32 v20, 0x3e0293ee, v20
v_mul_f32 v21, 0x3e0293ee, v21
v_mul_f32 v22, 0x3e0293ee, v22
v_mul_f32 v23, 0x3e0293ee, v23
v_mul_f32 v24, 0x3e0293ee, v24
v_mul_f32 v25, 0x3e0293ee, v25
v_mul_f32 v26, 0x3e0293ee, v26
v_mul_f32 v27, 0x3e0293ee, v27
v_cvt_pk_bf16_f32 v36, v20, v21
v_cvt_pk_bf16_f32 v37, v22, v23
v_cvt_pk_bf16_f32 v38, v24, v25
v_cvt_pk_bf16_f32 v39, v26, v27
buffer_store_dwordx4 v[36:39], v251, s[4:7], s53 offen offset:0 sc1
v_accvgpr_read_b32 v40, a40
v_accvgpr_read_b32 v41, a41
v_accvgpr_read_b32 v42, a42
v_accvgpr_read_b32 v43, a43
v_accvgpr_read_b32 v44, a44
v_accvgpr_read_b32 v45, a45
v_accvgpr_read_b32 v46, a46
v_accvgpr_read_b32 v47, a47
v_mul_f32 v40, 0x3e0293ee, v40
v_mul_f32 v41, 0x3e0293ee, v41
v_mul_f32 v42, 0x3e0293ee, v42
v_mul_f32 v43, 0x3e0293ee, v43
v_mul_f32 v44, 0x3e0293ee, v44
v_mul_f32 v45, 0x3e0293ee, v45
v_mul_f32 v46, 0x3e0293ee, v46
v_mul_f32 v47, 0x3e0293ee, v47
v_cvt_pk_bf16_f32 v56, v40, v41
v_cvt_pk_bf16_f32 v57, v42, v43
v_cvt_pk_bf16_f32 v58, v44, v45
v_cvt_pk_bf16_f32 v59, v46, v47
buffer_store_dwordx4 v[56:59], v251, s[4:7], s53 offen offset:1024 sc1
v_accvgpr_read_b32 v0, a48
v_accvgpr_read_b32 v1, a49
v_accvgpr_read_b32 v2, a50
v_accvgpr_read_b32 v3, a51
v_accvgpr_read_b32 v4, a52
v_accvgpr_read_b32 v5, a53
v_accvgpr_read_b32 v6, a54
v_accvgpr_read_b32 v7, a55
v_mul_f32 v0, 0x3e0293ee, v0
v_mul_f32 v1, 0x3e0293ee, v1
v_mul_f32 v2, 0x3e0293ee, v2
v_mul_f32 v3, 0x3e0293ee, v3
v_mul_f32 v4, 0x3e0293ee, v4
v_mul_f32 v5, 0x3e0293ee, v5
v_mul_f32 v6, 0x3e0293ee, v6
v_mul_f32 v7, 0x3e0293ee, v7
v_cvt_pk_bf16_f32 v16, v0, v1
v_cvt_pk_bf16_f32 v17, v2, v3
v_cvt_pk_bf16_f32 v18, v4, v5
v_cvt_pk_bf16_f32 v19, v6, v7
buffer_store_dwordx4 v[16:19], v251, s[4:7], s53 offen offset:2048 sc1
v_accvgpr_read_b32 v20, a56
v_accvgpr_read_b32 v21, a57
v_accvgpr_read_b32 v22, a58
v_accvgpr_read_b32 v23, a59
v_accvgpr_read_b32 v24, a60
v_accvgpr_read_b32 v25, a61
v_accvgpr_read_b32 v26, a62
v_accvgpr_read_b32 v27, a63
v_mul_f32 v20, 0x3e0293ee, v20
v_mul_f32 v21, 0x3e0293ee, v21
v_mul_f32 v22, 0x3e0293ee, v22
v_mul_f32 v23, 0x3e0293ee, v23
v_mul_f32 v24, 0x3e0293ee, v24
v_mul_f32 v25, 0x3e0293ee, v25
v_mul_f32 v26, 0x3e0293ee, v26
v_mul_f32 v27, 0x3e0293ee, v27
v_cvt_pk_bf16_f32 v36, v20, v21
v_cvt_pk_bf16_f32 v37, v22, v23
v_cvt_pk_bf16_f32 v38, v24, v25
v_cvt_pk_bf16_f32 v39, v26, v27
buffer_store_dwordx4 v[36:39], v251, s[4:7], s53 offen offset:3072 sc1
s_add_u32 s53, s53, s2
v_accvgpr_read_b32 v40, a64
v_accvgpr_read_b32 v41, a65
v_accvgpr_read_b32 v42, a66
v_accvgpr_read_b32 v43, a67
v_accvgpr_read_b32 v44, a68
v_accvgpr_read_b32 v45, a69
v_accvgpr_read_b32 v46, a70
v_accvgpr_read_b32 v47, a71
v_mul_f32 v40, 0x3e0293ee, v40
v_mul_f32 v41, 0x3e0293ee, v41
v_mul_f32 v42, 0x3e0293ee, v42
v_mul_f32 v43, 0x3e0293ee, v43
v_mul_f32 v44, 0x3e0293ee, v44
v_mul_f32 v45, 0x3e0293ee, v45
v_mul_f32 v46, 0x3e0293ee, v46
v_mul_f32 v47, 0x3e0293ee, v47
v_cvt_pk_bf16_f32 v56, v40, v41
v_cvt_pk_bf16_f32 v57, v42, v43
v_cvt_pk_bf16_f32 v58, v44, v45
v_cvt_pk_bf16_f32 v59, v46, v47
buffer_store_dwordx4 v[56:59], v251, s[4:7], s53 offen offset:0 sc1
v_accvgpr_read_b32 v0, a72
v_accvgpr_read_b32 v1, a73
v_accvgpr_read_b32 v2, a74
v_accvgpr_read_b32 v3, a75
v_accvgpr_read_b32 v4, a76
v_accvgpr_read_b32 v5, a77
v_accvgpr_read_b32 v6, a78
v_accvgpr_read_b32 v7, a79
v_mul_f32 v0, 0x3e0293ee, v0
v_mul_f32 v1, 0x3e0293ee, v1
v_mul_f32 v2, 0x3e0293ee, v2
v_mul_f32 v3, 0x3e0293ee, v3
v_mul_f32 v4, 0x3e0293ee, v4
v_mul_f32 v5, 0x3e0293ee, v5
v_mul_f32 v6, 0x3e0293ee, v6
v_mul_f32 v7, 0x3e0293ee, v7
v_cvt_pk_bf16_f32 v16, v0, v1
v_cvt_pk_bf16_f32 v17, v2, v3
v_cvt_pk_bf16_f32 v18, v4, v5
v_cvt_pk_bf16_f32 v19, v6, v7
buffer_store_dwordx4 v[16:19], v251, s[4:7], s53 offen offset:1024 sc1
v_accvgpr_read_b32 v20, a80
v_accvgpr_read_b32 v21, a81
v_accvgpr_read_b32 v22, a82
v_accvgpr_read_b32 v23, a83
v_accvgpr_read_b32 v24, a84
v_accvgpr_read_b32 v25, a85
v_accvgpr_read_b32 v26, a86
v_accvgpr_read_b32 v27, a87
v_mul_f32 v20, 0x3e0293ee, v20
v_mul_f32 v21, 0x3e0293ee, v21
v_mul_f32 v22, 0x3e0293ee, v22
v_mul_f32 v23, 0x3e0293ee, v23
v_mul_f32 v24, 0x3e0293ee, v24
v_mul_f32 v25, 0x3e0293ee, v25
v_mul_f32 v26, 0x3e0293ee, v26
v_mul_f32 v27, 0x3e0293ee, v27
v_cvt_pk_bf16_f32 v36, v20, v21
v_cvt_pk_bf16_f32 v37, v22, v23
v_cvt_pk_bf16_f32 v38, v24, v25
v_cvt_pk_bf16_f32 v39, v26, v27
buffer_store_dwordx4 v[36:39], v251, s[4:7], s53 offen offset:2048 sc1
v_accvgpr_read_b32 v40, a88
v_accvgpr_read_b32 v41, a89
v_accvgpr_read_b32 v42, a90
v_accvgpr_read_b32 v43, a91
v_accvgpr_read_b32 v44, a92
v_accvgpr_read_b32 v45, a93
v_accvgpr_read_b32 v46, a94
v_accvgpr_read_b32 v47, a95
v_mul_f32 v40, 0x3e0293ee, v40
v_mul_f32 v41, 0x3e0293ee, v41
v_mul_f32 v42, 0x3e0293ee, v42
v_mul_f32 v43, 0x3e0293ee, v43
v_mul_f32 v44, 0x3e0293ee, v44
v_mul_f32 v45, 0x3e0293ee, v45
v_mul_f32 v46, 0x3e0293ee, v46
v_mul_f32 v47, 0x3e0293ee, v47
v_cvt_pk_bf16_f32 v56, v40, v41
v_cvt_pk_bf16_f32 v57, v42, v43
v_cvt_pk_bf16_f32 v58, v44, v45
v_cvt_pk_bf16_f32 v59, v46, v47
buffer_store_dwordx4 v[56:59], v251, s[4:7], s53 offen offset:3072 sc1
s_add_u32 s53, s53, s2
v_accvgpr_read_b32 v0, a96
v_accvgpr_read_b32 v1, a97
v_accvgpr_read_b32 v2, a98
v_accvgpr_read_b32 v3, a99
v_accvgpr_read_b32 v4, a100
v_accvgpr_read_b32 v5, a101
v_accvgpr_read_b32 v6, a102
v_accvgpr_read_b32 v7, a103
v_mul_f32 v0, 0x3e0293ee, v0
v_mul_f32 v1, 0x3e0293ee, v1
v_mul_f32 v2, 0x3e0293ee, v2
v_mul_f32 v3, 0x3e0293ee, v3
v_mul_f32 v4, 0x3e0293ee, v4
v_mul_f32 v5, 0x3e0293ee, v5
v_mul_f32 v6, 0x3e0293ee, v6
v_mul_f32 v7, 0x3e0293ee, v7
v_cvt_pk_bf16_f32 v16, v0, v1
v_cvt_pk_bf16_f32 v17, v2, v3
v_cvt_pk_bf16_f32 v18, v4, v5
v_cvt_pk_bf16_f32 v19, v6, v7
buffer_store_dwordx4 v[16:19], v251, s[4:7], s53 offen offset:0 sc1
v_accvgpr_read_b32 v20, a104
v_accvgpr_read_b32 v21, a105
v_accvgpr_read_b32 v22, a106
v_accvgpr_read_b32 v23, a107
v_accvgpr_read_b32 v24, a108
v_accvgpr_read_b32 v25, a109
v_accvgpr_read_b32 v26, a110
v_accvgpr_read_b32 v27, a111
v_mul_f32 v20, 0x3e0293ee, v20
v_mul_f32 v21, 0x3e0293ee, v21
v_mul_f32 v22, 0x3e0293ee, v22
v_mul_f32 v23, 0x3e0293ee, v23
v_mul_f32 v24, 0x3e0293ee, v24
v_mul_f32 v25, 0x3e0293ee, v25
v_mul_f32 v26, 0x3e0293ee, v26
v_mul_f32 v27, 0x3e0293ee, v27
v_cvt_pk_bf16_f32 v36, v20, v21
v_cvt_pk_bf16_f32 v37, v22, v23
v_cvt_pk_bf16_f32 v38, v24, v25
v_cvt_pk_bf16_f32 v39, v26, v27
buffer_store_dwordx4 v[36:39], v251, s[4:7], s53 offen offset:1024 sc1
v_accvgpr_read_b32 v40, a112
v_accvgpr_read_b32 v41, a113
v_accvgpr_read_b32 v42, a114
v_accvgpr_read_b32 v43, a115
v_accvgpr_read_b32 v44, a116
v_accvgpr_read_b32 v45, a117
v_accvgpr_read_b32 v46, a118
v_accvgpr_read_b32 v47, a119
v_mul_f32 v40, 0x3e0293ee, v40
v_mul_f32 v41, 0x3e0293ee, v41
v_mul_f32 v42, 0x3e0293ee, v42
v_mul_f32 v43, 0x3e0293ee, v43
v_mul_f32 v44, 0x3e0293ee, v44
v_mul_f32 v45, 0x3e0293ee, v45
v_mul_f32 v46, 0x3e0293ee, v46
v_mul_f32 v47, 0x3e0293ee, v47
v_cvt_pk_bf16_f32 v56, v40, v41
v_cvt_pk_bf16_f32 v57, v42, v43
v_cvt_pk_bf16_f32 v58, v44, v45
v_cvt_pk_bf16_f32 v59, v46, v47
buffer_store_dwordx4 v[56:59], v251, s[4:7], s53 offen offset:2048 sc1
v_accvgpr_read_b32 v0, a120
v_accvgpr_read_b32 v1, a121
v_accvgpr_read_b32 v2, a122
v_accvgpr_read_b32 v3, a123
v_accvgpr_read_b32 v4, a124
v_accvgpr_read_b32 v5, a125
v_accvgpr_read_b32 v6, a126
v_accvgpr_read_b32 v7, a127
v_mul_f32 v0, 0x3e0293ee, v0
v_mul_f32 v1, 0x3e0293ee, v1
v_mul_f32 v2, 0x3e0293ee, v2
v_mul_f32 v3, 0x3e0293ee, v3
v_mul_f32 v4, 0x3e0293ee, v4
v_mul_f32 v5, 0x3e0293ee, v5
v_mul_f32 v6, 0x3e0293ee, v6
v_mul_f32 v7, 0x3e0293ee, v7
v_cvt_pk_bf16_f32 v16, v0, v1
v_cvt_pk_bf16_f32 v17, v2, v3
v_cvt_pk_bf16_f32 v18, v4, v5
v_cvt_pk_bf16_f32 v19, v6, v7
buffer_store_dwordx4 v[16:19], v251, s[4:7], s53 offen offset:3072 sc1
s_branch main_kernel_w_ee
main_kernel_w_e8:
s_mov_b32 s53, s1
v_accvgpr_read_b32 v0, a0
v_accvgpr_read_b32 v1, a1
v_accvgpr_read_b32 v2, a2
v_accvgpr_read_b32 v3, a3
v_accvgpr_read_b32 v4, a32
v_accvgpr_read_b32 v5, a33
v_accvgpr_read_b32 v6, a34
v_accvgpr_read_b32 v7, a35
v_cvt_pk_bf16_f32 v8, v0, v1
v_cvt_pk_bf16_f32 v9, v2, v3
v_cvt_pk_bf16_f32 v10, v4, v5
v_cvt_pk_bf16_f32 v11, v6, v7
buffer_store_dwordx4 v[8:11], v251, s[4:7], s53 offen offset:0 sc1
v_accvgpr_read_b32 v16, a4
v_accvgpr_read_b32 v17, a5
v_accvgpr_read_b32 v18, a6
v_accvgpr_read_b32 v19, a7
v_accvgpr_read_b32 v20, a36
v_accvgpr_read_b32 v21, a37
v_accvgpr_read_b32 v22, a38
v_accvgpr_read_b32 v23, a39
v_cvt_pk_bf16_f32 v24, v16, v17
v_cvt_pk_bf16_f32 v25, v18, v19
v_cvt_pk_bf16_f32 v26, v20, v21
v_cvt_pk_bf16_f32 v27, v22, v23
buffer_store_dwordx4 v[24:27], v251, s[4:7], s53 offen offset:1024 sc1
v_accvgpr_read_b32 v32, a8
v_accvgpr_read_b32 v33, a9
v_accvgpr_read_b32 v34, a10
v_accvgpr_read_b32 v35, a11
v_accvgpr_read_b32 v36, a40
v_accvgpr_read_b32 v37, a41
v_accvgpr_read_b32 v38, a42
v_accvgpr_read_b32 v39, a43
v_cvt_pk_bf16_f32 v40, v32, v33
v_cvt_pk_bf16_f32 v41, v34, v35
v_cvt_pk_bf16_f32 v42, v36, v37
v_cvt_pk_bf16_f32 v43, v38, v39
buffer_store_dwordx4 v[40:43], v251, s[4:7], s53 offen offset:2048 sc1
v_accvgpr_read_b32 v48, a12
v_accvgpr_read_b32 v49, a13
v_accvgpr_read_b32 v50, a14
v_accvgpr_read_b32 v51, a15
v_accvgpr_read_b32 v52, a44
v_accvgpr_read_b32 v53, a45
v_accvgpr_read_b32 v54, a46
v_accvgpr_read_b32 v55, a47
v_cvt_pk_bf16_f32 v56, v48, v49
v_cvt_pk_bf16_f32 v57, v50, v51
v_cvt_pk_bf16_f32 v58, v52, v53
v_cvt_pk_bf16_f32 v59, v54, v55
buffer_store_dwordx4 v[56:59], v251, s[4:7], s53 offen offset:3072 sc1
s_add_u32 s53, s53, 4096
v_accvgpr_read_b32 v0, a16
v_accvgpr_read_b32 v1, a17
v_accvgpr_read_b32 v2, a18
v_accvgpr_read_b32 v3, a19
v_accvgpr_read_b32 v4, a48
v_accvgpr_read_b32 v5, a49
v_accvgpr_read_b32 v6, a50
v_accvgpr_read_b32 v7, a51
v_cvt_pk_bf16_f32 v8, v0, v1
v_cvt_pk_bf16_f32 v9, v2, v3
v_cvt_pk_bf16_f32 v10, v4, v5
v_cvt_pk_bf16_f32 v11, v6, v7
buffer_store_dwordx4 v[8:11], v251, s[4:7], s53 offen offset:0 sc1
v_accvgpr_read_b32 v16, a20
v_accvgpr_read_b32 v17, a21
v_accvgpr_read_b32 v18, a22
v_accvgpr_read_b32 v19, a23
v_accvgpr_read_b32 v20, a52
v_accvgpr_read_b32 v21, a53
v_accvgpr_read_b32 v22, a54
v_accvgpr_read_b32 v23, a55
v_cvt_pk_bf16_f32 v24, v16, v17
v_cvt_pk_bf16_f32 v25, v18, v19
v_cvt_pk_bf16_f32 v26, v20, v21
v_cvt_pk_bf16_f32 v27, v22, v23
buffer_store_dwordx4 v[24:27], v251, s[4:7], s53 offen offset:1024 sc1
v_accvgpr_read_b32 v32, a24
v_accvgpr_read_b32 v33, a25
v_accvgpr_read_b32 v34, a26
v_accvgpr_read_b32 v35, a27
v_accvgpr_read_b32 v36, a56
v_accvgpr_read_b32 v37, a57
v_accvgpr_read_b32 v38, a58
v_accvgpr_read_b32 v39, a59
v_cvt_pk_bf16_f32 v40, v32, v33
v_cvt_pk_bf16_f32 v41, v34, v35
v_cvt_pk_bf16_f32 v42, v36, v37
v_cvt_pk_bf16_f32 v43, v38, v39
buffer_store_dwordx4 v[40:43], v251, s[4:7], s53 offen offset:2048 sc1
v_accvgpr_read_b32 v48, a28
v_accvgpr_read_b32 v49, a29
v_accvgpr_read_b32 v50, a30
v_accvgpr_read_b32 v51, a31
v_accvgpr_read_b32 v52, a60
v_accvgpr_read_b32 v53, a61
v_accvgpr_read_b32 v54, a62
v_accvgpr_read_b32 v55, a63
v_cvt_pk_bf16_f32 v56, v48, v49
v_cvt_pk_bf16_f32 v57, v50, v51
v_cvt_pk_bf16_f32 v58, v52, v53
v_cvt_pk_bf16_f32 v59, v54, v55
buffer_store_dwordx4 v[56:59], v251, s[4:7], s53 offen offset:3072 sc1
s_add_u32 s53, s53, 258048
v_accvgpr_read_b32 v0, a64
v_accvgpr_read_b32 v1, a65
v_accvgpr_read_b32 v2, a66
v_accvgpr_read_b32 v3, a67
v_accvgpr_read_b32 v4, a96
v_accvgpr_read_b32 v5, a97
v_accvgpr_read_b32 v6, a98
v_accvgpr_read_b32 v7, a99
v_cvt_pk_bf16_f32 v8, v0, v1
v_cvt_pk_bf16_f32 v9, v2, v3
v_cvt_pk_bf16_f32 v10, v4, v5
v_cvt_pk_bf16_f32 v11, v6, v7
buffer_store_dwordx4 v[8:11], v251, s[4:7], s53 offen offset:0 sc1
v_accvgpr_read_b32 v16, a68
v_accvgpr_read_b32 v17, a69
v_accvgpr_read_b32 v18, a70
v_accvgpr_read_b32 v19, a71
v_accvgpr_read_b32 v20, a100
v_accvgpr_read_b32 v21, a101
v_accvgpr_read_b32 v22, a102
v_accvgpr_read_b32 v23, a103
v_cvt_pk_bf16_f32 v24, v16, v17
v_cvt_pk_bf16_f32 v25, v18, v19
v_cvt_pk_bf16_f32 v26, v20, v21
v_cvt_pk_bf16_f32 v27, v22, v23
buffer_store_dwordx4 v[24:27], v251, s[4:7], s53 offen offset:1024 sc1
v_accvgpr_read_b32 v32, a72
v_accvgpr_read_b32 v33, a73
v_accvgpr_read_b32 v34, a74
v_accvgpr_read_b32 v35, a75
v_accvgpr_read_b32 v36, a104
v_accvgpr_read_b32 v37, a105
v_accvgpr_read_b32 v38, a106
v_accvgpr_read_b32 v39, a107
v_cvt_pk_bf16_f32 v40, v32, v33
v_cvt_pk_bf16_f32 v41, v34, v35
v_cvt_pk_bf16_f32 v42, v36, v37
v_cvt_pk_bf16_f32 v43, v38, v39
buffer_store_dwordx4 v[40:43], v251, s[4:7], s53 offen offset:2048 sc1
v_accvgpr_read_b32 v48, a76
v_accvgpr_read_b32 v49, a77
v_accvgpr_read_b32 v50, a78
v_accvgpr_read_b32 v51, a79
v_accvgpr_read_b32 v52, a108
v_accvgpr_read_b32 v53, a109
v_accvgpr_read_b32 v54, a110
v_accvgpr_read_b32 v55, a111
v_cvt_pk_bf16_f32 v56, v48, v49
v_cvt_pk_bf16_f32 v57, v50, v51
v_cvt_pk_bf16_f32 v58, v52, v53
v_cvt_pk_bf16_f32 v59, v54, v55
buffer_store_dwordx4 v[56:59], v251, s[4:7], s53 offen offset:3072 sc1
s_add_u32 s53, s53, 4096
v_accvgpr_read_b32 v0, a80
v_accvgpr_read_b32 v1, a81
v_accvgpr_read_b32 v2, a82
v_accvgpr_read_b32 v3, a83
v_accvgpr_read_b32 v4, a112
v_accvgpr_read_b32 v5, a113
v_accvgpr_read_b32 v6, a114
v_accvgpr_read_b32 v7, a115
v_cvt_pk_bf16_f32 v8, v0, v1
v_cvt_pk_bf16_f32 v9, v2, v3
v_cvt_pk_bf16_f32 v10, v4, v5
v_cvt_pk_bf16_f32 v11, v6, v7
buffer_store_dwordx4 v[8:11], v251, s[4:7], s53 offen offset:0 sc1
v_accvgpr_read_b32 v16, a84
v_accvgpr_read_b32 v17, a85
v_accvgpr_read_b32 v18, a86
v_accvgpr_read_b32 v19, a87
v_accvgpr_read_b32 v20, a116
v_accvgpr_read_b32 v21, a117
v_accvgpr_read_b32 v22, a118
v_accvgpr_read_b32 v23, a119
v_cvt_pk_bf16_f32 v24, v16, v17
v_cvt_pk_bf16_f32 v25, v18, v19
v_cvt_pk_bf16_f32 v26, v20, v21
v_cvt_pk_bf16_f32 v27, v22, v23
buffer_store_dwordx4 v[24:27], v251, s[4:7], s53 offen offset:1024 sc1
v_accvgpr_read_b32 v32, a88
v_accvgpr_read_b32 v33, a89
v_accvgpr_read_b32 v34, a90
v_accvgpr_read_b32 v35, a91
v_accvgpr_read_b32 v36, a120
v_accvgpr_read_b32 v37, a121
v_accvgpr_read_b32 v38, a122
v_accvgpr_read_b32 v39, a123
v_cvt_pk_bf16_f32 v40, v32, v33
v_cvt_pk_bf16_f32 v41, v34, v35
v_cvt_pk_bf16_f32 v42, v36, v37
v_cvt_pk_bf16_f32 v43, v38, v39
buffer_store_dwordx4 v[40:43], v251, s[4:7], s53 offen offset:2048 sc1
v_accvgpr_read_b32 v48, a92
v_accvgpr_read_b32 v49, a93
v_accvgpr_read_b32 v50, a94
v_accvgpr_read_b32 v51, a95
v_accvgpr_read_b32 v52, a124
v_accvgpr_read_b32 v53, a125
v_accvgpr_read_b32 v54, a126
v_accvgpr_read_b32 v55, a127
v_cvt_pk_bf16_f32 v56, v48, v49
v_cvt_pk_bf16_f32 v57, v50, v51
v_cvt_pk_bf16_f32 v58, v52, v53
v_cvt_pk_bf16_f32 v59, v54, v55
buffer_store_dwordx4 v[56:59], v251, s[4:7], s53 offen offset:3072 sc1
s_add_u32 s53, s53, 258048
s_branch main_kernel_w_ee
main_kernel_w_e9:
s_mov_b32 s53, s1
v_accvgpr_read_b32 v0, a0
v_accvgpr_read_b32 v1, a1
v_accvgpr_read_b32 v2, a2
v_accvgpr_read_b32 v3, a3
v_accvgpr_read_b32 v4, a4
v_accvgpr_read_b32 v5, a5
v_accvgpr_read_b32 v6, a6
v_accvgpr_read_b32 v7, a7
v_pk_mul_f32 v[8:9], v[0:1], v[0:1]
v_pk_mul_f32 v[10:11], v[2:3], v[2:3]
v_pk_mul_f32 v[12:13], v[4:5], v[4:5]
v_pk_mul_f32 v[14:15], v[6:7], v[6:7]
v_pk_fma_f32 v[8:9], v[8:9], v[242:243], v[240:241]
v_pk_fma_f32 v[10:11], v[10:11], v[242:243], v[240:241]
v_pk_fma_f32 v[12:13], v[12:13], v[242:243], v[240:241]
v_pk_fma_f32 v[14:15], v[14:15], v[242:243], v[240:241]
v_pk_mul_f32 v[8:9], v[8:9], v[0:1]
v_pk_mul_f32 v[10:11], v[10:11], v[2:3]
v_pk_mul_f32 v[12:13], v[12:13], v[4:5]
v_pk_mul_f32 v[14:15], v[14:15], v[6:7]
v_exp_f32 v8, v8
v_exp_f32 v9, v9
v_exp_f32 v10, v10
v_exp_f32 v11, v11
v_exp_f32 v12, v12
v_exp_f32 v13, v13
v_exp_f32 v14, v14
v_exp_f32 v15, v15
v_pk_add_f32 v[8:9], v[8:9], v[244:245]
v_pk_add_f32 v[10:11], v[10:11], v[244:245]
v_pk_add_f32 v[12:13], v[12:13], v[244:245]
v_pk_add_f32 v[14:15], v[14:15], v[244:245]
v_rcp_f32 v8, v8
v_rcp_f32 v9, v9
v_rcp_f32 v10, v10
v_rcp_f32 v11, v11
v_rcp_f32 v12, v12
v_rcp_f32 v13, v13
v_rcp_f32 v14, v14
v_rcp_f32 v15, v15
v_pk_mul_f32 v[0:1], v[8:9], v[0:1]
v_pk_mul_f32 v[2:3], v[10:11], v[2:3]
v_pk_mul_f32 v[4:5], v[12:13], v[4:5]
v_pk_mul_f32 v[6:7], v[14:15], v[6:7]
v_cvt_pk_bf16_f32 v16, v0, v1
v_cvt_pk_bf16_f32 v17, v2, v3
v_cvt_pk_bf16_f32 v18, v4, v5
v_cvt_pk_bf16_f32 v19, v6, v7
buffer_store_dwordx4 v[16:19], v145, s[4:7], s53 offen offset:0 sc1
v_accvgpr_read_b32 v20, a8
v_accvgpr_read_b32 v21, a9
v_accvgpr_read_b32 v22, a10
v_accvgpr_read_b32 v23, a11
v_accvgpr_read_b32 v24, a12
v_accvgpr_read_b32 v25, a13
v_accvgpr_read_b32 v26, a14
v_accvgpr_read_b32 v27, a15
v_pk_mul_f32 v[28:29], v[20:21], v[20:21]
v_pk_mul_f32 v[30:31], v[22:23], v[22:23]
v_pk_mul_f32 v[32:33], v[24:25], v[24:25]
v_pk_mul_f32 v[34:35], v[26:27], v[26:27]
v_pk_fma_f32 v[28:29], v[28:29], v[242:243], v[240:241]
v_pk_fma_f32 v[30:31], v[30:31], v[242:243], v[240:241]
v_pk_fma_f32 v[32:33], v[32:33], v[242:243], v[240:241]
v_pk_fma_f32 v[34:35], v[34:35], v[242:243], v[240:241]
v_pk_mul_f32 v[28:29], v[28:29], v[20:21]
v_pk_mul_f32 v[30:31], v[30:31], v[22:23]
v_pk_mul_f32 v[32:33], v[32:33], v[24:25]
v_pk_mul_f32 v[34:35], v[34:35], v[26:27]
v_exp_f32 v28, v28
v_exp_f32 v29, v29
v_exp_f32 v30, v30
v_exp_f32 v31, v31
v_exp_f32 v32, v32
v_exp_f32 v33, v33
v_exp_f32 v34, v34
v_exp_f32 v35, v35
v_pk_add_f32 v[28:29], v[28:29], v[244:245]
v_pk_add_f32 v[30:31], v[30:31], v[244:245]
v_pk_add_f32 v[32:33], v[32:33], v[244:245]
v_pk_add_f32 v[34:35], v[34:35], v[244:245]
v_rcp_f32 v28, v28
v_rcp_f32 v29, v29
v_rcp_f32 v30, v30
v_rcp_f32 v31, v31
v_rcp_f32 v32, v32
v_rcp_f32 v33, v33
v_rcp_f32 v34, v34
v_rcp_f32 v35, v35
v_pk_mul_f32 v[20:21], v[28:29], v[20:21]
v_pk_mul_f32 v[22:23], v[30:31], v[22:23]
v_pk_mul_f32 v[24:25], v[32:33], v[24:25]
v_pk_mul_f32 v[26:27], v[34:35], v[26:27]
v_cvt_pk_bf16_f32 v36, v20, v21
v_cvt_pk_bf16_f32 v37, v22, v23
v_cvt_pk_bf16_f32 v38, v24, v25
v_cvt_pk_bf16_f32 v39, v26, v27
buffer_store_dwordx4 v[36:39], v145, s[4:7], s53 offen offset:1024 sc1
v_accvgpr_read_b32 v40, a16
v_accvgpr_read_b32 v41, a17
v_accvgpr_read_b32 v42, a18
v_accvgpr_read_b32 v43, a19
v_accvgpr_read_b32 v44, a20
v_accvgpr_read_b32 v45, a21
v_accvgpr_read_b32 v46, a22
v_accvgpr_read_b32 v47, a23
v_pk_mul_f32 v[48:49], v[40:41], v[40:41]
v_pk_mul_f32 v[50:51], v[42:43], v[42:43]
v_pk_mul_f32 v[52:53], v[44:45], v[44:45]
v_pk_mul_f32 v[54:55], v[46:47], v[46:47]
v_pk_fma_f32 v[48:49], v[48:49], v[242:243], v[240:241]
v_pk_fma_f32 v[50:51], v[50:51], v[242:243], v[240:241]
v_pk_fma_f32 v[52:53], v[52:53], v[242:243], v[240:241]
v_pk_fma_f32 v[54:55], v[54:55], v[242:243], v[240:241]
v_pk_mul_f32 v[48:49], v[48:49], v[40:41]
v_pk_mul_f32 v[50:51], v[50:51], v[42:43]
v_pk_mul_f32 v[52:53], v[52:53], v[44:45]
v_pk_mul_f32 v[54:55], v[54:55], v[46:47]
v_exp_f32 v48, v48
v_exp_f32 v49, v49
v_exp_f32 v50, v50
v_exp_f32 v51, v51
v_exp_f32 v52, v52
v_exp_f32 v53, v53
v_exp_f32 v54, v54
v_exp_f32 v55, v55
v_pk_add_f32 v[48:49], v[48:49], v[244:245]
v_pk_add_f32 v[50:51], v[50:51], v[244:245]
v_pk_add_f32 v[52:53], v[52:53], v[244:245]
v_pk_add_f32 v[54:55], v[54:55], v[244:245]
v_rcp_f32 v48, v48
v_rcp_f32 v49, v49
v_rcp_f32 v50, v50
v_rcp_f32 v51, v51
v_rcp_f32 v52, v52
v_rcp_f32 v53, v53
v_rcp_f32 v54, v54
v_rcp_f32 v55, v55
v_pk_mul_f32 v[40:41], v[48:49], v[40:41]
v_pk_mul_f32 v[42:43], v[50:51], v[42:43]
v_pk_mul_f32 v[44:45], v[52:53], v[44:45]
v_pk_mul_f32 v[46:47], v[54:55], v[46:47]
v_cvt_pk_bf16_f32 v56, v40, v41
v_cvt_pk_bf16_f32 v57, v42, v43
v_cvt_pk_bf16_f32 v58, v44, v45
v_cvt_pk_bf16_f32 v59, v46, v47
buffer_store_dwordx4 v[56:59], v145, s[4:7], s53 offen offset:2048 sc1
v_accvgpr_read_b32 v0, a24
v_accvgpr_read_b32 v1, a25
v_accvgpr_read_b32 v2, a26
v_accvgpr_read_b32 v3, a27
v_accvgpr_read_b32 v4, a28
v_accvgpr_read_b32 v5, a29
v_accvgpr_read_b32 v6, a30
v_accvgpr_read_b32 v7, a31
v_pk_mul_f32 v[8:9], v[0:1], v[0:1]
v_pk_mul_f32 v[10:11], v[2:3], v[2:3]
v_pk_mul_f32 v[12:13], v[4:5], v[4:5]
v_pk_mul_f32 v[14:15], v[6:7], v[6:7]
v_pk_fma_f32 v[8:9], v[8:9], v[242:243], v[240:241]
v_pk_fma_f32 v[10:11], v[10:11], v[242:243], v[240:241]
v_pk_fma_f32 v[12:13], v[12:13], v[242:243], v[240:241]
v_pk_fma_f32 v[14:15], v[14:15], v[242:243], v[240:241]
v_pk_mul_f32 v[8:9], v[8:9], v[0:1]
v_pk_mul_f32 v[10:11], v[10:11], v[2:3]
v_pk_mul_f32 v[12:13], v[12:13], v[4:5]
v_pk_mul_f32 v[14:15], v[14:15], v[6:7]
v_exp_f32 v8, v8
v_exp_f32 v9, v9
v_exp_f32 v10, v10
v_exp_f32 v11, v11
v_exp_f32 v12, v12
v_exp_f32 v13, v13
v_exp_f32 v14, v14
v_exp_f32 v15, v15
v_pk_add_f32 v[8:9], v[8:9], v[244:245]
v_pk_add_f32 v[10:11], v[10:11], v[244:245]
v_pk_add_f32 v[12:13], v[12:13], v[244:245]
v_pk_add_f32 v[14:15], v[14:15], v[244:245]
v_rcp_f32 v8, v8
v_rcp_f32 v9, v9
v_rcp_f32 v10, v10
v_rcp_f32 v11, v11
v_rcp_f32 v12, v12
v_rcp_f32 v13, v13
v_rcp_f32 v14, v14
v_rcp_f32 v15, v15
v_pk_mul_f32 v[0:1], v[8:9], v[0:1]
v_pk_mul_f32 v[2:3], v[10:11], v[2:3]
v_pk_mul_f32 v[4:5], v[12:13], v[4:5]
v_pk_mul_f32 v[6:7], v[14:15], v[6:7]
v_cvt_pk_bf16_f32 v16, v0, v1
v_cvt_pk_bf16_f32 v17, v2, v3
v_cvt_pk_bf16_f32 v18, v4, v5
v_cvt_pk_bf16_f32 v19, v6, v7
buffer_store_dwordx4 v[16:19], v145, s[4:7], s53 offen offset:3072 sc1
s_add_u32 s53, s53, s2
v_accvgpr_read_b32 v20, a32
v_accvgpr_read_b32 v21, a33
v_accvgpr_read_b32 v22, a34
v_accvgpr_read_b32 v23, a35
v_accvgpr_read_b32 v24, a36
v_accvgpr_read_b32 v25, a37
v_accvgpr_read_b32 v26, a38
v_accvgpr_read_b32 v27, a39
v_pk_mul_f32 v[28:29], v[20:21], v[20:21]
v_pk_mul_f32 v[30:31], v[22:23], v[22:23]
v_pk_mul_f32 v[32:33], v[24:25], v[24:25]
v_pk_mul_f32 v[34:35], v[26:27], v[26:27]
v_pk_fma_f32 v[28:29], v[28:29], v[242:243], v[240:241]
v_pk_fma_f32 v[30:31], v[30:31], v[242:243], v[240:241]
v_pk_fma_f32 v[32:33], v[32:33], v[242:243], v[240:241]
v_pk_fma_f32 v[34:35], v[34:35], v[242:243], v[240:241]
v_pk_mul_f32 v[28:29], v[28:29], v[20:21]
v_pk_mul_f32 v[30:31], v[30:31], v[22:23]
v_pk_mul_f32 v[32:33], v[32:33], v[24:25]
v_pk_mul_f32 v[34:35], v[34:35], v[26:27]
v_exp_f32 v28, v28
v_exp_f32 v29, v29
v_exp_f32 v30, v30
v_exp_f32 v31, v31
v_exp_f32 v32, v32
v_exp_f32 v33, v33
v_exp_f32 v34, v34
v_exp_f32 v35, v35
v_pk_add_f32 v[28:29], v[28:29], v[244:245]
v_pk_add_f32 v[30:31], v[30:31], v[244:245]
v_pk_add_f32 v[32:33], v[32:33], v[244:245]
v_pk_add_f32 v[34:35], v[34:35], v[244:245]
v_rcp_f32 v28, v28
v_rcp_f32 v29, v29
v_rcp_f32 v30, v30
v_rcp_f32 v31, v31
v_rcp_f32 v32, v32
v_rcp_f32 v33, v33
v_rcp_f32 v34, v34
v_rcp_f32 v35, v35
v_pk_mul_f32 v[20:21], v[28:29], v[20:21]
v_pk_mul_f32 v[22:23], v[30:31], v[22:23]
v_pk_mul_f32 v[24:25], v[32:33], v[24:25]
v_pk_mul_f32 v[26:27], v[34:35], v[26:27]
v_cvt_pk_bf16_f32 v36, v20, v21
v_cvt_pk_bf16_f32 v37, v22, v23
v_cvt_pk_bf16_f32 v38, v24, v25
v_cvt_pk_bf16_f32 v39, v26, v27
buffer_store_dwordx4 v[36:39], v145, s[4:7], s53 offen offset:0 sc1
v_accvgpr_read_b32 v40, a40
v_accvgpr_read_b32 v41, a41
v_accvgpr_read_b32 v42, a42
v_accvgpr_read_b32 v43, a43
v_accvgpr_read_b32 v44, a44
v_accvgpr_read_b32 v45, a45
v_accvgpr_read_b32 v46, a46
v_accvgpr_read_b32 v47, a47
v_pk_mul_f32 v[48:49], v[40:41], v[40:41]
v_pk_mul_f32 v[50:51], v[42:43], v[42:43]
v_pk_mul_f32 v[52:53], v[44:45], v[44:45]
v_pk_mul_f32 v[54:55], v[46:47], v[46:47]
v_pk_fma_f32 v[48:49], v[48:49], v[242:243], v[240:241]
v_pk_fma_f32 v[50:51], v[50:51], v[242:243], v[240:241]
v_pk_fma_f32 v[52:53], v[52:53], v[242:243], v[240:241]
v_pk_fma_f32 v[54:55], v[54:55], v[242:243], v[240:241]
v_pk_mul_f32 v[48:49], v[48:49], v[40:41]
v_pk_mul_f32 v[50:51], v[50:51], v[42:43]
v_pk_mul_f32 v[52:53], v[52:53], v[44:45]
v_pk_mul_f32 v[54:55], v[54:55], v[46:47]
v_exp_f32 v48, v48
v_exp_f32 v49, v49
v_exp_f32 v50, v50
v_exp_f32 v51, v51
v_exp_f32 v52, v52
v_exp_f32 v53, v53
v_exp_f32 v54, v54
v_exp_f32 v55, v55
v_pk_add_f32 v[48:49], v[48:49], v[244:245]
v_pk_add_f32 v[50:51], v[50:51], v[244:245]
v_pk_add_f32 v[52:53], v[52:53], v[244:245]
v_pk_add_f32 v[54:55], v[54:55], v[244:245]
v_rcp_f32 v48, v48
v_rcp_f32 v49, v49
v_rcp_f32 v50, v50
v_rcp_f32 v51, v51
v_rcp_f32 v52, v52
v_rcp_f32 v53, v53
v_rcp_f32 v54, v54
v_rcp_f32 v55, v55
v_pk_mul_f32 v[40:41], v[48:49], v[40:41]
v_pk_mul_f32 v[42:43], v[50:51], v[42:43]
v_pk_mul_f32 v[44:45], v[52:53], v[44:45]
v_pk_mul_f32 v[46:47], v[54:55], v[46:47]
v_cvt_pk_bf16_f32 v56, v40, v41
v_cvt_pk_bf16_f32 v57, v42, v43
v_cvt_pk_bf16_f32 v58, v44, v45
v_cvt_pk_bf16_f32 v59, v46, v47
buffer_store_dwordx4 v[56:59], v145, s[4:7], s53 offen offset:1024 sc1
v_accvgpr_read_b32 v0, a48
v_accvgpr_read_b32 v1, a49
v_accvgpr_read_b32 v2, a50
v_accvgpr_read_b32 v3, a51
v_accvgpr_read_b32 v4, a52
v_accvgpr_read_b32 v5, a53
v_accvgpr_read_b32 v6, a54
v_accvgpr_read_b32 v7, a55
v_pk_mul_f32 v[8:9], v[0:1], v[0:1]
v_pk_mul_f32 v[10:11], v[2:3], v[2:3]
v_pk_mul_f32 v[12:13], v[4:5], v[4:5]
v_pk_mul_f32 v[14:15], v[6:7], v[6:7]
v_pk_fma_f32 v[8:9], v[8:9], v[242:243], v[240:241]
v_pk_fma_f32 v[10:11], v[10:11], v[242:243], v[240:241]
v_pk_fma_f32 v[12:13], v[12:13], v[242:243], v[240:241]
v_pk_fma_f32 v[14:15], v[14:15], v[242:243], v[240:241]
v_pk_mul_f32 v[8:9], v[8:9], v[0:1]
v_pk_mul_f32 v[10:11], v[10:11], v[2:3]
v_pk_mul_f32 v[12:13], v[12:13], v[4:5]
v_pk_mul_f32 v[14:15], v[14:15], v[6:7]
v_exp_f32 v8, v8
v_exp_f32 v9, v9
v_exp_f32 v10, v10
v_exp_f32 v11, v11
v_exp_f32 v12, v12
v_exp_f32 v13, v13
v_exp_f32 v14, v14
v_exp_f32 v15, v15
v_pk_add_f32 v[8:9], v[8:9], v[244:245]
v_pk_add_f32 v[10:11], v[10:11], v[244:245]
v_pk_add_f32 v[12:13], v[12:13], v[244:245]
v_pk_add_f32 v[14:15], v[14:15], v[244:245]
v_rcp_f32 v8, v8
v_rcp_f32 v9, v9
v_rcp_f32 v10, v10
v_rcp_f32 v11, v11
v_rcp_f32 v12, v12
v_rcp_f32 v13, v13
v_rcp_f32 v14, v14
v_rcp_f32 v15, v15
v_pk_mul_f32 v[0:1], v[8:9], v[0:1]
v_pk_mul_f32 v[2:3], v[10:11], v[2:3]
v_pk_mul_f32 v[4:5], v[12:13], v[4:5]
v_pk_mul_f32 v[6:7], v[14:15], v[6:7]
v_cvt_pk_bf16_f32 v16, v0, v1
v_cvt_pk_bf16_f32 v17, v2, v3
v_cvt_pk_bf16_f32 v18, v4, v5
v_cvt_pk_bf16_f32 v19, v6, v7
buffer_store_dwordx4 v[16:19], v145, s[4:7], s53 offen offset:2048 sc1
v_accvgpr_read_b32 v20, a56
v_accvgpr_read_b32 v21, a57
v_accvgpr_read_b32 v22, a58
v_accvgpr_read_b32 v23, a59
v_accvgpr_read_b32 v24, a60
v_accvgpr_read_b32 v25, a61
v_accvgpr_read_b32 v26, a62
v_accvgpr_read_b32 v27, a63
v_pk_mul_f32 v[28:29], v[20:21], v[20:21]
v_pk_mul_f32 v[30:31], v[22:23], v[22:23]
v_pk_mul_f32 v[32:33], v[24:25], v[24:25]
v_pk_mul_f32 v[34:35], v[26:27], v[26:27]
v_pk_fma_f32 v[28:29], v[28:29], v[242:243], v[240:241]
v_pk_fma_f32 v[30:31], v[30:31], v[242:243], v[240:241]
v_pk_fma_f32 v[32:33], v[32:33], v[242:243], v[240:241]
v_pk_fma_f32 v[34:35], v[34:35], v[242:243], v[240:241]
v_pk_mul_f32 v[28:29], v[28:29], v[20:21]
v_pk_mul_f32 v[30:31], v[30:31], v[22:23]
v_pk_mul_f32 v[32:33], v[32:33], v[24:25]
v_pk_mul_f32 v[34:35], v[34:35], v[26:27]
v_exp_f32 v28, v28
v_exp_f32 v29, v29
v_exp_f32 v30, v30
v_exp_f32 v31, v31
v_exp_f32 v32, v32
v_exp_f32 v33, v33
v_exp_f32 v34, v34
v_exp_f32 v35, v35
v_pk_add_f32 v[28:29], v[28:29], v[244:245]
v_pk_add_f32 v[30:31], v[30:31], v[244:245]
v_pk_add_f32 v[32:33], v[32:33], v[244:245]
v_pk_add_f32 v[34:35], v[34:35], v[244:245]
v_rcp_f32 v28, v28
v_rcp_f32 v29, v29
v_rcp_f32 v30, v30
v_rcp_f32 v31, v31
v_rcp_f32 v32, v32
v_rcp_f32 v33, v33
v_rcp_f32 v34, v34
v_rcp_f32 v35, v35
v_pk_mul_f32 v[20:21], v[28:29], v[20:21]
v_pk_mul_f32 v[22:23], v[30:31], v[22:23]
v_pk_mul_f32 v[24:25], v[32:33], v[24:25]
v_pk_mul_f32 v[26:27], v[34:35], v[26:27]
v_cvt_pk_bf16_f32 v36, v20, v21
v_cvt_pk_bf16_f32 v37, v22, v23
v_cvt_pk_bf16_f32 v38, v24, v25
v_cvt_pk_bf16_f32 v39, v26, v27
buffer_store_dwordx4 v[36:39], v145, s[4:7], s53 offen offset:3072 sc1
s_add_u32 s53, s53, s2
v_accvgpr_read_b32 v40, a64
v_accvgpr_read_b32 v41, a65
v_accvgpr_read_b32 v42, a66
v_accvgpr_read_b32 v43, a67
v_accvgpr_read_b32 v44, a68
v_accvgpr_read_b32 v45, a69
v_accvgpr_read_b32 v46, a70
v_accvgpr_read_b32 v47, a71
v_pk_mul_f32 v[48:49], v[40:41], v[40:41]
v_pk_mul_f32 v[50:51], v[42:43], v[42:43]
v_pk_mul_f32 v[52:53], v[44:45], v[44:45]
v_pk_mul_f32 v[54:55], v[46:47], v[46:47]
v_pk_fma_f32 v[48:49], v[48:49], v[242:243], v[240:241]
v_pk_fma_f32 v[50:51], v[50:51], v[242:243], v[240:241]
v_pk_fma_f32 v[52:53], v[52:53], v[242:243], v[240:241]
v_pk_fma_f32 v[54:55], v[54:55], v[242:243], v[240:241]
v_pk_mul_f32 v[48:49], v[48:49], v[40:41]
v_pk_mul_f32 v[50:51], v[50:51], v[42:43]
v_pk_mul_f32 v[52:53], v[52:53], v[44:45]
v_pk_mul_f32 v[54:55], v[54:55], v[46:47]
v_exp_f32 v48, v48
v_exp_f32 v49, v49
v_exp_f32 v50, v50
v_exp_f32 v51, v51
v_exp_f32 v52, v52
v_exp_f32 v53, v53
v_exp_f32 v54, v54
v_exp_f32 v55, v55
v_pk_add_f32 v[48:49], v[48:49], v[244:245]
v_pk_add_f32 v[50:51], v[50:51], v[244:245]
v_pk_add_f32 v[52:53], v[52:53], v[244:245]
v_pk_add_f32 v[54:55], v[54:55], v[244:245]
v_rcp_f32 v48, v48
v_rcp_f32 v49, v49
v_rcp_f32 v50, v50
v_rcp_f32 v51, v51
v_rcp_f32 v52, v52
v_rcp_f32 v53, v53
v_rcp_f32 v54, v54
v_rcp_f32 v55, v55
v_pk_mul_f32 v[40:41], v[48:49], v[40:41]
v_pk_mul_f32 v[42:43], v[50:51], v[42:43]
v_pk_mul_f32 v[44:45], v[52:53], v[44:45]
v_pk_mul_f32 v[46:47], v[54:55], v[46:47]
v_cvt_pk_bf16_f32 v56, v40, v41
v_cvt_pk_bf16_f32 v57, v42, v43
v_cvt_pk_bf16_f32 v58, v44, v45
v_cvt_pk_bf16_f32 v59, v46, v47
buffer_store_dwordx4 v[56:59], v145, s[4:7], s53 offen offset:0 sc1
v_accvgpr_read_b32 v0, a72
v_accvgpr_read_b32 v1, a73
v_accvgpr_read_b32 v2, a74
v_accvgpr_read_b32 v3, a75
v_accvgpr_read_b32 v4, a76
v_accvgpr_read_b32 v5, a77
v_accvgpr_read_b32 v6, a78
v_accvgpr_read_b32 v7, a79
v_pk_mul_f32 v[8:9], v[0:1], v[0:1]
v_pk_mul_f32 v[10:11], v[2:3], v[2:3]
v_pk_mul_f32 v[12:13], v[4:5], v[4:5]
v_pk_mul_f32 v[14:15], v[6:7], v[6:7]
v_pk_fma_f32 v[8:9], v[8:9], v[242:243], v[240:241]
v_pk_fma_f32 v[10:11], v[10:11], v[242:243], v[240:241]
v_pk_fma_f32 v[12:13], v[12:13], v[242:243], v[240:241]
v_pk_fma_f32 v[14:15], v[14:15], v[242:243], v[240:241]
v_pk_mul_f32 v[8:9], v[8:9], v[0:1]
v_pk_mul_f32 v[10:11], v[10:11], v[2:3]
v_pk_mul_f32 v[12:13], v[12:13], v[4:5]
v_pk_mul_f32 v[14:15], v[14:15], v[6:7]
v_exp_f32 v8, v8
v_exp_f32 v9, v9
v_exp_f32 v10, v10
v_exp_f32 v11, v11
v_exp_f32 v12, v12
v_exp_f32 v13, v13
v_exp_f32 v14, v14
v_exp_f32 v15, v15
v_pk_add_f32 v[8:9], v[8:9], v[244:245]
v_pk_add_f32 v[10:11], v[10:11], v[244:245]
v_pk_add_f32 v[12:13], v[12:13], v[244:245]
v_pk_add_f32 v[14:15], v[14:15], v[244:245]
v_rcp_f32 v8, v8
v_rcp_f32 v9, v9
v_rcp_f32 v10, v10
v_rcp_f32 v11, v11
v_rcp_f32 v12, v12
v_rcp_f32 v13, v13
v_rcp_f32 v14, v14
v_rcp_f32 v15, v15
v_pk_mul_f32 v[0:1], v[8:9], v[0:1]
v_pk_mul_f32 v[2:3], v[10:11], v[2:3]
v_pk_mul_f32 v[4:5], v[12:13], v[4:5]
v_pk_mul_f32 v[6:7], v[14:15], v[6:7]
v_cvt_pk_bf16_f32 v16, v0, v1
v_cvt_pk_bf16_f32 v17, v2, v3
v_cvt_pk_bf16_f32 v18, v4, v5
v_cvt_pk_bf16_f32 v19, v6, v7
buffer_store_dwordx4 v[16:19], v145, s[4:7], s53 offen offset:1024 sc1
v_accvgpr_read_b32 v20, a80
v_accvgpr_read_b32 v21, a81
v_accvgpr_read_b32 v22, a82
v_accvgpr_read_b32 v23, a83
v_accvgpr_read_b32 v24, a84
v_accvgpr_read_b32 v25, a85
v_accvgpr_read_b32 v26, a86
v_accvgpr_read_b32 v27, a87
v_pk_mul_f32 v[28:29], v[20:21], v[20:21]
v_pk_mul_f32 v[30:31], v[22:23], v[22:23]
v_pk_mul_f32 v[32:33], v[24:25], v[24:25]
v_pk_mul_f32 v[34:35], v[26:27], v[26:27]
v_pk_fma_f32 v[28:29], v[28:29], v[242:243], v[240:241]
v_pk_fma_f32 v[30:31], v[30:31], v[242:243], v[240:241]
v_pk_fma_f32 v[32:33], v[32:33], v[242:243], v[240:241]
v_pk_fma_f32 v[34:35], v[34:35], v[242:243], v[240:241]
v_pk_mul_f32 v[28:29], v[28:29], v[20:21]
v_pk_mul_f32 v[30:31], v[30:31], v[22:23]
v_pk_mul_f32 v[32:33], v[32:33], v[24:25]
v_pk_mul_f32 v[34:35], v[34:35], v[26:27]
v_exp_f32 v28, v28
v_exp_f32 v29, v29
v_exp_f32 v30, v30
v_exp_f32 v31, v31
v_exp_f32 v32, v32
v_exp_f32 v33, v33
v_exp_f32 v34, v34
v_exp_f32 v35, v35
v_pk_add_f32 v[28:29], v[28:29], v[244:245]
v_pk_add_f32 v[30:31], v[30:31], v[244:245]
v_pk_add_f32 v[32:33], v[32:33], v[244:245]
v_pk_add_f32 v[34:35], v[34:35], v[244:245]
v_rcp_f32 v28, v28
v_rcp_f32 v29, v29
v_rcp_f32 v30, v30
v_rcp_f32 v31, v31
v_rcp_f32 v32, v32
v_rcp_f32 v33, v33
v_rcp_f32 v34, v34
v_rcp_f32 v35, v35
v_pk_mul_f32 v[20:21], v[28:29], v[20:21]
v_pk_mul_f32 v[22:23], v[30:31], v[22:23]
v_pk_mul_f32 v[24:25], v[32:33], v[24:25]
v_pk_mul_f32 v[26:27], v[34:35], v[26:27]
v_cvt_pk_bf16_f32 v36, v20, v21
v_cvt_pk_bf16_f32 v37, v22, v23
v_cvt_pk_bf16_f32 v38, v24, v25
v_cvt_pk_bf16_f32 v39, v26, v27
buffer_store_dwordx4 v[36:39], v145, s[4:7], s53 offen offset:2048 sc1
v_accvgpr_read_b32 v40, a88
v_accvgpr_read_b32 v41, a89
v_accvgpr_read_b32 v42, a90
v_accvgpr_read_b32 v43, a91
v_accvgpr_read_b32 v44, a92
v_accvgpr_read_b32 v45, a93
v_accvgpr_read_b32 v46, a94
v_accvgpr_read_b32 v47, a95
v_pk_mul_f32 v[48:49], v[40:41], v[40:41]
v_pk_mul_f32 v[50:51], v[42:43], v[42:43]
v_pk_mul_f32 v[52:53], v[44:45], v[44:45]
v_pk_mul_f32 v[54:55], v[46:47], v[46:47]
v_pk_fma_f32 v[48:49], v[48:49], v[242:243], v[240:241]
v_pk_fma_f32 v[50:51], v[50:51], v[242:243], v[240:241]
v_pk_fma_f32 v[52:53], v[52:53], v[242:243], v[240:241]
v_pk_fma_f32 v[54:55], v[54:55], v[242:243], v[240:241]
v_pk_mul_f32 v[48:49], v[48:49], v[40:41]
v_pk_mul_f32 v[50:51], v[50:51], v[42:43]
v_pk_mul_f32 v[52:53], v[52:53], v[44:45]
v_pk_mul_f32 v[54:55], v[54:55], v[46:47]
v_exp_f32 v48, v48
v_exp_f32 v49, v49
v_exp_f32 v50, v50
v_exp_f32 v51, v51
v_exp_f32 v52, v52
v_exp_f32 v53, v53
v_exp_f32 v54, v54
v_exp_f32 v55, v55
v_pk_add_f32 v[48:49], v[48:49], v[244:245]
v_pk_add_f32 v[50:51], v[50:51], v[244:245]
v_pk_add_f32 v[52:53], v[52:53], v[244:245]
v_pk_add_f32 v[54:55], v[54:55], v[244:245]
v_rcp_f32 v48, v48
v_rcp_f32 v49, v49
v_rcp_f32 v50, v50
v_rcp_f32 v51, v51
v_rcp_f32 v52, v52
v_rcp_f32 v53, v53
v_rcp_f32 v54, v54
v_rcp_f32 v55, v55
v_pk_mul_f32 v[40:41], v[48:49], v[40:41]
v_pk_mul_f32 v[42:43], v[50:51], v[42:43]
v_pk_mul_f32 v[44:45], v[52:53], v[44:45]
v_pk_mul_f32 v[46:47], v[54:55], v[46:47]
v_cvt_pk_bf16_f32 v56, v40, v41
v_cvt_pk_bf16_f32 v57, v42, v43
v_cvt_pk_bf16_f32 v58, v44, v45
v_cvt_pk_bf16_f32 v59, v46, v47
buffer_store_dwordx4 v[56:59], v145, s[4:7], s53 offen offset:3072 sc1
s_add_u32 s53, s53, s2
v_accvgpr_read_b32 v0, a96
v_accvgpr_read_b32 v1, a97
v_accvgpr_read_b32 v2, a98
v_accvgpr_read_b32 v3, a99
v_accvgpr_read_b32 v4, a100
v_accvgpr_read_b32 v5, a101
v_accvgpr_read_b32 v6, a102
v_accvgpr_read_b32 v7, a103
v_pk_mul_f32 v[8:9], v[0:1], v[0:1]
v_pk_mul_f32 v[10:11], v[2:3], v[2:3]
v_pk_mul_f32 v[12:13], v[4:5], v[4:5]
v_pk_mul_f32 v[14:15], v[6:7], v[6:7]
v_pk_fma_f32 v[8:9], v[8:9], v[242:243], v[240:241]
v_pk_fma_f32 v[10:11], v[10:11], v[242:243], v[240:241]
v_pk_fma_f32 v[12:13], v[12:13], v[242:243], v[240:241]
v_pk_fma_f32 v[14:15], v[14:15], v[242:243], v[240:241]
v_pk_mul_f32 v[8:9], v[8:9], v[0:1]
v_pk_mul_f32 v[10:11], v[10:11], v[2:3]
v_pk_mul_f32 v[12:13], v[12:13], v[4:5]
v_pk_mul_f32 v[14:15], v[14:15], v[6:7]
v_exp_f32 v8, v8
v_exp_f32 v9, v9
v_exp_f32 v10, v10
v_exp_f32 v11, v11
v_exp_f32 v12, v12
v_exp_f32 v13, v13
v_exp_f32 v14, v14
v_exp_f32 v15, v15
v_pk_add_f32 v[8:9], v[8:9], v[244:245]
v_pk_add_f32 v[10:11], v[10:11], v[244:245]
v_pk_add_f32 v[12:13], v[12:13], v[244:245]
v_pk_add_f32 v[14:15], v[14:15], v[244:245]
v_rcp_f32 v8, v8
v_rcp_f32 v9, v9
v_rcp_f32 v10, v10
v_rcp_f32 v11, v11
v_rcp_f32 v12, v12
v_rcp_f32 v13, v13
v_rcp_f32 v14, v14
v_rcp_f32 v15, v15
v_pk_mul_f32 v[0:1], v[8:9], v[0:1]
v_pk_mul_f32 v[2:3], v[10:11], v[2:3]
v_pk_mul_f32 v[4:5], v[12:13], v[4:5]
v_pk_mul_f32 v[6:7], v[14:15], v[6:7]
v_cvt_pk_bf16_f32 v16, v0, v1
v_cvt_pk_bf16_f32 v17, v2, v3
v_cvt_pk_bf16_f32 v18, v4, v5
v_cvt_pk_bf16_f32 v19, v6, v7
buffer_store_dwordx4 v[16:19], v145, s[4:7], s53 offen offset:0 sc1
v_accvgpr_read_b32 v20, a104
v_accvgpr_read_b32 v21, a105
v_accvgpr_read_b32 v22, a106
v_accvgpr_read_b32 v23, a107
v_accvgpr_read_b32 v24, a108
v_accvgpr_read_b32 v25, a109
v_accvgpr_read_b32 v26, a110
v_accvgpr_read_b32 v27, a111
v_pk_mul_f32 v[28:29], v[20:21], v[20:21]
v_pk_mul_f32 v[30:31], v[22:23], v[22:23]
v_pk_mul_f32 v[32:33], v[24:25], v[24:25]
v_pk_mul_f32 v[34:35], v[26:27], v[26:27]
v_pk_fma_f32 v[28:29], v[28:29], v[242:243], v[240:241]
v_pk_fma_f32 v[30:31], v[30:31], v[242:243], v[240:241]
v_pk_fma_f32 v[32:33], v[32:33], v[242:243], v[240:241]
v_pk_fma_f32 v[34:35], v[34:35], v[242:243], v[240:241]
v_pk_mul_f32 v[28:29], v[28:29], v[20:21]
v_pk_mul_f32 v[30:31], v[30:31], v[22:23]
v_pk_mul_f32 v[32:33], v[32:33], v[24:25]
v_pk_mul_f32 v[34:35], v[34:35], v[26:27]
v_exp_f32 v28, v28
v_exp_f32 v29, v29
v_exp_f32 v30, v30
v_exp_f32 v31, v31
v_exp_f32 v32, v32
v_exp_f32 v33, v33
v_exp_f32 v34, v34
v_exp_f32 v35, v35
v_pk_add_f32 v[28:29], v[28:29], v[244:245]
v_pk_add_f32 v[30:31], v[30:31], v[244:245]
v_pk_add_f32 v[32:33], v[32:33], v[244:245]
v_pk_add_f32 v[34:35], v[34:35], v[244:245]
v_rcp_f32 v28, v28
v_rcp_f32 v29, v29
v_rcp_f32 v30, v30
v_rcp_f32 v31, v31
v_rcp_f32 v32, v32
v_rcp_f32 v33, v33
v_rcp_f32 v34, v34
v_rcp_f32 v35, v35
v_pk_mul_f32 v[20:21], v[28:29], v[20:21]
v_pk_mul_f32 v[22:23], v[30:31], v[22:23]
v_pk_mul_f32 v[24:25], v[32:33], v[24:25]
v_pk_mul_f32 v[26:27], v[34:35], v[26:27]
v_cvt_pk_bf16_f32 v36, v20, v21
v_cvt_pk_bf16_f32 v37, v22, v23
v_cvt_pk_bf16_f32 v38, v24, v25
v_cvt_pk_bf16_f32 v39, v26, v27
buffer_store_dwordx4 v[36:39], v145, s[4:7], s53 offen offset:1024 sc1
v_accvgpr_read_b32 v40, a112
v_accvgpr_read_b32 v41, a113
v_accvgpr_read_b32 v42, a114
v_accvgpr_read_b32 v43, a115
v_accvgpr_read_b32 v44, a116
v_accvgpr_read_b32 v45, a117
v_accvgpr_read_b32 v46, a118
v_accvgpr_read_b32 v47, a119
v_pk_mul_f32 v[48:49], v[40:41], v[40:41]
v_pk_mul_f32 v[50:51], v[42:43], v[42:43]
v_pk_mul_f32 v[52:53], v[44:45], v[44:45]
v_pk_mul_f32 v[54:55], v[46:47], v[46:47]
v_pk_fma_f32 v[48:49], v[48:49], v[242:243], v[240:241]
v_pk_fma_f32 v[50:51], v[50:51], v[242:243], v[240:241]
v_pk_fma_f32 v[52:53], v[52:53], v[242:243], v[240:241]
v_pk_fma_f32 v[54:55], v[54:55], v[242:243], v[240:241]
v_pk_mul_f32 v[48:49], v[48:49], v[40:41]
v_pk_mul_f32 v[50:51], v[50:51], v[42:43]
v_pk_mul_f32 v[52:53], v[52:53], v[44:45]
v_pk_mul_f32 v[54:55], v[54:55], v[46:47]
v_exp_f32 v48, v48
v_exp_f32 v49, v49
v_exp_f32 v50, v50
v_exp_f32 v51, v51
v_exp_f32 v52, v52
v_exp_f32 v53, v53
v_exp_f32 v54, v54
v_exp_f32 v55, v55
v_pk_add_f32 v[48:49], v[48:49], v[244:245]
v_pk_add_f32 v[50:51], v[50:51], v[244:245]
v_pk_add_f32 v[52:53], v[52:53], v[244:245]
v_pk_add_f32 v[54:55], v[54:55], v[244:245]
v_rcp_f32 v48, v48
v_rcp_f32 v49, v49
v_rcp_f32 v50, v50
v_rcp_f32 v51, v51
v_rcp_f32 v52, v52
v_rcp_f32 v53, v53
v_rcp_f32 v54, v54
v_rcp_f32 v55, v55
v_pk_mul_f32 v[40:41], v[48:49], v[40:41]
v_pk_mul_f32 v[42:43], v[50:51], v[42:43]
v_pk_mul_f32 v[44:45], v[52:53], v[44:45]
v_pk_mul_f32 v[46:47], v[54:55], v[46:47]
v_cvt_pk_bf16_f32 v56, v40, v41
v_cvt_pk_bf16_f32 v57, v42, v43
v_cvt_pk_bf16_f32 v58, v44, v45
v_cvt_pk_bf16_f32 v59, v46, v47
buffer_store_dwordx4 v[56:59], v145, s[4:7], s53 offen offset:2048 sc1
v_accvgpr_read_b32 v0, a120
v_accvgpr_read_b32 v1, a121
v_accvgpr_read_b32 v2, a122
v_accvgpr_read_b32 v3, a123
v_accvgpr_read_b32 v4, a124
v_accvgpr_read_b32 v5, a125
v_accvgpr_read_b32 v6, a126
v_accvgpr_read_b32 v7, a127
v_pk_mul_f32 v[8:9], v[0:1], v[0:1]
v_pk_mul_f32 v[10:11], v[2:3], v[2:3]
v_pk_mul_f32 v[12:13], v[4:5], v[4:5]
v_pk_mul_f32 v[14:15], v[6:7], v[6:7]
v_pk_fma_f32 v[8:9], v[8:9], v[242:243], v[240:241]
v_pk_fma_f32 v[10:11], v[10:11], v[242:243], v[240:241]
v_pk_fma_f32 v[12:13], v[12:13], v[242:243], v[240:241]
v_pk_fma_f32 v[14:15], v[14:15], v[242:243], v[240:241]
v_pk_mul_f32 v[8:9], v[8:9], v[0:1]
v_pk_mul_f32 v[10:11], v[10:11], v[2:3]
v_pk_mul_f32 v[12:13], v[12:13], v[4:5]
v_pk_mul_f32 v[14:15], v[14:15], v[6:7]
v_exp_f32 v8, v8
v_exp_f32 v9, v9
v_exp_f32 v10, v10
v_exp_f32 v11, v11
v_exp_f32 v12, v12
v_exp_f32 v13, v13
v_exp_f32 v14, v14
v_exp_f32 v15, v15
v_pk_add_f32 v[8:9], v[8:9], v[244:245]
v_pk_add_f32 v[10:11], v[10:11], v[244:245]
v_pk_add_f32 v[12:13], v[12:13], v[244:245]
v_pk_add_f32 v[14:15], v[14:15], v[244:245]
v_rcp_f32 v8, v8
v_rcp_f32 v9, v9
v_rcp_f32 v10, v10
v_rcp_f32 v11, v11
v_rcp_f32 v12, v12
v_rcp_f32 v13, v13
v_rcp_f32 v14, v14
v_rcp_f32 v15, v15
v_pk_mul_f32 v[0:1], v[8:9], v[0:1]
v_pk_mul_f32 v[2:3], v[10:11], v[2:3]
v_pk_mul_f32 v[4:5], v[12:13], v[4:5]
v_pk_mul_f32 v[6:7], v[14:15], v[6:7]
v_cvt_pk_bf16_f32 v16, v0, v1
v_cvt_pk_bf16_f32 v17, v2, v3
v_cvt_pk_bf16_f32 v18, v4, v5
v_cvt_pk_bf16_f32 v19, v6, v7
buffer_store_dwordx4 v[16:19], v145, s[4:7], s53 offen offset:3072 sc1
s_branch main_kernel_w_ee
main_kernel_w_e10:
s_mov_b32 s53, s1
v_accvgpr_read_b32 v0, a0
v_accvgpr_read_b32 v1, a1
v_accvgpr_read_b32 v2, a2
v_accvgpr_read_b32 v3, a3
v_accvgpr_read_b32 v4, a4
v_accvgpr_read_b32 v5, a5
v_accvgpr_read_b32 v6, a6
v_accvgpr_read_b32 v7, a7
v_pk_mul_f32 v[8:9], v[0:1], v[0:1]
v_pk_mul_f32 v[10:11], v[2:3], v[2:3]
v_pk_mul_f32 v[12:13], v[4:5], v[4:5]
v_pk_mul_f32 v[14:15], v[6:7], v[6:7]
v_pk_fma_f32 v[8:9], v[8:9], v[242:243], v[240:241]
v_pk_fma_f32 v[10:11], v[10:11], v[242:243], v[240:241]
v_pk_fma_f32 v[12:13], v[12:13], v[242:243], v[240:241]
v_pk_fma_f32 v[14:15], v[14:15], v[242:243], v[240:241]
v_pk_mul_f32 v[8:9], v[8:9], v[0:1]
v_pk_mul_f32 v[10:11], v[10:11], v[2:3]
v_pk_mul_f32 v[12:13], v[12:13], v[4:5]
v_pk_mul_f32 v[14:15], v[14:15], v[6:7]
v_exp_f32 v8, v8
v_exp_f32 v9, v9
v_exp_f32 v10, v10
v_exp_f32 v11, v11
v_exp_f32 v12, v12
v_exp_f32 v13, v13
v_exp_f32 v14, v14
v_exp_f32 v15, v15
v_pk_add_f32 v[8:9], v[8:9], v[244:245]
v_pk_add_f32 v[10:11], v[10:11], v[244:245]
v_pk_add_f32 v[12:13], v[12:13], v[244:245]
v_pk_add_f32 v[14:15], v[14:15], v[244:245]
v_rcp_f32 v8, v8
v_rcp_f32 v9, v9
v_rcp_f32 v10, v10
v_rcp_f32 v11, v11
v_rcp_f32 v12, v12
v_rcp_f32 v13, v13
v_rcp_f32 v14, v14
v_rcp_f32 v15, v15
v_pk_mul_f32 v[0:1], v[8:9], v[0:1]
v_pk_mul_f32 v[2:3], v[10:11], v[2:3]
v_pk_mul_f32 v[4:5], v[12:13], v[4:5]
v_pk_mul_f32 v[6:7], v[14:15], v[6:7]
v_cvt_pk_bf16_f32 v16, v0, v1
v_cvt_pk_bf16_f32 v17, v2, v3
v_cvt_pk_bf16_f32 v18, v4, v5
v_cvt_pk_bf16_f32 v19, v6, v7
buffer_store_dwordx4 v[16:19], v251, s[4:7], s53 offen offset:0 sc1
v_accvgpr_read_b32 v20, a8
v_accvgpr_read_b32 v21, a9
v_accvgpr_read_b32 v22, a10
v_accvgpr_read_b32 v23, a11
v_accvgpr_read_b32 v24, a12
v_accvgpr_read_b32 v25, a13
v_accvgpr_read_b32 v26, a14
v_accvgpr_read_b32 v27, a15
v_pk_mul_f32 v[28:29], v[20:21], v[20:21]
v_pk_mul_f32 v[30:31], v[22:23], v[22:23]
v_pk_mul_f32 v[32:33], v[24:25], v[24:25]
v_pk_mul_f32 v[34:35], v[26:27], v[26:27]
v_pk_fma_f32 v[28:29], v[28:29], v[242:243], v[240:241]
v_pk_fma_f32 v[30:31], v[30:31], v[242:243], v[240:241]
v_pk_fma_f32 v[32:33], v[32:33], v[242:243], v[240:241]
v_pk_fma_f32 v[34:35], v[34:35], v[242:243], v[240:241]
v_pk_mul_f32 v[28:29], v[28:29], v[20:21]
v_pk_mul_f32 v[30:31], v[30:31], v[22:23]
v_pk_mul_f32 v[32:33], v[32:33], v[24:25]
v_pk_mul_f32 v[34:35], v[34:35], v[26:27]
v_exp_f32 v28, v28
v_exp_f32 v29, v29
v_exp_f32 v30, v30
v_exp_f32 v31, v31
v_exp_f32 v32, v32
v_exp_f32 v33, v33
v_exp_f32 v34, v34
v_exp_f32 v35, v35
v_pk_add_f32 v[28:29], v[28:29], v[244:245]
v_pk_add_f32 v[30:31], v[30:31], v[244:245]
v_pk_add_f32 v[32:33], v[32:33], v[244:245]
v_pk_add_f32 v[34:35], v[34:35], v[244:245]
v_rcp_f32 v28, v28
v_rcp_f32 v29, v29
v_rcp_f32 v30, v30
v_rcp_f32 v31, v31
v_rcp_f32 v32, v32
v_rcp_f32 v33, v33
v_rcp_f32 v34, v34
v_rcp_f32 v35, v35
v_pk_mul_f32 v[20:21], v[28:29], v[20:21]
v_pk_mul_f32 v[22:23], v[30:31], v[22:23]
v_pk_mul_f32 v[24:25], v[32:33], v[24:25]
v_pk_mul_f32 v[26:27], v[34:35], v[26:27]
v_cvt_pk_bf16_f32 v36, v20, v21
v_cvt_pk_bf16_f32 v37, v22, v23
v_cvt_pk_bf16_f32 v38, v24, v25
v_cvt_pk_bf16_f32 v39, v26, v27
buffer_store_dwordx4 v[36:39], v251, s[4:7], s53 offen offset:1024 sc1
v_accvgpr_read_b32 v40, a16
v_accvgpr_read_b32 v41, a17
v_accvgpr_read_b32 v42, a18
v_accvgpr_read_b32 v43, a19
v_accvgpr_read_b32 v44, a20
v_accvgpr_read_b32 v45, a21
v_accvgpr_read_b32 v46, a22
v_accvgpr_read_b32 v47, a23
v_pk_mul_f32 v[48:49], v[40:41], v[40:41]
v_pk_mul_f32 v[50:51], v[42:43], v[42:43]
v_pk_mul_f32 v[52:53], v[44:45], v[44:45]
v_pk_mul_f32 v[54:55], v[46:47], v[46:47]
v_pk_fma_f32 v[48:49], v[48:49], v[242:243], v[240:241]
v_pk_fma_f32 v[50:51], v[50:51], v[242:243], v[240:241]
v_pk_fma_f32 v[52:53], v[52:53], v[242:243], v[240:241]
v_pk_fma_f32 v[54:55], v[54:55], v[242:243], v[240:241]
v_pk_mul_f32 v[48:49], v[48:49], v[40:41]
v_pk_mul_f32 v[50:51], v[50:51], v[42:43]
v_pk_mul_f32 v[52:53], v[52:53], v[44:45]
v_pk_mul_f32 v[54:55], v[54:55], v[46:47]
v_exp_f32 v48, v48
v_exp_f32 v49, v49
v_exp_f32 v50, v50
v_exp_f32 v51, v51
v_exp_f32 v52, v52
v_exp_f32 v53, v53
v_exp_f32 v54, v54
v_exp_f32 v55, v55
v_pk_add_f32 v[48:49], v[48:49], v[244:245]
v_pk_add_f32 v[50:51], v[50:51], v[244:245]
v_pk_add_f32 v[52:53], v[52:53], v[244:245]
v_pk_add_f32 v[54:55], v[54:55], v[244:245]
v_rcp_f32 v48, v48
v_rcp_f32 v49, v49
v_rcp_f32 v50, v50
v_rcp_f32 v51, v51
v_rcp_f32 v52, v52
v_rcp_f32 v53, v53
v_rcp_f32 v54, v54
v_rcp_f32 v55, v55
v_pk_mul_f32 v[40:41], v[48:49], v[40:41]
v_pk_mul_f32 v[42:43], v[50:51], v[42:43]
v_pk_mul_f32 v[44:45], v[52:53], v[44:45]
v_pk_mul_f32 v[46:47], v[54:55], v[46:47]
v_cvt_pk_bf16_f32 v56, v40, v41
v_cvt_pk_bf16_f32 v57, v42, v43
v_cvt_pk_bf16_f32 v58, v44, v45
v_cvt_pk_bf16_f32 v59, v46, v47
buffer_store_dwordx4 v[56:59], v251, s[4:7], s53 offen offset:2048 sc1
v_accvgpr_read_b32 v0, a24
v_accvgpr_read_b32 v1, a25
v_accvgpr_read_b32 v2, a26
v_accvgpr_read_b32 v3, a27
v_accvgpr_read_b32 v4, a28
v_accvgpr_read_b32 v5, a29
v_accvgpr_read_b32 v6, a30
v_accvgpr_read_b32 v7, a31
v_pk_mul_f32 v[8:9], v[0:1], v[0:1]
v_pk_mul_f32 v[10:11], v[2:3], v[2:3]
v_pk_mul_f32 v[12:13], v[4:5], v[4:5]
v_pk_mul_f32 v[14:15], v[6:7], v[6:7]
v_pk_fma_f32 v[8:9], v[8:9], v[242:243], v[240:241]
v_pk_fma_f32 v[10:11], v[10:11], v[242:243], v[240:241]
v_pk_fma_f32 v[12:13], v[12:13], v[242:243], v[240:241]
v_pk_fma_f32 v[14:15], v[14:15], v[242:243], v[240:241]
v_pk_mul_f32 v[8:9], v[8:9], v[0:1]
v_pk_mul_f32 v[10:11], v[10:11], v[2:3]
v_pk_mul_f32 v[12:13], v[12:13], v[4:5]
v_pk_mul_f32 v[14:15], v[14:15], v[6:7]
v_exp_f32 v8, v8
v_exp_f32 v9, v9
v_exp_f32 v10, v10
v_exp_f32 v11, v11
v_exp_f32 v12, v12
v_exp_f32 v13, v13
v_exp_f32 v14, v14
v_exp_f32 v15, v15
v_pk_add_f32 v[8:9], v[8:9], v[244:245]
v_pk_add_f32 v[10:11], v[10:11], v[244:245]
v_pk_add_f32 v[12:13], v[12:13], v[244:245]
v_pk_add_f32 v[14:15], v[14:15], v[244:245]
v_rcp_f32 v8, v8
v_rcp_f32 v9, v9
v_rcp_f32 v10, v10
v_rcp_f32 v11, v11
v_rcp_f32 v12, v12
v_rcp_f32 v13, v13
v_rcp_f32 v14, v14
v_rcp_f32 v15, v15
v_pk_mul_f32 v[0:1], v[8:9], v[0:1]
v_pk_mul_f32 v[2:3], v[10:11], v[2:3]
v_pk_mul_f32 v[4:5], v[12:13], v[4:5]
v_pk_mul_f32 v[6:7], v[14:15], v[6:7]
v_cvt_pk_bf16_f32 v16, v0, v1
v_cvt_pk_bf16_f32 v17, v2, v3
v_cvt_pk_bf16_f32 v18, v4, v5
v_cvt_pk_bf16_f32 v19, v6, v7
buffer_store_dwordx4 v[16:19], v251, s[4:7], s53 offen offset:3072 sc1
s_add_u32 s53, s53, s2
v_accvgpr_read_b32 v20, a32
v_accvgpr_read_b32 v21, a33
v_accvgpr_read_b32 v22, a34
v_accvgpr_read_b32 v23, a35
v_accvgpr_read_b32 v24, a36
v_accvgpr_read_b32 v25, a37
v_accvgpr_read_b32 v26, a38
v_accvgpr_read_b32 v27, a39
v_pk_mul_f32 v[28:29], v[20:21], v[20:21]
v_pk_mul_f32 v[30:31], v[22:23], v[22:23]
v_pk_mul_f32 v[32:33], v[24:25], v[24:25]
v_pk_mul_f32 v[34:35], v[26:27], v[26:27]
v_pk_fma_f32 v[28:29], v[28:29], v[242:243], v[240:241]
v_pk_fma_f32 v[30:31], v[30:31], v[242:243], v[240:241]
v_pk_fma_f32 v[32:33], v[32:33], v[242:243], v[240:241]
v_pk_fma_f32 v[34:35], v[34:35], v[242:243], v[240:241]
v_pk_mul_f32 v[28:29], v[28:29], v[20:21]
v_pk_mul_f32 v[30:31], v[30:31], v[22:23]
v_pk_mul_f32 v[32:33], v[32:33], v[24:25]
v_pk_mul_f32 v[34:35], v[34:35], v[26:27]
v_exp_f32 v28, v28
v_exp_f32 v29, v29
v_exp_f32 v30, v30
v_exp_f32 v31, v31
v_exp_f32 v32, v32
v_exp_f32 v33, v33
v_exp_f32 v34, v34
v_exp_f32 v35, v35
v_pk_add_f32 v[28:29], v[28:29], v[244:245]
v_pk_add_f32 v[30:31], v[30:31], v[244:245]
v_pk_add_f32 v[32:33], v[32:33], v[244:245]
v_pk_add_f32 v[34:35], v[34:35], v[244:245]
v_rcp_f32 v28, v28
v_rcp_f32 v29, v29
v_rcp_f32 v30, v30
v_rcp_f32 v31, v31
v_rcp_f32 v32, v32
v_rcp_f32 v33, v33
v_rcp_f32 v34, v34
v_rcp_f32 v35, v35
v_pk_mul_f32 v[20:21], v[28:29], v[20:21]
v_pk_mul_f32 v[22:23], v[30:31], v[22:23]
v_pk_mul_f32 v[24:25], v[32:33], v[24:25]
v_pk_mul_f32 v[26:27], v[34:35], v[26:27]
v_cvt_pk_bf16_f32 v36, v20, v21
v_cvt_pk_bf16_f32 v37, v22, v23
v_cvt_pk_bf16_f32 v38, v24, v25
v_cvt_pk_bf16_f32 v39, v26, v27
buffer_store_dwordx4 v[36:39], v251, s[4:7], s53 offen offset:0 sc1
v_accvgpr_read_b32 v40, a40
v_accvgpr_read_b32 v41, a41
v_accvgpr_read_b32 v42, a42
v_accvgpr_read_b32 v43, a43
v_accvgpr_read_b32 v44, a44
v_accvgpr_read_b32 v45, a45
v_accvgpr_read_b32 v46, a46
v_accvgpr_read_b32 v47, a47
v_pk_mul_f32 v[48:49], v[40:41], v[40:41]
v_pk_mul_f32 v[50:51], v[42:43], v[42:43]
v_pk_mul_f32 v[52:53], v[44:45], v[44:45]
v_pk_mul_f32 v[54:55], v[46:47], v[46:47]
v_pk_fma_f32 v[48:49], v[48:49], v[242:243], v[240:241]
v_pk_fma_f32 v[50:51], v[50:51], v[242:243], v[240:241]
v_pk_fma_f32 v[52:53], v[52:53], v[242:243], v[240:241]
v_pk_fma_f32 v[54:55], v[54:55], v[242:243], v[240:241]
v_pk_mul_f32 v[48:49], v[48:49], v[40:41]
v_pk_mul_f32 v[50:51], v[50:51], v[42:43]
v_pk_mul_f32 v[52:53], v[52:53], v[44:45]
v_pk_mul_f32 v[54:55], v[54:55], v[46:47]
v_exp_f32 v48, v48
v_exp_f32 v49, v49
v_exp_f32 v50, v50
v_exp_f32 v51, v51
v_exp_f32 v52, v52
v_exp_f32 v53, v53
v_exp_f32 v54, v54
v_exp_f32 v55, v55
v_pk_add_f32 v[48:49], v[48:49], v[244:245]
v_pk_add_f32 v[50:51], v[50:51], v[244:245]
v_pk_add_f32 v[52:53], v[52:53], v[244:245]
v_pk_add_f32 v[54:55], v[54:55], v[244:245]
v_rcp_f32 v48, v48
v_rcp_f32 v49, v49
v_rcp_f32 v50, v50
v_rcp_f32 v51, v51
v_rcp_f32 v52, v52
v_rcp_f32 v53, v53
v_rcp_f32 v54, v54
v_rcp_f32 v55, v55
v_pk_mul_f32 v[40:41], v[48:49], v[40:41]
v_pk_mul_f32 v[42:43], v[50:51], v[42:43]
v_pk_mul_f32 v[44:45], v[52:53], v[44:45]
v_pk_mul_f32 v[46:47], v[54:55], v[46:47]
v_cvt_pk_bf16_f32 v56, v40, v41
v_cvt_pk_bf16_f32 v57, v42, v43
v_cvt_pk_bf16_f32 v58, v44, v45
v_cvt_pk_bf16_f32 v59, v46, v47
buffer_store_dwordx4 v[56:59], v251, s[4:7], s53 offen offset:1024 sc1
v_accvgpr_read_b32 v0, a48
v_accvgpr_read_b32 v1, a49
v_accvgpr_read_b32 v2, a50
v_accvgpr_read_b32 v3, a51
v_accvgpr_read_b32 v4, a52
v_accvgpr_read_b32 v5, a53
v_accvgpr_read_b32 v6, a54
v_accvgpr_read_b32 v7, a55
v_pk_mul_f32 v[8:9], v[0:1], v[0:1]
v_pk_mul_f32 v[10:11], v[2:3], v[2:3]
v_pk_mul_f32 v[12:13], v[4:5], v[4:5]
v_pk_mul_f32 v[14:15], v[6:7], v[6:7]
v_pk_fma_f32 v[8:9], v[8:9], v[242:243], v[240:241]
v_pk_fma_f32 v[10:11], v[10:11], v[242:243], v[240:241]
v_pk_fma_f32 v[12:13], v[12:13], v[242:243], v[240:241]
v_pk_fma_f32 v[14:15], v[14:15], v[242:243], v[240:241]
v_pk_mul_f32 v[8:9], v[8:9], v[0:1]
v_pk_mul_f32 v[10:11], v[10:11], v[2:3]
v_pk_mul_f32 v[12:13], v[12:13], v[4:5]
v_pk_mul_f32 v[14:15], v[14:15], v[6:7]
v_exp_f32 v8, v8
v_exp_f32 v9, v9
v_exp_f32 v10, v10
v_exp_f32 v11, v11
v_exp_f32 v12, v12
v_exp_f32 v13, v13
v_exp_f32 v14, v14
v_exp_f32 v15, v15
v_pk_add_f32 v[8:9], v[8:9], v[244:245]
v_pk_add_f32 v[10:11], v[10:11], v[244:245]
v_pk_add_f32 v[12:13], v[12:13], v[244:245]
v_pk_add_f32 v[14:15], v[14:15], v[244:245]
v_rcp_f32 v8, v8
v_rcp_f32 v9, v9
v_rcp_f32 v10, v10
v_rcp_f32 v11, v11
v_rcp_f32 v12, v12
v_rcp_f32 v13, v13
v_rcp_f32 v14, v14
v_rcp_f32 v15, v15
v_pk_mul_f32 v[0:1], v[8:9], v[0:1]
v_pk_mul_f32 v[2:3], v[10:11], v[2:3]
v_pk_mul_f32 v[4:5], v[12:13], v[4:5]
v_pk_mul_f32 v[6:7], v[14:15], v[6:7]
v_cvt_pk_bf16_f32 v16, v0, v1
v_cvt_pk_bf16_f32 v17, v2, v3
v_cvt_pk_bf16_f32 v18, v4, v5
v_cvt_pk_bf16_f32 v19, v6, v7
buffer_store_dwordx4 v[16:19], v251, s[4:7], s53 offen offset:2048 sc1
v_accvgpr_read_b32 v20, a56
v_accvgpr_read_b32 v21, a57
v_accvgpr_read_b32 v22, a58
v_accvgpr_read_b32 v23, a59
v_accvgpr_read_b32 v24, a60
v_accvgpr_read_b32 v25, a61
v_accvgpr_read_b32 v26, a62
v_accvgpr_read_b32 v27, a63
v_pk_mul_f32 v[28:29], v[20:21], v[20:21]
v_pk_mul_f32 v[30:31], v[22:23], v[22:23]
v_pk_mul_f32 v[32:33], v[24:25], v[24:25]
v_pk_mul_f32 v[34:35], v[26:27], v[26:27]
v_pk_fma_f32 v[28:29], v[28:29], v[242:243], v[240:241]
v_pk_fma_f32 v[30:31], v[30:31], v[242:243], v[240:241]
v_pk_fma_f32 v[32:33], v[32:33], v[242:243], v[240:241]
v_pk_fma_f32 v[34:35], v[34:35], v[242:243], v[240:241]
v_pk_mul_f32 v[28:29], v[28:29], v[20:21]
v_pk_mul_f32 v[30:31], v[30:31], v[22:23]
v_pk_mul_f32 v[32:33], v[32:33], v[24:25]
v_pk_mul_f32 v[34:35], v[34:35], v[26:27]
v_exp_f32 v28, v28
v_exp_f32 v29, v29
v_exp_f32 v30, v30
v_exp_f32 v31, v31
v_exp_f32 v32, v32
v_exp_f32 v33, v33
v_exp_f32 v34, v34
v_exp_f32 v35, v35
v_pk_add_f32 v[28:29], v[28:29], v[244:245]
v_pk_add_f32 v[30:31], v[30:31], v[244:245]
v_pk_add_f32 v[32:33], v[32:33], v[244:245]
v_pk_add_f32 v[34:35], v[34:35], v[244:245]
v_rcp_f32 v28, v28
v_rcp_f32 v29, v29
v_rcp_f32 v30, v30
v_rcp_f32 v31, v31
v_rcp_f32 v32, v32
v_rcp_f32 v33, v33
v_rcp_f32 v34, v34
v_rcp_f32 v35, v35
v_pk_mul_f32 v[20:21], v[28:29], v[20:21]
v_pk_mul_f32 v[22:23], v[30:31], v[22:23]
v_pk_mul_f32 v[24:25], v[32:33], v[24:25]
v_pk_mul_f32 v[26:27], v[34:35], v[26:27]
v_cvt_pk_bf16_f32 v36, v20, v21
v_cvt_pk_bf16_f32 v37, v22, v23
v_cvt_pk_bf16_f32 v38, v24, v25
v_cvt_pk_bf16_f32 v39, v26, v27
buffer_store_dwordx4 v[36:39], v251, s[4:7], s53 offen offset:3072 sc1
s_add_u32 s53, s53, s2
v_accvgpr_read_b32 v40, a64
v_accvgpr_read_b32 v41, a65
v_accvgpr_read_b32 v42, a66
v_accvgpr_read_b32 v43, a67
v_accvgpr_read_b32 v44, a68
v_accvgpr_read_b32 v45, a69
v_accvgpr_read_b32 v46, a70
v_accvgpr_read_b32 v47, a71
v_pk_mul_f32 v[48:49], v[40:41], v[40:41]
v_pk_mul_f32 v[50:51], v[42:43], v[42:43]
v_pk_mul_f32 v[52:53], v[44:45], v[44:45]
v_pk_mul_f32 v[54:55], v[46:47], v[46:47]
v_pk_fma_f32 v[48:49], v[48:49], v[242:243], v[240:241]
v_pk_fma_f32 v[50:51], v[50:51], v[242:243], v[240:241]
v_pk_fma_f32 v[52:53], v[52:53], v[242:243], v[240:241]
v_pk_fma_f32 v[54:55], v[54:55], v[242:243], v[240:241]
v_pk_mul_f32 v[48:49], v[48:49], v[40:41]
v_pk_mul_f32 v[50:51], v[50:51], v[42:43]
v_pk_mul_f32 v[52:53], v[52:53], v[44:45]
v_pk_mul_f32 v[54:55], v[54:55], v[46:47]
v_exp_f32 v48, v48
v_exp_f32 v49, v49
v_exp_f32 v50, v50
v_exp_f32 v51, v51
v_exp_f32 v52, v52
v_exp_f32 v53, v53
v_exp_f32 v54, v54
v_exp_f32 v55, v55
v_pk_add_f32 v[48:49], v[48:49], v[244:245]
v_pk_add_f32 v[50:51], v[50:51], v[244:245]
v_pk_add_f32 v[52:53], v[52:53], v[244:245]
v_pk_add_f32 v[54:55], v[54:55], v[244:245]
v_rcp_f32 v48, v48
v_rcp_f32 v49, v49
v_rcp_f32 v50, v50
v_rcp_f32 v51, v51
v_rcp_f32 v52, v52
v_rcp_f32 v53, v53
v_rcp_f32 v54, v54
v_rcp_f32 v55, v55
v_pk_mul_f32 v[40:41], v[48:49], v[40:41]
v_pk_mul_f32 v[42:43], v[50:51], v[42:43]
v_pk_mul_f32 v[44:45], v[52:53], v[44:45]
v_pk_mul_f32 v[46:47], v[54:55], v[46:47]
v_cvt_pk_bf16_f32 v56, v40, v41
v_cvt_pk_bf16_f32 v57, v42, v43
v_cvt_pk_bf16_f32 v58, v44, v45
v_cvt_pk_bf16_f32 v59, v46, v47
buffer_store_dwordx4 v[56:59], v251, s[4:7], s53 offen offset:0 sc1
v_accvgpr_read_b32 v0, a72
v_accvgpr_read_b32 v1, a73
v_accvgpr_read_b32 v2, a74
v_accvgpr_read_b32 v3, a75
v_accvgpr_read_b32 v4, a76
v_accvgpr_read_b32 v5, a77
v_accvgpr_read_b32 v6, a78
v_accvgpr_read_b32 v7, a79
v_pk_mul_f32 v[8:9], v[0:1], v[0:1]
v_pk_mul_f32 v[10:11], v[2:3], v[2:3]
v_pk_mul_f32 v[12:13], v[4:5], v[4:5]
v_pk_mul_f32 v[14:15], v[6:7], v[6:7]
v_pk_fma_f32 v[8:9], v[8:9], v[242:243], v[240:241]
v_pk_fma_f32 v[10:11], v[10:11], v[242:243], v[240:241]
v_pk_fma_f32 v[12:13], v[12:13], v[242:243], v[240:241]
v_pk_fma_f32 v[14:15], v[14:15], v[242:243], v[240:241]
v_pk_mul_f32 v[8:9], v[8:9], v[0:1]
v_pk_mul_f32 v[10:11], v[10:11], v[2:3]
v_pk_mul_f32 v[12:13], v[12:13], v[4:5]
v_pk_mul_f32 v[14:15], v[14:15], v[6:7]
v_exp_f32 v8, v8
v_exp_f32 v9, v9
v_exp_f32 v10, v10
v_exp_f32 v11, v11
v_exp_f32 v12, v12
v_exp_f32 v13, v13
v_exp_f32 v14, v14
v_exp_f32 v15, v15
v_pk_add_f32 v[8:9], v[8:9], v[244:245]
v_pk_add_f32 v[10:11], v[10:11], v[244:245]
v_pk_add_f32 v[12:13], v[12:13], v[244:245]
v_pk_add_f32 v[14:15], v[14:15], v[244:245]
v_rcp_f32 v8, v8
v_rcp_f32 v9, v9
v_rcp_f32 v10, v10
v_rcp_f32 v11, v11
v_rcp_f32 v12, v12
v_rcp_f32 v13, v13
v_rcp_f32 v14, v14
v_rcp_f32 v15, v15
v_pk_mul_f32 v[0:1], v[8:9], v[0:1]
v_pk_mul_f32 v[2:3], v[10:11], v[2:3]
v_pk_mul_f32 v[4:5], v[12:13], v[4:5]
v_pk_mul_f32 v[6:7], v[14:15], v[6:7]
v_cvt_pk_bf16_f32 v16, v0, v1
v_cvt_pk_bf16_f32 v17, v2, v3
v_cvt_pk_bf16_f32 v18, v4, v5
v_cvt_pk_bf16_f32 v19, v6, v7
buffer_store_dwordx4 v[16:19], v251, s[4:7], s53 offen offset:1024 sc1
v_accvgpr_read_b32 v20, a80
v_accvgpr_read_b32 v21, a81
v_accvgpr_read_b32 v22, a82
v_accvgpr_read_b32 v23, a83
v_accvgpr_read_b32 v24, a84
v_accvgpr_read_b32 v25, a85
v_accvgpr_read_b32 v26, a86
v_accvgpr_read_b32 v27, a87
v_pk_mul_f32 v[28:29], v[20:21], v[20:21]
v_pk_mul_f32 v[30:31], v[22:23], v[22:23]
v_pk_mul_f32 v[32:33], v[24:25], v[24:25]
v_pk_mul_f32 v[34:35], v[26:27], v[26:27]
v_pk_fma_f32 v[28:29], v[28:29], v[242:243], v[240:241]
v_pk_fma_f32 v[30:31], v[30:31], v[242:243], v[240:241]
v_pk_fma_f32 v[32:33], v[32:33], v[242:243], v[240:241]
v_pk_fma_f32 v[34:35], v[34:35], v[242:243], v[240:241]
v_pk_mul_f32 v[28:29], v[28:29], v[20:21]
v_pk_mul_f32 v[30:31], v[30:31], v[22:23]
v_pk_mul_f32 v[32:33], v[32:33], v[24:25]
v_pk_mul_f32 v[34:35], v[34:35], v[26:27]
v_exp_f32 v28, v28
v_exp_f32 v29, v29
v_exp_f32 v30, v30
v_exp_f32 v31, v31
v_exp_f32 v32, v32
v_exp_f32 v33, v33
v_exp_f32 v34, v34
v_exp_f32 v35, v35
v_pk_add_f32 v[28:29], v[28:29], v[244:245]
v_pk_add_f32 v[30:31], v[30:31], v[244:245]
v_pk_add_f32 v[32:33], v[32:33], v[244:245]
v_pk_add_f32 v[34:35], v[34:35], v[244:245]
v_rcp_f32 v28, v28
v_rcp_f32 v29, v29
v_rcp_f32 v30, v30
v_rcp_f32 v31, v31
v_rcp_f32 v32, v32
v_rcp_f32 v33, v33
v_rcp_f32 v34, v34
v_rcp_f32 v35, v35
v_pk_mul_f32 v[20:21], v[28:29], v[20:21]
v_pk_mul_f32 v[22:23], v[30:31], v[22:23]
v_pk_mul_f32 v[24:25], v[32:33], v[24:25]
v_pk_mul_f32 v[26:27], v[34:35], v[26:27]
v_cvt_pk_bf16_f32 v36, v20, v21
v_cvt_pk_bf16_f32 v37, v22, v23
v_cvt_pk_bf16_f32 v38, v24, v25
v_cvt_pk_bf16_f32 v39, v26, v27
buffer_store_dwordx4 v[36:39], v251, s[4:7], s53 offen offset:2048 sc1
v_accvgpr_read_b32 v40, a88
v_accvgpr_read_b32 v41, a89
v_accvgpr_read_b32 v42, a90
v_accvgpr_read_b32 v43, a91
v_accvgpr_read_b32 v44, a92
v_accvgpr_read_b32 v45, a93
v_accvgpr_read_b32 v46, a94
v_accvgpr_read_b32 v47, a95
v_pk_mul_f32 v[48:49], v[40:41], v[40:41]
v_pk_mul_f32 v[50:51], v[42:43], v[42:43]
v_pk_mul_f32 v[52:53], v[44:45], v[44:45]
v_pk_mul_f32 v[54:55], v[46:47], v[46:47]
v_pk_fma_f32 v[48:49], v[48:49], v[242:243], v[240:241]
v_pk_fma_f32 v[50:51], v[50:51], v[242:243], v[240:241]
v_pk_fma_f32 v[52:53], v[52:53], v[242:243], v[240:241]
v_pk_fma_f32 v[54:55], v[54:55], v[242:243], v[240:241]
v_pk_mul_f32 v[48:49], v[48:49], v[40:41]
v_pk_mul_f32 v[50:51], v[50:51], v[42:43]
v_pk_mul_f32 v[52:53], v[52:53], v[44:45]
v_pk_mul_f32 v[54:55], v[54:55], v[46:47]
v_exp_f32 v48, v48
v_exp_f32 v49, v49
v_exp_f32 v50, v50
v_exp_f32 v51, v51
v_exp_f32 v52, v52
v_exp_f32 v53, v53
v_exp_f32 v54, v54
v_exp_f32 v55, v55
v_pk_add_f32 v[48:49], v[48:49], v[244:245]
v_pk_add_f32 v[50:51], v[50:51], v[244:245]
v_pk_add_f32 v[52:53], v[52:53], v[244:245]
v_pk_add_f32 v[54:55], v[54:55], v[244:245]
v_rcp_f32 v48, v48
v_rcp_f32 v49, v49
v_rcp_f32 v50, v50
v_rcp_f32 v51, v51
v_rcp_f32 v52, v52
v_rcp_f32 v53, v53
v_rcp_f32 v54, v54
v_rcp_f32 v55, v55
v_pk_mul_f32 v[40:41], v[48:49], v[40:41]
v_pk_mul_f32 v[42:43], v[50:51], v[42:43]
v_pk_mul_f32 v[44:45], v[52:53], v[44:45]
v_pk_mul_f32 v[46:47], v[54:55], v[46:47]
v_cvt_pk_bf16_f32 v56, v40, v41
v_cvt_pk_bf16_f32 v57, v42, v43
v_cvt_pk_bf16_f32 v58, v44, v45
v_cvt_pk_bf16_f32 v59, v46, v47
buffer_store_dwordx4 v[56:59], v251, s[4:7], s53 offen offset:3072 sc1
s_add_u32 s53, s53, s2
v_accvgpr_read_b32 v0, a96
v_accvgpr_read_b32 v1, a97
v_accvgpr_read_b32 v2, a98
v_accvgpr_read_b32 v3, a99
v_accvgpr_read_b32 v4, a100
v_accvgpr_read_b32 v5, a101
v_accvgpr_read_b32 v6, a102
v_accvgpr_read_b32 v7, a103
v_pk_mul_f32 v[8:9], v[0:1], v[0:1]
v_pk_mul_f32 v[10:11], v[2:3], v[2:3]
v_pk_mul_f32 v[12:13], v[4:5], v[4:5]
v_pk_mul_f32 v[14:15], v[6:7], v[6:7]
v_pk_fma_f32 v[8:9], v[8:9], v[242:243], v[240:241]
v_pk_fma_f32 v[10:11], v[10:11], v[242:243], v[240:241]
v_pk_fma_f32 v[12:13], v[12:13], v[242:243], v[240:241]
v_pk_fma_f32 v[14:15], v[14:15], v[242:243], v[240:241]
v_pk_mul_f32 v[8:9], v[8:9], v[0:1]
v_pk_mul_f32 v[10:11], v[10:11], v[2:3]
v_pk_mul_f32 v[12:13], v[12:13], v[4:5]
v_pk_mul_f32 v[14:15], v[14:15], v[6:7]
v_exp_f32 v8, v8
v_exp_f32 v9, v9
v_exp_f32 v10, v10
v_exp_f32 v11, v11
v_exp_f32 v12, v12
v_exp_f32 v13, v13
v_exp_f32 v14, v14
v_exp_f32 v15, v15
v_pk_add_f32 v[8:9], v[8:9], v[244:245]
v_pk_add_f32 v[10:11], v[10:11], v[244:245]
v_pk_add_f32 v[12:13], v[12:13], v[244:245]
v_pk_add_f32 v[14:15], v[14:15], v[244:245]
v_rcp_f32 v8, v8
v_rcp_f32 v9, v9
v_rcp_f32 v10, v10
v_rcp_f32 v11, v11
v_rcp_f32 v12, v12
v_rcp_f32 v13, v13
v_rcp_f32 v14, v14
v_rcp_f32 v15, v15
v_pk_mul_f32 v[0:1], v[8:9], v[0:1]
v_pk_mul_f32 v[2:3], v[10:11], v[2:3]
v_pk_mul_f32 v[4:5], v[12:13], v[4:5]
v_pk_mul_f32 v[6:7], v[14:15], v[6:7]
v_cvt_pk_bf16_f32 v16, v0, v1
v_cvt_pk_bf16_f32 v17, v2, v3
v_cvt_pk_bf16_f32 v18, v4, v5
v_cvt_pk_bf16_f32 v19, v6, v7
buffer_store_dwordx4 v[16:19], v251, s[4:7], s53 offen offset:0 sc1
v_accvgpr_read_b32 v20, a104
v_accvgpr_read_b32 v21, a105
v_accvgpr_read_b32 v22, a106
v_accvgpr_read_b32 v23, a107
v_accvgpr_read_b32 v24, a108
v_accvgpr_read_b32 v25, a109
v_accvgpr_read_b32 v26, a110
v_accvgpr_read_b32 v27, a111
v_pk_mul_f32 v[28:29], v[20:21], v[20:21]
v_pk_mul_f32 v[30:31], v[22:23], v[22:23]
v_pk_mul_f32 v[32:33], v[24:25], v[24:25]
v_pk_mul_f32 v[34:35], v[26:27], v[26:27]
v_pk_fma_f32 v[28:29], v[28:29], v[242:243], v[240:241]
v_pk_fma_f32 v[30:31], v[30:31], v[242:243], v[240:241]
v_pk_fma_f32 v[32:33], v[32:33], v[242:243], v[240:241]
v_pk_fma_f32 v[34:35], v[34:35], v[242:243], v[240:241]
v_pk_mul_f32 v[28:29], v[28:29], v[20:21]
v_pk_mul_f32 v[30:31], v[30:31], v[22:23]
v_pk_mul_f32 v[32:33], v[32:33], v[24:25]
v_pk_mul_f32 v[34:35], v[34:35], v[26:27]
v_exp_f32 v28, v28
v_exp_f32 v29, v29
v_exp_f32 v30, v30
v_exp_f32 v31, v31
v_exp_f32 v32, v32
v_exp_f32 v33, v33
v_exp_f32 v34, v34
v_exp_f32 v35, v35
v_pk_add_f32 v[28:29], v[28:29], v[244:245]
v_pk_add_f32 v[30:31], v[30:31], v[244:245]
v_pk_add_f32 v[32:33], v[32:33], v[244:245]
v_pk_add_f32 v[34:35], v[34:35], v[244:245]
v_rcp_f32 v28, v28
v_rcp_f32 v29, v29
v_rcp_f32 v30, v30
v_rcp_f32 v31, v31
v_rcp_f32 v32, v32
v_rcp_f32 v33, v33
v_rcp_f32 v34, v34
v_rcp_f32 v35, v35
v_pk_mul_f32 v[20:21], v[28:29], v[20:21]
v_pk_mul_f32 v[22:23], v[30:31], v[22:23]
v_pk_mul_f32 v[24:25], v[32:33], v[24:25]
v_pk_mul_f32 v[26:27], v[34:35], v[26:27]
v_cvt_pk_bf16_f32 v36, v20, v21
v_cvt_pk_bf16_f32 v37, v22, v23
v_cvt_pk_bf16_f32 v38, v24, v25
v_cvt_pk_bf16_f32 v39, v26, v27
buffer_store_dwordx4 v[36:39], v251, s[4:7], s53 offen offset:1024 sc1
v_accvgpr_read_b32 v40, a112
v_accvgpr_read_b32 v41, a113
v_accvgpr_read_b32 v42, a114
v_accvgpr_read_b32 v43, a115
v_accvgpr_read_b32 v44, a116
v_accvgpr_read_b32 v45, a117
v_accvgpr_read_b32 v46, a118
v_accvgpr_read_b32 v47, a119
v_pk_mul_f32 v[48:49], v[40:41], v[40:41]
v_pk_mul_f32 v[50:51], v[42:43], v[42:43]
v_pk_mul_f32 v[52:53], v[44:45], v[44:45]
v_pk_mul_f32 v[54:55], v[46:47], v[46:47]
v_pk_fma_f32 v[48:49], v[48:49], v[242:243], v[240:241]
v_pk_fma_f32 v[50:51], v[50:51], v[242:243], v[240:241]
v_pk_fma_f32 v[52:53], v[52:53], v[242:243], v[240:241]
v_pk_fma_f32 v[54:55], v[54:55], v[242:243], v[240:241]
v_pk_mul_f32 v[48:49], v[48:49], v[40:41]
v_pk_mul_f32 v[50:51], v[50:51], v[42:43]
v_pk_mul_f32 v[52:53], v[52:53], v[44:45]
v_pk_mul_f32 v[54:55], v[54:55], v[46:47]
v_exp_f32 v48, v48
v_exp_f32 v49, v49
v_exp_f32 v50, v50
v_exp_f32 v51, v51
v_exp_f32 v52, v52
v_exp_f32 v53, v53
v_exp_f32 v54, v54
v_exp_f32 v55, v55
v_pk_add_f32 v[48:49], v[48:49], v[244:245]
v_pk_add_f32 v[50:51], v[50:51], v[244:245]
v_pk_add_f32 v[52:53], v[52:53], v[244:245]
v_pk_add_f32 v[54:55], v[54:55], v[244:245]
v_rcp_f32 v48, v48
v_rcp_f32 v49, v49
v_rcp_f32 v50, v50
v_rcp_f32 v51, v51
v_rcp_f32 v52, v52
v_rcp_f32 v53, v53
v_rcp_f32 v54, v54
v_rcp_f32 v55, v55
v_pk_mul_f32 v[40:41], v[48:49], v[40:41]
v_pk_mul_f32 v[42:43], v[50:51], v[42:43]
v_pk_mul_f32 v[44:45], v[52:53], v[44:45]
v_pk_mul_f32 v[46:47], v[54:55], v[46:47]
v_cvt_pk_bf16_f32 v56, v40, v41
v_cvt_pk_bf16_f32 v57, v42, v43
v_cvt_pk_bf16_f32 v58, v44, v45
v_cvt_pk_bf16_f32 v59, v46, v47
buffer_store_dwordx4 v[56:59], v251, s[4:7], s53 offen offset:2048 sc1
v_accvgpr_read_b32 v0, a120
v_accvgpr_read_b32 v1, a121
v_accvgpr_read_b32 v2, a122
v_accvgpr_read_b32 v3, a123
v_accvgpr_read_b32 v4, a124
v_accvgpr_read_b32 v5, a125
v_accvgpr_read_b32 v6, a126
v_accvgpr_read_b32 v7, a127
v_pk_mul_f32 v[8:9], v[0:1], v[0:1]
v_pk_mul_f32 v[10:11], v[2:3], v[2:3]
v_pk_mul_f32 v[12:13], v[4:5], v[4:5]
v_pk_mul_f32 v[14:15], v[6:7], v[6:7]
v_pk_fma_f32 v[8:9], v[8:9], v[242:243], v[240:241]
v_pk_fma_f32 v[10:11], v[10:11], v[242:243], v[240:241]
v_pk_fma_f32 v[12:13], v[12:13], v[242:243], v[240:241]
v_pk_fma_f32 v[14:15], v[14:15], v[242:243], v[240:241]
v_pk_mul_f32 v[8:9], v[8:9], v[0:1]
v_pk_mul_f32 v[10:11], v[10:11], v[2:3]
v_pk_mul_f32 v[12:13], v[12:13], v[4:5]
v_pk_mul_f32 v[14:15], v[14:15], v[6:7]
v_exp_f32 v8, v8
v_exp_f32 v9, v9
v_exp_f32 v10, v10
v_exp_f32 v11, v11
v_exp_f32 v12, v12
v_exp_f32 v13, v13
v_exp_f32 v14, v14
v_exp_f32 v15, v15
v_pk_add_f32 v[8:9], v[8:9], v[244:245]
v_pk_add_f32 v[10:11], v[10:11], v[244:245]
v_pk_add_f32 v[12:13], v[12:13], v[244:245]
v_pk_add_f32 v[14:15], v[14:15], v[244:245]
v_rcp_f32 v8, v8
v_rcp_f32 v9, v9
v_rcp_f32 v10, v10
v_rcp_f32 v11, v11
v_rcp_f32 v12, v12
v_rcp_f32 v13, v13
v_rcp_f32 v14, v14
v_rcp_f32 v15, v15
v_pk_mul_f32 v[0:1], v[8:9], v[0:1]
v_pk_mul_f32 v[2:3], v[10:11], v[2:3]
v_pk_mul_f32 v[4:5], v[12:13], v[4:5]
v_pk_mul_f32 v[6:7], v[14:15], v[6:7]
v_cvt_pk_bf16_f32 v16, v0, v1
v_cvt_pk_bf16_f32 v17, v2, v3
v_cvt_pk_bf16_f32 v18, v4, v5
v_cvt_pk_bf16_f32 v19, v6, v7
buffer_store_dwordx4 v[16:19], v251, s[4:7], s53 offen offset:3072 sc1
main_kernel_w_ee:
s_cmp_eq_u32 s58, 0
s_cbranch_scc1 main_kernel_w_c0_n_ent
s_cmp_eq_u32 s58, 1
s_cbranch_scc1 main_kernel_w_c0_v_ent
s_cmp_eq_u32 s58, 2
s_cbranch_scc1 main_kernel_w_c1_n_ent
s_cmp_eq_u32 s58, 3
s_cbranch_scc1 main_kernel_w_c1_v_ent
s_branch main_kernel_w_drain
main_kernel_w_pref:
s_cmp_lg_u32 s24, 0
s_cbranch_scc1 main_kernel_w_pf0
s_mov_b32 s8, s64
s_and_b32 s9, s65, 0xffff
s_mov_b32 s10, 0x200000
s_mov_b32 s11, 0x20000
s_branch main_kernel_w_pfg
main_kernel_w_pf0:
s_cmp_lg_u32 s24, 1
s_cbranch_scc1 main_kernel_w_pf1
s_mov_b32 s8, s66
s_and_b32 s9, s67, 0xffff
s_mov_b32 s10, 0x200000
s_mov_b32 s11, 0x20000
s_branch main_kernel_w_pfg
main_kernel_w_pf1:
s_cmp_lg_u32 s24, 2
s_cbranch_scc1 main_kernel_w_pf2
s_mov_b32 s8, s68
s_and_b32 s9, s69, 0xffff
s_mov_b32 s10, 0x700000
s_mov_b32 s11, 0x20000
s_branch main_kernel_w_pfg
main_kernel_w_pf2:
s_mov_b32 s8, s70
s_and_b32 s9, s71, 0xffff
s_mov_b32 s10, 0x700000
s_mov_b32 s11, 0x20000
main_kernel_w_pfg:
s_lshl_b32 s32, s25, 19
s_lshl_b32 s33, s14, 17
s_add_u32 s32, s32, s33
v_lshlrev_b32 v253, 7, v250
buffer_load_dword v0, v253, s[8:11], s32 offen
s_add_u32 s32, s32, 8192
buffer_load_dword v0, v253, s[8:11], s32 offen
s_add_u32 s32, s32, 8192
buffer_load_dword v0, v253, s[8:11], s32 offen
s_add_u32 s32, s32, 8192
buffer_load_dword v0, v253, s[8:11], s32 offen
s_add_u32 s32, s32, 8192
buffer_load_dword v0, v253, s[8:11], s32 offen
s_add_u32 s32, s32, 8192
buffer_load_dword v0, v253, s[8:11], s32 offen
s_add_u32 s32, s32, 8192
buffer_load_dword v0, v253, s[8:11], s32 offen
s_add_u32 s32, s32, 8192
buffer_load_dword v0, v253, s[8:11], s32 offen
s_add_u32 s32, s32, 8192
buffer_load_dword v0, v253, s[8:11], s32 offen
s_add_u32 s32, s32, 8192
buffer_load_dword v0, v253, s[8:11], s32 offen
s_add_u32 s32, s32, 8192
buffer_load_dword v0, v253, s[8:11], s32 offen
s_add_u32 s32, s32, 8192
buffer_load_dword v0, v253, s[8:11], s32 offen
s_add_u32 s32, s32, 8192
buffer_load_dword v0, v253, s[8:11], s32 offen
s_add_u32 s32, s32, 8192
buffer_load_dword v0, v253, s[8:11], s32 offen
s_add_u32 s32, s32, 8192
buffer_load_dword v0, v253, s[8:11], s32 offen
s_add_u32 s32, s32, 8192
buffer_load_dword v0, v253, s[8:11], s32 offen
s_add_u32 s32, s32, 8192
s_branch main_kernel_w_done
main_kernel_w_fill:
s_lshl_b32 s32, s24, 2
s_add_u32 s32, s32, s25
s_lshl_b32 s33, s32, 16
s_add_u32 s32, s33, 0x6e00000
s_add_u32 s35, s33, 0x8c00000
s_add_u32 s33, s33, 0x8000000
s_lshl_b32 s34, s14, 12
v_add_u32 v253, s34, v251
v_mov_b32 v0, -1
v_mov_b32 v1, -1
v_mov_b32 v2, -1
v_mov_b32 v3, -1
s_mov_b32 s18, 4
main_kernel_w_fl:
buffer_store_dwordx4 v[0:3], v253, s[4:7], s32 offen offset:0 sc1
buffer_store_dwordx4 v[0:3], v253, s[4:7], s32 offen offset:1024 sc1
buffer_store_dwordx4 v[0:3], v253, s[4:7], s32 offen offset:2048 sc1
buffer_store_dwordx4 v[0:3], v253, s[4:7], s32 offen offset:3072 sc1
s_add_u32 s32, s32, 16384
buffer_store_dwordx4 v[0:3], v253, s[4:7], s33 offen offset:0 sc1
buffer_store_dwordx4 v[0:3], v253, s[4:7], s33 offen offset:1024 sc1
buffer_store_dwordx4 v[0:3], v253, s[4:7], s33 offen offset:2048 sc1
buffer_store_dwordx4 v[0:3], v253, s[4:7], s33 offen offset:3072 sc1
s_add_u32 s33, s33, 16384
buffer_store_dwordx4 v[0:3], v253, s[4:7], s35 offen offset:0 sc1
buffer_store_dwordx4 v[0:3], v253, s[4:7], s35 offen offset:1024 sc1
buffer_store_dwordx4 v[0:3], v253, s[4:7], s35 offen offset:2048 sc1
buffer_store_dwordx4 v[0:3], v253, s[4:7], s35 offen offset:3072 sc1
s_add_u32 s35, s35, 16384
s_sub_u32 s18, s18, 1
s_cmp_lg_u32 s18, 0
s_cbranch_scc1 main_kernel_w_fl
s_branch main_kernel_w_done
main_kernel_w_ln2:
s_lshl_b32 s32, s24, 3
s_mul_i32 s33, s25, 2
s_add_u32 s32, s32, s33
s_lshl_b32 s32, s32, 15
s_lshl_b32 s33, s14, 13
s_add_u32 s32, s32, s33
s_add_u32 s21, s32, 0x6800000
s_add_u32 s32, s32, 0x5000000
buffer_load_dwordx4 v[0:3], v251, s[4:7], s32 offen offset:0 sc1
buffer_load_dwordx4 v[4:7], v251, s[4:7], s32 offen offset:1024 sc1
buffer_load_dwordx4 v[8:11], v251, s[4:7], s32 offen offset:2048 sc1
buffer_load_dwordx4 v[12:15], v251, s[4:7], s32 offen offset:3072 sc1
s_add_u32 s32, s32, 4096
buffer_load_dwordx4 v[16:19], v251, s[4:7], s32 offen offset:0 sc1
buffer_load_dwordx4 v[20:23], v251, s[4:7], s32 offen offset:1024 sc1
buffer_load_dwordx4 v[24:27], v251, s[4:7], s32 offen offset:2048 sc1
buffer_load_dwordx4 v[28:31], v251, s[4:7], s32 offen offset:3072 sc1
s_add_u32 s32, s32, 28672
buffer_load_dwordx4 v[32:35], v251, s[4:7], s32 offen offset:0 sc1
buffer_load_dwordx4 v[36:39], v251, s[4:7], s32 offen offset:1024 sc1
buffer_load_dwordx4 v[40:43], v251, s[4:7], s32 offen offset:2048 sc1
buffer_load_dwordx4 v[44:47], v251, s[4:7], s32 offen offset:3072 sc1
s_add_u32 s32, s32, 4096
buffer_load_dwordx4 v[48:51], v251, s[4:7], s32 offen offset:0 sc1
buffer_load_dwordx4 v[52:55], v251, s[4:7], s32 offen offset:1024 sc1
buffer_load_dwordx4 v[56:59], v251, s[4:7], s32 offen offset:2048 sc1
buffer_load_dwordx4 v[60:63], v251, s[4:7], s32 offen offset:3072 sc1
s_add_u32 s32, s32, 28672
v_and_b32 v255, 15, v250
v_lshlrev_b32 v254, 6, v255
v_add_u32 v254, 132096, v254
v_lshrrev_b32 v255, 4, v250
v_lshl_add_u32 v253, v255, 2, v254
v_lshl_add_u32 v253, s14, 4, v253
s_waitcnt vmcnt(8)
v_lshlrev_b32 v128, 16, v0
v_and_b32 v129, 0xffff0000, v0
v_lshlrev_b32 v130, 16, v1
v_and_b32 v131, 0xffff0000, v1
v_lshlrev_b32 v132, 16, v2
v_and_b32 v133, 0xffff0000, v2
v_lshlrev_b32 v134, 16, v3
v_and_b32 v135, 0xffff0000, v3
v_lshlrev_b32 v136, 16, v4
v_and_b32 v137, 0xffff0000, v4
v_lshlrev_b32 v138, 16, v5
v_and_b32 v139, 0xffff0000, v5
v_lshlrev_b32 v140, 16, v6
v_and_b32 v141, 0xffff0000, v6
v_lshlrev_b32 v142, 16, v7
v_and_b32 v143, 0xffff0000, v7
v_lshlrev_b32 v144, 16, v8
v_and_b32 v145, 0xffff0000, v8
v_lshlrev_b32 v146, 16, v9
v_and_b32 v147, 0xffff0000, v9
v_lshlrev_b32 v148, 16, v10
v_and_b32 v149, 0xffff0000, v10
v_lshlrev_b32 v150, 16, v11
v_and_b32 v151, 0xffff0000, v11
v_lshlrev_b32 v152, 16, v12
v_and_b32 v153, 0xffff0000, v12
v_lshlrev_b32 v154, 16, v13
v_and_b32 v155, 0xffff0000, v13
v_lshlrev_b32 v156, 16, v14
v_and_b32 v157, 0xffff0000, v14
v_lshlrev_b32 v158, 16, v15
v_and_b32 v159, 0xffff0000, v15
v_lshlrev_b32 v160, 16, v16
v_and_b32 v161, 0xffff0000, v16
v_lshlrev_b32 v162, 16, v17
v_and_b32 v163, 0xffff0000, v17
v_lshlrev_b32 v164, 16, v18
v_and_b32 v165, 0xffff0000, v18
v_lshlrev_b32 v166, 16, v19
v_and_b32 v167, 0xffff0000, v19
v_lshlrev_b32 v168, 16, v20
v_and_b32 v169, 0xffff0000, v20
v_lshlrev_b32 v170, 16, v21
v_and_b32 v171, 0xffff0000, v21
v_lshlrev_b32 v172, 16, v22
v_and_b32 v173, 0xffff0000, v22
v_lshlrev_b32 v174, 16, v23
v_and_b32 v175, 0xffff0000, v23
v_lshlrev_b32 v176, 16, v24
v_and_b32 v177, 0xffff0000, v24
v_lshlrev_b32 v178, 16, v25
v_and_b32 v179, 0xffff0000, v25
v_lshlrev_b32 v180, 16, v26
v_and_b32 v181, 0xffff0000, v26
v_lshlrev_b32 v182, 16, v27
v_and_b32 v183, 0xffff0000, v27
v_lshlrev_b32 v184, 16, v28
v_and_b32 v185, 0xffff0000, v28
v_lshlrev_b32 v186, 16, v29
v_and_b32 v187, 0xffff0000, v29
v_lshlrev_b32 v188, 16, v30
v_and_b32 v189, 0xffff0000, v30
v_lshlrev_b32 v190, 16, v31
v_and_b32 v191, 0xffff0000, v31
v_pk_add_f32 v[192:193], v[128:129], v[136:137]
v_pk_add_f32 v[194:195], v[130:131], v[138:139]
v_pk_add_f32 v[196:197], v[132:133], v[140:141]
v_pk_add_f32 v[198:199], v[134:135], v[142:143]
v_pk_add_f32 v[192:193], v[192:193], v[144:145]
v_pk_add_f32 v[194:195], v[194:195], v[146:147]
v_pk_add_f32 v[196:197], v[196:197], v[148:149]
v_pk_add_f32 v[198:199], v[198:199], v[150:151]
v_pk_add_f32 v[192:193], v[192:193], v[152:153]
v_pk_add_f32 v[194:195], v[194:195], v[154:155]
v_pk_add_f32 v[196:197], v[196:197], v[156:157]
v_pk_add_f32 v[198:199], v[198:199], v[158:159]
v_pk_add_f32 v[192:193], v[192:193], v[160:161]
v_pk_add_f32 v[194:195], v[194:195], v[162:163]
v_pk_add_f32 v[196:197], v[196:197], v[164:165]
v_pk_add_f32 v[198:199], v[198:199], v[166:167]
v_pk_add_f32 v[192:193], v[192:193], v[168:169]
v_pk_add_f32 v[194:195], v[194:195], v[170:171]
v_pk_add_f32 v[196:197], v[196:197], v[172:173]
v_pk_add_f32 v[198:199], v[198:199], v[174:175]
v_pk_add_f32 v[192:193], v[192:193], v[176:177]
v_pk_add_f32 v[194:195], v[194:195], v[178:179]
v_pk_add_f32 v[196:197], v[196:197], v[180:181]
v_pk_add_f32 v[198:199], v[198:199], v[182:183]
v_pk_add_f32 v[192:193], v[192:193], v[184:185]
v_pk_add_f32 v[194:195], v[194:195], v[186:187]
v_pk_add_f32 v[196:197], v[196:197], v[188:189]
v_pk_add_f32 v[198:199], v[198:199], v[190:191]
v_pk_add_f32 v[192:193], v[192:193], v[194:195]
v_pk_add_f32 v[196:197], v[196:197], v[198:199]
v_pk_add_f32 v[192:193], v[192:193], v[196:197]
v_add_f32 v192, v192, v193
ds_write_b32 v253, v192 offset:0
s_waitcnt lgkmcnt(0)
s_barrier
ds_read_b128 v[192:195], v254 offset:0
ds_read_b128 v[196:199], v254 offset:16
ds_read_b128 v[200:203], v254 offset:32
ds_read_b128 v[204:207], v254 offset:48
s_waitcnt lgkmcnt(2)
v_pk_add_f32 v[192:193], v[192:193], v[194:195]
v_pk_add_f32 v[196:197], v[196:197], v[198:199]
s_waitcnt lgkmcnt(0)
v_pk_add_f32 v[200:201], v[200:201], v[202:203]
v_pk_add_f32 v[204:205], v[204:205], v[206:207]
v_pk_add_f32 v[192:193], v[192:193], v[196:197]
v_pk_add_f32 v[200:201], v[200:201], v[204:205]
v_pk_add_f32 v[192:193], v[192:193], v[200:201]
v_add_f32 v192, v192, v193
v_mul_f32 v192, 0xba800000, v192
v_mov_b32 v193, v192
v_pk_add_f32 v[128:129], v[128:129], v[192:193]
v_pk_add_f32 v[130:131], v[130:131], v[192:193]
v_pk_add_f32 v[132:133], v[132:133], v[192:193]
v_pk_add_f32 v[134:135], v[134:135], v[192:193]
v_pk_add_f32 v[136:137], v[136:137], v[192:193]
v_pk_add_f32 v[138:139], v[138:139], v[192:193]
v_pk_add_f32 v[140:141], v[140:141], v[192:193]
v_pk_add_f32 v[142:143], v[142:143], v[192:193]
v_pk_add_f32 v[144:145], v[144:145], v[192:193]
v_pk_add_f32 v[146:147], v[146:147], v[192:193]
v_pk_add_f32 v[148:149], v[148:149], v[192:193]
v_pk_add_f32 v[150:151], v[150:151], v[192:193]
v_pk_add_f32 v[152:153], v[152:153], v[192:193]
v_pk_add_f32 v[154:155], v[154:155], v[192:193]
v_pk_add_f32 v[156:157], v[156:157], v[192:193]
v_pk_add_f32 v[158:159], v[158:159], v[192:193]
v_pk_add_f32 v[160:161], v[160:161], v[192:193]
v_pk_add_f32 v[162:163], v[162:163], v[192:193]
v_pk_add_f32 v[164:165], v[164:165], v[192:193]
v_pk_add_f32 v[166:167], v[166:167], v[192:193]
v_pk_add_f32 v[168:169], v[168:169], v[192:193]
v_pk_add_f32 v[170:171], v[170:171], v[192:193]
v_pk_add_f32 v[172:173], v[172:173], v[192:193]
v_pk_add_f32 v[174:175], v[174:175], v[192:193]
v_pk_add_f32 v[176:177], v[176:177], v[192:193]
v_pk_add_f32 v[178:179], v[178:179], v[192:193]
v_pk_add_f32 v[180:181], v[180:181], v[192:193]
v_pk_add_f32 v[182:183], v[182:183], v[192:193]
v_pk_add_f32 v[184:185], v[184:185], v[192:193]
v_pk_add_f32 v[186:187], v[186:187], v[192:193]
v_pk_add_f32 v[188:189], v[188:189], v[192:193]
v_pk_add_f32 v[190:191], v[190:191], v[192:193]
v_pk_mul_f32 v[192:193], v[128:129], v[128:129]
v_pk_mul_f32 v[194:195], v[130:131], v[130:131]
v_pk_mul_f32 v[196:197], v[132:133], v[132:133]
v_pk_mul_f32 v[198:199], v[134:135], v[134:135]
v_pk_fma_f32 v[192:193], v[136:137], v[136:137], v[192:193]
v_pk_fma_f32 v[194:195], v[138:139], v[138:139], v[194:195]
v_pk_fma_f32 v[196:197], v[140:141], v[140:141], v[196:197]
v_pk_fma_f32 v[198:199], v[142:143], v[142:143], v[198:199]
v_pk_fma_f32 v[192:193], v[144:145], v[144:145], v[192:193]
v_pk_fma_f32 v[194:195], v[146:147], v[146:147], v[194:195]
v_pk_fma_f32 v[196:197], v[148:149], v[148:149], v[196:197]
v_pk_fma_f32 v[198:199], v[150:151], v[150:151], v[198:199]
v_pk_fma_f32 v[192:193], v[152:153], v[152:153], v[192:193]
v_pk_fma_f32 v[194:195], v[154:155], v[154:155], v[194:195]
v_pk_fma_f32 v[196:197], v[156:157], v[156:157], v[196:197]
v_pk_fma_f32 v[198:199], v[158:159], v[158:159], v[198:199]
v_pk_fma_f32 v[192:193], v[160:161], v[160:161], v[192:193]
v_pk_fma_f32 v[194:195], v[162:163], v[162:163], v[194:195]
v_pk_fma_f32 v[196:197], v[164:165], v[164:165], v[196:197]
v_pk_fma_f32 v[198:199], v[166:167], v[166:167], v[198:199]
v_pk_fma_f32 v[192:193], v[168:169], v[168:169], v[192:193]
v_pk_fma_f32 v[194:195], v[170:171], v[170:171], v[194:195]
v_pk_fma_f32 v[196:197], v[172:173], v[172:173], v[196:197]
v_pk_fma_f32 v[198:199], v[174:175], v[174:175], v[198:199]
v_pk_fma_f32 v[192:193], v[176:177], v[176:177], v[192:193]
v_pk_fma_f32 v[194:195], v[178:179], v[178:179], v[194:195]
v_pk_fma_f32 v[196:197], v[180:181], v[180:181], v[196:197]
v_pk_fma_f32 v[198:199], v[182:183], v[182:183], v[198:199]
v_pk_fma_f32 v[192:193], v[184:185], v[184:185], v[192:193]
v_pk_fma_f32 v[194:195], v[186:187], v[186:187], v[194:195]
v_pk_fma_f32 v[196:197], v[188:189], v[188:189], v[196:197]
v_pk_fma_f32 v[198:199], v[190:191], v[190:191], v[198:199]
v_pk_add_f32 v[192:193], v[192:193], v[194:195]
v_pk_add_f32 v[196:197], v[196:197], v[198:199]
v_pk_add_f32 v[192:193], v[192:193], v[196:197]
v_add_f32 v192, v192, v193
ds_write_b32 v253, v192 offset:1024
s_waitcnt lgkmcnt(0)
s_barrier
ds_read_b128 v[192:195], v254 offset:1024
ds_read_b128 v[196:199], v254 offset:1040
ds_read_b128 v[200:203], v254 offset:1056
ds_read_b128 v[204:207], v254 offset:1072
s_waitcnt lgkmcnt(2)
v_pk_add_f32 v[192:193], v[192:193], v[194:195]
v_pk_add_f32 v[196:197], v[196:197], v[198:199]
s_waitcnt lgkmcnt(0)
v_pk_add_f32 v[200:201], v[200:201], v[202:203]
v_pk_add_f32 v[204:205], v[204:205], v[206:207]
v_pk_add_f32 v[192:193], v[192:193], v[196:197]
v_pk_add_f32 v[200:201], v[200:201], v[204:205]
v_pk_add_f32 v[192:193], v[192:193], v[200:201]
v_add_f32 v192, v192, v193
v_mov_b32 v193, 0x3727c5ac
v_fmac_f32 v193, 0x3a800000, v192
v_rsq_f32 v192, v193
s_nop 0
v_mov_b32 v193, v192
v_pk_mul_f32 v[128:129], v[128:129], v[192:193]
v_pk_mul_f32 v[130:131], v[130:131], v[192:193]
v_pk_mul_f32 v[132:133], v[132:133], v[192:193]
v_pk_mul_f32 v[134:135], v[134:135], v[192:193]
v_pk_mul_f32 v[136:137], v[136:137], v[192:193]
v_pk_mul_f32 v[138:139], v[138:139], v[192:193]
v_pk_mul_f32 v[140:141], v[140:141], v[192:193]
v_pk_mul_f32 v[142:143], v[142:143], v[192:193]
v_pk_mul_f32 v[144:145], v[144:145], v[192:193]
v_pk_mul_f32 v[146:147], v[146:147], v[192:193]
v_pk_mul_f32 v[148:149], v[148:149], v[192:193]
v_pk_mul_f32 v[150:151], v[150:151], v[192:193]
v_pk_mul_f32 v[152:153], v[152:153], v[192:193]
v_pk_mul_f32 v[154:155], v[154:155], v[192:193]
v_pk_mul_f32 v[156:157], v[156:157], v[192:193]
v_pk_mul_f32 v[158:159], v[158:159], v[192:193]
v_pk_mul_f32 v[160:161], v[160:161], v[192:193]
v_pk_mul_f32 v[162:163], v[162:163], v[192:193]
v_pk_mul_f32 v[164:165], v[164:165], v[192:193]
v_pk_mul_f32 v[166:167], v[166:167], v[192:193]
v_pk_mul_f32 v[168:169], v[168:169], v[192:193]
v_pk_mul_f32 v[170:171], v[170:171], v[192:193]
v_pk_mul_f32 v[172:173], v[172:173], v[192:193]
v_pk_mul_f32 v[174:175], v[174:175], v[192:193]
v_pk_mul_f32 v[176:177], v[176:177], v[192:193]
v_pk_mul_f32 v[178:179], v[178:179], v[192:193]
v_pk_mul_f32 v[180:181], v[180:181], v[192:193]
v_pk_mul_f32 v[182:183], v[182:183], v[192:193]
v_pk_mul_f32 v[184:185], v[184:185], v[192:193]
v_pk_mul_f32 v[186:187], v[186:187], v[192:193]
v_pk_mul_f32 v[188:189], v[188:189], v[192:193]
v_pk_mul_f32 v[190:191], v[190:191], v[192:193]
v_cvt_pk_bf16_f32 v0, v128, v129
v_cvt_pk_bf16_f32 v1, v130, v131
v_cvt_pk_bf16_f32 v2, v132, v133
v_cvt_pk_bf16_f32 v3, v134, v135
v_cvt_pk_bf16_f32 v4, v136, v137
v_cvt_pk_bf16_f32 v5, v138, v139
v_cvt_pk_bf16_f32 v6, v140, v141
v_cvt_pk_bf16_f32 v7, v142, v143
v_cvt_pk_bf16_f32 v8, v144, v145
v_cvt_pk_bf16_f32 v9, v146, v147
v_cvt_pk_bf16_f32 v10, v148, v149
v_cvt_pk_bf16_f32 v11, v150, v151
v_cvt_pk_bf16_f32 v12, v152, v153
v_cvt_pk_bf16_f32 v13, v154, v155
v_cvt_pk_bf16_f32 v14, v156, v157
v_cvt_pk_bf16_f32 v15, v158, v159
v_cvt_pk_bf16_f32 v16, v160, v161
v_cvt_pk_bf16_f32 v17, v162, v163
v_cvt_pk_bf16_f32 v18, v164, v165
v_cvt_pk_bf16_f32 v19, v166, v167
v_cvt_pk_bf16_f32 v20, v168, v169
v_cvt_pk_bf16_f32 v21, v170, v171
v_cvt_pk_bf16_f32 v22, v172, v173
v_cvt_pk_bf16_f32 v23, v174, v175
v_cvt_pk_bf16_f32 v24, v176, v177
v_cvt_pk_bf16_f32 v25, v178, v179
v_cvt_pk_bf16_f32 v26, v180, v181
v_cvt_pk_bf16_f32 v27, v182, v183
v_cvt_pk_bf16_f32 v28, v184, v185
v_cvt_pk_bf16_f32 v29, v186, v187
v_cvt_pk_bf16_f32 v30, v188, v189
v_cvt_pk_bf16_f32 v31, v190, v191
buffer_store_dwordx4 v[0:3], v251, s[4:7], s21 offen offset:0 sc1
buffer_store_dwordx4 v[4:7], v251, s[4:7], s21 offen offset:1024 sc1
buffer_store_dwordx4 v[8:11], v251, s[4:7], s21 offen offset:2048 sc1
buffer_store_dwordx4 v[12:15], v251, s[4:7], s21 offen offset:3072 sc1
s_add_u32 s21, s21, 4096
buffer_store_dwordx4 v[16:19], v251, s[4:7], s21 offen offset:0 sc1
buffer_store_dwordx4 v[20:23], v251, s[4:7], s21 offen offset:1024 sc1
buffer_store_dwordx4 v[24:27], v251, s[4:7], s21 offen offset:2048 sc1
buffer_store_dwordx4 v[28:31], v251, s[4:7], s21 offen offset:3072 sc1
s_add_u32 s21, s21, 28672
s_waitcnt vmcnt(8)
v_lshlrev_b32 v128, 16, v32
v_and_b32 v129, 0xffff0000, v32
v_lshlrev_b32 v130, 16, v33
v_and_b32 v131, 0xffff0000, v33
v_lshlrev_b32 v132, 16, v34
v_and_b32 v133, 0xffff0000, v34
v_lshlrev_b32 v134, 16, v35
v_and_b32 v135, 0xffff0000, v35
v_lshlrev_b32 v136, 16, v36
v_and_b32 v137, 0xffff0000, v36
v_lshlrev_b32 v138, 16, v37
v_and_b32 v139, 0xffff0000, v37
v_lshlrev_b32 v140, 16, v38
v_and_b32 v141, 0xffff0000, v38
v_lshlrev_b32 v142, 16, v39
v_and_b32 v143, 0xffff0000, v39
v_lshlrev_b32 v144, 16, v40
v_and_b32 v145, 0xffff0000, v40
v_lshlrev_b32 v146, 16, v41
v_and_b32 v147, 0xffff0000, v41
v_lshlrev_b32 v148, 16, v42
v_and_b32 v149, 0xffff0000, v42
v_lshlrev_b32 v150, 16, v43
v_and_b32 v151, 0xffff0000, v43
v_lshlrev_b32 v152, 16, v44
v_and_b32 v153, 0xffff0000, v44
v_lshlrev_b32 v154, 16, v45
v_and_b32 v155, 0xffff0000, v45
v_lshlrev_b32 v156, 16, v46
v_and_b32 v157, 0xffff0000, v46
v_lshlrev_b32 v158, 16, v47
v_and_b32 v159, 0xffff0000, v47
v_lshlrev_b32 v160, 16, v48
v_and_b32 v161, 0xffff0000, v48
v_lshlrev_b32 v162, 16, v49
v_and_b32 v163, 0xffff0000, v49
v_lshlrev_b32 v164, 16, v50
v_and_b32 v165, 0xffff0000, v50
v_lshlrev_b32 v166, 16, v51
v_and_b32 v167, 0xffff0000, v51
v_lshlrev_b32 v168, 16, v52
v_and_b32 v169, 0xffff0000, v52
v_lshlrev_b32 v170, 16, v53
v_and_b32 v171, 0xffff0000, v53
v_lshlrev_b32 v172, 16, v54
v_and_b32 v173, 0xffff0000, v54
v_lshlrev_b32 v174, 16, v55
v_and_b32 v175, 0xffff0000, v55
v_lshlrev_b32 v176, 16, v56
v_and_b32 v177, 0xffff0000, v56
v_lshlrev_b32 v178, 16, v57
v_and_b32 v179, 0xffff0000, v57
v_lshlrev_b32 v180, 16, v58
v_and_b32 v181, 0xffff0000, v58
v_lshlrev_b32 v182, 16, v59
v_and_b32 v183, 0xffff0000, v59
v_lshlrev_b32 v184, 16, v60
v_and_b32 v185, 0xffff0000, v60
v_lshlrev_b32 v186, 16, v61
v_and_b32 v187, 0xffff0000, v61
v_lshlrev_b32 v188, 16, v62
v_and_b32 v189, 0xffff0000, v62
v_lshlrev_b32 v190, 16, v63
v_and_b32 v191, 0xffff0000, v63
v_pk_add_f32 v[192:193], v[128:129], v[136:137]
v_pk_add_f32 v[194:195], v[130:131], v[138:139]
v_pk_add_f32 v[196:197], v[132:133], v[140:141]
v_pk_add_f32 v[198:199], v[134:135], v[142:143]
v_pk_add_f32 v[192:193], v[192:193], v[144:145]
v_pk_add_f32 v[194:195], v[194:195], v[146:147]
v_pk_add_f32 v[196:197], v[196:197], v[148:149]
v_pk_add_f32 v[198:199], v[198:199], v[150:151]
v_pk_add_f32 v[192:193], v[192:193], v[152:153]
v_pk_add_f32 v[194:195], v[194:195], v[154:155]
v_pk_add_f32 v[196:197], v[196:197], v[156:157]
v_pk_add_f32 v[198:199], v[198:199], v[158:159]
v_pk_add_f32 v[192:193], v[192:193], v[160:161]
v_pk_add_f32 v[194:195], v[194:195], v[162:163]
v_pk_add_f32 v[196:197], v[196:197], v[164:165]
v_pk_add_f32 v[198:199], v[198:199], v[166:167]
v_pk_add_f32 v[192:193], v[192:193], v[168:169]
v_pk_add_f32 v[194:195], v[194:195], v[170:171]
v_pk_add_f32 v[196:197], v[196:197], v[172:173]
v_pk_add_f32 v[198:199], v[198:199], v[174:175]
v_pk_add_f32 v[192:193], v[192:193], v[176:177]
v_pk_add_f32 v[194:195], v[194:195], v[178:179]
v_pk_add_f32 v[196:197], v[196:197], v[180:181]
v_pk_add_f32 v[198:199], v[198:199], v[182:183]
v_pk_add_f32 v[192:193], v[192:193], v[184:185]
v_pk_add_f32 v[194:195], v[194:195], v[186:187]
v_pk_add_f32 v[196:197], v[196:197], v[188:189]
v_pk_add_f32 v[198:199], v[198:199], v[190:191]
v_pk_add_f32 v[192:193], v[192:193], v[194:195]
v_pk_add_f32 v[196:197], v[196:197], v[198:199]
v_pk_add_f32 v[192:193], v[192:193], v[196:197]
v_add_f32 v192, v192, v193
ds_write_b32 v253, v192 offset:0
s_waitcnt lgkmcnt(0)
s_barrier
ds_read_b128 v[192:195], v254 offset:0
ds_read_b128 v[196:199], v254 offset:16
ds_read_b128 v[200:203], v254 offset:32
ds_read_b128 v[204:207], v254 offset:48
s_waitcnt lgkmcnt(2)
v_pk_add_f32 v[192:193], v[192:193], v[194:195]
v_pk_add_f32 v[196:197], v[196:197], v[198:199]
s_waitcnt lgkmcnt(0)
v_pk_add_f32 v[200:201], v[200:201], v[202:203]
v_pk_add_f32 v[204:205], v[204:205], v[206:207]
v_pk_add_f32 v[192:193], v[192:193], v[196:197]
v_pk_add_f32 v[200:201], v[200:201], v[204:205]
v_pk_add_f32 v[192:193], v[192:193], v[200:201]
v_add_f32 v192, v192, v193
v_mul_f32 v192, 0xba800000, v192
v_mov_b32 v193, v192
v_pk_add_f32 v[128:129], v[128:129], v[192:193]
v_pk_add_f32 v[130:131], v[130:131], v[192:193]
v_pk_add_f32 v[132:133], v[132:133], v[192:193]
v_pk_add_f32 v[134:135], v[134:135], v[192:193]
v_pk_add_f32 v[136:137], v[136:137], v[192:193]
v_pk_add_f32 v[138:139], v[138:139], v[192:193]
v_pk_add_f32 v[140:141], v[140:141], v[192:193]
v_pk_add_f32 v[142:143], v[142:143], v[192:193]
v_pk_add_f32 v[144:145], v[144:145], v[192:193]
v_pk_add_f32 v[146:147], v[146:147], v[192:193]
v_pk_add_f32 v[148:149], v[148:149], v[192:193]
v_pk_add_f32 v[150:151], v[150:151], v[192:193]
v_pk_add_f32 v[152:153], v[152:153], v[192:193]
v_pk_add_f32 v[154:155], v[154:155], v[192:193]
v_pk_add_f32 v[156:157], v[156:157], v[192:193]
v_pk_add_f32 v[158:159], v[158:159], v[192:193]
v_pk_add_f32 v[160:161], v[160:161], v[192:193]
v_pk_add_f32 v[162:163], v[162:163], v[192:193]
v_pk_add_f32 v[164:165], v[164:165], v[192:193]
v_pk_add_f32 v[166:167], v[166:167], v[192:193]
v_pk_add_f32 v[168:169], v[168:169], v[192:193]
v_pk_add_f32 v[170:171], v[170:171], v[192:193]
v_pk_add_f32 v[172:173], v[172:173], v[192:193]
v_pk_add_f32 v[174:175], v[174:175], v[192:193]
v_pk_add_f32 v[176:177], v[176:177], v[192:193]
v_pk_add_f32 v[178:179], v[178:179], v[192:193]
v_pk_add_f32 v[180:181], v[180:181], v[192:193]
v_pk_add_f32 v[182:183], v[182:183], v[192:193]
v_pk_add_f32 v[184:185], v[184:185], v[192:193]
v_pk_add_f32 v[186:187], v[186:187], v[192:193]
v_pk_add_f32 v[188:189], v[188:189], v[192:193]
v_pk_add_f32 v[190:191], v[190:191], v[192:193]
v_pk_mul_f32 v[192:193], v[128:129], v[128:129]
v_pk_mul_f32 v[194:195], v[130:131], v[130:131]
v_pk_mul_f32 v[196:197], v[132:133], v[132:133]
v_pk_mul_f32 v[198:199], v[134:135], v[134:135]
v_pk_fma_f32 v[192:193], v[136:137], v[136:137], v[192:193]
v_pk_fma_f32 v[194:195], v[138:139], v[138:139], v[194:195]
v_pk_fma_f32 v[196:197], v[140:141], v[140:141], v[196:197]
v_pk_fma_f32 v[198:199], v[142:143], v[142:143], v[198:199]
v_pk_fma_f32 v[192:193], v[144:145], v[144:145], v[192:193]
v_pk_fma_f32 v[194:195], v[146:147], v[146:147], v[194:195]
v_pk_fma_f32 v[196:197], v[148:149], v[148:149], v[196:197]
v_pk_fma_f32 v[198:199], v[150:151], v[150:151], v[198:199]
v_pk_fma_f32 v[192:193], v[152:153], v[152:153], v[192:193]
v_pk_fma_f32 v[194:195], v[154:155], v[154:155], v[194:195]
v_pk_fma_f32 v[196:197], v[156:157], v[156:157], v[196:197]
v_pk_fma_f32 v[198:199], v[158:159], v[158:159], v[198:199]
v_pk_fma_f32 v[192:193], v[160:161], v[160:161], v[192:193]
v_pk_fma_f32 v[194:195], v[162:163], v[162:163], v[194:195]
v_pk_fma_f32 v[196:197], v[164:165], v[164:165], v[196:197]
v_pk_fma_f32 v[198:199], v[166:167], v[166:167], v[198:199]
v_pk_fma_f32 v[192:193], v[168:169], v[168:169], v[192:193]
v_pk_fma_f32 v[194:195], v[170:171], v[170:171], v[194:195]
v_pk_fma_f32 v[196:197], v[172:173], v[172:173], v[196:197]
v_pk_fma_f32 v[198:199], v[174:175], v[174:175], v[198:199]
v_pk_fma_f32 v[192:193], v[176:177], v[176:177], v[192:193]
v_pk_fma_f32 v[194:195], v[178:179], v[178:179], v[194:195]
v_pk_fma_f32 v[196:197], v[180:181], v[180:181], v[196:197]
v_pk_fma_f32 v[198:199], v[182:183], v[182:183], v[198:199]
v_pk_fma_f32 v[192:193], v[184:185], v[184:185], v[192:193]
v_pk_fma_f32 v[194:195], v[186:187], v[186:187], v[194:195]
v_pk_fma_f32 v[196:197], v[188:189], v[188:189], v[196:197]
v_pk_fma_f32 v[198:199], v[190:191], v[190:191], v[198:199]
v_pk_add_f32 v[192:193], v[192:193], v[194:195]
v_pk_add_f32 v[196:197], v[196:197], v[198:199]
v_pk_add_f32 v[192:193], v[192:193], v[196:197]
v_add_f32 v192, v192, v193
ds_write_b32 v253, v192 offset:1024
s_waitcnt lgkmcnt(0)
s_barrier
ds_read_b128 v[192:195], v254 offset:1024
ds_read_b128 v[196:199], v254 offset:1040
ds_read_b128 v[200:203], v254 offset:1056
ds_read_b128 v[204:207], v254 offset:1072
s_waitcnt lgkmcnt(2)
v_pk_add_f32 v[192:193], v[192:193], v[194:195]
v_pk_add_f32 v[196:197], v[196:197], v[198:199]
s_waitcnt lgkmcnt(0)
v_pk_add_f32 v[200:201], v[200:201], v[202:203]
v_pk_add_f32 v[204:205], v[204:205], v[206:207]
v_pk_add_f32 v[192:193], v[192:193], v[196:197]
v_pk_add_f32 v[200:201], v[200:201], v[204:205]
v_pk_add_f32 v[192:193], v[192:193], v[200:201]
v_add_f32 v192, v192, v193
v_mov_b32 v193, 0x3727c5ac
v_fmac_f32 v193, 0x3a800000, v192
v_rsq_f32 v192, v193
s_nop 0
v_mov_b32 v193, v192
v_pk_mul_f32 v[128:129], v[128:129], v[192:193]
v_pk_mul_f32 v[130:131], v[130:131], v[192:193]
v_pk_mul_f32 v[132:133], v[132:133], v[192:193]
v_pk_mul_f32 v[134:135], v[134:135], v[192:193]
v_pk_mul_f32 v[136:137], v[136:137], v[192:193]
v_pk_mul_f32 v[138:139], v[138:139], v[192:193]
v_pk_mul_f32 v[140:141], v[140:141], v[192:193]
v_pk_mul_f32 v[142:143], v[142:143], v[192:193]
v_pk_mul_f32 v[144:145], v[144:145], v[192:193]
v_pk_mul_f32 v[146:147], v[146:147], v[192:193]
v_pk_mul_f32 v[148:149], v[148:149], v[192:193]
v_pk_mul_f32 v[150:151], v[150:151], v[192:193]
v_pk_mul_f32 v[152:153], v[152:153], v[192:193]
v_pk_mul_f32 v[154:155], v[154:155], v[192:193]
v_pk_mul_f32 v[156:157], v[156:157], v[192:193]
v_pk_mul_f32 v[158:159], v[158:159], v[192:193]
v_pk_mul_f32 v[160:161], v[160:161], v[192:193]
v_pk_mul_f32 v[162:163], v[162:163], v[192:193]
v_pk_mul_f32 v[164:165], v[164:165], v[192:193]
v_pk_mul_f32 v[166:167], v[166:167], v[192:193]
v_pk_mul_f32 v[168:169], v[168:169], v[192:193]
v_pk_mul_f32 v[170:171], v[170:171], v[192:193]
v_pk_mul_f32 v[172:173], v[172:173], v[192:193]
v_pk_mul_f32 v[174:175], v[174:175], v[192:193]
v_pk_mul_f32 v[176:177], v[176:177], v[192:193]
v_pk_mul_f32 v[178:179], v[178:179], v[192:193]
v_pk_mul_f32 v[180:181], v[180:181], v[192:193]
v_pk_mul_f32 v[182:183], v[182:183], v[192:193]
v_pk_mul_f32 v[184:185], v[184:185], v[192:193]
v_pk_mul_f32 v[186:187], v[186:187], v[192:193]
v_pk_mul_f32 v[188:189], v[188:189], v[192:193]
v_pk_mul_f32 v[190:191], v[190:191], v[192:193]
v_cvt_pk_bf16_f32 v32, v128, v129
v_cvt_pk_bf16_f32 v33, v130, v131
v_cvt_pk_bf16_f32 v34, v132, v133
v_cvt_pk_bf16_f32 v35, v134, v135
v_cvt_pk_bf16_f32 v36, v136, v137
v_cvt_pk_bf16_f32 v37, v138, v139
v_cvt_pk_bf16_f32 v38, v140, v141
v_cvt_pk_bf16_f32 v39, v142, v143
v_cvt_pk_bf16_f32 v40, v144, v145
v_cvt_pk_bf16_f32 v41, v146, v147
v_cvt_pk_bf16_f32 v42, v148, v149
v_cvt_pk_bf16_f32 v43, v150, v151
v_cvt_pk_bf16_f32 v44, v152, v153
v_cvt_pk_bf16_f32 v45, v154, v155
v_cvt_pk_bf16_f32 v46, v156, v157
v_cvt_pk_bf16_f32 v47, v158, v159
v_cvt_pk_bf16_f32 v48, v160, v161
v_cvt_pk_bf16_f32 v49, v162, v163
v_cvt_pk_bf16_f32 v50, v164, v165
v_cvt_pk_bf16_f32 v51, v166, v167
v_cvt_pk_bf16_f32 v52, v168, v169
v_cvt_pk_bf16_f32 v53, v170, v171
v_cvt_pk_bf16_f32 v54, v172, v173
v_cvt_pk_bf16_f32 v55, v174, v175
v_cvt_pk_bf16_f32 v56, v176, v177
v_cvt_pk_bf16_f32 v57, v178, v179
v_cvt_pk_bf16_f32 v58, v180, v181
v_cvt_pk_bf16_f32 v59, v182, v183
v_cvt_pk_bf16_f32 v60, v184, v185
v_cvt_pk_bf16_f32 v61, v186, v187
v_cvt_pk_bf16_f32 v62, v188, v189
v_cvt_pk_bf16_f32 v63, v190, v191
buffer_store_dwordx4 v[32:35], v251, s[4:7], s21 offen offset:0 sc1
buffer_store_dwordx4 v[36:39], v251, s[4:7], s21 offen offset:1024 sc1
buffer_store_dwordx4 v[40:43], v251, s[4:7], s21 offen offset:2048 sc1
buffer_store_dwordx4 v[44:47], v251, s[4:7], s21 offen offset:3072 sc1
s_add_u32 s21, s21, 4096
buffer_store_dwordx4 v[48:51], v251, s[4:7], s21 offen offset:0 sc1
buffer_store_dwordx4 v[52:55], v251, s[4:7], s21 offen offset:1024 sc1
buffer_store_dwordx4 v[56:59], v251, s[4:7], s21 offen offset:2048 sc1
buffer_store_dwordx4 v[60:63], v251, s[4:7], s21 offen offset:3072 sc1
s_add_u32 s21, s21, 28672
s_mov_b32 s54, 0
main_kernel_w_done:
s_add_u32 s32, s23, 1
s_bitcmp0_b32 s32, 2
s_cselect_b32 s34, 7, 2
s_cselect_b32 s35, 2, 4
s_lshl_b32 s59, s23, 13
s_add_u32 s59, s59, 0x8404000
v_lshrrev_b32 v253, 3, v250
v_add_lshl_u32 v253, s24, v253, 9
v_and_b32 v254, 3, v250
v_lshl_add_u32 v253, v254, s34, v253
v_bfe_u32 v254, v250, 2, 1
v_add_u32 v254, s25, v254
v_lshl_add_u32 v248, v254, s35, v253
s_lshl_b32 s0, 4, s54
main_kernel_w_drain:
s_waitcnt vmcnt(0)
s_barrier
s_cmp_lg_u32 s14, 0
s_cbranch_scc1 main_kernel_w_bar
s_bfm_b64 exec, s0, 0
buffer_store_dword v244, v248, s[4:7], s59 offen sc1
s_mov_b64 exec, -1
s_cmp_eq_u32 s58, -1
s_cbranch_scc1 main_kernel_w_chk
s_lshl_b32 s32, s27, 8
s_add_u32 s32, s32, 0x841e000
s_mov_b64 exec, 1
v_mov_b32 v249, 1
buffer_atomic_add v249, off, s[4:7], s32 sc0 sc1
s_mov_b64 exec, -1
s_branch main_kernel_w_dec
.section .rodata,"a"
.p2align 6
.amdhsa_kernel main_kernel
  .amdhsa_next_free_vgpr 512
  .amdhsa_next_free_sgpr 102
  .amdhsa_accum_offset 256
  .amdhsa_group_segment_fixed_size 0
  .amdhsa_kernarg_size 120
  .amdhsa_user_sgpr_count 2
  .amdhsa_user_sgpr_kernarg_segment_ptr 1
  .amdhsa_system_sgpr_workgroup_id_x 1
.end_amdhsa_kernel
```

```asm
; @launch kernel=main_kernel grid=(256,1,1) block=(256,1,1) lds=163840
.amdgcn_target "amdgcn-amd-amdhsa--gfx950"
.text
.text
.globl main_kernel
.p2align 8
.type main_kernel,@function
main_kernel:
s_load_dwordx4 s[20:23], s[0:1], 104
s_load_dwordx8 s[40:47], s[0:1], 16
s_load_dwordx8 s[64:71], s[0:1], 64
s_load_dwordx2 s[72:73], s[0:1], 0
s_load_dwordx2 s[74:75], s[0:1], 96
s_load_dwordx2 s[76:77], s[0:1], 8
s_cmp_ge_u32 s2, 256
s_cbranch_scc1 main_kernel_end
v_lshrrev_b32 v126, 6, v0
v_and_b32 v94, 63, v0
v_and_b32 v250, 63, v0
v_readfirstlane_b32 s14, v126
s_mov_b32 s29, 0x80000
s_waitcnt lgkmcnt(0)
s_mov_b32 s60, s20
s_and_b32 s61, s21, 0xffff
s_mov_b32 s62, 0x100
s_mov_b32 s63, 0x20000
s_mov_b32 s4, s22
s_and_b32 s5, s23, 0xffff
s_mov_b32 s6, 0x10000000
s_mov_b32 s7, 0x20000
s_cmp_lg_u32 s14, 0
s_cbranch_scc1 main_kernel_slot_wait
s_getreg_b32 s12, hwreg(HW_REG_XCC_ID, 0, 4)
s_and_b32 s12, s12, 7
s_lshl_b32 s32, s12, 5
v_mov_b32 v126, 0
v_mov_b32 v127, 1
s_mov_b64 exec, 1
buffer_atomic_add v127, v126, s[60:63], s32 offen sc0 sc1
s_waitcnt vmcnt(0)
s_mov_b64 exec, -1
v_readfirstlane_b32 s13, v127
s_nop 3
s_cmp_lt_u32 s13, 32
s_cbranch_scc1 main_kernel_slot_pub
v_and_b32 v126, 7, v94
v_lshlrev_b32 v126, 5, v126
main_kernel_ovf_cnt:
buffer_load_dword v127, v126, s[60:63], 0 offen sc1
s_waitcnt vmcnt(0)
v_readlane_b32 s48, v127, 0
v_readlane_b32 s49, v127, 1
v_readlane_b32 s50, v127, 2
v_readlane_b32 s51, v127, 3
v_readlane_b32 s52, v127, 4
v_readlane_b32 s53, v127, 5
v_readlane_b32 s54, v127, 6
v_readlane_b32 s55, v127, 7
s_nop 3
s_add_u32 s33, s48, s49
s_add_u32 s33, s33, s50
s_add_u32 s33, s33, s51
s_add_u32 s33, s33, s52
s_add_u32 s33, s33, s53
s_add_u32 s33, s33, s54
s_add_u32 s33, s33, s55
s_cmp_ge_u32 s33, 256
s_cbranch_scc1 main_kernel_ovf_cnt_ok
s_sub_u32 s29, s29, 1
s_cbranch_scc1 main_kernel_end
s_sleep 4
s_branch main_kernel_ovf_cnt
main_kernel_ovf_cnt_ok:
v_mov_b32 v126, 0
v_mov_b32 v127, 1
s_mov_b64 exec, 1
buffer_atomic_add v127, v126, s[60:63], 0 offen offset:8 sc0 sc1
s_waitcnt vmcnt(0)
s_mov_b64 exec, -1
v_readfirstlane_b32 s33, v127
s_nop 3
s_min_u32 s34, s48, 32
s_sub_u32 s35, 32, s34
s_mov_b32 s12, 0
s_add_u32 s13, s34, s33
s_cmp_lt_u32 s33, s35
s_cbranch_scc1 main_kernel_slot_pub
s_sub_u32 s33, s33, s35
s_min_u32 s34, s49, 32
s_sub_u32 s35, 32, s34
s_mov_b32 s12, 1
s_add_u32 s13, s34, s33
s_cmp_lt_u32 s33, s35
s_cbranch_scc1 main_kernel_slot_pub
s_sub_u32 s33, s33, s35
s_min_u32 s34, s50, 32
s_sub_u32 s35, 32, s34
s_mov_b32 s12, 2
s_add_u32 s13, s34, s33
s_cmp_lt_u32 s33, s35
s_cbranch_scc1 main_kernel_slot_pub
s_sub_u32 s33, s33, s35
s_min_u32 s34, s51, 32
s_sub_u32 s35, 32, s34
s_mov_b32 s12, 3
s_add_u32 s13, s34, s33
s_cmp_lt_u32 s33, s35
s_cbranch_scc1 main_kernel_slot_pub
s_sub_u32 s33, s33, s35
s_min_u32 s34, s52, 32
s_sub_u32 s35, 32, s34
s_mov_b32 s12, 4
s_add_u32 s13, s34, s33
s_cmp_lt_u32 s33, s35
s_cbranch_scc1 main_kernel_slot_pub
s_sub_u32 s33, s33, s35
s_min_u32 s34, s53, 32
s_sub_u32 s35, 32, s34
s_mov_b32 s12, 5
s_add_u32 s13, s34, s33
s_cmp_lt_u32 s33, s35
s_cbranch_scc1 main_kernel_slot_pub
s_sub_u32 s33, s33, s35
s_min_u32 s34, s54, 32
s_sub_u32 s35, 32, s34
s_mov_b32 s12, 6
s_add_u32 s13, s34, s33
s_cmp_lt_u32 s33, s35
s_cbranch_scc1 main_kernel_slot_pub
s_sub_u32 s33, s33, s35
s_min_u32 s34, s55, 32
s_sub_u32 s35, 32, s34
s_mov_b32 s12, 7
s_add_u32 s13, s34, s33
s_cmp_lt_u32 s33, s35
s_cbranch_scc1 main_kernel_slot_pub
s_sub_u32 s33, s33, s35
s_mov_b32 s12, 8
s_mov_b32 s13, 0
main_kernel_slot_pub:
v_mov_b32 v126, 0
v_mov_b32 v127, s12
v_mov_b32 v95, s13
ds_write_b32 v126, v127
ds_write_b32 v126, v95 offset:4
s_waitcnt lgkmcnt(0)
main_kernel_slot_wait:
s_barrier
v_mov_b32 v126, 0
ds_read_b32 v127, v126
ds_read_b32 v95, v126 offset:4
s_waitcnt lgkmcnt(0)
v_readfirstlane_b32 s12, v127
v_readfirstlane_b32 s13, v95
s_nop 3
s_barrier
s_cmp_ge_u32 s12, 8
s_cbranch_scc1 main_kernel_end
s_cmp_lt_u32 s12, 2
s_cbranch_scc1 main_kernel_chain
s_mov_b32 s96, s72
s_and_b32 s97, s73, 0xffff
s_mov_b32 s98, 0x400000
s_mov_b32 s99, 0x20000
s_mov_b32 s92, s74
s_and_b32 s93, s75, 0xffff
s_mov_b32 s94, 0x400000
s_mov_b32 s95, 0x20000
v_lshlrev_b32 v1, 4, v0
v_lshlrev_b32 v251, 4, v250
v_mov_b32 v4, 0
v_mov_b32 v8, -1
v_mov_b32 v5, 0
v_mov_b32 v9, -1
v_mov_b32 v6, 0
v_mov_b32 v10, -1
v_mov_b32 v7, 0
v_mov_b32 v11, -1
v_mul_u32_u24 v12, 128, v0
s_lshl_b32 s15, s12, 4
s_and_b32 s32, s12, 1
s_lshl_b32 s32, s32, 5
s_cmp_lt_u32 s12, 4
s_cselect_b32 s15, s32, s15
s_cselect_b32 s32, 32, 16
s_add_u32 s15, s15, s13
s_sub_u32 s16, s15, 80
s_sub_u32 s27, s12, 2
s_mov_b32 s52, 0
s_cmp_lt_u32 s13, s32
s_cbranch_scc1 main_kernel_s_ln
s_cmp_lg_u32 s13, 16
s_cbranch_scc1 main_kernel_s_fill
s_lshl_b32 s32, s16, 11
s_add_u32 s32, s32, 0x8400000
buffer_store_dwordx4 v[4:7], v1, s[4:7], s32 offen sc1
s_add_u32 s32, s32, 4096
buffer_store_dwordx4 v[4:7], v1, s[4:7], s32 offen sc1
s_add_u32 s32, s32, 4096
buffer_store_dwordx4 v[4:7], v1, s[4:7], s32 offen sc1
s_add_u32 s32, s32, 4096
buffer_store_dwordx4 v[4:7], v1, s[4:7], s32 offen sc1
s_add_u32 s32, s32, 4096
buffer_store_dwordx4 v[4:7], v1, s[4:7], s32 offen sc1
s_add_u32 s32, s32, 4096
buffer_store_dwordx4 v[4:7], v1, s[4:7], s32 offen sc1
s_add_u32 s32, s32, 4096
buffer_store_dwordx4 v[4:7], v1, s[4:7], s32 offen sc1
s_add_u32 s32, s32, 4096
buffer_store_dwordx4 v[4:7], v1, s[4:7], s32 offen sc1
s_add_u32 s32, s32, 4096
v_bfe_u32 v2, v0, 2, 1
s_lshr_b32 s32, s14, 1
v_and_b32 v2, s32, v2
s_bitcmp1_b32 s14, 0
s_cselect_b32 s32, 15, 0
s_cselect_b32 s33, 4161536, 0
v_xor_b32 v2, s32, v2
v_lshlrev_b32 v2, 4, v2
v_and_b32 v3, 3, v0
v_lshl_add_u32 v2, v3, 8, v2
v_lshrrev_b32 v3, 3, v0
v_lshl_add_u32 v2, v3, 10, v2
s_add_u32 s33, s33, 0x4808000
buffer_store_dwordx4 v[4:7], v2, s[4:7], s33 offen sc1
s_waitcnt vmcnt(0)
s_barrier
s_cmp_lg_u32 s14, 0
s_cbranch_scc1 main_kernel_s_fill
v_mov_b32 v2, 1
s_mov_b64 exec, 1
buffer_atomic_add v2, v4, s[60:63], 0 offen offset:12 sc1
s_mov_b64 exec, -1
s_branch main_kernel_s_fill
main_kernel_s_ln:
v_and_b32 v3, 15, v250
v_and_b32 v2, 48, v250
v_lshl_add_u32 v3, v3, 11, v2
s_lshl_b32 s34, s15, 15
s_lshl_b32 s32, s14, 9
s_add_u32 s32, s34, s32
buffer_load_dwordx4 v[32:35], v3, s[96:99], s32 offen offset:0
buffer_load_dwordx4 v[36:39], v3, s[96:99], s32 offen offset:64
buffer_load_dwordx4 v[40:43], v3, s[96:99], s32 offen offset:128
buffer_load_dwordx4 v[44:47], v3, s[96:99], s32 offen offset:192
buffer_load_dwordx4 v[48:51], v3, s[96:99], s32 offen offset:256
buffer_load_dwordx4 v[52:55], v3, s[96:99], s32 offen offset:320
buffer_load_dwordx4 v[56:59], v3, s[96:99], s32 offen offset:384
buffer_load_dwordx4 v[60:63], v3, s[96:99], s32 offen offset:448
v_and_b32 v255, 15, v250
v_lshlrev_b32 v254, 6, v255
v_add_u32 v254, 132096, v254
v_lshrrev_b32 v255, 4, v250
v_lshl_add_u32 v253, v255, 2, v254
v_lshl_add_u32 v253, s14, 4, v253
s_lshl_b32 s32, s14, 13
s_add_u32 s34, s34, s32
s_waitcnt vmcnt(0)
v_permlane16_swap_b32 v32, v34
v_permlane16_swap_b32 v33, v35
v_permlane16_swap_b32 v36, v38
v_permlane16_swap_b32 v37, v39
v_permlane16_swap_b32 v40, v42
v_permlane16_swap_b32 v41, v43
v_permlane16_swap_b32 v44, v46
v_permlane16_swap_b32 v45, v47
v_permlane16_swap_b32 v48, v50
v_permlane16_swap_b32 v49, v51
v_permlane16_swap_b32 v52, v54
v_permlane16_swap_b32 v53, v55
v_permlane16_swap_b32 v56, v58
v_permlane16_swap_b32 v57, v59
v_permlane16_swap_b32 v60, v62
v_permlane16_swap_b32 v61, v63
v_permlane32_swap_b32 v32, v34
v_permlane32_swap_b32 v33, v35
v_permlane32_swap_b32 v36, v38
v_permlane32_swap_b32 v37, v39
v_permlane32_swap_b32 v40, v42
v_permlane32_swap_b32 v41, v43
v_permlane32_swap_b32 v44, v46
v_permlane32_swap_b32 v45, v47
v_permlane32_swap_b32 v48, v50
v_permlane32_swap_b32 v49, v51
v_permlane32_swap_b32 v52, v54
v_permlane32_swap_b32 v53, v55
v_permlane32_swap_b32 v56, v58
v_permlane32_swap_b32 v57, v59
v_permlane32_swap_b32 v60, v62
v_permlane32_swap_b32 v61, v63
s_lshr_b32 s32, s15, 3
s_lshl_b32 s32, s32, 9
s_and_b32 s33, s15, 7
s_lshl_b32 s33, s33, 4
s_add_u32 s32, s32, s33
s_add_u32 s16, s32, 0x8416000
v_lshlrev_b32 v64, 16, v32
v_and_b32 v65, 0xffff0000, v32
v_lshlrev_b32 v66, 16, v33
v_and_b32 v67, 0xffff0000, v33
v_lshlrev_b32 v68, 16, v34
v_and_b32 v69, 0xffff0000, v34
v_lshlrev_b32 v70, 16, v35
v_and_b32 v71, 0xffff0000, v35
v_lshlrev_b32 v72, 16, v36
v_and_b32 v73, 0xffff0000, v36
v_lshlrev_b32 v74, 16, v37
v_and_b32 v75, 0xffff0000, v37
v_lshlrev_b32 v76, 16, v38
v_and_b32 v77, 0xffff0000, v38
v_lshlrev_b32 v78, 16, v39
v_and_b32 v79, 0xffff0000, v39
v_lshlrev_b32 v80, 16, v40
v_and_b32 v81, 0xffff0000, v40
v_lshlrev_b32 v82, 16, v41
v_and_b32 v83, 0xffff0000, v41
v_lshlrev_b32 v84, 16, v42
v_and_b32 v85, 0xffff0000, v42
v_lshlrev_b32 v86, 16, v43
v_and_b32 v87, 0xffff0000, v43
v_lshlrev_b32 v88, 16, v44
v_and_b32 v89, 0xffff0000, v44
v_lshlrev_b32 v90, 16, v45
v_and_b32 v91, 0xffff0000, v45
v_lshlrev_b32 v92, 16, v46
v_and_b32 v93, 0xffff0000, v46
v_lshlrev_b32 v94, 16, v47
v_and_b32 v95, 0xffff0000, v47
v_lshlrev_b32 v96, 16, v48
v_and_b32 v97, 0xffff0000, v48
v_lshlrev_b32 v98, 16, v49
v_and_b32 v99, 0xffff0000, v49
v_lshlrev_b32 v100, 16, v50
v_and_b32 v101, 0xffff0000, v50
v_lshlrev_b32 v102, 16, v51
v_and_b32 v103, 0xffff0000, v51
v_lshlrev_b32 v104, 16, v52
v_and_b32 v105, 0xffff0000, v52
v_lshlrev_b32 v106, 16, v53
v_and_b32 v107, 0xffff0000, v53
v_lshlrev_b32 v108, 16, v54
v_and_b32 v109, 0xffff0000, v54
v_lshlrev_b32 v110, 16, v55
v_and_b32 v111, 0xffff0000, v55
v_lshlrev_b32 v112, 16, v56
v_and_b32 v113, 0xffff0000, v56
v_lshlrev_b32 v114, 16, v57
v_and_b32 v115, 0xffff0000, v57
v_lshlrev_b32 v116, 16, v58
v_and_b32 v117, 0xffff0000, v58
v_lshlrev_b32 v118, 16, v59
v_and_b32 v119, 0xffff0000, v59
v_lshlrev_b32 v120, 16, v60
v_and_b32 v121, 0xffff0000, v60
v_lshlrev_b32 v122, 16, v61
v_and_b32 v123, 0xffff0000, v61
v_lshlrev_b32 v124, 16, v62
v_and_b32 v125, 0xffff0000, v62
v_lshlrev_b32 v126, 16, v63
v_and_b32 v127, 0xffff0000, v63
v_pk_add_f32 v[16:17], v[64:65], v[72:73]
v_pk_add_f32 v[18:19], v[66:67], v[74:75]
v_pk_add_f32 v[20:21], v[68:69], v[76:77]
v_pk_add_f32 v[22:23], v[70:71], v[78:79]
v_pk_add_f32 v[16:17], v[16:17], v[80:81]
v_pk_add_f32 v[18:19], v[18:19], v[82:83]
v_pk_add_f32 v[20:21], v[20:21], v[84:85]
v_pk_add_f32 v[22:23], v[22:23], v[86:87]
v_pk_add_f32 v[16:17], v[16:17], v[88:89]
v_pk_add_f32 v[18:19], v[18:19], v[90:91]
v_pk_add_f32 v[20:21], v[20:21], v[92:93]
v_pk_add_f32 v[22:23], v[22:23], v[94:95]
v_pk_add_f32 v[16:17], v[16:17], v[96:97]
v_pk_add_f32 v[18:19], v[18:19], v[98:99]
v_pk_add_f32 v[20:21], v[20:21], v[100:101]
v_pk_add_f32 v[22:23], v[22:23], v[102:103]
v_pk_add_f32 v[16:17], v[16:17], v[104:105]
v_pk_add_f32 v[18:19], v[18:19], v[106:107]
v_pk_add_f32 v[20:21], v[20:21], v[108:109]
v_pk_add_f32 v[22:23], v[22:23], v[110:111]
v_pk_add_f32 v[16:17], v[16:17], v[112:113]
v_pk_add_f32 v[18:19], v[18:19], v[114:115]
v_pk_add_f32 v[20:21], v[20:21], v[116:117]
v_pk_add_f32 v[22:23], v[22:23], v[118:119]
v_pk_add_f32 v[16:17], v[16:17], v[120:121]
v_pk_add_f32 v[18:19], v[18:19], v[122:123]
v_pk_add_f32 v[20:21], v[20:21], v[124:125]
v_pk_add_f32 v[22:23], v[22:23], v[126:127]
v_pk_add_f32 v[16:17], v[16:17], v[18:19]
v_pk_add_f32 v[20:21], v[20:21], v[22:23]
v_pk_add_f32 v[16:17], v[16:17], v[20:21]
v_add_f32 v16, v16, v17
ds_write_b32 v253, v16 offset:0
s_waitcnt lgkmcnt(0)
s_barrier
ds_read_b128 v[16:19], v254 offset:0
ds_read_b128 v[20:23], v254 offset:16
ds_read_b128 v[24:27], v254 offset:32
ds_read_b128 v[28:31], v254 offset:48
s_waitcnt lgkmcnt(2)
v_pk_add_f32 v[16:17], v[16:17], v[18:19]
v_pk_add_f32 v[20:21], v[20:21], v[22:23]
s_waitcnt lgkmcnt(0)
v_pk_add_f32 v[24:25], v[24:25], v[26:27]
v_pk_add_f32 v[28:29], v[28:29], v[30:31]
v_pk_add_f32 v[16:17], v[16:17], v[20:21]
v_pk_add_f32 v[24:25], v[24:25], v[28:29]
v_pk_add_f32 v[16:17], v[16:17], v[24:25]
v_add_f32 v16, v16, v17
v_mul_f32 v16, 0xba800000, v16
v_mov_b32 v17, v16
v_pk_add_f32 v[64:65], v[64:65], v[16:17]
v_pk_add_f32 v[66:67], v[66:67], v[16:17]
v_pk_add_f32 v[68:69], v[68:69], v[16:17]
v_pk_add_f32 v[70:71], v[70:71], v[16:17]
v_pk_add_f32 v[72:73], v[72:73], v[16:17]
v_pk_add_f32 v[74:75], v[74:75], v[16:17]
v_pk_add_f32 v[76:77], v[76:77], v[16:17]
v_pk_add_f32 v[78:79], v[78:79], v[16:17]
v_pk_add_f32 v[80:81], v[80:81], v[16:17]
v_pk_add_f32 v[82:83], v[82:83], v[16:17]
v_pk_add_f32 v[84:85], v[84:85], v[16:17]
v_pk_add_f32 v[86:87], v[86:87], v[16:17]
v_pk_add_f32 v[88:89], v[88:89], v[16:17]
v_pk_add_f32 v[90:91], v[90:91], v[16:17]
v_pk_add_f32 v[92:93], v[92:93], v[16:17]
v_pk_add_f32 v[94:95], v[94:95], v[16:17]
v_pk_add_f32 v[96:97], v[96:97], v[16:17]
v_pk_add_f32 v[98:99], v[98:99], v[16:17]
v_pk_add_f32 v[100:101], v[100:101], v[16:17]
v_pk_add_f32 v[102:103], v[102:103], v[16:17]
v_pk_add_f32 v[104:105], v[104:105], v[16:17]
v_pk_add_f32 v[106:107], v[106:107], v[16:17]
v_pk_add_f32 v[108:109], v[108:109], v[16:17]
v_pk_add_f32 v[110:111], v[110:111], v[16:17]
v_pk_add_f32 v[112:113], v[112:113], v[16:17]
v_pk_add_f32 v[114:115], v[114:115], v[16:17]
v_pk_add_f32 v[116:117], v[116:117], v[16:17]
v_pk_add_f32 v[118:119], v[118:119], v[16:17]
v_pk_add_f32 v[120:121], v[120:121], v[16:17]
v_pk_add_f32 v[122:123], v[122:123], v[16:17]
v_pk_add_f32 v[124:125], v[124:125], v[16:17]
v_pk_add_f32 v[126:127], v[126:127], v[16:17]
v_pk_mul_f32 v[16:17], v[64:65], v[64:65]
v_pk_mul_f32 v[18:19], v[66:67], v[66:67]
v_pk_mul_f32 v[20:21], v[68:69], v[68:69]
v_pk_mul_f32 v[22:23], v[70:71], v[70:71]
v_pk_fma_f32 v[16:17], v[72:73], v[72:73], v[16:17]
v_pk_fma_f32 v[18:19], v[74:75], v[74:75], v[18:19]
v_pk_fma_f32 v[20:21], v[76:77], v[76:77], v[20:21]
v_pk_fma_f32 v[22:23], v[78:79], v[78:79], v[22:23]
v_pk_fma_f32 v[16:17], v[80:81], v[80:81], v[16:17]
v_pk_fma_f32 v[18:19], v[82:83], v[82:83], v[18:19]
v_pk_fma_f32 v[20:21], v[84:85], v[84:85], v[20:21]
v_pk_fma_f32 v[22:23], v[86:87], v[86:87], v[22:23]
v_pk_fma_f32 v[16:17], v[88:89], v[88:89], v[16:17]
v_pk_fma_f32 v[18:19], v[90:91], v[90:91], v[18:19]
v_pk_fma_f32 v[20:21], v[92:93], v[92:93], v[20:21]
v_pk_fma_f32 v[22:23], v[94:95], v[94:95], v[22:23]
v_pk_fma_f32 v[16:17], v[96:97], v[96:97], v[16:17]
v_pk_fma_f32 v[18:19], v[98:99], v[98:99], v[18:19]
v_pk_fma_f32 v[20:21], v[100:101], v[100:101], v[20:21]
v_pk_fma_f32 v[22:23], v[102:103], v[102:103], v[22:23]
v_pk_fma_f32 v[16:17], v[104:105], v[104:105], v[16:17]
v_pk_fma_f32 v[18:19], v[106:107], v[106:107], v[18:19]
v_pk_fma_f32 v[20:21], v[108:109], v[108:109], v[20:21]
v_pk_fma_f32 v[22:23], v[110:111], v[110:111], v[22:23]
v_pk_fma_f32 v[16:17], v[112:113], v[112:113], v[16:17]
v_pk_fma_f32 v[18:19], v[114:115], v[114:115], v[18:19]
v_pk_fma_f32 v[20:21], v[116:117], v[116:117], v[20:21]
v_pk_fma_f32 v[22:23], v[118:119], v[118:119], v[22:23]
v_pk_fma_f32 v[16:17], v[120:121], v[120:121], v[16:17]
v_pk_fma_f32 v[18:19], v[122:123], v[122:123], v[18:19]
v_pk_fma_f32 v[20:21], v[124:125], v[124:125], v[20:21]
v_pk_fma_f32 v[22:23], v[126:127], v[126:127], v[22:23]
v_pk_add_f32 v[16:17], v[16:17], v[18:19]
v_pk_add_f32 v[20:21], v[20:21], v[22:23]
v_pk_add_f32 v[16:17], v[16:17], v[20:21]
v_add_f32 v16, v16, v17
ds_write_b32 v253, v16 offset:1024
s_waitcnt lgkmcnt(0)
s_barrier
ds_read_b128 v[16:19], v254 offset:1024
ds_read_b128 v[20:23], v254 offset:1040
ds_read_b128 v[24:27], v254 offset:1056
ds_read_b128 v[28:31], v254 offset:1072
s_waitcnt lgkmcnt(2)
v_pk_add_f32 v[16:17], v[16:17], v[18:19]
v_pk_add_f32 v[20:21], v[20:21], v[22:23]
s_waitcnt lgkmcnt(0)
v_pk_add_f32 v[24:25], v[24:25], v[26:27]
v_pk_add_f32 v[28:29], v[28:29], v[30:31]
v_pk_add_f32 v[16:17], v[16:17], v[20:21]
v_pk_add_f32 v[24:25], v[24:25], v[28:29]
v_pk_add_f32 v[16:17], v[16:17], v[24:25]
v_add_f32 v16, v16, v17
v_mov_b32 v17, 0x3727c5ac
v_fmac_f32 v17, 0x3a800000, v16
v_rsq_f32 v16, v17
s_nop 0
v_mov_b32 v17, v16
v_pk_mul_f32 v[64:65], v[64:65], v[16:17]
v_pk_mul_f32 v[66:67], v[66:67], v[16:17]
v_pk_mul_f32 v[68:69], v[68:69], v[16:17]
v_pk_mul_f32 v[70:71], v[70:71], v[16:17]
v_pk_mul_f32 v[72:73], v[72:73], v[16:17]
v_pk_mul_f32 v[74:75], v[74:75], v[16:17]
v_pk_mul_f32 v[76:77], v[76:77], v[16:17]
v_pk_mul_f32 v[78:79], v[78:79], v[16:17]
v_pk_mul_f32 v[80:81], v[80:81], v[16:17]
v_pk_mul_f32 v[82:83], v[82:83], v[16:17]
v_pk_mul_f32 v[84:85], v[84:85], v[16:17]
v_pk_mul_f32 v[86:87], v[86:87], v[16:17]
v_pk_mul_f32 v[88:89], v[88:89], v[16:17]
v_pk_mul_f32 v[90:91], v[90:91], v[16:17]
v_pk_mul_f32 v[92:93], v[92:93], v[16:17]
v_pk_mul_f32 v[94:95], v[94:95], v[16:17]
v_pk_mul_f32 v[96:97], v[96:97], v[16:17]
v_pk_mul_f32 v[98:99], v[98:99], v[16:17]
v_pk_mul_f32 v[100:101], v[100:101], v[16:17]
v_pk_mul_f32 v[102:103], v[102:103], v[16:17]
v_pk_mul_f32 v[104:105], v[104:105], v[16:17]
v_pk_mul_f32 v[106:107], v[106:107], v[16:17]
v_pk_mul_f32 v[108:109], v[108:109], v[16:17]
v_pk_mul_f32 v[110:111], v[110:111], v[16:17]
v_pk_mul_f32 v[112:113], v[112:113], v[16:17]
v_pk_mul_f32 v[114:115], v[114:115], v[16:17]
v_pk_mul_f32 v[116:117], v[116:117], v[16:17]
v_pk_mul_f32 v[118:119], v[118:119], v[16:17]
v_pk_mul_f32 v[120:121], v[120:121], v[16:17]
v_pk_mul_f32 v[122:123], v[122:123], v[16:17]
v_pk_mul_f32 v[124:125], v[124:125], v[16:17]
v_pk_mul_f32 v[126:127], v[126:127], v[16:17]
v_cvt_pk_bf16_f32 v128, v64, v65
v_cvt_pk_bf16_f32 v129, v66, v67
v_cvt_pk_bf16_f32 v130, v68, v69
v_cvt_pk_bf16_f32 v131, v70, v71
v_cvt_pk_bf16_f32 v132, v72, v73
v_cvt_pk_bf16_f32 v133, v74, v75
v_cvt_pk_bf16_f32 v134, v76, v77
v_cvt_pk_bf16_f32 v135, v78, v79
v_cvt_pk_bf16_f32 v136, v80, v81
v_cvt_pk_bf16_f32 v137, v82, v83
v_cvt_pk_bf16_f32 v138, v84, v85
v_cvt_pk_bf16_f32 v139, v86, v87
v_cvt_pk_bf16_f32 v140, v88, v89
v_cvt_pk_bf16_f32 v141, v90, v91
v_cvt_pk_bf16_f32 v142, v92, v93
v_cvt_pk_bf16_f32 v143, v94, v95
v_cvt_pk_bf16_f32 v144, v96, v97
v_cvt_pk_bf16_f32 v145, v98, v99
v_cvt_pk_bf16_f32 v146, v100, v101
v_cvt_pk_bf16_f32 v147, v102, v103
v_cvt_pk_bf16_f32 v148, v104, v105
v_cvt_pk_bf16_f32 v149, v106, v107
v_cvt_pk_bf16_f32 v150, v108, v109
v_cvt_pk_bf16_f32 v151, v110, v111
v_cvt_pk_bf16_f32 v152, v112, v113
v_cvt_pk_bf16_f32 v153, v114, v115
v_cvt_pk_bf16_f32 v154, v116, v117
v_cvt_pk_bf16_f32 v155, v118, v119
v_cvt_pk_bf16_f32 v156, v120, v121
v_cvt_pk_bf16_f32 v157, v122, v123
v_cvt_pk_bf16_f32 v158, v124, v125
v_cvt_pk_bf16_f32 v159, v126, v127
s_add_u32 s32, s34, 0x0
s_add_u32 s33, s32, 4096
buffer_store_dwordx4 v[128:131], v251, s[4:7], s32 offen offset:0 sc1
buffer_store_dwordx4 v[132:135], v251, s[4:7], s32 offen offset:1024 sc1
buffer_store_dwordx4 v[136:139], v251, s[4:7], s32 offen offset:2048 sc1
buffer_store_dwordx4 v[140:143], v251, s[4:7], s32 offen offset:3072 sc1
buffer_store_dwordx4 v[144:147], v251, s[4:7], s33 offen offset:0 sc1
buffer_store_dwordx4 v[148:151], v251, s[4:7], s33 offen offset:1024 sc1
buffer_store_dwordx4 v[152:155], v251, s[4:7], s33 offen offset:2048 sc1
buffer_store_dwordx4 v[156:159], v251, s[4:7], s33 offen offset:3072 sc1
buffer_load_dword v2, v4, s[60:63], 0 offen offset:12 sc1
v_lshlrev_b32 v64, 16, v128
v_and_b32 v65, 0xffff0000, v128
v_lshlrev_b32 v66, 16, v129
v_and_b32 v67, 0xffff0000, v129
v_lshlrev_b32 v68, 16, v130
v_and_b32 v69, 0xffff0000, v130
v_lshlrev_b32 v70, 16, v131
v_and_b32 v71, 0xffff0000, v131
v_lshlrev_b32 v72, 16, v132
v_and_b32 v73, 0xffff0000, v132
v_lshlrev_b32 v74, 16, v133
v_and_b32 v75, 0xffff0000, v133
v_lshlrev_b32 v76, 16, v134
v_and_b32 v77, 0xffff0000, v134
v_lshlrev_b32 v78, 16, v135
v_and_b32 v79, 0xffff0000, v135
v_lshlrev_b32 v80, 16, v136
v_and_b32 v81, 0xffff0000, v136
v_lshlrev_b32 v82, 16, v137
v_and_b32 v83, 0xffff0000, v137
v_lshlrev_b32 v84, 16, v138
v_and_b32 v85, 0xffff0000, v138
v_lshlrev_b32 v86, 16, v139
v_and_b32 v87, 0xffff0000, v139
v_lshlrev_b32 v88, 16, v140
v_and_b32 v89, 0xffff0000, v140
v_lshlrev_b32 v90, 16, v141
v_and_b32 v91, 0xffff0000, v141
v_lshlrev_b32 v92, 16, v142
v_and_b32 v93, 0xffff0000, v142
v_lshlrev_b32 v94, 16, v143
v_and_b32 v95, 0xffff0000, v143
v_lshlrev_b32 v96, 16, v144
v_and_b32 v97, 0xffff0000, v144
v_lshlrev_b32 v98, 16, v145
v_and_b32 v99, 0xffff0000, v145
v_lshlrev_b32 v100, 16, v146
v_and_b32 v101, 0xffff0000, v146
v_lshlrev_b32 v102, 16, v147
v_and_b32 v103, 0xffff0000, v147
v_lshlrev_b32 v104, 16, v148
v_and_b32 v105, 0xffff0000, v148
v_lshlrev_b32 v106, 16, v149
v_and_b32 v107, 0xffff0000, v149
v_lshlrev_b32 v108, 16, v150
v_and_b32 v109, 0xffff0000, v150
v_lshlrev_b32 v110, 16, v151
v_and_b32 v111, 0xffff0000, v151
v_lshlrev_b32 v112, 16, v152
v_and_b32 v113, 0xffff0000, v152
v_lshlrev_b32 v114, 16, v153
v_and_b32 v115, 0xffff0000, v153
v_lshlrev_b32 v116, 16, v154
v_and_b32 v117, 0xffff0000, v154
v_lshlrev_b32 v118, 16, v155
v_and_b32 v119, 0xffff0000, v155
v_lshlrev_b32 v120, 16, v156
v_and_b32 v121, 0xffff0000, v156
v_lshlrev_b32 v122, 16, v157
v_and_b32 v123, 0xffff0000, v157
v_lshlrev_b32 v124, 16, v158
v_and_b32 v125, 0xffff0000, v158
v_lshlrev_b32 v126, 16, v159
v_and_b32 v127, 0xffff0000, v159
v_pk_add_f32 v[16:17], v[64:65], v[72:73]
v_pk_add_f32 v[18:19], v[66:67], v[74:75]
v_pk_add_f32 v[20:21], v[68:69], v[76:77]
v_pk_add_f32 v[22:23], v[70:71], v[78:79]
v_pk_add_f32 v[16:17], v[16:17], v[80:81]
v_pk_add_f32 v[18:19], v[18:19], v[82:83]
v_pk_add_f32 v[20:21], v[20:21], v[84:85]
v_pk_add_f32 v[22:23], v[22:23], v[86:87]
v_pk_add_f32 v[16:17], v[16:17], v[88:89]
v_pk_add_f32 v[18:19], v[18:19], v[90:91]
v_pk_add_f32 v[20:21], v[20:21], v[92:93]
v_pk_add_f32 v[22:23], v[22:23], v[94:95]
v_pk_add_f32 v[16:17], v[16:17], v[96:97]
v_pk_add_f32 v[18:19], v[18:19], v[98:99]
v_pk_add_f32 v[20:21], v[20:21], v[100:101]
v_pk_add_f32 v[22:23], v[22:23], v[102:103]
v_pk_add_f32 v[16:17], v[16:17], v[104:105]
v_pk_add_f32 v[18:19], v[18:19], v[106:107]
v_pk_add_f32 v[20:21], v[20:21], v[108:109]
v_pk_add_f32 v[22:23], v[22:23], v[110:111]
v_pk_add_f32 v[16:17], v[16:17], v[112:113]
v_pk_add_f32 v[18:19], v[18:19], v[114:115]
v_pk_add_f32 v[20:21], v[20:21], v[116:117]
v_pk_add_f32 v[22:23], v[22:23], v[118:119]
v_pk_add_f32 v[16:17], v[16:17], v[120:121]
v_pk_add_f32 v[18:19], v[18:19], v[122:123]
v_pk_add_f32 v[20:21], v[20:21], v[124:125]
v_pk_add_f32 v[22:23], v[22:23], v[126:127]
v_pk_add_f32 v[16:17], v[16:17], v[18:19]
v_pk_add_f32 v[20:21], v[20:21], v[22:23]
v_pk_add_f32 v[16:17], v[16:17], v[20:21]
v_add_f32 v16, v16, v17
ds_write_b32 v253, v16 offset:0
s_waitcnt lgkmcnt(0)
s_barrier
ds_read_b128 v[16:19], v254 offset:0
ds_read_b128 v[20:23], v254 offset:16
ds_read_b128 v[24:27], v254 offset:32
ds_read_b128 v[28:31], v254 offset:48
s_waitcnt lgkmcnt(2)
v_pk_add_f32 v[16:17], v[16:17], v[18:19]
v_pk_add_f32 v[20:21], v[20:21], v[22:23]
s_waitcnt lgkmcnt(0)
v_pk_add_f32 v[24:25], v[24:25], v[26:27]
v_pk_add_f32 v[28:29], v[28:29], v[30:31]
v_pk_add_f32 v[16:17], v[16:17], v[20:21]
v_pk_add_f32 v[24:25], v[24:25], v[28:29]
v_pk_add_f32 v[16:17], v[16:17], v[24:25]
v_add_f32 v16, v16, v17
v_mul_f32 v16, 0xba800000, v16
v_mov_b32 v17, v16
v_pk_add_f32 v[64:65], v[64:65], v[16:17]
v_pk_add_f32 v[66:67], v[66:67], v[16:17]
v_pk_add_f32 v[68:69], v[68:69], v[16:17]
v_pk_add_f32 v[70:71], v[70:71], v[16:17]
v_pk_add_f32 v[72:73], v[72:73], v[16:17]
v_pk_add_f32 v[74:75], v[74:75], v[16:17]
v_pk_add_f32 v[76:77], v[76:77], v[16:17]
v_pk_add_f32 v[78:79], v[78:79], v[16:17]
v_pk_add_f32 v[80:81], v[80:81], v[16:17]
v_pk_add_f32 v[82:83], v[82:83], v[16:17]
v_pk_add_f32 v[84:85], v[84:85], v[16:17]
v_pk_add_f32 v[86:87], v[86:87], v[16:17]
v_pk_add_f32 v[88:89], v[88:89], v[16:17]
v_pk_add_f32 v[90:91], v[90:91], v[16:17]
v_pk_add_f32 v[92:93], v[92:93], v[16:17]
v_pk_add_f32 v[94:95], v[94:95], v[16:17]
v_pk_add_f32 v[96:97], v[96:97], v[16:17]
v_pk_add_f32 v[98:99], v[98:99], v[16:17]
v_pk_add_f32 v[100:101], v[100:101], v[16:17]
v_pk_add_f32 v[102:103], v[102:103], v[16:17]
v_pk_add_f32 v[104:105], v[104:105], v[16:17]
v_pk_add_f32 v[106:107], v[106:107], v[16:17]
v_pk_add_f32 v[108:109], v[108:109], v[16:17]
v_pk_add_f32 v[110:111], v[110:111], v[16:17]
v_pk_add_f32 v[112:113], v[112:113], v[16:17]
v_pk_add_f32 v[114:115], v[114:115], v[16:17]
v_pk_add_f32 v[116:117], v[116:117], v[16:17]
v_pk_add_f32 v[118:119], v[118:119], v[16:17]
v_pk_add_f32 v[120:121], v[120:121], v[16:17]
v_pk_add_f32 v[122:123], v[122:123], v[16:17]
v_pk_add_f32 v[124:125], v[124:125], v[16:17]
v_pk_add_f32 v[126:127], v[126:127], v[16:17]
v_pk_mul_f32 v[16:17], v[64:65], v[64:65]
v_pk_mul_f32 v[18:19], v[66:67], v[66:67]
v_pk_mul_f32 v[20:21], v[68:69], v[68:69]
v_pk_mul_f32 v[22:23], v[70:71], v[70:71]
v_pk_fma_f32 v[16:17], v[72:73], v[72:73], v[16:17]
v_pk_fma_f32 v[18:19], v[74:75], v[74:75], v[18:19]
v_pk_fma_f32 v[20:21], v[76:77], v[76:77], v[20:21]
v_pk_fma_f32 v[22:23], v[78:79], v[78:79], v[22:23]
v_pk_fma_f32 v[16:17], v[80:81], v[80:81], v[16:17]
v_pk_fma_f32 v[18:19], v[82:83], v[82:83], v[18:19]
v_pk_fma_f32 v[20:21], v[84:85], v[84:85], v[20:21]
v_pk_fma_f32 v[22:23], v[86:87], v[86:87], v[22:23]
v_pk_fma_f32 v[16:17], v[88:89], v[88:89], v[16:17]
v_pk_fma_f32 v[18:19], v[90:91], v[90:91], v[18:19]
v_pk_fma_f32 v[20:21], v[92:93], v[92:93], v[20:21]
v_pk_fma_f32 v[22:23], v[94:95], v[94:95], v[22:23]
v_pk_fma_f32 v[16:17], v[96:97], v[96:97], v[16:17]
v_pk_fma_f32 v[18:19], v[98:99], v[98:99], v[18:19]
v_pk_fma_f32 v[20:21], v[100:101], v[100:101], v[20:21]
v_pk_fma_f32 v[22:23], v[102:103], v[102:103], v[22:23]
v_pk_fma_f32 v[16:17], v[104:105], v[104:105], v[16:17]
v_pk_fma_f32 v[18:19], v[106:107], v[106:107], v[18:19]
v_pk_fma_f32 v[20:21], v[108:109], v[108:109], v[20:21]
v_pk_fma_f32 v[22:23], v[110:111], v[110:111], v[22:23]
v_pk_fma_f32 v[16:17], v[112:113], v[112:113], v[16:17]
v_pk_fma_f32 v[18:19], v[114:115], v[114:115], v[18:19]
v_pk_fma_f32 v[20:21], v[116:117], v[116:117], v[20:21]
v_pk_fma_f32 v[22:23], v[118:119], v[118:119], v[22:23]
v_pk_fma_f32 v[16:17], v[120:121], v[120:121], v[16:17]
v_pk_fma_f32 v[18:19], v[122:123], v[122:123], v[18:19]
v_pk_fma_f32 v[20:21], v[124:125], v[124:125], v[20:21]
v_pk_fma_f32 v[22:23], v[126:127], v[126:127], v[22:23]
v_pk_add_f32 v[16:17], v[16:17], v[18:19]
v_pk_add_f32 v[20:21], v[20:21], v[22:23]
v_pk_add_f32 v[16:17], v[16:17], v[20:21]
v_add_f32 v16, v16, v17
ds_write_b32 v253, v16 offset:1024
s_waitcnt lgkmcnt(0)
s_waitcnt vmcnt(0)
s_barrier
s_cmp_lg_u32 s14, 0
s_cbranch_scc1 main_kernel_s_nf
v_cmp_gt_u32 vcc, 4, v2
s_cbranch_vccz main_kernel_s_wa1_ok
v_mov_b32 v2, 0
main_kernel_s_wa1:
buffer_load_dword v3, v2, s[60:63], 0 offen offset:12 sc1
s_waitcnt vmcnt(0)
v_cmp_gt_u32 vcc, 4, v3
s_cbranch_vccz main_kernel_s_wa1_ok
s_sleep 4
s_sub_u32 s29, s29, 1
s_cbranch_scc0 main_kernel_s_wa1
s_branch main_kernel_end
main_kernel_s_wa1_ok:
s_mov_b64 exec, 1
buffer_store_dword v8, v4, s[4:7], s16 offen sc1
s_mov_b64 exec, -1
main_kernel_s_nf:
ds_read_b128 v[16:19], v254 offset:1024
ds_read_b128 v[20:23], v254 offset:1040
ds_read_b128 v[24:27], v254 offset:1056
ds_read_b128 v[28:31], v254 offset:1072
s_waitcnt lgkmcnt(2)
v_pk_add_f32 v[16:17], v[16:17], v[18:19]
v_pk_add_f32 v[20:21], v[20:21], v[22:23]
s_waitcnt lgkmcnt(0)
v_pk_add_f32 v[24:25], v[24:25], v[26:27]
v_pk_add_f32 v[28:29], v[28:29], v[30:31]
v_pk_add_f32 v[16:17], v[16:17], v[20:21]
v_pk_add_f32 v[24:25], v[24:25], v[28:29]
v_pk_add_f32 v[16:17], v[16:17], v[24:25]
v_add_f32 v16, v16, v17
v_mov_b32 v17, 0x3727c5ac
v_fmac_f32 v17, 0x3a800000, v16
v_rsq_f32 v16, v17
s_nop 0
v_mov_b32 v17, v16
v_pk_mul_f32 v[64:65], v[64:65], v[16:17]
v_pk_mul_f32 v[66:67], v[66:67], v[16:17]
v_pk_mul_f32 v[68:69], v[68:69], v[16:17]
v_pk_mul_f32 v[70:71], v[70:71], v[16:17]
v_pk_mul_f32 v[72:73], v[72:73], v[16:17]
v_pk_mul_f32 v[74:75], v[74:75], v[16:17]
v_pk_mul_f32 v[76:77], v[76:77], v[16:17]
v_pk_mul_f32 v[78:79], v[78:79], v[16:17]
v_pk_mul_f32 v[80:81], v[80:81], v[16:17]
v_pk_mul_f32 v[82:83], v[82:83], v[16:17]
v_pk_mul_f32 v[84:85], v[84:85], v[16:17]
v_pk_mul_f32 v[86:87], v[86:87], v[16:17]
v_pk_mul_f32 v[88:89], v[88:89], v[16:17]
v_pk_mul_f32 v[90:91], v[90:91], v[16:17]
v_pk_mul_f32 v[92:93], v[92:93], v[16:17]
v_pk_mul_f32 v[94:95], v[94:95], v[16:17]
v_pk_mul_f32 v[96:97], v[96:97], v[16:17]
v_pk_mul_f32 v[98:99], v[98:99], v[16:17]
v_pk_mul_f32 v[100:101], v[100:101], v[16:17]
v_pk_mul_f32 v[102:103], v[102:103], v[16:17]
v_pk_mul_f32 v[104:105], v[104:105], v[16:17]
v_pk_mul_f32 v[106:107], v[106:107], v[16:17]
v_pk_mul_f32 v[108:109], v[108:109], v[16:17]
v_pk_mul_f32 v[110:111], v[110:111], v[16:17]
v_pk_mul_f32 v[112:113], v[112:113], v[16:17]
v_pk_mul_f32 v[114:115], v[114:115], v[16:17]
v_pk_mul_f32 v[116:117], v[116:117], v[16:17]
v_pk_mul_f32 v[118:119], v[118:119], v[16:17]
v_pk_mul_f32 v[120:121], v[120:121], v[16:17]
v_pk_mul_f32 v[122:123], v[122:123], v[16:17]
v_pk_mul_f32 v[124:125], v[124:125], v[16:17]
v_pk_mul_f32 v[126:127], v[126:127], v[16:17]
v_cvt_pk_bf16_f32 v32, v64, v65
v_cvt_pk_bf16_f32 v33, v66, v67
v_cvt_pk_bf16_f32 v34, v68, v69
v_cvt_pk_bf16_f32 v35, v70, v71
v_cvt_pk_bf16_f32 v36, v72, v73
v_cvt_pk_bf16_f32 v37, v74, v75
v_cvt_pk_bf16_f32 v38, v76, v77
v_cvt_pk_bf16_f32 v39, v78, v79
v_cvt_pk_bf16_f32 v40, v80, v81
v_cvt_pk_bf16_f32 v41, v82, v83
v_cvt_pk_bf16_f32 v42, v84, v85
v_cvt_pk_bf16_f32 v43, v86, v87
v_cvt_pk_bf16_f32 v44, v88, v89
v_cvt_pk_bf16_f32 v45, v90, v91
v_cvt_pk_bf16_f32 v46, v92, v93
v_cvt_pk_bf16_f32 v47, v94, v95
v_cvt_pk_bf16_f32 v48, v96, v97
v_cvt_pk_bf16_f32 v49, v98, v99
v_cvt_pk_bf16_f32 v50, v100, v101
v_cvt_pk_bf16_f32 v51, v102, v103
v_cvt_pk_bf16_f32 v52, v104, v105
v_cvt_pk_bf16_f32 v53, v106, v107
v_cvt_pk_bf16_f32 v54, v108, v109
v_cvt_pk_bf16_f32 v55, v110, v111
v_cvt_pk_bf16_f32 v56, v112, v113
v_cvt_pk_bf16_f32 v57, v114, v115
v_cvt_pk_bf16_f32 v58, v116, v117
v_cvt_pk_bf16_f32 v59, v118, v119
v_cvt_pk_bf16_f32 v60, v120, v121
v_cvt_pk_bf16_f32 v61, v122, v123
v_cvt_pk_bf16_f32 v62, v124, v125
v_cvt_pk_bf16_f32 v63, v126, v127
s_add_u32 s32, s34, 0x400000
s_add_u32 s33, s32, 4096
buffer_store_dwordx4 v[32:35], v251, s[4:7], s32 offen offset:0 sc1
buffer_store_dwordx4 v[36:39], v251, s[4:7], s32 offen offset:1024 sc1
buffer_store_dwordx4 v[40:43], v251, s[4:7], s32 offen offset:2048 sc1
buffer_store_dwordx4 v[44:47], v251, s[4:7], s32 offen offset:3072 sc1
buffer_store_dwordx4 v[48:51], v251, s[4:7], s33 offen offset:0 sc1
buffer_store_dwordx4 v[52:55], v251, s[4:7], s33 offen offset:1024 sc1
buffer_store_dwordx4 v[56:59], v251, s[4:7], s33 offen offset:2048 sc1
buffer_store_dwordx4 v[60:63], v251, s[4:7], s33 offen offset:3072 sc1
s_add_u32 s16, s16, 4
s_branch main_kernel_s_wa2_ok
main_kernel_s_fill:
s_lshl_b32 s32, s16, 2
s_sub_u32 s33, s32, 48
s_lshl_b32 s34, s32, 12
s_add_u32 s34, s34, 0x6c00000
s_cmp_lt_u32 s33, 16
s_cselect_b32 s34, 0x7f000000, s34
buffer_store_dwordx4 v[8:11], v1, s[4:7], s34 offen sc1
s_sub_u32 s33, s32, 47
s_lshl_b32 s34, s32, 12
s_add_u32 s34, s34, 0x6c01000
s_cmp_lt_u32 s33, 16
s_cselect_b32 s34, 0x7f000000, s34
buffer_store_dwordx4 v[8:11], v1, s[4:7], s34 offen sc1
s_sub_u32 s33, s32, 46
s_lshl_b32 s34, s32, 12
s_add_u32 s34, s34, 0x6c02000
s_cmp_lt_u32 s33, 16
s_cselect_b32 s34, 0x7f000000, s34
buffer_store_dwordx4 v[8:11], v1, s[4:7], s34 offen sc1
s_sub_u32 s33, s32, 45
s_lshl_b32 s34, s32, 12
s_add_u32 s34, s34, 0x6c03000
s_cmp_lt_u32 s33, 16
s_cselect_b32 s34, 0x7f000000, s34
buffer_store_dwordx4 v[8:11], v1, s[4:7], s34 offen sc1
s_lshl_b32 s32, s16, 12
s_add_u32 s33, s32, 0x8c00000
s_add_u32 s34, s32, 0x6e00000
buffer_store_dwordx4 v[8:11], v1, s[4:7], s34 offen sc1
s_add_u32 s32, s32, 0x8000000
buffer_store_dwordx4 v[8:11], v1, s[4:7], s32 offen sc1
buffer_store_dwordx4 v[8:11], v1, s[4:7], s33 offen sc1
s_lshl_b32 s16, s16, 2
s_add_u32 s16, s16, 0x841f000
s_cmp_lg_u32 s16, 0x841f034
s_cbranch_scc1 main_kernel_s_fd
s_mov_b32 s8, s76
s_and_b32 s9, s77, 0xffff
s_mov_b32 s10, 0x4000
s_mov_b32 s11, 0x20000
v_and_b32 v2, 7, v0
v_lshlrev_b32 v2, 11, v2
v_lshrrev_b32 v3, 6, v0
v_lshl_add_u32 v2, v3, 7, v2
v_bfe_u32 v3, v0, 4, 2
v_lshl_add_u32 v2, v3, 5, v2
v_bfe_u32 v3, v0, 3, 1
v_lshl_add_u32 v2, v3, 4, v2
buffer_load_dwordx4 v[16:19], v2, s[8:11], 0 offen offset:0
buffer_load_dwordx4 v[20:23], v2, s[8:11], 0 offen offset:512
buffer_load_dwordx4 v[24:27], v2, s[8:11], 0 offen offset:1024
buffer_load_dwordx4 v[28:31], v2, s[8:11], 0 offen offset:1536
s_mov_b32 s32, 0x6c30000
s_waitcnt vmcnt(0)
s_cmp_lt_u32 s14, 0
s_cbranch_scc1 main_kernel_s_m0b
v_lshlrev_b32 v2, 16, v16
v_and_b32 v3, 0xffff0000, v16
v_cvt_pk_f16_f32 v16, v2, v3
v_lshlrev_b32 v2, 16, v17
v_and_b32 v3, 0xffff0000, v17
v_cvt_pk_f16_f32 v17, v2, v3
v_lshlrev_b32 v2, 16, v18
v_and_b32 v3, 0xffff0000, v18
v_cvt_pk_f16_f32 v18, v2, v3
v_lshlrev_b32 v2, 16, v19
v_and_b32 v3, 0xffff0000, v19
v_cvt_pk_f16_f32 v19, v2, v3
v_lshlrev_b32 v2, 16, v20
v_and_b32 v3, 0xffff0000, v20
v_cvt_pk_f16_f32 v20, v2, v3
v_lshlrev_b32 v2, 16, v21
v_and_b32 v3, 0xffff0000, v21
v_cvt_pk_f16_f32 v21, v2, v3
v_lshlrev_b32 v2, 16, v22
v_and_b32 v3, 0xffff0000, v22
v_cvt_pk_f16_f32 v22, v2, v3
v_lshlrev_b32 v2, 16, v23
v_and_b32 v3, 0xffff0000, v23
v_cvt_pk_f16_f32 v23, v2, v3
v_lshlrev_b32 v2, 16, v24
v_and_b32 v3, 0xffff0000, v24
v_cvt_pk_f16_f32 v24, v2, v3
v_lshlrev_b32 v2, 16, v25
v_and_b32 v3, 0xffff0000, v25
v_cvt_pk_f16_f32 v25, v2, v3
v_lshlrev_b32 v2, 16, v26
v_and_b32 v3, 0xffff0000, v26
v_cvt_pk_f16_f32 v26, v2, v3
v_lshlrev_b32 v2, 16, v27
v_and_b32 v3, 0xffff0000, v27
v_cvt_pk_f16_f32 v27, v2, v3
v_lshlrev_b32 v2, 16, v28
v_and_b32 v3, 0xffff0000, v28
v_cvt_pk_f16_f32 v28, v2, v3
v_lshlrev_b32 v2, 16, v29
v_and_b32 v3, 0xffff0000, v29
v_cvt_pk_f16_f32 v29, v2, v3
v_lshlrev_b32 v2, 16, v30
v_and_b32 v3, 0xffff0000, v30
v_cvt_pk_f16_f32 v30, v2, v3
v_lshlrev_b32 v2, 16, v31
v_and_b32 v3, 0xffff0000, v31
v_cvt_pk_f16_f32 v31, v2, v3
main_kernel_s_m0b:
v_xor_b32 v2, 0, v1
buffer_store_dwordx4 v[16:19], v1, s[4:7], s32 offen sc1
s_add_u32 s32, s32, 4096
buffer_store_dwordx4 v[20:23], v2, s[4:7], s32 offen sc1
s_add_u32 s32, s32, 4096
buffer_store_dwordx4 v[24:27], v1, s[4:7], s32 offen sc1
s_add_u32 s32, s32, 4096
buffer_store_dwordx4 v[28:31], v2, s[4:7], s32 offen sc1
s_add_u32 s32, s32, 4096
buffer_store_dwordx4 v[4:7], v1, s[4:7], s32 offen sc1
s_add_u32 s32, s32, 4096
buffer_store_dwordx4 v[4:7], v2, s[4:7], s32 offen sc1
s_add_u32 s32, s32, 4096
buffer_store_dwordx4 v[4:7], v1, s[4:7], s32 offen sc1
s_add_u32 s32, s32, 4096
buffer_store_dwordx4 v[4:7], v2, s[4:7], s32 offen sc1
s_add_u32 s32, s32, 4096
buffer_store_dwordx4 v[16:19], v1, s[4:7], s32 offen sc1
s_add_u32 s32, s32, 4096
buffer_store_dwordx4 v[20:23], v2, s[4:7], s32 offen sc1
s_add_u32 s32, s32, 4096
buffer_store_dwordx4 v[24:27], v1, s[4:7], s32 offen sc1
s_add_u32 s32, s32, 4096
buffer_store_dwordx4 v[28:31], v2, s[4:7], s32 offen sc1
s_add_u32 s32, s32, 4096
buffer_store_dwordx4 v[4:7], v1, s[4:7], s32 offen sc1
s_add_u32 s32, s32, 4096
buffer_store_dwordx4 v[4:7], v2, s[4:7], s32 offen sc1
s_add_u32 s32, s32, 4096
buffer_store_dwordx4 v[4:7], v1, s[4:7], s32 offen sc1
s_add_u32 s32, s32, 4096
buffer_store_dwordx4 v[4:7], v2, s[4:7], s32 offen sc1
s_add_u32 s32, s32, 4096
v_mov_b32 v2, 0
main_kernel_s_wa3:
buffer_load_dword v3, v2, s[60:63], 0 offen offset:12 sc1
s_waitcnt vmcnt(0)
v_cmp_gt_u32 vcc, 4, v3
s_cbranch_vccz main_kernel_s_wa3_ok
s_sleep 4
s_sub_u32 s29, s29, 1
s_cbranch_scc0 main_kernel_s_wa3
s_branch main_kernel_end
main_kernel_s_wa3_ok:
v_lshlrev_b32 v2, 7, v250
s_mov_b32 s32, 0x841a000
s_mov_b64 exec, 15
buffer_store_dwordx4 v[8:11], v2, s[4:7], s32 offen sc1
s_mov_b64 exec, -1
main_kernel_s_fd:
s_cmp_lg_u32 s14, 0
s_cbranch_scc1 main_kernel_s_wa2_ok
v_mov_b32 v2, 0
main_kernel_s_wa2:
buffer_load_dword v3, v2, s[60:63], 0 offen offset:12 sc1
s_waitcnt vmcnt(0)
v_cmp_gt_u32 vcc, 4, v3
s_cbranch_vccz main_kernel_s_wa2_ok
s_sleep 4
s_sub_u32 s29, s29, 1
s_cbranch_scc0 main_kernel_s_wa2
s_branch main_kernel_end
main_kernel_s_wa2_ok:
s_waitcnt vmcnt(0)
s_barrier
s_cmp_lg_u32 s14, 0
s_cbranch_scc1 main_kernel_s_end
s_mov_b64 exec, 1
buffer_store_dword v8, v4, s[4:7], s16 offen sc1
s_mov_b64 exec, -1
main_kernel_s_end:
s_lshl_b32 s32, s12, 5
s_add_u32 s32, s32, s13
s_sub_u32 s32, s32, 96
s_cmp_lt_u32 s32, 16
s_cbranch_scc1 main_kernel_att
s_branch main_kernel_worker
main_kernel_end:
s_endpgm
main_kernel_chain:
s_lshr_b32 s15, s13, 1
s_lshl_b32 s32, s12, 4
s_add_u32 s15, s15, s32
s_and_b32 s16, s13, 1
s_lshl_b32 s36, s14, 15
s_add_u32 s36, s36, 32768
v_lshrrev_b32 v126, 3, v94
v_and_b32 v127, 7, v94
v_lshlrev_b32 v126, 13, v126
v_lshl_add_u32 v64, v127, 4, v126
v_lshrrev_b32 v126, 2, v94
v_and_b32 v70, 3, v94
v_lshlrev_b32 v126, 11, v126
v_lshl_add_u32 v65, v70, 4, v126
v_lshrrev_b32 v126, 5, v94
v_lshlrev_b32 v69, 4, v126
v_bfe_u32 v126, v94, 4, 1
v_lshl_add_u32 v69, v126, 2, v69
v_bfe_u32 v126, v94, 2, 1
v_add_u32 v69, v69, v126
v_bfe_u32 v126, v94, 3, 1
v_lshl_add_u32 v69, v126, 3, v69
v_lshl_add_u32 v126, v69, 7, s36
v_lshl_add_u32 v67, v70, 3, v126
v_lshl_add_u32 v126, v69, 6, s36
v_lshl_add_u32 v68, v70, 3, v126
v_lshlrev_b32 v116, 4, v94
v_add_u32 v113, s36, v116
v_lshlrev_b32 v126, 7, v69
v_lshl_add_u32 v41, v70, 3, v126
v_lshl_add_u32 v41, s14, 5, v41
v_and_b32 v127, 1, v70
v_lshl_add_u32 v40, v127, 3, v126
v_lshrrev_b32 v127, 1, v70
v_lshl_add_u32 v40, v127, 5, v40
s_lshr_b32 s32, s14, 1
s_and_b32 s33, s14, 1
v_lshl_add_u32 v40, s32, 6, v40
v_lshl_add_u32 v40, s33, 4, v40
s_xor_b32 s32, s14, 0
s_lshl_b32 s32, s32, 15
s_add_u32 s32, s32, 32768
v_add_u32 v32, s32, v40
v_add_u32 v36, s32, v41
s_xor_b32 s32, s14, 1
s_lshl_b32 s32, s32, 15
s_add_u32 s32, s32, 32768
v_add_u32 v33, s32, v40
v_add_u32 v37, s32, v41
s_xor_b32 s32, s14, 2
s_lshl_b32 s32, s32, 15
s_add_u32 s32, s32, 32768
v_add_u32 v34, s32, v40
v_add_u32 v38, s32, v41
s_xor_b32 s32, s14, 3
s_lshl_b32 s32, s32, 15
s_add_u32 s32, s32, 32768
v_add_u32 v35, s32, v40
v_add_u32 v39, s32, v41
s_lshl_b32 s34, s14, 21
s_lshl_b32 s32, s15, 8
s_add_u32 s34, s34, s32
s_lshl_b32 s32, s16, 7
s_add_u32 s34, s34, s32
s_lshl_b32 s35, s12, 22
s_lshl_b32 s32, s14, 20
s_add_u32 s35, s35, s32
s_lshl_b32 s32, s13, 6
s_add_u32 s35, s35, s32
s_xor_b32 s32, s14, s13
s_and_b32 s32, s32, 3
s_lshl_b32 s32, s32, 19
s_add_u32 s34, s34, s32
s_xor_b32 s32, s14, s13
s_and_b32 s32, s32, 7
s_lshl_b32 s32, s32, 17
s_add_u32 s35, s35, s32
v_bfe_u32 v126, v94, 2, 1
v_lshl_add_u32 v126, s13, 1, v126
v_lshlrev_b32 v126, 13, v126
v_lshl_add_u32 v80, v70, 10, v126
v_and_b32 v126, 7, v94
v_lshl_add_u32 v126, s13, 3, v126
v_lshlrev_b32 v81, 10, v126
v_min_u32 v73, 8, v94
v_lshlrev_b32 v73, 5, v73
v_mov_b32 v126, 12
v_cmp_gt_u32 vcc, 8, v94
v_lshlrev_b32 v74, 2, v94
v_add_u32 v74, 0x841f000, v74
v_cndmask_b32 v73, v126, v73, vcc
v_and_b32 v75, 1, v94
s_lshl_b32 s32, s15, 2
s_add_u32 s32, s32, 0x8406000
v_lshl_add_u32 v75, v75, 13, s32
s_mov_b32 s8, s42
s_and_b32 s9, s43, 0xffff
s_mov_b32 s10, 0x800000
s_mov_b32 s11, 0x20000
s_sub_u32 s39, 511, s42
s_and_b32 s39, s39, 0x380
s_lshr_b32 s33, s39, 7
s_xor_b32 s33, s14, s33
s_and_b32 s33, s33, 3
s_lshl_b32 s33, s33, 19
s_add_u32 s39, s39, s33
s_andn2_b32 s32, s34, 0x180fff
s_add_u32 s39, s39, s32
s_xor_b32 s32, s39, 0x0
buffer_load_dword v82, v80, s[8:11], s32 offen
s_xor_b32 s32, s34, 0x0
s_add_u32 m0, s36, 0
s_nop 0
buffer_load_dwordx4 v64, s[8:11], s32 offen lds
s_xor_b32 s32, s34, 0x10000
s_add_u32 m0, s36, 1024
s_nop 0
buffer_load_dwordx4 v64, s[8:11], s32 offen lds
s_xor_b32 s32, s34, 0x20000
s_add_u32 m0, s36, 2048
s_nop 0
buffer_load_dwordx4 v64, s[8:11], s32 offen lds
s_xor_b32 s32, s34, 0x30000
s_add_u32 m0, s36, 3072
s_nop 0
buffer_load_dwordx4 v64, s[8:11], s32 offen lds
s_xor_b32 s32, s34, 0x40000
s_add_u32 m0, s36, 4096
s_nop 0
buffer_load_dwordx4 v64, s[8:11], s32 offen lds
s_xor_b32 s32, s34, 0x50000
s_add_u32 m0, s36, 5120
s_nop 0
buffer_load_dwordx4 v64, s[8:11], s32 offen lds
s_xor_b32 s32, s34, 0x60000
s_add_u32 m0, s36, 6144
s_nop 0
buffer_load_dwordx4 v64, s[8:11], s32 offen lds
s_xor_b32 s32, s34, 0x70000
s_add_u32 m0, s36, 7168
s_nop 0
buffer_load_dwordx4 v64, s[8:11], s32 offen lds
s_xor_b32 s32, s39, 0x80000
buffer_load_dword v82, v80, s[8:11], s32 offen
s_xor_b32 s32, s34, 0x80000
s_add_u32 m0, s36, 8192
s_nop 0
buffer_load_dwordx4 v64, s[8:11], s32 offen lds
s_xor_b32 s32, s34, 0x90000
s_add_u32 m0, s36, 9216
s_nop 0
buffer_load_dwordx4 v64, s[8:11], s32 offen lds
s_xor_b32 s32, s34, 0xa0000
s_add_u32 m0, s36, 10240
s_nop 0
buffer_load_dwordx4 v64, s[8:11], s32 offen lds
s_xor_b32 s32, s34, 0xb0000
s_add_u32 m0, s36, 11264
s_nop 0
buffer_load_dwordx4 v64, s[8:11], s32 offen lds
s_xor_b32 s32, s34, 0xc0000
s_add_u32 m0, s36, 12288
s_nop 0
buffer_load_dwordx4 v64, s[8:11], s32 offen lds
s_xor_b32 s32, s34, 0xd0000
s_add_u32 m0, s36, 13312
s_nop 0
buffer_load_dwordx4 v64, s[8:11], s32 offen lds
s_xor_b32 s32, s34, 0xe0000
s_add_u32 m0, s36, 14336
s_nop 0
buffer_load_dwordx4 v64, s[8:11], s32 offen lds
s_xor_b32 s32, s34, 0xf0000
s_add_u32 m0, s36, 15360
s_nop 0
buffer_load_dwordx4 v64, s[8:11], s32 offen lds
s_xor_b32 s32, s39, 0x100000
buffer_load_dword v82, v80, s[8:11], s32 offen
s_xor_b32 s32, s34, 0x100000
s_add_u32 m0, s36, 16384
s_nop 0
buffer_load_dwordx4 v64, s[8:11], s32 offen lds
s_xor_b32 s32, s34, 0x110000
s_add_u32 m0, s36, 17408
s_nop 0
buffer_load_dwordx4 v64, s[8:11], s32 offen lds
s_xor_b32 s32, s34, 0x120000
s_add_u32 m0, s36, 18432
s_nop 0
buffer_load_dwordx4 v64, s[8:11], s32 offen lds
s_xor_b32 s32, s34, 0x130000
s_add_u32 m0, s36, 19456
s_nop 0
buffer_load_dwordx4 v64, s[8:11], s32 offen lds
s_xor_b32 s32, s34, 0x140000
s_add_u32 m0, s36, 20480
s_nop 0
buffer_load_dwordx4 v64, s[8:11], s32 offen lds
s_xor_b32 s32, s34, 0x150000
s_add_u32 m0, s36, 21504
s_nop 0
buffer_load_dwordx4 v64, s[8:11], s32 offen lds
s_xor_b32 s32, s34, 0x160000
s_add_u32 m0, s36, 22528
s_nop 0
buffer_load_dwordx4 v64, s[8:11], s32 offen lds
s_xor_b32 s32, s34, 0x170000
s_add_u32 m0, s36, 23552
s_nop 0
buffer_load_dwordx4 v64, s[8:11], s32 offen lds
s_xor_b32 s32, s39, 0x180000
buffer_load_dword v82, v80, s[8:11], s32 offen
s_xor_b32 s32, s34, 0x180000
s_add_u32 m0, s36, 24576
s_nop 0
buffer_load_dwordx4 v64, s[8:11], s32 offen lds
s_xor_b32 s32, s34, 0x190000
s_add_u32 m0, s36, 25600
s_nop 0
buffer_load_dwordx4 v64, s[8:11], s32 offen lds
s_xor_b32 s32, s34, 0x1a0000
s_add_u32 m0, s36, 26624
s_nop 0
buffer_load_dwordx4 v64, s[8:11], s32 offen lds
s_xor_b32 s32, s34, 0x1b0000
s_add_u32 m0, s36, 27648
s_nop 0
buffer_load_dwordx4 v64, s[8:11], s32 offen lds
s_xor_b32 s32, s34, 0x1c0000
s_add_u32 m0, s36, 28672
s_nop 0
buffer_load_dwordx4 v64, s[8:11], s32 offen lds
s_xor_b32 s32, s34, 0x1d0000
s_add_u32 m0, s36, 29696
s_nop 0
buffer_load_dwordx4 v64, s[8:11], s32 offen lds
s_xor_b32 s32, s34, 0x1e0000
s_add_u32 m0, s36, 30720
s_nop 0
buffer_load_dwordx4 v64, s[8:11], s32 offen lds
s_xor_b32 s32, s34, 0x1f0000
s_add_u32 m0, s36, 31744
s_nop 0
buffer_load_dwordx4 v64, s[8:11], s32 offen lds
s_waitcnt vmcnt(27)
s_barrier
ds_read_b64_tr_b16 v[0:1], v32 offset:0
ds_read_b64_tr_b16 v[2:3], v32 offset:256
ds_read_b64_tr_b16 v[4:5], v32 offset:4096
ds_read_b64_tr_b16 v[6:7], v32 offset:4352
ds_read_b64_tr_b16 v[8:9], v33 offset:0
ds_read_b64_tr_b16 v[10:11], v33 offset:256
ds_read_b64_tr_b16 v[12:13], v33 offset:4096
ds_read_b64_tr_b16 v[14:15], v33 offset:4352
ds_read_b64_tr_b16 v[16:17], v34 offset:0
ds_read_b64_tr_b16 v[18:19], v34 offset:256
ds_read_b64_tr_b16 v[20:21], v34 offset:4096
ds_read_b64_tr_b16 v[22:23], v34 offset:4352
ds_read_b64_tr_b16 v[24:25], v35 offset:0
ds_read_b64_tr_b16 v[26:27], v35 offset:256
ds_read_b64_tr_b16 v[28:29], v35 offset:4096
ds_read_b64_tr_b16 v[30:31], v35 offset:4352
s_waitcnt lgkmcnt(0)
s_barrier
s_mov_b32 s8, s44
s_and_b32 s9, s45, 0xffff
s_mov_b32 s10, 0x800000
s_mov_b32 s11, 0x20000
s_sub_u32 s39, 511, s44
s_and_b32 s39, s39, 0x380
s_lshr_b32 s33, s39, 7
s_xor_b32 s33, s14, s33
s_and_b32 s33, s33, 3
s_lshl_b32 s33, s33, 19
s_add_u32 s39, s39, s33
s_andn2_b32 s32, s34, 0x180fff
s_add_u32 s39, s39, s32
s_xor_b32 s32, s39, 0x0
buffer_load_dword v82, v80, s[8:11], s32 offen
s_xor_b32 s32, s34, 0x0
s_add_u32 m0, s36, 0
s_nop 0
buffer_load_dwordx4 v64, s[8:11], s32 offen lds
s_xor_b32 s32, s34, 0x10000
s_add_u32 m0, s36, 1024
s_nop 0
buffer_load_dwordx4 v64, s[8:11], s32 offen lds
s_xor_b32 s32, s34, 0x20000
s_add_u32 m0, s36, 2048
s_nop 0
buffer_load_dwordx4 v64, s[8:11], s32 offen lds
s_xor_b32 s32, s34, 0x30000
s_add_u32 m0, s36, 3072
s_nop 0
buffer_load_dwordx4 v64, s[8:11], s32 offen lds
s_xor_b32 s32, s34, 0x40000
s_add_u32 m0, s36, 4096
s_nop 0
buffer_load_dwordx4 v64, s[8:11], s32 offen lds
s_xor_b32 s32, s34, 0x50000
s_add_u32 m0, s36, 5120
s_nop 0
buffer_load_dwordx4 v64, s[8:11], s32 offen lds
s_xor_b32 s32, s34, 0x60000
s_add_u32 m0, s36, 6144
s_nop 0
buffer_load_dwordx4 v64, s[8:11], s32 offen lds
s_xor_b32 s32, s34, 0x70000
s_add_u32 m0, s36, 7168
s_nop 0
buffer_load_dwordx4 v64, s[8:11], s32 offen lds
v_lshlrev_b32 v42, 16, v0
v_and_b32 v43, 0xffff0000, v0
v_cvt_pk_f16_f32 v0, v42, v43
v_lshlrev_b32 v44, 16, v1
v_and_b32 v45, 0xffff0000, v1
v_cvt_pk_f16_f32 v1, v44, v45
v_lshlrev_b32 v42, 16, v2
v_and_b32 v43, 0xffff0000, v2
v_cvt_pk_f16_f32 v2, v42, v43
v_lshlrev_b32 v44, 16, v3
v_and_b32 v45, 0xffff0000, v3
v_cvt_pk_f16_f32 v3, v44, v45
v_lshlrev_b32 v42, 16, v4
v_and_b32 v43, 0xffff0000, v4
v_cvt_pk_f16_f32 v4, v42, v43
v_lshlrev_b32 v44, 16, v5
v_and_b32 v45, 0xffff0000, v5
v_cvt_pk_f16_f32 v5, v44, v45
v_lshlrev_b32 v42, 16, v6
v_and_b32 v43, 0xffff0000, v6
v_cvt_pk_f16_f32 v6, v42, v43
v_lshlrev_b32 v44, 16, v7
v_and_b32 v45, 0xffff0000, v7
v_cvt_pk_f16_f32 v7, v44, v45
v_accvgpr_write_b32 a128, v0
v_accvgpr_write_b32 a129, v1
v_accvgpr_write_b32 a130, v2
v_accvgpr_write_b32 a131, v3
v_accvgpr_write_b32 a132, v4
v_accvgpr_write_b32 a133, v5
v_accvgpr_write_b32 a134, v6
v_accvgpr_write_b32 a135, v7
v_lshlrev_b32 v42, 16, v8
v_and_b32 v43, 0xffff0000, v8
v_cvt_pk_f16_f32 v8, v42, v43
v_lshlrev_b32 v44, 16, v9
v_and_b32 v45, 0xffff0000, v9
v_cvt_pk_f16_f32 v9, v44, v45
v_lshlrev_b32 v42, 16, v10
v_and_b32 v43, 0xffff0000, v10
v_cvt_pk_f16_f32 v10, v42, v43
v_lshlrev_b32 v44, 16, v11
v_and_b32 v45, 0xffff0000, v11
v_cvt_pk_f16_f32 v11, v44, v45
v_lshlrev_b32 v42, 16, v12
v_and_b32 v43, 0xffff0000, v12
v_cvt_pk_f16_f32 v12, v42, v43
v_lshlrev_b32 v44, 16, v13
v_and_b32 v45, 0xffff0000, v13
v_cvt_pk_f16_f32 v13, v44, v45
v_lshlrev_b32 v42, 16, v14
v_and_b32 v43, 0xffff0000, v14
v_cvt_pk_f16_f32 v14, v42, v43
v_lshlrev_b32 v44, 16, v15
v_and_b32 v45, 0xffff0000, v15
v_cvt_pk_f16_f32 v15, v44, v45
v_accvgpr_write_b32 a160, v8
v_accvgpr_write_b32 a161, v9
v_accvgpr_write_b32 a162, v10
v_accvgpr_write_b32 a163, v11
v_accvgpr_write_b32 a164, v12
v_accvgpr_write_b32 a165, v13
v_accvgpr_write_b32 a166, v14
v_accvgpr_write_b32 a167, v15
v_lshlrev_b32 v42, 16, v16
v_and_b32 v43, 0xffff0000, v16
v_cvt_pk_f16_f32 v16, v42, v43
v_lshlrev_b32 v44, 16, v17
v_and_b32 v45, 0xffff0000, v17
v_cvt_pk_f16_f32 v17, v44, v45
v_lshlrev_b32 v42, 16, v18
v_and_b32 v43, 0xffff0000, v18
v_cvt_pk_f16_f32 v18, v42, v43
v_lshlrev_b32 v44, 16, v19
v_and_b32 v45, 0xffff0000, v19
v_cvt_pk_f16_f32 v19, v44, v45
v_lshlrev_b32 v42, 16, v20
v_and_b32 v43, 0xffff0000, v20
v_cvt_pk_f16_f32 v20, v42, v43
v_lshlrev_b32 v44, 16, v21
v_and_b32 v45, 0xffff0000, v21
v_cvt_pk_f16_f32 v21, v44, v45
v_lshlrev_b32 v42, 16, v22
v_and_b32 v43, 0xffff0000, v22
v_cvt_pk_f16_f32 v22, v42, v43
v_lshlrev_b32 v44, 16, v23
v_and_b32 v45, 0xffff0000, v23
v_cvt_pk_f16_f32 v23, v44, v45
v_accvgpr_write_b32 a192, v16
v_accvgpr_write_b32 a193, v17
v_accvgpr_write_b32 a194, v18
v_accvgpr_write_b32 a195, v19
v_accvgpr_write_b32 a196, v20
v_accvgpr_write_b32 a197, v21
v_accvgpr_write_b32 a198, v22
v_accvgpr_write_b32 a199, v23
v_lshlrev_b32 v42, 16, v24
v_and_b32 v43, 0xffff0000, v24
v_cvt_pk_f16_f32 v24, v42, v43
v_lshlrev_b32 v44, 16, v25
v_and_b32 v45, 0xffff0000, v25
v_cvt_pk_f16_f32 v25, v44, v45
v_lshlrev_b32 v42, 16, v26
v_and_b32 v43, 0xffff0000, v26
v_cvt_pk_f16_f32 v26, v42, v43
v_lshlrev_b32 v44, 16, v27
v_and_b32 v45, 0xffff0000, v27
v_cvt_pk_f16_f32 v27, v44, v45
v_lshlrev_b32 v42, 16, v28
v_and_b32 v43, 0xffff0000, v28
v_cvt_pk_f16_f32 v28, v42, v43
v_lshlrev_b32 v44, 16, v29
v_and_b32 v45, 0xffff0000, v29
v_cvt_pk_f16_f32 v29, v44, v45
v_lshlrev_b32 v42, 16, v30
v_and_b32 v43, 0xffff0000, v30
v_cvt_pk_f16_f32 v30, v42, v43
v_lshlrev_b32 v44, 16, v31
v_and_b32 v45, 0xffff0000, v31
v_cvt_pk_f16_f32 v31, v44, v45
v_accvgpr_write_b32 a224, v24
v_accvgpr_write_b32 a225, v25
v_accvgpr_write_b32 a226, v26
v_accvgpr_write_b32 a227, v27
v_accvgpr_write_b32 a228, v28
v_accvgpr_write_b32 a229, v29
v_accvgpr_write_b32 a230, v30
v_accvgpr_write_b32 a231, v31
s_waitcnt vmcnt(27)
s_barrier
ds_read_b64_tr_b16 v[0:1], v32 offset:8192
ds_read_b64_tr_b16 v[2:3], v32 offset:8448
ds_read_b64_tr_b16 v[4:5], v32 offset:12288
ds_read_b64_tr_b16 v[6:7], v32 offset:12544
ds_read_b64_tr_b16 v[8:9], v33 offset:8192
ds_read_b64_tr_b16 v[10:11], v33 offset:8448
ds_read_b64_tr_b16 v[12:13], v33 offset:12288
ds_read_b64_tr_b16 v[14:15], v33 offset:12544
ds_read_b64_tr_b16 v[16:17], v34 offset:8192
ds_read_b64_tr_b16 v[18:19], v34 offset:8448
ds_read_b64_tr_b16 v[20:21], v34 offset:12288
ds_read_b64_tr_b16 v[22:23], v34 offset:12544
ds_read_b64_tr_b16 v[24:25], v35 offset:8192
ds_read_b64_tr_b16 v[26:27], v35 offset:8448
ds_read_b64_tr_b16 v[28:29], v35 offset:12288
ds_read_b64_tr_b16 v[30:31], v35 offset:12544
s_waitcnt lgkmcnt(0)
s_barrier
s_xor_b32 s32, s39, 0x80000
buffer_load_dword v82, v80, s[8:11], s32 offen
s_xor_b32 s32, s34, 0x80000
s_add_u32 m0, s36, 8192
s_nop 0
buffer_load_dwordx4 v64, s[8:11], s32 offen lds
s_xor_b32 s32, s34, 0x90000
s_add_u32 m0, s36, 9216
s_nop 0
buffer_load_dwordx4 v64, s[8:11], s32 offen lds
s_xor_b32 s32, s34, 0xa0000
s_add_u32 m0, s36, 10240
s_nop 0
buffer_load_dwordx4 v64, s[8:11], s32 offen lds
s_xor_b32 s32, s34, 0xb0000
s_add_u32 m0, s36, 11264
s_nop 0
buffer_load_dwordx4 v64, s[8:11], s32 offen lds
s_xor_b32 s32, s34, 0xc0000
s_add_u32 m0, s36, 12288
s_nop 0
buffer_load_dwordx4 v64, s[8:11], s32 offen lds
s_xor_b32 s32, s34, 0xd0000
s_add_u32 m0, s36, 13312
s_nop 0
buffer_load_dwordx4 v64, s[8:11], s32 offen lds
s_xor_b32 s32, s34, 0xe0000
s_add_u32 m0, s36, 14336
s_nop 0
buffer_load_dwordx4 v64, s[8:11], s32 offen lds
s_xor_b32 s32, s34, 0xf0000
s_add_u32 m0, s36, 15360
s_nop 0
buffer_load_dwordx4 v64, s[8:11], s32 offen lds
v_lshlrev_b32 v42, 16, v0
v_and_b32 v43, 0xffff0000, v0
v_cvt_pk_f16_f32 v0, v42, v43
v_lshlrev_b32 v44, 16, v1
v_and_b32 v45, 0xffff0000, v1
v_cvt_pk_f16_f32 v1, v44, v45
v_lshlrev_b32 v42, 16, v2
v_and_b32 v43, 0xffff0000, v2
v_cvt_pk_f16_f32 v2, v42, v43
v_lshlrev_b32 v44, 16, v3
v_and_b32 v45, 0xffff0000, v3
v_cvt_pk_f16_f32 v3, v44, v45
v_lshlrev_b32 v42, 16, v4
v_and_b32 v43, 0xffff0000, v4
v_cvt_pk_f16_f32 v4, v42, v43
v_lshlrev_b32 v44, 16, v5
v_and_b32 v45, 0xffff0000, v5
v_cvt_pk_f16_f32 v5, v44, v45
v_lshlrev_b32 v42, 16, v6
v_and_b32 v43, 0xffff0000, v6
v_cvt_pk_f16_f32 v6, v42, v43
v_lshlrev_b32 v44, 16, v7
v_and_b32 v45, 0xffff0000, v7
v_cvt_pk_f16_f32 v7, v44, v45
v_accvgpr_write_b32 a136, v0
v_accvgpr_write_b32 a137, v1
v_accvgpr_write_b32 a138, v2
v_accvgpr_write_b32 a139, v3
v_accvgpr_write_b32 a140, v4
v_accvgpr_write_b32 a141, v5
v_accvgpr_write_b32 a142, v6
v_accvgpr_write_b32 a143, v7
v_lshlrev_b32 v42, 16, v8
v_and_b32 v43, 0xffff0000, v8
v_cvt_pk_f16_f32 v8, v42, v43
v_lshlrev_b32 v44, 16, v9
v_and_b32 v45, 0xffff0000, v9
v_cvt_pk_f16_f32 v9, v44, v45
v_lshlrev_b32 v42, 16, v10
v_and_b32 v43, 0xffff0000, v10
v_cvt_pk_f16_f32 v10, v42, v43
v_lshlrev_b32 v44, 16, v11
v_and_b32 v45, 0xffff0000, v11
v_cvt_pk_f16_f32 v11, v44, v45
v_lshlrev_b32 v42, 16, v12
v_and_b32 v43, 0xffff0000, v12
v_cvt_pk_f16_f32 v12, v42, v43
v_lshlrev_b32 v44, 16, v13
v_and_b32 v45, 0xffff0000, v13
v_cvt_pk_f16_f32 v13, v44, v45
v_lshlrev_b32 v42, 16, v14
v_and_b32 v43, 0xffff0000, v14
v_cvt_pk_f16_f32 v14, v42, v43
v_lshlrev_b32 v44, 16, v15
v_and_b32 v45, 0xffff0000, v15
v_cvt_pk_f16_f32 v15, v44, v45
v_accvgpr_write_b32 a168, v8
v_accvgpr_write_b32 a169, v9
v_accvgpr_write_b32 a170, v10
v_accvgpr_write_b32 a171, v11
v_accvgpr_write_b32 a172, v12
v_accvgpr_write_b32 a173, v13
v_accvgpr_write_b32 a174, v14
v_accvgpr_write_b32 a175, v15
v_lshlrev_b32 v42, 16, v16
v_and_b32 v43, 0xffff0000, v16
v_cvt_pk_f16_f32 v16, v42, v43
v_lshlrev_b32 v44, 16, v17
v_and_b32 v45, 0xffff0000, v17
v_cvt_pk_f16_f32 v17, v44, v45
v_lshlrev_b32 v42, 16, v18
v_and_b32 v43, 0xffff0000, v18
v_cvt_pk_f16_f32 v18, v42, v43
v_lshlrev_b32 v44, 16, v19
v_and_b32 v45, 0xffff0000, v19
v_cvt_pk_f16_f32 v19, v44, v45
v_lshlrev_b32 v42, 16, v20
v_and_b32 v43, 0xffff0000, v20
v_cvt_pk_f16_f32 v20, v42, v43
v_lshlrev_b32 v44, 16, v21
v_and_b32 v45, 0xffff0000, v21
v_cvt_pk_f16_f32 v21, v44, v45
v_lshlrev_b32 v42, 16, v22
v_and_b32 v43, 0xffff0000, v22
v_cvt_pk_f16_f32 v22, v42, v43
v_lshlrev_b32 v44, 16, v23
v_and_b32 v45, 0xffff0000, v23
v_cvt_pk_f16_f32 v23, v44, v45
v_accvgpr_write_b32 a200, v16
v_accvgpr_write_b32 a201, v17
v_accvgpr_write_b32 a202, v18
v_accvgpr_write_b32 a203, v19
v_accvgpr_write_b32 a204, v20
v_accvgpr_write_b32 a205, v21
v_accvgpr_write_b32 a206, v22
v_accvgpr_write_b32 a207, v23
v_lshlrev_b32 v42, 16, v24
v_and_b32 v43, 0xffff0000, v24
v_cvt_pk_f16_f32 v24, v42, v43
v_lshlrev_b32 v44, 16, v25
v_and_b32 v45, 0xffff0000, v25
v_cvt_pk_f16_f32 v25, v44, v45
v_lshlrev_b32 v42, 16, v26
v_and_b32 v43, 0xffff0000, v26
v_cvt_pk_f16_f32 v26, v42, v43
v_lshlrev_b32 v44, 16, v27
v_and_b32 v45, 0xffff0000, v27
v_cvt_pk_f16_f32 v27, v44, v45
v_lshlrev_b32 v42, 16, v28
v_and_b32 v43, 0xffff0000, v28
v_cvt_pk_f16_f32 v28, v42, v43
v_lshlrev_b32 v44, 16, v29
v_and_b32 v45, 0xffff0000, v29
v_cvt_pk_f16_f32 v29, v44, v45
v_lshlrev_b32 v42, 16, v30
v_and_b32 v43, 0xffff0000, v30
v_cvt_pk_f16_f32 v30, v42, v43
v_lshlrev_b32 v44, 16, v31
v_and_b32 v45, 0xffff0000, v31
v_cvt_pk_f16_f32 v31, v44, v45
v_accvgpr_write_b32 a232, v24
v_accvgpr_write_b32 a233, v25
v_accvgpr_write_b32 a234, v26
v_accvgpr_write_b32 a235, v27
v_accvgpr_write_b32 a236, v28
v_accvgpr_write_b32 a237, v29
v_accvgpr_write_b32 a238, v30
v_accvgpr_write_b32 a239, v31
s_waitcnt vmcnt(27)
s_barrier
ds_read_b64_tr_b16 v[0:1], v32 offset:16384
ds_read_b64_tr_b16 v[2:3], v32 offset:16640
ds_read_b64_tr_b16 v[4:5], v32 offset:20480
ds_read_b64_tr_b16 v[6:7], v32 offset:20736
ds_read_b64_tr_b16 v[8:9], v33 offset:16384
ds_read_b64_tr_b16 v[10:11], v33 offset:16640
ds_read_b64_tr_b16 v[12:13], v33 offset:20480
ds_read_b64_tr_b16 v[14:15], v33 offset:20736
ds_read_b64_tr_b16 v[16:17], v34 offset:16384
ds_read_b64_tr_b16 v[18:19], v34 offset:16640
ds_read_b64_tr_b16 v[20:21], v34 offset:20480
ds_read_b64_tr_b16 v[22:23], v34 offset:20736
ds_read_b64_tr_b16 v[24:25], v35 offset:16384
ds_read_b64_tr_b16 v[26:27], v35 offset:16640
ds_read_b64_tr_b16 v[28:29], v35 offset:20480
ds_read_b64_tr_b16 v[30:31], v35 offset:20736
s_waitcnt lgkmcnt(0)
s_barrier
s_xor_b32 s32, s39, 0x100000
buffer_load_dword v82, v80, s[8:11], s32 offen
s_xor_b32 s32, s34, 0x100000
s_add_u32 m0, s36, 16384
s_nop 0
buffer_load_dwordx4 v64, s[8:11], s32 offen lds
s_xor_b32 s32, s34, 0x110000
s_add_u32 m0, s36, 17408
s_nop 0
buffer_load_dwordx4 v64, s[8:11], s32 offen lds
s_xor_b32 s32, s34, 0x120000
s_add_u32 m0, s36, 18432
s_nop 0
buffer_load_dwordx4 v64, s[8:11], s32 offen lds
s_xor_b32 s32, s34, 0x130000
s_add_u32 m0, s36, 19456
s_nop 0
buffer_load_dwordx4 v64, s[8:11], s32 offen lds
s_xor_b32 s32, s34, 0x140000
s_add_u32 m0, s36, 20480
s_nop 0
buffer_load_dwordx4 v64, s[8:11], s32 offen lds
s_xor_b32 s32, s34, 0x150000
s_add_u32 m0, s36, 21504
s_nop 0
buffer_load_dwordx4 v64, s[8:11], s32 offen lds
s_xor_b32 s32, s34, 0x160000
s_add_u32 m0, s36, 22528
s_nop 0
buffer_load_dwordx4 v64, s[8:11], s32 offen lds
s_xor_b32 s32, s34, 0x170000
s_add_u32 m0, s36, 23552
s_nop 0
buffer_load_dwordx4 v64, s[8:11], s32 offen lds
v_lshlrev_b32 v42, 16, v0
v_and_b32 v43, 0xffff0000, v0
v_cvt_pk_f16_f32 v0, v42, v43
v_lshlrev_b32 v44, 16, v1
v_and_b32 v45, 0xffff0000, v1
v_cvt_pk_f16_f32 v1, v44, v45
v_lshlrev_b32 v42, 16, v2
v_and_b32 v43, 0xffff0000, v2
v_cvt_pk_f16_f32 v2, v42, v43
v_lshlrev_b32 v44, 16, v3
v_and_b32 v45, 0xffff0000, v3
v_cvt_pk_f16_f32 v3, v44, v45
v_lshlrev_b32 v42, 16, v4
v_and_b32 v43, 0xffff0000, v4
v_cvt_pk_f16_f32 v4, v42, v43
v_lshlrev_b32 v44, 16, v5
v_and_b32 v45, 0xffff0000, v5
v_cvt_pk_f16_f32 v5, v44, v45
v_lshlrev_b32 v42, 16, v6
v_and_b32 v43, 0xffff0000, v6
v_cvt_pk_f16_f32 v6, v42, v43
v_lshlrev_b32 v44, 16, v7
v_and_b32 v45, 0xffff0000, v7
v_cvt_pk_f16_f32 v7, v44, v45
v_accvgpr_write_b32 a144, v0
v_accvgpr_write_b32 a145, v1
v_accvgpr_write_b32 a146, v2
v_accvgpr_write_b32 a147, v3
v_accvgpr_write_b32 a148, v4
v_accvgpr_write_b32 a149, v5
v_accvgpr_write_b32 a150, v6
v_accvgpr_write_b32 a151, v7
v_lshlrev_b32 v42, 16, v8
v_and_b32 v43, 0xffff0000, v8
v_cvt_pk_f16_f32 v8, v42, v43
v_lshlrev_b32 v44, 16, v9
v_and_b32 v45, 0xffff0000, v9
v_cvt_pk_f16_f32 v9, v44, v45
v_lshlrev_b32 v42, 16, v10
v_and_b32 v43, 0xffff0000, v10
v_cvt_pk_f16_f32 v10, v42, v43
v_lshlrev_b32 v44, 16, v11
v_and_b32 v45, 0xffff0000, v11
v_cvt_pk_f16_f32 v11, v44, v45
v_lshlrev_b32 v42, 16, v12
v_and_b32 v43, 0xffff0000, v12
v_cvt_pk_f16_f32 v12, v42, v43
v_lshlrev_b32 v44, 16, v13
v_and_b32 v45, 0xffff0000, v13
v_cvt_pk_f16_f32 v13, v44, v45
v_lshlrev_b32 v42, 16, v14
v_and_b32 v43, 0xffff0000, v14
v_cvt_pk_f16_f32 v14, v42, v43
v_lshlrev_b32 v44, 16, v15
v_and_b32 v45, 0xffff0000, v15
v_cvt_pk_f16_f32 v15, v44, v45
v_accvgpr_write_b32 a176, v8
v_accvgpr_write_b32 a177, v9
v_accvgpr_write_b32 a178, v10
v_accvgpr_write_b32 a179, v11
v_accvgpr_write_b32 a180, v12
v_accvgpr_write_b32 a181, v13
v_accvgpr_write_b32 a182, v14
v_accvgpr_write_b32 a183, v15
v_lshlrev_b32 v42, 16, v16
v_and_b32 v43, 0xffff0000, v16
v_cvt_pk_f16_f32 v16, v42, v43
v_lshlrev_b32 v44, 16, v17
v_and_b32 v45, 0xffff0000, v17
v_cvt_pk_f16_f32 v17, v44, v45
v_lshlrev_b32 v42, 16, v18
v_and_b32 v43, 0xffff0000, v18
v_cvt_pk_f16_f32 v18, v42, v43
v_lshlrev_b32 v44, 16, v19
v_and_b32 v45, 0xffff0000, v19
v_cvt_pk_f16_f32 v19, v44, v45
v_lshlrev_b32 v42, 16, v20
v_and_b32 v43, 0xffff0000, v20
v_cvt_pk_f16_f32 v20, v42, v43
v_lshlrev_b32 v44, 16, v21
v_and_b32 v45, 0xffff0000, v21
v_cvt_pk_f16_f32 v21, v44, v45
v_lshlrev_b32 v42, 16, v22
v_and_b32 v43, 0xffff0000, v22
v_cvt_pk_f16_f32 v22, v42, v43
v_lshlrev_b32 v44, 16, v23
v_and_b32 v45, 0xffff0000, v23
v_cvt_pk_f16_f32 v23, v44, v45
v_accvgpr_write_b32 a208, v16
v_accvgpr_write_b32 a209, v17
v_accvgpr_write_b32 a210, v18
v_accvgpr_write_b32 a211, v19
v_accvgpr_write_b32 a212, v20
v_accvgpr_write_b32 a213, v21
v_accvgpr_write_b32 a214, v22
v_accvgpr_write_b32 a215, v23
v_lshlrev_b32 v42, 16, v24
v_and_b32 v43, 0xffff0000, v24
v_cvt_pk_f16_f32 v24, v42, v43
v_lshlrev_b32 v44, 16, v25
v_and_b32 v45, 0xffff0000, v25
v_cvt_pk_f16_f32 v25, v44, v45
v_lshlrev_b32 v42, 16, v26
v_and_b32 v43, 0xffff0000, v26
v_cvt_pk_f16_f32 v26, v42, v43
v_lshlrev_b32 v44, 16, v27
v_and_b32 v45, 0xffff0000, v27
v_cvt_pk_f16_f32 v27, v44, v45
v_lshlrev_b32 v42, 16, v28
v_and_b32 v43, 0xffff0000, v28
v_cvt_pk_f16_f32 v28, v42, v43
v_lshlrev_b32 v44, 16, v29
v_and_b32 v45, 0xffff0000, v29
v_cvt_pk_f16_f32 v29, v44, v45
v_lshlrev_b32 v42, 16, v30
v_and_b32 v43, 0xffff0000, v30
v_cvt_pk_f16_f32 v30, v42, v43
v_lshlrev_b32 v44, 16, v31
v_and_b32 v45, 0xffff0000, v31
v_cvt_pk_f16_f32 v31, v44, v45
v_accvgpr_write_b32 a240, v24
v_accvgpr_write_b32 a241, v25
v_accvgpr_write_b32 a242, v26
v_accvgpr_write_b32 a243, v27
v_accvgpr_write_b32 a244, v28
v_accvgpr_write_b32 a245, v29
v_accvgpr_write_b32 a246, v30
v_accvgpr_write_b32 a247, v31
s_waitcnt vmcnt(27)
s_barrier
ds_read_b64_tr_b16 v[0:1], v32 offset:24576
ds_read_b64_tr_b16 v[2:3], v32 offset:24832
ds_read_b64_tr_b16 v[4:5], v32 offset:28672
ds_read_b64_tr_b16 v[6:7], v32 offset:28928
ds_read_b64_tr_b16 v[8:9], v33 offset:24576
ds_read_b64_tr_b16 v[10:11], v33 offset:24832
ds_read_b64_tr_b16 v[12:13], v33 offset:28672
ds_read_b64_tr_b16 v[14:15], v33 offset:28928
ds_read_b64_tr_b16 v[16:17], v34 offset:24576
ds_read_b64_tr_b16 v[18:19], v34 offset:24832
ds_read_b64_tr_b16 v[20:21], v34 offset:28672
ds_read_b64_tr_b16 v[22:23], v34 offset:28928
ds_read_b64_tr_b16 v[24:25], v35 offset:24576
ds_read_b64_tr_b16 v[26:27], v35 offset:24832
ds_read_b64_tr_b16 v[28:29], v35 offset:28672
ds_read_b64_tr_b16 v[30:31], v35 offset:28928
s_waitcnt lgkmcnt(0)
s_barrier
s_xor_b32 s32, s39, 0x180000
buffer_load_dword v82, v80, s[8:11], s32 offen
s_xor_b32 s32, s34, 0x180000
s_add_u32 m0, s36, 24576
s_nop 0
buffer_load_dwordx4 v64, s[8:11], s32 offen lds
s_xor_b32 s32, s34, 0x190000
s_add_u32 m0, s36, 25600
s_nop 0
buffer_load_dwordx4 v64, s[8:11], s32 offen lds
s_xor_b32 s32, s34, 0x1a0000
s_add_u32 m0, s36, 26624
s_nop 0
buffer_load_dwordx4 v64, s[8:11], s32 offen lds
s_xor_b32 s32, s34, 0x1b0000
s_add_u32 m0, s36, 27648
s_nop 0
buffer_load_dwordx4 v64, s[8:11], s32 offen lds
s_xor_b32 s32, s34, 0x1c0000
s_add_u32 m0, s36, 28672
s_nop 0
buffer_load_dwordx4 v64, s[8:11], s32 offen lds
s_xor_b32 s32, s34, 0x1d0000
s_add_u32 m0, s36, 29696
s_nop 0
buffer_load_dwordx4 v64, s[8:11], s32 offen lds
s_xor_b32 s32, s34, 0x1e0000
s_add_u32 m0, s36, 30720
s_nop 0
buffer_load_dwordx4 v64, s[8:11], s32 offen lds
s_xor_b32 s32, s34, 0x1f0000
s_add_u32 m0, s36, 31744
s_nop 0
buffer_load_dwordx4 v64, s[8:11], s32 offen lds
v_lshlrev_b32 v42, 16, v0
v_and_b32 v43, 0xffff0000, v0
v_cvt_pk_f16_f32 v0, v42, v43
v_lshlrev_b32 v44, 16, v1
v_and_b32 v45, 0xffff0000, v1
v_cvt_pk_f16_f32 v1, v44, v45
v_lshlrev_b32 v42, 16, v2
v_and_b32 v43, 0xffff0000, v2
v_cvt_pk_f16_f32 v2, v42, v43
v_lshlrev_b32 v44, 16, v3
v_and_b32 v45, 0xffff0000, v3
v_cvt_pk_f16_f32 v3, v44, v45
v_lshlrev_b32 v42, 16, v4
v_and_b32 v43, 0xffff0000, v4
v_cvt_pk_f16_f32 v4, v42, v43
v_lshlrev_b32 v44, 16, v5
v_and_b32 v45, 0xffff0000, v5
v_cvt_pk_f16_f32 v5, v44, v45
v_lshlrev_b32 v42, 16, v6
v_and_b32 v43, 0xffff0000, v6
v_cvt_pk_f16_f32 v6, v42, v43
v_lshlrev_b32 v44, 16, v7
v_and_b32 v45, 0xffff0000, v7
v_cvt_pk_f16_f32 v7, v44, v45
v_accvgpr_write_b32 a152, v0
v_accvgpr_write_b32 a153, v1
v_accvgpr_write_b32 a154, v2
v_accvgpr_write_b32 a155, v3
v_accvgpr_write_b32 a156, v4
v_accvgpr_write_b32 a157, v5
v_accvgpr_write_b32 a158, v6
v_accvgpr_write_b32 a159, v7
v_lshlrev_b32 v42, 16, v8
v_and_b32 v43, 0xffff0000, v8
v_cvt_pk_f16_f32 v8, v42, v43
v_lshlrev_b32 v44, 16, v9
v_and_b32 v45, 0xffff0000, v9
v_cvt_pk_f16_f32 v9, v44, v45
v_lshlrev_b32 v42, 16, v10
v_and_b32 v43, 0xffff0000, v10
v_cvt_pk_f16_f32 v10, v42, v43
v_lshlrev_b32 v44, 16, v11
v_and_b32 v45, 0xffff0000, v11
v_cvt_pk_f16_f32 v11, v44, v45
v_lshlrev_b32 v42, 16, v12
v_and_b32 v43, 0xffff0000, v12
v_cvt_pk_f16_f32 v12, v42, v43
v_lshlrev_b32 v44, 16, v13
v_and_b32 v45, 0xffff0000, v13
v_cvt_pk_f16_f32 v13, v44, v45
v_lshlrev_b32 v42, 16, v14
v_and_b32 v43, 0xffff0000, v14
v_cvt_pk_f16_f32 v14, v42, v43
v_lshlrev_b32 v44, 16, v15
v_and_b32 v45, 0xffff0000, v15
v_cvt_pk_f16_f32 v15, v44, v45
v_accvgpr_write_b32 a184, v8
v_accvgpr_write_b32 a185, v9
v_accvgpr_write_b32 a186, v10
v_accvgpr_write_b32 a187, v11
v_accvgpr_write_b32 a188, v12
v_accvgpr_write_b32 a189, v13
v_accvgpr_write_b32 a190, v14
v_accvgpr_write_b32 a191, v15
v_lshlrev_b32 v42, 16, v16
v_and_b32 v43, 0xffff0000, v16
v_cvt_pk_f16_f32 v16, v42, v43
v_lshlrev_b32 v44, 16, v17
v_and_b32 v45, 0xffff0000, v17
v_cvt_pk_f16_f32 v17, v44, v45
v_lshlrev_b32 v42, 16, v18
v_and_b32 v43, 0xffff0000, v18
v_cvt_pk_f16_f32 v18, v42, v43
v_lshlrev_b32 v44, 16, v19
v_and_b32 v45, 0xffff0000, v19
v_cvt_pk_f16_f32 v19, v44, v45
v_lshlrev_b32 v42, 16, v20
v_and_b32 v43, 0xffff0000, v20
v_cvt_pk_f16_f32 v20, v42, v43
v_lshlrev_b32 v44, 16, v21
v_and_b32 v45, 0xffff0000, v21
v_cvt_pk_f16_f32 v21, v44, v45
v_lshlrev_b32 v42, 16, v22
v_and_b32 v43, 0xffff0000, v22
v_cvt_pk_f16_f32 v22, v42, v43
v_lshlrev_b32 v44, 16, v23
v_and_b32 v45, 0xffff0000, v23
v_cvt_pk_f16_f32 v23, v44, v45
v_accvgpr_write_b32 a216, v16
v_accvgpr_write_b32 a217, v17
v_accvgpr_write_b32 a218, v18
v_accvgpr_write_b32 a219, v19
v_accvgpr_write_b32 a220, v20
v_accvgpr_write_b32 a221, v21
v_accvgpr_write_b32 a222, v22
v_accvgpr_write_b32 a223, v23
v_lshlrev_b32 v42, 16, v24
v_and_b32 v43, 0xffff0000, v24
v_cvt_pk_f16_f32 v24, v42, v43
v_lshlrev_b32 v44, 16, v25
v_and_b32 v45, 0xffff0000, v25
v_cvt_pk_f16_f32 v25, v44, v45
v_lshlrev_b32 v42, 16, v26
v_and_b32 v43, 0xffff0000, v26
v_cvt_pk_f16_f32 v26, v42, v43
v_lshlrev_b32 v44, 16, v27
v_and_b32 v45, 0xffff0000, v27
v_cvt_pk_f16_f32 v27, v44, v45
v_lshlrev_b32 v42, 16, v28
v_and_b32 v43, 0xffff0000, v28
v_cvt_pk_f16_f32 v28, v42, v43
v_lshlrev_b32 v44, 16, v29
v_and_b32 v45, 0xffff0000, v29
v_cvt_pk_f16_f32 v29, v44, v45
v_lshlrev_b32 v42, 16, v30
v_and_b32 v43, 0xffff0000, v30
v_cvt_pk_f16_f32 v30, v42, v43
v_lshlrev_b32 v44, 16, v31
v_and_b32 v45, 0xffff0000, v31
v_cvt_pk_f16_f32 v31, v44, v45
v_accvgpr_write_b32 a248, v24
v_accvgpr_write_b32 a249, v25
v_accvgpr_write_b32 a250, v26
v_accvgpr_write_b32 a251, v27
v_accvgpr_write_b32 a252, v28
v_accvgpr_write_b32 a253, v29
v_accvgpr_write_b32 a254, v30
v_accvgpr_write_b32 a255, v31
s_waitcnt vmcnt(27)
s_barrier
ds_read_b64_tr_b16 v[128:129], v36 offset:0
ds_read_b64_tr_b16 v[130:131], v36 offset:256
ds_read_b64_tr_b16 v[132:133], v36 offset:4096
ds_read_b64_tr_b16 v[134:135], v36 offset:4352
ds_read_b64_tr_b16 v[136:137], v37 offset:0
ds_read_b64_tr_b16 v[138:139], v37 offset:256
ds_read_b64_tr_b16 v[140:141], v37 offset:4096
ds_read_b64_tr_b16 v[142:143], v37 offset:4352
ds_read_b64_tr_b16 v[144:145], v38 offset:0
ds_read_b64_tr_b16 v[146:147], v38 offset:256
ds_read_b64_tr_b16 v[148:149], v38 offset:4096
ds_read_b64_tr_b16 v[150:151], v38 offset:4352
ds_read_b64_tr_b16 v[152:153], v39 offset:0
ds_read_b64_tr_b16 v[154:155], v39 offset:256
ds_read_b64_tr_b16 v[156:157], v39 offset:4096
ds_read_b64_tr_b16 v[158:159], v39 offset:4352
s_waitcnt lgkmcnt(0)
s_barrier
s_mov_b32 s8, s40
s_and_b32 s9, s41, 0xffff
s_mov_b32 s10, 0x800000
s_mov_b32 s11, 0x20000
s_sub_u32 s39, 511, s40
s_and_b32 s39, s39, 0x380
s_lshr_b32 s33, s39, 7
s_xor_b32 s33, s14, s33
s_and_b32 s33, s33, 3
s_lshl_b32 s33, s33, 19
s_add_u32 s39, s39, s33
s_andn2_b32 s32, s34, 0x180fff
s_add_u32 s39, s39, s32
s_xor_b32 s32, s39, 0x0
buffer_load_dword v82, v80, s[8:11], s32 offen
s_xor_b32 s32, s34, 0x0
s_add_u32 m0, s36, 0
s_nop 0
buffer_load_dwordx4 v64, s[8:11], s32 offen lds
s_xor_b32 s32, s34, 0x10000
s_add_u32 m0, s36, 1024
s_nop 0
buffer_load_dwordx4 v64, s[8:11], s32 offen lds
s_xor_b32 s32, s34, 0x20000
s_add_u32 m0, s36, 2048
s_nop 0
buffer_load_dwordx4 v64, s[8:11], s32 offen lds
s_xor_b32 s32, s34, 0x30000
s_add_u32 m0, s36, 3072
s_nop 0
buffer_load_dwordx4 v64, s[8:11], s32 offen lds
s_xor_b32 s32, s34, 0x40000
s_add_u32 m0, s36, 4096
s_nop 0
buffer_load_dwordx4 v64, s[8:11], s32 offen lds
s_xor_b32 s32, s34, 0x50000
s_add_u32 m0, s36, 5120
s_nop 0
buffer_load_dwordx4 v64, s[8:11], s32 offen lds
s_xor_b32 s32, s34, 0x60000
s_add_u32 m0, s36, 6144
s_nop 0
buffer_load_dwordx4 v64, s[8:11], s32 offen lds
s_xor_b32 s32, s34, 0x70000
s_add_u32 m0, s36, 7168
s_nop 0
buffer_load_dwordx4 v64, s[8:11], s32 offen lds
v_lshlrev_b32 v42, 16, v128
v_and_b32 v43, 0xffff0000, v128
v_cvt_pk_f16_f32 v128, v42, v43
v_lshlrev_b32 v44, 16, v129
v_and_b32 v45, 0xffff0000, v129
v_cvt_pk_f16_f32 v129, v44, v45
v_lshlrev_b32 v42, 16, v130
v_and_b32 v43, 0xffff0000, v130
v_cvt_pk_f16_f32 v130, v42, v43
v_lshlrev_b32 v44, 16, v131
v_and_b32 v45, 0xffff0000, v131
v_cvt_pk_f16_f32 v131, v44, v45
v_lshlrev_b32 v42, 16, v132
v_and_b32 v43, 0xffff0000, v132
v_cvt_pk_f16_f32 v132, v42, v43
v_lshlrev_b32 v44, 16, v133
v_and_b32 v45, 0xffff0000, v133
v_cvt_pk_f16_f32 v133, v44, v45
v_lshlrev_b32 v42, 16, v134
v_and_b32 v43, 0xffff0000, v134
v_cvt_pk_f16_f32 v134, v42, v43
v_lshlrev_b32 v44, 16, v135
v_and_b32 v45, 0xffff0000, v135
v_cvt_pk_f16_f32 v135, v44, v45
v_lshlrev_b32 v42, 16, v136
v_and_b32 v43, 0xffff0000, v136
v_cvt_pk_f16_f32 v136, v42, v43
v_lshlrev_b32 v44, 16, v137
v_and_b32 v45, 0xffff0000, v137
v_cvt_pk_f16_f32 v137, v44, v45
v_lshlrev_b32 v42, 16, v138
v_and_b32 v43, 0xffff0000, v138
v_cvt_pk_f16_f32 v138, v42, v43
v_lshlrev_b32 v44, 16, v139
v_and_b32 v45, 0xffff0000, v139
v_cvt_pk_f16_f32 v139, v44, v45
v_lshlrev_b32 v42, 16, v140
v_and_b32 v43, 0xffff0000, v140
v_cvt_pk_f16_f32 v140, v42, v43
v_lshlrev_b32 v44, 16, v141
v_and_b32 v45, 0xffff0000, v141
v_cvt_pk_f16_f32 v141, v44, v45
v_lshlrev_b32 v42, 16, v142
v_and_b32 v43, 0xffff0000, v142
v_cvt_pk_f16_f32 v142, v42, v43
v_lshlrev_b32 v44, 16, v143
v_and_b32 v45, 0xffff0000, v143
v_cvt_pk_f16_f32 v143, v44, v45
v_lshlrev_b32 v42, 16, v144
v_and_b32 v43, 0xffff0000, v144
v_cvt_pk_f16_f32 v144, v42, v43
v_lshlrev_b32 v44, 16, v145
v_and_b32 v45, 0xffff0000, v145
v_cvt_pk_f16_f32 v145, v44, v45
v_lshlrev_b32 v42, 16, v146
v_and_b32 v43, 0xffff0000, v146
v_cvt_pk_f16_f32 v146, v42, v43
v_lshlrev_b32 v44, 16, v147
v_and_b32 v45, 0xffff0000, v147
v_cvt_pk_f16_f32 v147, v44, v45
v_lshlrev_b32 v42, 16, v148
v_and_b32 v43, 0xffff0000, v148
v_cvt_pk_f16_f32 v148, v42, v43
v_lshlrev_b32 v44, 16, v149
v_and_b32 v45, 0xffff0000, v149
v_cvt_pk_f16_f32 v149, v44, v45
v_lshlrev_b32 v42, 16, v150
v_and_b32 v43, 0xffff0000, v150
v_cvt_pk_f16_f32 v150, v42, v43
v_lshlrev_b32 v44, 16, v151
v_and_b32 v45, 0xffff0000, v151
v_cvt_pk_f16_f32 v151, v44, v45
v_lshlrev_b32 v42, 16, v152
v_and_b32 v43, 0xffff0000, v152
v_cvt_pk_f16_f32 v152, v42, v43
v_lshlrev_b32 v44, 16, v153
v_and_b32 v45, 0xffff0000, v153
v_cvt_pk_f16_f32 v153, v44, v45
v_lshlrev_b32 v42, 16, v154
v_and_b32 v43, 0xffff0000, v154
v_cvt_pk_f16_f32 v154, v42, v43
v_lshlrev_b32 v44, 16, v155
v_and_b32 v45, 0xffff0000, v155
v_cvt_pk_f16_f32 v155, v44, v45
v_lshlrev_b32 v42, 16, v156
v_and_b32 v43, 0xffff0000, v156
v_cvt_pk_f16_f32 v156, v42, v43
v_lshlrev_b32 v44, 16, v157
v_and_b32 v45, 0xffff0000, v157
v_cvt_pk_f16_f32 v157, v44, v45
v_lshlrev_b32 v42, 16, v158
v_and_b32 v43, 0xffff0000, v158
v_cvt_pk_f16_f32 v158, v42, v43
v_lshlrev_b32 v44, 16, v159
v_and_b32 v45, 0xffff0000, v159
v_cvt_pk_f16_f32 v159, v44, v45
s_waitcnt vmcnt(27)
s_barrier
ds_read_b64_tr_b16 v[160:161], v36 offset:8192
ds_read_b64_tr_b16 v[162:163], v36 offset:8448
ds_read_b64_tr_b16 v[164:165], v36 offset:12288
ds_read_b64_tr_b16 v[166:167], v36 offset:12544
ds_read_b64_tr_b16 v[168:169], v37 offset:8192
ds_read_b64_tr_b16 v[170:171], v37 offset:8448
ds_read_b64_tr_b16 v[172:173], v37 offset:12288
ds_read_b64_tr_b16 v[174:175], v37 offset:12544
ds_read_b64_tr_b16 v[176:177], v38 offset:8192
ds_read_b64_tr_b16 v[178:179], v38 offset:8448
ds_read_b64_tr_b16 v[180:181], v38 offset:12288
ds_read_b64_tr_b16 v[182:183], v38 offset:12544
ds_read_b64_tr_b16 v[184:185], v39 offset:8192
ds_read_b64_tr_b16 v[186:187], v39 offset:8448
ds_read_b64_tr_b16 v[188:189], v39 offset:12288
ds_read_b64_tr_b16 v[190:191], v39 offset:12544
s_waitcnt lgkmcnt(0)
s_barrier
s_xor_b32 s32, s39, 0x80000
buffer_load_dword v82, v80, s[8:11], s32 offen
s_xor_b32 s32, s34, 0x80000
s_add_u32 m0, s36, 8192
s_nop 0
buffer_load_dwordx4 v64, s[8:11], s32 offen lds
s_xor_b32 s32, s34, 0x90000
s_add_u32 m0, s36, 9216
s_nop 0
buffer_load_dwordx4 v64, s[8:11], s32 offen lds
s_xor_b32 s32, s34, 0xa0000
s_add_u32 m0, s36, 10240
s_nop 0
buffer_load_dwordx4 v64, s[8:11], s32 offen lds
s_xor_b32 s32, s34, 0xb0000
s_add_u32 m0, s36, 11264
s_nop 0
buffer_load_dwordx4 v64, s[8:11], s32 offen lds
s_xor_b32 s32, s34, 0xc0000
s_add_u32 m0, s36, 12288
s_nop 0
buffer_load_dwordx4 v64, s[8:11], s32 offen lds
s_xor_b32 s32, s34, 0xd0000
s_add_u32 m0, s36, 13312
s_nop 0
buffer_load_dwordx4 v64, s[8:11], s32 offen lds
s_xor_b32 s32, s34, 0xe0000
s_add_u32 m0, s36, 14336
s_nop 0
buffer_load_dwordx4 v64, s[8:11], s32 offen lds
s_xor_b32 s32, s34, 0xf0000
s_add_u32 m0, s36, 15360
s_nop 0
buffer_load_dwordx4 v64, s[8:11], s32 offen lds
v_lshlrev_b32 v42, 16, v160
v_and_b32 v43, 0xffff0000, v160
v_cvt_pk_f16_f32 v160, v42, v43
v_lshlrev_b32 v44, 16, v161
v_and_b32 v45, 0xffff0000, v161
v_cvt_pk_f16_f32 v161, v44, v45
v_lshlrev_b32 v42, 16, v162
v_and_b32 v43, 0xffff0000, v162
v_cvt_pk_f16_f32 v162, v42, v43
v_lshlrev_b32 v44, 16, v163
v_and_b32 v45, 0xffff0000, v163
v_cvt_pk_f16_f32 v163, v44, v45
v_lshlrev_b32 v42, 16, v164
v_and_b32 v43, 0xffff0000, v164
v_cvt_pk_f16_f32 v164, v42, v43
v_lshlrev_b32 v44, 16, v165
v_and_b32 v45, 0xffff0000, v165
v_cvt_pk_f16_f32 v165, v44, v45
v_lshlrev_b32 v42, 16, v166
v_and_b32 v43, 0xffff0000, v166
v_cvt_pk_f16_f32 v166, v42, v43
v_lshlrev_b32 v44, 16, v167
v_and_b32 v45, 0xffff0000, v167
v_cvt_pk_f16_f32 v167, v44, v45
v_lshlrev_b32 v42, 16, v168
v_and_b32 v43, 0xffff0000, v168
v_cvt_pk_f16_f32 v168, v42, v43
v_lshlrev_b32 v44, 16, v169
v_and_b32 v45, 0xffff0000, v169
v_cvt_pk_f16_f32 v169, v44, v45
v_lshlrev_b32 v42, 16, v170
v_and_b32 v43, 0xffff0000, v170
v_cvt_pk_f16_f32 v170, v42, v43
v_lshlrev_b32 v44, 16, v171
v_and_b32 v45, 0xffff0000, v171
v_cvt_pk_f16_f32 v171, v44, v45
v_lshlrev_b32 v42, 16, v172
v_and_b32 v43, 0xffff0000, v172
v_cvt_pk_f16_f32 v172, v42, v43
v_lshlrev_b32 v44, 16, v173
v_and_b32 v45, 0xffff0000, v173
v_cvt_pk_f16_f32 v173, v44, v45
v_lshlrev_b32 v42, 16, v174
v_and_b32 v43, 0xffff0000, v174
v_cvt_pk_f16_f32 v174, v42, v43
v_lshlrev_b32 v44, 16, v175
v_and_b32 v45, 0xffff0000, v175
v_cvt_pk_f16_f32 v175, v44, v45
v_lshlrev_b32 v42, 16, v176
v_and_b32 v43, 0xffff0000, v176
v_cvt_pk_f16_f32 v176, v42, v43
v_lshlrev_b32 v44, 16, v177
v_and_b32 v45, 0xffff0000, v177
v_cvt_pk_f16_f32 v177, v44, v45
v_lshlrev_b32 v42, 16, v178
v_and_b32 v43, 0xffff0000, v178
v_cvt_pk_f16_f32 v178, v42, v43
v_lshlrev_b32 v44, 16, v179
v_and_b32 v45, 0xffff0000, v179
v_cvt_pk_f16_f32 v179, v44, v45
v_lshlrev_b32 v42, 16, v180
v_and_b32 v43, 0xffff0000, v180
v_cvt_pk_f16_f32 v180, v42, v43
v_lshlrev_b32 v44, 16, v181
v_and_b32 v45, 0xffff0000, v181
v_cvt_pk_f16_f32 v181, v44, v45
v_lshlrev_b32 v42, 16, v182
v_and_b32 v43, 0xffff0000, v182
v_cvt_pk_f16_f32 v182, v42, v43
v_lshlrev_b32 v44, 16, v183
v_and_b32 v45, 0xffff0000, v183
v_cvt_pk_f16_f32 v183, v44, v45
v_lshlrev_b32 v42, 16, v184
v_and_b32 v43, 0xffff0000, v184
v_cvt_pk_f16_f32 v184, v42, v43
v_lshlrev_b32 v44, 16, v185
v_and_b32 v45, 0xffff0000, v185
v_cvt_pk_f16_f32 v185, v44, v45
v_lshlrev_b32 v42, 16, v186
v_and_b32 v43, 0xffff0000, v186
v_cvt_pk_f16_f32 v186, v42, v43
v_lshlrev_b32 v44, 16, v187
v_and_b32 v45, 0xffff0000, v187
v_cvt_pk_f16_f32 v187, v44, v45
v_lshlrev_b32 v42, 16, v188
v_and_b32 v43, 0xffff0000, v188
v_cvt_pk_f16_f32 v188, v42, v43
v_lshlrev_b32 v44, 16, v189
v_and_b32 v45, 0xffff0000, v189
v_cvt_pk_f16_f32 v189, v44, v45
v_lshlrev_b32 v42, 16, v190
v_and_b32 v43, 0xffff0000, v190
v_cvt_pk_f16_f32 v190, v42, v43
v_lshlrev_b32 v44, 16, v191
v_and_b32 v45, 0xffff0000, v191
v_cvt_pk_f16_f32 v191, v44, v45
s_waitcnt vmcnt(27)
s_barrier
ds_read_b64_tr_b16 v[192:193], v36 offset:16384
ds_read_b64_tr_b16 v[194:195], v36 offset:16640
ds_read_b64_tr_b16 v[196:197], v36 offset:20480
ds_read_b64_tr_b16 v[198:199], v36 offset:20736
ds_read_b64_tr_b16 v[200:201], v37 offset:16384
ds_read_b64_tr_b16 v[202:203], v37 offset:16640
ds_read_b64_tr_b16 v[204:205], v37 offset:20480
ds_read_b64_tr_b16 v[206:207], v37 offset:20736
ds_read_b64_tr_b16 v[208:209], v38 offset:16384
ds_read_b64_tr_b16 v[210:211], v38 offset:16640
ds_read_b64_tr_b16 v[212:213], v38 offset:20480
ds_read_b64_tr_b16 v[214:215], v38 offset:20736
ds_read_b64_tr_b16 v[216:217], v39 offset:16384
ds_read_b64_tr_b16 v[218:219], v39 offset:16640
ds_read_b64_tr_b16 v[220:221], v39 offset:20480
ds_read_b64_tr_b16 v[222:223], v39 offset:20736
s_waitcnt lgkmcnt(0)
s_barrier
buffer_load_dword v72, v73, s[60:63], 0 offen sc1
buffer_load_dwordx2 v[84:85], off, s[60:63], 0 offset:16 sc1
s_xor_b32 s32, s39, 0x100000
buffer_load_dword v82, v80, s[8:11], s32 offen
s_xor_b32 s32, s34, 0x100000
s_add_u32 m0, s36, 16384
s_nop 0
buffer_load_dwordx4 v64, s[8:11], s32 offen lds
s_xor_b32 s32, s34, 0x110000
s_add_u32 m0, s36, 17408
s_nop 0
buffer_load_dwordx4 v64, s[8:11], s32 offen lds
s_xor_b32 s32, s34, 0x120000
s_add_u32 m0, s36, 18432
s_nop 0
buffer_load_dwordx4 v64, s[8:11], s32 offen lds
s_xor_b32 s32, s34, 0x130000
s_add_u32 m0, s36, 19456
s_nop 0
buffer_load_dwordx4 v64, s[8:11], s32 offen lds
s_xor_b32 s32, s34, 0x140000
s_add_u32 m0, s36, 20480
s_nop 0
buffer_load_dwordx4 v64, s[8:11], s32 offen lds
s_xor_b32 s32, s34, 0x150000
s_add_u32 m0, s36, 21504
s_nop 0
buffer_load_dwordx4 v64, s[8:11], s32 offen lds
s_xor_b32 s32, s34, 0x160000
s_add_u32 m0, s36, 22528
s_nop 0
buffer_load_dwordx4 v64, s[8:11], s32 offen lds
s_xor_b32 s32, s34, 0x170000
s_add_u32 m0, s36, 23552
s_nop 0
buffer_load_dwordx4 v64, s[8:11], s32 offen lds
v_lshlrev_b32 v42, 16, v192
v_and_b32 v43, 0xffff0000, v192
v_cvt_pk_f16_f32 v192, v42, v43
v_lshlrev_b32 v44, 16, v193
v_and_b32 v45, 0xffff0000, v193
v_cvt_pk_f16_f32 v193, v44, v45
v_lshlrev_b32 v42, 16, v194
v_and_b32 v43, 0xffff0000, v194
v_cvt_pk_f16_f32 v194, v42, v43
v_lshlrev_b32 v44, 16, v195
v_and_b32 v45, 0xffff0000, v195
v_cvt_pk_f16_f32 v195, v44, v45
v_lshlrev_b32 v42, 16, v196
v_and_b32 v43, 0xffff0000, v196
v_cvt_pk_f16_f32 v196, v42, v43
v_lshlrev_b32 v44, 16, v197
v_and_b32 v45, 0xffff0000, v197
v_cvt_pk_f16_f32 v197, v44, v45
v_lshlrev_b32 v42, 16, v198
v_and_b32 v43, 0xffff0000, v198
v_cvt_pk_f16_f32 v198, v42, v43
v_lshlrev_b32 v44, 16, v199
v_and_b32 v45, 0xffff0000, v199
v_cvt_pk_f16_f32 v199, v44, v45
v_lshlrev_b32 v42, 16, v200
v_and_b32 v43, 0xffff0000, v200
v_cvt_pk_f16_f32 v200, v42, v43
v_lshlrev_b32 v44, 16, v201
v_and_b32 v45, 0xffff0000, v201
v_cvt_pk_f16_f32 v201, v44, v45
v_lshlrev_b32 v42, 16, v202
v_and_b32 v43, 0xffff0000, v202
v_cvt_pk_f16_f32 v202, v42, v43
v_lshlrev_b32 v44, 16, v203
v_and_b32 v45, 0xffff0000, v203
v_cvt_pk_f16_f32 v203, v44, v45
v_lshlrev_b32 v42, 16, v204
v_and_b32 v43, 0xffff0000, v204
v_cvt_pk_f16_f32 v204, v42, v43
v_lshlrev_b32 v44, 16, v205
v_and_b32 v45, 0xffff0000, v205
v_cvt_pk_f16_f32 v205, v44, v45
v_lshlrev_b32 v42, 16, v206
v_and_b32 v43, 0xffff0000, v206
v_cvt_pk_f16_f32 v206, v42, v43
v_lshlrev_b32 v44, 16, v207
v_and_b32 v45, 0xffff0000, v207
v_cvt_pk_f16_f32 v207, v44, v45
v_lshlrev_b32 v42, 16, v208
v_and_b32 v43, 0xffff0000, v208
v_cvt_pk_f16_f32 v208, v42, v43
v_lshlrev_b32 v44, 16, v209
v_and_b32 v45, 0xffff0000, v209
v_cvt_pk_f16_f32 v209, v44, v45
v_lshlrev_b32 v42, 16, v210
v_and_b32 v43, 0xffff0000, v210
v_cvt_pk_f16_f32 v210, v42, v43
v_lshlrev_b32 v44, 16, v211
v_and_b32 v45, 0xffff0000, v211
v_cvt_pk_f16_f32 v211, v44, v45
v_lshlrev_b32 v42, 16, v212
v_and_b32 v43, 0xffff0000, v212
v_cvt_pk_f16_f32 v212, v42, v43
v_lshlrev_b32 v44, 16, v213
v_and_b32 v45, 0xffff0000, v213
v_cvt_pk_f16_f32 v213, v44, v45
v_lshlrev_b32 v42, 16, v214
v_and_b32 v43, 0xffff0000, v214
v_cvt_pk_f16_f32 v214, v42, v43
v_lshlrev_b32 v44, 16, v215
v_and_b32 v45, 0xffff0000, v215
v_cvt_pk_f16_f32 v215, v44, v45
v_lshlrev_b32 v42, 16, v216
v_and_b32 v43, 0xffff0000, v216
v_cvt_pk_f16_f32 v216, v42, v43
v_lshlrev_b32 v44, 16, v217
v_and_b32 v45, 0xffff0000, v217
v_cvt_pk_f16_f32 v217, v44, v45
v_lshlrev_b32 v42, 16, v218
v_and_b32 v43, 0xffff0000, v218
v_cvt_pk_f16_f32 v218, v42, v43
v_lshlrev_b32 v44, 16, v219
v_and_b32 v45, 0xffff0000, v219
v_cvt_pk_f16_f32 v219, v44, v45
v_lshlrev_b32 v42, 16, v220
v_and_b32 v43, 0xffff0000, v220
v_cvt_pk_f16_f32 v220, v42, v43
v_lshlrev_b32 v44, 16, v221
v_and_b32 v45, 0xffff0000, v221
v_cvt_pk_f16_f32 v221, v44, v45
v_lshlrev_b32 v42, 16, v222
v_and_b32 v43, 0xffff0000, v222
v_cvt_pk_f16_f32 v222, v42, v43
v_lshlrev_b32 v44, 16, v223
v_and_b32 v45, 0xffff0000, v223
v_cvt_pk_f16_f32 v223, v44, v45
s_waitcnt vmcnt(29)
s_barrier
ds_read_b64_tr_b16 v[224:225], v36 offset:24576
ds_read_b64_tr_b16 v[226:227], v36 offset:24832
ds_read_b64_tr_b16 v[228:229], v36 offset:28672
ds_read_b64_tr_b16 v[230:231], v36 offset:28928
ds_read_b64_tr_b16 v[232:233], v37 offset:24576
ds_read_b64_tr_b16 v[234:235], v37 offset:24832
ds_read_b64_tr_b16 v[236:237], v37 offset:28672
ds_read_b64_tr_b16 v[238:239], v37 offset:28928
ds_read_b64_tr_b16 v[240:241], v38 offset:24576
ds_read_b64_tr_b16 v[242:243], v38 offset:24832
ds_read_b64_tr_b16 v[244:245], v38 offset:28672
ds_read_b64_tr_b16 v[246:247], v38 offset:28928
ds_read_b64_tr_b16 v[248:249], v39 offset:24576
ds_read_b64_tr_b16 v[250:251], v39 offset:24832
ds_read_b64_tr_b16 v[252:253], v39 offset:28672
ds_read_b64_tr_b16 v[254:255], v39 offset:28928
s_waitcnt lgkmcnt(0)
s_barrier
s_xor_b32 s32, s39, 0x180000
buffer_load_dword v82, v80, s[8:11], s32 offen
s_xor_b32 s32, s34, 0x180000
s_add_u32 m0, s36, 24576
s_nop 0
buffer_load_dwordx4 v64, s[8:11], s32 offen lds
s_xor_b32 s32, s34, 0x190000
s_add_u32 m0, s36, 25600
s_nop 0
buffer_load_dwordx4 v64, s[8:11], s32 offen lds
s_xor_b32 s32, s34, 0x1a0000
s_add_u32 m0, s36, 26624
s_nop 0
buffer_load_dwordx4 v64, s[8:11], s32 offen lds
s_xor_b32 s32, s34, 0x1b0000
s_add_u32 m0, s36, 27648
s_nop 0
buffer_load_dwordx4 v64, s[8:11], s32 offen lds
s_xor_b32 s32, s34, 0x1c0000
s_add_u32 m0, s36, 28672
s_nop 0
buffer_load_dwordx4 v64, s[8:11], s32 offen lds
s_xor_b32 s32, s34, 0x1d0000
s_add_u32 m0, s36, 29696
s_nop 0
buffer_load_dwordx4 v64, s[8:11], s32 offen lds
s_xor_b32 s32, s34, 0x1e0000
s_add_u32 m0, s36, 30720
s_nop 0
buffer_load_dwordx4 v64, s[8:11], s32 offen lds
s_xor_b32 s32, s34, 0x1f0000
s_add_u32 m0, s36, 31744
s_nop 0
buffer_load_dwordx4 v64, s[8:11], s32 offen lds
v_lshlrev_b32 v42, 16, v224
v_and_b32 v43, 0xffff0000, v224
v_cvt_pk_f16_f32 v224, v42, v43
v_lshlrev_b32 v44, 16, v225
v_and_b32 v45, 0xffff0000, v225
v_cvt_pk_f16_f32 v225, v44, v45
v_lshlrev_b32 v42, 16, v226
v_and_b32 v43, 0xffff0000, v226
v_cvt_pk_f16_f32 v226, v42, v43
v_lshlrev_b32 v44, 16, v227
v_and_b32 v45, 0xffff0000, v227
v_cvt_pk_f16_f32 v227, v44, v45
v_lshlrev_b32 v42, 16, v228
v_and_b32 v43, 0xffff0000, v228
v_cvt_pk_f16_f32 v228, v42, v43
v_lshlrev_b32 v44, 16, v229
v_and_b32 v45, 0xffff0000, v229
v_cvt_pk_f16_f32 v229, v44, v45
v_lshlrev_b32 v42, 16, v230
v_and_b32 v43, 0xffff0000, v230
v_cvt_pk_f16_f32 v230, v42, v43
v_lshlrev_b32 v44, 16, v231
v_and_b32 v45, 0xffff0000, v231
v_cvt_pk_f16_f32 v231, v44, v45
v_lshlrev_b32 v42, 16, v232
v_and_b32 v43, 0xffff0000, v232
v_cvt_pk_f16_f32 v232, v42, v43
v_lshlrev_b32 v44, 16, v233
v_and_b32 v45, 0xffff0000, v233
v_cvt_pk_f16_f32 v233, v44, v45
v_lshlrev_b32 v42, 16, v234
v_and_b32 v43, 0xffff0000, v234
v_cvt_pk_f16_f32 v234, v42, v43
v_lshlrev_b32 v44, 16, v235
v_and_b32 v45, 0xffff0000, v235
v_cvt_pk_f16_f32 v235, v44, v45
v_lshlrev_b32 v42, 16, v236
v_and_b32 v43, 0xffff0000, v236
v_cvt_pk_f16_f32 v236, v42, v43
v_lshlrev_b32 v44, 16, v237
v_and_b32 v45, 0xffff0000, v237
v_cvt_pk_f16_f32 v237, v44, v45
v_lshlrev_b32 v42, 16, v238
v_and_b32 v43, 0xffff0000, v238
v_cvt_pk_f16_f32 v238, v42, v43
v_lshlrev_b32 v44, 16, v239
v_and_b32 v45, 0xffff0000, v239
v_cvt_pk_f16_f32 v239, v44, v45
v_lshlrev_b32 v42, 16, v240
v_and_b32 v43, 0xffff0000, v240
v_cvt_pk_f16_f32 v240, v42, v43
v_lshlrev_b32 v44, 16, v241
v_and_b32 v45, 0xffff0000, v241
v_cvt_pk_f16_f32 v241, v44, v45
v_lshlrev_b32 v42, 16, v242
v_and_b32 v43, 0xffff0000, v242
v_cvt_pk_f16_f32 v242, v42, v43
v_lshlrev_b32 v44, 16, v243
v_and_b32 v45, 0xffff0000, v243
v_cvt_pk_f16_f32 v243, v44, v45
v_lshlrev_b32 v42, 16, v244
v_and_b32 v43, 0xffff0000, v244
v_cvt_pk_f16_f32 v244, v42, v43
v_lshlrev_b32 v44, 16, v245
v_and_b32 v45, 0xffff0000, v245
v_cvt_pk_f16_f32 v245, v44, v45
v_lshlrev_b32 v42, 16, v246
v_and_b32 v43, 0xffff0000, v246
v_cvt_pk_f16_f32 v246, v42, v43
v_lshlrev_b32 v44, 16, v247
v_and_b32 v45, 0xffff0000, v247
v_cvt_pk_f16_f32 v247, v44, v45
v_lshlrev_b32 v42, 16, v248
v_and_b32 v43, 0xffff0000, v248
v_cvt_pk_f16_f32 v248, v42, v43
v_lshlrev_b32 v44, 16, v249
v_and_b32 v45, 0xffff0000, v249
v_cvt_pk_f16_f32 v249, v44, v45
v_lshlrev_b32 v42, 16, v250
v_and_b32 v43, 0xffff0000, v250
v_cvt_pk_f16_f32 v250, v42, v43
v_lshlrev_b32 v44, 16, v251
v_and_b32 v45, 0xffff0000, v251
v_cvt_pk_f16_f32 v251, v44, v45
v_lshlrev_b32 v42, 16, v252
v_and_b32 v43, 0xffff0000, v252
v_cvt_pk_f16_f32 v252, v42, v43
v_lshlrev_b32 v44, 16, v253
v_and_b32 v45, 0xffff0000, v253
v_cvt_pk_f16_f32 v253, v44, v45
v_lshlrev_b32 v42, 16, v254
v_and_b32 v43, 0xffff0000, v254
v_cvt_pk_f16_f32 v254, v42, v43
v_lshlrev_b32 v44, 16, v255
v_and_b32 v45, 0xffff0000, v255
v_cvt_pk_f16_f32 v255, v44, v45
s_waitcnt vmcnt(29)
s_barrier
ds_read_b64_tr_b16 v[0:1], v32 offset:0
ds_read_b64_tr_b16 v[2:3], v32 offset:256
ds_read_b64_tr_b16 v[4:5], v32 offset:4096
ds_read_b64_tr_b16 v[6:7], v32 offset:4352
ds_read_b64_tr_b16 v[8:9], v33 offset:0
ds_read_b64_tr_b16 v[10:11], v33 offset:256
ds_read_b64_tr_b16 v[12:13], v33 offset:4096
ds_read_b64_tr_b16 v[14:15], v33 offset:4352
ds_read_b64_tr_b16 v[16:17], v34 offset:0
ds_read_b64_tr_b16 v[18:19], v34 offset:256
ds_read_b64_tr_b16 v[20:21], v34 offset:4096
ds_read_b64_tr_b16 v[22:23], v34 offset:4352
ds_read_b64_tr_b16 v[24:25], v35 offset:0
ds_read_b64_tr_b16 v[26:27], v35 offset:256
ds_read_b64_tr_b16 v[28:29], v35 offset:4096
ds_read_b64_tr_b16 v[30:31], v35 offset:4352
s_waitcnt lgkmcnt(0)
s_barrier
s_mov_b32 s8, s46
s_and_b32 s9, s47, 0xffff
s_mov_b32 s10, 0x800000
s_mov_b32 s11, 0x20000
s_sub_u32 s39, 511, s46
s_and_b32 s39, s39, 0x380
s_lshr_b32 s33, s39, 6
s_xor_b32 s33, s14, s33
s_and_b32 s33, s33, 6
s_lshl_b32 s33, s33, 17
s_add_u32 s39, s39, s33
s_andn2_b32 s32, s35, 0xe0fff
s_add_u32 s39, s39, s32
s_xor_b32 s32, s39, 0x0
buffer_load_dword v82, v81, s[8:11], s32 offen
s_xor_b32 s32, s35, 0x0
s_add_u32 m0, s36, 0
s_nop 0
buffer_load_dwordx4 v65, s[8:11], s32 offen lds
s_xor_b32 s32, s35, 0x8000
s_add_u32 m0, s36, 1024
s_nop 0
buffer_load_dwordx4 v65, s[8:11], s32 offen lds
s_xor_b32 s32, s35, 0x10000
s_add_u32 m0, s36, 2048
s_nop 0
buffer_load_dwordx4 v65, s[8:11], s32 offen lds
s_xor_b32 s32, s35, 0x18000
s_add_u32 m0, s36, 3072
s_nop 0
buffer_load_dwordx4 v65, s[8:11], s32 offen lds
s_xor_b32 s32, s35, 0x20000
s_add_u32 m0, s36, 4096
s_nop 0
buffer_load_dwordx4 v65, s[8:11], s32 offen lds
s_xor_b32 s32, s35, 0x28000
s_add_u32 m0, s36, 5120
s_nop 0
buffer_load_dwordx4 v65, s[8:11], s32 offen lds
s_xor_b32 s32, s35, 0x30000
s_add_u32 m0, s36, 6144
s_nop 0
buffer_load_dwordx4 v65, s[8:11], s32 offen lds
s_xor_b32 s32, s35, 0x38000
s_add_u32 m0, s36, 7168
s_nop 0
buffer_load_dwordx4 v65, s[8:11], s32 offen lds
v_lshlrev_b32 v42, 16, v0
v_and_b32 v43, 0xffff0000, v0
v_cvt_pk_f16_f32 v0, v42, v43
v_lshlrev_b32 v44, 16, v1
v_and_b32 v45, 0xffff0000, v1
v_cvt_pk_f16_f32 v1, v44, v45
v_lshlrev_b32 v42, 16, v2
v_and_b32 v43, 0xffff0000, v2
v_cvt_pk_f16_f32 v2, v42, v43
v_lshlrev_b32 v44, 16, v3
v_and_b32 v45, 0xffff0000, v3
v_cvt_pk_f16_f32 v3, v44, v45
v_lshlrev_b32 v42, 16, v4
v_and_b32 v43, 0xffff0000, v4
v_cvt_pk_f16_f32 v4, v42, v43
v_lshlrev_b32 v44, 16, v5
v_and_b32 v45, 0xffff0000, v5
v_cvt_pk_f16_f32 v5, v44, v45
v_lshlrev_b32 v42, 16, v6
v_and_b32 v43, 0xffff0000, v6
v_cvt_pk_f16_f32 v6, v42, v43
v_lshlrev_b32 v44, 16, v7
v_and_b32 v45, 0xffff0000, v7
v_cvt_pk_f16_f32 v7, v44, v45
v_accvgpr_write_b32 a0, v0
v_accvgpr_write_b32 a1, v1
v_accvgpr_write_b32 a2, v2
v_accvgpr_write_b32 a3, v3
v_accvgpr_write_b32 a4, v4
v_accvgpr_write_b32 a5, v5
v_accvgpr_write_b32 a6, v6
v_accvgpr_write_b32 a7, v7
v_lshlrev_b32 v42, 16, v8
v_and_b32 v43, 0xffff0000, v8
v_cvt_pk_f16_f32 v8, v42, v43
v_lshlrev_b32 v44, 16, v9
v_and_b32 v45, 0xffff0000, v9
v_cvt_pk_f16_f32 v9, v44, v45
v_lshlrev_b32 v42, 16, v10
v_and_b32 v43, 0xffff0000, v10
v_cvt_pk_f16_f32 v10, v42, v43
v_lshlrev_b32 v44, 16, v11
v_and_b32 v45, 0xffff0000, v11
v_cvt_pk_f16_f32 v11, v44, v45
v_lshlrev_b32 v42, 16, v12
v_and_b32 v43, 0xffff0000, v12
v_cvt_pk_f16_f32 v12, v42, v43
v_lshlrev_b32 v44, 16, v13
v_and_b32 v45, 0xffff0000, v13
v_cvt_pk_f16_f32 v13, v44, v45
v_lshlrev_b32 v42, 16, v14
v_and_b32 v43, 0xffff0000, v14
v_cvt_pk_f16_f32 v14, v42, v43
v_lshlrev_b32 v44, 16, v15
v_and_b32 v45, 0xffff0000, v15
v_cvt_pk_f16_f32 v15, v44, v45
v_accvgpr_write_b32 a32, v8
v_accvgpr_write_b32 a33, v9
v_accvgpr_write_b32 a34, v10
v_accvgpr_write_b32 a35, v11
v_accvgpr_write_b32 a36, v12
v_accvgpr_write_b32 a37, v13
v_accvgpr_write_b32 a38, v14
v_accvgpr_write_b32 a39, v15
v_lshlrev_b32 v42, 16, v16
v_and_b32 v43, 0xffff0000, v16
v_cvt_pk_f16_f32 v16, v42, v43
v_lshlrev_b32 v44, 16, v17
v_and_b32 v45, 0xffff0000, v17
v_cvt_pk_f16_f32 v17, v44, v45
v_lshlrev_b32 v42, 16, v18
v_and_b32 v43, 0xffff0000, v18
v_cvt_pk_f16_f32 v18, v42, v43
v_lshlrev_b32 v44, 16, v19
v_and_b32 v45, 0xffff0000, v19
v_cvt_pk_f16_f32 v19, v44, v45
v_lshlrev_b32 v42, 16, v20
v_and_b32 v43, 0xffff0000, v20
v_cvt_pk_f16_f32 v20, v42, v43
v_lshlrev_b32 v44, 16, v21
v_and_b32 v45, 0xffff0000, v21
v_cvt_pk_f16_f32 v21, v44, v45
v_lshlrev_b32 v42, 16, v22
v_and_b32 v43, 0xffff0000, v22
v_cvt_pk_f16_f32 v22, v42, v43
v_lshlrev_b32 v44, 16, v23
v_and_b32 v45, 0xffff0000, v23
v_cvt_pk_f16_f32 v23, v44, v45
v_accvgpr_write_b32 a64, v16
v_accvgpr_write_b32 a65, v17
v_accvgpr_write_b32 a66, v18
v_accvgpr_write_b32 a67, v19
v_accvgpr_write_b32 a68, v20
v_accvgpr_write_b32 a69, v21
v_accvgpr_write_b32 a70, v22
v_accvgpr_write_b32 a71, v23
v_lshlrev_b32 v42, 16, v24
v_and_b32 v43, 0xffff0000, v24
v_cvt_pk_f16_f32 v24, v42, v43
v_lshlrev_b32 v44, 16, v25
v_and_b32 v45, 0xffff0000, v25
v_cvt_pk_f16_f32 v25, v44, v45
v_lshlrev_b32 v42, 16, v26
v_and_b32 v43, 0xffff0000, v26
v_cvt_pk_f16_f32 v26, v42, v43
v_lshlrev_b32 v44, 16, v27
v_and_b32 v45, 0xffff0000, v27
v_cvt_pk_f16_f32 v27, v44, v45
v_lshlrev_b32 v42, 16, v28
v_and_b32 v43, 0xffff0000, v28
v_cvt_pk_f16_f32 v28, v42, v43
v_lshlrev_b32 v44, 16, v29
v_and_b32 v45, 0xffff0000, v29
v_cvt_pk_f16_f32 v29, v44, v45
v_lshlrev_b32 v42, 16, v30
v_and_b32 v43, 0xffff0000, v30
v_cvt_pk_f16_f32 v30, v42, v43
v_lshlrev_b32 v44, 16, v31
v_and_b32 v45, 0xffff0000, v31
v_cvt_pk_f16_f32 v31, v44, v45
v_accvgpr_write_b32 a96, v24
v_accvgpr_write_b32 a97, v25
v_accvgpr_write_b32 a98, v26
v_accvgpr_write_b32 a99, v27
v_accvgpr_write_b32 a100, v28
v_accvgpr_write_b32 a101, v29
v_accvgpr_write_b32 a102, v30
v_accvgpr_write_b32 a103, v31
s_waitcnt vmcnt(29)
s_barrier
ds_read_b64_tr_b16 v[0:1], v32 offset:8192
ds_read_b64_tr_b16 v[2:3], v32 offset:8448
ds_read_b64_tr_b16 v[4:5], v32 offset:12288
ds_read_b64_tr_b16 v[6:7], v32 offset:12544
ds_read_b64_tr_b16 v[8:9], v33 offset:8192
ds_read_b64_tr_b16 v[10:11], v33 offset:8448
ds_read_b64_tr_b16 v[12:13], v33 offset:12288
ds_read_b64_tr_b16 v[14:15], v33 offset:12544
ds_read_b64_tr_b16 v[16:17], v34 offset:8192
ds_read_b64_tr_b16 v[18:19], v34 offset:8448
ds_read_b64_tr_b16 v[20:21], v34 offset:12288
ds_read_b64_tr_b16 v[22:23], v34 offset:12544
ds_read_b64_tr_b16 v[24:25], v35 offset:8192
ds_read_b64_tr_b16 v[26:27], v35 offset:8448
ds_read_b64_tr_b16 v[28:29], v35 offset:12288
ds_read_b64_tr_b16 v[30:31], v35 offset:12544
s_waitcnt lgkmcnt(0)
s_barrier
s_xor_b32 s32, s39, 0x40000
buffer_load_dword v82, v81, s[8:11], s32 offen
s_xor_b32 s32, s35, 0x40000
s_add_u32 m0, s36, 8192
s_nop 0
buffer_load_dwordx4 v65, s[8:11], s32 offen lds
s_xor_b32 s32, s35, 0x48000
s_add_u32 m0, s36, 9216
s_nop 0
buffer_load_dwordx4 v65, s[8:11], s32 offen lds
s_xor_b32 s32, s35, 0x50000
s_add_u32 m0, s36, 10240
s_nop 0
buffer_load_dwordx4 v65, s[8:11], s32 offen lds
s_xor_b32 s32, s35, 0x58000
s_add_u32 m0, s36, 11264
s_nop 0
buffer_load_dwordx4 v65, s[8:11], s32 offen lds
s_xor_b32 s32, s35, 0x60000
s_add_u32 m0, s36, 12288
s_nop 0
buffer_load_dwordx4 v65, s[8:11], s32 offen lds
s_xor_b32 s32, s35, 0x68000
s_add_u32 m0, s36, 13312
s_nop 0
buffer_load_dwordx4 v65, s[8:11], s32 offen lds
s_xor_b32 s32, s35, 0x70000
s_add_u32 m0, s36, 14336
s_nop 0
buffer_load_dwordx4 v65, s[8:11], s32 offen lds
s_xor_b32 s32, s35, 0x78000
s_add_u32 m0, s36, 15360
s_nop 0
buffer_load_dwordx4 v65, s[8:11], s32 offen lds
v_lshlrev_b32 v42, 16, v0
v_and_b32 v43, 0xffff0000, v0
v_cvt_pk_f16_f32 v0, v42, v43
v_lshlrev_b32 v44, 16, v1
v_and_b32 v45, 0xffff0000, v1
v_cvt_pk_f16_f32 v1, v44, v45
v_lshlrev_b32 v42, 16, v2
v_and_b32 v43, 0xffff0000, v2
v_cvt_pk_f16_f32 v2, v42, v43
v_lshlrev_b32 v44, 16, v3
v_and_b32 v45, 0xffff0000, v3
v_cvt_pk_f16_f32 v3, v44, v45
v_lshlrev_b32 v42, 16, v4
v_and_b32 v43, 0xffff0000, v4
v_cvt_pk_f16_f32 v4, v42, v43
v_lshlrev_b32 v44, 16, v5
v_and_b32 v45, 0xffff0000, v5
v_cvt_pk_f16_f32 v5, v44, v45
v_lshlrev_b32 v42, 16, v6
v_and_b32 v43, 0xffff0000, v6
v_cvt_pk_f16_f32 v6, v42, v43
v_lshlrev_b32 v44, 16, v7
v_and_b32 v45, 0xffff0000, v7
v_cvt_pk_f16_f32 v7, v44, v45
v_accvgpr_write_b32 a8, v0
v_accvgpr_write_b32 a9, v1
v_accvgpr_write_b32 a10, v2
v_accvgpr_write_b32 a11, v3
v_accvgpr_write_b32 a12, v4
v_accvgpr_write_b32 a13, v5
v_accvgpr_write_b32 a14, v6
v_accvgpr_write_b32 a15, v7
v_lshlrev_b32 v42, 16, v8
v_and_b32 v43, 0xffff0000, v8
v_cvt_pk_f16_f32 v8, v42, v43
v_lshlrev_b32 v44, 16, v9
v_and_b32 v45, 0xffff0000, v9
v_cvt_pk_f16_f32 v9, v44, v45
v_lshlrev_b32 v42, 16, v10
v_and_b32 v43, 0xffff0000, v10
v_cvt_pk_f16_f32 v10, v42, v43
v_lshlrev_b32 v44, 16, v11
v_and_b32 v45, 0xffff0000, v11
v_cvt_pk_f16_f32 v11, v44, v45
v_lshlrev_b32 v42, 16, v12
v_and_b32 v43, 0xffff0000, v12
v_cvt_pk_f16_f32 v12, v42, v43
v_lshlrev_b32 v44, 16, v13
v_and_b32 v45, 0xffff0000, v13
v_cvt_pk_f16_f32 v13, v44, v45
v_lshlrev_b32 v42, 16, v14
v_and_b32 v43, 0xffff0000, v14
v_cvt_pk_f16_f32 v14, v42, v43
v_lshlrev_b32 v44, 16, v15
v_and_b32 v45, 0xffff0000, v15
v_cvt_pk_f16_f32 v15, v44, v45
v_accvgpr_write_b32 a40, v8
v_accvgpr_write_b32 a41, v9
v_accvgpr_write_b32 a42, v10
v_accvgpr_write_b32 a43, v11
v_accvgpr_write_b32 a44, v12
v_accvgpr_write_b32 a45, v13
v_accvgpr_write_b32 a46, v14
v_accvgpr_write_b32 a47, v15
v_lshlrev_b32 v42, 16, v16
v_and_b32 v43, 0xffff0000, v16
v_cvt_pk_f16_f32 v16, v42, v43
v_lshlrev_b32 v44, 16, v17
v_and_b32 v45, 0xffff0000, v17
v_cvt_pk_f16_f32 v17, v44, v45
v_lshlrev_b32 v42, 16, v18
v_and_b32 v43, 0xffff0000, v18
v_cvt_pk_f16_f32 v18, v42, v43
v_lshlrev_b32 v44, 16, v19
v_and_b32 v45, 0xffff0000, v19
v_cvt_pk_f16_f32 v19, v44, v45
v_lshlrev_b32 v42, 16, v20
v_and_b32 v43, 0xffff0000, v20
v_cvt_pk_f16_f32 v20, v42, v43
v_lshlrev_b32 v44, 16, v21
v_and_b32 v45, 0xffff0000, v21
v_cvt_pk_f16_f32 v21, v44, v45
v_lshlrev_b32 v42, 16, v22
v_and_b32 v43, 0xffff0000, v22
v_cvt_pk_f16_f32 v22, v42, v43
v_lshlrev_b32 v44, 16, v23
v_and_b32 v45, 0xffff0000, v23
v_cvt_pk_f16_f32 v23, v44, v45
v_accvgpr_write_b32 a72, v16
v_accvgpr_write_b32 a73, v17
v_accvgpr_write_b32 a74, v18
v_accvgpr_write_b32 a75, v19
v_accvgpr_write_b32 a76, v20
v_accvgpr_write_b32 a77, v21
v_accvgpr_write_b32 a78, v22
v_accvgpr_write_b32 a79, v23
v_lshlrev_b32 v42, 16, v24
v_and_b32 v43, 0xffff0000, v24
v_cvt_pk_f16_f32 v24, v42, v43
v_lshlrev_b32 v44, 16, v25
v_and_b32 v45, 0xffff0000, v25
v_cvt_pk_f16_f32 v25, v44, v45
v_lshlrev_b32 v42, 16, v26
v_and_b32 v43, 0xffff0000, v26
v_cvt_pk_f16_f32 v26, v42, v43
v_lshlrev_b32 v44, 16, v27
v_and_b32 v45, 0xffff0000, v27
v_cvt_pk_f16_f32 v27, v44, v45
v_lshlrev_b32 v42, 16, v28
v_and_b32 v43, 0xffff0000, v28
v_cvt_pk_f16_f32 v28, v42, v43
v_lshlrev_b32 v44, 16, v29
v_and_b32 v45, 0xffff0000, v29
v_cvt_pk_f16_f32 v29, v44, v45
v_lshlrev_b32 v42, 16, v30
v_and_b32 v43, 0xffff0000, v30
v_cvt_pk_f16_f32 v30, v42, v43
v_lshlrev_b32 v44, 16, v31
v_and_b32 v45, 0xffff0000, v31
v_cvt_pk_f16_f32 v31, v44, v45
v_accvgpr_write_b32 a104, v24
v_accvgpr_write_b32 a105, v25
v_accvgpr_write_b32 a106, v26
v_accvgpr_write_b32 a107, v27
v_accvgpr_write_b32 a108, v28
v_accvgpr_write_b32 a109, v29
v_accvgpr_write_b32 a110, v30
v_accvgpr_write_b32 a111, v31
s_waitcnt vmcnt(27)
v_readlane_b32 s48, v72, 0
v_readlane_b32 s49, v72, 1
v_readlane_b32 s50, v72, 2
v_readlane_b32 s51, v72, 3
v_readlane_b32 s52, v72, 4
v_readlane_b32 s53, v72, 5
v_readlane_b32 s54, v72, 6
v_readlane_b32 s55, v72, 7
v_readlane_b32 s38, v72, 8
s_nop 3
s_add_u32 s33, s48, s49
s_add_u32 s33, s33, s50
s_add_u32 s33, s33, s51
s_add_u32 s33, s33, s52
s_add_u32 s33, s33, s53
s_add_u32 s33, s33, s54
s_add_u32 s33, s33, s55
s_cmp_ge_u32 s38, 4
s_cselect_b32 s33, s33, 0
s_cmp_ge_u32 s33, 256
s_cselect_b32 s38, 0, 1
s_barrier
ds_read_b64_tr_b16 v[0:1], v32 offset:16384
ds_read_b64_tr_b16 v[2:3], v32 offset:16640
ds_read_b64_tr_b16 v[4:5], v32 offset:20480
ds_read_b64_tr_b16 v[6:7], v32 offset:20736
ds_read_b64_tr_b16 v[8:9], v33 offset:16384
ds_read_b64_tr_b16 v[10:11], v33 offset:16640
ds_read_b64_tr_b16 v[12:13], v33 offset:20480
ds_read_b64_tr_b16 v[14:15], v33 offset:20736
ds_read_b64_tr_b16 v[16:17], v34 offset:16384
ds_read_b64_tr_b16 v[18:19], v34 offset:16640
ds_read_b64_tr_b16 v[20:21], v34 offset:20480
ds_read_b64_tr_b16 v[22:23], v34 offset:20736
ds_read_b64_tr_b16 v[24:25], v35 offset:16384
ds_read_b64_tr_b16 v[26:27], v35 offset:16640
ds_read_b64_tr_b16 v[28:29], v35 offset:20480
ds_read_b64_tr_b16 v[30:31], v35 offset:20736
s_waitcnt lgkmcnt(0)
s_barrier
s_xor_b32 s32, s39, 0x80000
buffer_load_dword v82, v81, s[8:11], s32 offen
s_xor_b32 s32, s35, 0x80000
s_add_u32 m0, s36, 16384
s_nop 0
buffer_load_dwordx4 v65, s[8:11], s32 offen lds
s_xor_b32 s32, s35, 0x88000
s_add_u32 m0, s36, 17408
s_nop 0
buffer_load_dwordx4 v65, s[8:11], s32 offen lds
s_xor_b32 s32, s35, 0x90000
s_add_u32 m0, s36, 18432
s_nop 0
buffer_load_dwordx4 v65, s[8:11], s32 offen lds
s_xor_b32 s32, s35, 0x98000
s_add_u32 m0, s36, 19456
s_nop 0
buffer_load_dwordx4 v65, s[8:11], s32 offen lds
s_xor_b32 s32, s35, 0xa0000
s_add_u32 m0, s36, 20480
s_nop 0
buffer_load_dwordx4 v65, s[8:11], s32 offen lds
s_xor_b32 s32, s35, 0xa8000
s_add_u32 m0, s36, 21504
s_nop 0
buffer_load_dwordx4 v65, s[8:11], s32 offen lds
s_xor_b32 s32, s35, 0xb0000
s_add_u32 m0, s36, 22528
s_nop 0
buffer_load_dwordx4 v65, s[8:11], s32 offen lds
s_xor_b32 s32, s35, 0xb8000
s_add_u32 m0, s36, 23552
s_nop 0
buffer_load_dwordx4 v65, s[8:11], s32 offen lds
v_lshlrev_b32 v42, 16, v0
v_and_b32 v43, 0xffff0000, v0
v_cvt_pk_f16_f32 v0, v42, v43
v_lshlrev_b32 v44, 16, v1
v_and_b32 v45, 0xffff0000, v1
v_cvt_pk_f16_f32 v1, v44, v45
v_lshlrev_b32 v42, 16, v2
v_and_b32 v43, 0xffff0000, v2
v_cvt_pk_f16_f32 v2, v42, v43
v_lshlrev_b32 v44, 16, v3
v_and_b32 v45, 0xffff0000, v3
v_cvt_pk_f16_f32 v3, v44, v45
v_lshlrev_b32 v42, 16, v4
v_and_b32 v43, 0xffff0000, v4
v_cvt_pk_f16_f32 v4, v42, v43
v_lshlrev_b32 v44, 16, v5
v_and_b32 v45, 0xffff0000, v5
v_cvt_pk_f16_f32 v5, v44, v45
v_lshlrev_b32 v42, 16, v6
v_and_b32 v43, 0xffff0000, v6
v_cvt_pk_f16_f32 v6, v42, v43
v_lshlrev_b32 v44, 16, v7
v_and_b32 v45, 0xffff0000, v7
v_cvt_pk_f16_f32 v7, v44, v45
v_accvgpr_write_b32 a16, v0
v_accvgpr_write_b32 a17, v1
v_accvgpr_write_b32 a18, v2
v_accvgpr_write_b32 a19, v3
v_accvgpr_write_b32 a20, v4
v_accvgpr_write_b32 a21, v5
v_accvgpr_write_b32 a22, v6
v_accvgpr_write_b32 a23, v7
v_lshlrev_b32 v42, 16, v8
v_and_b32 v43, 0xffff0000, v8
v_cvt_pk_f16_f32 v8, v42, v43
v_lshlrev_b32 v44, 16, v9
v_and_b32 v45, 0xffff0000, v9
v_cvt_pk_f16_f32 v9, v44, v45
v_lshlrev_b32 v42, 16, v10
v_and_b32 v43, 0xffff0000, v10
v_cvt_pk_f16_f32 v10, v42, v43
v_lshlrev_b32 v44, 16, v11
v_and_b32 v45, 0xffff0000, v11
v_cvt_pk_f16_f32 v11, v44, v45
v_lshlrev_b32 v42, 16, v12
v_and_b32 v43, 0xffff0000, v12
v_cvt_pk_f16_f32 v12, v42, v43
v_lshlrev_b32 v44, 16, v13
v_and_b32 v45, 0xffff0000, v13
v_cvt_pk_f16_f32 v13, v44, v45
v_lshlrev_b32 v42, 16, v14
v_and_b32 v43, 0xffff0000, v14
v_cvt_pk_f16_f32 v14, v42, v43
v_lshlrev_b32 v44, 16, v15
v_and_b32 v45, 0xffff0000, v15
v_cvt_pk_f16_f32 v15, v44, v45
v_accvgpr_write_b32 a48, v8
v_accvgpr_write_b32 a49, v9
v_accvgpr_write_b32 a50, v10
v_accvgpr_write_b32 a51, v11
v_accvgpr_write_b32 a52, v12
v_accvgpr_write_b32 a53, v13
v_accvgpr_write_b32 a54, v14
v_accvgpr_write_b32 a55, v15
v_lshlrev_b32 v42, 16, v16
v_and_b32 v43, 0xffff0000, v16
v_cvt_pk_f16_f32 v16, v42, v43
v_lshlrev_b32 v44, 16, v17
v_and_b32 v45, 0xffff0000, v17
v_cvt_pk_f16_f32 v17, v44, v45
v_lshlrev_b32 v42, 16, v18
v_and_b32 v43, 0xffff0000, v18
v_cvt_pk_f16_f32 v18, v42, v43
v_lshlrev_b32 v44, 16, v19
v_and_b32 v45, 0xffff0000, v19
v_cvt_pk_f16_f32 v19, v44, v45
v_lshlrev_b32 v42, 16, v20
v_and_b32 v43, 0xffff0000, v20
v_cvt_pk_f16_f32 v20, v42, v43
v_lshlrev_b32 v44, 16, v21
v_and_b32 v45, 0xffff0000, v21
v_cvt_pk_f16_f32 v21, v44, v45
v_lshlrev_b32 v42, 16, v22
v_and_b32 v43, 0xffff0000, v22
v_cvt_pk_f16_f32 v22, v42, v43
v_lshlrev_b32 v44, 16, v23
v_and_b32 v45, 0xffff0000, v23
v_cvt_pk_f16_f32 v23, v44, v45
v_accvgpr_write_b32 a80, v16
v_accvgpr_write_b32 a81, v17
v_accvgpr_write_b32 a82, v18
v_accvgpr_write_b32 a83, v19
v_accvgpr_write_b32 a84, v20
v_accvgpr_write_b32 a85, v21
v_accvgpr_write_b32 a86, v22
v_accvgpr_write_b32 a87, v23
v_lshlrev_b32 v42, 16, v24
v_and_b32 v43, 0xffff0000, v24
v_cvt_pk_f16_f32 v24, v42, v43
v_lshlrev_b32 v44, 16, v25
v_and_b32 v45, 0xffff0000, v25
v_cvt_pk_f16_f32 v25, v44, v45
v_lshlrev_b32 v42, 16, v26
v_and_b32 v43, 0xffff0000, v26
v_cvt_pk_f16_f32 v26, v42, v43
v_lshlrev_b32 v44, 16, v27
v_and_b32 v45, 0xffff0000, v27
v_cvt_pk_f16_f32 v27, v44, v45
v_lshlrev_b32 v42, 16, v28
v_and_b32 v43, 0xffff0000, v28
v_cvt_pk_f16_f32 v28, v42, v43
v_lshlrev_b32 v44, 16, v29
v_and_b32 v45, 0xffff0000, v29
v_cvt_pk_f16_f32 v29, v44, v45
v_lshlrev_b32 v42, 16, v30
v_and_b32 v43, 0xffff0000, v30
v_cvt_pk_f16_f32 v30, v42, v43
v_lshlrev_b32 v44, 16, v31
v_and_b32 v45, 0xffff0000, v31
v_cvt_pk_f16_f32 v31, v44, v45
v_accvgpr_write_b32 a112, v24
v_accvgpr_write_b32 a113, v25
v_accvgpr_write_b32 a114, v26
v_accvgpr_write_b32 a115, v27
v_accvgpr_write_b32 a116, v28
v_accvgpr_write_b32 a117, v29
v_accvgpr_write_b32 a118, v30
v_accvgpr_write_b32 a119, v31
s_waitcnt vmcnt(27)
s_barrier
ds_read_b64_tr_b16 v[0:1], v32 offset:24576
ds_read_b64_tr_b16 v[2:3], v32 offset:24832
ds_read_b64_tr_b16 v[4:5], v32 offset:28672
ds_read_b64_tr_b16 v[6:7], v32 offset:28928
ds_read_b64_tr_b16 v[8:9], v33 offset:24576
ds_read_b64_tr_b16 v[10:11], v33 offset:24832
ds_read_b64_tr_b16 v[12:13], v33 offset:28672
ds_read_b64_tr_b16 v[14:15], v33 offset:28928
ds_read_b64_tr_b16 v[16:17], v34 offset:24576
ds_read_b64_tr_b16 v[18:19], v34 offset:24832
ds_read_b64_tr_b16 v[20:21], v34 offset:28672
ds_read_b64_tr_b16 v[22:23], v34 offset:28928
ds_read_b64_tr_b16 v[24:25], v35 offset:24576
ds_read_b64_tr_b16 v[26:27], v35 offset:24832
ds_read_b64_tr_b16 v[28:29], v35 offset:28672
ds_read_b64_tr_b16 v[30:31], v35 offset:28928
s_waitcnt lgkmcnt(0)
s_barrier
s_xor_b32 s32, s39, 0xc0000
buffer_load_dword v82, v81, s[8:11], s32 offen
s_xor_b32 s32, s35, 0xc0000
s_add_u32 m0, s36, 24576
s_nop 0
buffer_load_dwordx4 v65, s[8:11], s32 offen lds
s_xor_b32 s32, s35, 0xc8000
s_add_u32 m0, s36, 25600
s_nop 0
buffer_load_dwordx4 v65, s[8:11], s32 offen lds
s_xor_b32 s32, s35, 0xd0000
s_add_u32 m0, s36, 26624
s_nop 0
buffer_load_dwordx4 v65, s[8:11], s32 offen lds
s_xor_b32 s32, s35, 0xd8000
s_add_u32 m0, s36, 27648
s_nop 0
buffer_load_dwordx4 v65, s[8:11], s32 offen lds
s_xor_b32 s32, s35, 0xe0000
s_add_u32 m0, s36, 28672
s_nop 0
buffer_load_dwordx4 v65, s[8:11], s32 offen lds
s_xor_b32 s32, s35, 0xe8000
s_add_u32 m0, s36, 29696
s_nop 0
buffer_load_dwordx4 v65, s[8:11], s32 offen lds
s_xor_b32 s32, s35, 0xf0000
s_add_u32 m0, s36, 30720
s_nop 0
buffer_load_dwordx4 v65, s[8:11], s32 offen lds
s_xor_b32 s32, s35, 0xf8000
s_add_u32 m0, s36, 31744
s_nop 0
buffer_load_dwordx4 v65, s[8:11], s32 offen lds
v_lshlrev_b32 v42, 16, v0
v_and_b32 v43, 0xffff0000, v0
v_cvt_pk_f16_f32 v0, v42, v43
v_lshlrev_b32 v44, 16, v1
v_and_b32 v45, 0xffff0000, v1
v_cvt_pk_f16_f32 v1, v44, v45
v_lshlrev_b32 v42, 16, v2
v_and_b32 v43, 0xffff0000, v2
v_cvt_pk_f16_f32 v2, v42, v43
v_lshlrev_b32 v44, 16, v3
v_and_b32 v45, 0xffff0000, v3
v_cvt_pk_f16_f32 v3, v44, v45
v_lshlrev_b32 v42, 16, v4
v_and_b32 v43, 0xffff0000, v4
v_cvt_pk_f16_f32 v4, v42, v43
v_lshlrev_b32 v44, 16, v5
v_and_b32 v45, 0xffff0000, v5
v_cvt_pk_f16_f32 v5, v44, v45
v_lshlrev_b32 v42, 16, v6
v_and_b32 v43, 0xffff0000, v6
v_cvt_pk_f16_f32 v6, v42, v43
v_lshlrev_b32 v44, 16, v7
v_and_b32 v45, 0xffff0000, v7
v_cvt_pk_f16_f32 v7, v44, v45
v_accvgpr_write_b32 a24, v0
v_accvgpr_write_b32 a25, v1
v_accvgpr_write_b32 a26, v2
v_accvgpr_write_b32 a27, v3
v_accvgpr_write_b32 a28, v4
v_accvgpr_write_b32 a29, v5
v_accvgpr_write_b32 a30, v6
v_accvgpr_write_b32 a31, v7
v_lshlrev_b32 v42, 16, v8
v_and_b32 v43, 0xffff0000, v8
v_cvt_pk_f16_f32 v8, v42, v43
v_lshlrev_b32 v44, 16, v9
v_and_b32 v45, 0xffff0000, v9
v_cvt_pk_f16_f32 v9, v44, v45
v_lshlrev_b32 v42, 16, v10
v_and_b32 v43, 0xffff0000, v10
v_cvt_pk_f16_f32 v10, v42, v43
v_lshlrev_b32 v44, 16, v11
v_and_b32 v45, 0xffff0000, v11
v_cvt_pk_f16_f32 v11, v44, v45
v_lshlrev_b32 v42, 16, v12
v_and_b32 v43, 0xffff0000, v12
v_cvt_pk_f16_f32 v12, v42, v43
v_lshlrev_b32 v44, 16, v13
v_and_b32 v45, 0xffff0000, v13
v_cvt_pk_f16_f32 v13, v44, v45
v_lshlrev_b32 v42, 16, v14
v_and_b32 v43, 0xffff0000, v14
v_cvt_pk_f16_f32 v14, v42, v43
v_lshlrev_b32 v44, 16, v15
v_and_b32 v45, 0xffff0000, v15
v_cvt_pk_f16_f32 v15, v44, v45
v_accvgpr_write_b32 a56, v8
v_accvgpr_write_b32 a57, v9
v_accvgpr_write_b32 a58, v10
v_accvgpr_write_b32 a59, v11
v_accvgpr_write_b32 a60, v12
v_accvgpr_write_b32 a61, v13
v_accvgpr_write_b32 a62, v14
v_accvgpr_write_b32 a63, v15
v_lshlrev_b32 v42, 16, v16
v_and_b32 v43, 0xffff0000, v16
v_cvt_pk_f16_f32 v16, v42, v43
v_lshlrev_b32 v44, 16, v17
v_and_b32 v45, 0xffff0000, v17
v_cvt_pk_f16_f32 v17, v44, v45
v_lshlrev_b32 v42, 16, v18
v_and_b32 v43, 0xffff0000, v18
v_cvt_pk_f16_f32 v18, v42, v43
v_lshlrev_b32 v44, 16, v19
v_and_b32 v45, 0xffff0000, v19
v_cvt_pk_f16_f32 v19, v44, v45
v_lshlrev_b32 v42, 16, v20
v_and_b32 v43, 0xffff0000, v20
v_cvt_pk_f16_f32 v20, v42, v43
v_lshlrev_b32 v44, 16, v21
v_and_b32 v45, 0xffff0000, v21
v_cvt_pk_f16_f32 v21, v44, v45
v_lshlrev_b32 v42, 16, v22
v_and_b32 v43, 0xffff0000, v22
v_cvt_pk_f16_f32 v22, v42, v43
v_lshlrev_b32 v44, 16, v23
v_and_b32 v45, 0xffff0000, v23
v_cvt_pk_f16_f32 v23, v44, v45
v_accvgpr_write_b32 a88, v16
v_accvgpr_write_b32 a89, v17
v_accvgpr_write_b32 a90, v18
v_accvgpr_write_b32 a91, v19
v_accvgpr_write_b32 a92, v20
v_accvgpr_write_b32 a93, v21
v_accvgpr_write_b32 a94, v22
v_accvgpr_write_b32 a95, v23
v_lshlrev_b32 v42, 16, v24
v_and_b32 v43, 0xffff0000, v24
v_cvt_pk_f16_f32 v24, v42, v43
v_lshlrev_b32 v44, 16, v25
v_and_b32 v45, 0xffff0000, v25
v_cvt_pk_f16_f32 v25, v44, v45
v_lshlrev_b32 v42, 16, v26
v_and_b32 v43, 0xffff0000, v26
v_cvt_pk_f16_f32 v26, v42, v43
v_lshlrev_b32 v44, 16, v27
v_and_b32 v45, 0xffff0000, v27
v_cvt_pk_f16_f32 v27, v44, v45
v_lshlrev_b32 v42, 16, v28
v_and_b32 v43, 0xffff0000, v28
v_cvt_pk_f16_f32 v28, v42, v43
v_lshlrev_b32 v44, 16, v29
v_and_b32 v45, 0xffff0000, v29
v_cvt_pk_f16_f32 v29, v44, v45
v_lshlrev_b32 v42, 16, v30
v_and_b32 v43, 0xffff0000, v30
v_cvt_pk_f16_f32 v30, v42, v43
v_lshlrev_b32 v44, 16, v31
v_and_b32 v45, 0xffff0000, v31
v_cvt_pk_f16_f32 v31, v44, v45
v_accvgpr_write_b32 a120, v24
v_accvgpr_write_b32 a121, v25
v_accvgpr_write_b32 a122, v26
v_accvgpr_write_b32 a123, v27
v_accvgpr_write_b32 a124, v28
v_accvgpr_write_b32 a125, v29
v_accvgpr_write_b32 a126, v30
v_accvgpr_write_b32 a127, v31
v_and_b32 v64, 15, v94
v_lshrrev_b32 v65, 4, v94
v_bfe_u32 v126, v94, 4, 1
v_lshlrev_b32 v126, 2, v126
v_sub_u32 v126, v64, v126
v_mov_b32 v66, 0x3f80
v_mov_b32 v67, 0x3f800000
s_and_b32 s33, s14, 1
s_lshl_b32 s32, s33, 3
v_subrev_u32 v71, s32, v126
v_lshrrev_b32 v70, 3, v64
v_and_b32 v69, 5, v64
v_lshl_add_u32 v69, v70, 1, v69
v_sub_u32 v126, v126, v64
v_add_u32 v126, v126, v69
v_and_b32 v70, 2, v64
v_lshl_add_u32 v126, v70, 4, v126
v_cmp_eq_u32 vcc, 32, v126
s_nop 1
v_cndmask_b32 v127, 0, v66, vcc
v_cmp_eq_u32 vcc, 33, v126
s_nop 1
v_cndmask_b32 v104, v127, v67, vcc
v_mov_b32 v106, v104
v_cmp_eq_u32 vcc, 34, v126
s_nop 1
v_cndmask_b32 v127, 0, v66, vcc
v_cmp_eq_u32 vcc, 35, v126
s_nop 1
v_cndmask_b32 v105, v127, v67, vcc
v_mov_b32 v107, v105
v_cmp_eq_u32 vcc, 0, v126
s_nop 1
v_cndmask_b32 v127, 0, v66, vcc
v_cmp_eq_u32 vcc, 1, v126
s_nop 1
v_cndmask_b32 v108, v127, v67, vcc
v_mov_b32 v110, v108
v_mov_b32 v106, v108
v_cmp_eq_u32 vcc, 2, v126
s_nop 1
v_cndmask_b32 v127, 0, v66, vcc
v_cmp_eq_u32 vcc, 3, v126
s_nop 1
v_cndmask_b32 v109, v127, v67, vcc
v_mov_b32 v111, v109
v_mov_b32 v107, v109
v_mov_b32 v127, 0x4444
v_mov_b32 v95, 0xeeee
v_cmp_gt_u32 vcc, 8, v64
s_nop 1
v_cndmask_b32 v112, v95, v127, vcc
v_lshrrev_b32 v126, 1, v65
v_lshlrev_b32 v126, 7, v126
v_lshl_add_u32 v126, v64, 4, v126
v_and_b32 v127, 1, v65
v_lshl_add_u32 v126, v127, 3, v126
v_mov_b32 v95, 0x7f000000
v_cndmask_b32 v118, v95, v126, vcc
v_lshlrev_b32 v126, 3, v64
v_lshl_add_u32 v126, v127, 7, v126
v_cmp_le_u32 vcc, 2, v65
s_nop 1
v_cndmask_b32 v120, v95, v126, vcc
v_mov_b32 v126, 0xf149f2ca
v_cndmask_b32 v124, v126, 0, vcc
v_lshrrev_b32 v126, 3, v64
v_cmp_eq_u32 vcc, s33, v126
v_and_b32 v126, 7, v64
v_lshlrev_b32 v126, 4, v126
v_lshl_add_u32 v126, v65, 7, v126
v_cndmask_b32 v117, v95, v116, vcc
v_cndmask_b32 v119, v95, v126, vcc
s_lshl_b32 s32, s14, 11
v_add_u32 v114, s32, v116
s_lshr_b32 s32, s14, 1
s_lshl_b32 s32, s32, 10
s_lshl_b32 s33, s33, 3
s_add_u32 s32, s32, s33
v_add_u32 v115, s32, v116
v_lshrrev_b32 v126, 3, v64
v_lshl_add_u32 v125, v126, 11, v116
v_lshrrev_b32 v71, 1, v65
v_cmp_ne_u32 vcc, 0, v70
v_lshlrev_b32 v126, 4, v64
v_lshl_add_u32 v126, v127, 8, v126
v_lshl_add_u32 v117, v71, 3, v126
v_lshrrev_b32 v120, 1, v117
v_lshlrev_b32 v69, 4, v69
v_lshl_add_u32 v126, v127, 7, v69
v_lshl_add_u32 v126, v71, 3, v126
v_cndmask_b32 v119, v126, v95, vcc
v_lshl_add_u32 v126, v71, 7, v69
v_lshl_add_u32 v126, v127, 3, v126
v_cndmask_b32 v125, v126, v95, vcc
v_cndmask_b32 v118, v95, v126, vcc
s_mov_b32 s17, 0
s_lshl_b32 s32, s12, 14
s_lshl_b32 s33, s14, 12
s_add_u32 s18, s32, s33
s_xor_b32 s33, s14, s13
s_and_b32 s33, s33, 3
s_lshl_b32 s33, s33, 10
s_add_u32 s18, s18, s33
s_xor_b32 s19, s18, 0x4000
s_add_u32 s18, s18, 0x6c30000
s_add_u32 s19, s19, 0x6c38000
s_lshl_b32 s20, s15, 12
s_add_u32 s20, s20, 0x6c00000
s_lshl_b32 s32, s16, 11
s_lshl_b32 s33, s14, 9
s_add_u32 s32, s32, s33
s_add_u32 s21, s20, s32
s_lshl_b32 s32, s16, 11
s_xor_b32 s32, s32, 2048
s_add_u32 s20, s20, s32
s_lshl_b32 s32, s12, 15
s_add_u32 s32, s32, 0x6c20000
s_lshl_b32 s33, s13, 10
s_add_u32 s22, s32, s33
s_lshl_b32 s33, s14, 8
s_add_u32 s22, s22, s33
s_lshl_b32 s33, s14, 13
s_add_u32 s23, s32, s33
s_add_u32 s24, s23, 4096
s_xor_b32 s33, s14, s13
s_and_b32 s33, s33, 7
s_lshl_b32 s33, s33, 10
s_add_u32 s23, s23, s33
s_lshl_b32 s32, s12, 14
s_lshl_b32 s33, s13, 9
s_add_u32 s32, s32, s33
s_bitcmp1_b32 s14, 0
s_cselect_b32 s33, 256, 0
s_add_u32 s32, s32, s33
s_add_u32 s25, s32, 0x6c30000
s_lshl_b32 s32, s16, 6
s_lshl_b32 s33, s14, 4
s_add_u32 s32, s32, s33
s_lshl_b32 s33, s15, 7
s_add_u32 s32, s32, s33
s_lshl_b32 s26, s32, 4
s_add_u32 s26, s26, 0x6e00000
s_lshl_b32 s37, s15, 2
s_lshl_b32 s33, s16, 1
s_add_u32 s37, s37, s33
s_lshr_b32 s33, s14, 1
s_add_u32 s37, s37, s33
s_lshl_b32 s37, s37, 9
s_add_u32 s37, s37, 0x8000000
s_bitcmp1_b32 s14, 0
s_cselect_b32 s33, 256, 0
s_add_u32 s37, s37, s33
s_lshl_b32 s28, s32, 6
s_add_u32 s28, s28, 0x2800000
s_lshl_b32 s27, s15, 12
s_lshl_b32 s36, s14, 11
s_and_b32 s33, s36, 2048
s_lshl_b32 s32, s16, 11
s_xor_b32 s33, s33, s32
s_add_u32 s27, s27, s33
s_lshr_b32 s33, s14, 1
s_lshl_b32 s33, s33, 17
s_add_u32 s27, s27, s33
s_add_u32 s27, s27, 0x1800000
s_add_u32 s36, s36, 24576
s_mov_b32 s30, 0x3e0293ee
s_mov_b32 s31, 0xbe0293ee
v_mov_b32 v100, 0x3f803f80
v_mov_b32 v101, 0x3f803f80
v_mov_b32 v102, 0x3f803f80
v_mov_b32 v103, 0x3f803f80
v_mov_b32 v121, 0x7f000000
v_mov_b32 v122, 0
v_and_b32 v127, 1, v94
v_mov_b32 v77, 0x7f000000
s_lshl_b32 s32, s16, 3
s_lshl_b64 exec, 0xff, s32
s_add_u32 s32, s27, 0x40000
v_lshl_add_u32 v121, v64, 7, s32
v_mov_b32 v122, 0x40000
s_mov_b32 exec_lo, 0xff0000
s_add_u32 s32, s28, 0x40000
v_lshl_add_u32 v121, v64, 7, s32
v_mov_b32 v122, 0x40000
s_mov_b32 exec_lo, 0x000f000f
s_mov_b32 exec_hi, 0x000f000f
s_and_b32 s33, s14, 1
s_lshl_b32 s33, s33, 7
s_add_u32 s32, s21, s33
v_lshl_add_u32 v77, v64, 7, s21
s_mov_b32 exec_lo, 0x00300030
s_mov_b32 exec_hi, 0x00300030
v_lshl_add_u32 v77, v127, 7, s22
s_mov_b32 exec_lo, 0x00400040
s_mov_b32 exec_hi, 0x00400040
s_lshl_b32 s32, s12, 14
s_lshl_b32 s33, s13, 9
s_add_u32 s33, s32, s33
s_add_u32 s33, s33, 0x6c30000
s_andn2_b32 s3, s33, 0x3ff
s_andn2_b32 s34, s22, 0x3ff
s_cmp_eq_u32 s14, 1
s_cselect_b32 s3, s34, s3
s_bitcmp0_b32 s14, 0
s_cselect_b32 s3, s21, s3
s_add_u32 s3, s3, 0x80000
s_lshl_b32 s34, s14, 7
s_add_u32 s33, s33, s34
v_mov_b32 v77, s33
s_mov_b32 exec_lo, 0x00800080
s_mov_b32 exec_hi, 0x00800080
s_add_u32 s32, s32, s34
s_add_u32 s32, s32, 0x6c38000
v_mov_b32 v77, s32
s_mov_b64 exec, -1
v_lshl_add_u32 v77, v65, 18, v77
s_mov_b32 exec_lo, 0
s_mov_b32 exec_hi, 0x300
s_lshl_b32 s32, s15, 2
s_add_u32 s32, s32, 0x8406000
v_lshl_add_u32 v121, v127, 13, s32
s_mov_b32 exec_hi, 0x3c00
s_mov_b32 s32, 0x8418158
v_lshl_add_u32 v121, v64, 2, s32
s_mov_b32 exec_hi, 0x3f00
v_mov_b32 v122, 128
s_mov_b64 exec, -1
s_lshl_b32 s32, s15, 3
s_lshl_b32 s33, s16, 2
s_add_u32 s32, s32, s33
s_add_u32 s32, s32, s14
s_mov_b32 s39, 0x7f000000
s_cmp_eq_u32 s32, 2
s_cselect_b32 s39, 0x841ec00, s39
s_waitcnt vmcnt(27)
ds_read_b64_tr_b16 v[0:1], v68 offset:0
ds_read_b64_tr_b16 v[2:3], v68 offset:128
ds_read_b64_tr_b16 v[4:5], v68 offset:2048
ds_read_b64_tr_b16 v[6:7], v68 offset:2176
ds_read_b64_tr_b16 v[8:9], v68 offset:32
ds_read_b64_tr_b16 v[10:11], v68 offset:160
ds_read_b64_tr_b16 v[12:13], v68 offset:2080
ds_read_b64_tr_b16 v[14:15], v68 offset:2208
ds_read_b64_tr_b16 v[16:17], v68 offset:4096
ds_read_b64_tr_b16 v[18:19], v68 offset:4224
ds_read_b64_tr_b16 v[20:21], v68 offset:6144
ds_read_b64_tr_b16 v[22:23], v68 offset:6272
ds_read_b64_tr_b16 v[24:25], v68 offset:4128
ds_read_b64_tr_b16 v[26:27], v68 offset:4256
ds_read_b64_tr_b16 v[28:29], v68 offset:6176
ds_read_b64_tr_b16 v[30:31], v68 offset:6304
s_waitcnt lgkmcnt(0)
ds_write_b128 v113, v[0:3] offset:0
ds_write_b128 v113, v[4:7] offset:1024
ds_write_b128 v113, v[8:11] offset:2048
ds_write_b128 v113, v[12:15] offset:3072
ds_write_b128 v113, v[16:19] offset:4096
ds_write_b128 v113, v[20:23] offset:5120
ds_write_b128 v113, v[24:27] offset:6144
ds_write_b128 v113, v[28:31] offset:7168
s_waitcnt lgkmcnt(0)
s_waitcnt vmcnt(18)
ds_read_b64_tr_b16 v[0:1], v68 offset:8192
ds_read_b64_tr_b16 v[2:3], v68 offset:8320
ds_read_b64_tr_b16 v[4:5], v68 offset:10240
ds_read_b64_tr_b16 v[6:7], v68 offset:10368
ds_read_b64_tr_b16 v[8:9], v68 offset:8224
ds_read_b64_tr_b16 v[10:11], v68 offset:8352
ds_read_b64_tr_b16 v[12:13], v68 offset:10272
ds_read_b64_tr_b16 v[14:15], v68 offset:10400
ds_read_b64_tr_b16 v[16:17], v68 offset:12288
ds_read_b64_tr_b16 v[18:19], v68 offset:12416
ds_read_b64_tr_b16 v[20:21], v68 offset:14336
ds_read_b64_tr_b16 v[22:23], v68 offset:14464
ds_read_b64_tr_b16 v[24:25], v68 offset:12320
ds_read_b64_tr_b16 v[26:27], v68 offset:12448
ds_read_b64_tr_b16 v[28:29], v68 offset:14368
ds_read_b64_tr_b16 v[30:31], v68 offset:14496
s_waitcnt lgkmcnt(0)
ds_write_b128 v113, v[0:3] offset:8192
ds_write_b128 v113, v[4:7] offset:9216
ds_write_b128 v113, v[8:11] offset:10240
ds_write_b128 v113, v[12:15] offset:11264
ds_write_b128 v113, v[16:19] offset:12288
ds_write_b128 v113, v[20:23] offset:13312
ds_write_b128 v113, v[24:27] offset:14336
ds_write_b128 v113, v[28:31] offset:15360
s_waitcnt lgkmcnt(0)
s_waitcnt vmcnt(9)
buffer_load_dword v76, v74, s[4:7], 0 offen sc1
buffer_load_dword v79, v75, s[4:7], 0 offen sc1
ds_read_b64_tr_b16 v[0:1], v68 offset:16384
ds_read_b64_tr_b16 v[2:3], v68 offset:16512
ds_read_b64_tr_b16 v[4:5], v68 offset:18432
ds_read_b64_tr_b16 v[6:7], v68 offset:18560
ds_read_b64_tr_b16 v[8:9], v68 offset:16416
ds_read_b64_tr_b16 v[10:11], v68 offset:16544
ds_read_b64_tr_b16 v[12:13], v68 offset:18464
ds_read_b64_tr_b16 v[14:15], v68 offset:18592
ds_read_b64_tr_b16 v[16:17], v68 offset:20480
ds_read_b64_tr_b16 v[18:19], v68 offset:20608
ds_read_b64_tr_b16 v[20:21], v68 offset:22528
ds_read_b64_tr_b16 v[22:23], v68 offset:22656
ds_read_b64_tr_b16 v[24:25], v68 offset:20512
ds_read_b64_tr_b16 v[26:27], v68 offset:20640
ds_read_b64_tr_b16 v[28:29], v68 offset:22560
ds_read_b64_tr_b16 v[30:31], v68 offset:22688
s_waitcnt lgkmcnt(0)
ds_write_b128 v113, v[0:3] offset:16384
ds_write_b128 v113, v[4:7] offset:17408
ds_write_b128 v113, v[8:11] offset:18432
ds_write_b128 v113, v[12:15] offset:19456
ds_write_b128 v113, v[16:19] offset:20480
ds_write_b128 v113, v[20:23] offset:21504
ds_write_b128 v113, v[24:27] offset:22528
ds_write_b128 v113, v[28:31] offset:23552
s_waitcnt lgkmcnt(0)
s_waitcnt vmcnt(2)
s_waitcnt vmcnt(0)
v_min_u32 v76, v76, v79
v_cmp_eq_u32 vcc, 0, v76
s_cmp_eq_u32 s38, 0
s_cbranch_scc0 main_kernel_c_sl0
s_cbranch_vccnz main_kernel_c_sl1
s_branch main_kernel_c_kv0_ok
main_kernel_c_sl0:
v_and_b32 v126, 7, v94
v_lshlrev_b32 v126, 5, v126
main_kernel_c_mode_cnt:
buffer_load_dword v127, v126, s[60:63], 0 offen sc1
s_waitcnt vmcnt(0)
v_readlane_b32 s48, v127, 0
v_readlane_b32 s49, v127, 1
v_readlane_b32 s50, v127, 2
v_readlane_b32 s51, v127, 3
v_readlane_b32 s52, v127, 4
v_readlane_b32 s53, v127, 5
v_readlane_b32 s54, v127, 6
v_readlane_b32 s55, v127, 7
s_nop 3
s_add_u32 s33, s48, s49
s_add_u32 s33, s33, s50
s_add_u32 s33, s33, s51
s_add_u32 s33, s33, s52
s_add_u32 s33, s33, s53
s_add_u32 s33, s33, s54
s_add_u32 s33, s33, s55
s_cmp_ge_u32 s33, 256
s_cbranch_scc1 main_kernel_c_mode_cnt_ok
s_sub_u32 s29, s29, 1
s_cbranch_scc1 main_kernel_end
s_sleep 4
s_branch main_kernel_c_mode_cnt
main_kernel_c_mode_cnt_ok:
v_mov_b32 v126, 0
main_kernel_c_wa:
buffer_load_dword v127, v126, s[60:63], 0 offen offset:12 sc1
s_waitcnt vmcnt(0)
v_cmp_gt_u32 vcc, 4, v127
s_cbranch_vccz main_kernel_c_wa_ok
s_sleep 4
s_sub_u32 s29, s29, 1
s_cbranch_scc0 main_kernel_c_wa
s_branch main_kernel_end
main_kernel_c_wa_ok:
main_kernel_c_sl1:
v_lshlrev_b32 v126, 2, v94
s_mov_b32 s32, 0x841f000
main_kernel_c_wf:
buffer_load_dword v0, v126, s[4:7], s32 offen sc1
s_waitcnt vmcnt(0)
v_cmp_eq_u32 vcc, 0, v0
s_cbranch_vccz main_kernel_c_wf_ok
s_sleep 4
s_sub_u32 s29, s29, 1
s_cbranch_scc0 main_kernel_c_wf
s_branch main_kernel_end
main_kernel_c_wf_ok:
s_mov_b32 exec_lo, 0
s_mov_b32 exec_hi, 0x300
v_subrev_u32 v127, 0, v121
main_kernel_c_kv0:
buffer_load_dword v126, v127, s[4:7], 0 offen sc1
s_waitcnt vmcnt(0)
v_cmp_eq_u32 vcc, 0, v126
s_cbranch_vccz main_kernel_c_kv0_ok
s_sleep 2
s_sub_u32 s29, s29, 1
s_cbranch_scc0 main_kernel_c_kv0
s_branch main_kernel_end
main_kernel_c_kv0_ok:
s_mov_b32 exec_lo, 0
s_mov_b32 exec_hi, 0x3f00
v_add_u32 v121, 128, v121
s_mov_b64 exec, -1
s_mov_b32 m0, s36
buffer_load_dwordx4 v[96:99], v116, s[4:7], s28 offen sc1
buffer_load_dwordx4 v116, s[4:7], s27 offen sc1 lds
buffer_load_dwordx4 v116, s[4:7], s27 offen offset:1024 sc1 lds
s_add_u32 s27, s27, 0x40000
buffer_load_dword v123, v77, s[4:7], 0 offen sc1
ds_read_b64_tr_b16 v[0:1], v68 offset:24576
ds_read_b64_tr_b16 v[2:3], v68 offset:24704
ds_read_b64_tr_b16 v[4:5], v68 offset:26624
ds_read_b64_tr_b16 v[6:7], v68 offset:26752
ds_read_b64_tr_b16 v[8:9], v68 offset:24608
ds_read_b64_tr_b16 v[10:11], v68 offset:24736
ds_read_b64_tr_b16 v[12:13], v68 offset:26656
ds_read_b64_tr_b16 v[14:15], v68 offset:26784
ds_read_b64_tr_b16 v[16:17], v68 offset:28672
ds_read_b64_tr_b16 v[18:19], v68 offset:28800
ds_read_b64_tr_b16 v[20:21], v68 offset:30720
ds_read_b64_tr_b16 v[22:23], v68 offset:30848
ds_read_b64_tr_b16 v[24:25], v68 offset:28704
ds_read_b64_tr_b16 v[26:27], v68 offset:28832
ds_read_b64_tr_b16 v[28:29], v68 offset:30752
ds_read_b64_tr_b16 v[30:31], v68 offset:30880
s_waitcnt lgkmcnt(0)
ds_write_b128 v113, v[0:3] offset:24576
ds_write_b128 v113, v[4:7] offset:25600
ds_write_b128 v113, v[8:11] offset:26624
ds_write_b128 v113, v[12:15] offset:27648
ds_write_b128 v113, v[16:19] offset:28672
ds_write_b128 v113, v[20:23] offset:29696
ds_write_b128 v113, v[24:27] offset:30720
ds_write_b128 v113, v[28:31] offset:31744
s_waitcnt lgkmcnt(0)
main_kernel_c_nb:
v_readfirstlane_b32 s33, v84
v_readfirstlane_b32 s32, v85
s_nop 3
s_and_b32 s34, s32, s33
s_cbranch_scc1 main_kernel_c_nb_ok
buffer_load_dwordx2 v[84:85], off, s[60:63], 0 offset:16 sc1
s_sub_u32 s29, s29, 1
s_cbranch_scc1 main_kernel_end
s_waitcnt vmcnt(0)
s_branch main_kernel_c_nb
main_kernel_c_nb_ok:
s_and_b32 s33, s33, 1
s_lshl_b32 s33, s33, 13
s_add_u32 s52, s33, 0x8c10000
s_and_b32 s32, s32, 1
s_lshl_b32 s32, s32, 13
s_sub_u32 s53, s32, s33
s_add_u32 s53, s53, 65536
s_and_b32 s59, s25, 0x7fff
s_and_b32 s33, s59, 0x6000
s_add_u32 s59, s59, s33
s_and_b32 s54, s19, 0x7fff
s_and_b32 s33, s54, 0x6000
s_add_u32 s54, s54, s33
s_xor_b32 s34, s52, 0x2000
s_lshl_b32 s32, s14, 14
s_lshl_b32 s33, s13, 8
s_add_u32 s33, s33, s34
s_add_u32 s55, s32, s33
v_writelane_b32 v121, s55, 39
s_lshl_b32 s32, s12, 15
s_add_u32 s44, s32, s33
s_xor_b32 s32, s32, 0x8000
s_add_u32 s45, s32, s34
s_lshl_b32 s32, s12, 14
s_add_u32 s32, s32, 0x6c78000
s_lshl_b32 s33, s13, 3
s_add_u32 s46, s32, s33
s_andn2_b32 s32, s25, 0x3ff
s_add_u32 s32, s32, 0x80000
s_cmp_eq_u32 s14, 1
s_cselect_b32 s46, s32, s46
s_add_u32 s20, s20, 0xc0000
s_add_u32 s21, s21, 0xc0000
s_add_u32 s22, s22, 0xc0000
s_add_u32 s23, s23, 0xc0000
s_sub_u32 s3, s3, 0x40000
s_sub_u32 s37, s37, 65536
s_sub_u32 s26, s26, 65536
s_cmp_eq_u32 s14, 3
s_cselect_b32 s39, 0, s39
s_mov_b32 s15, 0
s_mov_b32 s16, 0
s_cselect_b32 s27, 0, s27
s_mov_b32 s17, -1
s_memrealtime s[32:33]
s_memtime s[40:41]
s_waitcnt lgkmcnt(0)
s_mul_i32 s32, s32, 22
s_sub_u32 s11, s40, s32
s_sub_u32 s31, s32, 0x20000
s_sub_u32 s43, s31, 0x20000
s_min_u32 s32, s48, s49
s_cmp_ge_u32 s32, 32
s_waitcnt vmcnt(0)
s_cselect_b32 s32, 0, 4
s_add_u32 s32, s32, s14
s_cmp_eq_u32 s32, 1
s_cbranch_scc1 main_kernel_c1_top
s_cmp_eq_u32 s32, 2
s_cbranch_scc1 main_kernel_c2_top
s_cmp_eq_u32 s32, 3
s_cbranch_scc1 main_kernel_c3_top
s_cmp_eq_u32 s32, 4
s_cbranch_scc1 main_kernel_c4_top
s_cmp_eq_u32 s32, 5
s_cbranch_scc1 main_kernel_c5_top
s_cmp_eq_u32 s32, 6
s_cbranch_scc1 main_kernel_c6_top
s_cmp_eq_u32 s32, 7
s_cbranch_scc1 main_kernel_c7_top
s_branch main_kernel_c0_top
.p2align 6
main_kernel_c0_top:
s_barrier
buffer_load_dwordx4 v[0:3], v116, s[4:7], s18 offen sc1
s_add_u32 s20, s20, 0x40000
s_bitset0_b32 s20, 20
s_add_u32 s21, s21, 0x40000
s_bitset0_b32 s21, 20
s_add_u32 s22, s22, 0x40000
s_bitset0_b32 s22, 20
s_add_u32 s23, s23, 0x40000
s_bitset0_b32 s23, 20
s_xor_b32 s32, s18, 1024
buffer_load_dwordx4 v[16:19], v116, s[4:7], s32 offen sc1
s_add_u32 s3, s3, 0x40000
s_bitset0_b32 s3, 20
s_add_u32 s17, s17, 1
s_bitcmp1_b32 0x77777777, s17
s_cselect_b32 s33, 0x800, 0
s_xor_b32 s54, s54, s33
s_xor_b32 s59, s59, s33
s_add_u32 s25, s52, s59
s_nop 0
buffer_load_dwordx4 v[64:67], v116, s[4:7], s19 offen sc1
v_mov_b32 v80, 0
v_mov_b32 v81, 0
s_nop 3
s_xor_b32 s32, s19, 1024
buffer_load_dwordx4 v[68:71], v116, s[4:7], s32 offen sc1
v_mov_b32 v82, 0
v_mov_b32 v83, 0
s_nop 3
s_xor_b32 s32, s18, 2048
buffer_load_dwordx4 v[32:35], v116, s[4:7], s32 offen sc1
v_mov_b32 v84, 0
v_mov_b32 v85, 0
s_nop 3
s_xor_b32 s32, s19, 2048
buffer_load_dwordx4 v[72:75], v116, s[4:7], s32 offen sc1
v_mov_b32 v86, 0
v_mov_b32 v87, 0
s_nop 3
s_xor_b32 s32, s18, 3072
buffer_load_dwordx4 v[48:51], v116, s[4:7], s32 offen sc1
v_mov_b32 v88, 0
v_mov_b32 v89, 0
s_nop 3
s_xor_b32 s32, s19, 3072
buffer_load_dwordx4 v[76:79], v116, s[4:7], s32 offen sc1
v_mov_b32 v90, 0
v_mov_b32 v91, 0
s_waitcnt vmcnt(5)
v_pk_add_f16 v0, v0, v64
v_pk_add_f16 v1, v1, v65
v_pk_add_f16 v2, v2, v66
v_pk_add_f16 v3, v3, v67
v_cmp_u_f16 vcc, v0, v2
s_cbranch_vccnz main_kernel_c0_m0_f
main_kernel_c0_m0:
v_smfmac_f32_16x16x64_f16 v[80:83], v[0:3], a[0:7], v112
ds_write_b128 v116, v[0:3] offset:0
v_smfmac_f32_16x16x64_f16 v[84:87], v[0:3], a[128:135], v112
buffer_load_dword v123, v121, s[4:7], 0 offen sc1
s_waitcnt vmcnt(5)
v_pk_add_f16 v16, v16, v68
v_pk_add_f16 v17, v17, v69
v_pk_add_f16 v18, v18, v70
v_pk_add_f16 v19, v19, v71
v_cmp_u_f16 vcc, v16, v18
s_waitcnt lgkmcnt(0)
s_barrier
ds_read_b128 v[4:7], v116 offset:1024
ds_write_b128 v116, v[16:19] offset:4096
s_cbranch_vccnz main_kernel_c0_m1_f
main_kernel_c0_m1:
v_smfmac_f32_16x16x64_f16 v[80:83], v[16:19], a[8:15], v112
v_smfmac_f32_16x16x64_f16 v[84:87], v[16:19], a[136:143], v112
ds_read_b128 v[8:11], v116 offset:2048
v_smfmac_f32_16x16x64_f16 v[88:91], v[0:3], v[128:135], v112
ds_read_b128 v[12:15], v116 offset:3072
s_waitcnt lgkmcnt(3)
v_smfmac_f32_16x16x64_f16 v[80:83], v[4:7], a[32:39], v112
v_smfmac_f32_16x16x64_f16 v[84:87], v[4:7], a[160:167], v112
v_smfmac_f32_16x16x64_f16 v[88:91], v[4:7], v[136:143], v112
s_waitcnt lgkmcnt(2)
s_barrier
s_waitcnt lgkmcnt(1)
v_smfmac_f32_16x16x64_f16 v[80:83], v[8:11], a[64:71], v112
s_waitcnt vmcnt(3)
ds_read_b128 v[20:23], v116 offset:5120
v_pk_add_f16 v32, v32, v72
v_smfmac_f32_16x16x64_f16 v[84:87], v[8:11], a[192:199], v112
ds_read_b128 v[24:27], v116 offset:6144
s_waitcnt lgkmcnt(2)
v_pk_add_f16 v33, v33, v73
v_smfmac_f32_16x16x64_f16 v[80:83], v[12:15], a[96:103], v112
ds_read_b128 v[28:31], v116 offset:7168
v_pk_add_f16 v34, v34, v74
v_smfmac_f32_16x16x64_f16 v[84:87], v[12:15], a[224:231], v112
s_waitcnt lgkmcnt(2)
v_pk_add_f16 v35, v35, v75
v_smfmac_f32_16x16x64_f16 v[80:83], v[20:23], a[40:47], v112
ds_write_b128 v116, v[32:35] offset:8192
v_cmp_u_f16 vcc, v32, v34
v_smfmac_f32_16x16x64_f16 v[84:87], v[20:23], a[168:175], v112
s_cbranch_vccnz main_kernel_c0_m2_f
main_kernel_c0_m2:
v_smfmac_f32_16x16x64_f16 v[80:83], v[32:35], a[16:23], v112
buffer_load_dwordx4 v[96:99], v116, s[4:7], s28 offen sc1
v_smfmac_f32_16x16x64_f16 v[84:87], v[32:35], a[144:151], v112
s_add_u32 s28, s28, 0x40000
s_waitcnt lgkmcnt(2)
v_smfmac_f32_16x16x64_f16 v[80:83], v[24:27], a[72:79], v112
s_waitcnt vmcnt(2)
v_pk_add_f16 v48, v48, v76
v_smfmac_f32_16x16x64_f16 v[84:87], v[24:27], a[200:207], v112
s_waitcnt lgkmcnt(0)
s_barrier
ds_read_b128 v[36:39], v116 offset:9216
v_pk_add_f16 v49, v49, v77
v_smfmac_f32_16x16x64_f16 v[80:83], v[28:31], a[104:111], v112
ds_read_b128 v[40:43], v116 offset:10240
v_pk_add_f16 v50, v50, v78
v_smfmac_f32_16x16x64_f16 v[84:87], v[28:31], a[232:239], v112
ds_read_b128 v[44:47], v116 offset:11264
v_pk_add_f16 v51, v51, v79
v_smfmac_f32_16x16x64_f16 v[88:91], v[8:11], v[144:151], v112
ds_write_b128 v116, v[48:51] offset:12288
s_waitcnt lgkmcnt(3)
v_cmp_u_f16 vcc, v48, v50
v_smfmac_f32_16x16x64_f16 v[80:83], v[36:39], a[48:55], v112
s_cbranch_vccnz main_kernel_c0_m3_f
main_kernel_c0_m3:
v_smfmac_f32_16x16x64_f16 v[80:83], v[48:51], a[24:31], v112
v_smfmac_f32_16x16x64_f16 v[84:87], v[48:51], a[152:159], v112
v_smfmac_f32_16x16x64_f16 v[84:87], v[36:39], a[176:183], v112
s_waitcnt lgkmcnt(2)
v_smfmac_f32_16x16x64_f16 v[80:83], v[40:43], a[80:87], v112
s_waitcnt lgkmcnt(0)
s_barrier
ds_read_b128 v[52:55], v116 offset:13312
v_smfmac_f32_16x16x64_f16 v[84:87], v[40:43], a[208:215], v112
s_add_u32 s19, s52, s54
ds_read_b128 v[56:59], v116 offset:14336
v_smfmac_f32_16x16x64_f16 v[80:83], v[44:47], a[112:119], v112
s_add_u32 s18, s18, 0x40000
ds_read_b128 v[60:63], v116 offset:15360
v_smfmac_f32_16x16x64_f16 v[84:87], v[44:47], a[240:247], v112
s_bitset0_b32 s18, 20
s_waitcnt lgkmcnt(2)
v_smfmac_f32_16x16x64_f16 v[80:83], v[52:55], a[56:63], v112
s_cmp_eq_u32 s17, 30
s_cselect_b32 s32, s53, 0x10000
s_waitcnt lgkmcnt(1)
v_smfmac_f32_16x16x64_f16 v[80:83], v[56:59], a[88:95], v112
s_add_u32 s52, s52, s32
s_waitcnt lgkmcnt(0)
v_smfmac_f32_16x16x64_f16 v[80:83], v[60:63], a[120:127], v112
s_sub_u32 s24, 0x20000, s32
ds_read_b128 v[64:67], v116 offset:24576
v_smfmac_f32_16x16x64_f16 v[84:87], v[52:55], a[184:191], v112
s_add_u32 s55, s55, s24
ds_read_b128 v[68:71], v116 offset:28672
v_smfmac_f32_16x16x64_f16 v[84:87], v[56:59], a[216:223], v112
ds_read_b128 v[72:75], v116 offset:25600
s_nop 0
v_cvt_pk_bf16_f32 v92, v80, v81
v_smfmac_f32_16x16x64_f16 v[84:87], v[60:63], a[248:255], v112
ds_read_b128 v[76:79], v116 offset:29696
s_nop 0
v_cvt_pk_bf16_f32 v93, v82, v83
v_smfmac_f32_16x16x64_f16 v[88:91], v[12:15], v[152:159], v112
s_nop 3
v_cvt_pk_bf16_f32 v94, v84, v85
v_cvt_pk_bf16_f32 v95, v86, v87
s_mov_b32 vcc_lo, 0xcccccccc
s_mov_b32 vcc_hi, 0xcccccccc
v_mfma_f32_16x16x32_bf16 v[84:87], v[92:95], v[104:107], 0
v_add_u32 v121, v121, v122
v_writelane_b32 v121, s55, 39
s_nop 0
v_smfmac_f32_16x16x64_f16 v[88:91], v[16:19], v[160:167], v112
s_nop 2
s_cmp_eq_u32 s17, 63
v_cvt_pk_bf16_f32 v114, v84, v85
v_cvt_pk_bf16_f32 v115, v86, v87
buffer_store_dwordx2 v[114:115], v117, s[4:7], s21 offen
s_cbranch_scc1 main_kernel_c0_last
ds_write_b64 v117, v[114:115] offset:16384
v_smfmac_f32_16x16x64_f16 v[88:91], v[20:23], v[168:175], v112
v_smfmac_f32_16x16x64_f16 v[88:91], v[24:27], v[176:183], v112
v_smfmac_f32_16x16x64_f16 v[88:91], v[28:31], v[184:191], v112
v_smfmac_f32_16x16x64_f16 v[88:91], v[32:35], v[192:199], v112
s_waitcnt lgkmcnt(0)
s_barrier
ds_read_b128 v[0:3], v116 offset:16384
v_smfmac_f32_16x16x64_f16 v[88:91], v[36:39], v[200:207], v112
ds_read_b128 v[4:7], v116 offset:17408
v_smfmac_f32_16x16x64_f16 v[88:91], v[40:43], v[208:215], v112
ds_read_b128 v[16:19], v116 offset:26624
v_smfmac_f32_16x16x64_f16 v[88:91], v[44:47], v[216:223], v112
ds_read_b128 v[20:23], v116 offset:30720
v_smfmac_f32_16x16x64_f16 v[88:91], v[48:51], v[224:231], v112
ds_read_b128 v[24:27], v116 offset:27648
v_smfmac_f32_16x16x64_f16 v[88:91], v[52:55], v[232:239], v112
ds_read_b128 v[28:31], v116 offset:31744
v_smfmac_f32_16x16x64_f16 v[88:91], v[56:59], v[240:247], v112
v_smfmac_f32_16x16x64_f16 v[88:91], v[60:63], v[248:255], v112
s_waitcnt lgkmcnt(5)
v_mfma_f32_16x16x32_bf16 v[80:83], v[64:67], v[0:3], 0
v_mfma_f32_16x16x32_bf16 v[84:87], v[68:71], v[0:3], 0
buffer_load_dwordx4 v[8:11], v116, s[4:7], s20 offen offset:0 sc1
v_mfma_f32_16x16x32_bf16 v[92:95], v[0:3], v[0:3], 0
buffer_load_dwordx4 v[12:15], v116, s[4:7], s20 offen offset:1024 sc1
v_permlane32_swap_b32 v88, v90
s_waitcnt lgkmcnt(4)
v_mfma_f32_16x16x32_bf16 v[80:83], v[72:75], v[4:7], v[80:83]
v_permlane32_swap_b32 v89, v91
v_mfma_f32_16x16x32_bf16 v[84:87], v[76:79], v[4:7], v[84:87]
v_pk_add_f32 v[88:89], v[88:89], v[90:91]
v_mfma_f32_16x16x32_bf16 v[92:95], v[4:7], v[4:7], v[92:95]
v_cvt_pk_bf16_f32 v124, v88, v89
v_mov_b32 v65, 0
s_waitcnt lgkmcnt(0)
s_waitcnt vmcnt(1)
v_mfma_f32_16x16x32_bf16 v[88:91], v[8:11], v[8:11], v[92:95]
v_mfma_f32_16x16x32_bf16 v[0:3], v[16:19], v[8:11], v[80:83]
v_cmp_u_f32 s[0:1], v8, v10
v_mfma_f32_16x16x32_bf16 v[4:7], v[20:23], v[8:11], v[84:87]
s_waitcnt vmcnt(0)
v_mfma_f32_16x16x32_bf16 v[88:91], v[12:15], v[12:15], v[88:91]
v_mfma_f32_16x16x32_bf16 v[0:3], v[24:27], v[12:15], v[0:3]
v_cmp_u_f32 s[32:33], v12, v14
v_mfma_f32_16x16x32_bf16 v[4:7], v[28:31], v[12:15], v[4:7]
s_or_b64 s[0:1], s[0:1], s[32:33]
s_cbranch_scc1 main_kernel_c0_z_f
main_kernel_c0_z:
v_mul_f32 v88, s30, v88
v_mul_f32 v89, s30, v89
v_exp_f32 v88, v88
v_exp_f32 v89, v89
v_cndmask_b32_dpp v0, v2, v0, vcc quad_perm:[2,3,2,3] row_mask:0xf bank_mask:0xf
v_cvt_pk_bf16_f32 v64, v88, v89
v_cndmask_b32_dpp v1, v3, v1, vcc quad_perm:[2,3,2,3] row_mask:0xf bank_mask:0xf
v_exp_f32 v0, v0
v_mfma_f32_16x16x16_bf16 v[16:19], v[100:101], v[64:65], 0
v_exp_f32 v1, v1
v_cndmask_b32_dpp v4, v6, v4, vcc quad_perm:[2,3,2,3] row_mask:0xf bank_mask:0xf
v_mfma_f32_16x16x16_bf16 v[8:11], v[124:125], v[64:65], 0
v_cndmask_b32_dpp v5, v7, v5, vcc quad_perm:[2,3,2,3] row_mask:0xf bank_mask:0xf
v_exp_f32 v4, v4
v_exp_f32 v5, v5
v_cvt_pk_bf16_f32 v92, v0, v1
v_cvt_pk_bf16_f32 v94, v4, v5
v_mov_b32 v80, 0
v_mov_b32_dpp v93, v92 quad_perm:[0,1,0,1] row_mask:0xf bank_mask:0xf
v_mov_b32_dpp v95, v94 quad_perm:[0,1,0,1] row_mask:0xf bank_mask:0xf
v_mov_b32 v81, 0
v_mov_b32 v82, 0
v_mfma_f32_16x16x32_bf16 v[16:19], v[100:103], v[92:95], v[16:19]
v_mov_b32 v83, 0
v_mov_b32 v84, 0
v_mfma_f32_16x16x32_bf16 v[8:11], v[96:99], v[92:95], v[8:11]
s_nop 1
v_mov_b32 v85, 0
v_mov_b32 v86, 0
v_mov_b32 v87, 0
v_rcp_f32 v126, v16
v_subrev_u32 v127, 0x21800000, v16
v_cmp_lt_u32 vcc, 0x3c000000, v127
v_pk_mul_f32 v[8:9], v[8:9], v[126:127] op_sel_hi:[1,0]
v_pk_mul_f32 v[10:11], v[10:11], v[126:127] op_sel_hi:[1,0]
s_and_b32 s32, vcc_lo, 0xcccc
v_cvt_pk_bf16_f32 v126, v8, v9
v_cvt_pk_bf16_f32 v127, v10, v11
s_cbranch_scc1 main_kernel_c0_sm_f
main_kernel_c0_ost:
buffer_store_dwordx2 v[126:127], v118, s[4:7], s22 offen
v_cmp_eq_u32 s[0:1], 0, v123
v_mov_b32 v24, -1
v_mov_b32 v25, -1
v_mov_b32 v26, -1
v_mov_b32 v27, -1
ds_read_b128 v[32:35], v113 offset:0
ds_read_b128 v[36:39], v113 offset:1024
ds_read_b128 v[40:43], v113 offset:2048
ds_read_b128 v[44:47], v113 offset:3072
ds_read_b128 v[48:51], v113 offset:4096
ds_read_b128 v[52:55], v113 offset:5120
s_and_b32 s10, s1, 0x3f00
buffer_store_dwordx4 v[24:27], v116, s[4:7], s3 offen
s_barrier
buffer_load_dwordx4 v[0:3], v116, s[4:7], s23 offen sc1
ds_read_b128 v[56:59], v113 offset:6144
ds_read_b128 v[60:63], v113 offset:7168
s_add_u32 s37, s37, 65536
s_add_u32 s26, s26, 65536
s_nop 1
s_xor_b32 s32, s23, 1024
buffer_load_dwordx4 v[4:7], v116, s[4:7], s32 offen sc1
ds_read_b128 v[64:67], v113 offset:8192
ds_read_b128 v[68:71], v113 offset:9216
s_nop 3
s_xor_b32 s32, s23, 2048
buffer_load_dwordx4 v[8:11], v116, s[4:7], s32 offen sc1
ds_read_b128 v[72:75], v113 offset:10240
ds_read_b128 v[76:79], v113 offset:11264
s_nop 3
s_xor_b32 s32, s23, 3072
buffer_load_dwordx4 v[12:15], v116, s[4:7], s32 offen sc1
ds_read_b128 v[88:91], v113 offset:12288
ds_read_b128 v[92:95], v113 offset:13312
s_nop 3
s_xor_b32 s32, s23, 4096
buffer_load_dwordx4 v[16:19], v116, s[4:7], s32 offen sc1
s_nop 7
s_xor_b32 s32, s23, 5120
buffer_load_dwordx4 v[20:23], v116, s[4:7], s32 offen sc1
s_nop 7
s_xor_b32 s32, s23, 6144
buffer_load_dwordx4 v[24:27], v116, s[4:7], s32 offen sc1
s_nop 7
s_xor_b32 s32, s23, 7168
buffer_load_dwordx4 v[28:31], v116, s[4:7], s32 offen sc1
s_waitcnt lgkmcnt(12)
s_waitcnt vmcnt(7)
v_cmp_u_f32 vcc, v0, v2
s_cbranch_vccnz main_kernel_c0_o0_f
main_kernel_c0_o0:
v_smfmac_f32_16x16x64_bf16 v[80:83], v[0:3], v[32:39], v112
ds_read_b128 v[32:35], v113 offset:14336
ds_read_b128 v[36:39], v113 offset:15360
s_waitcnt lgkmcnt(12)
s_waitcnt vmcnt(6)
v_cmp_u_f32 vcc, v4, v6
v_smfmac_f32_16x16x64_bf16 v[84:87], v[0:3], v[40:47], v112
ds_read_b128 v[40:43], v113 offset:16384
ds_read_b128 v[44:47], v113 offset:17408
buffer_store_dwordx2 v[114:115], v119, s[4:7], s37 offen sc1
s_cbranch_vccnz main_kernel_c0_o1_f
main_kernel_c0_o1:
s_waitcnt lgkmcnt(12)
v_smfmac_f32_16x16x64_bf16 v[80:83], v[4:7], v[48:55], v112
ds_read_b128 v[48:51], v113 offset:18432
ds_read_b128 v[52:55], v113 offset:19456
s_waitcnt lgkmcnt(12)
s_waitcnt vmcnt(6)
v_cmp_u_f32 vcc, v8, v10
v_smfmac_f32_16x16x64_bf16 v[84:87], v[4:7], v[56:63], v112
ds_read_b128 v[56:59], v113 offset:20480
ds_read_b128 v[60:63], v113 offset:21504
buffer_store_dword v124, v120, s[4:7], s26 offen sc1
s_cbranch_vccnz main_kernel_c0_o2_f
main_kernel_c0_o2:
s_waitcnt lgkmcnt(12)
v_smfmac_f32_16x16x64_bf16 v[80:83], v[8:11], v[64:71], v112
ds_read_b128 v[64:67], v113 offset:22528
ds_read_b128 v[68:71], v113 offset:23552
s_waitcnt lgkmcnt(12)
s_waitcnt vmcnt(6)
v_cmp_u_f32 vcc, v12, v14
v_smfmac_f32_16x16x64_bf16 v[84:87], v[8:11], v[72:79], v112
ds_read_b128 v[72:75], v113 offset:24576
ds_read_b128 v[76:79], v113 offset:25600
s_cbranch_vccnz main_kernel_c0_o3_f
main_kernel_c0_o3:
s_waitcnt lgkmcnt(12)
v_smfmac_f32_16x16x64_bf16 v[80:83], v[12:15], v[88:95], v112
ds_read_b128 v[88:91], v113 offset:26624
ds_read_b128 v[92:95], v113 offset:27648
s_waitcnt lgkmcnt(12)
s_waitcnt vmcnt(5)
v_cmp_u_f32 vcc, v16, v18
v_smfmac_f32_16x16x64_bf16 v[84:87], v[12:15], v[32:39], v112
ds_read_b128 v[32:35], v113 offset:28672
ds_read_b128 v[36:39], v113 offset:29696
s_cbranch_vccnz main_kernel_c0_o4_f
main_kernel_c0_o4:
s_waitcnt lgkmcnt(12)
v_smfmac_f32_16x16x64_bf16 v[80:83], v[16:19], v[40:47], v112
ds_read_b128 v[40:43], v113 offset:30720
ds_read_b128 v[44:47], v113 offset:31744
s_waitcnt lgkmcnt(12)
s_waitcnt vmcnt(4)
v_cmp_u_f32 vcc, v20, v22
v_smfmac_f32_16x16x64_bf16 v[84:87], v[16:19], v[48:55], v112
s_cbranch_vccnz main_kernel_c0_o5_f
main_kernel_c0_o5:
s_waitcnt lgkmcnt(10)
v_smfmac_f32_16x16x64_bf16 v[80:83], v[20:23], v[56:63], v112
s_waitcnt lgkmcnt(8)
s_waitcnt vmcnt(3)
v_cmp_u_f32 vcc, v24, v26
v_smfmac_f32_16x16x64_bf16 v[84:87], v[20:23], v[64:71], v112
s_cbranch_vccnz main_kernel_c0_o6_f
main_kernel_c0_o6:
s_waitcnt lgkmcnt(6)
v_smfmac_f32_16x16x64_bf16 v[80:83], v[24:27], v[72:79], v112
s_waitcnt lgkmcnt(4)
v_smfmac_f32_16x16x64_bf16 v[84:87], v[24:27], v[88:95], v112
s_waitcnt lgkmcnt(2)
s_waitcnt vmcnt(2)
v_cmp_u_f32 vcc, v28, v30
s_cbranch_vccnz main_kernel_c0_o7_f
main_kernel_c0_o7:
v_smfmac_f32_16x16x64_bf16 v[80:83], v[28:31], v[32:39], v112
s_waitcnt lgkmcnt(0)
v_smfmac_f32_16x16x64_bf16 v[84:87], v[28:31], v[40:47], v112
s_nop 4
v_cvt_pk_bf16_f32 v80, v80, v81
v_cvt_pk_bf16_f32 v81, v82, v83
ds_write_b64 v116, v[80:81] offset:20480
v_cvt_pk_bf16_f32 v82, v84, v85
v_cvt_pk_bf16_f32 v83, v86, v87
ds_write_b64 v116, v[82:83] offset:22528
s_waitcnt lgkmcnt(0)
s_barrier
ds_read_b128 v[72:75], v116 offset:20480
ds_read_b128 v[76:79], v116 offset:21504
s_mov_b32 m0, 24576
s_cmp_lg_u32 s10, 0
s_waitcnt lgkmcnt(1)
v_mfma_f32_16x16x32_bf16 v[64:67], v[72:75], v[108:111], 0
s_waitcnt lgkmcnt(0)
v_mfma_f32_16x16x32_bf16 v[64:67], v[76:79], v[108:111], v[64:67]
s_nop 7
v_cvt_pk_f16_f32 v68, v64, v65
v_cvt_pk_f16_f32 v69, v66, v67
buffer_store_dwordx2 v[68:69], v125, s[4:7], s25 offen sc1
s_cbranch_scc1 main_kernel_c0_kvw
main_kernel_c0_kvok:
s_nop 3
buffer_load_dwordx4 v116, s[4:7], s27 offen sc1 lds
buffer_load_dwordx4 v116, s[4:7], s27 offen offset:1024 sc1 lds
s_add_u32 s27, s27, 0x40000
s_branch main_kernel_c0_top
main_kernel_c0_kvw:
s_mov_b32 exec_lo, 0
s_mov_b32 exec_hi, 0x3f00
v_subrev_u32 v127, 128, v121
main_kernel_c0_kvp:
buffer_load_dword v126, v127, s[4:7], 0 offen sc1
s_waitcnt vmcnt(0)
v_cmp_eq_u32 vcc, 0, v126
s_cbranch_vccz main_kernel_c0_kvp_ok
s_sleep 2
s_sub_u32 s29, s29, 1
s_cbranch_scc0 main_kernel_c0_kvp
s_branch main_kernel_end
main_kernel_c0_kvp_ok:
s_mov_b64 exec, -1
s_branch main_kernel_c0_kvok
main_kernel_c0_last:
s_add_u32 s37, s37, 65536
s_add_u32 s26, s26, 65536
buffer_store_dwordx2 v[114:115], v119, s[4:7], s37 offen sc1
v_smfmac_f32_16x16x64_f16 v[88:91], v[20:23], v[168:175], v112
v_smfmac_f32_16x16x64_f16 v[88:91], v[24:27], v[176:183], v112
v_smfmac_f32_16x16x64_f16 v[88:91], v[28:31], v[184:191], v112
v_smfmac_f32_16x16x64_f16 v[88:91], v[32:35], v[192:199], v112
v_smfmac_f32_16x16x64_f16 v[88:91], v[36:39], v[200:207], v112
v_smfmac_f32_16x16x64_f16 v[88:91], v[40:43], v[208:215], v112
v_smfmac_f32_16x16x64_f16 v[88:91], v[44:47], v[216:223], v112
v_smfmac_f32_16x16x64_f16 v[88:91], v[48:51], v[224:231], v112
v_smfmac_f32_16x16x64_f16 v[88:91], v[52:55], v[232:239], v112
v_smfmac_f32_16x16x64_f16 v[88:91], v[56:59], v[240:247], v112
v_smfmac_f32_16x16x64_f16 v[88:91], v[60:63], v[248:255], v112
s_nop 7
v_permlane32_swap_b32 v88, v90
s_nop 1
v_permlane32_swap_b32 v89, v91
s_nop 1
v_pk_add_f32 v[88:89], v[88:89], v[90:91]
s_nop 1
v_cvt_pk_bf16_f32 v124, v88, v89
s_nop 1
buffer_store_dword v124, v120, s[4:7], s26 offen sc1
s_branch main_kernel_end
main_kernel_c0_m0_f:
s_waitcnt lgkmcnt(0)
buffer_load_dwordx4 v[0:3], v116, s[4:7], s18 offen sc1
buffer_load_dwordx4 v[64:67], v116, s[4:7], s19 offen sc1
s_xor_b32 s32, s18, 1024
buffer_load_dwordx4 v[16:19], v116, s[4:7], s32 offen sc1
s_xor_b32 s32, s19, 1024
buffer_load_dwordx4 v[68:71], v116, s[4:7], s32 offen sc1
s_xor_b32 s32, s18, 2048
buffer_load_dwordx4 v[32:35], v116, s[4:7], s32 offen sc1
s_xor_b32 s32, s19, 2048
buffer_load_dwordx4 v[72:75], v116, s[4:7], s32 offen sc1
s_xor_b32 s32, s18, 3072
buffer_load_dwordx4 v[48:51], v116, s[4:7], s32 offen sc1
s_xor_b32 s32, s19, 3072
buffer_load_dwordx4 v[76:79], v116, s[4:7], s32 offen sc1
s_sub_u32 s29, s29, 1
s_cbranch_scc1 main_kernel_end
s_waitcnt vmcnt(0)
v_max_u32 v126, v0, v2
v_max3_u32 v126, v126, v64, v66
v_cmp_eq_u32 vcc, -1, v126
s_cbranch_vccnz main_kernel_c0_m0_f
v_pk_add_f16 v0, v0, v64
v_pk_add_f16 v1, v1, v65
v_pk_add_f16 v2, v2, v66
v_pk_add_f16 v3, v3, v67
s_nop 0
s_branch main_kernel_c0_m0
main_kernel_c0_m1_f:
s_waitcnt lgkmcnt(0)
s_xor_b32 s32, s18, 1024
buffer_load_dwordx4 v[16:19], v116, s[4:7], s32 offen sc1
s_xor_b32 s32, s19, 1024
buffer_load_dwordx4 v[68:71], v116, s[4:7], s32 offen sc1
s_xor_b32 s32, s18, 2048
buffer_load_dwordx4 v[32:35], v116, s[4:7], s32 offen sc1
s_xor_b32 s32, s19, 2048
buffer_load_dwordx4 v[72:75], v116, s[4:7], s32 offen sc1
s_xor_b32 s32, s18, 3072
buffer_load_dwordx4 v[48:51], v116, s[4:7], s32 offen sc1
s_xor_b32 s32, s19, 3072
buffer_load_dwordx4 v[76:79], v116, s[4:7], s32 offen sc1
s_sub_u32 s29, s29, 1
s_cbranch_scc1 main_kernel_end
s_waitcnt vmcnt(0)
v_max_u32 v126, v16, v18
v_max3_u32 v126, v126, v68, v70
v_cmp_eq_u32 vcc, -1, v126
s_cbranch_vccnz main_kernel_c0_m1_f
v_pk_add_f16 v16, v16, v68
v_pk_add_f16 v17, v17, v69
v_pk_add_f16 v18, v18, v70
v_pk_add_f16 v19, v19, v71
ds_write_b128 v116, v[16:19] offset:4096
s_branch main_kernel_c0_m1
main_kernel_c0_m2_f:
s_waitcnt lgkmcnt(0)
s_xor_b32 s32, s18, 2048
buffer_load_dwordx4 v[32:35], v116, s[4:7], s32 offen sc1
s_xor_b32 s32, s19, 2048
buffer_load_dwordx4 v[72:75], v116, s[4:7], s32 offen sc1
s_xor_b32 s32, s18, 3072
buffer_load_dwordx4 v[48:51], v116, s[4:7], s32 offen sc1
s_xor_b32 s32, s19, 3072
buffer_load_dwordx4 v[76:79], v116, s[4:7], s32 offen sc1
s_sub_u32 s29, s29, 1
s_cbranch_scc1 main_kernel_end
s_waitcnt vmcnt(0)
v_max_u32 v126, v32, v34
v_max3_u32 v126, v126, v72, v74
v_cmp_eq_u32 vcc, -1, v126
s_cbranch_vccnz main_kernel_c0_m2_f
v_pk_add_f16 v32, v32, v72
v_pk_add_f16 v33, v33, v73
v_pk_add_f16 v34, v34, v74
v_pk_add_f16 v35, v35, v75
ds_write_b128 v116, v[32:35] offset:8192
s_branch main_kernel_c0_m2
main_kernel_c0_m3_f:
s_waitcnt lgkmcnt(0)
s_xor_b32 s32, s18, 3072
buffer_load_dwordx4 v[48:51], v116, s[4:7], s32 offen sc1
s_xor_b32 s32, s19, 3072
buffer_load_dwordx4 v[76:79], v116, s[4:7], s32 offen sc1
s_sub_u32 s29, s29, 1
s_cbranch_scc1 main_kernel_end
s_waitcnt vmcnt(0)
v_max_u32 v126, v48, v50
v_max3_u32 v126, v126, v76, v78
v_cmp_eq_u32 vcc, -1, v126
s_cbranch_vccnz main_kernel_c0_m3_f
v_pk_add_f16 v48, v48, v76
v_pk_add_f16 v49, v49, v77
v_pk_add_f16 v50, v50, v78
v_pk_add_f16 v51, v51, v79
ds_write_b128 v116, v[48:51] offset:12288
s_branch main_kernel_c0_m3
main_kernel_c0_z_f:
buffer_load_dwordx4 v[8:11], v116, s[4:7], s20 offen offset:0 sc1
buffer_load_dwordx4 v[12:15], v116, s[4:7], s20 offen offset:1024 sc1
s_memtime s[32:33]
ds_read_b32 v126, v116 offset:18432
s_sub_u32 s34, s19, s54
s_xor_b32 s34, s34, 0x2000
s_lshl_b32 s35, s12, 15
s_add_u32 s34, s34, s35
s_lshl_b32 s35, s13, 8
s_add_u32 s35, s35, s34
s_add_u32 s34, s34, 0x4000
s_waitcnt lgkmcnt(0)
s_sub_u32 s32, s32, 450
v_sub_u32 v127, s32, v126
buffer_store_dword v127, off, s[4:7], s34
s_sub_u32 s29, s29, 1
s_cbranch_scc1 main_kernel_end
s_waitcnt vmcnt(1)
main_kernel_c0_z_g:
v_max_u32 v126, v8, v10
v_max3_u32 v126, v126, v12, v14
v_cmp_eq_u32 vcc, -1, v126
s_cbranch_vccnz main_kernel_c0_z_h
v_mfma_f32_16x16x32_bf16 v[88:91], v[8:11], v[8:11], v[92:95]
v_mfma_f32_16x16x32_bf16 v[0:3], v[16:19], v[8:11], v[80:83]
v_mfma_f32_16x16x32_bf16 v[4:7], v[20:23], v[8:11], v[84:87]
v_mfma_f32_16x16x32_bf16 v[88:91], v[12:15], v[12:15], v[88:91]
v_mfma_f32_16x16x32_bf16 v[0:3], v[24:27], v[12:15], v[0:3]
v_mfma_f32_16x16x32_bf16 v[4:7], v[28:31], v[12:15], v[4:7]
buffer_store_dword v127, off, s[4:7], s35 offset:132 sc1
s_mov_b32 vcc_lo, 0xcccccccc
s_mov_b32 vcc_hi, 0xcccccccc
s_branch main_kernel_c0_z
main_kernel_c0_z_h:
buffer_load_dwordx4 v[8:11], v116, s[4:7], s20 offen offset:0 sc1
buffer_load_dwordx4 v[12:15], v116, s[4:7], s20 offen offset:1024 sc1
s_sub_u32 s29, s29, 1
s_cbranch_scc1 main_kernel_end
v_add_u32 v127, 300, v127
s_waitcnt vmcnt(0)
s_branch main_kernel_c0_z_g
main_kernel_c0_sm_f:
s_waitcnt vmcnt(0) lgkmcnt(0)
buffer_load_dwordx4 v[8:11], v116, s[4:7], s20 offen offset:0 sc1
buffer_load_dwordx4 v[12:15], v116, s[4:7], s20 offen offset:1024 sc1
ds_read_b128 v[0:3], v116 offset:16384
ds_read_b128 v[4:7], v116 offset:17408
ds_read_b128 v[64:67], v116 offset:24576
ds_read_b128 v[68:71], v116 offset:28672
ds_read_b128 v[72:75], v116 offset:25600
ds_read_b128 v[76:79], v116 offset:29696
ds_read_b128 v[16:19], v116 offset:26624
ds_read_b128 v[20:23], v116 offset:30720
ds_read_b128 v[24:27], v116 offset:27648
ds_read_b128 v[28:31], v116 offset:31744
s_waitcnt vmcnt(0)
s_waitcnt lgkmcnt(0)
v_mfma_f32_16x16x32_bf16 v[80:83], v[64:67], v[0:3], 0
v_mfma_f32_16x16x32_bf16 v[84:87], v[68:71], v[0:3], 0
v_mfma_f32_16x16x32_bf16 v[92:95], v[0:3], v[0:3], 0
v_mfma_f32_16x16x32_bf16 v[80:83], v[72:75], v[4:7], v[80:83]
v_mfma_f32_16x16x32_bf16 v[84:87], v[76:79], v[4:7], v[84:87]
v_mfma_f32_16x16x32_bf16 v[92:95], v[4:7], v[4:7], v[92:95]
v_mfma_f32_16x16x32_bf16 v[0:3], v[16:19], v[8:11], v[80:83]
v_mfma_f32_16x16x32_bf16 v[4:7], v[20:23], v[8:11], v[84:87]
v_mfma_f32_16x16x32_bf16 v[88:91], v[8:11], v[8:11], v[92:95]
v_mfma_f32_16x16x32_bf16 v[0:3], v[24:27], v[12:15], v[0:3]
v_mfma_f32_16x16x32_bf16 v[4:7], v[28:31], v[12:15], v[4:7]
v_mfma_f32_16x16x32_bf16 v[88:91], v[12:15], v[12:15], v[88:91]
s_nop 7
v_mov_b32 v65, 0
v_max_f32 v126, v88, v89
v_mul_f32 v126, s30, v126
v_max3_f32 v126, v126, v0, v1
v_max3_f32 v126, v126, v2, v3
v_max3_f32 v126, v126, v4, v5
v_max3_f32 v126, v126, v6, v7
v_mov_b32 v127, v126
s_nop 1
v_permlane32_swap_b32 v126, v127
v_max_f32 v126, v126, v127
v_mov_b32 v127, v126
s_nop 1
v_permlane16_swap_b32 v126, v127
v_max_f32 v126, v126, v127
v_mul_f32 v127, 0x40faf233, v126
s_mov_b32 vcc_lo, 0xcccccccc
s_mov_b32 vcc_hi, 0xcccccccc
v_sub_f32 v0, v0, v126
v_sub_f32 v1, v1, v126
v_sub_f32 v2, v2, v126
v_sub_f32 v3, v3, v126
v_sub_f32 v4, v4, v126
v_sub_f32 v5, v5, v126
v_sub_f32 v6, v6, v126
v_sub_f32 v7, v7, v126
v_sub_f32 v88, v88, v127
v_sub_f32 v89, v89, v127
s_waitcnt lgkmcnt(0)
s_nop 0
v_mul_f32 v88, s30, v88
v_mul_f32 v89, s30, v89
v_exp_f32 v88, v88
v_exp_f32 v89, v89
v_cndmask_b32_dpp v0, v2, v0, vcc quad_perm:[2,3,2,3] row_mask:0xf bank_mask:0xf
v_cvt_pk_bf16_f32 v64, v88, v89
v_cndmask_b32_dpp v1, v3, v1, vcc quad_perm:[2,3,2,3] row_mask:0xf bank_mask:0xf
v_exp_f32 v0, v0
v_mfma_f32_16x16x16_bf16 v[16:19], v[100:101], v[64:65], 0
v_exp_f32 v1, v1
v_cndmask_b32_dpp v4, v6, v4, vcc quad_perm:[2,3,2,3] row_mask:0xf bank_mask:0xf
v_mfma_f32_16x16x16_bf16 v[8:11], v[124:125], v[64:65], 0
v_cndmask_b32_dpp v5, v7, v5, vcc quad_perm:[2,3,2,3] row_mask:0xf bank_mask:0xf
v_exp_f32 v4, v4
v_exp_f32 v5, v5
v_cvt_pk_bf16_f32 v92, v0, v1
v_cvt_pk_bf16_f32 v94, v4, v5
v_mov_b32 v80, 0
v_mov_b32_dpp v93, v92 quad_perm:[0,1,0,1] row_mask:0xf bank_mask:0xf
v_mov_b32_dpp v95, v94 quad_perm:[0,1,0,1] row_mask:0xf bank_mask:0xf
v_mov_b32 v81, 0
v_mov_b32 v82, 0
v_mfma_f32_16x16x32_bf16 v[16:19], v[100:103], v[92:95], v[16:19]
v_mov_b32 v83, 0
v_mov_b32 v84, 0
v_mfma_f32_16x16x32_bf16 v[8:11], v[96:99], v[92:95], v[8:11]
s_nop 1
v_mov_b32 v85, 0
v_mov_b32 v86, 0
v_mov_b32 v87, 0
v_rcp_f32 v126, v16
v_subrev_u32 v127, 0x21800000, v16
v_cmp_lt_u32 vcc, 0x3c000000, v127
v_pk_mul_f32 v[8:9], v[8:9], v[126:127] op_sel_hi:[1,0]
v_pk_mul_f32 v[10:11], v[10:11], v[126:127] op_sel_hi:[1,0]
s_and_b32 s32, vcc_lo, 0xcccc
v_cvt_pk_bf16_f32 v126, v8, v9
v_cvt_pk_bf16_f32 v127, v10, v11
s_branch main_kernel_c0_ost
main_kernel_c0_o0_f:
s_nop 0
buffer_load_dwordx4 v[0:3], v116, s[4:7], s23 offen sc1
s_xor_b32 s32, s23, 1024
buffer_load_dwordx4 v[4:7], v116, s[4:7], s32 offen sc1
s_sub_u32 s29, s29, 1
s_cbranch_scc1 main_kernel_end
s_waitcnt vmcnt(0)
v_max_u32 v126, v0, v2
v_cmp_eq_u32 vcc, -1, v126
s_cbranch_vccnz main_kernel_c0_o0_f
s_branch main_kernel_c0_o0
main_kernel_c0_o1_f:
s_nop 0
s_xor_b32 s32, s23, 1024
buffer_load_dwordx4 v[4:7], v116, s[4:7], s32 offen sc1
s_xor_b32 s32, s23, 2048
buffer_load_dwordx4 v[8:11], v116, s[4:7], s32 offen sc1
s_sub_u32 s29, s29, 1
s_cbranch_scc1 main_kernel_end
s_waitcnt vmcnt(0)
v_max_u32 v126, v4, v6
v_cmp_eq_u32 vcc, -1, v126
s_cbranch_vccnz main_kernel_c0_o1_f
s_branch main_kernel_c0_o1
main_kernel_c0_o2_f:
s_nop 0
s_xor_b32 s32, s23, 2048
buffer_load_dwordx4 v[8:11], v116, s[4:7], s32 offen sc1
s_xor_b32 s32, s23, 3072
buffer_load_dwordx4 v[12:15], v116, s[4:7], s32 offen sc1
s_sub_u32 s29, s29, 1
s_cbranch_scc1 main_kernel_end
s_waitcnt vmcnt(0)
v_max_u32 v126, v8, v10
v_cmp_eq_u32 vcc, -1, v126
s_cbranch_vccnz main_kernel_c0_o2_f
s_branch main_kernel_c0_o2
main_kernel_c0_o3_f:
s_nop 0
s_xor_b32 s32, s23, 3072
buffer_load_dwordx4 v[12:15], v116, s[4:7], s32 offen sc1
s_xor_b32 s32, s23, 4096
buffer_load_dwordx4 v[16:19], v116, s[4:7], s32 offen sc1
s_sub_u32 s29, s29, 1
s_cbranch_scc1 main_kernel_end
s_waitcnt vmcnt(0)
v_max_u32 v126, v12, v14
v_cmp_eq_u32 vcc, -1, v126
s_cbranch_vccnz main_kernel_c0_o3_f
s_branch main_kernel_c0_o3
main_kernel_c0_o4_f:
s_nop 0
s_xor_b32 s32, s23, 4096
buffer_load_dwordx4 v[16:19], v116, s[4:7], s32 offen sc1
s_xor_b32 s32, s23, 5120
buffer_load_dwordx4 v[20:23], v116, s[4:7], s32 offen sc1
s_sub_u32 s29, s29, 1
s_cbranch_scc1 main_kernel_end
s_waitcnt vmcnt(0)
v_max_u32 v126, v16, v18
v_cmp_eq_u32 vcc, -1, v126
s_cbranch_vccnz main_kernel_c0_o4_f
s_branch main_kernel_c0_o4
main_kernel_c0_o5_f:
s_nop 0
s_xor_b32 s32, s23, 5120
buffer_load_dwordx4 v[20:23], v116, s[4:7], s32 offen sc1
s_xor_b32 s32, s23, 6144
buffer_load_dwordx4 v[24:27], v116, s[4:7], s32 offen sc1
s_sub_u32 s29, s29, 1
s_cbranch_scc1 main_kernel_end
s_waitcnt vmcnt(0)
v_max_u32 v126, v20, v22
v_cmp_eq_u32 vcc, -1, v126
s_cbranch_vccnz main_kernel_c0_o5_f
s_branch main_kernel_c0_o5
main_kernel_c0_o6_f:
s_nop 0
s_xor_b32 s32, s23, 6144
buffer_load_dwordx4 v[24:27], v116, s[4:7], s32 offen sc1
s_xor_b32 s32, s23, 7168
buffer_load_dwordx4 v[28:31], v116, s[4:7], s32 offen sc1
s_sub_u32 s29, s29, 1
s_cbranch_scc1 main_kernel_end
s_waitcnt vmcnt(0)
v_max_u32 v126, v24, v26
v_cmp_eq_u32 vcc, -1, v126
s_cbranch_vccnz main_kernel_c0_o6_f
s_branch main_kernel_c0_o6
main_kernel_c0_o7_f:
s_nop 0
s_xor_b32 s32, s23, 7168
buffer_load_dwordx4 v[28:31], v116, s[4:7], s32 offen sc1
s_sub_u32 s29, s29, 1
s_cbranch_scc1 main_kernel_end
s_waitcnt vmcnt(0)
v_max_u32 v126, v28, v30
v_cmp_eq_u32 vcc, -1, v126
s_cbranch_vccnz main_kernel_c0_o7_f
s_branch main_kernel_c0_o7
.p2align 6
main_kernel_c1_top:
s_barrier
buffer_load_dwordx4 v[0:3], v116, s[4:7], s18 offen sc1
s_add_u32 s20, s20, 0x40000
s_bitset0_b32 s20, 20
s_add_u32 s21, s21, 0x40000
s_bitset0_b32 s21, 20
s_add_u32 s22, s22, 0x40000
s_bitset0_b32 s22, 20
s_add_u32 s23, s23, 0x40000
s_bitset0_b32 s23, 20
s_xor_b32 s32, s18, 1024
buffer_load_dwordx4 v[16:19], v116, s[4:7], s32 offen sc1
s_add_u32 s3, s3, 0x40000
s_bitset0_b32 s3, 20
s_add_u32 s17, s17, 1
s_bitcmp1_b32 0x77777777, s17
s_cselect_b32 s33, 0x800, 0
s_xor_b32 s54, s54, s33
s_xor_b32 s59, s59, s33
s_add_u32 s25, s52, s59
s_nop 0
buffer_load_dwordx4 v[64:67], v116, s[4:7], s19 offen sc1
v_mov_b32 v80, 0
v_mov_b32 v81, 0
s_nop 3
s_xor_b32 s32, s19, 1024
buffer_load_dwordx4 v[68:71], v116, s[4:7], s32 offen sc1
v_mov_b32 v82, 0
v_mov_b32 v83, 0
s_nop 3
s_xor_b32 s32, s18, 2048
buffer_load_dwordx4 v[32:35], v116, s[4:7], s32 offen sc1
v_mov_b32 v84, 0
v_mov_b32 v85, 0
s_nop 3
s_xor_b32 s32, s19, 2048
buffer_load_dwordx4 v[72:75], v116, s[4:7], s32 offen sc1
v_mov_b32 v86, 0
v_mov_b32 v87, 0
s_nop 3
s_xor_b32 s32, s18, 3072
buffer_load_dwordx4 v[48:51], v116, s[4:7], s32 offen sc1
v_mov_b32 v88, 0
v_mov_b32 v89, 0
s_nop 3
s_xor_b32 s32, s19, 3072
buffer_load_dwordx4 v[76:79], v116, s[4:7], s32 offen sc1
v_mov_b32 v90, 0
v_mov_b32 v91, 0
s_waitcnt vmcnt(5)
v_pk_add_f16 v0, v0, v64
v_pk_add_f16 v1, v1, v65
v_pk_add_f16 v2, v2, v66
v_pk_add_f16 v3, v3, v67
v_cmp_u_f16 vcc, v0, v2
s_cbranch_vccnz main_kernel_c1_m0_f
main_kernel_c1_m0:
v_smfmac_f32_16x16x64_f16 v[80:83], v[0:3], a[0:7], v112
ds_write_b128 v116, v[0:3] offset:1024
v_smfmac_f32_16x16x64_f16 v[84:87], v[0:3], a[128:135], v112
buffer_load_dword v123, v121, s[4:7], 0 offen sc1
s_waitcnt vmcnt(5)
v_pk_add_f16 v16, v16, v68
v_pk_add_f16 v17, v17, v69
v_pk_add_f16 v18, v18, v70
v_pk_add_f16 v19, v19, v71
v_cmp_u_f16 vcc, v16, v18
s_waitcnt lgkmcnt(0)
s_barrier
ds_read_b128 v[4:7], v116 offset:0
ds_write_b128 v116, v[16:19] offset:5120
s_cbranch_vccnz main_kernel_c1_m1_f
main_kernel_c1_m1:
v_smfmac_f32_16x16x64_f16 v[80:83], v[16:19], a[8:15], v112
v_smfmac_f32_16x16x64_f16 v[84:87], v[16:19], a[136:143], v112
ds_read_b128 v[8:11], v116 offset:3072
v_smfmac_f32_16x16x64_f16 v[88:91], v[0:3], v[128:135], v112
ds_read_b128 v[12:15], v116 offset:2048
s_waitcnt lgkmcnt(3)
v_smfmac_f32_16x16x64_f16 v[80:83], v[4:7], a[32:39], v112
v_smfmac_f32_16x16x64_f16 v[84:87], v[4:7], a[160:167], v112
v_smfmac_f32_16x16x64_f16 v[88:91], v[4:7], v[136:143], v112
s_waitcnt lgkmcnt(2)
s_barrier
s_waitcnt lgkmcnt(1)
v_smfmac_f32_16x16x64_f16 v[80:83], v[8:11], a[64:71], v112
s_waitcnt vmcnt(3)
ds_read_b128 v[20:23], v116 offset:4096
v_pk_add_f16 v32, v32, v72
v_smfmac_f32_16x16x64_f16 v[84:87], v[8:11], a[192:199], v112
ds_read_b128 v[24:27], v116 offset:7168
s_waitcnt lgkmcnt(2)
v_pk_add_f16 v33, v33, v73
v_smfmac_f32_16x16x64_f16 v[80:83], v[12:15], a[96:103], v112
ds_read_b128 v[28:31], v116 offset:6144
v_pk_add_f16 v34, v34, v74
v_smfmac_f32_16x16x64_f16 v[84:87], v[12:15], a[224:231], v112
s_waitcnt lgkmcnt(2)
v_pk_add_f16 v35, v35, v75
v_smfmac_f32_16x16x64_f16 v[80:83], v[20:23], a[40:47], v112
ds_write_b128 v116, v[32:35] offset:9216
v_cmp_u_f16 vcc, v32, v34
v_smfmac_f32_16x16x64_f16 v[84:87], v[20:23], a[168:175], v112
s_cbranch_vccnz main_kernel_c1_m2_f
main_kernel_c1_m2:
v_smfmac_f32_16x16x64_f16 v[80:83], v[32:35], a[16:23], v112
buffer_load_dwordx4 v[96:99], v116, s[4:7], s28 offen sc1
v_smfmac_f32_16x16x64_f16 v[84:87], v[32:35], a[144:151], v112
s_add_u32 s28, s28, 0x40000
s_waitcnt lgkmcnt(2)
v_smfmac_f32_16x16x64_f16 v[80:83], v[24:27], a[72:79], v112
s_waitcnt vmcnt(2)
v_pk_add_f16 v48, v48, v76
v_smfmac_f32_16x16x64_f16 v[84:87], v[24:27], a[200:207], v112
s_waitcnt lgkmcnt(0)
s_barrier
ds_read_b128 v[36:39], v116 offset:8192
v_pk_add_f16 v49, v49, v77
v_smfmac_f32_16x16x64_f16 v[80:83], v[28:31], a[104:111], v112
ds_read_b128 v[40:43], v116 offset:11264
v_pk_add_f16 v50, v50, v78
v_smfmac_f32_16x16x64_f16 v[84:87], v[28:31], a[232:239], v112
ds_read_b128 v[44:47], v116 offset:10240
v_pk_add_f16 v51, v51, v79
v_smfmac_f32_16x16x64_f16 v[88:91], v[8:11], v[144:151], v112
ds_write_b128 v116, v[48:51] offset:13312
s_waitcnt lgkmcnt(3)
v_cmp_u_f16 vcc, v48, v50
v_smfmac_f32_16x16x64_f16 v[80:83], v[36:39], a[48:55], v112
s_cbranch_vccnz main_kernel_c1_m3_f
main_kernel_c1_m3:
v_smfmac_f32_16x16x64_f16 v[80:83], v[48:51], a[24:31], v112
v_smfmac_f32_16x16x64_f16 v[84:87], v[48:51], a[152:159], v112
v_smfmac_f32_16x16x64_f16 v[84:87], v[36:39], a[176:183], v112
s_waitcnt lgkmcnt(2)
v_smfmac_f32_16x16x64_f16 v[80:83], v[40:43], a[80:87], v112
s_waitcnt lgkmcnt(0)
s_barrier
ds_read_b128 v[52:55], v116 offset:12288
v_smfmac_f32_16x16x64_f16 v[84:87], v[40:43], a[208:215], v112
s_add_u32 s19, s52, s54
ds_read_b128 v[56:59], v116 offset:15360
v_smfmac_f32_16x16x64_f16 v[80:83], v[44:47], a[112:119], v112
s_add_u32 s18, s18, 0x40000
ds_read_b128 v[60:63], v116 offset:14336
v_smfmac_f32_16x16x64_f16 v[84:87], v[44:47], a[240:247], v112
s_bitset0_b32 s18, 20
s_waitcnt lgkmcnt(2)
v_smfmac_f32_16x16x64_f16 v[80:83], v[52:55], a[56:63], v112
s_cmp_eq_u32 s17, 30
s_cselect_b32 s32, s53, 0x10000
s_waitcnt lgkmcnt(1)
v_smfmac_f32_16x16x64_f16 v[80:83], v[56:59], a[88:95], v112
s_add_u32 s52, s52, s32
s_waitcnt lgkmcnt(0)
v_smfmac_f32_16x16x64_f16 v[80:83], v[60:63], a[120:127], v112
s_sub_u32 s24, 0x20000, s32
ds_read_b128 v[64:67], v116 offset:24576
v_smfmac_f32_16x16x64_f16 v[84:87], v[52:55], a[184:191], v112
s_add_u32 s55, s55, s24
ds_read_b128 v[68:71], v116 offset:28672
v_smfmac_f32_16x16x64_f16 v[84:87], v[56:59], a[216:223], v112
ds_read_b128 v[72:75], v116 offset:25600
s_nop 0
v_cvt_pk_bf16_f32 v92, v80, v81
v_smfmac_f32_16x16x64_f16 v[84:87], v[60:63], a[248:255], v112
ds_read_b128 v[76:79], v116 offset:29696
s_nop 0
v_cvt_pk_bf16_f32 v93, v82, v83
v_smfmac_f32_16x16x64_f16 v[88:91], v[12:15], v[152:159], v112
s_nop 3
v_cvt_pk_bf16_f32 v94, v84, v85
v_cvt_pk_bf16_f32 v95, v86, v87
s_mov_b32 vcc_lo, 0xcccccccc
s_mov_b32 vcc_hi, 0xcccccccc
v_mfma_f32_16x16x32_bf16 v[84:87], v[92:95], v[104:107], 0
v_add_u32 v121, v121, v122
v_writelane_b32 v121, s55, 39
s_nop 0
v_smfmac_f32_16x16x64_f16 v[88:91], v[16:19], v[160:167], v112
s_nop 2
s_cmp_eq_u32 s17, 63
v_cvt_pk_bf16_f32 v114, v84, v85
v_cvt_pk_bf16_f32 v115, v86, v87
buffer_store_dwordx2 v[114:115], v117, s[4:7], s21 offen
s_cbranch_scc1 main_kernel_c1_last
ds_write_b64 v117, v[114:115] offset:16896
v_smfmac_f32_16x16x64_f16 v[88:91], v[20:23], v[168:175], v112
v_smfmac_f32_16x16x64_f16 v[88:91], v[24:27], v[176:183], v112
v_smfmac_f32_16x16x64_f16 v[88:91], v[28:31], v[184:191], v112
v_smfmac_f32_16x16x64_f16 v[88:91], v[32:35], v[192:199], v112
s_waitcnt lgkmcnt(0)
s_barrier
ds_read_b128 v[0:3], v116 offset:16384
v_smfmac_f32_16x16x64_f16 v[88:91], v[36:39], v[200:207], v112
ds_read_b128 v[4:7], v116 offset:17408
v_smfmac_f32_16x16x64_f16 v[88:91], v[40:43], v[208:215], v112
ds_read_b128 v[16:19], v116 offset:26624
v_smfmac_f32_16x16x64_f16 v[88:91], v[44:47], v[216:223], v112
ds_read_b128 v[20:23], v116 offset:30720
v_smfmac_f32_16x16x64_f16 v[88:91], v[48:51], v[224:231], v112
ds_read_b128 v[24:27], v116 offset:27648
v_smfmac_f32_16x16x64_f16 v[88:91], v[52:55], v[232:239], v112
ds_read_b128 v[28:31], v116 offset:31744
v_smfmac_f32_16x16x64_f16 v[88:91], v[56:59], v[240:247], v112
v_smfmac_f32_16x16x64_f16 v[88:91], v[60:63], v[248:255], v112
s_waitcnt lgkmcnt(5)
v_mfma_f32_16x16x32_bf16 v[80:83], v[64:67], v[0:3], 0
v_mfma_f32_16x16x32_bf16 v[84:87], v[68:71], v[0:3], 0
buffer_load_dwordx4 v[8:11], v116, s[4:7], s20 offen offset:0 sc1
v_mfma_f32_16x16x32_bf16 v[92:95], v[0:3], v[0:3], 0
buffer_load_dwordx4 v[12:15], v116, s[4:7], s20 offen offset:1024 sc1
v_permlane32_swap_b32 v88, v90
s_waitcnt lgkmcnt(4)
v_mfma_f32_16x16x32_bf16 v[80:83], v[72:75], v[4:7], v[80:83]
v_permlane32_swap_b32 v89, v91
v_mfma_f32_16x16x32_bf16 v[84:87], v[76:79], v[4:7], v[84:87]
v_pk_add_f32 v[88:89], v[88:89], v[90:91]
v_mfma_f32_16x16x32_bf16 v[92:95], v[4:7], v[4:7], v[92:95]
v_cvt_pk_bf16_f32 v124, v88, v89
v_mov_b32 v65, 0
s_waitcnt lgkmcnt(0)
s_waitcnt vmcnt(1)
v_mfma_f32_16x16x32_bf16 v[88:91], v[8:11], v[8:11], v[92:95]
v_mfma_f32_16x16x32_bf16 v[0:3], v[16:19], v[8:11], v[80:83]
v_cmp_u_f32 s[0:1], v8, v10
v_mfma_f32_16x16x32_bf16 v[4:7], v[20:23], v[8:11], v[84:87]
s_waitcnt vmcnt(0)
v_mfma_f32_16x16x32_bf16 v[88:91], v[12:15], v[12:15], v[88:91]
v_mfma_f32_16x16x32_bf16 v[0:3], v[24:27], v[12:15], v[0:3]
v_cmp_u_f32 s[32:33], v12, v14
v_mfma_f32_16x16x32_bf16 v[4:7], v[28:31], v[12:15], v[4:7]
s_or_b64 s[0:1], s[0:1], s[32:33]
s_cbranch_scc1 main_kernel_c1_z_f
main_kernel_c1_z:
v_mul_f32 v88, s30, v88
v_mul_f32 v89, s30, v89
v_exp_f32 v88, v88
v_exp_f32 v89, v89
v_cndmask_b32_dpp v0, v2, v0, vcc quad_perm:[2,3,2,3] row_mask:0xf bank_mask:0xf
v_cvt_pk_bf16_f32 v64, v88, v89
v_cndmask_b32_dpp v1, v3, v1, vcc quad_perm:[2,3,2,3] row_mask:0xf bank_mask:0xf
v_exp_f32 v0, v0
v_mfma_f32_16x16x16_bf16 v[16:19], v[100:101], v[64:65], 0
v_exp_f32 v1, v1
v_cndmask_b32_dpp v4, v6, v4, vcc quad_perm:[2,3,2,3] row_mask:0xf bank_mask:0xf
v_mfma_f32_16x16x16_bf16 v[8:11], v[124:125], v[64:65], 0
v_cndmask_b32_dpp v5, v7, v5, vcc quad_perm:[2,3,2,3] row_mask:0xf bank_mask:0xf
v_exp_f32 v4, v4
v_exp_f32 v5, v5
v_cvt_pk_bf16_f32 v92, v0, v1
v_cvt_pk_bf16_f32 v94, v4, v5
v_mov_b32 v80, 0
v_mov_b32_dpp v93, v92 quad_perm:[0,1,0,1] row_mask:0xf bank_mask:0xf
v_mov_b32_dpp v95, v94 quad_perm:[0,1,0,1] row_mask:0xf bank_mask:0xf
v_mov_b32 v81, 0
v_mov_b32 v82, 0
v_mfma_f32_16x16x32_bf16 v[16:19], v[100:103], v[92:95], v[16:19]
v_mov_b32 v83, 0
v_mov_b32 v84, 0
v_mfma_f32_16x16x32_bf16 v[8:11], v[96:99], v[92:95], v[8:11]
s_nop 1
v_mov_b32 v85, 0
v_mov_b32 v86, 0
v_mov_b32 v87, 0
v_rcp_f32 v126, v16
v_subrev_u32 v127, 0x21800000, v16
v_cmp_lt_u32 vcc, 0x3c000000, v127
v_pk_mul_f32 v[8:9], v[8:9], v[126:127] op_sel_hi:[1,0]
v_pk_mul_f32 v[10:11], v[10:11], v[126:127] op_sel_hi:[1,0]
s_and_b32 s32, vcc_lo, 0xcccc
v_cvt_pk_bf16_f32 v126, v8, v9
v_cvt_pk_bf16_f32 v127, v10, v11
s_cbranch_scc1 main_kernel_c1_sm_f
main_kernel_c1_ost:
buffer_store_dwordx2 v[126:127], v118, s[4:7], s22 offen
v_cmp_eq_u32 s[0:1], 0, v123
v_mov_b32 v24, -1
v_mov_b32 v25, -1
v_mov_b32 v26, -1
v_mov_b32 v27, -1
ds_read_b128 v[32:35], v113 offset:0
ds_read_b128 v[36:39], v113 offset:1024
ds_read_b128 v[40:43], v113 offset:2048
ds_read_b128 v[44:47], v113 offset:3072
ds_read_b128 v[48:51], v113 offset:4096
ds_read_b128 v[52:55], v113 offset:5120
s_and_b32 s10, s1, 0x3f00
buffer_store_dwordx4 v[24:27], v116, s[4:7], s3 offen
buffer_store_dwordx4 v[24:27], v116, s[4:7], s46 offen
s_barrier
buffer_load_dwordx4 v[0:3], v116, s[4:7], s23 offen sc1
ds_read_b128 v[56:59], v113 offset:6144
ds_read_b128 v[60:63], v113 offset:7168
s_add_u32 s46, s46, 0x40000
s_bitset0_b32 s46, 20
s_add_u32 s37, s37, 65536
s_add_u32 s26, s26, 65536
s_xor_b32 s32, s23, 1024
buffer_load_dwordx4 v[4:7], v116, s[4:7], s32 offen sc1
ds_read_b128 v[64:67], v113 offset:8192
ds_read_b128 v[68:71], v113 offset:9216
s_nop 3
s_xor_b32 s32, s23, 2048
buffer_load_dwordx4 v[8:11], v116, s[4:7], s32 offen sc1
ds_read_b128 v[72:75], v113 offset:10240
ds_read_b128 v[76:79], v113 offset:11264
s_nop 3
s_xor_b32 s32, s23, 3072
buffer_load_dwordx4 v[12:15], v116, s[4:7], s32 offen sc1
ds_read_b128 v[88:91], v113 offset:12288
ds_read_b128 v[92:95], v113 offset:13312
s_nop 3
s_xor_b32 s32, s23, 4096
buffer_load_dwordx4 v[16:19], v116, s[4:7], s32 offen sc1
s_nop 7
s_xor_b32 s32, s23, 5120
buffer_load_dwordx4 v[20:23], v116, s[4:7], s32 offen sc1
s_nop 7
s_xor_b32 s32, s23, 6144
buffer_load_dwordx4 v[24:27], v116, s[4:7], s32 offen sc1
s_nop 7
s_xor_b32 s32, s23, 7168
buffer_load_dwordx4 v[28:31], v116, s[4:7], s32 offen sc1
s_waitcnt lgkmcnt(12)
s_waitcnt vmcnt(7)
v_cmp_u_f32 vcc, v0, v2
s_cbranch_vccnz main_kernel_c1_o0_f
main_kernel_c1_o0:
v_smfmac_f32_16x16x64_bf16 v[80:83], v[0:3], v[32:39], v112
ds_read_b128 v[32:35], v113 offset:14336
ds_read_b128 v[36:39], v113 offset:15360
s_waitcnt lgkmcnt(12)
s_waitcnt vmcnt(6)
v_cmp_u_f32 vcc, v4, v6
v_smfmac_f32_16x16x64_bf16 v[84:87], v[0:3], v[40:47], v112
ds_read_b128 v[40:43], v113 offset:16384
ds_read_b128 v[44:47], v113 offset:17408
buffer_store_dwordx2 v[114:115], v119, s[4:7], s37 offen sc1
s_cbranch_vccnz main_kernel_c1_o1_f
main_kernel_c1_o1:
s_waitcnt lgkmcnt(12)
v_smfmac_f32_16x16x64_bf16 v[80:83], v[4:7], v[48:55], v112
ds_read_b128 v[48:51], v113 offset:18432
ds_read_b128 v[52:55], v113 offset:19456
s_waitcnt lgkmcnt(12)
s_waitcnt vmcnt(6)
v_cmp_u_f32 vcc, v8, v10
v_smfmac_f32_16x16x64_bf16 v[84:87], v[4:7], v[56:63], v112
ds_read_b128 v[56:59], v113 offset:20480
ds_read_b128 v[60:63], v113 offset:21504
buffer_store_dword v124, v120, s[4:7], s26 offen sc1
s_cbranch_vccnz main_kernel_c1_o2_f
main_kernel_c1_o2:
s_waitcnt lgkmcnt(12)
v_smfmac_f32_16x16x64_bf16 v[80:83], v[8:11], v[64:71], v112
ds_read_b128 v[64:67], v113 offset:22528
ds_read_b128 v[68:71], v113 offset:23552
s_waitcnt lgkmcnt(12)
s_waitcnt vmcnt(6)
v_cmp_u_f32 vcc, v12, v14
v_smfmac_f32_16x16x64_bf16 v[84:87], v[8:11], v[72:79], v112
ds_read_b128 v[72:75], v113 offset:24576
ds_read_b128 v[76:79], v113 offset:25600
s_cbranch_vccnz main_kernel_c1_o3_f
main_kernel_c1_o3:
s_waitcnt lgkmcnt(12)
v_smfmac_f32_16x16x64_bf16 v[80:83], v[12:15], v[88:95], v112
ds_read_b128 v[88:91], v113 offset:26624
ds_read_b128 v[92:95], v113 offset:27648
s_waitcnt lgkmcnt(12)
s_waitcnt vmcnt(5)
v_cmp_u_f32 vcc, v16, v18
v_smfmac_f32_16x16x64_bf16 v[84:87], v[12:15], v[32:39], v112
ds_read_b128 v[32:35], v113 offset:28672
ds_read_b128 v[36:39], v113 offset:29696
s_cbranch_vccnz main_kernel_c1_o4_f
main_kernel_c1_o4:
s_waitcnt lgkmcnt(12)
v_smfmac_f32_16x16x64_bf16 v[80:83], v[16:19], v[40:47], v112
ds_read_b128 v[40:43], v113 offset:30720
ds_read_b128 v[44:47], v113 offset:31744
s_waitcnt lgkmcnt(12)
s_waitcnt vmcnt(4)
v_cmp_u_f32 vcc, v20, v22
v_smfmac_f32_16x16x64_bf16 v[84:87], v[16:19], v[48:55], v112
s_cbranch_vccnz main_kernel_c1_o5_f
main_kernel_c1_o5:
s_waitcnt lgkmcnt(10)
v_smfmac_f32_16x16x64_bf16 v[80:83], v[20:23], v[56:63], v112
s_waitcnt lgkmcnt(8)
s_waitcnt vmcnt(3)
v_cmp_u_f32 vcc, v24, v26
v_smfmac_f32_16x16x64_bf16 v[84:87], v[20:23], v[64:71], v112
s_cbranch_vccnz main_kernel_c1_o6_f
main_kernel_c1_o6:
s_waitcnt lgkmcnt(6)
v_smfmac_f32_16x16x64_bf16 v[80:83], v[24:27], v[72:79], v112
s_waitcnt lgkmcnt(4)
v_smfmac_f32_16x16x64_bf16 v[84:87], v[24:27], v[88:95], v112
s_waitcnt lgkmcnt(2)
s_waitcnt vmcnt(2)
v_cmp_u_f32 vcc, v28, v30
s_cbranch_vccnz main_kernel_c1_o7_f
main_kernel_c1_o7:
v_smfmac_f32_16x16x64_bf16 v[80:83], v[28:31], v[32:39], v112
s_waitcnt lgkmcnt(0)
v_smfmac_f32_16x16x64_bf16 v[84:87], v[28:31], v[40:47], v112
s_nop 4
v_cvt_pk_bf16_f32 v80, v80, v81
v_cvt_pk_bf16_f32 v81, v82, v83
ds_write_b64 v116, v[80:81] offset:20488
v_cvt_pk_bf16_f32 v82, v84, v85
v_cvt_pk_bf16_f32 v83, v86, v87
ds_write_b64 v116, v[82:83] offset:22536
s_waitcnt lgkmcnt(0)
s_barrier
ds_read_b128 v[72:75], v116 offset:22528
ds_read_b128 v[76:79], v116 offset:23552
s_mov_b32 m0, 26624
s_cmp_lg_u32 s10, 0
s_waitcnt lgkmcnt(1)
v_mfma_f32_16x16x32_bf16 v[64:67], v[72:75], v[108:111], 0
s_waitcnt lgkmcnt(0)
v_mfma_f32_16x16x32_bf16 v[64:67], v[76:79], v[108:111], v[64:67]
s_nop 7
v_cvt_pk_f16_f32 v68, v64, v65
v_cvt_pk_f16_f32 v69, v66, v67
buffer_store_dwordx2 v[68:69], v125, s[4:7], s25 offen sc1
s_cbranch_scc1 main_kernel_c1_kvw
main_kernel_c1_kvok:
s_nop 3
buffer_load_dwordx4 v116, s[4:7], s27 offen sc1 lds
buffer_load_dwordx4 v116, s[4:7], s27 offen offset:1024 sc1 lds
s_mov_b32 m0, 30720
s_xor_b32 s32, s27, 131072
buffer_load_dwordx4 v116, s[4:7], s32 offen offset:0 sc1 lds
s_add_u32 s27, s27, 0x40000
s_branch main_kernel_c1_top
main_kernel_c1_kvw:
s_mov_b32 exec_lo, 0
s_mov_b32 exec_hi, 0x3f00
v_subrev_u32 v127, 128, v121
main_kernel_c1_kvp:
buffer_load_dword v126, v127, s[4:7], 0 offen sc1
s_waitcnt vmcnt(0)
v_cmp_eq_u32 vcc, 0, v126
s_cbranch_vccz main_kernel_c1_kvp_ok
s_sleep 2
s_sub_u32 s29, s29, 1
s_cbranch_scc0 main_kernel_c1_kvp
s_branch main_kernel_end
main_kernel_c1_kvp_ok:
s_mov_b64 exec, -1
s_branch main_kernel_c1_kvok
main_kernel_c1_last:
s_add_u32 s37, s37, 65536
s_add_u32 s26, s26, 65536
buffer_store_dwordx2 v[114:115], v119, s[4:7], s37 offen sc1
v_smfmac_f32_16x16x64_f16 v[88:91], v[20:23], v[168:175], v112
v_smfmac_f32_16x16x64_f16 v[88:91], v[24:27], v[176:183], v112
v_smfmac_f32_16x16x64_f16 v[88:91], v[28:31], v[184:191], v112
v_smfmac_f32_16x16x64_f16 v[88:91], v[32:35], v[192:199], v112
v_smfmac_f32_16x16x64_f16 v[88:91], v[36:39], v[200:207], v112
v_smfmac_f32_16x16x64_f16 v[88:91], v[40:43], v[208:215], v112
v_smfmac_f32_16x16x64_f16 v[88:91], v[44:47], v[216:223], v112
v_smfmac_f32_16x16x64_f16 v[88:91], v[48:51], v[224:231], v112
v_smfmac_f32_16x16x64_f16 v[88:91], v[52:55], v[232:239], v112
v_smfmac_f32_16x16x64_f16 v[88:91], v[56:59], v[240:247], v112
v_smfmac_f32_16x16x64_f16 v[88:91], v[60:63], v[248:255], v112
s_nop 7
v_permlane32_swap_b32 v88, v90
s_nop 1
v_permlane32_swap_b32 v89, v91
s_nop 1
v_pk_add_f32 v[88:89], v[88:89], v[90:91]
s_nop 1
v_cvt_pk_bf16_f32 v124, v88, v89
s_nop 1
buffer_store_dword v124, v120, s[4:7], s26 offen sc1
s_branch main_kernel_end
main_kernel_c1_m0_f:
s_waitcnt lgkmcnt(0)
buffer_load_dwordx4 v[0:3], v116, s[4:7], s18 offen sc1
buffer_load_dwordx4 v[64:67], v116, s[4:7], s19 offen sc1
s_xor_b32 s32, s18, 1024
buffer_load_dwordx4 v[16:19], v116, s[4:7], s32 offen sc1
s_xor_b32 s32, s19, 1024
buffer_load_dwordx4 v[68:71], v116, s[4:7], s32 offen sc1
s_xor_b32 s32, s18, 2048
buffer_load_dwordx4 v[32:35], v116, s[4:7], s32 offen sc1
s_xor_b32 s32, s19, 2048
buffer_load_dwordx4 v[72:75], v116, s[4:7], s32 offen sc1
s_xor_b32 s32, s18, 3072
buffer_load_dwordx4 v[48:51], v116, s[4:7], s32 offen sc1
s_xor_b32 s32, s19, 3072
buffer_load_dwordx4 v[76:79], v116, s[4:7], s32 offen sc1
s_sub_u32 s29, s29, 1
s_cbranch_scc1 main_kernel_end
s_waitcnt vmcnt(0)
v_max_u32 v126, v0, v2
v_max3_u32 v126, v126, v64, v66
v_cmp_eq_u32 vcc, -1, v126
s_cbranch_vccnz main_kernel_c1_m0_f
v_pk_add_f16 v0, v0, v64
v_pk_add_f16 v1, v1, v65
v_pk_add_f16 v2, v2, v66
v_pk_add_f16 v3, v3, v67
s_nop 0
s_branch main_kernel_c1_m0
main_kernel_c1_m1_f:
s_waitcnt lgkmcnt(0)
s_xor_b32 s32, s18, 1024
buffer_load_dwordx4 v[16:19], v116, s[4:7], s32 offen sc1
s_xor_b32 s32, s19, 1024
buffer_load_dwordx4 v[68:71], v116, s[4:7], s32 offen sc1
s_xor_b32 s32, s18, 2048
buffer_load_dwordx4 v[32:35], v116, s[4:7], s32 offen sc1
s_xor_b32 s32, s19, 2048
buffer_load_dwordx4 v[72:75], v116, s[4:7], s32 offen sc1
s_xor_b32 s32, s18, 3072
buffer_load_dwordx4 v[48:51], v116, s[4:7], s32 offen sc1
s_xor_b32 s32, s19, 3072
buffer_load_dwordx4 v[76:79], v116, s[4:7], s32 offen sc1
s_sub_u32 s29, s29, 1
s_cbranch_scc1 main_kernel_end
s_waitcnt vmcnt(0)
v_max_u32 v126, v16, v18
v_max3_u32 v126, v126, v68, v70
v_cmp_eq_u32 vcc, -1, v126
s_cbranch_vccnz main_kernel_c1_m1_f
v_pk_add_f16 v16, v16, v68
v_pk_add_f16 v17, v17, v69
v_pk_add_f16 v18, v18, v70
v_pk_add_f16 v19, v19, v71
ds_write_b128 v116, v[16:19] offset:5120
s_branch main_kernel_c1_m1
main_kernel_c1_m2_f:
s_waitcnt lgkmcnt(0)
s_xor_b32 s32, s18, 2048
buffer_load_dwordx4 v[32:35], v116, s[4:7], s32 offen sc1
s_xor_b32 s32, s19, 2048
buffer_load_dwordx4 v[72:75], v116, s[4:7], s32 offen sc1
s_xor_b32 s32, s18, 3072
buffer_load_dwordx4 v[48:51], v116, s[4:7], s32 offen sc1
s_xor_b32 s32, s19, 3072
buffer_load_dwordx4 v[76:79], v116, s[4:7], s32 offen sc1
s_sub_u32 s29, s29, 1
s_cbranch_scc1 main_kernel_end
s_waitcnt vmcnt(0)
v_max_u32 v126, v32, v34
v_max3_u32 v126, v126, v72, v74
v_cmp_eq_u32 vcc, -1, v126
s_cbranch_vccnz main_kernel_c1_m2_f
v_pk_add_f16 v32, v32, v72
v_pk_add_f16 v33, v33, v73
v_pk_add_f16 v34, v34, v74
v_pk_add_f16 v35, v35, v75
ds_write_b128 v116, v[32:35] offset:9216
s_branch main_kernel_c1_m2
main_kernel_c1_m3_f:
s_waitcnt lgkmcnt(0)
s_xor_b32 s32, s18, 3072
buffer_load_dwordx4 v[48:51], v116, s[4:7], s32 offen sc1
s_xor_b32 s32, s19, 3072
buffer_load_dwordx4 v[76:79], v116, s[4:7], s32 offen sc1
s_sub_u32 s29, s29, 1
s_cbranch_scc1 main_kernel_end
s_waitcnt vmcnt(0)
v_max_u32 v126, v48, v50
v_max3_u32 v126, v126, v76, v78
v_cmp_eq_u32 vcc, -1, v126
s_cbranch_vccnz main_kernel_c1_m3_f
v_pk_add_f16 v48, v48, v76
v_pk_add_f16 v49, v49, v77
v_pk_add_f16 v50, v50, v78
v_pk_add_f16 v51, v51, v79
ds_write_b128 v116, v[48:51] offset:13312
s_branch main_kernel_c1_m3
main_kernel_c1_z_f:
buffer_load_dwordx4 v[8:11], v116, s[4:7], s20 offen offset:0 sc1
buffer_load_dwordx4 v[12:15], v116, s[4:7], s20 offen offset:1024 sc1
s_memtime s[32:33]
ds_read_b32 v126, v116 offset:18432
s_sub_u32 s34, s19, s54
s_xor_b32 s34, s34, 0x2000
s_lshl_b32 s35, s12, 15
s_add_u32 s34, s34, s35
s_lshl_b32 s35, s13, 8
s_add_u32 s35, s35, s34
s_add_u32 s34, s34, 0x4000
s_waitcnt lgkmcnt(0)
s_sub_u32 s32, s32, 450
v_sub_u32 v127, s32, v126
buffer_store_dword v127, off, s[4:7], s34
s_sub_u32 s29, s29, 1
s_cbranch_scc1 main_kernel_end
s_waitcnt vmcnt(1)
main_kernel_c1_z_g:
v_max_u32 v126, v8, v10
v_max3_u32 v126, v126, v12, v14
v_cmp_eq_u32 vcc, -1, v126
s_cbranch_vccnz main_kernel_c1_z_h
v_mfma_f32_16x16x32_bf16 v[88:91], v[8:11], v[8:11], v[92:95]
v_mfma_f32_16x16x32_bf16 v[0:3], v[16:19], v[8:11], v[80:83]
v_mfma_f32_16x16x32_bf16 v[4:7], v[20:23], v[8:11], v[84:87]
v_mfma_f32_16x16x32_bf16 v[88:91], v[12:15], v[12:15], v[88:91]
v_mfma_f32_16x16x32_bf16 v[0:3], v[24:27], v[12:15], v[0:3]
v_mfma_f32_16x16x32_bf16 v[4:7], v[28:31], v[12:15], v[4:7]
buffer_store_dword v127, off, s[4:7], s35 offset:132 sc1
s_mov_b32 vcc_lo, 0xcccccccc
s_mov_b32 vcc_hi, 0xcccccccc
s_branch main_kernel_c1_z
main_kernel_c1_z_h:
buffer_load_dwordx4 v[8:11], v116, s[4:7], s20 offen offset:0 sc1
buffer_load_dwordx4 v[12:15], v116, s[4:7], s20 offen offset:1024 sc1
s_sub_u32 s29, s29, 1
s_cbranch_scc1 main_kernel_end
v_add_u32 v127, 300, v127
s_waitcnt vmcnt(0)
s_branch main_kernel_c1_z_g
main_kernel_c1_sm_f:
s_waitcnt vmcnt(0) lgkmcnt(0)
buffer_load_dwordx4 v[8:11], v116, s[4:7], s20 offen offset:0 sc1
buffer_load_dwordx4 v[12:15], v116, s[4:7], s20 offen offset:1024 sc1
ds_read_b128 v[0:3], v116 offset:16384
ds_read_b128 v[4:7], v116 offset:17408
ds_read_b128 v[64:67], v116 offset:24576
ds_read_b128 v[68:71], v116 offset:28672
ds_read_b128 v[72:75], v116 offset:25600
ds_read_b128 v[76:79], v116 offset:29696
ds_read_b128 v[16:19], v116 offset:26624
ds_read_b128 v[20:23], v116 offset:30720
ds_read_b128 v[24:27], v116 offset:27648
ds_read_b128 v[28:31], v116 offset:31744
s_waitcnt vmcnt(0)
s_waitcnt lgkmcnt(0)
v_mfma_f32_16x16x32_bf16 v[80:83], v[64:67], v[0:3], 0
v_mfma_f32_16x16x32_bf16 v[84:87], v[68:71], v[0:3], 0
v_mfma_f32_16x16x32_bf16 v[92:95], v[0:3], v[0:3], 0
v_mfma_f32_16x16x32_bf16 v[80:83], v[72:75], v[4:7], v[80:83]
v_mfma_f32_16x16x32_bf16 v[84:87], v[76:79], v[4:7], v[84:87]
v_mfma_f32_16x16x32_bf16 v[92:95], v[4:7], v[4:7], v[92:95]
v_mfma_f32_16x16x32_bf16 v[0:3], v[16:19], v[8:11], v[80:83]
v_mfma_f32_16x16x32_bf16 v[4:7], v[20:23], v[8:11], v[84:87]
v_mfma_f32_16x16x32_bf16 v[88:91], v[8:11], v[8:11], v[92:95]
v_mfma_f32_16x16x32_bf16 v[0:3], v[24:27], v[12:15], v[0:3]
v_mfma_f32_16x16x32_bf16 v[4:7], v[28:31], v[12:15], v[4:7]
v_mfma_f32_16x16x32_bf16 v[88:91], v[12:15], v[12:15], v[88:91]
s_nop 7
v_mov_b32 v65, 0
v_max_f32 v126, v88, v89
v_mul_f32 v126, s30, v126
v_max3_f32 v126, v126, v0, v1
v_max3_f32 v126, v126, v2, v3
v_max3_f32 v126, v126, v4, v5
v_max3_f32 v126, v126, v6, v7
v_mov_b32 v127, v126
s_nop 1
v_permlane32_swap_b32 v126, v127
v_max_f32 v126, v126, v127
v_mov_b32 v127, v126
s_nop 1
v_permlane16_swap_b32 v126, v127
v_max_f32 v126, v126, v127
v_mul_f32 v127, 0x40faf233, v126
s_mov_b32 vcc_lo, 0xcccccccc
s_mov_b32 vcc_hi, 0xcccccccc
v_sub_f32 v0, v0, v126
v_sub_f32 v1, v1, v126
v_sub_f32 v2, v2, v126
v_sub_f32 v3, v3, v126
v_sub_f32 v4, v4, v126
v_sub_f32 v5, v5, v126
v_sub_f32 v6, v6, v126
v_sub_f32 v7, v7, v126
v_sub_f32 v88, v88, v127
v_sub_f32 v89, v89, v127
s_waitcnt lgkmcnt(0)
s_nop 0
v_mul_f32 v88, s30, v88
v_mul_f32 v89, s30, v89
v_exp_f32 v88, v88
v_exp_f32 v89, v89
v_cndmask_b32_dpp v0, v2, v0, vcc quad_perm:[2,3,2,3] row_mask:0xf bank_mask:0xf
v_cvt_pk_bf16_f32 v64, v88, v89
v_cndmask_b32_dpp v1, v3, v1, vcc quad_perm:[2,3,2,3] row_mask:0xf bank_mask:0xf
v_exp_f32 v0, v0
v_mfma_f32_16x16x16_bf16 v[16:19], v[100:101], v[64:65], 0
v_exp_f32 v1, v1
v_cndmask_b32_dpp v4, v6, v4, vcc quad_perm:[2,3,2,3] row_mask:0xf bank_mask:0xf
v_mfma_f32_16x16x16_bf16 v[8:11], v[124:125], v[64:65], 0
v_cndmask_b32_dpp v5, v7, v5, vcc quad_perm:[2,3,2,3] row_mask:0xf bank_mask:0xf
v_exp_f32 v4, v4
v_exp_f32 v5, v5
v_cvt_pk_bf16_f32 v92, v0, v1
v_cvt_pk_bf16_f32 v94, v4, v5
v_mov_b32 v80, 0
v_mov_b32_dpp v93, v92 quad_perm:[0,1,0,1] row_mask:0xf bank_mask:0xf
v_mov_b32_dpp v95, v94 quad_perm:[0,1,0,1] row_mask:0xf bank_mask:0xf
v_mov_b32 v81, 0
v_mov_b32 v82, 0
v_mfma_f32_16x16x32_bf16 v[16:19], v[100:103], v[92:95], v[16:19]
v_mov_b32 v83, 0
v_mov_b32 v84, 0
v_mfma_f32_16x16x32_bf16 v[8:11], v[96:99], v[92:95], v[8:11]
s_nop 1
v_mov_b32 v85, 0
v_mov_b32 v86, 0
v_mov_b32 v87, 0
v_rcp_f32 v126, v16
v_subrev_u32 v127, 0x21800000, v16
v_cmp_lt_u32 vcc, 0x3c000000, v127
v_pk_mul_f32 v[8:9], v[8:9], v[126:127] op_sel_hi:[1,0]
v_pk_mul_f32 v[10:11], v[10:11], v[126:127] op_sel_hi:[1,0]
s_and_b32 s32, vcc_lo, 0xcccc
v_cvt_pk_bf16_f32 v126, v8, v9
v_cvt_pk_bf16_f32 v127, v10, v11
s_branch main_kernel_c1_ost
main_kernel_c1_o0_f:
s_nop 0
buffer_load_dwordx4 v[0:3], v116, s[4:7], s23 offen sc1
s_xor_b32 s32, s23, 1024
buffer_load_dwordx4 v[4:7], v116, s[4:7], s32 offen sc1
s_sub_u32 s29, s29, 1
s_cbranch_scc1 main_kernel_end
s_waitcnt vmcnt(0)
v_max_u32 v126, v0, v2
v_cmp_eq_u32 vcc, -1, v126
s_cbranch_vccnz main_kernel_c1_o0_f
s_branch main_kernel_c1_o0
main_kernel_c1_o1_f:
s_nop 0
s_xor_b32 s32, s23, 1024
buffer_load_dwordx4 v[4:7], v116, s[4:7], s32 offen sc1
s_xor_b32 s32, s23, 2048
buffer_load_dwordx4 v[8:11], v116, s[4:7], s32 offen sc1
s_sub_u32 s29, s29, 1
s_cbranch_scc1 main_kernel_end
s_waitcnt vmcnt(0)
v_max_u32 v126, v4, v6
v_cmp_eq_u32 vcc, -1, v126
s_cbranch_vccnz main_kernel_c1_o1_f
s_branch main_kernel_c1_o1
main_kernel_c1_o2_f:
s_nop 0
s_xor_b32 s32, s23, 2048
buffer_load_dwordx4 v[8:11], v116, s[4:7], s32 offen sc1
s_xor_b32 s32, s23, 3072
buffer_load_dwordx4 v[12:15], v116, s[4:7], s32 offen sc1
s_sub_u32 s29, s29, 1
s_cbranch_scc1 main_kernel_end
s_waitcnt vmcnt(0)
v_max_u32 v126, v8, v10
v_cmp_eq_u32 vcc, -1, v126
s_cbranch_vccnz main_kernel_c1_o2_f
s_branch main_kernel_c1_o2
main_kernel_c1_o3_f:
s_nop 0
s_xor_b32 s32, s23, 3072
buffer_load_dwordx4 v[12:15], v116, s[4:7], s32 offen sc1
s_xor_b32 s32, s23, 4096
buffer_load_dwordx4 v[16:19], v116, s[4:7], s32 offen sc1
s_sub_u32 s29, s29, 1
s_cbranch_scc1 main_kernel_end
s_waitcnt vmcnt(0)
v_max_u32 v126, v12, v14
v_cmp_eq_u32 vcc, -1, v126
s_cbranch_vccnz main_kernel_c1_o3_f
s_branch main_kernel_c1_o3
main_kernel_c1_o4_f:
s_nop 0
s_xor_b32 s32, s23, 4096
buffer_load_dwordx4 v[16:19], v116, s[4:7], s32 offen sc1
s_xor_b32 s32, s23, 5120
buffer_load_dwordx4 v[20:23], v116, s[4:7], s32 offen sc1
s_sub_u32 s29, s29, 1
s_cbranch_scc1 main_kernel_end
s_waitcnt vmcnt(0)
v_max_u32 v126, v16, v18
v_cmp_eq_u32 vcc, -1, v126
s_cbranch_vccnz main_kernel_c1_o4_f
s_branch main_kernel_c1_o4
main_kernel_c1_o5_f:
s_nop 0
s_xor_b32 s32, s23, 5120
buffer_load_dwordx4 v[20:23], v116, s[4:7], s32 offen sc1
s_xor_b32 s32, s23, 6144
buffer_load_dwordx4 v[24:27], v116, s[4:7], s32 offen sc1
s_sub_u32 s29, s29, 1
s_cbranch_scc1 main_kernel_end
s_waitcnt vmcnt(0)
v_max_u32 v126, v20, v22
v_cmp_eq_u32 vcc, -1, v126
s_cbranch_vccnz main_kernel_c1_o5_f
s_branch main_kernel_c1_o5
main_kernel_c1_o6_f:
s_nop 0
s_xor_b32 s32, s23, 6144
buffer_load_dwordx4 v[24:27], v116, s[4:7], s32 offen sc1
s_xor_b32 s32, s23, 7168
buffer_load_dwordx4 v[28:31], v116, s[4:7], s32 offen sc1
s_sub_u32 s29, s29, 1
s_cbranch_scc1 main_kernel_end
s_waitcnt vmcnt(0)
v_max_u32 v126, v24, v26
v_cmp_eq_u32 vcc, -1, v126
s_cbranch_vccnz main_kernel_c1_o6_f
s_branch main_kernel_c1_o6
main_kernel_c1_o7_f:
s_nop 0
s_xor_b32 s32, s23, 7168
buffer_load_dwordx4 v[28:31], v116, s[4:7], s32 offen sc1
s_sub_u32 s29, s29, 1
s_cbranch_scc1 main_kernel_end
s_waitcnt vmcnt(0)
v_max_u32 v126, v28, v30
v_cmp_eq_u32 vcc, -1, v126
s_cbranch_vccnz main_kernel_c1_o7_f
s_branch main_kernel_c1_o7
.p2align 6
main_kernel_c2_top:
s_barrier
buffer_load_dwordx4 v[0:3], v116, s[4:7], s18 offen sc1
s_add_u32 s20, s20, 0x40000
s_bitset0_b32 s20, 20
s_add_u32 s21, s21, 0x40000
s_bitset0_b32 s21, 20
s_add_u32 s22, s22, 0x40000
s_bitset0_b32 s22, 20
s_add_u32 s23, s23, 0x40000
s_bitset0_b32 s23, 20
s_xor_b32 s32, s18, 1024
buffer_load_dwordx4 v[16:19], v116, s[4:7], s32 offen sc1
s_add_u32 s3, s3, 0x40000
s_bitset0_b32 s3, 20
s_add_u32 s17, s17, 1
s_bitcmp1_b32 0x77777777, s17
s_cselect_b32 s33, 0x800, 0
s_xor_b32 s54, s54, s33
s_add_u32 s25, s25, 0x40000
s_bitset0_b32 s25, 20
s_nop 0
buffer_load_dwordx4 v[64:67], v116, s[4:7], s19 offen sc1
v_mov_b32 v80, 0
v_mov_b32 v81, 0
s_nop 3
s_xor_b32 s32, s19, 1024
buffer_load_dwordx4 v[68:71], v116, s[4:7], s32 offen sc1
v_mov_b32 v82, 0
v_mov_b32 v83, 0
s_nop 3
s_xor_b32 s32, s18, 2048
buffer_load_dwordx4 v[32:35], v116, s[4:7], s32 offen sc1
v_mov_b32 v84, 0
v_mov_b32 v85, 0
s_nop 3
s_xor_b32 s32, s19, 2048
buffer_load_dwordx4 v[72:75], v116, s[4:7], s32 offen sc1
v_mov_b32 v86, 0
v_mov_b32 v87, 0
s_nop 3
s_xor_b32 s32, s18, 3072
buffer_load_dwordx4 v[48:51], v116, s[4:7], s32 offen sc1
v_mov_b32 v88, 0
v_mov_b32 v89, 0
s_nop 3
s_xor_b32 s32, s19, 3072
buffer_load_dwordx4 v[76:79], v116, s[4:7], s32 offen sc1
v_mov_b32 v90, 0
v_mov_b32 v91, 0
s_waitcnt vmcnt(5)
v_pk_add_f16 v0, v0, v64
v_pk_add_f16 v1, v1, v65
v_pk_add_f16 v2, v2, v66
v_pk_add_f16 v3, v3, v67
v_cmp_u_f16 vcc, v0, v2
s_cbranch_vccnz main_kernel_c2_m0_f
main_kernel_c2_m0:
v_smfmac_f32_16x16x64_f16 v[80:83], v[0:3], a[0:7], v112
ds_write_b128 v116, v[0:3] offset:2048
v_smfmac_f32_16x16x64_f16 v[84:87], v[0:3], a[128:135], v112
buffer_load_dword v123, v121, s[4:7], 0 offen sc1
s_waitcnt vmcnt(5)
v_pk_add_f16 v16, v16, v68
v_pk_add_f16 v17, v17, v69
v_pk_add_f16 v18, v18, v70
v_pk_add_f16 v19, v19, v71
v_cmp_u_f16 vcc, v16, v18
s_waitcnt lgkmcnt(0)
s_barrier
ds_read_b128 v[4:7], v116 offset:3072
s_cbranch_vccnz main_kernel_c2_m1_f
main_kernel_c2_m1:
v_smfmac_f32_16x16x64_f16 v[80:83], v[16:19], a[8:15], v112
ds_write_b128 v116, v[16:19] offset:6144
v_smfmac_f32_16x16x64_f16 v[84:87], v[16:19], a[136:143], v112
ds_read_b128 v[8:11], v116 offset:0
v_smfmac_f32_16x16x64_f16 v[88:91], v[0:3], v[128:135], v112
ds_read_b128 v[12:15], v116 offset:1024
s_waitcnt lgkmcnt(3)
v_smfmac_f32_16x16x64_f16 v[80:83], v[4:7], a[32:39], v112
v_smfmac_f32_16x16x64_f16 v[84:87], v[4:7], a[160:167], v112
v_smfmac_f32_16x16x64_f16 v[88:91], v[4:7], v[136:143], v112
s_waitcnt lgkmcnt(2)
s_barrier
s_waitcnt lgkmcnt(1)
v_smfmac_f32_16x16x64_f16 v[80:83], v[8:11], a[64:71], v112
s_waitcnt vmcnt(3)
ds_read_b128 v[20:23], v116 offset:7168
v_pk_add_f16 v32, v32, v72
v_smfmac_f32_16x16x64_f16 v[84:87], v[8:11], a[192:199], v112
ds_read_b128 v[24:27], v116 offset:4096
s_waitcnt lgkmcnt(2)
v_pk_add_f16 v33, v33, v73
v_smfmac_f32_16x16x64_f16 v[80:83], v[12:15], a[96:103], v112
ds_read_b128 v[28:31], v116 offset:5120
v_pk_add_f16 v34, v34, v74
v_smfmac_f32_16x16x64_f16 v[84:87], v[12:15], a[224:231], v112
s_waitcnt lgkmcnt(2)
v_pk_add_f16 v35, v35, v75
v_smfmac_f32_16x16x64_f16 v[80:83], v[20:23], a[40:47], v112
v_cmp_u_f16 vcc, v32, v34
v_smfmac_f32_16x16x64_f16 v[84:87], v[20:23], a[168:175], v112
ds_write_b128 v116, v[32:35] offset:10240
s_cbranch_vccnz main_kernel_c2_m2_f
main_kernel_c2_m2:
v_smfmac_f32_16x16x64_f16 v[80:83], v[32:35], a[16:23], v112
buffer_load_dwordx4 v[96:99], v116, s[4:7], s28 offen sc1
v_smfmac_f32_16x16x64_f16 v[84:87], v[32:35], a[144:151], v112
s_add_u32 s28, s28, 0x40000
s_waitcnt lgkmcnt(2)
v_smfmac_f32_16x16x64_f16 v[80:83], v[24:27], a[72:79], v112
s_waitcnt vmcnt(2)
v_pk_add_f16 v48, v48, v76
v_smfmac_f32_16x16x64_f16 v[84:87], v[24:27], a[200:207], v112
s_waitcnt lgkmcnt(0)
s_barrier
ds_read_b128 v[36:39], v116 offset:11264
v_pk_add_f16 v49, v49, v77
v_smfmac_f32_16x16x64_f16 v[80:83], v[28:31], a[104:111], v112
ds_read_b128 v[40:43], v116 offset:8192
v_pk_add_f16 v50, v50, v78
v_smfmac_f32_16x16x64_f16 v[84:87], v[28:31], a[232:239], v112
ds_read_b128 v[44:47], v116 offset:9216
v_pk_add_f16 v51, v51, v79
v_smfmac_f32_16x16x64_f16 v[88:91], v[8:11], v[144:151], v112
s_waitcnt lgkmcnt(2)
v_cmp_u_f16 vcc, v48, v50
v_smfmac_f32_16x16x64_f16 v[80:83], v[36:39], a[48:55], v112
ds_write_b128 v116, v[48:51] offset:14336
s_cbranch_vccnz main_kernel_c2_m3_f
main_kernel_c2_m3:
v_smfmac_f32_16x16x64_f16 v[80:83], v[48:51], a[24:31], v112
v_smfmac_f32_16x16x64_f16 v[84:87], v[48:51], a[152:159], v112
v_smfmac_f32_16x16x64_f16 v[84:87], v[36:39], a[176:183], v112
s_waitcnt lgkmcnt(2)
v_smfmac_f32_16x16x64_f16 v[80:83], v[40:43], a[80:87], v112
s_waitcnt lgkmcnt(0)
s_barrier
ds_read_b128 v[52:55], v116 offset:15360
v_smfmac_f32_16x16x64_f16 v[84:87], v[40:43], a[208:215], v112
s_add_u32 s19, s52, s54
ds_read_b128 v[56:59], v116 offset:12288
v_smfmac_f32_16x16x64_f16 v[80:83], v[44:47], a[112:119], v112
s_add_u32 s18, s18, 0x40000
ds_read_b128 v[60:63], v116 offset:13312
v_smfmac_f32_16x16x64_f16 v[84:87], v[44:47], a[240:247], v112
s_bitset0_b32 s18, 20
s_waitcnt lgkmcnt(2)
v_smfmac_f32_16x16x64_f16 v[80:83], v[52:55], a[56:63], v112
s_cmp_eq_u32 s17, 30
s_cselect_b32 s32, s53, 0x10000
s_waitcnt lgkmcnt(1)
v_smfmac_f32_16x16x64_f16 v[80:83], v[56:59], a[88:95], v112
s_add_u32 s52, s52, s32
s_waitcnt lgkmcnt(0)
v_smfmac_f32_16x16x64_f16 v[80:83], v[60:63], a[120:127], v112
s_sub_u32 s24, 0x20000, s32
ds_read_b128 v[64:67], v116 offset:24576
v_smfmac_f32_16x16x64_f16 v[84:87], v[52:55], a[184:191], v112
s_add_u32 s55, s55, s24
ds_read_b128 v[68:71], v116 offset:28672
v_smfmac_f32_16x16x64_f16 v[84:87], v[56:59], a[216:223], v112
ds_read_b128 v[72:75], v116 offset:25600
s_nop 0
v_cvt_pk_bf16_f32 v92, v80, v81
v_smfmac_f32_16x16x64_f16 v[84:87], v[60:63], a[248:255], v112
ds_read_b128 v[76:79], v116 offset:29696
s_nop 0
v_cvt_pk_bf16_f32 v93, v82, v83
v_smfmac_f32_16x16x64_f16 v[88:91], v[12:15], v[152:159], v112
s_nop 3
v_cvt_pk_bf16_f32 v94, v84, v85
v_cvt_pk_bf16_f32 v95, v86, v87
s_mov_b32 vcc_lo, 0xcccccccc
s_mov_b32 vcc_hi, 0xcccccccc
v_mfma_f32_16x16x32_bf16 v[84:87], v[92:95], v[104:107], 0
v_add_u32 v121, v121, v122
v_writelane_b32 v121, s55, 39
s_nop 0
v_smfmac_f32_16x16x64_f16 v[88:91], v[16:19], v[160:167], v112
s_nop 2
s_cmp_eq_u32 s17, 63
v_cvt_pk_bf16_f32 v114, v84, v85
v_cvt_pk_bf16_f32 v115, v86, v87
buffer_store_dwordx2 v[114:115], v117, s[4:7], s21 offen
s_cbranch_scc1 main_kernel_c2_last
ds_write_b64 v117, v[114:115] offset:17408
v_smfmac_f32_16x16x64_f16 v[88:91], v[20:23], v[168:175], v112
v_smfmac_f32_16x16x64_f16 v[88:91], v[24:27], v[176:183], v112
v_smfmac_f32_16x16x64_f16 v[88:91], v[28:31], v[184:191], v112
v_smfmac_f32_16x16x64_f16 v[88:91], v[32:35], v[192:199], v112
s_waitcnt lgkmcnt(0)
s_barrier
ds_read_b128 v[0:3], v116 offset:16384
v_smfmac_f32_16x16x64_f16 v[88:91], v[36:39], v[200:207], v112
ds_read_b128 v[4:7], v116 offset:17408
v_smfmac_f32_16x16x64_f16 v[88:91], v[40:43], v[208:215], v112
ds_read_b128 v[16:19], v116 offset:26624
v_smfmac_f32_16x16x64_f16 v[88:91], v[44:47], v[216:223], v112
ds_read_b128 v[20:23], v116 offset:30720
v_smfmac_f32_16x16x64_f16 v[88:91], v[48:51], v[224:231], v112
ds_read_b128 v[24:27], v116 offset:27648
v_smfmac_f32_16x16x64_f16 v[88:91], v[52:55], v[232:239], v112
ds_read_b128 v[28:31], v116 offset:31744
v_smfmac_f32_16x16x64_f16 v[88:91], v[56:59], v[240:247], v112
v_smfmac_f32_16x16x64_f16 v[88:91], v[60:63], v[248:255], v112
s_waitcnt lgkmcnt(5)
v_mfma_f32_16x16x32_bf16 v[80:83], v[64:67], v[0:3], 0
v_mfma_f32_16x16x32_bf16 v[84:87], v[68:71], v[0:3], 0
buffer_load_dwordx4 v[8:11], v116, s[4:7], s20 offen offset:0 sc1
v_mfma_f32_16x16x32_bf16 v[92:95], v[0:3], v[0:3], 0
buffer_load_dwordx4 v[12:15], v116, s[4:7], s20 offen offset:1024 sc1
v_permlane32_swap_b32 v88, v90
s_waitcnt lgkmcnt(4)
v_mfma_f32_16x16x32_bf16 v[80:83], v[72:75], v[4:7], v[80:83]
v_permlane32_swap_b32 v89, v91
v_mfma_f32_16x16x32_bf16 v[84:87], v[76:79], v[4:7], v[84:87]
v_pk_add_f32 v[88:89], v[88:89], v[90:91]
v_mfma_f32_16x16x32_bf16 v[92:95], v[4:7], v[4:7], v[92:95]
v_cvt_pk_bf16_f32 v124, v88, v89
v_mov_b32 v65, 0
s_waitcnt lgkmcnt(0)
s_waitcnt vmcnt(1)
v_mfma_f32_16x16x32_bf16 v[88:91], v[8:11], v[8:11], v[92:95]
v_mfma_f32_16x16x32_bf16 v[0:3], v[16:19], v[8:11], v[80:83]
v_cmp_u_f32 s[0:1], v8, v10
v_mfma_f32_16x16x32_bf16 v[4:7], v[20:23], v[8:11], v[84:87]
s_waitcnt vmcnt(0)
v_mfma_f32_16x16x32_bf16 v[88:91], v[12:15], v[12:15], v[88:91]
v_mfma_f32_16x16x32_bf16 v[0:3], v[24:27], v[12:15], v[0:3]
v_cmp_u_f32 s[32:33], v12, v14
v_mfma_f32_16x16x32_bf16 v[4:7], v[28:31], v[12:15], v[4:7]
s_or_b64 s[0:1], s[0:1], s[32:33]
s_cbranch_scc1 main_kernel_c2_z_f
main_kernel_c2_z:
v_mul_f32 v88, s30, v88
v_mul_f32 v89, s30, v89
v_exp_f32 v88, v88
v_exp_f32 v89, v89
v_cndmask_b32_dpp v0, v2, v0, vcc quad_perm:[2,3,2,3] row_mask:0xf bank_mask:0xf
v_cvt_pk_bf16_f32 v64, v88, v89
v_cndmask_b32_dpp v1, v3, v1, vcc quad_perm:[2,3,2,3] row_mask:0xf bank_mask:0xf
v_exp_f32 v0, v0
v_mfma_f32_16x16x16_bf16 v[16:19], v[100:101], v[64:65], 0
v_exp_f32 v1, v1
v_cndmask_b32_dpp v4, v6, v4, vcc quad_perm:[2,3,2,3] row_mask:0xf bank_mask:0xf
v_mfma_f32_16x16x16_bf16 v[8:11], v[124:125], v[64:65], 0
v_cndmask_b32_dpp v5, v7, v5, vcc quad_perm:[2,3,2,3] row_mask:0xf bank_mask:0xf
v_exp_f32 v4, v4
v_exp_f32 v5, v5
v_cvt_pk_bf16_f32 v92, v0, v1
v_cvt_pk_bf16_f32 v94, v4, v5
v_mov_b32 v80, 0
v_mov_b32_dpp v93, v92 quad_perm:[0,1,0,1] row_mask:0xf bank_mask:0xf
v_mov_b32_dpp v95, v94 quad_perm:[0,1,0,1] row_mask:0xf bank_mask:0xf
v_mov_b32 v81, 0
v_mov_b32 v82, 0
v_mfma_f32_16x16x32_bf16 v[16:19], v[100:103], v[92:95], v[16:19]
v_mov_b32 v83, 0
v_mov_b32 v84, 0
v_mfma_f32_16x16x32_bf16 v[8:11], v[96:99], v[92:95], v[8:11]
s_nop 1
v_mov_b32 v85, 0
v_mov_b32 v86, 0
v_mov_b32 v87, 0
v_rcp_f32 v126, v16
v_subrev_u32 v127, 0x21800000, v16
v_cmp_lt_u32 vcc, 0x3c000000, v127
v_pk_mul_f32 v[8:9], v[8:9], v[126:127] op_sel_hi:[1,0]
v_pk_mul_f32 v[10:11], v[10:11], v[126:127] op_sel_hi:[1,0]
s_and_b32 s32, vcc_lo, 0xcccc
v_cvt_pk_bf16_f32 v126, v8, v9
v_cvt_pk_bf16_f32 v127, v10, v11
s_cbranch_scc1 main_kernel_c2_sm_f
main_kernel_c2_ost:
buffer_store_dwordx2 v[126:127], v118, s[4:7], s22 offen
v_cmp_eq_u32 s[0:1], 0, v123
v_mov_b32 v24, -1
v_mov_b32 v25, -1
v_mov_b32 v26, -1
v_mov_b32 v27, -1
ds_read_b128 v[32:35], v113 offset:0
ds_read_b128 v[36:39], v113 offset:1024
ds_read_b128 v[40:43], v113 offset:2048
ds_read_b128 v[44:47], v113 offset:3072
ds_read_b128 v[48:51], v113 offset:4096
ds_read_b128 v[52:55], v113 offset:5120
s_and_b32 s10, s1, 0x3f00
buffer_store_dwordx4 v[24:27], v116, s[4:7], s3 offen
s_barrier
buffer_load_dwordx4 v[0:3], v116, s[4:7], s23 offen sc1
ds_read_b128 v[56:59], v113 offset:6144
ds_read_b128 v[60:63], v113 offset:7168
s_add_u32 s37, s37, 65536
s_add_u32 s26, s26, 65536
s_nop 1
s_xor_b32 s32, s23, 1024
buffer_load_dwordx4 v[4:7], v116, s[4:7], s32 offen sc1
ds_read_b128 v[64:67], v113 offset:8192
ds_read_b128 v[68:71], v113 offset:9216
s_nop 3
s_xor_b32 s32, s23, 2048
buffer_load_dwordx4 v[8:11], v116, s[4:7], s32 offen sc1
ds_read_b128 v[72:75], v113 offset:10240
ds_read_b128 v[76:79], v113 offset:11264
s_nop 3
s_xor_b32 s32, s23, 3072
buffer_load_dwordx4 v[12:15], v116, s[4:7], s32 offen sc1
ds_read_b128 v[88:91], v113 offset:12288
ds_read_b128 v[92:95], v113 offset:13312
s_nop 3
s_xor_b32 s32, s23, 4096
buffer_load_dwordx4 v[16:19], v116, s[4:7], s32 offen sc1
s_nop 7
s_xor_b32 s32, s23, 5120
buffer_load_dwordx4 v[20:23], v116, s[4:7], s32 offen sc1
s_nop 7
s_xor_b32 s32, s23, 6144
buffer_load_dwordx4 v[24:27], v116, s[4:7], s32 offen sc1
s_nop 7
s_xor_b32 s32, s23, 7168
buffer_load_dwordx4 v[28:31], v116, s[4:7], s32 offen sc1
s_waitcnt lgkmcnt(12)
s_waitcnt vmcnt(7)
v_cmp_u_f32 vcc, v0, v2
s_cbranch_vccnz main_kernel_c2_o0_f
main_kernel_c2_o0:
v_smfmac_f32_16x16x64_bf16 v[80:83], v[0:3], v[32:39], v112
ds_read_b128 v[32:35], v113 offset:14336
ds_read_b128 v[36:39], v113 offset:15360
s_waitcnt lgkmcnt(12)
s_waitcnt vmcnt(6)
v_cmp_u_f32 vcc, v4, v6
v_smfmac_f32_16x16x64_bf16 v[84:87], v[0:3], v[40:47], v112
ds_read_b128 v[40:43], v113 offset:16384
ds_read_b128 v[44:47], v113 offset:17408
buffer_store_dwordx2 v[114:115], v119, s[4:7], s37 offen sc1
s_cbranch_vccnz main_kernel_c2_o1_f
main_kernel_c2_o1:
s_waitcnt lgkmcnt(12)
v_smfmac_f32_16x16x64_bf16 v[80:83], v[4:7], v[48:55], v112
ds_read_b128 v[48:51], v113 offset:18432
ds_read_b128 v[52:55], v113 offset:19456
s_waitcnt lgkmcnt(12)
s_waitcnt vmcnt(6)
v_cmp_u_f32 vcc, v8, v10
v_smfmac_f32_16x16x64_bf16 v[84:87], v[4:7], v[56:63], v112
ds_read_b128 v[56:59], v113 offset:20480
ds_read_b128 v[60:63], v113 offset:21504
buffer_store_dword v124, v120, s[4:7], s26 offen sc1
s_cbranch_vccnz main_kernel_c2_o2_f
main_kernel_c2_o2:
s_waitcnt lgkmcnt(12)
v_smfmac_f32_16x16x64_bf16 v[80:83], v[8:11], v[64:71], v112
ds_read_b128 v[64:67], v113 offset:22528
ds_read_b128 v[68:71], v113 offset:23552
s_waitcnt lgkmcnt(12)
s_waitcnt vmcnt(6)
v_cmp_u_f32 vcc, v12, v14
v_smfmac_f32_16x16x64_bf16 v[84:87], v[8:11], v[72:79], v112
ds_read_b128 v[72:75], v113 offset:24576
ds_read_b128 v[76:79], v113 offset:25600
s_cbranch_vccnz main_kernel_c2_o3_f
main_kernel_c2_o3:
s_waitcnt lgkmcnt(12)
v_smfmac_f32_16x16x64_bf16 v[80:83], v[12:15], v[88:95], v112
ds_read_b128 v[88:91], v113 offset:26624
ds_read_b128 v[92:95], v113 offset:27648
s_waitcnt lgkmcnt(12)
s_waitcnt vmcnt(5)
v_cmp_u_f32 vcc, v16, v18
v_smfmac_f32_16x16x64_bf16 v[84:87], v[12:15], v[32:39], v112
ds_read_b128 v[32:35], v113 offset:28672
ds_read_b128 v[36:39], v113 offset:29696
s_cbranch_vccnz main_kernel_c2_o4_f
main_kernel_c2_o4:
s_waitcnt lgkmcnt(12)
v_smfmac_f32_16x16x64_bf16 v[80:83], v[16:19], v[40:47], v112
ds_read_b128 v[40:43], v113 offset:30720
ds_read_b128 v[44:47], v113 offset:31744
s_waitcnt lgkmcnt(12)
s_waitcnt vmcnt(4)
v_cmp_u_f32 vcc, v20, v22
v_smfmac_f32_16x16x64_bf16 v[84:87], v[16:19], v[48:55], v112
s_cbranch_vccnz main_kernel_c2_o5_f
main_kernel_c2_o5:
s_waitcnt lgkmcnt(10)
v_smfmac_f32_16x16x64_bf16 v[80:83], v[20:23], v[56:63], v112
s_waitcnt lgkmcnt(8)
s_waitcnt vmcnt(3)
v_cmp_u_f32 vcc, v24, v26
v_smfmac_f32_16x16x64_bf16 v[84:87], v[20:23], v[64:71], v112
s_cbranch_vccnz main_kernel_c2_o6_f
main_kernel_c2_o6:
s_waitcnt lgkmcnt(6)
v_smfmac_f32_16x16x64_bf16 v[80:83], v[24:27], v[72:79], v112
s_waitcnt lgkmcnt(4)
v_smfmac_f32_16x16x64_bf16 v[84:87], v[24:27], v[88:95], v112
s_waitcnt lgkmcnt(2)
s_waitcnt vmcnt(2)
v_cmp_u_f32 vcc, v28, v30
s_cbranch_vccnz main_kernel_c2_o7_f
main_kernel_c2_o7:
v_smfmac_f32_16x16x64_bf16 v[80:83], v[28:31], v[32:39], v112
s_waitcnt lgkmcnt(0)
v_smfmac_f32_16x16x64_bf16 v[84:87], v[28:31], v[40:47], v112
s_nop 4
v_cvt_pk_bf16_f32 v80, v80, v81
v_cvt_pk_bf16_f32 v81, v82, v83
ds_write_b64 v116, v[80:81] offset:21504
v_cvt_pk_bf16_f32 v82, v84, v85
v_cvt_pk_bf16_f32 v83, v86, v87
ds_write_b64 v116, v[82:83] offset:23552
s_waitcnt lgkmcnt(0)
s_barrier
ds_read_b128 v[72:75], v116 offset:20480
ds_read_b128 v[76:79], v116 offset:21504
s_mov_b32 m0, 28672
s_cmp_lg_u32 s10, 0
s_waitcnt lgkmcnt(1)
v_mfma_f32_16x16x32_bf16 v[64:67], v[72:75], v[108:111], 0
s_waitcnt lgkmcnt(0)
v_mfma_f32_16x16x32_bf16 v[64:67], v[76:79], v[108:111], v[64:67]
s_nop 7
v_cvt_pk_f16_f32 v68, v64, v65
v_cvt_pk_f16_f32 v69, v66, v67
buffer_store_dwordx2 v[68:69], v125, s[4:7], s25 offen
s_cbranch_scc1 main_kernel_c2_kvw
main_kernel_c2_kvok:
s_nop 3
buffer_load_dwordx4 v116, s[4:7], s27 offen sc1 lds
buffer_load_dwordx4 v116, s[4:7], s27 offen offset:1024 sc1 lds
s_mov_b32 m0, 30720
s_xor_b32 s32, s27, 2048
buffer_load_dwordx4 v116, s[4:7], s32 offen offset:1024 sc1 lds
s_add_u32 s27, s27, 0x40000
s_branch main_kernel_c2_top
main_kernel_c2_kvw:
s_mov_b32 exec_lo, 0
s_mov_b32 exec_hi, 0x3f00
v_subrev_u32 v127, 128, v121
main_kernel_c2_kvp:
buffer_load_dword v126, v127, s[4:7], 0 offen sc1
s_waitcnt vmcnt(0)
v_cmp_eq_u32 vcc, 0, v126
s_cbranch_vccz main_kernel_c2_kvp_ok
s_sleep 2
s_sub_u32 s29, s29, 1
s_cbranch_scc0 main_kernel_c2_kvp
s_branch main_kernel_end
main_kernel_c2_kvp_ok:
s_mov_b64 exec, -1
s_branch main_kernel_c2_kvok
main_kernel_c2_last:
s_add_u32 s37, s37, 65536
s_add_u32 s26, s26, 65536
buffer_store_dwordx2 v[114:115], v119, s[4:7], s37 offen sc1
v_smfmac_f32_16x16x64_f16 v[88:91], v[20:23], v[168:175], v112
v_smfmac_f32_16x16x64_f16 v[88:91], v[24:27], v[176:183], v112
v_smfmac_f32_16x16x64_f16 v[88:91], v[28:31], v[184:191], v112
v_smfmac_f32_16x16x64_f16 v[88:91], v[32:35], v[192:199], v112
v_smfmac_f32_16x16x64_f16 v[88:91], v[36:39], v[200:207], v112
v_smfmac_f32_16x16x64_f16 v[88:91], v[40:43], v[208:215], v112
v_smfmac_f32_16x16x64_f16 v[88:91], v[44:47], v[216:223], v112
v_smfmac_f32_16x16x64_f16 v[88:91], v[48:51], v[224:231], v112
v_smfmac_f32_16x16x64_f16 v[88:91], v[52:55], v[232:239], v112
v_smfmac_f32_16x16x64_f16 v[88:91], v[56:59], v[240:247], v112
v_smfmac_f32_16x16x64_f16 v[88:91], v[60:63], v[248:255], v112
s_nop 7
v_permlane32_swap_b32 v88, v90
s_nop 1
v_permlane32_swap_b32 v89, v91
s_nop 1
v_pk_add_f32 v[88:89], v[88:89], v[90:91]
s_nop 1
v_cvt_pk_bf16_f32 v124, v88, v89
s_nop 1
buffer_store_dword v124, v120, s[4:7], s26 offen sc1
s_branch main_kernel_end
main_kernel_c2_m0_f:
s_waitcnt lgkmcnt(0)
buffer_load_dwordx4 v[0:3], v116, s[4:7], s18 offen sc1
buffer_load_dwordx4 v[64:67], v116, s[4:7], s19 offen sc1
s_xor_b32 s32, s18, 1024
buffer_load_dwordx4 v[16:19], v116, s[4:7], s32 offen sc1
s_xor_b32 s32, s19, 1024
buffer_load_dwordx4 v[68:71], v116, s[4:7], s32 offen sc1
s_xor_b32 s32, s18, 2048
buffer_load_dwordx4 v[32:35], v116, s[4:7], s32 offen sc1
s_xor_b32 s32, s19, 2048
buffer_load_dwordx4 v[72:75], v116, s[4:7], s32 offen sc1
s_xor_b32 s32, s18, 3072
buffer_load_dwordx4 v[48:51], v116, s[4:7], s32 offen sc1
s_xor_b32 s32, s19, 3072
buffer_load_dwordx4 v[76:79], v116, s[4:7], s32 offen sc1
s_sub_u32 s29, s29, 1
s_cbranch_scc1 main_kernel_end
s_waitcnt vmcnt(0)
v_max_u32 v126, v0, v2
v_max3_u32 v126, v126, v64, v66
v_cmp_eq_u32 vcc, -1, v126
s_cbranch_vccnz main_kernel_c2_m0_f
v_pk_add_f16 v0, v0, v64
v_pk_add_f16 v1, v1, v65
v_pk_add_f16 v2, v2, v66
v_pk_add_f16 v3, v3, v67
s_nop 0
s_branch main_kernel_c2_m0
main_kernel_c2_m1_f:
s_waitcnt lgkmcnt(0)
s_xor_b32 s32, s18, 1024
buffer_load_dwordx4 v[16:19], v116, s[4:7], s32 offen sc1
s_xor_b32 s32, s19, 1024
buffer_load_dwordx4 v[68:71], v116, s[4:7], s32 offen sc1
s_xor_b32 s32, s18, 2048
buffer_load_dwordx4 v[32:35], v116, s[4:7], s32 offen sc1
s_xor_b32 s32, s19, 2048
buffer_load_dwordx4 v[72:75], v116, s[4:7], s32 offen sc1
s_xor_b32 s32, s18, 3072
buffer_load_dwordx4 v[48:51], v116, s[4:7], s32 offen sc1
s_xor_b32 s32, s19, 3072
buffer_load_dwordx4 v[76:79], v116, s[4:7], s32 offen sc1
s_sub_u32 s29, s29, 1
s_cbranch_scc1 main_kernel_end
s_waitcnt vmcnt(0)
v_max_u32 v126, v16, v18
v_max3_u32 v126, v126, v68, v70
v_cmp_eq_u32 vcc, -1, v126
s_cbranch_vccnz main_kernel_c2_m1_f
v_pk_add_f16 v16, v16, v68
v_pk_add_f16 v17, v17, v69
v_pk_add_f16 v18, v18, v70
v_pk_add_f16 v19, v19, v71
s_nop 0
s_branch main_kernel_c2_m1
main_kernel_c2_m2_f:
s_waitcnt lgkmcnt(0)
s_xor_b32 s32, s18, 2048
buffer_load_dwordx4 v[32:35], v116, s[4:7], s32 offen sc1
s_xor_b32 s32, s19, 2048
buffer_load_dwordx4 v[72:75], v116, s[4:7], s32 offen sc1
s_xor_b32 s32, s18, 3072
buffer_load_dwordx4 v[48:51], v116, s[4:7], s32 offen sc1
s_xor_b32 s32, s19, 3072
buffer_load_dwordx4 v[76:79], v116, s[4:7], s32 offen sc1
s_sub_u32 s29, s29, 1
s_cbranch_scc1 main_kernel_end
s_waitcnt vmcnt(0)
v_max_u32 v126, v32, v34
v_max3_u32 v126, v126, v72, v74
v_cmp_eq_u32 vcc, -1, v126
s_cbranch_vccnz main_kernel_c2_m2_f
v_pk_add_f16 v32, v32, v72
v_pk_add_f16 v33, v33, v73
v_pk_add_f16 v34, v34, v74
v_pk_add_f16 v35, v35, v75
ds_write_b128 v116, v[32:35] offset:10240
s_branch main_kernel_c2_m2
main_kernel_c2_m3_f:
s_waitcnt lgkmcnt(0)
s_xor_b32 s32, s18, 3072
buffer_load_dwordx4 v[48:51], v116, s[4:7], s32 offen sc1
s_xor_b32 s32, s19, 3072
buffer_load_dwordx4 v[76:79], v116, s[4:7], s32 offen sc1
s_sub_u32 s29, s29, 1
s_cbranch_scc1 main_kernel_end
s_waitcnt vmcnt(0)
v_max_u32 v126, v48, v50
v_max3_u32 v126, v126, v76, v78
v_cmp_eq_u32 vcc, -1, v126
s_cbranch_vccnz main_kernel_c2_m3_f
v_pk_add_f16 v48, v48, v76
v_pk_add_f16 v49, v49, v77
v_pk_add_f16 v50, v50, v78
v_pk_add_f16 v51, v51, v79
ds_write_b128 v116, v[48:51] offset:14336
s_branch main_kernel_c2_m3
main_kernel_c2_z_f:
buffer_load_dwordx4 v[8:11], v116, s[4:7], s20 offen offset:0 sc1
buffer_load_dwordx4 v[12:15], v116, s[4:7], s20 offen offset:1024 sc1
s_memtime s[32:33]
ds_read_b32 v126, v116 offset:18432
s_sub_u32 s34, s19, s54
s_xor_b32 s34, s34, 0x2000
s_lshl_b32 s35, s12, 15
s_add_u32 s34, s34, s35
s_lshl_b32 s35, s13, 8
s_add_u32 s35, s35, s34
s_add_u32 s34, s34, 0x4000
s_waitcnt lgkmcnt(0)
s_sub_u32 s32, s32, 450
v_sub_u32 v127, s32, v126
buffer_store_dword v127, off, s[4:7], s34
s_sub_u32 s29, s29, 1
s_cbranch_scc1 main_kernel_end
s_waitcnt vmcnt(1)
main_kernel_c2_z_g:
v_max_u32 v126, v8, v10
v_max3_u32 v126, v126, v12, v14
v_cmp_eq_u32 vcc, -1, v126
s_cbranch_vccnz main_kernel_c2_z_h
v_mfma_f32_16x16x32_bf16 v[88:91], v[8:11], v[8:11], v[92:95]
v_mfma_f32_16x16x32_bf16 v[0:3], v[16:19], v[8:11], v[80:83]
v_mfma_f32_16x16x32_bf16 v[4:7], v[20:23], v[8:11], v[84:87]
v_mfma_f32_16x16x32_bf16 v[88:91], v[12:15], v[12:15], v[88:91]
v_mfma_f32_16x16x32_bf16 v[0:3], v[24:27], v[12:15], v[0:3]
v_mfma_f32_16x16x32_bf16 v[4:7], v[28:31], v[12:15], v[4:7]
buffer_store_dword v127, off, s[4:7], s35 offset:132 sc1
s_mov_b32 vcc_lo, 0xcccccccc
s_mov_b32 vcc_hi, 0xcccccccc
s_branch main_kernel_c2_z
main_kernel_c2_z_h:
buffer_load_dwordx4 v[8:11], v116, s[4:7], s20 offen offset:0 sc1
buffer_load_dwordx4 v[12:15], v116, s[4:7], s20 offen offset:1024 sc1
s_sub_u32 s29, s29, 1
s_cbranch_scc1 main_kernel_end
v_add_u32 v127, 300, v127
s_waitcnt vmcnt(0)
s_branch main_kernel_c2_z_g
main_kernel_c2_sm_f:
s_waitcnt vmcnt(0) lgkmcnt(0)
buffer_load_dwordx4 v[8:11], v116, s[4:7], s20 offen offset:0 sc1
buffer_load_dwordx4 v[12:15], v116, s[4:7], s20 offen offset:1024 sc1
ds_read_b128 v[0:3], v116 offset:16384
ds_read_b128 v[4:7], v116 offset:17408
ds_read_b128 v[64:67], v116 offset:24576
ds_read_b128 v[68:71], v116 offset:28672
ds_read_b128 v[72:75], v116 offset:25600
ds_read_b128 v[76:79], v116 offset:29696
ds_read_b128 v[16:19], v116 offset:26624
ds_read_b128 v[20:23], v116 offset:30720
ds_read_b128 v[24:27], v116 offset:27648
ds_read_b128 v[28:31], v116 offset:31744
s_waitcnt vmcnt(0)
s_waitcnt lgkmcnt(0)
v_mfma_f32_16x16x32_bf16 v[80:83], v[64:67], v[0:3], 0
v_mfma_f32_16x16x32_bf16 v[84:87], v[68:71], v[0:3], 0
v_mfma_f32_16x16x32_bf16 v[92:95], v[0:3], v[0:3], 0
v_mfma_f32_16x16x32_bf16 v[80:83], v[72:75], v[4:7], v[80:83]
v_mfma_f32_16x16x32_bf16 v[84:87], v[76:79], v[4:7], v[84:87]
v_mfma_f32_16x16x32_bf16 v[92:95], v[4:7], v[4:7], v[92:95]
v_mfma_f32_16x16x32_bf16 v[0:3], v[16:19], v[8:11], v[80:83]
v_mfma_f32_16x16x32_bf16 v[4:7], v[20:23], v[8:11], v[84:87]
v_mfma_f32_16x16x32_bf16 v[88:91], v[8:11], v[8:11], v[92:95]
v_mfma_f32_16x16x32_bf16 v[0:3], v[24:27], v[12:15], v[0:3]
v_mfma_f32_16x16x32_bf16 v[4:7], v[28:31], v[12:15], v[4:7]
v_mfma_f32_16x16x32_bf16 v[88:91], v[12:15], v[12:15], v[88:91]
s_nop 7
v_mov_b32 v65, 0
v_max_f32 v126, v88, v89
v_mul_f32 v126, s30, v126
v_max3_f32 v126, v126, v0, v1
v_max3_f32 v126, v126, v2, v3
v_max3_f32 v126, v126, v4, v5
v_max3_f32 v126, v126, v6, v7
v_mov_b32 v127, v126
s_nop 1
v_permlane32_swap_b32 v126, v127
v_max_f32 v126, v126, v127
v_mov_b32 v127, v126
s_nop 1
v_permlane16_swap_b32 v126, v127
v_max_f32 v126, v126, v127
v_mul_f32 v127, 0x40faf233, v126
s_mov_b32 vcc_lo, 0xcccccccc
s_mov_b32 vcc_hi, 0xcccccccc
v_sub_f32 v0, v0, v126
v_sub_f32 v1, v1, v126
v_sub_f32 v2, v2, v126
v_sub_f32 v3, v3, v126
v_sub_f32 v4, v4, v126
v_sub_f32 v5, v5, v126
v_sub_f32 v6, v6, v126
v_sub_f32 v7, v7, v126
v_sub_f32 v88, v88, v127
v_sub_f32 v89, v89, v127
s_waitcnt lgkmcnt(0)
s_nop 0
v_mul_f32 v88, s30, v88
v_mul_f32 v89, s30, v89
v_exp_f32 v88, v88
v_exp_f32 v89, v89
v_cndmask_b32_dpp v0, v2, v0, vcc quad_perm:[2,3,2,3] row_mask:0xf bank_mask:0xf
v_cvt_pk_bf16_f32 v64, v88, v89
v_cndmask_b32_dpp v1, v3, v1, vcc quad_perm:[2,3,2,3] row_mask:0xf bank_mask:0xf
v_exp_f32 v0, v0
v_mfma_f32_16x16x16_bf16 v[16:19], v[100:101], v[64:65], 0
v_exp_f32 v1, v1
v_cndmask_b32_dpp v4, v6, v4, vcc quad_perm:[2,3,2,3] row_mask:0xf bank_mask:0xf
v_mfma_f32_16x16x16_bf16 v[8:11], v[124:125], v[64:65], 0
v_cndmask_b32_dpp v5, v7, v5, vcc quad_perm:[2,3,2,3] row_mask:0xf bank_mask:0xf
v_exp_f32 v4, v4
v_exp_f32 v5, v5
v_cvt_pk_bf16_f32 v92, v0, v1
v_cvt_pk_bf16_f32 v94, v4, v5
v_mov_b32 v80, 0
v_mov_b32_dpp v93, v92 quad_perm:[0,1,0,1] row_mask:0xf bank_mask:0xf
v_mov_b32_dpp v95, v94 quad_perm:[0,1,0,1] row_mask:0xf bank_mask:0xf
v_mov_b32 v81, 0
v_mov_b32 v82, 0
v_mfma_f32_16x16x32_bf16 v[16:19], v[100:103], v[92:95], v[16:19]
v_mov_b32 v83, 0
v_mov_b32 v84, 0
v_mfma_f32_16x16x32_bf16 v[8:11], v[96:99], v[92:95], v[8:11]
s_nop 1
v_mov_b32 v85, 0
v_mov_b32 v86, 0
v_mov_b32 v87, 0
v_rcp_f32 v126, v16
v_subrev_u32 v127, 0x21800000, v16
v_cmp_lt_u32 vcc, 0x3c000000, v127
v_pk_mul_f32 v[8:9], v[8:9], v[126:127] op_sel_hi:[1,0]
v_pk_mul_f32 v[10:11], v[10:11], v[126:127] op_sel_hi:[1,0]
s_and_b32 s32, vcc_lo, 0xcccc
v_cvt_pk_bf16_f32 v126, v8, v9
v_cvt_pk_bf16_f32 v127, v10, v11
s_branch main_kernel_c2_ost
main_kernel_c2_o0_f:
s_nop 0
buffer_load_dwordx4 v[0:3], v116, s[4:7], s23 offen sc1
s_xor_b32 s32, s23, 1024
buffer_load_dwordx4 v[4:7], v116, s[4:7], s32 offen sc1
s_sub_u32 s29, s29, 1
s_cbranch_scc1 main_kernel_end
s_waitcnt vmcnt(0)
v_max_u32 v126, v0, v2
v_cmp_eq_u32 vcc, -1, v126
s_cbranch_vccnz main_kernel_c2_o0_f
s_branch main_kernel_c2_o0
main_kernel_c2_o1_f:
s_nop 0
s_xor_b32 s32, s23, 1024
buffer_load_dwordx4 v[4:7], v116, s[4:7], s32 offen sc1
s_xor_b32 s32, s23, 2048
buffer_load_dwordx4 v[8:11], v116, s[4:7], s32 offen sc1
s_sub_u32 s29, s29, 1
s_cbranch_scc1 main_kernel_end
s_waitcnt vmcnt(0)
v_max_u32 v126, v4, v6
v_cmp_eq_u32 vcc, -1, v126
s_cbranch_vccnz main_kernel_c2_o1_f
s_branch main_kernel_c2_o1
main_kernel_c2_o2_f:
s_nop 0
s_xor_b32 s32, s23, 2048
buffer_load_dwordx4 v[8:11], v116, s[4:7], s32 offen sc1
s_xor_b32 s32, s23, 3072
buffer_load_dwordx4 v[12:15], v116, s[4:7], s32 offen sc1
s_sub_u32 s29, s29, 1
s_cbranch_scc1 main_kernel_end
s_waitcnt vmcnt(0)
v_max_u32 v126, v8, v10
v_cmp_eq_u32 vcc, -1, v126
s_cbranch_vccnz main_kernel_c2_o2_f
s_branch main_kernel_c2_o2
main_kernel_c2_o3_f:
s_nop 0
s_xor_b32 s32, s23, 3072
buffer_load_dwordx4 v[12:15], v116, s[4:7], s32 offen sc1
s_xor_b32 s32, s23, 4096
buffer_load_dwordx4 v[16:19], v116, s[4:7], s32 offen sc1
s_sub_u32 s29, s29, 1
s_cbranch_scc1 main_kernel_end
s_waitcnt vmcnt(0)
v_max_u32 v126, v12, v14
v_cmp_eq_u32 vcc, -1, v126
s_cbranch_vccnz main_kernel_c2_o3_f
s_branch main_kernel_c2_o3
main_kernel_c2_o4_f:
s_nop 0
s_xor_b32 s32, s23, 4096
buffer_load_dwordx4 v[16:19], v116, s[4:7], s32 offen sc1
s_xor_b32 s32, s23, 5120
buffer_load_dwordx4 v[20:23], v116, s[4:7], s32 offen sc1
s_sub_u32 s29, s29, 1
s_cbranch_scc1 main_kernel_end
s_waitcnt vmcnt(0)
v_max_u32 v126, v16, v18
v_cmp_eq_u32 vcc, -1, v126
s_cbranch_vccnz main_kernel_c2_o4_f
s_branch main_kernel_c2_o4
main_kernel_c2_o5_f:
s_nop 0
s_xor_b32 s32, s23, 5120
buffer_load_dwordx4 v[20:23], v116, s[4:7], s32 offen sc1
s_xor_b32 s32, s23, 6144
buffer_load_dwordx4 v[24:27], v116, s[4:7], s32 offen sc1
s_sub_u32 s29, s29, 1
s_cbranch_scc1 main_kernel_end
s_waitcnt vmcnt(0)
v_max_u32 v126, v20, v22
v_cmp_eq_u32 vcc, -1, v126
s_cbranch_vccnz main_kernel_c2_o5_f
s_branch main_kernel_c2_o5
main_kernel_c2_o6_f:
s_nop 0
s_xor_b32 s32, s23, 6144
buffer_load_dwordx4 v[24:27], v116, s[4:7], s32 offen sc1
s_xor_b32 s32, s23, 7168
buffer_load_dwordx4 v[28:31], v116, s[4:7], s32 offen sc1
s_sub_u32 s29, s29, 1
s_cbranch_scc1 main_kernel_end
s_waitcnt vmcnt(0)
v_max_u32 v126, v24, v26
v_cmp_eq_u32 vcc, -1, v126
s_cbranch_vccnz main_kernel_c2_o6_f
s_branch main_kernel_c2_o6
main_kernel_c2_o7_f:
s_nop 0
s_xor_b32 s32, s23, 7168
buffer_load_dwordx4 v[28:31], v116, s[4:7], s32 offen sc1
s_sub_u32 s29, s29, 1
s_cbranch_scc1 main_kernel_end
s_waitcnt vmcnt(0)
v_max_u32 v126, v28, v30
v_cmp_eq_u32 vcc, -1, v126
s_cbranch_vccnz main_kernel_c2_o7_f
s_branch main_kernel_c2_o7
.p2align 6
main_kernel_c3_top:
s_barrier
buffer_load_dwordx4 v[0:3], v116, s[4:7], s18 offen sc1
s_add_u32 s20, s20, 0x40000
s_bitset0_b32 s20, 20
s_add_u32 s21, s21, 0x40000
s_bitset0_b32 s21, 20
s_add_u32 s22, s22, 0x40000
s_bitset0_b32 s22, 20
s_add_u32 s23, s23, 0x40000
s_bitset0_b32 s23, 20
s_xor_b32 s32, s18, 1024
buffer_load_dwordx4 v[16:19], v116, s[4:7], s32 offen sc1
s_add_u32 s3, s3, 0x40000
s_bitset0_b32 s3, 20
s_add_u32 s17, s17, 1
s_bitcmp1_b32 0x77777777, s17
s_cselect_b32 s33, 0x800, 0
s_xor_b32 s54, s54, s33
s_add_u32 s25, s25, 0x40000
s_bitset0_b32 s25, 20
s_nop 0
buffer_load_dwordx4 v[64:67], v116, s[4:7], s19 offen sc1
v_mov_b32 v80, 0
v_mov_b32 v81, 0
s_nop 3
s_xor_b32 s32, s19, 1024
buffer_load_dwordx4 v[68:71], v116, s[4:7], s32 offen sc1
v_mov_b32 v82, 0
v_mov_b32 v83, 0
s_nop 3
s_xor_b32 s32, s18, 2048
buffer_load_dwordx4 v[32:35], v116, s[4:7], s32 offen sc1
v_mov_b32 v84, 0
v_mov_b32 v85, 0
s_nop 3
s_xor_b32 s32, s19, 2048
buffer_load_dwordx4 v[72:75], v116, s[4:7], s32 offen sc1
v_mov_b32 v86, 0
v_mov_b32 v87, 0
s_nop 3
s_xor_b32 s32, s18, 3072
buffer_load_dwordx4 v[48:51], v116, s[4:7], s32 offen sc1
v_mov_b32 v88, 0
v_mov_b32 v89, 0
s_nop 3
s_xor_b32 s32, s19, 3072
buffer_load_dwordx4 v[76:79], v116, s[4:7], s32 offen sc1
s_memtime s[40:41]
s_memrealtime s[80:81]
s_memrealtime s[82:83]
s_memrealtime s[84:85]
s_memrealtime s[86:87]
s_memrealtime s[88:89]
s_memrealtime s[90:91]
s_memrealtime s[92:93]
s_memrealtime s[94:95]
s_memrealtime s[96:97]
s_memrealtime s[98:99]
s_memrealtime s[100:101]
s_sub_u32 s32, s15, s16
s_lshr_b32 s33, s17, 1
s_min_u32 s33, s33, 3
s_ashr_i32 s32, s32, s33
s_add_u32 s11, s11, s32
s_sub_u32 s32, s16, s27
s_sub_u32 s32, s32, s39
s_ashr_i32 s32, s32, 2
s_add_u32 s39, s39, s32
s_mov_b32 s27, s16
s_mov_b32 s2, s31
v_mov_b32 v126, s11
s_add_u32 s32, s43, 1590
v_mov_b32 v127, s32
s_waitcnt lgkmcnt(0)
ds_write_b32 v116, v126 offset:18432
s_add_u32 s80, s80, s82
s_add_u32 s80, s80, s84
s_add_u32 s80, s80, s86
s_add_u32 s80, s80, s88
s_add_u32 s80, s80, s90
s_add_u32 s80, s80, s92
s_add_u32 s80, s80, s94
s_add_u32 s80, s80, s96
s_add_u32 s80, s80, s98
s_add_u32 s80, s80, s100
s_lshl1_add_u32 s80, s80, s11
s_sub_u32 s15, s40, s80
s_add_u32 s32, s15, s39
v_mov_b32 v126, s32
buffer_store_dwordx2 v[126:127], off, s[4:7], s44 offset:128 sc1
v_mov_b32 v90, 0
v_mov_b32 v91, 0
s_waitcnt vmcnt(6)
v_pk_add_f16 v0, v0, v64
v_pk_add_f16 v1, v1, v65
v_pk_add_f16 v2, v2, v66
v_pk_add_f16 v3, v3, v67
v_cmp_u_f16 vcc, v0, v2
s_cbranch_vccnz main_kernel_c3_m0_f
main_kernel_c3_m0:
v_smfmac_f32_16x16x64_f16 v[80:83], v[0:3], a[0:7], v112
ds_write_b128 v116, v[0:3] offset:3072
v_smfmac_f32_16x16x64_f16 v[84:87], v[0:3], a[128:135], v112
buffer_load_dword v123, v121, s[4:7], 0 offen sc1
s_waitcnt vmcnt(6)
v_pk_add_f16 v16, v16, v68
v_pk_add_f16 v17, v17, v69
v_pk_add_f16 v18, v18, v70
v_pk_add_f16 v19, v19, v71
v_cmp_u_f16 vcc, v16, v18
s_waitcnt lgkmcnt(0)
s_barrier
ds_read_b128 v[4:7], v116 offset:2048
s_cbranch_vccnz main_kernel_c3_m1_f
main_kernel_c3_m1:
v_smfmac_f32_16x16x64_f16 v[80:83], v[16:19], a[8:15], v112
ds_write_b128 v116, v[16:19] offset:7168
v_smfmac_f32_16x16x64_f16 v[84:87], v[16:19], a[136:143], v112
ds_read_b128 v[8:11], v116 offset:1024
v_smfmac_f32_16x16x64_f16 v[88:91], v[0:3], v[128:135], v112
ds_read_b128 v[12:15], v116 offset:0
s_waitcnt lgkmcnt(3)
v_smfmac_f32_16x16x64_f16 v[80:83], v[4:7], a[32:39], v112
v_smfmac_f32_16x16x64_f16 v[84:87], v[4:7], a[160:167], v112
v_smfmac_f32_16x16x64_f16 v[88:91], v[4:7], v[136:143], v112
s_waitcnt lgkmcnt(2)
s_barrier
s_waitcnt lgkmcnt(1)
v_smfmac_f32_16x16x64_f16 v[80:83], v[8:11], a[64:71], v112
s_waitcnt vmcnt(4)
ds_read_b128 v[20:23], v116 offset:6144
v_pk_add_f16 v32, v32, v72
v_smfmac_f32_16x16x64_f16 v[84:87], v[8:11], a[192:199], v112
ds_read_b128 v[24:27], v116 offset:5120
s_waitcnt lgkmcnt(2)
v_pk_add_f16 v33, v33, v73
v_smfmac_f32_16x16x64_f16 v[80:83], v[12:15], a[96:103], v112
ds_read_b128 v[28:31], v116 offset:4096
v_pk_add_f16 v34, v34, v74
v_smfmac_f32_16x16x64_f16 v[84:87], v[12:15], a[224:231], v112
s_waitcnt lgkmcnt(2)
v_pk_add_f16 v35, v35, v75
v_smfmac_f32_16x16x64_f16 v[80:83], v[20:23], a[40:47], v112
v_cmp_u_f16 vcc, v32, v34
v_smfmac_f32_16x16x64_f16 v[84:87], v[20:23], a[168:175], v112
ds_write_b128 v116, v[32:35] offset:11264
s_cbranch_vccnz main_kernel_c3_m2_f
main_kernel_c3_m2:
v_smfmac_f32_16x16x64_f16 v[80:83], v[32:35], a[16:23], v112
buffer_load_dwordx4 v[96:99], v116, s[4:7], s28 offen sc1
v_smfmac_f32_16x16x64_f16 v[84:87], v[32:35], a[144:151], v112
s_add_u32 s28, s28, 0x40000
s_waitcnt lgkmcnt(2)
v_smfmac_f32_16x16x64_f16 v[80:83], v[24:27], a[72:79], v112
s_waitcnt vmcnt(3)
v_pk_add_f16 v48, v48, v76
v_smfmac_f32_16x16x64_f16 v[84:87], v[24:27], a[200:207], v112
s_waitcnt lgkmcnt(0)
s_barrier
ds_read_b128 v[36:39], v116 offset:10240
v_pk_add_f16 v49, v49, v77
v_smfmac_f32_16x16x64_f16 v[80:83], v[28:31], a[104:111], v112
ds_read_b128 v[40:43], v116 offset:9216
v_pk_add_f16 v50, v50, v78
v_smfmac_f32_16x16x64_f16 v[84:87], v[28:31], a[232:239], v112
ds_read_b128 v[44:47], v116 offset:8192
v_pk_add_f16 v51, v51, v79
v_smfmac_f32_16x16x64_f16 v[88:91], v[8:11], v[144:151], v112
s_waitcnt lgkmcnt(2)
v_cmp_u_f16 vcc, v48, v50
v_smfmac_f32_16x16x64_f16 v[80:83], v[36:39], a[48:55], v112
ds_write_b128 v116, v[48:51] offset:15360
s_cbranch_vccnz main_kernel_c3_m3_f
main_kernel_c3_m3:
v_smfmac_f32_16x16x64_f16 v[80:83], v[48:51], a[24:31], v112
v_smfmac_f32_16x16x64_f16 v[84:87], v[48:51], a[152:159], v112
v_smfmac_f32_16x16x64_f16 v[84:87], v[36:39], a[176:183], v112
s_waitcnt lgkmcnt(2)
v_smfmac_f32_16x16x64_f16 v[80:83], v[40:43], a[80:87], v112
s_waitcnt lgkmcnt(0)
s_barrier
ds_read_b128 v[52:55], v116 offset:14336
v_smfmac_f32_16x16x64_f16 v[84:87], v[40:43], a[208:215], v112
s_memtime s[40:41]
ds_read_b128 v[56:59], v116 offset:13312
v_smfmac_f32_16x16x64_f16 v[80:83], v[44:47], a[112:119], v112
s_add_u32 s19, s52, s54
ds_read_b128 v[60:63], v116 offset:12288
v_smfmac_f32_16x16x64_f16 v[84:87], v[44:47], a[240:247], v112
s_add_u32 s18, s18, 0x40000
s_waitcnt lgkmcnt(2)
v_smfmac_f32_16x16x64_f16 v[80:83], v[52:55], a[56:63], v112
s_bitset0_b32 s18, 20
s_waitcnt lgkmcnt(1)
v_smfmac_f32_16x16x64_f16 v[80:83], v[56:59], a[88:95], v112
s_cmp_eq_u32 s17, 30
s_cselect_b32 s32, s53, 0x10000
s_waitcnt lgkmcnt(0)
v_smfmac_f32_16x16x64_f16 v[80:83], v[60:63], a[120:127], v112
s_add_u32 s52, s52, s32
ds_read_b128 v[64:67], v116 offset:24576
v_smfmac_f32_16x16x64_f16 v[84:87], v[52:55], a[184:191], v112
s_sub_u32 s24, 0x20000, s32
ds_read_b128 v[68:71], v116 offset:28672
v_smfmac_f32_16x16x64_f16 v[84:87], v[56:59], a[216:223], v112
ds_read_b128 v[72:75], v116 offset:25600
s_add_u32 s55, s55, s24
v_cvt_pk_bf16_f32 v92, v80, v81
v_smfmac_f32_16x16x64_f16 v[84:87], v[60:63], a[248:255], v112
ds_read_b128 v[76:79], v116 offset:29696
s_nop 0
v_cvt_pk_bf16_f32 v93, v82, v83
v_smfmac_f32_16x16x64_f16 v[88:91], v[12:15], v[152:159], v112
s_nop 3
v_cvt_pk_bf16_f32 v94, v84, v85
v_cvt_pk_bf16_f32 v95, v86, v87
s_mov_b32 vcc_lo, 0xcccccccc
s_mov_b32 vcc_hi, 0xcccccccc
v_mfma_f32_16x16x32_bf16 v[84:87], v[92:95], v[104:107], 0
v_add_u32 v121, v121, v122
s_waitcnt lgkmcnt(0)
s_sub_u32 s31, s40, s11
v_smfmac_f32_16x16x64_f16 v[88:91], v[16:19], v[160:167], v112
s_sub_u32 s32, s31, s43
s_sub_u32 s47, 1590, s32
s_max_i32 s47, s47, 0
s_cmp_eq_u32 s17, 63
v_cvt_pk_bf16_f32 v114, v84, v85
v_cvt_pk_bf16_f32 v115, v86, v87
buffer_store_dwordx2 v[114:115], v117, s[4:7], s21 offen
s_cbranch_scc1 main_kernel_c3_last
ds_write_b64 v117, v[114:115] offset:17920
v_smfmac_f32_16x16x64_f16 v[88:91], v[20:23], v[168:175], v112
s_cmp_gt_u32 s32, 1790
s_cselect_b32 s33, 900, s47
v_smfmac_f32_16x16x64_f16 v[88:91], v[24:27], v[176:183], v112
s_add_u32 s10, s33, s31
s_andn2_b32 s42, s44, 0x1f00
v_mov_b32 v126, s15
v_smfmac_f32_16x16x64_f16 v[88:91], v[28:31], v[184:191], v112
s_add_u32 s42, s42, 0x4000
v_mov_b32 v127, s10
v_smfmac_f32_16x16x64_f16 v[88:91], v[32:35], v[192:199], v112
.p2align 3
main_kernel_c3_b21:
s_sub_u32 s47, s47, 28
s_cbranch_scc0 main_kernel_c3_b21
s_waitcnt lgkmcnt(0)
s_barrier
ds_read_b128 v[0:3], v116 offset:16384
v_smfmac_f32_16x16x64_f16 v[88:91], v[36:39], v[200:207], v112
ds_read_b128 v[4:7], v116 offset:17408
buffer_store_dwordx2 v[126:127], off, s[4:7], s46
v_smfmac_f32_16x16x64_f16 v[88:91], v[40:43], v[208:215], v112
ds_read_b128 v[16:19], v116 offset:26624
s_cmp_gt_u32 s32, 1790
s_cselect_b32 s80, s44, 0x7f000000
v_smfmac_f32_16x16x64_f16 v[88:91], v[44:47], v[216:223], v112
ds_read_b128 v[20:23], v116 offset:30720
v_writelane_b32 v121, s55, 39
v_smfmac_f32_16x16x64_f16 v[88:91], v[48:51], v[224:231], v112
ds_read_b128 v[24:27], v116 offset:27648
v_smfmac_f32_16x16x64_f16 v[88:91], v[52:55], v[232:239], v112
ds_read_b128 v[28:31], v116 offset:31744
v_smfmac_f32_16x16x64_f16 v[88:91], v[56:59], v[240:247], v112
v_smfmac_f32_16x16x64_f16 v[88:91], v[60:63], v[248:255], v112
s_waitcnt lgkmcnt(5)
v_mfma_f32_16x16x32_bf16 v[80:83], v[64:67], v[0:3], 0
v_mfma_f32_16x16x32_bf16 v[84:87], v[68:71], v[0:3], 0
buffer_load_dwordx4 v[8:11], v116, s[4:7], s20 offen offset:0 sc1
v_mfma_f32_16x16x32_bf16 v[92:95], v[0:3], v[0:3], 0
buffer_load_dwordx4 v[12:15], v116, s[4:7], s20 offen offset:1024 sc1
v_permlane32_swap_b32 v88, v90
s_waitcnt lgkmcnt(4)
v_mfma_f32_16x16x32_bf16 v[80:83], v[72:75], v[4:7], v[80:83]
v_permlane32_swap_b32 v89, v91
v_mfma_f32_16x16x32_bf16 v[84:87], v[76:79], v[4:7], v[84:87]
v_pk_add_f32 v[88:89], v[88:89], v[90:91]
v_mfma_f32_16x16x32_bf16 v[92:95], v[4:7], v[4:7], v[92:95]
v_cvt_pk_bf16_f32 v124, v88, v89
s_andn2_b32 s35, s46, 0xff
v_bfe_u32 v68, v116, 1, 8
v_mov_b32 v65, 0
buffer_load_dwordx2 v[66:67], v68, s[4:7], s35 offen sc1
buffer_store_dword v127, off, s[4:7], s80 offset:132 sc1
s_waitcnt lgkmcnt(0)
s_waitcnt vmcnt(3)
v_mfma_f32_16x16x32_bf16 v[88:91], v[8:11], v[8:11], v[92:95]
v_mfma_f32_16x16x32_bf16 v[0:3], v[16:19], v[8:11], v[80:83]
v_cmp_u_f32 s[0:1], v8, v10
v_mfma_f32_16x16x32_bf16 v[4:7], v[20:23], v[8:11], v[84:87]
s_waitcnt vmcnt(2)
v_mfma_f32_16x16x32_bf16 v[88:91], v[12:15], v[12:15], v[88:91]
v_mfma_f32_16x16x32_bf16 v[0:3], v[24:27], v[12:15], v[0:3]
v_cmp_u_f32 s[32:33], v12, v14
v_mfma_f32_16x16x32_bf16 v[4:7], v[28:31], v[12:15], v[4:7]
s_or_b64 s[0:1], s[0:1], s[32:33]
s_cbranch_scc1 main_kernel_c3_z_f
main_kernel_c3_z:
v_mul_f32 v88, s30, v88
v_mul_f32 v89, s30, v89
v_exp_f32 v88, v88
v_exp_f32 v89, v89
v_cndmask_b32_dpp v0, v2, v0, vcc quad_perm:[2,3,2,3] row_mask:0xf bank_mask:0xf
v_cvt_pk_bf16_f32 v64, v88, v89
v_cndmask_b32_dpp v1, v3, v1, vcc quad_perm:[2,3,2,3] row_mask:0xf bank_mask:0xf
v_exp_f32 v0, v0
v_mfma_f32_16x16x16_bf16 v[16:19], v[100:101], v[64:65], 0
v_exp_f32 v1, v1
v_cndmask_b32_dpp v4, v6, v4, vcc quad_perm:[2,3,2,3] row_mask:0xf bank_mask:0xf
v_mfma_f32_16x16x16_bf16 v[8:11], v[124:125], v[64:65], 0
v_cndmask_b32_dpp v5, v7, v5, vcc quad_perm:[2,3,2,3] row_mask:0xf bank_mask:0xf
v_exp_f32 v4, v4
v_exp_f32 v5, v5
v_cvt_pk_bf16_f32 v92, v0, v1
v_cvt_pk_bf16_f32 v94, v4, v5
v_mov_b32 v80, 0
v_mov_b32_dpp v93, v92 quad_perm:[0,1,0,1] row_mask:0xf bank_mask:0xf
v_mov_b32_dpp v95, v94 quad_perm:[0,1,0,1] row_mask:0xf bank_mask:0xf
v_mov_b32 v81, 0
v_mov_b32 v82, 0
v_mfma_f32_16x16x32_bf16 v[16:19], v[100:103], v[92:95], v[16:19]
v_mov_b32 v83, 0
v_mov_b32 v84, 0
v_mfma_f32_16x16x32_bf16 v[8:11], v[96:99], v[92:95], v[8:11]
s_buffer_load_dword s42, s[4:7], s42
s_nop 1
v_mov_b32 v85, 0
v_mov_b32 v86, 0
v_mov_b32 v87, 0
v_rcp_f32 v126, v16
v_subrev_u32 v127, 0x21800000, v16
v_cmp_lt_u32 vcc, 0x3c000000, v127
v_pk_mul_f32 v[8:9], v[8:9], v[126:127] op_sel_hi:[1,0]
v_pk_mul_f32 v[10:11], v[10:11], v[126:127] op_sel_hi:[1,0]
s_and_b32 s32, vcc_lo, 0xcccc
v_cvt_pk_bf16_f32 v126, v8, v9
v_cvt_pk_bf16_f32 v127, v10, v11
s_cbranch_scc1 main_kernel_c3_sm_f
main_kernel_c3_ost:
buffer_store_dwordx2 v[126:127], v118, s[4:7], s22 offen
s_waitcnt vmcnt(2)
main_kernel_c3_to0:
s_memtime s[40:41]
v_readlane_b32 s16, v66, 0
v_subrev_u32 v67, s2, v67
s_add_u32 s34, s11, s2
s_nop 0
v_max_u32_dpp v67, v67, v67 row_ror:8 row_mask:0xf bank_mask:0xf
s_nop 1
v_max_u32_dpp v67, v67, v67 row_ror:4 row_mask:0xf bank_mask:0xf
s_nop 1
v_max_u32_dpp v67, v67, v67 row_ror:2 row_mask:0xf bank_mask:0xf
s_nop 1
v_max_u32_dpp v67, v67, v67 row_ror:1 row_mask:0xf bank_mask:0xf
s_waitcnt lgkmcnt(0)
v_readlane_b32 s32, v67, 0
v_readlane_b32 s33, v67, 16
s_sub_u32 s34, s40, s34
s_max_u32 s32, s32, s33
s_add_u32 s35, s34, 1536
s_cmp_gt_u32 s32, s35
s_cbranch_scc1 main_kernel_c3_to2
main_kernel_c3_to3:
s_sub_u32 s33, s42, s2
s_cmp_le_u32 s33, s35
s_cselect_b32 s33, s33, 0
s_max_u32 s32, s32, s33
s_add_u32 s36, s32, 2750
s_add_u32 s32, s32, 1270
s_sub_u32 s47, s32, s34
s_max_i32 s47, s47, 0
.p2align 3
main_kernel_c3_to1:
s_sub_u32 s47, s47, 28
s_cbranch_scc0 main_kernel_c3_to1
s_barrier
buffer_load_dwordx4 v[0:3], v116, s[4:7], s23 offen sc1
ds_read_b128 v[32:35], v113 offset:0
ds_read_b128 v[36:39], v113 offset:1024
s_add_u32 s46, s46, 0x40000
s_bitset0_b32 s46, 20
s_add_u32 s37, s37, 65536
s_add_u32 s26, s26, 65536
s_xor_b32 s32, s23, 1024
buffer_load_dwordx4 v[4:7], v116, s[4:7], s32 offen sc1
ds_read_b128 v[40:43], v113 offset:2048
ds_read_b128 v[44:47], v113 offset:3072
s_add_u32 s44, s44, s24
s_nop 2
s_xor_b32 s32, s23, 2048
buffer_load_dwordx4 v[8:11], v116, s[4:7], s32 offen sc1
ds_read_b128 v[48:51], v113 offset:4096
ds_read_b128 v[52:55], v113 offset:5120
s_nop 3
s_xor_b32 s32, s23, 3072
buffer_load_dwordx4 v[12:15], v116, s[4:7], s32 offen sc1
ds_read_b128 v[56:59], v113 offset:6144
ds_read_b128 v[60:63], v113 offset:7168
s_nop 3
s_xor_b32 s32, s23, 4096
buffer_load_dwordx4 v[16:19], v116, s[4:7], s32 offen sc1
ds_read_b128 v[64:67], v113 offset:8192
ds_read_b128 v[68:71], v113 offset:9216
s_nop 3
s_xor_b32 s32, s23, 5120
buffer_load_dwordx4 v[20:23], v116, s[4:7], s32 offen sc1
ds_read_b128 v[72:75], v113 offset:10240
ds_read_b128 v[76:79], v113 offset:11264
s_nop 3
s_xor_b32 s32, s23, 6144
buffer_load_dwordx4 v[24:27], v116, s[4:7], s32 offen sc1
ds_read_b128 v[88:91], v113 offset:12288
ds_read_b128 v[92:95], v113 offset:13312
s_nop 3
s_xor_b32 s32, s23, 7168
buffer_load_dwordx4 v[28:31], v116, s[4:7], s32 offen sc1
v_and_b32 v127, 0x1f0, v116
v_lshlrev_b32 v127, 4, v127
s_waitcnt lgkmcnt(12)
s_waitcnt vmcnt(7)
v_cmp_u_f32 vcc, v0, v2
s_cbranch_vccnz main_kernel_c3_o0_f
main_kernel_c3_o0:
v_smfmac_f32_16x16x64_bf16 v[80:83], v[0:3], v[32:39], v112
ds_read_b128 v[32:35], v113 offset:14336
ds_read_b128 v[36:39], v113 offset:15360
buffer_load_dwordx2 v[96:97], v127, s[4:7], s45 offen offset:128 sc1
s_waitcnt lgkmcnt(12)
s_waitcnt vmcnt(7)
v_cmp_u_f32 vcc, v4, v6
v_smfmac_f32_16x16x64_bf16 v[84:87], v[0:3], v[40:47], v112
ds_read_b128 v[40:43], v113 offset:16384
ds_read_b128 v[44:47], v113 offset:17408
buffer_store_dwordx2 v[114:115], v119, s[4:7], s37 offen sc1
s_cbranch_vccnz main_kernel_c3_o1_f
main_kernel_c3_o1:
s_waitcnt lgkmcnt(12)
v_smfmac_f32_16x16x64_bf16 v[80:83], v[4:7], v[48:55], v112
ds_read_b128 v[48:51], v113 offset:18432
ds_read_b128 v[52:55], v113 offset:19456
s_waitcnt lgkmcnt(12)
s_waitcnt vmcnt(7)
v_cmp_u_f32 vcc, v8, v10
v_smfmac_f32_16x16x64_bf16 v[84:87], v[4:7], v[56:63], v112
ds_read_b128 v[56:59], v113 offset:20480
ds_read_b128 v[60:63], v113 offset:21504
buffer_store_dword v124, v120, s[4:7], s26 offen sc1
s_cbranch_vccnz main_kernel_c3_o2_f
main_kernel_c3_o2:
s_waitcnt lgkmcnt(12)
v_smfmac_f32_16x16x64_bf16 v[80:83], v[8:11], v[64:71], v112
ds_read_b128 v[64:67], v113 offset:22528
ds_read_b128 v[68:71], v113 offset:23552
s_waitcnt lgkmcnt(12)
s_waitcnt vmcnt(7)
v_cmp_u_f32 vcc, v12, v14
v_smfmac_f32_16x16x64_bf16 v[84:87], v[8:11], v[72:79], v112
ds_read_b128 v[72:75], v113 offset:24576
ds_read_b128 v[76:79], v113 offset:25600
s_cbranch_vccnz main_kernel_c3_o3_f
main_kernel_c3_o3:
s_waitcnt lgkmcnt(12)
v_smfmac_f32_16x16x64_bf16 v[80:83], v[12:15], v[88:95], v112
ds_read_b128 v[88:91], v113 offset:26624
ds_read_b128 v[92:95], v113 offset:27648
s_waitcnt lgkmcnt(12)
s_waitcnt vmcnt(6)
v_cmp_u_f32 vcc, v16, v18
v_smfmac_f32_16x16x64_bf16 v[84:87], v[12:15], v[32:39], v112
ds_read_b128 v[32:35], v113 offset:28672
ds_read_b128 v[36:39], v113 offset:29696
s_cbranch_vccnz main_kernel_c3_o4_f
main_kernel_c3_o4:
s_waitcnt lgkmcnt(12)
v_smfmac_f32_16x16x64_bf16 v[80:83], v[16:19], v[40:47], v112
ds_read_b128 v[40:43], v113 offset:30720
ds_read_b128 v[44:47], v113 offset:31744
s_waitcnt lgkmcnt(12)
s_waitcnt vmcnt(5)
v_cmp_u_f32 vcc, v20, v22
v_smfmac_f32_16x16x64_bf16 v[84:87], v[16:19], v[48:55], v112
s_cbranch_vccnz main_kernel_c3_o5_f
main_kernel_c3_o5:
s_waitcnt lgkmcnt(10)
v_smfmac_f32_16x16x64_bf16 v[80:83], v[20:23], v[56:63], v112
s_waitcnt lgkmcnt(8)
s_waitcnt vmcnt(4)
v_cmp_u_f32 vcc, v24, v26
v_smfmac_f32_16x16x64_bf16 v[84:87], v[20:23], v[64:71], v112
s_cbranch_vccnz main_kernel_c3_o6_f
main_kernel_c3_o6:
s_waitcnt lgkmcnt(6)
v_smfmac_f32_16x16x64_bf16 v[80:83], v[24:27], v[72:79], v112
s_waitcnt lgkmcnt(4)
v_smfmac_f32_16x16x64_bf16 v[84:87], v[24:27], v[88:95], v112
s_waitcnt lgkmcnt(2)
s_waitcnt vmcnt(3)
v_cmp_u_f32 vcc, v28, v30
s_cbranch_vccnz main_kernel_c3_o7_f
main_kernel_c3_o7:
v_smfmac_f32_16x16x64_bf16 v[80:83], v[28:31], v[32:39], v112
s_waitcnt lgkmcnt(0)
v_smfmac_f32_16x16x64_bf16 v[84:87], v[28:31], v[40:47], v112
s_nop 4
v_cvt_pk_bf16_f32 v80, v80, v81
v_cvt_pk_bf16_f32 v81, v82, v83
ds_write_b64 v116, v[80:81] offset:21512
v_cvt_pk_bf16_f32 v82, v84, v85
v_cvt_pk_bf16_f32 v83, v86, v87
ds_write_b64 v116, v[82:83] offset:23560
s_waitcnt lgkmcnt(0)
s_barrier
ds_read_b128 v[72:75], v116 offset:22528
ds_read_b128 v[76:79], v116 offset:23552
s_waitcnt lgkmcnt(1)
v_mfma_f32_16x16x32_bf16 v[64:67], v[72:75], v[108:111], 0
s_waitcnt lgkmcnt(0)
v_mfma_f32_16x16x32_bf16 v[64:67], v[76:79], v[108:111], v[64:67]
s_nop 7
v_cvt_pk_f16_f32 v68, v64, v65
v_cvt_pk_f16_f32 v69, v66, v67
buffer_store_dwordx2 v[68:69], v125, s[4:7], s25 offen
s_sub_u32 s0, s2, s16
s_sub_u32 s0, s0, s39
s_waitcnt vmcnt(3)
main_kernel_c3_tm0:
s_memtime s[40:41]
v_sub_u32 v97, v97, v96
v_subrev_u32 v97, s0, v97
s_add_u32 s34, s11, s2
s_nop 0
v_max_u32_dpp v97, v97, v97 row_ror:8 row_mask:0xf bank_mask:0xf
s_nop 1
v_max_u32_dpp v97, v97, v97 row_ror:4 row_mask:0xf bank_mask:0xf
s_nop 1
v_max_u32_dpp v97, v97, v97 row_ror:2 row_mask:0xf bank_mask:0xf
s_nop 1
v_max_u32_dpp v97, v97, v97 row_ror:1 row_mask:0xf bank_mask:0xf
s_waitcnt lgkmcnt(0)
v_readlane_b32 s32, v97, 0
v_readlane_b32 s33, v97, 16
s_sub_u32 s34, s40, s34
s_max_u32 s32, s32, s33
s_add_u32 s35, s34, 1536
s_cmp_gt_u32 s32, s35
s_cbranch_scc1 main_kernel_c3_tm2
main_kernel_c3_tm3:
s_add_u32 s32, s32, 2750
s_max_u32 s32, s32, s36
s_add_u32 s43, s32, s2
s_sub_u32 s47, s32, s34
s_max_i32 s47, s47, 0
.p2align 3
main_kernel_c3_tm1:
s_sub_u32 s47, s47, 28
s_cbranch_scc0 main_kernel_c3_tm1
s_add_u32 s45, s45, s24
s_branch main_kernel_c3_top
main_kernel_c3_to2:
s_mov_b32 s32, s34
s_mov_b32 s16, s15
s_cmp_gt_u32 s34, 0x40000
s_cbranch_scc1 main_kernel_c3_to3
s_andn2_b32 s35, s46, 0xff
v_bfe_u32 v68, v116, 1, 8
buffer_load_dwordx2 v[66:67], v68, s[4:7], s35 offen sc1
s_sub_u32 s29, s29, 1
s_cbranch_scc1 main_kernel_end
s_waitcnt vmcnt(0)
s_branch main_kernel_c3_to0
main_kernel_c3_tm2:
s_mov_b32 s32, s34
s_cmp_gt_u32 s34, 0x40000
s_cbranch_scc1 main_kernel_c3_tm3
v_and_b32 v127, 0x1f0, v116
v_lshlrev_b32 v127, 4, v127
buffer_load_dwordx2 v[96:97], v127, s[4:7], s45 offen offset:128 sc1
s_sub_u32 s29, s29, 1
s_cbranch_scc1 main_kernel_end
s_waitcnt vmcnt(0)
s_branch main_kernel_c3_tm0
main_kernel_c3_last:
s_add_u32 s37, s37, 65536
s_add_u32 s26, s26, 65536
buffer_store_dwordx2 v[114:115], v119, s[4:7], s37 offen sc1
v_smfmac_f32_16x16x64_f16 v[88:91], v[20:23], v[168:175], v112
v_smfmac_f32_16x16x64_f16 v[88:91], v[24:27], v[176:183], v112
v_smfmac_f32_16x16x64_f16 v[88:91], v[28:31], v[184:191], v112
v_smfmac_f32_16x16x64_f16 v[88:91], v[32:35], v[192:199], v112
v_smfmac_f32_16x16x64_f16 v[88:91], v[36:39], v[200:207], v112
v_smfmac_f32_16x16x64_f16 v[88:91], v[40:43], v[208:215], v112
v_smfmac_f32_16x16x64_f16 v[88:91], v[44:47], v[216:223], v112
v_smfmac_f32_16x16x64_f16 v[88:91], v[48:51], v[224:231], v112
v_smfmac_f32_16x16x64_f16 v[88:91], v[52:55], v[232:239], v112
v_smfmac_f32_16x16x64_f16 v[88:91], v[56:59], v[240:247], v112
v_smfmac_f32_16x16x64_f16 v[88:91], v[60:63], v[248:255], v112
s_nop 7
v_permlane32_swap_b32 v88, v90
s_nop 1
v_permlane32_swap_b32 v89, v91
s_nop 1
v_pk_add_f32 v[88:89], v[88:89], v[90:91]
s_nop 1
v_cvt_pk_bf16_f32 v124, v88, v89
s_nop 1
buffer_store_dword v124, v120, s[4:7], s26 offen sc1
s_branch main_kernel_end
main_kernel_c3_m0_f:
s_waitcnt lgkmcnt(0)
buffer_load_dwordx4 v[0:3], v116, s[4:7], s18 offen sc1
buffer_load_dwordx4 v[64:67], v116, s[4:7], s19 offen sc1
s_xor_b32 s32, s18, 1024
buffer_load_dwordx4 v[16:19], v116, s[4:7], s32 offen sc1
s_xor_b32 s32, s19, 1024
buffer_load_dwordx4 v[68:71], v116, s[4:7], s32 offen sc1
s_xor_b32 s32, s18, 2048
buffer_load_dwordx4 v[32:35], v116, s[4:7], s32 offen sc1
s_xor_b32 s32, s19, 2048
buffer_load_dwordx4 v[72:75], v116, s[4:7], s32 offen sc1
s_xor_b32 s32, s18, 3072
buffer_load_dwordx4 v[48:51], v116, s[4:7], s32 offen sc1
s_xor_b32 s32, s19, 3072
buffer_load_dwordx4 v[76:79], v116, s[4:7], s32 offen sc1
s_sub_u32 s29, s29, 1
s_cbranch_scc1 main_kernel_end
s_waitcnt vmcnt(0)
v_max_u32 v126, v0, v2
v_max3_u32 v126, v126, v64, v66
v_cmp_eq_u32 vcc, -1, v126
s_cbranch_vccnz main_kernel_c3_m0_f
v_pk_add_f16 v0, v0, v64
v_pk_add_f16 v1, v1, v65
v_pk_add_f16 v2, v2, v66
v_pk_add_f16 v3, v3, v67
s_nop 0
s_branch main_kernel_c3_m0
main_kernel_c3_m1_f:
s_waitcnt lgkmcnt(0)
s_xor_b32 s32, s18, 1024
buffer_load_dwordx4 v[16:19], v116, s[4:7], s32 offen sc1
s_xor_b32 s32, s19, 1024
buffer_load_dwordx4 v[68:71], v116, s[4:7], s32 offen sc1
s_xor_b32 s32, s18, 2048
buffer_load_dwordx4 v[32:35], v116, s[4:7], s32 offen sc1
s_xor_b32 s32, s19, 2048
buffer_load_dwordx4 v[72:75], v116, s[4:7], s32 offen sc1
s_xor_b32 s32, s18, 3072
buffer_load_dwordx4 v[48:51], v116, s[4:7], s32 offen sc1
s_xor_b32 s32, s19, 3072
buffer_load_dwordx4 v[76:79], v116, s[4:7], s32 offen sc1
s_sub_u32 s29, s29, 1
s_cbranch_scc1 main_kernel_end
s_waitcnt vmcnt(0)
v_max_u32 v126, v16, v18
v_max3_u32 v126, v126, v68, v70
v_cmp_eq_u32 vcc, -1, v126
s_cbranch_vccnz main_kernel_c3_m1_f
v_pk_add_f16 v16, v16, v68
v_pk_add_f16 v17, v17, v69
v_pk_add_f16 v18, v18, v70
v_pk_add_f16 v19, v19, v71
s_nop 0
s_branch main_kernel_c3_m1
main_kernel_c3_m2_f:
s_waitcnt lgkmcnt(0)
s_xor_b32 s32, s18, 2048
buffer_load_dwordx4 v[32:35], v116, s[4:7], s32 offen sc1
s_xor_b32 s32, s19, 2048
buffer_load_dwordx4 v[72:75], v116, s[4:7], s32 offen sc1
s_xor_b32 s32, s18, 3072
buffer_load_dwordx4 v[48:51], v116, s[4:7], s32 offen sc1
s_xor_b32 s32, s19, 3072
buffer_load_dwordx4 v[76:79], v116, s[4:7], s32 offen sc1
s_sub_u32 s29, s29, 1
s_cbranch_scc1 main_kernel_end
s_waitcnt vmcnt(0)
v_max_u32 v126, v32, v34
v_max3_u32 v126, v126, v72, v74
v_cmp_eq_u32 vcc, -1, v126
s_cbranch_vccnz main_kernel_c3_m2_f
v_pk_add_f16 v32, v32, v72
v_pk_add_f16 v33, v33, v73
v_pk_add_f16 v34, v34, v74
v_pk_add_f16 v35, v35, v75
ds_write_b128 v116, v[32:35] offset:11264
s_branch main_kernel_c3_m2
main_kernel_c3_m3_f:
s_waitcnt lgkmcnt(0)
s_xor_b32 s32, s18, 3072
buffer_load_dwordx4 v[48:51], v116, s[4:7], s32 offen sc1
s_xor_b32 s32, s19, 3072
buffer_load_dwordx4 v[76:79], v116, s[4:7], s32 offen sc1
s_sub_u32 s29, s29, 1
s_cbranch_scc1 main_kernel_end
s_waitcnt vmcnt(0)
v_max_u32 v126, v48, v50
v_max3_u32 v126, v126, v76, v78
v_cmp_eq_u32 vcc, -1, v126
s_cbranch_vccnz main_kernel_c3_m3_f
v_pk_add_f16 v48, v48, v76
v_pk_add_f16 v49, v49, v77
v_pk_add_f16 v50, v50, v78
v_pk_add_f16 v51, v51, v79
ds_write_b128 v116, v[48:51] offset:15360
s_branch main_kernel_c3_m3
main_kernel_c3_z_f:
buffer_load_dwordx4 v[8:11], v116, s[4:7], s20 offen offset:0 sc1
buffer_load_dwordx4 v[12:15], v116, s[4:7], s20 offen offset:1024 sc1
s_memtime s[32:33]
ds_read_b32 v126, v116 offset:18432
s_sub_u32 s34, s19, s54
s_xor_b32 s34, s34, 0x2000
s_lshl_b32 s35, s12, 15
s_add_u32 s34, s34, s35
s_lshl_b32 s35, s13, 8
s_add_u32 s35, s35, s34
s_add_u32 s34, s34, 0x4000
s_waitcnt lgkmcnt(0)
s_sub_u32 s32, s32, 450
v_sub_u32 v126, s32, v126
v_max_u32 v127, v126, v127
buffer_store_dword v127, off, s[4:7], s34
s_sub_u32 s29, s29, 1
s_cbranch_scc1 main_kernel_end
s_waitcnt vmcnt(1)
main_kernel_c3_z_g:
v_max_u32 v126, v8, v10
v_max3_u32 v126, v126, v12, v14
v_cmp_eq_u32 vcc, -1, v126
s_cbranch_vccnz main_kernel_c3_z_h
v_mfma_f32_16x16x32_bf16 v[88:91], v[8:11], v[8:11], v[92:95]
v_mfma_f32_16x16x32_bf16 v[0:3], v[16:19], v[8:11], v[80:83]
v_mfma_f32_16x16x32_bf16 v[4:7], v[20:23], v[8:11], v[84:87]
v_mfma_f32_16x16x32_bf16 v[88:91], v[12:15], v[12:15], v[88:91]
v_mfma_f32_16x16x32_bf16 v[0:3], v[24:27], v[12:15], v[0:3]
v_mfma_f32_16x16x32_bf16 v[4:7], v[28:31], v[12:15], v[4:7]
buffer_store_dword v127, off, s[4:7], s35 offset:132 sc1
s_mov_b32 vcc_lo, 0xcccccccc
s_mov_b32 vcc_hi, 0xcccccccc
s_branch main_kernel_c3_z
main_kernel_c3_z_h:
buffer_load_dwordx4 v[8:11], v116, s[4:7], s20 offen offset:0 sc1
buffer_load_dwordx4 v[12:15], v116, s[4:7], s20 offen offset:1024 sc1
s_sub_u32 s29, s29, 1
s_cbranch_scc1 main_kernel_end
v_add_u32 v127, 300, v127
s_waitcnt vmcnt(0)
s_branch main_kernel_c3_z_g
main_kernel_c3_sm_f:
s_waitcnt vmcnt(0) lgkmcnt(0)
buffer_load_dwordx4 v[8:11], v116, s[4:7], s20 offen offset:0 sc1
buffer_load_dwordx4 v[12:15], v116, s[4:7], s20 offen offset:1024 sc1
ds_read_b128 v[0:3], v116 offset:16384
ds_read_b128 v[4:7], v116 offset:17408
ds_read_b128 v[64:67], v116 offset:24576
ds_read_b128 v[68:71], v116 offset:28672
ds_read_b128 v[72:75], v116 offset:25600
ds_read_b128 v[76:79], v116 offset:29696
ds_read_b128 v[16:19], v116 offset:26624
ds_read_b128 v[20:23], v116 offset:30720
ds_read_b128 v[24:27], v116 offset:27648
ds_read_b128 v[28:31], v116 offset:31744
s_waitcnt vmcnt(0)
s_waitcnt lgkmcnt(0)
v_mfma_f32_16x16x32_bf16 v[80:83], v[64:67], v[0:3], 0
v_mfma_f32_16x16x32_bf16 v[84:87], v[68:71], v[0:3], 0
v_mfma_f32_16x16x32_bf16 v[92:95], v[0:3], v[0:3], 0
v_mfma_f32_16x16x32_bf16 v[80:83], v[72:75], v[4:7], v[80:83]
v_mfma_f32_16x16x32_bf16 v[84:87], v[76:79], v[4:7], v[84:87]
v_mfma_f32_16x16x32_bf16 v[92:95], v[4:7], v[4:7], v[92:95]
v_mfma_f32_16x16x32_bf16 v[0:3], v[16:19], v[8:11], v[80:83]
v_mfma_f32_16x16x32_bf16 v[4:7], v[20:23], v[8:11], v[84:87]
v_mfma_f32_16x16x32_bf16 v[88:91], v[8:11], v[8:11], v[92:95]
v_mfma_f32_16x16x32_bf16 v[0:3], v[24:27], v[12:15], v[0:3]
v_mfma_f32_16x16x32_bf16 v[4:7], v[28:31], v[12:15], v[4:7]
v_mfma_f32_16x16x32_bf16 v[88:91], v[12:15], v[12:15], v[88:91]
s_nop 7
v_mov_b32 v65, 0
v_max_f32 v126, v88, v89
v_mul_f32 v126, s30, v126
v_max3_f32 v126, v126, v0, v1
v_max3_f32 v126, v126, v2, v3
v_max3_f32 v126, v126, v4, v5
v_max3_f32 v126, v126, v6, v7
v_mov_b32 v127, v126
s_nop 1
v_permlane32_swap_b32 v126, v127
v_max_f32 v126, v126, v127
v_mov_b32 v127, v126
s_nop 1
v_permlane16_swap_b32 v126, v127
v_max_f32 v126, v126, v127
v_mul_f32 v127, 0x40faf233, v126
s_mov_b32 vcc_lo, 0xcccccccc
s_mov_b32 vcc_hi, 0xcccccccc
v_sub_f32 v0, v0, v126
v_sub_f32 v1, v1, v126
v_sub_f32 v2, v2, v126
v_sub_f32 v3, v3, v126
v_sub_f32 v4, v4, v126
v_sub_f32 v5, v5, v126
v_sub_f32 v6, v6, v126
v_sub_f32 v7, v7, v126
v_sub_f32 v88, v88, v127
v_sub_f32 v89, v89, v127
s_waitcnt lgkmcnt(0)
s_nop 0
v_mul_f32 v88, s30, v88
v_mul_f32 v89, s30, v89
v_exp_f32 v88, v88
v_exp_f32 v89, v89
v_cndmask_b32_dpp v0, v2, v0, vcc quad_perm:[2,3,2,3] row_mask:0xf bank_mask:0xf
v_cvt_pk_bf16_f32 v64, v88, v89
v_cndmask_b32_dpp v1, v3, v1, vcc quad_perm:[2,3,2,3] row_mask:0xf bank_mask:0xf
v_exp_f32 v0, v0
v_mfma_f32_16x16x16_bf16 v[16:19], v[100:101], v[64:65], 0
v_exp_f32 v1, v1
v_cndmask_b32_dpp v4, v6, v4, vcc quad_perm:[2,3,2,3] row_mask:0xf bank_mask:0xf
v_mfma_f32_16x16x16_bf16 v[8:11], v[124:125], v[64:65], 0
v_cndmask_b32_dpp v5, v7, v5, vcc quad_perm:[2,3,2,3] row_mask:0xf bank_mask:0xf
v_exp_f32 v4, v4
v_exp_f32 v5, v5
v_cvt_pk_bf16_f32 v92, v0, v1
v_cvt_pk_bf16_f32 v94, v4, v5
v_mov_b32 v80, 0
v_mov_b32_dpp v93, v92 quad_perm:[0,1,0,1] row_mask:0xf bank_mask:0xf
v_mov_b32_dpp v95, v94 quad_perm:[0,1,0,1] row_mask:0xf bank_mask:0xf
v_mov_b32 v81, 0
v_mov_b32 v82, 0
v_mfma_f32_16x16x32_bf16 v[16:19], v[100:103], v[92:95], v[16:19]
v_mov_b32 v83, 0
v_mov_b32 v84, 0
v_mfma_f32_16x16x32_bf16 v[8:11], v[96:99], v[92:95], v[8:11]
s_nop 1
v_mov_b32 v85, 0
v_mov_b32 v86, 0
v_mov_b32 v87, 0
v_rcp_f32 v126, v16
v_subrev_u32 v127, 0x21800000, v16
v_cmp_lt_u32 vcc, 0x3c000000, v127
v_pk_mul_f32 v[8:9], v[8:9], v[126:127] op_sel_hi:[1,0]
v_pk_mul_f32 v[10:11], v[10:11], v[126:127] op_sel_hi:[1,0]
s_and_b32 s32, vcc_lo, 0xcccc
v_cvt_pk_bf16_f32 v126, v8, v9
v_cvt_pk_bf16_f32 v127, v10, v11
s_andn2_b32 s35, s46, 0xff
v_bfe_u32 v68, v116, 1, 8
buffer_load_dwordx2 v[66:67], v68, s[4:7], s35 offen sc1
s_waitcnt vmcnt(0)
s_branch main_kernel_c3_ost
main_kernel_c3_o0_f:
s_nop 0
buffer_load_dwordx4 v[0:3], v116, s[4:7], s23 offen sc1
s_xor_b32 s32, s23, 1024
buffer_load_dwordx4 v[4:7], v116, s[4:7], s32 offen sc1
s_sub_u32 s29, s29, 1
s_cbranch_scc1 main_kernel_end
s_waitcnt vmcnt(0)
v_max_u32 v126, v0, v2
v_cmp_eq_u32 vcc, -1, v126
s_cbranch_vccnz main_kernel_c3_o0_f
s_branch main_kernel_c3_o0
main_kernel_c3_o1_f:
s_nop 0
s_xor_b32 s32, s23, 1024
buffer_load_dwordx4 v[4:7], v116, s[4:7], s32 offen sc1
s_xor_b32 s32, s23, 2048
buffer_load_dwordx4 v[8:11], v116, s[4:7], s32 offen sc1
s_sub_u32 s29, s29, 1
s_cbranch_scc1 main_kernel_end
s_waitcnt vmcnt(0)
v_max_u32 v126, v4, v6
v_cmp_eq_u32 vcc, -1, v126
s_cbranch_vccnz main_kernel_c3_o1_f
s_branch main_kernel_c3_o1
main_kernel_c3_o2_f:
s_nop 0
s_xor_b32 s32, s23, 2048
buffer_load_dwordx4 v[8:11], v116, s[4:7], s32 offen sc1
s_xor_b32 s32, s23, 3072
buffer_load_dwordx4 v[12:15], v116, s[4:7], s32 offen sc1
s_sub_u32 s29, s29, 1
s_cbranch_scc1 main_kernel_end
s_waitcnt vmcnt(0)
v_max_u32 v126, v8, v10
v_cmp_eq_u32 vcc, -1, v126
s_cbranch_vccnz main_kernel_c3_o2_f
s_branch main_kernel_c3_o2
main_kernel_c3_o3_f:
s_nop 0
s_xor_b32 s32, s23, 3072
buffer_load_dwordx4 v[12:15], v116, s[4:7], s32 offen sc1
s_xor_b32 s32, s23, 4096
buffer_load_dwordx4 v[16:19], v116, s[4:7], s32 offen sc1
s_sub_u32 s29, s29, 1
s_cbranch_scc1 main_kernel_end
s_waitcnt vmcnt(0)
v_max_u32 v126, v12, v14
v_cmp_eq_u32 vcc, -1, v126
s_cbranch_vccnz main_kernel_c3_o3_f
s_branch main_kernel_c3_o3
main_kernel_c3_o4_f:
s_nop 0
s_xor_b32 s32, s23, 4096
buffer_load_dwordx4 v[16:19], v116, s[4:7], s32 offen sc1
s_xor_b32 s32, s23, 5120
buffer_load_dwordx4 v[20:23], v116, s[4:7], s32 offen sc1
s_sub_u32 s29, s29, 1
s_cbranch_scc1 main_kernel_end
s_waitcnt vmcnt(0)
v_max_u32 v126, v16, v18
v_cmp_eq_u32 vcc, -1, v126
s_cbranch_vccnz main_kernel_c3_o4_f
s_branch main_kernel_c3_o4
main_kernel_c3_o5_f:
s_nop 0
s_xor_b32 s32, s23, 5120
buffer_load_dwordx4 v[20:23], v116, s[4:7], s32 offen sc1
s_xor_b32 s32, s23, 6144
buffer_load_dwordx4 v[24:27], v116, s[4:7], s32 offen sc1
s_sub_u32 s29, s29, 1
s_cbranch_scc1 main_kernel_end
s_waitcnt vmcnt(0)
v_max_u32 v126, v20, v22
v_cmp_eq_u32 vcc, -1, v126
s_cbranch_vccnz main_kernel_c3_o5_f
s_branch main_kernel_c3_o5
main_kernel_c3_o6_f:
s_nop 0
s_xor_b32 s32, s23, 6144
buffer_load_dwordx4 v[24:27], v116, s[4:7], s32 offen sc1
s_xor_b32 s32, s23, 7168
buffer_load_dwordx4 v[28:31], v116, s[4:7], s32 offen sc1
s_sub_u32 s29, s29, 1
s_cbranch_scc1 main_kernel_end
s_waitcnt vmcnt(0)
v_max_u32 v126, v24, v26
v_cmp_eq_u32 vcc, -1, v126
s_cbranch_vccnz main_kernel_c3_o6_f
s_branch main_kernel_c3_o6
main_kernel_c3_o7_f:
s_nop 0
s_xor_b32 s32, s23, 7168
buffer_load_dwordx4 v[28:31], v116, s[4:7], s32 offen sc1
s_sub_u32 s29, s29, 1
s_cbranch_scc1 main_kernel_end
s_waitcnt vmcnt(0)
v_max_u32 v126, v28, v30
v_cmp_eq_u32 vcc, -1, v126
s_cbranch_vccnz main_kernel_c3_o7_f
s_branch main_kernel_c3_o7
.p2align 6
main_kernel_c4_top:
s_barrier
buffer_load_dwordx4 v[0:3], v116, s[4:7], s18 offen sc1
s_add_u32 s20, s20, 0x40000
s_bitset0_b32 s20, 20
s_add_u32 s21, s21, 0x40000
s_bitset0_b32 s21, 20
s_add_u32 s22, s22, 0x40000
s_bitset0_b32 s22, 20
s_add_u32 s23, s23, 0x40000
s_bitset0_b32 s23, 20
s_xor_b32 s32, s18, 1024
buffer_load_dwordx4 v[16:19], v116, s[4:7], s32 offen sc1
s_add_u32 s3, s3, 0x40000
s_bitset0_b32 s3, 20
s_add_u32 s17, s17, 1
s_bitcmp1_b32 0x77777777, s17
s_cselect_b32 s33, 0x800, 0
s_xor_b32 s54, s54, s33
s_xor_b32 s59, s59, s33
s_add_u32 s25, s52, s59
s_nop 0
buffer_load_dwordx4 v[64:67], v116, s[4:7], s19 offen sc1
v_mov_b32 v80, 0
v_mov_b32 v81, 0
s_nop 3
s_xor_b32 s32, s19, 1024
buffer_load_dwordx4 v[68:71], v116, s[4:7], s32 offen sc1
v_mov_b32 v82, 0
v_mov_b32 v83, 0
s_nop 3
s_xor_b32 s32, s18, 2048
buffer_load_dwordx4 v[32:35], v116, s[4:7], s32 offen sc1
v_mov_b32 v84, 0
v_mov_b32 v85, 0
s_nop 3
s_xor_b32 s32, s19, 2048
buffer_load_dwordx4 v[72:75], v116, s[4:7], s32 offen sc1
v_mov_b32 v86, 0
v_mov_b32 v87, 0
s_nop 3
s_xor_b32 s32, s18, 3072
buffer_load_dwordx4 v[48:51], v116, s[4:7], s32 offen sc1
v_mov_b32 v88, 0
v_mov_b32 v89, 0
s_nop 3
s_xor_b32 s32, s19, 3072
buffer_load_dwordx4 v[76:79], v116, s[4:7], s32 offen sc1
v_mov_b32 v90, 0
v_mov_b32 v91, 0
s_waitcnt vmcnt(5)
v_pk_add_f16 v0, v0, v64
v_pk_add_f16 v1, v1, v65
v_pk_add_f16 v2, v2, v66
v_pk_add_f16 v3, v3, v67
v_cmp_u_f16 vcc, v0, v2
s_cbranch_vccnz main_kernel_c4_m0_f
main_kernel_c4_m0:
v_smfmac_f32_16x16x64_f16 v[80:83], v[0:3], a[0:7], v112
ds_write_b128 v116, v[0:3] offset:0
v_smfmac_f32_16x16x64_f16 v[84:87], v[0:3], a[128:135], v112
buffer_load_dword v123, v121, s[4:7], 0 offen sc1
s_waitcnt vmcnt(5)
v_pk_add_f16 v16, v16, v68
v_pk_add_f16 v17, v17, v69
v_pk_add_f16 v18, v18, v70
v_pk_add_f16 v19, v19, v71
v_cmp_u_f16 vcc, v16, v18
s_waitcnt lgkmcnt(0)
s_barrier
ds_read_b128 v[4:7], v116 offset:1024
ds_write_b128 v116, v[16:19] offset:4096
s_cbranch_vccnz main_kernel_c4_m1_f
main_kernel_c4_m1:
v_smfmac_f32_16x16x64_f16 v[80:83], v[16:19], a[8:15], v112
v_smfmac_f32_16x16x64_f16 v[84:87], v[16:19], a[136:143], v112
ds_read_b128 v[8:11], v116 offset:2048
v_smfmac_f32_16x16x64_f16 v[88:91], v[0:3], v[128:135], v112
ds_read_b128 v[12:15], v116 offset:3072
s_waitcnt lgkmcnt(3)
v_smfmac_f32_16x16x64_f16 v[80:83], v[4:7], a[32:39], v112
v_smfmac_f32_16x16x64_f16 v[84:87], v[4:7], a[160:167], v112
v_smfmac_f32_16x16x64_f16 v[88:91], v[4:7], v[136:143], v112
s_waitcnt lgkmcnt(2)
s_barrier
s_waitcnt lgkmcnt(1)
v_smfmac_f32_16x16x64_f16 v[80:83], v[8:11], a[64:71], v112
s_waitcnt vmcnt(3)
ds_read_b128 v[20:23], v116 offset:5120
v_pk_add_f16 v32, v32, v72
v_smfmac_f32_16x16x64_f16 v[84:87], v[8:11], a[192:199], v112
ds_read_b128 v[24:27], v116 offset:6144
s_waitcnt lgkmcnt(2)
v_pk_add_f16 v33, v33, v73
v_smfmac_f32_16x16x64_f16 v[80:83], v[12:15], a[96:103], v112
ds_read_b128 v[28:31], v116 offset:7168
v_pk_add_f16 v34, v34, v74
v_smfmac_f32_16x16x64_f16 v[84:87], v[12:15], a[224:231], v112
s_waitcnt lgkmcnt(2)
v_pk_add_f16 v35, v35, v75
v_smfmac_f32_16x16x64_f16 v[80:83], v[20:23], a[40:47], v112
ds_write_b128 v116, v[32:35] offset:8192
v_cmp_u_f16 vcc, v32, v34
v_smfmac_f32_16x16x64_f16 v[84:87], v[20:23], a[168:175], v112
s_cbranch_vccnz main_kernel_c4_m2_f
main_kernel_c4_m2:
v_smfmac_f32_16x16x64_f16 v[80:83], v[32:35], a[16:23], v112
buffer_load_dwordx4 v[96:99], v116, s[4:7], s28 offen sc1
v_smfmac_f32_16x16x64_f16 v[84:87], v[32:35], a[144:151], v112
s_add_u32 s28, s28, 0x40000
s_waitcnt lgkmcnt(2)
v_smfmac_f32_16x16x64_f16 v[80:83], v[24:27], a[72:79], v112
s_waitcnt vmcnt(2)
v_pk_add_f16 v48, v48, v76
v_smfmac_f32_16x16x64_f16 v[84:87], v[24:27], a[200:207], v112
s_waitcnt lgkmcnt(0)
s_barrier
ds_read_b128 v[36:39], v116 offset:9216
v_pk_add_f16 v49, v49, v77
v_smfmac_f32_16x16x64_f16 v[80:83], v[28:31], a[104:111], v112
ds_read_b128 v[40:43], v116 offset:10240
v_pk_add_f16 v50, v50, v78
v_smfmac_f32_16x16x64_f16 v[84:87], v[28:31], a[232:239], v112
ds_read_b128 v[44:47], v116 offset:11264
v_pk_add_f16 v51, v51, v79
v_smfmac_f32_16x16x64_f16 v[88:91], v[8:11], v[144:151], v112
ds_write_b128 v116, v[48:51] offset:12288
s_waitcnt lgkmcnt(3)
v_cmp_u_f16 vcc, v48, v50
v_smfmac_f32_16x16x64_f16 v[80:83], v[36:39], a[48:55], v112
s_cbranch_vccnz main_kernel_c4_m3_f
main_kernel_c4_m3:
v_smfmac_f32_16x16x64_f16 v[80:83], v[48:51], a[24:31], v112
v_smfmac_f32_16x16x64_f16 v[84:87], v[48:51], a[152:159], v112
v_smfmac_f32_16x16x64_f16 v[84:87], v[36:39], a[176:183], v112
s_waitcnt lgkmcnt(2)
v_smfmac_f32_16x16x64_f16 v[80:83], v[40:43], a[80:87], v112
s_waitcnt lgkmcnt(0)
s_barrier
ds_read_b128 v[52:55], v116 offset:13312
v_smfmac_f32_16x16x64_f16 v[84:87], v[40:43], a[208:215], v112
s_add_u32 s19, s52, s54
ds_read_b128 v[56:59], v116 offset:14336
v_smfmac_f32_16x16x64_f16 v[80:83], v[44:47], a[112:119], v112
s_add_u32 s18, s18, 0x40000
ds_read_b128 v[60:63], v116 offset:15360
v_smfmac_f32_16x16x64_f16 v[84:87], v[44:47], a[240:247], v112
s_bitset0_b32 s18, 20
s_waitcnt lgkmcnt(2)
v_smfmac_f32_16x16x64_f16 v[80:83], v[52:55], a[56:63], v112
s_cmp_eq_u32 s17, 30
s_cselect_b32 s32, s53, 0x10000
s_waitcnt lgkmcnt(1)
v_smfmac_f32_16x16x64_f16 v[80:83], v[56:59], a[88:95], v112
s_add_u32 s52, s52, s32
s_waitcnt lgkmcnt(0)
v_smfmac_f32_16x16x64_f16 v[80:83], v[60:63], a[120:127], v112
s_sub_u32 s24, 0x20000, s32
ds_read_b128 v[64:67], v116 offset:24576
v_smfmac_f32_16x16x64_f16 v[84:87], v[52:55], a[184:191], v112
s_add_u32 s55, s55, s24
ds_read_b128 v[68:71], v116 offset:28672
v_smfmac_f32_16x16x64_f16 v[84:87], v[56:59], a[216:223], v112
ds_read_b128 v[72:75], v116 offset:25600
s_nop 0
v_cvt_pk_bf16_f32 v92, v80, v81
v_smfmac_f32_16x16x64_f16 v[84:87], v[60:63], a[248:255], v112
ds_read_b128 v[76:79], v116 offset:29696
s_nop 0
v_cvt_pk_bf16_f32 v93, v82, v83
v_smfmac_f32_16x16x64_f16 v[88:91], v[12:15], v[152:159], v112
s_nop 3
v_cvt_pk_bf16_f32 v94, v84, v85
v_cvt_pk_bf16_f32 v95, v86, v87
s_mov_b32 vcc_lo, 0xcccccccc
s_mov_b32 vcc_hi, 0xcccccccc
v_mfma_f32_16x16x32_bf16 v[84:87], v[92:95], v[104:107], 0
v_add_u32 v121, v121, v122
v_writelane_b32 v121, s55, 39
s_nop 0
v_smfmac_f32_16x16x64_f16 v[88:91], v[16:19], v[160:167], v112
s_nop 2
s_cmp_eq_u32 s17, 63
v_cvt_pk_bf16_f32 v114, v84, v85
v_cvt_pk_bf16_f32 v115, v86, v87
buffer_store_dwordx2 v[114:115], v117, s[4:7], s21 offen sc1
s_cbranch_scc1 main_kernel_c4_last
ds_write_b64 v117, v[114:115] offset:16384
v_smfmac_f32_16x16x64_f16 v[88:91], v[20:23], v[168:175], v112
v_smfmac_f32_16x16x64_f16 v[88:91], v[24:27], v[176:183], v112
v_smfmac_f32_16x16x64_f16 v[88:91], v[28:31], v[184:191], v112
v_smfmac_f32_16x16x64_f16 v[88:91], v[32:35], v[192:199], v112
s_waitcnt lgkmcnt(0)
s_barrier
ds_read_b128 v[0:3], v116 offset:16384
v_smfmac_f32_16x16x64_f16 v[88:91], v[36:39], v[200:207], v112
ds_read_b128 v[4:7], v116 offset:17408
v_smfmac_f32_16x16x64_f16 v[88:91], v[40:43], v[208:215], v112
ds_read_b128 v[16:19], v116 offset:26624
v_smfmac_f32_16x16x64_f16 v[88:91], v[44:47], v[216:223], v112
ds_read_b128 v[20:23], v116 offset:30720
v_smfmac_f32_16x16x64_f16 v[88:91], v[48:51], v[224:231], v112
ds_read_b128 v[24:27], v116 offset:27648
v_smfmac_f32_16x16x64_f16 v[88:91], v[52:55], v[232:239], v112
ds_read_b128 v[28:31], v116 offset:31744
v_smfmac_f32_16x16x64_f16 v[88:91], v[56:59], v[240:247], v112
v_smfmac_f32_16x16x64_f16 v[88:91], v[60:63], v[248:255], v112
s_waitcnt lgkmcnt(5)
v_mfma_f32_16x16x32_bf16 v[80:83], v[64:67], v[0:3], 0
v_mfma_f32_16x16x32_bf16 v[84:87], v[68:71], v[0:3], 0
buffer_load_dwordx4 v[8:11], v116, s[4:7], s20 offen offset:0 sc1
v_mfma_f32_16x16x32_bf16 v[92:95], v[0:3], v[0:3], 0
buffer_load_dwordx4 v[12:15], v116, s[4:7], s20 offen offset:1024 sc1
v_permlane32_swap_b32 v88, v90
s_waitcnt lgkmcnt(4)
v_mfma_f32_16x16x32_bf16 v[80:83], v[72:75], v[4:7], v[80:83]
v_permlane32_swap_b32 v89, v91
v_mfma_f32_16x16x32_bf16 v[84:87], v[76:79], v[4:7], v[84:87]
v_pk_add_f32 v[88:89], v[88:89], v[90:91]
v_mfma_f32_16x16x32_bf16 v[92:95], v[4:7], v[4:7], v[92:95]
v_cvt_pk_bf16_f32 v124, v88, v89
v_mov_b32 v65, 0
s_waitcnt lgkmcnt(0)
s_waitcnt vmcnt(1)
v_mfma_f32_16x16x32_bf16 v[88:91], v[8:11], v[8:11], v[92:95]
v_mfma_f32_16x16x32_bf16 v[0:3], v[16:19], v[8:11], v[80:83]
v_cmp_u_f32 s[0:1], v8, v10
v_mfma_f32_16x16x32_bf16 v[4:7], v[20:23], v[8:11], v[84:87]
s_waitcnt vmcnt(0)
v_mfma_f32_16x16x32_bf16 v[88:91], v[12:15], v[12:15], v[88:91]
v_mfma_f32_16x16x32_bf16 v[0:3], v[24:27], v[12:15], v[0:3]
v_cmp_u_f32 s[32:33], v12, v14
v_mfma_f32_16x16x32_bf16 v[4:7], v[28:31], v[12:15], v[4:7]
s_or_b64 s[0:1], s[0:1], s[32:33]
s_cbranch_scc1 main_kernel_c4_z_f
main_kernel_c4_z:
v_mul_f32 v88, s30, v88
v_mul_f32 v89, s30, v89
v_exp_f32 v88, v88
v_exp_f32 v89, v89
v_cndmask_b32_dpp v0, v2, v0, vcc quad_perm:[2,3,2,3] row_mask:0xf bank_mask:0xf
v_cvt_pk_bf16_f32 v64, v88, v89
v_cndmask_b32_dpp v1, v3, v1, vcc quad_perm:[2,3,2,3] row_mask:0xf bank_mask:0xf
v_exp_f32 v0, v0
v_mfma_f32_16x16x16_bf16 v[16:19], v[100:101], v[64:65], 0
v_exp_f32 v1, v1
v_cndmask_b32_dpp v4, v6, v4, vcc quad_perm:[2,3,2,3] row_mask:0xf bank_mask:0xf
v_mfma_f32_16x16x16_bf16 v[8:11], v[124:125], v[64:65], 0
v_cndmask_b32_dpp v5, v7, v5, vcc quad_perm:[2,3,2,3] row_mask:0xf bank_mask:0xf
v_exp_f32 v4, v4
v_exp_f32 v5, v5
v_cvt_pk_bf16_f32 v92, v0, v1
v_cvt_pk_bf16_f32 v94, v4, v5
v_mov_b32 v80, 0
v_mov_b32_dpp v93, v92 quad_perm:[0,1,0,1] row_mask:0xf bank_mask:0xf
v_mov_b32_dpp v95, v94 quad_perm:[0,1,0,1] row_mask:0xf bank_mask:0xf
v_mov_b32 v81, 0
v_mov_b32 v82, 0
v_mfma_f32_16x16x32_bf16 v[16:19], v[100:103], v[92:95], v[16:19]
v_mov_b32 v83, 0
v_mov_b32 v84, 0
v_mfma_f32_16x16x32_bf16 v[8:11], v[96:99], v[92:95], v[8:11]
s_nop 1
v_mov_b32 v85, 0
v_mov_b32 v86, 0
v_mov_b32 v87, 0
v_rcp_f32 v126, v16
v_subrev_u32 v127, 0x21800000, v16
v_cmp_lt_u32 vcc, 0x3c000000, v127
v_pk_mul_f32 v[8:9], v[8:9], v[126:127] op_sel_hi:[1,0]
v_pk_mul_f32 v[10:11], v[10:11], v[126:127] op_sel_hi:[1,0]
s_and_b32 s32, vcc_lo, 0xcccc
v_cvt_pk_bf16_f32 v126, v8, v9
v_cvt_pk_bf16_f32 v127, v10, v11
s_cbranch_scc1 main_kernel_c4_sm_f
main_kernel_c4_ost:
buffer_store_dwordx2 v[126:127], v118, s[4:7], s22 offen sc1
v_cmp_eq_u32 s[0:1], 0, v123
v_mov_b32 v24, -1
v_mov_b32 v25, -1
v_mov_b32 v26, -1
v_mov_b32 v27, -1
ds_read_b128 v[32:35], v113 offset:0
ds_read_b128 v[36:39], v113 offset:1024
ds_read_b128 v[40:43], v113 offset:2048
ds_read_b128 v[44:47], v113 offset:3072
ds_read_b128 v[48:51], v113 offset:4096
ds_read_b128 v[52:55], v113 offset:5120
s_and_b32 s10, s1, 0x3f00
buffer_store_dwordx4 v[24:27], v116, s[4:7], s3 offen sc1
s_barrier
buffer_load_dwordx4 v[0:3], v116, s[4:7], s23 offen sc1
ds_read_b128 v[56:59], v113 offset:6144
ds_read_b128 v[60:63], v113 offset:7168
s_add_u32 s37, s37, 65536
s_add_u32 s26, s26, 65536
s_nop 1
s_xor_b32 s32, s23, 1024
buffer_load_dwordx4 v[4:7], v116, s[4:7], s32 offen sc1
ds_read_b128 v[64:67], v113 offset:8192
ds_read_b128 v[68:71], v113 offset:9216
s_nop 3
s_xor_b32 s32, s23, 2048
buffer_load_dwordx4 v[8:11], v116, s[4:7], s32 offen sc1
ds_read_b128 v[72:75], v113 offset:10240
ds_read_b128 v[76:79], v113 offset:11264
s_nop 3
s_xor_b32 s32, s23, 3072
buffer_load_dwordx4 v[12:15], v116, s[4:7], s32 offen sc1
ds_read_b128 v[88:91], v113 offset:12288
ds_read_b128 v[92:95], v113 offset:13312
s_nop 3
s_xor_b32 s32, s23, 4096
buffer_load_dwordx4 v[16:19], v116, s[4:7], s32 offen sc1
s_nop 7
s_xor_b32 s32, s23, 5120
buffer_load_dwordx4 v[20:23], v116, s[4:7], s32 offen sc1
s_nop 7
s_xor_b32 s32, s23, 6144
buffer_load_dwordx4 v[24:27], v116, s[4:7], s32 offen sc1
s_nop 7
s_xor_b32 s32, s23, 7168
buffer_load_dwordx4 v[28:31], v116, s[4:7], s32 offen sc1
s_waitcnt lgkmcnt(12)
s_waitcnt vmcnt(7)
v_cmp_u_f32 vcc, v0, v2
s_cbranch_vccnz main_kernel_c4_o0_f
main_kernel_c4_o0:
v_smfmac_f32_16x16x64_bf16 v[80:83], v[0:3], v[32:39], v112
ds_read_b128 v[32:35], v113 offset:14336
ds_read_b128 v[36:39], v113 offset:15360
s_waitcnt lgkmcnt(12)
s_waitcnt vmcnt(6)
v_cmp_u_f32 vcc, v4, v6
v_smfmac_f32_16x16x64_bf16 v[84:87], v[0:3], v[40:47], v112
ds_read_b128 v[40:43], v113 offset:16384
ds_read_b128 v[44:47], v113 offset:17408
buffer_store_dwordx2 v[114:115], v119, s[4:7], s37 offen sc1
s_cbranch_vccnz main_kernel_c4_o1_f
main_kernel_c4_o1:
s_waitcnt lgkmcnt(12)
v_smfmac_f32_16x16x64_bf16 v[80:83], v[4:7], v[48:55], v112
ds_read_b128 v[48:51], v113 offset:18432
ds_read_b128 v[52:55], v113 offset:19456
s_waitcnt lgkmcnt(12)
s_waitcnt vmcnt(6)
v_cmp_u_f32 vcc, v8, v10
v_smfmac_f32_16x16x64_bf16 v[84:87], v[4:7], v[56:63], v112
ds_read_b128 v[56:59], v113 offset:20480
ds_read_b128 v[60:63], v113 offset:21504
buffer_store_dword v124, v120, s[4:7], s26 offen sc1
s_cbranch_vccnz main_kernel_c4_o2_f
main_kernel_c4_o2:
s_waitcnt lgkmcnt(12)
v_smfmac_f32_16x16x64_bf16 v[80:83], v[8:11], v[64:71], v112
ds_read_b128 v[64:67], v113 offset:22528
ds_read_b128 v[68:71], v113 offset:23552
s_waitcnt lgkmcnt(12)
s_waitcnt vmcnt(6)
v_cmp_u_f32 vcc, v12, v14
v_smfmac_f32_16x16x64_bf16 v[84:87], v[8:11], v[72:79], v112
ds_read_b128 v[72:75], v113 offset:24576
ds_read_b128 v[76:79], v113 offset:25600
s_cbranch_vccnz main_kernel_c4_o3_f
main_kernel_c4_o3:
s_waitcnt lgkmcnt(12)
v_smfmac_f32_16x16x64_bf16 v[80:83], v[12:15], v[88:95], v112
ds_read_b128 v[88:91], v113 offset:26624
ds_read_b128 v[92:95], v113 offset:27648
s_waitcnt lgkmcnt(12)
s_waitcnt vmcnt(5)
v_cmp_u_f32 vcc, v16, v18
v_smfmac_f32_16x16x64_bf16 v[84:87], v[12:15], v[32:39], v112
ds_read_b128 v[32:35], v113 offset:28672
ds_read_b128 v[36:39], v113 offset:29696
s_cbranch_vccnz main_kernel_c4_o4_f
main_kernel_c4_o4:
s_waitcnt lgkmcnt(12)
v_smfmac_f32_16x16x64_bf16 v[80:83], v[16:19], v[40:47], v112
ds_read_b128 v[40:43], v113 offset:30720
ds_read_b128 v[44:47], v113 offset:31744
s_waitcnt lgkmcnt(12)
s_waitcnt vmcnt(4)
v_cmp_u_f32 vcc, v20, v22
v_smfmac_f32_16x16x64_bf16 v[84:87], v[16:19], v[48:55], v112
s_cbranch_vccnz main_kernel_c4_o5_f
main_kernel_c4_o5:
s_waitcnt lgkmcnt(10)
v_smfmac_f32_16x16x64_bf16 v[80:83], v[20:23], v[56:63], v112
s_waitcnt lgkmcnt(8)
s_waitcnt vmcnt(3)
v_cmp_u_f32 vcc, v24, v26
v_smfmac_f32_16x16x64_bf16 v[84:87], v[20:23], v[64:71], v112
s_cbranch_vccnz main_kernel_c4_o6_f
main_kernel_c4_o6:
s_waitcnt lgkmcnt(6)
v_smfmac_f32_16x16x64_bf16 v[80:83], v[24:27], v[72:79], v112
s_waitcnt lgkmcnt(4)
v_smfmac_f32_16x16x64_bf16 v[84:87], v[24:27], v[88:95], v112
s_waitcnt lgkmcnt(2)
s_waitcnt vmcnt(2)
v_cmp_u_f32 vcc, v28, v30
s_cbranch_vccnz main_kernel_c4_o7_f
main_kernel_c4_o7:
v_smfmac_f32_16x16x64_bf16 v[80:83], v[28:31], v[32:39], v112
s_waitcnt lgkmcnt(0)
v_smfmac_f32_16x16x64_bf16 v[84:87], v[28:31], v[40:47], v112
s_nop 4
v_cvt_pk_bf16_f32 v80, v80, v81
v_cvt_pk_bf16_f32 v81, v82, v83
ds_write_b64 v116, v[80:81] offset:20480
v_cvt_pk_bf16_f32 v82, v84, v85
v_cvt_pk_bf16_f32 v83, v86, v87
ds_write_b64 v116, v[82:83] offset:22528
s_waitcnt lgkmcnt(0)
s_barrier
ds_read_b128 v[72:75], v116 offset:20480
ds_read_b128 v[76:79], v116 offset:21504
s_mov_b32 m0, 24576
s_cmp_lg_u32 s10, 0
s_waitcnt lgkmcnt(1)
v_mfma_f32_16x16x32_bf16 v[64:67], v[72:75], v[108:111], 0
s_waitcnt lgkmcnt(0)
v_mfma_f32_16x16x32_bf16 v[64:67], v[76:79], v[108:111], v[64:67]
s_nop 7
v_cvt_pk_f16_f32 v68, v64, v65
v_cvt_pk_f16_f32 v69, v66, v67
buffer_store_dwordx2 v[68:69], v125, s[4:7], s25 offen sc1
s_cbranch_scc1 main_kernel_c4_kvw
main_kernel_c4_kvok:
s_nop 3
buffer_load_dwordx4 v116, s[4:7], s27 offen sc1 lds
buffer_load_dwordx4 v116, s[4:7], s27 offen offset:1024 sc1 lds
s_add_u32 s27, s27, 0x40000
s_branch main_kernel_c4_top
main_kernel_c4_kvw:
s_mov_b32 exec_lo, 0
s_mov_b32 exec_hi, 0x3f00
v_subrev_u32 v127, 128, v121
main_kernel_c4_kvp:
buffer_load_dword v126, v127, s[4:7], 0 offen sc1
s_waitcnt vmcnt(0)
v_cmp_eq_u32 vcc, 0, v126
s_cbranch_vccz main_kernel_c4_kvp_ok
s_sleep 2
s_sub_u32 s29, s29, 1
s_cbranch_scc0 main_kernel_c4_kvp
s_branch main_kernel_end
main_kernel_c4_kvp_ok:
s_mov_b64 exec, -1
s_branch main_kernel_c4_kvok
main_kernel_c4_last:
s_add_u32 s37, s37, 65536
s_add_u32 s26, s26, 65536
buffer_store_dwordx2 v[114:115], v119, s[4:7], s37 offen sc1
v_smfmac_f32_16x16x64_f16 v[88:91], v[20:23], v[168:175], v112
v_smfmac_f32_16x16x64_f16 v[88:91], v[24:27], v[176:183], v112
v_smfmac_f32_16x16x64_f16 v[88:91], v[28:31], v[184:191], v112
v_smfmac_f32_16x16x64_f16 v[88:91], v[32:35], v[192:199], v112
v_smfmac_f32_16x16x64_f16 v[88:91], v[36:39], v[200:207], v112
v_smfmac_f32_16x16x64_f16 v[88:91], v[40:43], v[208:215], v112
v_smfmac_f32_16x16x64_f16 v[88:91], v[44:47], v[216:223], v112
v_smfmac_f32_16x16x64_f16 v[88:91], v[48:51], v[224:231], v112
v_smfmac_f32_16x16x64_f16 v[88:91], v[52:55], v[232:239], v112
v_smfmac_f32_16x16x64_f16 v[88:91], v[56:59], v[240:247], v112
v_smfmac_f32_16x16x64_f16 v[88:91], v[60:63], v[248:255], v112
s_nop 7
v_permlane32_swap_b32 v88, v90
s_nop 1
v_permlane32_swap_b32 v89, v91
s_nop 1
v_pk_add_f32 v[88:89], v[88:89], v[90:91]
s_nop 1
v_cvt_pk_bf16_f32 v124, v88, v89
s_nop 1
buffer_store_dword v124, v120, s[4:7], s26 offen sc1
s_branch main_kernel_end
main_kernel_c4_m0_f:
s_waitcnt lgkmcnt(0)
buffer_load_dwordx4 v[0:3], v116, s[4:7], s18 offen sc1
buffer_load_dwordx4 v[64:67], v116, s[4:7], s19 offen sc1
s_xor_b32 s32, s18, 1024
buffer_load_dwordx4 v[16:19], v116, s[4:7], s32 offen sc1
s_xor_b32 s32, s19, 1024
buffer_load_dwordx4 v[68:71], v116, s[4:7], s32 offen sc1
s_xor_b32 s32, s18, 2048
buffer_load_dwordx4 v[32:35], v116, s[4:7], s32 offen sc1
s_xor_b32 s32, s19, 2048
buffer_load_dwordx4 v[72:75], v116, s[4:7], s32 offen sc1
s_xor_b32 s32, s18, 3072
buffer_load_dwordx4 v[48:51], v116, s[4:7], s32 offen sc1
s_xor_b32 s32, s19, 3072
buffer_load_dwordx4 v[76:79], v116, s[4:7], s32 offen sc1
s_sub_u32 s29, s29, 1
s_cbranch_scc1 main_kernel_end
s_waitcnt vmcnt(0)
v_max_u32 v126, v0, v2
v_max3_u32 v126, v126, v64, v66
v_cmp_eq_u32 vcc, -1, v126
s_cbranch_vccnz main_kernel_c4_m0_f
v_pk_add_f16 v0, v0, v64
v_pk_add_f16 v1, v1, v65
v_pk_add_f16 v2, v2, v66
v_pk_add_f16 v3, v3, v67
s_nop 0
s_branch main_kernel_c4_m0
main_kernel_c4_m1_f:
s_waitcnt lgkmcnt(0)
s_xor_b32 s32, s18, 1024
buffer_load_dwordx4 v[16:19], v116, s[4:7], s32 offen sc1
s_xor_b32 s32, s19, 1024
buffer_load_dwordx4 v[68:71], v116, s[4:7], s32 offen sc1
s_xor_b32 s32, s18, 2048
buffer_load_dwordx4 v[32:35], v116, s[4:7], s32 offen sc1
s_xor_b32 s32, s19, 2048
buffer_load_dwordx4 v[72:75], v116, s[4:7], s32 offen sc1
s_xor_b32 s32, s18, 3072
buffer_load_dwordx4 v[48:51], v116, s[4:7], s32 offen sc1
s_xor_b32 s32, s19, 3072
buffer_load_dwordx4 v[76:79], v116, s[4:7], s32 offen sc1
s_sub_u32 s29, s29, 1
s_cbranch_scc1 main_kernel_end
s_waitcnt vmcnt(0)
v_max_u32 v126, v16, v18
v_max3_u32 v126, v126, v68, v70
v_cmp_eq_u32 vcc, -1, v126
s_cbranch_vccnz main_kernel_c4_m1_f
v_pk_add_f16 v16, v16, v68
v_pk_add_f16 v17, v17, v69
v_pk_add_f16 v18, v18, v70
v_pk_add_f16 v19, v19, v71
ds_write_b128 v116, v[16:19] offset:4096
s_branch main_kernel_c4_m1
main_kernel_c4_m2_f:
s_waitcnt lgkmcnt(0)
s_xor_b32 s32, s18, 2048
buffer_load_dwordx4 v[32:35], v116, s[4:7], s32 offen sc1
s_xor_b32 s32, s19, 2048
buffer_load_dwordx4 v[72:75], v116, s[4:7], s32 offen sc1
s_xor_b32 s32, s18, 3072
buffer_load_dwordx4 v[48:51], v116, s[4:7], s32 offen sc1
s_xor_b32 s32, s19, 3072
buffer_load_dwordx4 v[76:79], v116, s[4:7], s32 offen sc1
s_sub_u32 s29, s29, 1
s_cbranch_scc1 main_kernel_end
s_waitcnt vmcnt(0)
v_max_u32 v126, v32, v34
v_max3_u32 v126, v126, v72, v74
v_cmp_eq_u32 vcc, -1, v126
s_cbranch_vccnz main_kernel_c4_m2_f
v_pk_add_f16 v32, v32, v72
v_pk_add_f16 v33, v33, v73
v_pk_add_f16 v34, v34, v74
v_pk_add_f16 v35, v35, v75
ds_write_b128 v116, v[32:35] offset:8192
s_branch main_kernel_c4_m2
main_kernel_c4_m3_f:
s_waitcnt lgkmcnt(0)
s_xor_b32 s32, s18, 3072
buffer_load_dwordx4 v[48:51], v116, s[4:7], s32 offen sc1
s_xor_b32 s32, s19, 3072
buffer_load_dwordx4 v[76:79], v116, s[4:7], s32 offen sc1
s_sub_u32 s29, s29, 1
s_cbranch_scc1 main_kernel_end
s_waitcnt vmcnt(0)
v_max_u32 v126, v48, v50
v_max3_u32 v126, v126, v76, v78
v_cmp_eq_u32 vcc, -1, v126
s_cbranch_vccnz main_kernel_c4_m3_f
v_pk_add_f16 v48, v48, v76
v_pk_add_f16 v49, v49, v77
v_pk_add_f16 v50, v50, v78
v_pk_add_f16 v51, v51, v79
ds_write_b128 v116, v[48:51] offset:12288
s_branch main_kernel_c4_m3
main_kernel_c4_z_f:
buffer_load_dwordx4 v[8:11], v116, s[4:7], s20 offen offset:0 sc1
buffer_load_dwordx4 v[12:15], v116, s[4:7], s20 offen offset:1024 sc1
s_memtime s[32:33]
ds_read_b32 v126, v116 offset:18432
s_sub_u32 s34, s19, s54
s_xor_b32 s34, s34, 0x2000
s_lshl_b32 s35, s12, 15
s_add_u32 s34, s34, s35
s_lshl_b32 s35, s13, 8
s_add_u32 s35, s35, s34
s_add_u32 s34, s34, 0x4000
s_waitcnt lgkmcnt(0)
s_sub_u32 s32, s32, 450
v_sub_u32 v127, s32, v126
buffer_store_dword v127, off, s[4:7], s34 sc1
s_sub_u32 s29, s29, 1
s_cbranch_scc1 main_kernel_end
s_waitcnt vmcnt(1)
main_kernel_c4_z_g:
v_max_u32 v126, v8, v10
v_max3_u32 v126, v126, v12, v14
v_cmp_eq_u32 vcc, -1, v126
s_cbranch_vccnz main_kernel_c4_z_h
v_mfma_f32_16x16x32_bf16 v[88:91], v[8:11], v[8:11], v[92:95]
v_mfma_f32_16x16x32_bf16 v[0:3], v[16:19], v[8:11], v[80:83]
v_mfma_f32_16x16x32_bf16 v[4:7], v[20:23], v[8:11], v[84:87]
v_mfma_f32_16x16x32_bf16 v[88:91], v[12:15], v[12:15], v[88:91]
v_mfma_f32_16x16x32_bf16 v[0:3], v[24:27], v[12:15], v[0:3]
v_mfma_f32_16x16x32_bf16 v[4:7], v[28:31], v[12:15], v[4:7]
buffer_store_dword v127, off, s[4:7], s35 offset:132 sc1
s_mov_b32 vcc_lo, 0xcccccccc
s_mov_b32 vcc_hi, 0xcccccccc
s_branch main_kernel_c4_z
main_kernel_c4_z_h:
buffer_load_dwordx4 v[8:11], v116, s[4:7], s20 offen offset:0 sc1
buffer_load_dwordx4 v[12:15], v116, s[4:7], s20 offen offset:1024 sc1
s_sub_u32 s29, s29, 1
s_cbranch_scc1 main_kernel_end
v_add_u32 v127, 300, v127
s_waitcnt vmcnt(0)
s_branch main_kernel_c4_z_g
main_kernel_c4_sm_f:
s_waitcnt vmcnt(0) lgkmcnt(0)
buffer_load_dwordx4 v[8:11], v116, s[4:7], s20 offen offset:0 sc1
buffer_load_dwordx4 v[12:15], v116, s[4:7], s20 offen offset:1024 sc1
ds_read_b128 v[0:3], v116 offset:16384
ds_read_b128 v[4:7], v116 offset:17408
ds_read_b128 v[64:67], v116 offset:24576
ds_read_b128 v[68:71], v116 offset:28672
ds_read_b128 v[72:75], v116 offset:25600
ds_read_b128 v[76:79], v116 offset:29696
ds_read_b128 v[16:19], v116 offset:26624
ds_read_b128 v[20:23], v116 offset:30720
ds_read_b128 v[24:27], v116 offset:27648
ds_read_b128 v[28:31], v116 offset:31744
s_waitcnt vmcnt(0)
s_waitcnt lgkmcnt(0)
v_mfma_f32_16x16x32_bf16 v[80:83], v[64:67], v[0:3], 0
v_mfma_f32_16x16x32_bf16 v[84:87], v[68:71], v[0:3], 0
v_mfma_f32_16x16x32_bf16 v[92:95], v[0:3], v[0:3], 0
v_mfma_f32_16x16x32_bf16 v[80:83], v[72:75], v[4:7], v[80:83]
v_mfma_f32_16x16x32_bf16 v[84:87], v[76:79], v[4:7], v[84:87]
v_mfma_f32_16x16x32_bf16 v[92:95], v[4:7], v[4:7], v[92:95]
v_mfma_f32_16x16x32_bf16 v[0:3], v[16:19], v[8:11], v[80:83]
v_mfma_f32_16x16x32_bf16 v[4:7], v[20:23], v[8:11], v[84:87]
v_mfma_f32_16x16x32_bf16 v[88:91], v[8:11], v[8:11], v[92:95]
v_mfma_f32_16x16x32_bf16 v[0:3], v[24:27], v[12:15], v[0:3]
v_mfma_f32_16x16x32_bf16 v[4:7], v[28:31], v[12:15], v[4:7]
v_mfma_f32_16x16x32_bf16 v[88:91], v[12:15], v[12:15], v[88:91]
s_nop 7
v_mov_b32 v65, 0
v_max_f32 v126, v88, v89
v_mul_f32 v126, s30, v126
v_max3_f32 v126, v126, v0, v1
v_max3_f32 v126, v126, v2, v3
v_max3_f32 v126, v126, v4, v5
v_max3_f32 v126, v126, v6, v7
v_mov_b32 v127, v126
s_nop 1
v_permlane32_swap_b32 v126, v127
v_max_f32 v126, v126, v127
v_mov_b32 v127, v126
s_nop 1
v_permlane16_swap_b32 v126, v127
v_max_f32 v126, v126, v127
v_mul_f32 v127, 0x40faf233, v126
s_mov_b32 vcc_lo, 0xcccccccc
s_mov_b32 vcc_hi, 0xcccccccc
v_sub_f32 v0, v0, v126
v_sub_f32 v1, v1, v126
v_sub_f32 v2, v2, v126
v_sub_f32 v3, v3, v126
v_sub_f32 v4, v4, v126
v_sub_f32 v5, v5, v126
v_sub_f32 v6, v6, v126
v_sub_f32 v7, v7, v126
v_sub_f32 v88, v88, v127
v_sub_f32 v89, v89, v127
s_waitcnt lgkmcnt(0)
s_nop 0
v_mul_f32 v88, s30, v88
v_mul_f32 v89, s30, v89
v_exp_f32 v88, v88
v_exp_f32 v89, v89
v_cndmask_b32_dpp v0, v2, v0, vcc quad_perm:[2,3,2,3] row_mask:0xf bank_mask:0xf
v_cvt_pk_bf16_f32 v64, v88, v89
v_cndmask_b32_dpp v1, v3, v1, vcc quad_perm:[2,3,2,3] row_mask:0xf bank_mask:0xf
v_exp_f32 v0, v0
v_mfma_f32_16x16x16_bf16 v[16:19], v[100:101], v[64:65], 0
v_exp_f32 v1, v1
v_cndmask_b32_dpp v4, v6, v4, vcc quad_perm:[2,3,2,3] row_mask:0xf bank_mask:0xf
v_mfma_f32_16x16x16_bf16 v[8:11], v[124:125], v[64:65], 0
v_cndmask_b32_dpp v5, v7, v5, vcc quad_perm:[2,3,2,3] row_mask:0xf bank_mask:0xf
v_exp_f32 v4, v4
v_exp_f32 v5, v5
v_cvt_pk_bf16_f32 v92, v0, v1
v_cvt_pk_bf16_f32 v94, v4, v5
v_mov_b32 v80, 0
v_mov_b32_dpp v93, v92 quad_perm:[0,1,0,1] row_mask:0xf bank_mask:0xf
v_mov_b32_dpp v95, v94 quad_perm:[0,1,0,1] row_mask:0xf bank_mask:0xf
v_mov_b32 v81, 0
v_mov_b32 v82, 0
v_mfma_f32_16x16x32_bf16 v[16:19], v[100:103], v[92:95], v[16:19]
v_mov_b32 v83, 0
v_mov_b32 v84, 0
v_mfma_f32_16x16x32_bf16 v[8:11], v[96:99], v[92:95], v[8:11]
s_nop 1
v_mov_b32 v85, 0
v_mov_b32 v86, 0
v_mov_b32 v87, 0
v_rcp_f32 v126, v16
v_subrev_u32 v127, 0x21800000, v16
v_cmp_lt_u32 vcc, 0x3c000000, v127
v_pk_mul_f32 v[8:9], v[8:9], v[126:127] op_sel_hi:[1,0]
v_pk_mul_f32 v[10:11], v[10:11], v[126:127] op_sel_hi:[1,0]
s_and_b32 s32, vcc_lo, 0xcccc
v_cvt_pk_bf16_f32 v126, v8, v9
v_cvt_pk_bf16_f32 v127, v10, v11
s_branch main_kernel_c4_ost
main_kernel_c4_o0_f:
s_nop 0
buffer_load_dwordx4 v[0:3], v116, s[4:7], s23 offen sc1
s_xor_b32 s32, s23, 1024
buffer_load_dwordx4 v[4:7], v116, s[4:7], s32 offen sc1
s_sub_u32 s29, s29, 1
s_cbranch_scc1 main_kernel_end
s_waitcnt vmcnt(0)
v_max_u32 v126, v0, v2
v_cmp_eq_u32 vcc, -1, v126
s_cbranch_vccnz main_kernel_c4_o0_f
s_branch main_kernel_c4_o0
main_kernel_c4_o1_f:
s_nop 0
s_xor_b32 s32, s23, 1024
buffer_load_dwordx4 v[4:7], v116, s[4:7], s32 offen sc1
s_xor_b32 s32, s23, 2048
buffer_load_dwordx4 v[8:11], v116, s[4:7], s32 offen sc1
s_sub_u32 s29, s29, 1
s_cbranch_scc1 main_kernel_end
s_waitcnt vmcnt(0)
v_max_u32 v126, v4, v6
v_cmp_eq_u32 vcc, -1, v126
s_cbranch_vccnz main_kernel_c4_o1_f
s_branch main_kernel_c4_o1
main_kernel_c4_o2_f:
s_nop 0
s_xor_b32 s32, s23, 2048
buffer_load_dwordx4 v[8:11], v116, s[4:7], s32 offen sc1
s_xor_b32 s32, s23, 3072
buffer_load_dwordx4 v[12:15], v116, s[4:7], s32 offen sc1
s_sub_u32 s29, s29, 1
s_cbranch_scc1 main_kernel_end
s_waitcnt vmcnt(0)
v_max_u32 v126, v8, v10
v_cmp_eq_u32 vcc, -1, v126
s_cbranch_vccnz main_kernel_c4_o2_f
s_branch main_kernel_c4_o2
main_kernel_c4_o3_f:
s_nop 0
s_xor_b32 s32, s23, 3072
buffer_load_dwordx4 v[12:15], v116, s[4:7], s32 offen sc1
s_xor_b32 s32, s23, 4096
buffer_load_dwordx4 v[16:19], v116, s[4:7], s32 offen sc1
s_sub_u32 s29, s29, 1
s_cbranch_scc1 main_kernel_end
s_waitcnt vmcnt(0)
v_max_u32 v126, v12, v14
v_cmp_eq_u32 vcc, -1, v126
s_cbranch_vccnz main_kernel_c4_o3_f
s_branch main_kernel_c4_o3
main_kernel_c4_o4_f:
s_nop 0
s_xor_b32 s32, s23, 4096
buffer_load_dwordx4 v[16:19], v116, s[4:7], s32 offen sc1
s_xor_b32 s32, s23, 5120
buffer_load_dwordx4 v[20:23], v116, s[4:7], s32 offen sc1
s_sub_u32 s29, s29, 1
s_cbranch_scc1 main_kernel_end
s_waitcnt vmcnt(0)
v_max_u32 v126, v16, v18
v_cmp_eq_u32 vcc, -1, v126
s_cbranch_vccnz main_kernel_c4_o4_f
s_branch main_kernel_c4_o4
main_kernel_c4_o5_f:
s_nop 0
s_xor_b32 s32, s23, 5120
buffer_load_dwordx4 v[20:23], v116, s[4:7], s32 offen sc1
s_xor_b32 s32, s23, 6144
buffer_load_dwordx4 v[24:27], v116, s[4:7], s32 offen sc1
s_sub_u32 s29, s29, 1
s_cbranch_scc1 main_kernel_end
s_waitcnt vmcnt(0)
v_max_u32 v126, v20, v22
v_cmp_eq_u32 vcc, -1, v126
s_cbranch_vccnz main_kernel_c4_o5_f
s_branch main_kernel_c4_o5
main_kernel_c4_o6_f:
s_nop 0
s_xor_b32 s32, s23, 6144
buffer_load_dwordx4 v[24:27], v116, s[4:7], s32 offen sc1
s_xor_b32 s32, s23, 7168
buffer_load_dwordx4 v[28:31], v116, s[4:7], s32 offen sc1
s_sub_u32 s29, s29, 1
s_cbranch_scc1 main_kernel_end
s_waitcnt vmcnt(0)
v_max_u32 v126, v24, v26
v_cmp_eq_u32 vcc, -1, v126
s_cbranch_vccnz main_kernel_c4_o6_f
s_branch main_kernel_c4_o6
main_kernel_c4_o7_f:
s_nop 0
s_xor_b32 s32, s23, 7168
buffer_load_dwordx4 v[28:31], v116, s[4:7], s32 offen sc1
s_sub_u32 s29, s29, 1
s_cbranch_scc1 main_kernel_end
s_waitcnt vmcnt(0)
v_max_u32 v126, v28, v30
v_cmp_eq_u32 vcc, -1, v126
s_cbranch_vccnz main_kernel_c4_o7_f
s_branch main_kernel_c4_o7
.p2align 6
main_kernel_c5_top:
s_barrier
buffer_load_dwordx4 v[0:3], v116, s[4:7], s18 offen sc1
s_add_u32 s20, s20, 0x40000
s_bitset0_b32 s20, 20
s_add_u32 s21, s21, 0x40000
s_bitset0_b32 s21, 20
s_add_u32 s22, s22, 0x40000
s_bitset0_b32 s22, 20
s_add_u32 s23, s23, 0x40000
s_bitset0_b32 s23, 20
s_xor_b32 s32, s18, 1024
buffer_load_dwordx4 v[16:19], v116, s[4:7], s32 offen sc1
s_add_u32 s3, s3, 0x40000
s_bitset0_b32 s3, 20
s_add_u32 s17, s17, 1
s_bitcmp1_b32 0x77777777, s17
s_cselect_b32 s33, 0x800, 0
s_xor_b32 s54, s54, s33
s_xor_b32 s59, s59, s33
s_add_u32 s25, s52, s59
s_nop 0
buffer_load_dwordx4 v[64:67], v116, s[4:7], s19 offen sc1
v_mov_b32 v80, 0
v_mov_b32 v81, 0
s_nop 3
s_xor_b32 s32, s19, 1024
buffer_load_dwordx4 v[68:71], v116, s[4:7], s32 offen sc1
v_mov_b32 v82, 0
v_mov_b32 v83, 0
s_nop 3
s_xor_b32 s32, s18, 2048
buffer_load_dwordx4 v[32:35], v116, s[4:7], s32 offen sc1
v_mov_b32 v84, 0
v_mov_b32 v85, 0
s_nop 3
s_xor_b32 s32, s19, 2048
buffer_load_dwordx4 v[72:75], v116, s[4:7], s32 offen sc1
v_mov_b32 v86, 0
v_mov_b32 v87, 0
s_nop 3
s_xor_b32 s32, s18, 3072
buffer_load_dwordx4 v[48:51], v116, s[4:7], s32 offen sc1
v_mov_b32 v88, 0
v_mov_b32 v89, 0
s_nop 3
s_xor_b32 s32, s19, 3072
buffer_load_dwordx4 v[76:79], v116, s[4:7], s32 offen sc1
v_mov_b32 v90, 0
v_mov_b32 v91, 0
s_waitcnt vmcnt(5)
v_pk_add_f16 v0, v0, v64
v_pk_add_f16 v1, v1, v65
v_pk_add_f16 v2, v2, v66
v_pk_add_f16 v3, v3, v67
v_cmp_u_f16 vcc, v0, v2
s_cbranch_vccnz main_kernel_c5_m0_f
main_kernel_c5_m0:
v_smfmac_f32_16x16x64_f16 v[80:83], v[0:3], a[0:7], v112
ds_write_b128 v116, v[0:3] offset:1024
v_smfmac_f32_16x16x64_f16 v[84:87], v[0:3], a[128:135], v112
buffer_load_dword v123, v121, s[4:7], 0 offen sc1
s_waitcnt vmcnt(5)
v_pk_add_f16 v16, v16, v68
v_pk_add_f16 v17, v17, v69
v_pk_add_f16 v18, v18, v70
v_pk_add_f16 v19, v19, v71
v_cmp_u_f16 vcc, v16, v18
s_waitcnt lgkmcnt(0)
s_barrier
ds_read_b128 v[4:7], v116 offset:0
ds_write_b128 v116, v[16:19] offset:5120
s_cbranch_vccnz main_kernel_c5_m1_f
main_kernel_c5_m1:
v_smfmac_f32_16x16x64_f16 v[80:83], v[16:19], a[8:15], v112
v_smfmac_f32_16x16x64_f16 v[84:87], v[16:19], a[136:143], v112
ds_read_b128 v[8:11], v116 offset:3072
v_smfmac_f32_16x16x64_f16 v[88:91], v[0:3], v[128:135], v112
ds_read_b128 v[12:15], v116 offset:2048
s_waitcnt lgkmcnt(3)
v_smfmac_f32_16x16x64_f16 v[80:83], v[4:7], a[32:39], v112
v_smfmac_f32_16x16x64_f16 v[84:87], v[4:7], a[160:167], v112
v_smfmac_f32_16x16x64_f16 v[88:91], v[4:7], v[136:143], v112
s_waitcnt lgkmcnt(2)
s_barrier
s_waitcnt lgkmcnt(1)
v_smfmac_f32_16x16x64_f16 v[80:83], v[8:11], a[64:71], v112
s_waitcnt vmcnt(3)
ds_read_b128 v[20:23], v116 offset:4096
v_pk_add_f16 v32, v32, v72
v_smfmac_f32_16x16x64_f16 v[84:87], v[8:11], a[192:199], v112
ds_read_b128 v[24:27], v116 offset:7168
s_waitcnt lgkmcnt(2)
v_pk_add_f16 v33, v33, v73
v_smfmac_f32_16x16x64_f16 v[80:83], v[12:15], a[96:103], v112
ds_read_b128 v[28:31], v116 offset:6144
v_pk_add_f16 v34, v34, v74
v_smfmac_f32_16x16x64_f16 v[84:87], v[12:15], a[224:231], v112
s_waitcnt lgkmcnt(2)
v_pk_add_f16 v35, v35, v75
v_smfmac_f32_16x16x64_f16 v[80:83], v[20:23], a[40:47], v112
ds_write_b128 v116, v[32:35] offset:9216
v_cmp_u_f16 vcc, v32, v34
v_smfmac_f32_16x16x64_f16 v[84:87], v[20:23], a[168:175], v112
s_cbranch_vccnz main_kernel_c5_m2_f
main_kernel_c5_m2:
v_smfmac_f32_16x16x64_f16 v[80:83], v[32:35], a[16:23], v112
buffer_load_dwordx4 v[96:99], v116, s[4:7], s28 offen sc1
v_smfmac_f32_16x16x64_f16 v[84:87], v[32:35], a[144:151], v112
s_add_u32 s28, s28, 0x40000
s_waitcnt lgkmcnt(2)
v_smfmac_f32_16x16x64_f16 v[80:83], v[24:27], a[72:79], v112
s_waitcnt vmcnt(2)
v_pk_add_f16 v48, v48, v76
v_smfmac_f32_16x16x64_f16 v[84:87], v[24:27], a[200:207], v112
s_waitcnt lgkmcnt(0)
s_barrier
ds_read_b128 v[36:39], v116 offset:8192
v_pk_add_f16 v49, v49, v77
v_smfmac_f32_16x16x64_f16 v[80:83], v[28:31], a[104:111], v112
ds_read_b128 v[40:43], v116 offset:11264
v_pk_add_f16 v50, v50, v78
v_smfmac_f32_16x16x64_f16 v[84:87], v[28:31], a[232:239], v112
ds_read_b128 v[44:47], v116 offset:10240
v_pk_add_f16 v51, v51, v79
v_smfmac_f32_16x16x64_f16 v[88:91], v[8:11], v[144:151], v112
ds_write_b128 v116, v[48:51] offset:13312
s_waitcnt lgkmcnt(3)
v_cmp_u_f16 vcc, v48, v50
v_smfmac_f32_16x16x64_f16 v[80:83], v[36:39], a[48:55], v112
s_cbranch_vccnz main_kernel_c5_m3_f
main_kernel_c5_m3:
v_smfmac_f32_16x16x64_f16 v[80:83], v[48:51], a[24:31], v112
v_smfmac_f32_16x16x64_f16 v[84:87], v[48:51], a[152:159], v112
v_smfmac_f32_16x16x64_f16 v[84:87], v[36:39], a[176:183], v112
s_waitcnt lgkmcnt(2)
v_smfmac_f32_16x16x64_f16 v[80:83], v[40:43], a[80:87], v112
s_waitcnt lgkmcnt(0)
s_barrier
ds_read_b128 v[52:55], v116 offset:12288
v_smfmac_f32_16x16x64_f16 v[84:87], v[40:43], a[208:215], v112
s_add_u32 s19, s52, s54
ds_read_b128 v[56:59], v116 offset:15360
v_smfmac_f32_16x16x64_f16 v[80:83], v[44:47], a[112:119], v112
s_add_u32 s18, s18, 0x40000
ds_read_b128 v[60:63], v116 offset:14336
v_smfmac_f32_16x16x64_f16 v[84:87], v[44:47], a[240:247], v112
s_bitset0_b32 s18, 20
s_waitcnt lgkmcnt(2)
v_smfmac_f32_16x16x64_f16 v[80:83], v[52:55], a[56:63], v112
s_cmp_eq_u32 s17, 30
s_cselect_b32 s32, s53, 0x10000
s_waitcnt lgkmcnt(1)
v_smfmac_f32_16x16x64_f16 v[80:83], v[56:59], a[88:95], v112
s_add_u32 s52, s52, s32
s_waitcnt lgkmcnt(0)
v_smfmac_f32_16x16x64_f16 v[80:83], v[60:63], a[120:127], v112
s_sub_u32 s24, 0x20000, s32
ds_read_b128 v[64:67], v116 offset:24576
v_smfmac_f32_16x16x64_f16 v[84:87], v[52:55], a[184:191], v112
s_add_u32 s55, s55, s24
ds_read_b128 v[68:71], v116 offset:28672
v_smfmac_f32_16x16x64_f16 v[84:87], v[56:59], a[216:223], v112
ds_read_b128 v[72:75], v116 offset:25600
s_nop 0
v_cvt_pk_bf16_f32 v92, v80, v81
v_smfmac_f32_16x16x64_f16 v[84:87], v[60:63], a[248:255], v112
ds_read_b128 v[76:79], v116 offset:29696
s_nop 0
v_cvt_pk_bf16_f32 v93, v82, v83
v_smfmac_f32_16x16x64_f16 v[88:91], v[12:15], v[152:159], v112
s_nop 3
v_cvt_pk_bf16_f32 v94, v84, v85
v_cvt_pk_bf16_f32 v95, v86, v87
s_mov_b32 vcc_lo, 0xcccccccc
s_mov_b32 vcc_hi, 0xcccccccc
v_mfma_f32_16x16x32_bf16 v[84:87], v[92:95], v[104:107], 0
v_add_u32 v121, v121, v122
v_writelane_b32 v121, s55, 39
s_nop 0
v_smfmac_f32_16x16x64_f16 v[88:91], v[16:19], v[160:167], v112
s_nop 2
s_cmp_eq_u32 s17, 63
v_cvt_pk_bf16_f32 v114, v84, v85
v_cvt_pk_bf16_f32 v115, v86, v87
buffer_store_dwordx2 v[114:115], v117, s[4:7], s21 offen sc1
s_cbranch_scc1 main_kernel_c5_last
ds_write_b64 v117, v[114:115] offset:16896
v_smfmac_f32_16x16x64_f16 v[88:91], v[20:23], v[168:175], v112
v_smfmac_f32_16x16x64_f16 v[88:91], v[24:27], v[176:183], v112
v_smfmac_f32_16x16x64_f16 v[88:91], v[28:31], v[184:191], v112
v_smfmac_f32_16x16x64_f16 v[88:91], v[32:35], v[192:199], v112
s_waitcnt lgkmcnt(0)
s_barrier
ds_read_b128 v[0:3], v116 offset:16384
v_smfmac_f32_16x16x64_f16 v[88:91], v[36:39], v[200:207], v112
ds_read_b128 v[4:7], v116 offset:17408
v_smfmac_f32_16x16x64_f16 v[88:91], v[40:43], v[208:215], v112
ds_read_b128 v[16:19], v116 offset:26624
v_smfmac_f32_16x16x64_f16 v[88:91], v[44:47], v[216:223], v112
ds_read_b128 v[20:23], v116 offset:30720
v_smfmac_f32_16x16x64_f16 v[88:91], v[48:51], v[224:231], v112
ds_read_b128 v[24:27], v116 offset:27648
v_smfmac_f32_16x16x64_f16 v[88:91], v[52:55], v[232:239], v112
ds_read_b128 v[28:31], v116 offset:31744
v_smfmac_f32_16x16x64_f16 v[88:91], v[56:59], v[240:247], v112
v_smfmac_f32_16x16x64_f16 v[88:91], v[60:63], v[248:255], v112
s_waitcnt lgkmcnt(5)
v_mfma_f32_16x16x32_bf16 v[80:83], v[64:67], v[0:3], 0
v_mfma_f32_16x16x32_bf16 v[84:87], v[68:71], v[0:3], 0
buffer_load_dwordx4 v[8:11], v116, s[4:7], s20 offen offset:0 sc1
v_mfma_f32_16x16x32_bf16 v[92:95], v[0:3], v[0:3], 0
buffer_load_dwordx4 v[12:15], v116, s[4:7], s20 offen offset:1024 sc1
v_permlane32_swap_b32 v88, v90
s_waitcnt lgkmcnt(4)
v_mfma_f32_16x16x32_bf16 v[80:83], v[72:75], v[4:7], v[80:83]
v_permlane32_swap_b32 v89, v91
v_mfma_f32_16x16x32_bf16 v[84:87], v[76:79], v[4:7], v[84:87]
v_pk_add_f32 v[88:89], v[88:89], v[90:91]
v_mfma_f32_16x16x32_bf16 v[92:95], v[4:7], v[4:7], v[92:95]
v_cvt_pk_bf16_f32 v124, v88, v89
v_mov_b32 v65, 0
s_waitcnt lgkmcnt(0)
s_waitcnt vmcnt(1)
v_mfma_f32_16x16x32_bf16 v[88:91], v[8:11], v[8:11], v[92:95]
v_mfma_f32_16x16x32_bf16 v[0:3], v[16:19], v[8:11], v[80:83]
v_cmp_u_f32 s[0:1], v8, v10
v_mfma_f32_16x16x32_bf16 v[4:7], v[20:23], v[8:11], v[84:87]
s_waitcnt vmcnt(0)
v_mfma_f32_16x16x32_bf16 v[88:91], v[12:15], v[12:15], v[88:91]
v_mfma_f32_16x16x32_bf16 v[0:3], v[24:27], v[12:15], v[0:3]
v_cmp_u_f32 s[32:33], v12, v14
v_mfma_f32_16x16x32_bf16 v[4:7], v[28:31], v[12:15], v[4:7]
s_or_b64 s[0:1], s[0:1], s[32:33]
s_cbranch_scc1 main_kernel_c5_z_f
main_kernel_c5_z:
v_mul_f32 v88, s30, v88
v_mul_f32 v89, s30, v89
v_exp_f32 v88, v88
v_exp_f32 v89, v89
v_cndmask_b32_dpp v0, v2, v0, vcc quad_perm:[2,3,2,3] row_mask:0xf bank_mask:0xf
v_cvt_pk_bf16_f32 v64, v88, v89
v_cndmask_b32_dpp v1, v3, v1, vcc quad_perm:[2,3,2,3] row_mask:0xf bank_mask:0xf
v_exp_f32 v0, v0
v_mfma_f32_16x16x16_bf16 v[16:19], v[100:101], v[64:65], 0
v_exp_f32 v1, v1
v_cndmask_b32_dpp v4, v6, v4, vcc quad_perm:[2,3,2,3] row_mask:0xf bank_mask:0xf
v_mfma_f32_16x16x16_bf16 v[8:11], v[124:125], v[64:65], 0
v_cndmask_b32_dpp v5, v7, v5, vcc quad_perm:[2,3,2,3] row_mask:0xf bank_mask:0xf
v_exp_f32 v4, v4
v_exp_f32 v5, v5
v_cvt_pk_bf16_f32 v92, v0, v1
v_cvt_pk_bf16_f32 v94, v4, v5
v_mov_b32 v80, 0
v_mov_b32_dpp v93, v92 quad_perm:[0,1,0,1] row_mask:0xf bank_mask:0xf
v_mov_b32_dpp v95, v94 quad_perm:[0,1,0,1] row_mask:0xf bank_mask:0xf
v_mov_b32 v81, 0
v_mov_b32 v82, 0
v_mfma_f32_16x16x32_bf16 v[16:19], v[100:103], v[92:95], v[16:19]
v_mov_b32 v83, 0
v_mov_b32 v84, 0
v_mfma_f32_16x16x32_bf16 v[8:11], v[96:99], v[92:95], v[8:11]
s_nop 1
v_mov_b32 v85, 0
v_mov_b32 v86, 0
v_mov_b32 v87, 0
v_rcp_f32 v126, v16
v_subrev_u32 v127, 0x21800000, v16
v_cmp_lt_u32 vcc, 0x3c000000, v127
v_pk_mul_f32 v[8:9], v[8:9], v[126:127] op_sel_hi:[1,0]
v_pk_mul_f32 v[10:11], v[10:11], v[126:127] op_sel_hi:[1,0]
s_and_b32 s32, vcc_lo, 0xcccc
v_cvt_pk_bf16_f32 v126, v8, v9
v_cvt_pk_bf16_f32 v127, v10, v11
s_cbranch_scc1 main_kernel_c5_sm_f
main_kernel_c5_ost:
buffer_store_dwordx2 v[126:127], v118, s[4:7], s22 offen sc1
v_cmp_eq_u32 s[0:1], 0, v123
v_mov_b32 v24, -1
v_mov_b32 v25, -1
v_mov_b32 v26, -1
v_mov_b32 v27, -1
ds_read_b128 v[32:35], v113 offset:0
ds_read_b128 v[36:39], v113 offset:1024
ds_read_b128 v[40:43], v113 offset:2048
ds_read_b128 v[44:47], v113 offset:3072
ds_read_b128 v[48:51], v113 offset:4096
ds_read_b128 v[52:55], v113 offset:5120
s_and_b32 s10, s1, 0x3f00
buffer_store_dwordx4 v[24:27], v116, s[4:7], s3 offen sc1
buffer_store_dwordx4 v[24:27], v116, s[4:7], s46 offen sc1
s_barrier
buffer_load_dwordx4 v[0:3], v116, s[4:7], s23 offen sc1
ds_read_b128 v[56:59], v113 offset:6144
ds_read_b128 v[60:63], v113 offset:7168
s_add_u32 s46, s46, 0x40000
s_bitset0_b32 s46, 20
s_add_u32 s37, s37, 65536
s_add_u32 s26, s26, 65536
s_xor_b32 s32, s23, 1024
buffer_load_dwordx4 v[4:7], v116, s[4:7], s32 offen sc1
ds_read_b128 v[64:67], v113 offset:8192
ds_read_b128 v[68:71], v113 offset:9216
s_nop 3
s_xor_b32 s32, s23, 2048
buffer_load_dwordx4 v[8:11], v116, s[4:7], s32 offen sc1
ds_read_b128 v[72:75], v113 offset:10240
ds_read_b128 v[76:79], v113 offset:11264
s_nop 3
s_xor_b32 s32, s23, 3072
buffer_load_dwordx4 v[12:15], v116, s[4:7], s32 offen sc1
ds_read_b128 v[88:91], v113 offset:12288
ds_read_b128 v[92:95], v113 offset:13312
s_nop 3
s_xor_b32 s32, s23, 4096
buffer_load_dwordx4 v[16:19], v116, s[4:7], s32 offen sc1
s_nop 7
s_xor_b32 s32, s23, 5120
buffer_load_dwordx4 v[20:23], v116, s[4:7], s32 offen sc1
s_nop 7
s_xor_b32 s32, s23, 6144
buffer_load_dwordx4 v[24:27], v116, s[4:7], s32 offen sc1
s_nop 7
s_xor_b32 s32, s23, 7168
buffer_load_dwordx4 v[28:31], v116, s[4:7], s32 offen sc1
s_waitcnt lgkmcnt(12)
s_waitcnt vmcnt(7)
v_cmp_u_f32 vcc, v0, v2
s_cbranch_vccnz main_kernel_c5_o0_f
main_kernel_c5_o0:
v_smfmac_f32_16x16x64_bf16 v[80:83], v[0:3], v[32:39], v112
ds_read_b128 v[32:35], v113 offset:14336
ds_read_b128 v[36:39], v113 offset:15360
s_waitcnt lgkmcnt(12)
s_waitcnt vmcnt(6)
v_cmp_u_f32 vcc, v4, v6
v_smfmac_f32_16x16x64_bf16 v[84:87], v[0:3], v[40:47], v112
ds_read_b128 v[40:43], v113 offset:16384
ds_read_b128 v[44:47], v113 offset:17408
buffer_store_dwordx2 v[114:115], v119, s[4:7], s37 offen sc1
s_cbranch_vccnz main_kernel_c5_o1_f
main_kernel_c5_o1:
s_waitcnt lgkmcnt(12)
v_smfmac_f32_16x16x64_bf16 v[80:83], v[4:7], v[48:55], v112
ds_read_b128 v[48:51], v113 offset:18432
ds_read_b128 v[52:55], v113 offset:19456
s_waitcnt lgkmcnt(12)
s_waitcnt vmcnt(6)
v_cmp_u_f32 vcc, v8, v10
v_smfmac_f32_16x16x64_bf16 v[84:87], v[4:7], v[56:63], v112
ds_read_b128 v[56:59], v113 offset:20480
ds_read_b128 v[60:63], v113 offset:21504
buffer_store_dword v124, v120, s[4:7], s26 offen sc1
s_cbranch_vccnz main_kernel_c5_o2_f
main_kernel_c5_o2:
s_waitcnt lgkmcnt(12)
v_smfmac_f32_16x16x64_bf16 v[80:83], v[8:11], v[64:71], v112
ds_read_b128 v[64:67], v113 offset:22528
ds_read_b128 v[68:71], v113 offset:23552
s_waitcnt lgkmcnt(12)
s_waitcnt vmcnt(6)
v_cmp_u_f32 vcc, v12, v14
v_smfmac_f32_16x16x64_bf16 v[84:87], v[8:11], v[72:79], v112
ds_read_b128 v[72:75], v113 offset:24576
ds_read_b128 v[76:79], v113 offset:25600
s_cbranch_vccnz main_kernel_c5_o3_f
main_kernel_c5_o3:
s_waitcnt lgkmcnt(12)
v_smfmac_f32_16x16x64_bf16 v[80:83], v[12:15], v[88:95], v112
ds_read_b128 v[88:91], v113 offset:26624
ds_read_b128 v[92:95], v113 offset:27648
s_waitcnt lgkmcnt(12)
s_waitcnt vmcnt(5)
v_cmp_u_f32 vcc, v16, v18
v_smfmac_f32_16x16x64_bf16 v[84:87], v[12:15], v[32:39], v112
ds_read_b128 v[32:35], v113 offset:28672
ds_read_b128 v[36:39], v113 offset:29696
s_cbranch_vccnz main_kernel_c5_o4_f
main_kernel_c5_o4:
s_waitcnt lgkmcnt(12)
v_smfmac_f32_16x16x64_bf16 v[80:83], v[16:19], v[40:47], v112
ds_read_b128 v[40:43], v113 offset:30720
ds_read_b128 v[44:47], v113 offset:31744
s_waitcnt lgkmcnt(12)
s_waitcnt vmcnt(4)
v_cmp_u_f32 vcc, v20, v22
v_smfmac_f32_16x16x64_bf16 v[84:87], v[16:19], v[48:55], v112
s_cbranch_vccnz main_kernel_c5_o5_f
main_kernel_c5_o5:
s_waitcnt lgkmcnt(10)
v_smfmac_f32_16x16x64_bf16 v[80:83], v[20:23], v[56:63], v112
s_waitcnt lgkmcnt(8)
s_waitcnt vmcnt(3)
v_cmp_u_f32 vcc, v24, v26
v_smfmac_f32_16x16x64_bf16 v[84:87], v[20:23], v[64:71], v112
s_cbranch_vccnz main_kernel_c5_o6_f
main_kernel_c5_o6:
s_waitcnt lgkmcnt(6)
v_smfmac_f32_16x16x64_bf16 v[80:83], v[24:27], v[72:79], v112
s_waitcnt lgkmcnt(4)
v_smfmac_f32_16x16x64_bf16 v[84:87], v[24:27], v[88:95], v112
s_waitcnt lgkmcnt(2)
s_waitcnt vmcnt(2)
v_cmp_u_f32 vcc, v28, v30
s_cbranch_vccnz main_kernel_c5_o7_f
main_kernel_c5_o7:
v_smfmac_f32_16x16x64_bf16 v[80:83], v[28:31], v[32:39], v112
s_waitcnt lgkmcnt(0)
v_smfmac_f32_16x16x64_bf16 v[84:87], v[28:31], v[40:47], v112
s_nop 4
v_cvt_pk_bf16_f32 v80, v80, v81
v_cvt_pk_bf16_f32 v81, v82, v83
ds_write_b64 v116, v[80:81] offset:20488
v_cvt_pk_bf16_f32 v82, v84, v85
v_cvt_pk_bf16_f32 v83, v86, v87
ds_write_b64 v116, v[82:83] offset:22536
s_waitcnt lgkmcnt(0)
s_barrier
ds_read_b128 v[72:75], v116 offset:22528
ds_read_b128 v[76:79], v116 offset:23552
s_mov_b32 m0, 26624
s_cmp_lg_u32 s10, 0
s_waitcnt lgkmcnt(1)
v_mfma_f32_16x16x32_bf16 v[64:67], v[72:75], v[108:111], 0
s_waitcnt lgkmcnt(0)
v_mfma_f32_16x16x32_bf16 v[64:67], v[76:79], v[108:111], v[64:67]
s_nop 7
v_cvt_pk_f16_f32 v68, v64, v65
v_cvt_pk_f16_f32 v69, v66, v67
buffer_store_dwordx2 v[68:69], v125, s[4:7], s25 offen sc1
s_cbranch_scc1 main_kernel_c5_kvw
main_kernel_c5_kvok:
s_nop 3
buffer_load_dwordx4 v116, s[4:7], s27 offen sc1 lds
buffer_load_dwordx4 v116, s[4:7], s27 offen offset:1024 sc1 lds
s_mov_b32 m0, 30720
s_xor_b32 s32, s27, 131072
buffer_load_dwordx4 v116, s[4:7], s32 offen offset:0 sc1 lds
s_add_u32 s27, s27, 0x40000
s_branch main_kernel_c5_top
main_kernel_c5_kvw:
s_mov_b32 exec_lo, 0
s_mov_b32 exec_hi, 0x3f00
v_subrev_u32 v127, 128, v121
main_kernel_c5_kvp:
buffer_load_dword v126, v127, s[4:7], 0 offen sc1
s_waitcnt vmcnt(0)
v_cmp_eq_u32 vcc, 0, v126
s_cbranch_vccz main_kernel_c5_kvp_ok
s_sleep 2
s_sub_u32 s29, s29, 1
s_cbranch_scc0 main_kernel_c5_kvp
s_branch main_kernel_end
main_kernel_c5_kvp_ok:
s_mov_b64 exec, -1
s_branch main_kernel_c5_kvok
main_kernel_c5_last:
s_add_u32 s37, s37, 65536
s_add_u32 s26, s26, 65536
buffer_store_dwordx2 v[114:115], v119, s[4:7], s37 offen sc1
v_smfmac_f32_16x16x64_f16 v[88:91], v[20:23], v[168:175], v112
v_smfmac_f32_16x16x64_f16 v[88:91], v[24:27], v[176:183], v112
v_smfmac_f32_16x16x64_f16 v[88:91], v[28:31], v[184:191], v112
v_smfmac_f32_16x16x64_f16 v[88:91], v[32:35], v[192:199], v112
v_smfmac_f32_16x16x64_f16 v[88:91], v[36:39], v[200:207], v112
v_smfmac_f32_16x16x64_f16 v[88:91], v[40:43], v[208:215], v112
v_smfmac_f32_16x16x64_f16 v[88:91], v[44:47], v[216:223], v112
v_smfmac_f32_16x16x64_f16 v[88:91], v[48:51], v[224:231], v112
v_smfmac_f32_16x16x64_f16 v[88:91], v[52:55], v[232:239], v112
v_smfmac_f32_16x16x64_f16 v[88:91], v[56:59], v[240:247], v112
v_smfmac_f32_16x16x64_f16 v[88:91], v[60:63], v[248:255], v112
s_nop 7
v_permlane32_swap_b32 v88, v90
s_nop 1
v_permlane32_swap_b32 v89, v91
s_nop 1
v_pk_add_f32 v[88:89], v[88:89], v[90:91]
s_nop 1
v_cvt_pk_bf16_f32 v124, v88, v89
s_nop 1
buffer_store_dword v124, v120, s[4:7], s26 offen sc1
s_branch main_kernel_end
main_kernel_c5_m0_f:
s_waitcnt lgkmcnt(0)
buffer_load_dwordx4 v[0:3], v116, s[4:7], s18 offen sc1
buffer_load_dwordx4 v[64:67], v116, s[4:7], s19 offen sc1
s_xor_b32 s32, s18, 1024
buffer_load_dwordx4 v[16:19], v116, s[4:7], s32 offen sc1
s_xor_b32 s32, s19, 1024
buffer_load_dwordx4 v[68:71], v116, s[4:7], s32 offen sc1
s_xor_b32 s32, s18, 2048
buffer_load_dwordx4 v[32:35], v116, s[4:7], s32 offen sc1
s_xor_b32 s32, s19, 2048
buffer_load_dwordx4 v[72:75], v116, s[4:7], s32 offen sc1
s_xor_b32 s32, s18, 3072
buffer_load_dwordx4 v[48:51], v116, s[4:7], s32 offen sc1
s_xor_b32 s32, s19, 3072
buffer_load_dwordx4 v[76:79], v116, s[4:7], s32 offen sc1
s_sub_u32 s29, s29, 1
s_cbranch_scc1 main_kernel_end
s_waitcnt vmcnt(0)
v_max_u32 v126, v0, v2
v_max3_u32 v126, v126, v64, v66
v_cmp_eq_u32 vcc, -1, v126
s_cbranch_vccnz main_kernel_c5_m0_f
v_pk_add_f16 v0, v0, v64
v_pk_add_f16 v1, v1, v65
v_pk_add_f16 v2, v2, v66
v_pk_add_f16 v3, v3, v67
s_nop 0
s_branch main_kernel_c5_m0
main_kernel_c5_m1_f:
s_waitcnt lgkmcnt(0)
s_xor_b32 s32, s18, 1024
buffer_load_dwordx4 v[16:19], v116, s[4:7], s32 offen sc1
s_xor_b32 s32, s19, 1024
buffer_load_dwordx4 v[68:71], v116, s[4:7], s32 offen sc1
s_xor_b32 s32, s18, 2048
buffer_load_dwordx4 v[32:35], v116, s[4:7], s32 offen sc1
s_xor_b32 s32, s19, 2048
buffer_load_dwordx4 v[72:75], v116, s[4:7], s32 offen sc1
s_xor_b32 s32, s18, 3072
buffer_load_dwordx4 v[48:51], v116, s[4:7], s32 offen sc1
s_xor_b32 s32, s19, 3072
buffer_load_dwordx4 v[76:79], v116, s[4:7], s32 offen sc1
s_sub_u32 s29, s29, 1
s_cbranch_scc1 main_kernel_end
s_waitcnt vmcnt(0)
v_max_u32 v126, v16, v18
v_max3_u32 v126, v126, v68, v70
v_cmp_eq_u32 vcc, -1, v126
s_cbranch_vccnz main_kernel_c5_m1_f
v_pk_add_f16 v16, v16, v68
v_pk_add_f16 v17, v17, v69
v_pk_add_f16 v18, v18, v70
v_pk_add_f16 v19, v19, v71
ds_write_b128 v116, v[16:19] offset:5120
s_branch main_kernel_c5_m1
main_kernel_c5_m2_f:
s_waitcnt lgkmcnt(0)
s_xor_b32 s32, s18, 2048
buffer_load_dwordx4 v[32:35], v116, s[4:7], s32 offen sc1
s_xor_b32 s32, s19, 2048
buffer_load_dwordx4 v[72:75], v116, s[4:7], s32 offen sc1
s_xor_b32 s32, s18, 3072
buffer_load_dwordx4 v[48:51], v116, s[4:7], s32 offen sc1
s_xor_b32 s32, s19, 3072
buffer_load_dwordx4 v[76:79], v116, s[4:7], s32 offen sc1
s_sub_u32 s29, s29, 1
s_cbranch_scc1 main_kernel_end
s_waitcnt vmcnt(0)
v_max_u32 v126, v32, v34
v_max3_u32 v126, v126, v72, v74
v_cmp_eq_u32 vcc, -1, v126
s_cbranch_vccnz main_kernel_c5_m2_f
v_pk_add_f16 v32, v32, v72
v_pk_add_f16 v33, v33, v73
v_pk_add_f16 v34, v34, v74
v_pk_add_f16 v35, v35, v75
ds_write_b128 v116, v[32:35] offset:9216
s_branch main_kernel_c5_m2
main_kernel_c5_m3_f:
s_waitcnt lgkmcnt(0)
s_xor_b32 s32, s18, 3072
buffer_load_dwordx4 v[48:51], v116, s[4:7], s32 offen sc1
s_xor_b32 s32, s19, 3072
buffer_load_dwordx4 v[76:79], v116, s[4:7], s32 offen sc1
s_sub_u32 s29, s29, 1
s_cbranch_scc1 main_kernel_end
s_waitcnt vmcnt(0)
v_max_u32 v126, v48, v50
v_max3_u32 v126, v126, v76, v78
v_cmp_eq_u32 vcc, -1, v126
s_cbranch_vccnz main_kernel_c5_m3_f
v_pk_add_f16 v48, v48, v76
v_pk_add_f16 v49, v49, v77
v_pk_add_f16 v50, v50, v78
v_pk_add_f16 v51, v51, v79
ds_write_b128 v116, v[48:51] offset:13312
s_branch main_kernel_c5_m3
main_kernel_c5_z_f:
buffer_load_dwordx4 v[8:11], v116, s[4:7], s20 offen offset:0 sc1
buffer_load_dwordx4 v[12:15], v116, s[4:7], s20 offen offset:1024 sc1
s_memtime s[32:33]
ds_read_b32 v126, v116 offset:18432
s_sub_u32 s34, s19, s54
s_xor_b32 s34, s34, 0x2000
s_lshl_b32 s35, s12, 15
s_add_u32 s34, s34, s35
s_lshl_b32 s35, s13, 8
s_add_u32 s35, s35, s34
s_add_u32 s34, s34, 0x4000
s_waitcnt lgkmcnt(0)
s_sub_u32 s32, s32, 450
v_sub_u32 v127, s32, v126
buffer_store_dword v127, off, s[4:7], s34 sc1
s_sub_u32 s29, s29, 1
s_cbranch_scc1 main_kernel_end
s_waitcnt vmcnt(1)
main_kernel_c5_z_g:
v_max_u32 v126, v8, v10
v_max3_u32 v126, v126, v12, v14
v_cmp_eq_u32 vcc, -1, v126
s_cbranch_vccnz main_kernel_c5_z_h
v_mfma_f32_16x16x32_bf16 v[88:91], v[8:11], v[8:11], v[92:95]
v_mfma_f32_16x16x32_bf16 v[0:3], v[16:19], v[8:11], v[80:83]
v_mfma_f32_16x16x32_bf16 v[4:7], v[20:23], v[8:11], v[84:87]
v_mfma_f32_16x16x32_bf16 v[88:91], v[12:15], v[12:15], v[88:91]
v_mfma_f32_16x16x32_bf16 v[0:3], v[24:27], v[12:15], v[0:3]
v_mfma_f32_16x16x32_bf16 v[4:7], v[28:31], v[12:15], v[4:7]
buffer_store_dword v127, off, s[4:7], s35 offset:132 sc1
s_mov_b32 vcc_lo, 0xcccccccc
s_mov_b32 vcc_hi, 0xcccccccc
s_branch main_kernel_c5_z
main_kernel_c5_z_h:
buffer_load_dwordx4 v[8:11], v116, s[4:7], s20 offen offset:0 sc1
buffer_load_dwordx4 v[12:15], v116, s[4:7], s20 offen offset:1024 sc1
s_sub_u32 s29, s29, 1
s_cbranch_scc1 main_kernel_end
v_add_u32 v127, 300, v127
s_waitcnt vmcnt(0)
s_branch main_kernel_c5_z_g
main_kernel_c5_sm_f:
s_waitcnt vmcnt(0) lgkmcnt(0)
buffer_load_dwordx4 v[8:11], v116, s[4:7], s20 offen offset:0 sc1
buffer_load_dwordx4 v[12:15], v116, s[4:7], s20 offen offset:1024 sc1
ds_read_b128 v[0:3], v116 offset:16384
ds_read_b128 v[4:7], v116 offset:17408
ds_read_b128 v[64:67], v116 offset:24576
ds_read_b128 v[68:71], v116 offset:28672
ds_read_b128 v[72:75], v116 offset:25600
ds_read_b128 v[76:79], v116 offset:29696
ds_read_b128 v[16:19], v116 offset:26624
ds_read_b128 v[20:23], v116 offset:30720
ds_read_b128 v[24:27], v116 offset:27648
ds_read_b128 v[28:31], v116 offset:31744
s_waitcnt vmcnt(0)
s_waitcnt lgkmcnt(0)
v_mfma_f32_16x16x32_bf16 v[80:83], v[64:67], v[0:3], 0
v_mfma_f32_16x16x32_bf16 v[84:87], v[68:71], v[0:3], 0
v_mfma_f32_16x16x32_bf16 v[92:95], v[0:3], v[0:3], 0
v_mfma_f32_16x16x32_bf16 v[80:83], v[72:75], v[4:7], v[80:83]
v_mfma_f32_16x16x32_bf16 v[84:87], v[76:79], v[4:7], v[84:87]
v_mfma_f32_16x16x32_bf16 v[92:95], v[4:7], v[4:7], v[92:95]
v_mfma_f32_16x16x32_bf16 v[0:3], v[16:19], v[8:11], v[80:83]
v_mfma_f32_16x16x32_bf16 v[4:7], v[20:23], v[8:11], v[84:87]
v_mfma_f32_16x16x32_bf16 v[88:91], v[8:11], v[8:11], v[92:95]
v_mfma_f32_16x16x32_bf16 v[0:3], v[24:27], v[12:15], v[0:3]
v_mfma_f32_16x16x32_bf16 v[4:7], v[28:31], v[12:15], v[4:7]
v_mfma_f32_16x16x32_bf16 v[88:91], v[12:15], v[12:15], v[88:91]
s_nop 7
v_mov_b32 v65, 0
v_max_f32 v126, v88, v89
v_mul_f32 v126, s30, v126
v_max3_f32 v126, v126, v0, v1
v_max3_f32 v126, v126, v2, v3
v_max3_f32 v126, v126, v4, v5
v_max3_f32 v126, v126, v6, v7
v_mov_b32 v127, v126
s_nop 1
v_permlane32_swap_b32 v126, v127
v_max_f32 v126, v126, v127
v_mov_b32 v127, v126
s_nop 1
v_permlane16_swap_b32 v126, v127
v_max_f32 v126, v126, v127
v_mul_f32 v127, 0x40faf233, v126
s_mov_b32 vcc_lo, 0xcccccccc
s_mov_b32 vcc_hi, 0xcccccccc
v_sub_f32 v0, v0, v126
v_sub_f32 v1, v1, v126
v_sub_f32 v2, v2, v126
v_sub_f32 v3, v3, v126
v_sub_f32 v4, v4, v126
v_sub_f32 v5, v5, v126
v_sub_f32 v6, v6, v126
v_sub_f32 v7, v7, v126
v_sub_f32 v88, v88, v127
v_sub_f32 v89, v89, v127
s_waitcnt lgkmcnt(0)
s_nop 0
v_mul_f32 v88, s30, v88
v_mul_f32 v89, s30, v89
v_exp_f32 v88, v88
v_exp_f32 v89, v89
v_cndmask_b32_dpp v0, v2, v0, vcc quad_perm:[2,3,2,3] row_mask:0xf bank_mask:0xf
v_cvt_pk_bf16_f32 v64, v88, v89
v_cndmask_b32_dpp v1, v3, v1, vcc quad_perm:[2,3,2,3] row_mask:0xf bank_mask:0xf
v_exp_f32 v0, v0
v_mfma_f32_16x16x16_bf16 v[16:19], v[100:101], v[64:65], 0
v_exp_f32 v1, v1
v_cndmask_b32_dpp v4, v6, v4, vcc quad_perm:[2,3,2,3] row_mask:0xf bank_mask:0xf
v_mfma_f32_16x16x16_bf16 v[8:11], v[124:125], v[64:65], 0
v_cndmask_b32_dpp v5, v7, v5, vcc quad_perm:[2,3,2,3] row_mask:0xf bank_mask:0xf
v_exp_f32 v4, v4
v_exp_f32 v5, v5
v_cvt_pk_bf16_f32 v92, v0, v1
v_cvt_pk_bf16_f32 v94, v4, v5
v_mov_b32 v80, 0
v_mov_b32_dpp v93, v92 quad_perm:[0,1,0,1] row_mask:0xf bank_mask:0xf
v_mov_b32_dpp v95, v94 quad_perm:[0,1,0,1] row_mask:0xf bank_mask:0xf
v_mov_b32 v81, 0
v_mov_b32 v82, 0
v_mfma_f32_16x16x32_bf16 v[16:19], v[100:103], v[92:95], v[16:19]
v_mov_b32 v83, 0
v_mov_b32 v84, 0
v_mfma_f32_16x16x32_bf16 v[8:11], v[96:99], v[92:95], v[8:11]
s_nop 1
v_mov_b32 v85, 0
v_mov_b32 v86, 0
v_mov_b32 v87, 0
v_rcp_f32 v126, v16
v_subrev_u32 v127, 0x21800000, v16
v_cmp_lt_u32 vcc, 0x3c000000, v127
v_pk_mul_f32 v[8:9], v[8:9], v[126:127] op_sel_hi:[1,0]
v_pk_mul_f32 v[10:11], v[10:11], v[126:127] op_sel_hi:[1,0]
s_and_b32 s32, vcc_lo, 0xcccc
v_cvt_pk_bf16_f32 v126, v8, v9
v_cvt_pk_bf16_f32 v127, v10, v11
s_branch main_kernel_c5_ost
main_kernel_c5_o0_f:
s_nop 0
buffer_load_dwordx4 v[0:3], v116, s[4:7], s23 offen sc1
s_xor_b32 s32, s23, 1024
buffer_load_dwordx4 v[4:7], v116, s[4:7], s32 offen sc1
s_sub_u32 s29, s29, 1
s_cbranch_scc1 main_kernel_end
s_waitcnt vmcnt(0)
v_max_u32 v126, v0, v2
v_cmp_eq_u32 vcc, -1, v126
s_cbranch_vccnz main_kernel_c5_o0_f
s_branch main_kernel_c5_o0
main_kernel_c5_o1_f:
s_nop 0
s_xor_b32 s32, s23, 1024
buffer_load_dwordx4 v[4:7], v116, s[4:7], s32 offen sc1
s_xor_b32 s32, s23, 2048
buffer_load_dwordx4 v[8:11], v116, s[4:7], s32 offen sc1
s_sub_u32 s29, s29, 1
s_cbranch_scc1 main_kernel_end
s_waitcnt vmcnt(0)
v_max_u32 v126, v4, v6
v_cmp_eq_u32 vcc, -1, v126
s_cbranch_vccnz main_kernel_c5_o1_f
s_branch main_kernel_c5_o1
main_kernel_c5_o2_f:
s_nop 0
s_xor_b32 s32, s23, 2048
buffer_load_dwordx4 v[8:11], v116, s[4:7], s32 offen sc1
s_xor_b32 s32, s23, 3072
buffer_load_dwordx4 v[12:15], v116, s[4:7], s32 offen sc1
s_sub_u32 s29, s29, 1
s_cbranch_scc1 main_kernel_end
s_waitcnt vmcnt(0)
v_max_u32 v126, v8, v10
v_cmp_eq_u32 vcc, -1, v126
s_cbranch_vccnz main_kernel_c5_o2_f
s_branch main_kernel_c5_o2
main_kernel_c5_o3_f:
s_nop 0
s_xor_b32 s32, s23, 3072
buffer_load_dwordx4 v[12:15], v116, s[4:7], s32 offen sc1
s_xor_b32 s32, s23, 4096
buffer_load_dwordx4 v[16:19], v116, s[4:7], s32 offen sc1
s_sub_u32 s29, s29, 1
s_cbranch_scc1 main_kernel_end
s_waitcnt vmcnt(0)
v_max_u32 v126, v12, v14
v_cmp_eq_u32 vcc, -1, v126
s_cbranch_vccnz main_kernel_c5_o3_f
s_branch main_kernel_c5_o3
main_kernel_c5_o4_f:
s_nop 0
s_xor_b32 s32, s23, 4096
buffer_load_dwordx4 v[16:19], v116, s[4:7], s32 offen sc1
s_xor_b32 s32, s23, 5120
buffer_load_dwordx4 v[20:23], v116, s[4:7], s32 offen sc1
s_sub_u32 s29, s29, 1
s_cbranch_scc1 main_kernel_end
s_waitcnt vmcnt(0)
v_max_u32 v126, v16, v18
v_cmp_eq_u32 vcc, -1, v126
s_cbranch_vccnz main_kernel_c5_o4_f
s_branch main_kernel_c5_o4
main_kernel_c5_o5_f:
s_nop 0
s_xor_b32 s32, s23, 5120
buffer_load_dwordx4 v[20:23], v116, s[4:7], s32 offen sc1
s_xor_b32 s32, s23, 6144
buffer_load_dwordx4 v[24:27], v116, s[4:7], s32 offen sc1
s_sub_u32 s29, s29, 1
s_cbranch_scc1 main_kernel_end
s_waitcnt vmcnt(0)
v_max_u32 v126, v20, v22
v_cmp_eq_u32 vcc, -1, v126
s_cbranch_vccnz main_kernel_c5_o5_f
s_branch main_kernel_c5_o5
main_kernel_c5_o6_f:
s_nop 0
s_xor_b32 s32, s23, 6144
buffer_load_dwordx4 v[24:27], v116, s[4:7], s32 offen sc1
s_xor_b32 s32, s23, 7168
buffer_load_dwordx4 v[28:31], v116, s[4:7], s32 offen sc1
s_sub_u32 s29, s29, 1
s_cbranch_scc1 main_kernel_end
s_waitcnt vmcnt(0)
v_max_u32 v126, v24, v26
v_cmp_eq_u32 vcc, -1, v126
s_cbranch_vccnz main_kernel_c5_o6_f
s_branch main_kernel_c5_o6
main_kernel_c5_o7_f:
s_nop 0
s_xor_b32 s32, s23, 7168
buffer_load_dwordx4 v[28:31], v116, s[4:7], s32 offen sc1
s_sub_u32 s29, s29, 1
s_cbranch_scc1 main_kernel_end
s_waitcnt vmcnt(0)
v_max_u32 v126, v28, v30
v_cmp_eq_u32 vcc, -1, v126
s_cbranch_vccnz main_kernel_c5_o7_f
s_branch main_kernel_c5_o7
.p2align 6
main_kernel_c6_top:
s_barrier
buffer_load_dwordx4 v[0:3], v116, s[4:7], s18 offen sc1
s_add_u32 s20, s20, 0x40000
s_bitset0_b32 s20, 20
s_add_u32 s21, s21, 0x40000
s_bitset0_b32 s21, 20
s_add_u32 s22, s22, 0x40000
s_bitset0_b32 s22, 20
s_add_u32 s23, s23, 0x40000
s_bitset0_b32 s23, 20
s_xor_b32 s32, s18, 1024
buffer_load_dwordx4 v[16:19], v116, s[4:7], s32 offen sc1
s_add_u32 s3, s3, 0x40000
s_bitset0_b32 s3, 20
s_add_u32 s17, s17, 1
s_bitcmp1_b32 0x77777777, s17
s_cselect_b32 s33, 0x800, 0
s_xor_b32 s54, s54, s33
s_add_u32 s25, s25, 0x40000
s_bitset0_b32 s25, 20
s_nop 0
buffer_load_dwordx4 v[64:67], v116, s[4:7], s19 offen sc1
v_mov_b32 v80, 0
v_mov_b32 v81, 0
s_nop 3
s_xor_b32 s32, s19, 1024
buffer_load_dwordx4 v[68:71], v116, s[4:7], s32 offen sc1
v_mov_b32 v82, 0
v_mov_b32 v83, 0
s_nop 3
s_xor_b32 s32, s18, 2048
buffer_load_dwordx4 v[32:35], v116, s[4:7], s32 offen sc1
v_mov_b32 v84, 0
v_mov_b32 v85, 0
s_nop 3
s_xor_b32 s32, s19, 2048
buffer_load_dwordx4 v[72:75], v116, s[4:7], s32 offen sc1
v_mov_b32 v86, 0
v_mov_b32 v87, 0
s_nop 3
s_xor_b32 s32, s18, 3072
buffer_load_dwordx4 v[48:51], v116, s[4:7], s32 offen sc1
v_mov_b32 v88, 0
v_mov_b32 v89, 0
s_nop 3
s_xor_b32 s32, s19, 3072
buffer_load_dwordx4 v[76:79], v116, s[4:7], s32 offen sc1
v_mov_b32 v90, 0
v_mov_b32 v91, 0
s_waitcnt vmcnt(5)
v_pk_add_f16 v0, v0, v64
v_pk_add_f16 v1, v1, v65
v_pk_add_f16 v2, v2, v66
v_pk_add_f16 v3, v3, v67
v_cmp_u_f16 vcc, v0, v2
s_cbranch_vccnz main_kernel_c6_m0_f
main_kernel_c6_m0:
v_smfmac_f32_16x16x64_f16 v[80:83], v[0:3], a[0:7], v112
ds_write_b128 v116, v[0:3] offset:2048
v_smfmac_f32_16x16x64_f16 v[84:87], v[0:3], a[128:135], v112
buffer_load_dword v123, v121, s[4:7], 0 offen sc1
s_waitcnt vmcnt(5)
v_pk_add_f16 v16, v16, v68
v_pk_add_f16 v17, v17, v69
v_pk_add_f16 v18, v18, v70
v_pk_add_f16 v19, v19, v71
v_cmp_u_f16 vcc, v16, v18
s_waitcnt lgkmcnt(0)
s_barrier
ds_read_b128 v[4:7], v116 offset:3072
s_cbranch_vccnz main_kernel_c6_m1_f
main_kernel_c6_m1:
v_smfmac_f32_16x16x64_f16 v[80:83], v[16:19], a[8:15], v112
ds_write_b128 v116, v[16:19] offset:6144
v_smfmac_f32_16x16x64_f16 v[84:87], v[16:19], a[136:143], v112
ds_read_b128 v[8:11], v116 offset:0
v_smfmac_f32_16x16x64_f16 v[88:91], v[0:3], v[128:135], v112
ds_read_b128 v[12:15], v116 offset:1024
s_waitcnt lgkmcnt(3)
v_smfmac_f32_16x16x64_f16 v[80:83], v[4:7], a[32:39], v112
v_smfmac_f32_16x16x64_f16 v[84:87], v[4:7], a[160:167], v112
v_smfmac_f32_16x16x64_f16 v[88:91], v[4:7], v[136:143], v112
s_waitcnt lgkmcnt(2)
s_barrier
s_waitcnt lgkmcnt(1)
v_smfmac_f32_16x16x64_f16 v[80:83], v[8:11], a[64:71], v112
s_waitcnt vmcnt(3)
ds_read_b128 v[20:23], v116 offset:7168
v_pk_add_f16 v32, v32, v72
v_smfmac_f32_16x16x64_f16 v[84:87], v[8:11], a[192:199], v112
ds_read_b128 v[24:27], v116 offset:4096
s_waitcnt lgkmcnt(2)
v_pk_add_f16 v33, v33, v73
v_smfmac_f32_16x16x64_f16 v[80:83], v[12:15], a[96:103], v112
ds_read_b128 v[28:31], v116 offset:5120
v_pk_add_f16 v34, v34, v74
v_smfmac_f32_16x16x64_f16 v[84:87], v[12:15], a[224:231], v112
s_waitcnt lgkmcnt(2)
v_pk_add_f16 v35, v35, v75
v_smfmac_f32_16x16x64_f16 v[80:83], v[20:23], a[40:47], v112
v_cmp_u_f16 vcc, v32, v34
v_smfmac_f32_16x16x64_f16 v[84:87], v[20:23], a[168:175], v112
ds_write_b128 v116, v[32:35] offset:10240
s_cbranch_vccnz main_kernel_c6_m2_f
main_kernel_c6_m2:
v_smfmac_f32_16x16x64_f16 v[80:83], v[32:35], a[16:23], v112
buffer_load_dwordx4 v[96:99], v116, s[4:7], s28 offen sc1
v_smfmac_f32_16x16x64_f16 v[84:87], v[32:35], a[144:151], v112
s_add_u32 s28, s28, 0x40000
s_waitcnt lgkmcnt(2)
v_smfmac_f32_16x16x64_f16 v[80:83], v[24:27], a[72:79], v112
s_waitcnt vmcnt(2)
v_pk_add_f16 v48, v48, v76
v_smfmac_f32_16x16x64_f16 v[84:87], v[24:27], a[200:207], v112
s_waitcnt lgkmcnt(0)
s_barrier
ds_read_b128 v[36:39], v116 offset:11264
v_pk_add_f16 v49, v49, v77
v_smfmac_f32_16x16x64_f16 v[80:83], v[28:31], a[104:111], v112
ds_read_b128 v[40:43], v116 offset:8192
v_pk_add_f16 v50, v50, v78
v_smfmac_f32_16x16x64_f16 v[84:87], v[28:31], a[232:239], v112
ds_read_b128 v[44:47], v116 offset:9216
v_pk_add_f16 v51, v51, v79
v_smfmac_f32_16x16x64_f16 v[88:91], v[8:11], v[144:151], v112
s_waitcnt lgkmcnt(2)
v_cmp_u_f16 vcc, v48, v50
v_smfmac_f32_16x16x64_f16 v[80:83], v[36:39], a[48:55], v112
ds_write_b128 v116, v[48:51] offset:14336
s_cbranch_vccnz main_kernel_c6_m3_f
main_kernel_c6_m3:
v_smfmac_f32_16x16x64_f16 v[80:83], v[48:51], a[24:31], v112
v_smfmac_f32_16x16x64_f16 v[84:87], v[48:51], a[152:159], v112
v_smfmac_f32_16x16x64_f16 v[84:87], v[36:39], a[176:183], v112
s_waitcnt lgkmcnt(2)
v_smfmac_f32_16x16x64_f16 v[80:83], v[40:43], a[80:87], v112
s_waitcnt lgkmcnt(0)
s_barrier
ds_read_b128 v[52:55], v116 offset:15360
v_smfmac_f32_16x16x64_f16 v[84:87], v[40:43], a[208:215], v112
s_add_u32 s19, s52, s54
ds_read_b128 v[56:59], v116 offset:12288
v_smfmac_f32_16x16x64_f16 v[80:83], v[44:47], a[112:119], v112
s_add_u32 s18, s18, 0x40000
ds_read_b128 v[60:63], v116 offset:13312
v_smfmac_f32_16x16x64_f16 v[84:87], v[44:47], a[240:247], v112
s_bitset0_b32 s18, 20
s_waitcnt lgkmcnt(2)
v_smfmac_f32_16x16x64_f16 v[80:83], v[52:55], a[56:63], v112
s_cmp_eq_u32 s17, 30
s_cselect_b32 s32, s53, 0x10000
s_waitcnt lgkmcnt(1)
v_smfmac_f32_16x16x64_f16 v[80:83], v[56:59], a[88:95], v112
s_add_u32 s52, s52, s32
s_waitcnt lgkmcnt(0)
v_smfmac_f32_16x16x64_f16 v[80:83], v[60:63], a[120:127], v112
s_sub_u32 s24, 0x20000, s32
ds_read_b128 v[64:67], v116 offset:24576
v_smfmac_f32_16x16x64_f16 v[84:87], v[52:55], a[184:191], v112
s_add_u32 s55, s55, s24
ds_read_b128 v[68:71], v116 offset:28672
v_smfmac_f32_16x16x64_f16 v[84:87], v[56:59], a[216:223], v112
ds_read_b128 v[72:75], v116 offset:25600
s_nop 0
v_cvt_pk_bf16_f32 v92, v80, v81
v_smfmac_f32_16x16x64_f16 v[84:87], v[60:63], a[248:255], v112
ds_read_b128 v[76:79], v116 offset:29696
s_nop 0
v_cvt_pk_bf16_f32 v93, v82, v83
v_smfmac_f32_16x16x64_f16 v[88:91], v[12:15], v[152:159], v112
s_nop 3
v_cvt_pk_bf16_f32 v94, v84, v85
v_cvt_pk_bf16_f32 v95, v86, v87
s_mov_b32 vcc_lo, 0xcccccccc
s_mov_b32 vcc_hi, 0xcccccccc
v_mfma_f32_16x16x32_bf16 v[84:87], v[92:95], v[104:107], 0
v_add_u32 v121, v121, v122
v_writelane_b32 v121, s55, 39
s_nop 0
v_smfmac_f32_16x16x64_f16 v[88:91], v[16:19], v[160:167], v112
s_nop 2
s_cmp_eq_u32 s17, 63
v_cvt_pk_bf16_f32 v114, v84, v85
v_cvt_pk_bf16_f32 v115, v86, v87
buffer_store_dwordx2 v[114:115], v117, s[4:7], s21 offen sc1
s_cbranch_scc1 main_kernel_c6_last
ds_write_b64 v117, v[114:115] offset:17408
v_smfmac_f32_16x16x64_f16 v[88:91], v[20:23], v[168:175], v112
v_smfmac_f32_16x16x64_f16 v[88:91], v[24:27], v[176:183], v112
v_smfmac_f32_16x16x64_f16 v[88:91], v[28:31], v[184:191], v112
v_smfmac_f32_16x16x64_f16 v[88:91], v[32:35], v[192:199], v112
s_waitcnt lgkmcnt(0)
s_barrier
ds_read_b128 v[0:3], v116 offset:16384
v_smfmac_f32_16x16x64_f16 v[88:91], v[36:39], v[200:207], v112
ds_read_b128 v[4:7], v116 offset:17408
v_smfmac_f32_16x16x64_f16 v[88:91], v[40:43], v[208:215], v112
ds_read_b128 v[16:19], v116 offset:26624
v_smfmac_f32_16x16x64_f16 v[88:91], v[44:47], v[216:223], v112
ds_read_b128 v[20:23], v116 offset:30720
v_smfmac_f32_16x16x64_f16 v[88:91], v[48:51], v[224:231], v112
ds_read_b128 v[24:27], v116 offset:27648
v_smfmac_f32_16x16x64_f16 v[88:91], v[52:55], v[232:239], v112
ds_read_b128 v[28:31], v116 offset:31744
v_smfmac_f32_16x16x64_f16 v[88:91], v[56:59], v[240:247], v112
v_smfmac_f32_16x16x64_f16 v[88:91], v[60:63], v[248:255], v112
s_waitcnt lgkmcnt(5)
v_mfma_f32_16x16x32_bf16 v[80:83], v[64:67], v[0:3], 0
v_mfma_f32_16x16x32_bf16 v[84:87], v[68:71], v[0:3], 0
buffer_load_dwordx4 v[8:11], v116, s[4:7], s20 offen offset:0 sc1
v_mfma_f32_16x16x32_bf16 v[92:95], v[0:3], v[0:3], 0
buffer_load_dwordx4 v[12:15], v116, s[4:7], s20 offen offset:1024 sc1
v_permlane32_swap_b32 v88, v90
s_waitcnt lgkmcnt(4)
v_mfma_f32_16x16x32_bf16 v[80:83], v[72:75], v[4:7], v[80:83]
v_permlane32_swap_b32 v89, v91
v_mfma_f32_16x16x32_bf16 v[84:87], v[76:79], v[4:7], v[84:87]
v_pk_add_f32 v[88:89], v[88:89], v[90:91]
v_mfma_f32_16x16x32_bf16 v[92:95], v[4:7], v[4:7], v[92:95]
v_cvt_pk_bf16_f32 v124, v88, v89
v_mov_b32 v65, 0
s_waitcnt lgkmcnt(0)
s_waitcnt vmcnt(1)
v_mfma_f32_16x16x32_bf16 v[88:91], v[8:11], v[8:11], v[92:95]
v_mfma_f32_16x16x32_bf16 v[0:3], v[16:19], v[8:11], v[80:83]
v_cmp_u_f32 s[0:1], v8, v10
v_mfma_f32_16x16x32_bf16 v[4:7], v[20:23], v[8:11], v[84:87]
s_waitcnt vmcnt(0)
v_mfma_f32_16x16x32_bf16 v[88:91], v[12:15], v[12:15], v[88:91]
v_mfma_f32_16x16x32_bf16 v[0:3], v[24:27], v[12:15], v[0:3]
v_cmp_u_f32 s[32:33], v12, v14
v_mfma_f32_16x16x32_bf16 v[4:7], v[28:31], v[12:15], v[4:7]
s_or_b64 s[0:1], s[0:1], s[32:33]
s_cbranch_scc1 main_kernel_c6_z_f
main_kernel_c6_z:
v_mul_f32 v88, s30, v88
v_mul_f32 v89, s30, v89
v_exp_f32 v88, v88
v_exp_f32 v89, v89
v_cndmask_b32_dpp v0, v2, v0, vcc quad_perm:[2,3,2,3] row_mask:0xf bank_mask:0xf
v_cvt_pk_bf16_f32 v64, v88, v89
v_cndmask_b32_dpp v1, v3, v1, vcc quad_perm:[2,3,2,3] row_mask:0xf bank_mask:0xf
v_exp_f32 v0, v0
v_mfma_f32_16x16x16_bf16 v[16:19], v[100:101], v[64:65], 0
v_exp_f32 v1, v1
v_cndmask_b32_dpp v4, v6, v4, vcc quad_perm:[2,3,2,3] row_mask:0xf bank_mask:0xf
v_mfma_f32_16x16x16_bf16 v[8:11], v[124:125], v[64:65], 0
v_cndmask_b32_dpp v5, v7, v5, vcc quad_perm:[2,3,2,3] row_mask:0xf bank_mask:0xf
v_exp_f32 v4, v4
v_exp_f32 v5, v5
v_cvt_pk_bf16_f32 v92, v0, v1
v_cvt_pk_bf16_f32 v94, v4, v5
v_mov_b32 v80, 0
v_mov_b32_dpp v93, v92 quad_perm:[0,1,0,1] row_mask:0xf bank_mask:0xf
v_mov_b32_dpp v95, v94 quad_perm:[0,1,0,1] row_mask:0xf bank_mask:0xf
v_mov_b32 v81, 0
v_mov_b32 v82, 0
v_mfma_f32_16x16x32_bf16 v[16:19], v[100:103], v[92:95], v[16:19]
v_mov_b32 v83, 0
v_mov_b32 v84, 0
v_mfma_f32_16x16x32_bf16 v[8:11], v[96:99], v[92:95], v[8:11]
s_nop 1
v_mov_b32 v85, 0
v_mov_b32 v86, 0
v_mov_b32 v87, 0
v_rcp_f32 v126, v16
v_subrev_u32 v127, 0x21800000, v16
v_cmp_lt_u32 vcc, 0x3c000000, v127
v_pk_mul_f32 v[8:9], v[8:9], v[126:127] op_sel_hi:[1,0]
v_pk_mul_f32 v[10:11], v[10:11], v[126:127] op_sel_hi:[1,0]
s_and_b32 s32, vcc_lo, 0xcccc
v_cvt_pk_bf16_f32 v126, v8, v9
v_cvt_pk_bf16_f32 v127, v10, v11
s_cbranch_scc1 main_kernel_c6_sm_f
main_kernel_c6_ost:
buffer_store_dwordx2 v[126:127], v118, s[4:7], s22 offen sc1
v_cmp_eq_u32 s[0:1], 0, v123
v_mov_b32 v24, -1
v_mov_b32 v25, -1
v_mov_b32 v26, -1
v_mov_b32 v27, -1
ds_read_b128 v[32:35], v113 offset:0
ds_read_b128 v[36:39], v113 offset:1024
ds_read_b128 v[40:43], v113 offset:2048
ds_read_b128 v[44:47], v113 offset:3072
ds_read_b128 v[48:51], v113 offset:4096
ds_read_b128 v[52:55], v113 offset:5120
s_and_b32 s10, s1, 0x3f00
buffer_store_dwordx4 v[24:27], v116, s[4:7], s3 offen sc1
s_barrier
buffer_load_dwordx4 v[0:3], v116, s[4:7], s23 offen sc1
ds_read_b128 v[56:59], v113 offset:6144
ds_read_b128 v[60:63], v113 offset:7168
s_add_u32 s37, s37, 65536
s_add_u32 s26, s26, 65536
s_nop 1
s_xor_b32 s32, s23, 1024
buffer_load_dwordx4 v[4:7], v116, s[4:7], s32 offen sc1
ds_read_b128 v[64:67], v113 offset:8192
ds_read_b128 v[68:71], v113 offset:9216
s_nop 3
s_xor_b32 s32, s23, 2048
buffer_load_dwordx4 v[8:11], v116, s[4:7], s32 offen sc1
ds_read_b128 v[72:75], v113 offset:10240
ds_read_b128 v[76:79], v113 offset:11264
s_nop 3
s_xor_b32 s32, s23, 3072
buffer_load_dwordx4 v[12:15], v116, s[4:7], s32 offen sc1
ds_read_b128 v[88:91], v113 offset:12288
ds_read_b128 v[92:95], v113 offset:13312
s_nop 3
s_xor_b32 s32, s23, 4096
buffer_load_dwordx4 v[16:19], v116, s[4:7], s32 offen sc1
s_nop 7
s_xor_b32 s32, s23, 5120
buffer_load_dwordx4 v[20:23], v116, s[4:7], s32 offen sc1
s_nop 7
s_xor_b32 s32, s23, 6144
buffer_load_dwordx4 v[24:27], v116, s[4:7], s32 offen sc1
s_nop 7
s_xor_b32 s32, s23, 7168
buffer_load_dwordx4 v[28:31], v116, s[4:7], s32 offen sc1
s_waitcnt lgkmcnt(12)
s_waitcnt vmcnt(7)
v_cmp_u_f32 vcc, v0, v2
s_cbranch_vccnz main_kernel_c6_o0_f
main_kernel_c6_o0:
v_smfmac_f32_16x16x64_bf16 v[80:83], v[0:3], v[32:39], v112
ds_read_b128 v[32:35], v113 offset:14336
ds_read_b128 v[36:39], v113 offset:15360
s_waitcnt lgkmcnt(12)
s_waitcnt vmcnt(6)
v_cmp_u_f32 vcc, v4, v6
v_smfmac_f32_16x16x64_bf16 v[84:87], v[0:3], v[40:47], v112
ds_read_b128 v[40:43], v113 offset:16384
ds_read_b128 v[44:47], v113 offset:17408
buffer_store_dwordx2 v[114:115], v119, s[4:7], s37 offen sc1
s_cbranch_vccnz main_kernel_c6_o1_f
main_kernel_c6_o1:
s_waitcnt lgkmcnt(12)
v_smfmac_f32_16x16x64_bf16 v[80:83], v[4:7], v[48:55], v112
ds_read_b128 v[48:51], v113 offset:18432
ds_read_b128 v[52:55], v113 offset:19456
s_waitcnt lgkmcnt(12)
s_waitcnt vmcnt(6)
v_cmp_u_f32 vcc, v8, v10
v_smfmac_f32_16x16x64_bf16 v[84:87], v[4:7], v[56:63], v112
ds_read_b128 v[56:59], v113 offset:20480
ds_read_b128 v[60:63], v113 offset:21504
buffer_store_dword v124, v120, s[4:7], s26 offen sc1
s_cbranch_vccnz main_kernel_c6_o2_f
main_kernel_c6_o2:
s_waitcnt lgkmcnt(12)
v_smfmac_f32_16x16x64_bf16 v[80:83], v[8:11], v[64:71], v112
ds_read_b128 v[64:67], v113 offset:22528
ds_read_b128 v[68:71], v113 offset:23552
s_waitcnt lgkmcnt(12)
s_waitcnt vmcnt(6)
v_cmp_u_f32 vcc, v12, v14
v_smfmac_f32_16x16x64_bf16 v[84:87], v[8:11], v[72:79], v112
ds_read_b128 v[72:75], v113 offset:24576
ds_read_b128 v[76:79], v113 offset:25600
s_cbranch_vccnz main_kernel_c6_o3_f
main_kernel_c6_o3:
s_waitcnt lgkmcnt(12)
v_smfmac_f32_16x16x64_bf16 v[80:83], v[12:15], v[88:95], v112
ds_read_b128 v[88:91], v113 offset:26624
ds_read_b128 v[92:95], v113 offset:27648
s_waitcnt lgkmcnt(12)
s_waitcnt vmcnt(5)
v_cmp_u_f32 vcc, v16, v18
v_smfmac_f32_16x16x64_bf16 v[84:87], v[12:15], v[32:39], v112
ds_read_b128 v[32:35], v113 offset:28672
ds_read_b128 v[36:39], v113 offset:29696
s_cbranch_vccnz main_kernel_c6_o4_f
main_kernel_c6_o4:
s_waitcnt lgkmcnt(12)
v_smfmac_f32_16x16x64_bf16 v[80:83], v[16:19], v[40:47], v112
ds_read_b128 v[40:43], v113 offset:30720
ds_read_b128 v[44:47], v113 offset:31744
s_waitcnt lgkmcnt(12)
s_waitcnt vmcnt(4)
v_cmp_u_f32 vcc, v20, v22
v_smfmac_f32_16x16x64_bf16 v[84:87], v[16:19], v[48:55], v112
s_cbranch_vccnz main_kernel_c6_o5_f
main_kernel_c6_o5:
s_waitcnt lgkmcnt(10)
v_smfmac_f32_16x16x64_bf16 v[80:83], v[20:23], v[56:63], v112
s_waitcnt lgkmcnt(8)
s_waitcnt vmcnt(3)
v_cmp_u_f32 vcc, v24, v26
v_smfmac_f32_16x16x64_bf16 v[84:87], v[20:23], v[64:71], v112
s_cbranch_vccnz main_kernel_c6_o6_f
main_kernel_c6_o6:
s_waitcnt lgkmcnt(6)
v_smfmac_f32_16x16x64_bf16 v[80:83], v[24:27], v[72:79], v112
s_waitcnt lgkmcnt(4)
v_smfmac_f32_16x16x64_bf16 v[84:87], v[24:27], v[88:95], v112
s_waitcnt lgkmcnt(2)
s_waitcnt vmcnt(2)
v_cmp_u_f32 vcc, v28, v30
s_cbranch_vccnz main_kernel_c6_o7_f
main_kernel_c6_o7:
v_smfmac_f32_16x16x64_bf16 v[80:83], v[28:31], v[32:39], v112
s_waitcnt lgkmcnt(0)
v_smfmac_f32_16x16x64_bf16 v[84:87], v[28:31], v[40:47], v112
s_nop 4
v_cvt_pk_bf16_f32 v80, v80, v81
v_cvt_pk_bf16_f32 v81, v82, v83
ds_write_b64 v116, v[80:81] offset:21504
v_cvt_pk_bf16_f32 v82, v84, v85
v_cvt_pk_bf16_f32 v83, v86, v87
ds_write_b64 v116, v[82:83] offset:23552
s_waitcnt lgkmcnt(0)
s_barrier
ds_read_b128 v[72:75], v116 offset:20480
ds_read_b128 v[76:79], v116 offset:21504
s_mov_b32 m0, 28672
s_cmp_lg_u32 s10, 0
s_waitcnt lgkmcnt(1)
v_mfma_f32_16x16x32_bf16 v[64:67], v[72:75], v[108:111], 0
s_waitcnt lgkmcnt(0)
v_mfma_f32_16x16x32_bf16 v[64:67], v[76:79], v[108:111], v[64:67]
s_nop 7
v_cvt_pk_f16_f32 v68, v64, v65
v_cvt_pk_f16_f32 v69, v66, v67
buffer_store_dwordx2 v[68:69], v125, s[4:7], s25 offen sc1
s_cbranch_scc1 main_kernel_c6_kvw
main_kernel_c6_kvok:
s_nop 3
buffer_load_dwordx4 v116, s[4:7], s27 offen sc1 lds
buffer_load_dwordx4 v116, s[4:7], s27 offen offset:1024 sc1 lds
s_mov_b32 m0, 30720
s_xor_b32 s32, s27, 2048
buffer_load_dwordx4 v116, s[4:7], s32 offen offset:1024 sc1 lds
s_add_u32 s27, s27, 0x40000
s_branch main_kernel_c6_top
main_kernel_c6_kvw:
s_mov_b32 exec_lo, 0
s_mov_b32 exec_hi, 0x3f00
v_subrev_u32 v127, 128, v121
main_kernel_c6_kvp:
buffer_load_dword v126, v127, s[4:7], 0 offen sc1
s_waitcnt vmcnt(0)
v_cmp_eq_u32 vcc, 0, v126
s_cbranch_vccz main_kernel_c6_kvp_ok
s_sleep 2
s_sub_u32 s29, s29, 1
s_cbranch_scc0 main_kernel_c6_kvp
s_branch main_kernel_end
main_kernel_c6_kvp_ok:
s_mov_b64 exec, -1
s_branch main_kernel_c6_kvok
main_kernel_c6_last:
s_add_u32 s37, s37, 65536
s_add_u32 s26, s26, 65536
buffer_store_dwordx2 v[114:115], v119, s[4:7], s37 offen sc1
v_smfmac_f32_16x16x64_f16 v[88:91], v[20:23], v[168:175], v112
v_smfmac_f32_16x16x64_f16 v[88:91], v[24:27], v[176:183], v112
v_smfmac_f32_16x16x64_f16 v[88:91], v[28:31], v[184:191], v112
v_smfmac_f32_16x16x64_f16 v[88:91], v[32:35], v[192:199], v112
v_smfmac_f32_16x16x64_f16 v[88:91], v[36:39], v[200:207], v112
v_smfmac_f32_16x16x64_f16 v[88:91], v[40:43], v[208:215], v112
v_smfmac_f32_16x16x64_f16 v[88:91], v[44:47], v[216:223], v112
v_smfmac_f32_16x16x64_f16 v[88:91], v[48:51], v[224:231], v112
v_smfmac_f32_16x16x64_f16 v[88:91], v[52:55], v[232:239], v112
v_smfmac_f32_16x16x64_f16 v[88:91], v[56:59], v[240:247], v112
v_smfmac_f32_16x16x64_f16 v[88:91], v[60:63], v[248:255], v112
s_nop 7
v_permlane32_swap_b32 v88, v90
s_nop 1
v_permlane32_swap_b32 v89, v91
s_nop 1
v_pk_add_f32 v[88:89], v[88:89], v[90:91]
s_nop 1
v_cvt_pk_bf16_f32 v124, v88, v89
s_nop 1
buffer_store_dword v124, v120, s[4:7], s26 offen sc1
s_branch main_kernel_end
main_kernel_c6_m0_f:
s_waitcnt lgkmcnt(0)
buffer_load_dwordx4 v[0:3], v116, s[4:7], s18 offen sc1
buffer_load_dwordx4 v[64:67], v116, s[4:7], s19 offen sc1
s_xor_b32 s32, s18, 1024
buffer_load_dwordx4 v[16:19], v116, s[4:7], s32 offen sc1
s_xor_b32 s32, s19, 1024
buffer_load_dwordx4 v[68:71], v116, s[4:7], s32 offen sc1
s_xor_b32 s32, s18, 2048
buffer_load_dwordx4 v[32:35], v116, s[4:7], s32 offen sc1
s_xor_b32 s32, s19, 2048
buffer_load_dwordx4 v[72:75], v116, s[4:7], s32 offen sc1
s_xor_b32 s32, s18, 3072
buffer_load_dwordx4 v[48:51], v116, s[4:7], s32 offen sc1
s_xor_b32 s32, s19, 3072
buffer_load_dwordx4 v[76:79], v116, s[4:7], s32 offen sc1
s_sub_u32 s29, s29, 1
s_cbranch_scc1 main_kernel_end
s_waitcnt vmcnt(0)
v_max_u32 v126, v0, v2
v_max3_u32 v126, v126, v64, v66
v_cmp_eq_u32 vcc, -1, v126
s_cbranch_vccnz main_kernel_c6_m0_f
v_pk_add_f16 v0, v0, v64
v_pk_add_f16 v1, v1, v65
v_pk_add_f16 v2, v2, v66
v_pk_add_f16 v3, v3, v67
s_nop 0
s_branch main_kernel_c6_m0
main_kernel_c6_m1_f:
s_waitcnt lgkmcnt(0)
s_xor_b32 s32, s18, 1024
buffer_load_dwordx4 v[16:19], v116, s[4:7], s32 offen sc1
s_xor_b32 s32, s19, 1024
buffer_load_dwordx4 v[68:71], v116, s[4:7], s32 offen sc1
s_xor_b32 s32, s18, 2048
buffer_load_dwordx4 v[32:35], v116, s[4:7], s32 offen sc1
s_xor_b32 s32, s19, 2048
buffer_load_dwordx4 v[72:75], v116, s[4:7], s32 offen sc1
s_xor_b32 s32, s18, 3072
buffer_load_dwordx4 v[48:51], v116, s[4:7], s32 offen sc1
s_xor_b32 s32, s19, 3072
buffer_load_dwordx4 v[76:79], v116, s[4:7], s32 offen sc1
s_sub_u32 s29, s29, 1
s_cbranch_scc1 main_kernel_end
s_waitcnt vmcnt(0)
v_max_u32 v126, v16, v18
v_max3_u32 v126, v126, v68, v70
v_cmp_eq_u32 vcc, -1, v126
s_cbranch_vccnz main_kernel_c6_m1_f
v_pk_add_f16 v16, v16, v68
v_pk_add_f16 v17, v17, v69
v_pk_add_f16 v18, v18, v70
v_pk_add_f16 v19, v19, v71
s_nop 0
s_branch main_kernel_c6_m1
main_kernel_c6_m2_f:
s_waitcnt lgkmcnt(0)
s_xor_b32 s32, s18, 2048
buffer_load_dwordx4 v[32:35], v116, s[4:7], s32 offen sc1
s_xor_b32 s32, s19, 2048
buffer_load_dwordx4 v[72:75], v116, s[4:7], s32 offen sc1
s_xor_b32 s32, s18, 3072
buffer_load_dwordx4 v[48:51], v116, s[4:7], s32 offen sc1
s_xor_b32 s32, s19, 3072
buffer_load_dwordx4 v[76:79], v116, s[4:7], s32 offen sc1
s_sub_u32 s29, s29, 1
s_cbranch_scc1 main_kernel_end
s_waitcnt vmcnt(0)
v_max_u32 v126, v32, v34
v_max3_u32 v126, v126, v72, v74
v_cmp_eq_u32 vcc, -1, v126
s_cbranch_vccnz main_kernel_c6_m2_f
v_pk_add_f16 v32, v32, v72
v_pk_add_f16 v33, v33, v73
v_pk_add_f16 v34, v34, v74
v_pk_add_f16 v35, v35, v75
ds_write_b128 v116, v[32:35] offset:10240
s_branch main_kernel_c6_m2
main_kernel_c6_m3_f:
s_waitcnt lgkmcnt(0)
s_xor_b32 s32, s18, 3072
buffer_load_dwordx4 v[48:51], v116, s[4:7], s32 offen sc1
s_xor_b32 s32, s19, 3072
buffer_load_dwordx4 v[76:79], v116, s[4:7], s32 offen sc1
s_sub_u32 s29, s29, 1
s_cbranch_scc1 main_kernel_end
s_waitcnt vmcnt(0)
v_max_u32 v126, v48, v50
v_max3_u32 v126, v126, v76, v78
v_cmp_eq_u32 vcc, -1, v126
s_cbranch_vccnz main_kernel_c6_m3_f
v_pk_add_f16 v48, v48, v76
v_pk_add_f16 v49, v49, v77
v_pk_add_f16 v50, v50, v78
v_pk_add_f16 v51, v51, v79
ds_write_b128 v116, v[48:51] offset:14336
s_branch main_kernel_c6_m3
main_kernel_c6_z_f:
buffer_load_dwordx4 v[8:11], v116, s[4:7], s20 offen offset:0 sc1
buffer_load_dwordx4 v[12:15], v116, s[4:7], s20 offen offset:1024 sc1
s_memtime s[32:33]
ds_read_b32 v126, v116 offset:18432
s_sub_u32 s34, s19, s54
s_xor_b32 s34, s34, 0x2000
s_lshl_b32 s35, s12, 15
s_add_u32 s34, s34, s35
s_lshl_b32 s35, s13, 8
s_add_u32 s35, s35, s34
s_add_u32 s34, s34, 0x4000
s_waitcnt lgkmcnt(0)
s_sub_u32 s32, s32, 450
v_sub_u32 v127, s32, v126
buffer_store_dword v127, off, s[4:7], s34 sc1
s_sub_u32 s29, s29, 1
s_cbranch_scc1 main_kernel_end
s_waitcnt vmcnt(1)
main_kernel_c6_z_g:
v_max_u32 v126, v8, v10
v_max3_u32 v126, v126, v12, v14
v_cmp_eq_u32 vcc, -1, v126
s_cbranch_vccnz main_kernel_c6_z_h
v_mfma_f32_16x16x32_bf16 v[88:91], v[8:11], v[8:11], v[92:95]
v_mfma_f32_16x16x32_bf16 v[0:3], v[16:19], v[8:11], v[80:83]
v_mfma_f32_16x16x32_bf16 v[4:7], v[20:23], v[8:11], v[84:87]
v_mfma_f32_16x16x32_bf16 v[88:91], v[12:15], v[12:15], v[88:91]
v_mfma_f32_16x16x32_bf16 v[0:3], v[24:27], v[12:15], v[0:3]
v_mfma_f32_16x16x32_bf16 v[4:7], v[28:31], v[12:15], v[4:7]
buffer_store_dword v127, off, s[4:7], s35 offset:132 sc1
s_mov_b32 vcc_lo, 0xcccccccc
s_mov_b32 vcc_hi, 0xcccccccc
s_branch main_kernel_c6_z
main_kernel_c6_z_h:
buffer_load_dwordx4 v[8:11], v116, s[4:7], s20 offen offset:0 sc1
buffer_load_dwordx4 v[12:15], v116, s[4:7], s20 offen offset:1024 sc1
s_sub_u32 s29, s29, 1
s_cbranch_scc1 main_kernel_end
v_add_u32 v127, 300, v127
s_waitcnt vmcnt(0)
s_branch main_kernel_c6_z_g
main_kernel_c6_sm_f:
s_waitcnt vmcnt(0) lgkmcnt(0)
buffer_load_dwordx4 v[8:11], v116, s[4:7], s20 offen offset:0 sc1
buffer_load_dwordx4 v[12:15], v116, s[4:7], s20 offen offset:1024 sc1
ds_read_b128 v[0:3], v116 offset:16384
ds_read_b128 v[4:7], v116 offset:17408
ds_read_b128 v[64:67], v116 offset:24576
ds_read_b128 v[68:71], v116 offset:28672
ds_read_b128 v[72:75], v116 offset:25600
ds_read_b128 v[76:79], v116 offset:29696
ds_read_b128 v[16:19], v116 offset:26624
ds_read_b128 v[20:23], v116 offset:30720
ds_read_b128 v[24:27], v116 offset:27648
ds_read_b128 v[28:31], v116 offset:31744
s_waitcnt vmcnt(0)
s_waitcnt lgkmcnt(0)
v_mfma_f32_16x16x32_bf16 v[80:83], v[64:67], v[0:3], 0
v_mfma_f32_16x16x32_bf16 v[84:87], v[68:71], v[0:3], 0
v_mfma_f32_16x16x32_bf16 v[92:95], v[0:3], v[0:3], 0
v_mfma_f32_16x16x32_bf16 v[80:83], v[72:75], v[4:7], v[80:83]
v_mfma_f32_16x16x32_bf16 v[84:87], v[76:79], v[4:7], v[84:87]
v_mfma_f32_16x16x32_bf16 v[92:95], v[4:7], v[4:7], v[92:95]
v_mfma_f32_16x16x32_bf16 v[0:3], v[16:19], v[8:11], v[80:83]
v_mfma_f32_16x16x32_bf16 v[4:7], v[20:23], v[8:11], v[84:87]
v_mfma_f32_16x16x32_bf16 v[88:91], v[8:11], v[8:11], v[92:95]
v_mfma_f32_16x16x32_bf16 v[0:3], v[24:27], v[12:15], v[0:3]
v_mfma_f32_16x16x32_bf16 v[4:7], v[28:31], v[12:15], v[4:7]
v_mfma_f32_16x16x32_bf16 v[88:91], v[12:15], v[12:15], v[88:91]
s_nop 7
v_mov_b32 v65, 0
v_max_f32 v126, v88, v89
v_mul_f32 v126, s30, v126
v_max3_f32 v126, v126, v0, v1
v_max3_f32 v126, v126, v2, v3
v_max3_f32 v126, v126, v4, v5
v_max3_f32 v126, v126, v6, v7
v_mov_b32 v127, v126
s_nop 1
v_permlane32_swap_b32 v126, v127
v_max_f32 v126, v126, v127
v_mov_b32 v127, v126
s_nop 1
v_permlane16_swap_b32 v126, v127
v_max_f32 v126, v126, v127
v_mul_f32 v127, 0x40faf233, v126
s_mov_b32 vcc_lo, 0xcccccccc
s_mov_b32 vcc_hi, 0xcccccccc
v_sub_f32 v0, v0, v126
v_sub_f32 v1, v1, v126
v_sub_f32 v2, v2, v126
v_sub_f32 v3, v3, v126
v_sub_f32 v4, v4, v126
v_sub_f32 v5, v5, v126
v_sub_f32 v6, v6, v126
v_sub_f32 v7, v7, v126
v_sub_f32 v88, v88, v127
v_sub_f32 v89, v89, v127
s_waitcnt lgkmcnt(0)
s_nop 0
v_mul_f32 v88, s30, v88
v_mul_f32 v89, s30, v89
v_exp_f32 v88, v88
v_exp_f32 v89, v89
v_cndmask_b32_dpp v0, v2, v0, vcc quad_perm:[2,3,2,3] row_mask:0xf bank_mask:0xf
v_cvt_pk_bf16_f32 v64, v88, v89
v_cndmask_b32_dpp v1, v3, v1, vcc quad_perm:[2,3,2,3] row_mask:0xf bank_mask:0xf
v_exp_f32 v0, v0
v_mfma_f32_16x16x16_bf16 v[16:19], v[100:101], v[64:65], 0
v_exp_f32 v1, v1
v_cndmask_b32_dpp v4, v6, v4, vcc quad_perm:[2,3,2,3] row_mask:0xf bank_mask:0xf
v_mfma_f32_16x16x16_bf16 v[8:11], v[124:125], v[64:65], 0
v_cndmask_b32_dpp v5, v7, v5, vcc quad_perm:[2,3,2,3] row_mask:0xf bank_mask:0xf
v_exp_f32 v4, v4
v_exp_f32 v5, v5
v_cvt_pk_bf16_f32 v92, v0, v1
v_cvt_pk_bf16_f32 v94, v4, v5
v_mov_b32 v80, 0
v_mov_b32_dpp v93, v92 quad_perm:[0,1,0,1] row_mask:0xf bank_mask:0xf
v_mov_b32_dpp v95, v94 quad_perm:[0,1,0,1] row_mask:0xf bank_mask:0xf
v_mov_b32 v81, 0
v_mov_b32 v82, 0
v_mfma_f32_16x16x32_bf16 v[16:19], v[100:103], v[92:95], v[16:19]
v_mov_b32 v83, 0
v_mov_b32 v84, 0
v_mfma_f32_16x16x32_bf16 v[8:11], v[96:99], v[92:95], v[8:11]
s_nop 1
v_mov_b32 v85, 0
v_mov_b32 v86, 0
v_mov_b32 v87, 0
v_rcp_f32 v126, v16
v_subrev_u32 v127, 0x21800000, v16
v_cmp_lt_u32 vcc, 0x3c000000, v127
v_pk_mul_f32 v[8:9], v[8:9], v[126:127] op_sel_hi:[1,0]
v_pk_mul_f32 v[10:11], v[10:11], v[126:127] op_sel_hi:[1,0]
s_and_b32 s32, vcc_lo, 0xcccc
v_cvt_pk_bf16_f32 v126, v8, v9
v_cvt_pk_bf16_f32 v127, v10, v11
s_branch main_kernel_c6_ost
main_kernel_c6_o0_f:
s_nop 0
buffer_load_dwordx4 v[0:3], v116, s[4:7], s23 offen sc1
s_xor_b32 s32, s23, 1024
buffer_load_dwordx4 v[4:7], v116, s[4:7], s32 offen sc1
s_sub_u32 s29, s29, 1
s_cbranch_scc1 main_kernel_end
s_waitcnt vmcnt(0)
v_max_u32 v126, v0, v2
v_cmp_eq_u32 vcc, -1, v126
s_cbranch_vccnz main_kernel_c6_o0_f
s_branch main_kernel_c6_o0
main_kernel_c6_o1_f:
s_nop 0
s_xor_b32 s32, s23, 1024
buffer_load_dwordx4 v[4:7], v116, s[4:7], s32 offen sc1
s_xor_b32 s32, s23, 2048
buffer_load_dwordx4 v[8:11], v116, s[4:7], s32 offen sc1
s_sub_u32 s29, s29, 1
s_cbranch_scc1 main_kernel_end
s_waitcnt vmcnt(0)
v_max_u32 v126, v4, v6
v_cmp_eq_u32 vcc, -1, v126
s_cbranch_vccnz main_kernel_c6_o1_f
s_branch main_kernel_c6_o1
main_kernel_c6_o2_f:
s_nop 0
s_xor_b32 s32, s23, 2048
buffer_load_dwordx4 v[8:11], v116, s[4:7], s32 offen sc1
s_xor_b32 s32, s23, 3072
buffer_load_dwordx4 v[12:15], v116, s[4:7], s32 offen sc1
s_sub_u32 s29, s29, 1
s_cbranch_scc1 main_kernel_end
s_waitcnt vmcnt(0)
v_max_u32 v126, v8, v10
v_cmp_eq_u32 vcc, -1, v126
s_cbranch_vccnz main_kernel_c6_o2_f
s_branch main_kernel_c6_o2
main_kernel_c6_o3_f:
s_nop 0
s_xor_b32 s32, s23, 3072
buffer_load_dwordx4 v[12:15], v116, s[4:7], s32 offen sc1
s_xor_b32 s32, s23, 4096
buffer_load_dwordx4 v[16:19], v116, s[4:7], s32 offen sc1
s_sub_u32 s29, s29, 1
s_cbranch_scc1 main_kernel_end
s_waitcnt vmcnt(0)
v_max_u32 v126, v12, v14
v_cmp_eq_u32 vcc, -1, v126
s_cbranch_vccnz main_kernel_c6_o3_f
s_branch main_kernel_c6_o3
main_kernel_c6_o4_f:
s_nop 0
s_xor_b32 s32, s23, 4096
buffer_load_dwordx4 v[16:19], v116, s[4:7], s32 offen sc1
s_xor_b32 s32, s23, 5120
buffer_load_dwordx4 v[20:23], v116, s[4:7], s32 offen sc1
s_sub_u32 s29, s29, 1
s_cbranch_scc1 main_kernel_end
s_waitcnt vmcnt(0)
v_max_u32 v126, v16, v18
v_cmp_eq_u32 vcc, -1, v126
s_cbranch_vccnz main_kernel_c6_o4_f
s_branch main_kernel_c6_o4
main_kernel_c6_o5_f:
s_nop 0
s_xor_b32 s32, s23, 5120
buffer_load_dwordx4 v[20:23], v116, s[4:7], s32 offen sc1
s_xor_b32 s32, s23, 6144
buffer_load_dwordx4 v[24:27], v116, s[4:7], s32 offen sc1
s_sub_u32 s29, s29, 1
s_cbranch_scc1 main_kernel_end
s_waitcnt vmcnt(0)
v_max_u32 v126, v20, v22
v_cmp_eq_u32 vcc, -1, v126
s_cbranch_vccnz main_kernel_c6_o5_f
s_branch main_kernel_c6_o5
main_kernel_c6_o6_f:
s_nop 0
s_xor_b32 s32, s23, 6144
buffer_load_dwordx4 v[24:27], v116, s[4:7], s32 offen sc1
s_xor_b32 s32, s23, 7168
buffer_load_dwordx4 v[28:31], v116, s[4:7], s32 offen sc1
s_sub_u32 s29, s29, 1
s_cbranch_scc1 main_kernel_end
s_waitcnt vmcnt(0)
v_max_u32 v126, v24, v26
v_cmp_eq_u32 vcc, -1, v126
s_cbranch_vccnz main_kernel_c6_o6_f
s_branch main_kernel_c6_o6
main_kernel_c6_o7_f:
s_nop 0
s_xor_b32 s32, s23, 7168
buffer_load_dwordx4 v[28:31], v116, s[4:7], s32 offen sc1
s_sub_u32 s29, s29, 1
s_cbranch_scc1 main_kernel_end
s_waitcnt vmcnt(0)
v_max_u32 v126, v28, v30
v_cmp_eq_u32 vcc, -1, v126
s_cbranch_vccnz main_kernel_c6_o7_f
s_branch main_kernel_c6_o7
.p2align 6
main_kernel_c7_top:
s_barrier
buffer_load_dwordx4 v[0:3], v116, s[4:7], s18 offen sc1
s_add_u32 s20, s20, 0x40000
s_bitset0_b32 s20, 20
s_add_u32 s21, s21, 0x40000
s_bitset0_b32 s21, 20
s_add_u32 s22, s22, 0x40000
s_bitset0_b32 s22, 20
s_add_u32 s23, s23, 0x40000
s_bitset0_b32 s23, 20
s_xor_b32 s32, s18, 1024
buffer_load_dwordx4 v[16:19], v116, s[4:7], s32 offen sc1
s_add_u32 s3, s3, 0x40000
s_bitset0_b32 s3, 20
s_add_u32 s17, s17, 1
s_bitcmp1_b32 0x77777777, s17
s_cselect_b32 s33, 0x800, 0
s_xor_b32 s54, s54, s33
s_add_u32 s25, s25, 0x40000
s_bitset0_b32 s25, 20
s_nop 0
buffer_load_dwordx4 v[64:67], v116, s[4:7], s19 offen sc1
v_mov_b32 v80, 0
v_mov_b32 v81, 0
s_nop 3
s_xor_b32 s32, s19, 1024
buffer_load_dwordx4 v[68:71], v116, s[4:7], s32 offen sc1
v_mov_b32 v82, 0
v_mov_b32 v83, 0
s_nop 3
s_xor_b32 s32, s18, 2048
buffer_load_dwordx4 v[32:35], v116, s[4:7], s32 offen sc1
v_mov_b32 v84, 0
v_mov_b32 v85, 0
s_nop 3
s_xor_b32 s32, s19, 2048
buffer_load_dwordx4 v[72:75], v116, s[4:7], s32 offen sc1
v_mov_b32 v86, 0
v_mov_b32 v87, 0
s_nop 3
s_xor_b32 s32, s18, 3072
buffer_load_dwordx4 v[48:51], v116, s[4:7], s32 offen sc1
v_mov_b32 v88, 0
v_mov_b32 v89, 0
s_nop 3
s_xor_b32 s32, s19, 3072
buffer_load_dwordx4 v[76:79], v116, s[4:7], s32 offen sc1
s_memtime s[40:41]
s_memrealtime s[80:81]
s_memrealtime s[82:83]
s_memrealtime s[84:85]
s_memrealtime s[86:87]
s_memrealtime s[88:89]
s_memrealtime s[90:91]
s_memrealtime s[92:93]
s_memrealtime s[94:95]
s_memrealtime s[96:97]
s_memrealtime s[98:99]
s_memrealtime s[100:101]
s_sub_u32 s32, s15, s16
s_lshr_b32 s33, s17, 1
s_min_u32 s33, s33, 3
s_ashr_i32 s32, s32, s33
s_add_u32 s11, s11, s32
s_sub_u32 s32, s16, s27
s_sub_u32 s32, s32, s39
s_ashr_i32 s32, s32, 2
s_add_u32 s39, s39, s32
s_mov_b32 s27, s16
s_mov_b32 s2, s31
v_mov_b32 v126, s11
s_add_u32 s32, s43, 1590
v_mov_b32 v127, s32
s_waitcnt lgkmcnt(0)
ds_write_b32 v116, v126 offset:18432
s_add_u32 s80, s80, s82
s_add_u32 s80, s80, s84
s_add_u32 s80, s80, s86
s_add_u32 s80, s80, s88
s_add_u32 s80, s80, s90
s_add_u32 s80, s80, s92
s_add_u32 s80, s80, s94
s_add_u32 s80, s80, s96
s_add_u32 s80, s80, s98
s_add_u32 s80, s80, s100
s_lshl1_add_u32 s80, s80, s11
s_sub_u32 s15, s40, s80
s_add_u32 s32, s15, s39
v_mov_b32 v126, s32
buffer_store_dwordx2 v[126:127], off, s[4:7], s44 offset:128 sc1
v_mov_b32 v90, 0
v_mov_b32 v91, 0
s_waitcnt vmcnt(6)
v_pk_add_f16 v0, v0, v64
v_pk_add_f16 v1, v1, v65
v_pk_add_f16 v2, v2, v66
v_pk_add_f16 v3, v3, v67
v_cmp_u_f16 vcc, v0, v2
s_cbranch_vccnz main_kernel_c7_m0_f
main_kernel_c7_m0:
v_smfmac_f32_16x16x64_f16 v[80:83], v[0:3], a[0:7], v112
ds_write_b128 v116, v[0:3] offset:3072
v_smfmac_f32_16x16x64_f16 v[84:87], v[0:3], a[128:135], v112
buffer_load_dword v123, v121, s[4:7], 0 offen sc1
s_waitcnt vmcnt(6)
v_pk_add_f16 v16, v16, v68
v_pk_add_f16 v17, v17, v69
v_pk_add_f16 v18, v18, v70
v_pk_add_f16 v19, v19, v71
v_cmp_u_f16 vcc, v16, v18
s_waitcnt lgkmcnt(0)
s_barrier
ds_read_b128 v[4:7], v116 offset:2048
s_cbranch_vccnz main_kernel_c7_m1_f
main_kernel_c7_m1:
v_smfmac_f32_16x16x64_f16 v[80:83], v[16:19], a[8:15], v112
ds_write_b128 v116, v[16:19] offset:7168
v_smfmac_f32_16x16x64_f16 v[84:87], v[16:19], a[136:143], v112
ds_read_b128 v[8:11], v116 offset:1024
v_smfmac_f32_16x16x64_f16 v[88:91], v[0:3], v[128:135], v112
ds_read_b128 v[12:15], v116 offset:0
s_waitcnt lgkmcnt(3)
v_smfmac_f32_16x16x64_f16 v[80:83], v[4:7], a[32:39], v112
v_smfmac_f32_16x16x64_f16 v[84:87], v[4:7], a[160:167], v112
v_smfmac_f32_16x16x64_f16 v[88:91], v[4:7], v[136:143], v112
s_waitcnt lgkmcnt(2)
s_barrier
s_waitcnt lgkmcnt(1)
v_smfmac_f32_16x16x64_f16 v[80:83], v[8:11], a[64:71], v112
s_waitcnt vmcnt(4)
ds_read_b128 v[20:23], v116 offset:6144
v_pk_add_f16 v32, v32, v72
v_smfmac_f32_16x16x64_f16 v[84:87], v[8:11], a[192:199], v112
ds_read_b128 v[24:27], v116 offset:5120
s_waitcnt lgkmcnt(2)
v_pk_add_f16 v33, v33, v73
v_smfmac_f32_16x16x64_f16 v[80:83], v[12:15], a[96:103], v112
ds_read_b128 v[28:31], v116 offset:4096
v_pk_add_f16 v34, v34, v74
v_smfmac_f32_16x16x64_f16 v[84:87], v[12:15], a[224:231], v112
s_waitcnt lgkmcnt(2)
v_pk_add_f16 v35, v35, v75
v_smfmac_f32_16x16x64_f16 v[80:83], v[20:23], a[40:47], v112
v_cmp_u_f16 vcc, v32, v34
v_smfmac_f32_16x16x64_f16 v[84:87], v[20:23], a[168:175], v112
ds_write_b128 v116, v[32:35] offset:11264
s_cbranch_vccnz main_kernel_c7_m2_f
main_kernel_c7_m2:
v_smfmac_f32_16x16x64_f16 v[80:83], v[32:35], a[16:23], v112
buffer_load_dwordx4 v[96:99], v116, s[4:7], s28 offen sc1
v_smfmac_f32_16x16x64_f16 v[84:87], v[32:35], a[144:151], v112
s_add_u32 s28, s28, 0x40000
s_waitcnt lgkmcnt(2)
v_smfmac_f32_16x16x64_f16 v[80:83], v[24:27], a[72:79], v112
s_waitcnt vmcnt(3)
v_pk_add_f16 v48, v48, v76
v_smfmac_f32_16x16x64_f16 v[84:87], v[24:27], a[200:207], v112
s_waitcnt lgkmcnt(0)
s_barrier
ds_read_b128 v[36:39], v116 offset:10240
v_pk_add_f16 v49, v49, v77
v_smfmac_f32_16x16x64_f16 v[80:83], v[28:31], a[104:111], v112
ds_read_b128 v[40:43], v116 offset:9216
v_pk_add_f16 v50, v50, v78
v_smfmac_f32_16x16x64_f16 v[84:87], v[28:31], a[232:239], v112
ds_read_b128 v[44:47], v116 offset:8192
v_pk_add_f16 v51, v51, v79
v_smfmac_f32_16x16x64_f16 v[88:91], v[8:11], v[144:151], v112
s_waitcnt lgkmcnt(2)
v_cmp_u_f16 vcc, v48, v50
v_smfmac_f32_16x16x64_f16 v[80:83], v[36:39], a[48:55], v112
ds_write_b128 v116, v[48:51] offset:15360
s_cbranch_vccnz main_kernel_c7_m3_f
main_kernel_c7_m3:
v_smfmac_f32_16x16x64_f16 v[80:83], v[48:51], a[24:31], v112
v_smfmac_f32_16x16x64_f16 v[84:87], v[48:51], a[152:159], v112
v_smfmac_f32_16x16x64_f16 v[84:87], v[36:39], a[176:183], v112
s_waitcnt lgkmcnt(2)
v_smfmac_f32_16x16x64_f16 v[80:83], v[40:43], a[80:87], v112
s_waitcnt lgkmcnt(0)
s_barrier
ds_read_b128 v[52:55], v116 offset:14336
v_smfmac_f32_16x16x64_f16 v[84:87], v[40:43], a[208:215], v112
s_memtime s[40:41]
ds_read_b128 v[56:59], v116 offset:13312
v_smfmac_f32_16x16x64_f16 v[80:83], v[44:47], a[112:119], v112
s_add_u32 s19, s52, s54
ds_read_b128 v[60:63], v116 offset:12288
v_smfmac_f32_16x16x64_f16 v[84:87], v[44:47], a[240:247], v112
s_add_u32 s18, s18, 0x40000
s_waitcnt lgkmcnt(2)
v_smfmac_f32_16x16x64_f16 v[80:83], v[52:55], a[56:63], v112
s_bitset0_b32 s18, 20
s_waitcnt lgkmcnt(1)
v_smfmac_f32_16x16x64_f16 v[80:83], v[56:59], a[88:95], v112
s_cmp_eq_u32 s17, 30
s_cselect_b32 s32, s53, 0x10000
s_waitcnt lgkmcnt(0)
v_smfmac_f32_16x16x64_f16 v[80:83], v[60:63], a[120:127], v112
s_add_u32 s52, s52, s32
ds_read_b128 v[64:67], v116 offset:24576
v_smfmac_f32_16x16x64_f16 v[84:87], v[52:55], a[184:191], v112
s_sub_u32 s24, 0x20000, s32
ds_read_b128 v[68:71], v116 offset:28672
v_smfmac_f32_16x16x64_f16 v[84:87], v[56:59], a[216:223], v112
ds_read_b128 v[72:75], v116 offset:25600
s_add_u32 s55, s55, s24
v_cvt_pk_bf16_f32 v92, v80, v81
v_smfmac_f32_16x16x64_f16 v[84:87], v[60:63], a[248:255], v112
ds_read_b128 v[76:79], v116 offset:29696
s_nop 0
v_cvt_pk_bf16_f32 v93, v82, v83
v_smfmac_f32_16x16x64_f16 v[88:91], v[12:15], v[152:159], v112
s_nop 3
v_cvt_pk_bf16_f32 v94, v84, v85
v_cvt_pk_bf16_f32 v95, v86, v87
s_mov_b32 vcc_lo, 0xcccccccc
s_mov_b32 vcc_hi, 0xcccccccc
v_mfma_f32_16x16x32_bf16 v[84:87], v[92:95], v[104:107], 0
v_add_u32 v121, v121, v122
s_waitcnt lgkmcnt(0)
s_sub_u32 s31, s40, s11
v_smfmac_f32_16x16x64_f16 v[88:91], v[16:19], v[160:167], v112
s_sub_u32 s32, s31, s43
s_sub_u32 s47, 1590, s32
s_max_i32 s47, s47, 0
s_cmp_eq_u32 s17, 63
v_cvt_pk_bf16_f32 v114, v84, v85
v_cvt_pk_bf16_f32 v115, v86, v87
buffer_store_dwordx2 v[114:115], v117, s[4:7], s21 offen sc1
s_cbranch_scc1 main_kernel_c7_last
ds_write_b64 v117, v[114:115] offset:17920
v_smfmac_f32_16x16x64_f16 v[88:91], v[20:23], v[168:175], v112
s_cmp_gt_u32 s32, 1790
s_cselect_b32 s33, 900, s47
v_smfmac_f32_16x16x64_f16 v[88:91], v[24:27], v[176:183], v112
s_add_u32 s10, s33, s31
s_andn2_b32 s42, s44, 0x1f00
v_mov_b32 v126, s15
v_smfmac_f32_16x16x64_f16 v[88:91], v[28:31], v[184:191], v112
s_add_u32 s42, s42, 0x4000
v_mov_b32 v127, s10
v_smfmac_f32_16x16x64_f16 v[88:91], v[32:35], v[192:199], v112
.p2align 3
main_kernel_c7_b21:
s_sub_u32 s47, s47, 28
s_cbranch_scc0 main_kernel_c7_b21
s_waitcnt lgkmcnt(0)
s_barrier
ds_read_b128 v[0:3], v116 offset:16384
v_smfmac_f32_16x16x64_f16 v[88:91], v[36:39], v[200:207], v112
ds_read_b128 v[4:7], v116 offset:17408
buffer_store_dwordx2 v[126:127], off, s[4:7], s46 sc1
v_smfmac_f32_16x16x64_f16 v[88:91], v[40:43], v[208:215], v112
ds_read_b128 v[16:19], v116 offset:26624
s_cmp_gt_u32 s32, 1790
s_cselect_b32 s80, s44, 0x7f000000
v_smfmac_f32_16x16x64_f16 v[88:91], v[44:47], v[216:223], v112
ds_read_b128 v[20:23], v116 offset:30720
v_writelane_b32 v121, s55, 39
v_smfmac_f32_16x16x64_f16 v[88:91], v[48:51], v[224:231], v112
ds_read_b128 v[24:27], v116 offset:27648
v_smfmac_f32_16x16x64_f16 v[88:91], v[52:55], v[232:239], v112
ds_read_b128 v[28:31], v116 offset:31744
v_smfmac_f32_16x16x64_f16 v[88:91], v[56:59], v[240:247], v112
v_smfmac_f32_16x16x64_f16 v[88:91], v[60:63], v[248:255], v112
s_waitcnt lgkmcnt(5)
v_mfma_f32_16x16x32_bf16 v[80:83], v[64:67], v[0:3], 0
v_mfma_f32_16x16x32_bf16 v[84:87], v[68:71], v[0:3], 0
buffer_load_dwordx4 v[8:11], v116, s[4:7], s20 offen offset:0 sc1
v_mfma_f32_16x16x32_bf16 v[92:95], v[0:3], v[0:3], 0
buffer_load_dwordx4 v[12:15], v116, s[4:7], s20 offen offset:1024 sc1
v_permlane32_swap_b32 v88, v90
s_waitcnt lgkmcnt(4)
v_mfma_f32_16x16x32_bf16 v[80:83], v[72:75], v[4:7], v[80:83]
v_permlane32_swap_b32 v89, v91
v_mfma_f32_16x16x32_bf16 v[84:87], v[76:79], v[4:7], v[84:87]
v_pk_add_f32 v[88:89], v[88:89], v[90:91]
v_mfma_f32_16x16x32_bf16 v[92:95], v[4:7], v[4:7], v[92:95]
v_cvt_pk_bf16_f32 v124, v88, v89
s_andn2_b32 s35, s46, 0xff
v_bfe_u32 v68, v116, 1, 8
v_mov_b32 v65, 0
buffer_load_dwordx2 v[66:67], v68, s[4:7], s35 offen sc1
buffer_store_dword v127, off, s[4:7], s80 offset:132 sc1
s_waitcnt lgkmcnt(0)
s_waitcnt vmcnt(3)
v_mfma_f32_16x16x32_bf16 v[88:91], v[8:11], v[8:11], v[92:95]
v_mfma_f32_16x16x32_bf16 v[0:3], v[16:19], v[8:11], v[80:83]
v_cmp_u_f32 s[0:1], v8, v10
v_mfma_f32_16x16x32_bf16 v[4:7], v[20:23], v[8:11], v[84:87]
s_waitcnt vmcnt(2)
v_mfma_f32_16x16x32_bf16 v[88:91], v[12:15], v[12:15], v[88:91]
v_mfma_f32_16x16x32_bf16 v[0:3], v[24:27], v[12:15], v[0:3]
v_cmp_u_f32 s[32:33], v12, v14
v_mfma_f32_16x16x32_bf16 v[4:7], v[28:31], v[12:15], v[4:7]
s_or_b64 s[0:1], s[0:1], s[32:33]
s_cbranch_scc1 main_kernel_c7_z_f
main_kernel_c7_z:
v_mul_f32 v88, s30, v88
v_mul_f32 v89, s30, v89
v_exp_f32 v88, v88
v_exp_f32 v89, v89
v_cndmask_b32_dpp v0, v2, v0, vcc quad_perm:[2,3,2,3] row_mask:0xf bank_mask:0xf
v_cvt_pk_bf16_f32 v64, v88, v89
v_cndmask_b32_dpp v1, v3, v1, vcc quad_perm:[2,3,2,3] row_mask:0xf bank_mask:0xf
v_exp_f32 v0, v0
v_mfma_f32_16x16x16_bf16 v[16:19], v[100:101], v[64:65], 0
v_exp_f32 v1, v1
v_cndmask_b32_dpp v4, v6, v4, vcc quad_perm:[2,3,2,3] row_mask:0xf bank_mask:0xf
v_mfma_f32_16x16x16_bf16 v[8:11], v[124:125], v[64:65], 0
v_cndmask_b32_dpp v5, v7, v5, vcc quad_perm:[2,3,2,3] row_mask:0xf bank_mask:0xf
v_exp_f32 v4, v4
v_exp_f32 v5, v5
v_cvt_pk_bf16_f32 v92, v0, v1
v_cvt_pk_bf16_f32 v94, v4, v5
v_mov_b32 v80, 0
v_mov_b32_dpp v93, v92 quad_perm:[0,1,0,1] row_mask:0xf bank_mask:0xf
v_mov_b32_dpp v95, v94 quad_perm:[0,1,0,1] row_mask:0xf bank_mask:0xf
v_mov_b32 v81, 0
v_mov_b32 v82, 0
v_mfma_f32_16x16x32_bf16 v[16:19], v[100:103], v[92:95], v[16:19]
v_mov_b32 v83, 0
v_mov_b32 v84, 0
v_mfma_f32_16x16x32_bf16 v[8:11], v[96:99], v[92:95], v[8:11]
s_buffer_load_dword s42, s[4:7], s42
s_nop 1
v_mov_b32 v85, 0
v_mov_b32 v86, 0
v_mov_b32 v87, 0
v_rcp_f32 v126, v16
v_subrev_u32 v127, 0x21800000, v16
v_cmp_lt_u32 vcc, 0x3c000000, v127
v_pk_mul_f32 v[8:9], v[8:9], v[126:127] op_sel_hi:[1,0]
v_pk_mul_f32 v[10:11], v[10:11], v[126:127] op_sel_hi:[1,0]
s_and_b32 s32, vcc_lo, 0xcccc
v_cvt_pk_bf16_f32 v126, v8, v9
v_cvt_pk_bf16_f32 v127, v10, v11
s_cbranch_scc1 main_kernel_c7_sm_f
main_kernel_c7_ost:
buffer_store_dwordx2 v[126:127], v118, s[4:7], s22 offen sc1
s_waitcnt vmcnt(2)
main_kernel_c7_to0:
s_memtime s[40:41]
v_readlane_b32 s16, v66, 0
v_subrev_u32 v67, s2, v67
s_add_u32 s34, s11, s2
s_nop 0
v_max_u32_dpp v67, v67, v67 row_ror:8 row_mask:0xf bank_mask:0xf
s_nop 1
v_max_u32_dpp v67, v67, v67 row_ror:4 row_mask:0xf bank_mask:0xf
s_nop 1
v_max_u32_dpp v67, v67, v67 row_ror:2 row_mask:0xf bank_mask:0xf
s_nop 1
v_max_u32_dpp v67, v67, v67 row_ror:1 row_mask:0xf bank_mask:0xf
s_waitcnt lgkmcnt(0)
v_readlane_b32 s32, v67, 0
v_readlane_b32 s33, v67, 16
s_sub_u32 s34, s40, s34
s_max_u32 s32, s32, s33
s_add_u32 s35, s34, 1536
s_cmp_gt_u32 s32, s35
s_cbranch_scc1 main_kernel_c7_to2
main_kernel_c7_to3:
s_sub_u32 s33, s42, s2
s_cmp_le_u32 s33, s35
s_cselect_b32 s33, s33, 0
s_max_u32 s32, s32, s33
s_add_u32 s36, s32, 2750
s_add_u32 s32, s32, 1270
s_sub_u32 s47, s32, s34
s_max_i32 s47, s47, 0
.p2align 3
main_kernel_c7_to1:
s_sub_u32 s47, s47, 28
s_cbranch_scc0 main_kernel_c7_to1
s_barrier
buffer_load_dwordx4 v[0:3], v116, s[4:7], s23 offen sc1
ds_read_b128 v[32:35], v113 offset:0
ds_read_b128 v[36:39], v113 offset:1024
s_add_u32 s46, s46, 0x40000
s_bitset0_b32 s46, 20
s_add_u32 s37, s37, 65536
s_add_u32 s26, s26, 65536
s_xor_b32 s32, s23, 1024
buffer_load_dwordx4 v[4:7], v116, s[4:7], s32 offen sc1
ds_read_b128 v[40:43], v113 offset:2048
ds_read_b128 v[44:47], v113 offset:3072
s_add_u32 s44, s44, s24
s_nop 2
s_xor_b32 s32, s23, 2048
buffer_load_dwordx4 v[8:11], v116, s[4:7], s32 offen sc1
ds_read_b128 v[48:51], v113 offset:4096
ds_read_b128 v[52:55], v113 offset:5120
s_nop 3
s_xor_b32 s32, s23, 3072
buffer_load_dwordx4 v[12:15], v116, s[4:7], s32 offen sc1
ds_read_b128 v[56:59], v113 offset:6144
ds_read_b128 v[60:63], v113 offset:7168
s_nop 3
s_xor_b32 s32, s23, 4096
buffer_load_dwordx4 v[16:19], v116, s[4:7], s32 offen sc1
ds_read_b128 v[64:67], v113 offset:8192
ds_read_b128 v[68:71], v113 offset:9216
s_nop 3
s_xor_b32 s32, s23, 5120
buffer_load_dwordx4 v[20:23], v116, s[4:7], s32 offen sc1
ds_read_b128 v[72:75], v113 offset:10240
ds_read_b128 v[76:79], v113 offset:11264
s_nop 3
s_xor_b32 s32, s23, 6144
buffer_load_dwordx4 v[24:27], v116, s[4:7], s32 offen sc1
ds_read_b128 v[88:91], v113 offset:12288
ds_read_b128 v[92:95], v113 offset:13312
s_nop 3
s_xor_b32 s32, s23, 7168
buffer_load_dwordx4 v[28:31], v116, s[4:7], s32 offen sc1
v_and_b32 v127, 0x1f0, v116
v_lshlrev_b32 v127, 4, v127
s_waitcnt lgkmcnt(12)
s_waitcnt vmcnt(7)
v_cmp_u_f32 vcc, v0, v2
s_cbranch_vccnz main_kernel_c7_o0_f
main_kernel_c7_o0:
v_smfmac_f32_16x16x64_bf16 v[80:83], v[0:3], v[32:39], v112
ds_read_b128 v[32:35], v113 offset:14336
ds_read_b128 v[36:39], v113 offset:15360
buffer_load_dwordx2 v[96:97], v127, s[4:7], s45 offen offset:128 sc1
s_waitcnt lgkmcnt(12)
s_waitcnt vmcnt(7)
v_cmp_u_f32 vcc, v4, v6
v_smfmac_f32_16x16x64_bf16 v[84:87], v[0:3], v[40:47], v112
ds_read_b128 v[40:43], v113 offset:16384
ds_read_b128 v[44:47], v113 offset:17408
buffer_store_dwordx2 v[114:115], v119, s[4:7], s37 offen sc1
s_cbranch_vccnz main_kernel_c7_o1_f
main_kernel_c7_o1:
s_waitcnt lgkmcnt(12)
v_smfmac_f32_16x16x64_bf16 v[80:83], v[4:7], v[48:55], v112
ds_read_b128 v[48:51], v113 offset:18432
ds_read_b128 v[52:55], v113 offset:19456
s_waitcnt lgkmcnt(12)
s_waitcnt vmcnt(7)
v_cmp_u_f32 vcc, v8, v10
v_smfmac_f32_16x16x64_bf16 v[84:87], v[4:7], v[56:63], v112
ds_read_b128 v[56:59], v113 offset:20480
ds_read_b128 v[60:63], v113 offset:21504
buffer_store_dword v124, v120, s[4:7], s26 offen sc1
s_cbranch_vccnz main_kernel_c7_o2_f
main_kernel_c7_o2:
s_waitcnt lgkmcnt(12)
v_smfmac_f32_16x16x64_bf16 v[80:83], v[8:11], v[64:71], v112
ds_read_b128 v[64:67], v113 offset:22528
ds_read_b128 v[68:71], v113 offset:23552
s_waitcnt lgkmcnt(12)
s_waitcnt vmcnt(7)
v_cmp_u_f32 vcc, v12, v14
v_smfmac_f32_16x16x64_bf16 v[84:87], v[8:11], v[72:79], v112
ds_read_b128 v[72:75], v113 offset:24576
ds_read_b128 v[76:79], v113 offset:25600
s_cbranch_vccnz main_kernel_c7_o3_f
main_kernel_c7_o3:
s_waitcnt lgkmcnt(12)
v_smfmac_f32_16x16x64_bf16 v[80:83], v[12:15], v[88:95], v112
ds_read_b128 v[88:91], v113 offset:26624
ds_read_b128 v[92:95], v113 offset:27648
s_waitcnt lgkmcnt(12)
s_waitcnt vmcnt(6)
v_cmp_u_f32 vcc, v16, v18
v_smfmac_f32_16x16x64_bf16 v[84:87], v[12:15], v[32:39], v112
ds_read_b128 v[32:35], v113 offset:28672
ds_read_b128 v[36:39], v113 offset:29696
s_cbranch_vccnz main_kernel_c7_o4_f
main_kernel_c7_o4:
s_waitcnt lgkmcnt(12)
v_smfmac_f32_16x16x64_bf16 v[80:83], v[16:19], v[40:47], v112
ds_read_b128 v[40:43], v113 offset:30720
ds_read_b128 v[44:47], v113 offset:31744
s_waitcnt lgkmcnt(12)
s_waitcnt vmcnt(5)
v_cmp_u_f32 vcc, v20, v22
v_smfmac_f32_16x16x64_bf16 v[84:87], v[16:19], v[48:55], v112
s_cbranch_vccnz main_kernel_c7_o5_f
main_kernel_c7_o5:
s_waitcnt lgkmcnt(10)
v_smfmac_f32_16x16x64_bf16 v[80:83], v[20:23], v[56:63], v112
s_waitcnt lgkmcnt(8)
s_waitcnt vmcnt(4)
v_cmp_u_f32 vcc, v24, v26
v_smfmac_f32_16x16x64_bf16 v[84:87], v[20:23], v[64:71], v112
s_cbranch_vccnz main_kernel_c7_o6_f
main_kernel_c7_o6:
s_waitcnt lgkmcnt(6)
v_smfmac_f32_16x16x64_bf16 v[80:83], v[24:27], v[72:79], v112
s_waitcnt lgkmcnt(4)
v_smfmac_f32_16x16x64_bf16 v[84:87], v[24:27], v[88:95], v112
s_waitcnt lgkmcnt(2)
s_waitcnt vmcnt(3)
v_cmp_u_f32 vcc, v28, v30
s_cbranch_vccnz main_kernel_c7_o7_f
main_kernel_c7_o7:
v_smfmac_f32_16x16x64_bf16 v[80:83], v[28:31], v[32:39], v112
s_waitcnt lgkmcnt(0)
v_smfmac_f32_16x16x64_bf16 v[84:87], v[28:31], v[40:47], v112
s_nop 4
v_cvt_pk_bf16_f32 v80, v80, v81
v_cvt_pk_bf16_f32 v81, v82, v83
ds_write_b64 v116, v[80:81] offset:21512
v_cvt_pk_bf16_f32 v82, v84, v85
v_cvt_pk_bf16_f32 v83, v86, v87
ds_write_b64 v116, v[82:83] offset:23560
s_waitcnt lgkmcnt(0)
s_barrier
ds_read_b128 v[72:75], v116 offset:22528
ds_read_b128 v[76:79], v116 offset:23552
s_waitcnt lgkmcnt(1)
v_mfma_f32_16x16x32_bf16 v[64:67], v[72:75], v[108:111], 0
s_waitcnt lgkmcnt(0)
v_mfma_f32_16x16x32_bf16 v[64:67], v[76:79], v[108:111], v[64:67]
s_nop 7
v_cvt_pk_f16_f32 v68, v64, v65
v_cvt_pk_f16_f32 v69, v66, v67
buffer_store_dwordx2 v[68:69], v125, s[4:7], s25 offen sc1
s_sub_u32 s0, s2, s16
s_sub_u32 s0, s0, s39
s_waitcnt vmcnt(3)
main_kernel_c7_tm0:
s_memtime s[40:41]
v_sub_u32 v97, v97, v96
v_subrev_u32 v97, s0, v97
s_add_u32 s34, s11, s2
s_nop 0
v_max_u32_dpp v97, v97, v97 row_ror:8 row_mask:0xf bank_mask:0xf
s_nop 1
v_max_u32_dpp v97, v97, v97 row_ror:4 row_mask:0xf bank_mask:0xf
s_nop 1
v_max_u32_dpp v97, v97, v97 row_ror:2 row_mask:0xf bank_mask:0xf
s_nop 1
v_max_u32_dpp v97, v97, v97 row_ror:1 row_mask:0xf bank_mask:0xf
s_waitcnt lgkmcnt(0)
v_readlane_b32 s32, v97, 0
v_readlane_b32 s33, v97, 16
s_sub_u32 s34, s40, s34
s_max_u32 s32, s32, s33
s_add_u32 s35, s34, 1536
s_cmp_gt_u32 s32, s35
s_cbranch_scc1 main_kernel_c7_tm2
main_kernel_c7_tm3:
s_add_u32 s32, s32, 2750
s_max_u32 s32, s32, s36
s_add_u32 s43, s32, s2
s_sub_u32 s47, s32, s34
s_max_i32 s47, s47, 0
.p2align 3
main_kernel_c7_tm1:
s_sub_u32 s47, s47, 28
s_cbranch_scc0 main_kernel_c7_tm1
s_add_u32 s45, s45, s24
s_branch main_kernel_c7_top
main_kernel_c7_to2:
s_mov_b32 s32, s34
s_mov_b32 s16, s15
s_cmp_gt_u32 s34, 0x40000
s_cbranch_scc1 main_kernel_c7_to3
s_andn2_b32 s35, s46, 0xff
v_bfe_u32 v68, v116, 1, 8
buffer_load_dwordx2 v[66:67], v68, s[4:7], s35 offen sc1
s_sub_u32 s29, s29, 1
s_cbranch_scc1 main_kernel_end
s_waitcnt vmcnt(0)
s_branch main_kernel_c7_to0
main_kernel_c7_tm2:
s_mov_b32 s32, s34
s_cmp_gt_u32 s34, 0x40000
s_cbranch_scc1 main_kernel_c7_tm3
v_and_b32 v127, 0x1f0, v116
v_lshlrev_b32 v127, 4, v127
buffer_load_dwordx2 v[96:97], v127, s[4:7], s45 offen offset:128 sc1
s_sub_u32 s29, s29, 1
s_cbranch_scc1 main_kernel_end
s_waitcnt vmcnt(0)
s_branch main_kernel_c7_tm0
main_kernel_c7_last:
s_add_u32 s37, s37, 65536
s_add_u32 s26, s26, 65536
buffer_store_dwordx2 v[114:115], v119, s[4:7], s37 offen sc1
v_smfmac_f32_16x16x64_f16 v[88:91], v[20:23], v[168:175], v112
v_smfmac_f32_16x16x64_f16 v[88:91], v[24:27], v[176:183], v112
v_smfmac_f32_16x16x64_f16 v[88:91], v[28:31], v[184:191], v112
v_smfmac_f32_16x16x64_f16 v[88:91], v[32:35], v[192:199], v112
v_smfmac_f32_16x16x64_f16 v[88:91], v[36:39], v[200:207], v112
v_smfmac_f32_16x16x64_f16 v[88:91], v[40:43], v[208:215], v112
v_smfmac_f32_16x16x64_f16 v[88:91], v[44:47], v[216:223], v112
v_smfmac_f32_16x16x64_f16 v[88:91], v[48:51], v[224:231], v112
v_smfmac_f32_16x16x64_f16 v[88:91], v[52:55], v[232:239], v112
v_smfmac_f32_16x16x64_f16 v[88:91], v[56:59], v[240:247], v112
v_smfmac_f32_16x16x64_f16 v[88:91], v[60:63], v[248:255], v112
s_nop 7
v_permlane32_swap_b32 v88, v90
s_nop 1
v_permlane32_swap_b32 v89, v91
s_nop 1
v_pk_add_f32 v[88:89], v[88:89], v[90:91]
s_nop 1
v_cvt_pk_bf16_f32 v124, v88, v89
s_nop 1
buffer_store_dword v124, v120, s[4:7], s26 offen sc1
s_branch main_kernel_end
main_kernel_c7_m0_f:
s_waitcnt lgkmcnt(0)
buffer_load_dwordx4 v[0:3], v116, s[4:7], s18 offen sc1
buffer_load_dwordx4 v[64:67], v116, s[4:7], s19 offen sc1
s_xor_b32 s32, s18, 1024
buffer_load_dwordx4 v[16:19], v116, s[4:7], s32 offen sc1
s_xor_b32 s32, s19, 1024
buffer_load_dwordx4 v[68:71], v116, s[4:7], s32 offen sc1
s_xor_b32 s32, s18, 2048
buffer_load_dwordx4 v[32:35], v116, s[4:7], s32 offen sc1
s_xor_b32 s32, s19, 2048
buffer_load_dwordx4 v[72:75], v116, s[4:7], s32 offen sc1
s_xor_b32 s32, s18, 3072
buffer_load_dwordx4 v[48:51], v116, s[4:7], s32 offen sc1
s_xor_b32 s32, s19, 3072
buffer_load_dwordx4 v[76:79], v116, s[4:7], s32 offen sc1
s_sub_u32 s29, s29, 1
s_cbranch_scc1 main_kernel_end
s_waitcnt vmcnt(0)
v_max_u32 v126, v0, v2
v_max3_u32 v126, v126, v64, v66
v_cmp_eq_u32 vcc, -1, v126
s_cbranch_vccnz main_kernel_c7_m0_f
v_pk_add_f16 v0, v0, v64
v_pk_add_f16 v1, v1, v65
v_pk_add_f16 v2, v2, v66
v_pk_add_f16 v3, v3, v67
s_nop 0
s_branch main_kernel_c7_m0
main_kernel_c7_m1_f:
s_waitcnt lgkmcnt(0)
s_xor_b32 s32, s18, 1024
buffer_load_dwordx4 v[16:19], v116, s[4:7], s32 offen sc1
s_xor_b32 s32, s19, 1024
buffer_load_dwordx4 v[68:71], v116, s[4:7], s32 offen sc1
s_xor_b32 s32, s18, 2048
buffer_load_dwordx4 v[32:35], v116, s[4:7], s32 offen sc1
s_xor_b32 s32, s19, 2048
buffer_load_dwordx4 v[72:75], v116, s[4:7], s32 offen sc1
s_xor_b32 s32, s18, 3072
buffer_load_dwordx4 v[48:51], v116, s[4:7], s32 offen sc1
s_xor_b32 s32, s19, 3072
buffer_load_dwordx4 v[76:79], v116, s[4:7], s32 offen sc1
s_sub_u32 s29, s29, 1
s_cbranch_scc1 main_kernel_end
s_waitcnt vmcnt(0)
v_max_u32 v126, v16, v18
v_max3_u32 v126, v126, v68, v70
v_cmp_eq_u32 vcc, -1, v126
s_cbranch_vccnz main_kernel_c7_m1_f
v_pk_add_f16 v16, v16, v68
v_pk_add_f16 v17, v17, v69
v_pk_add_f16 v18, v18, v70
v_pk_add_f16 v19, v19, v71
s_nop 0
s_branch main_kernel_c7_m1
main_kernel_c7_m2_f:
s_waitcnt lgkmcnt(0)
s_xor_b32 s32, s18, 2048
buffer_load_dwordx4 v[32:35], v116, s[4:7], s32 offen sc1
s_xor_b32 s32, s19, 2048
buffer_load_dwordx4 v[72:75], v116, s[4:7], s32 offen sc1
s_xor_b32 s32, s18, 3072
buffer_load_dwordx4 v[48:51], v116, s[4:7], s32 offen sc1
s_xor_b32 s32, s19, 3072
buffer_load_dwordx4 v[76:79], v116, s[4:7], s32 offen sc1
s_sub_u32 s29, s29, 1
s_cbranch_scc1 main_kernel_end
s_waitcnt vmcnt(0)
v_max_u32 v126, v32, v34
v_max3_u32 v126, v126, v72, v74
v_cmp_eq_u32 vcc, -1, v126
s_cbranch_vccnz main_kernel_c7_m2_f
v_pk_add_f16 v32, v32, v72
v_pk_add_f16 v33, v33, v73
v_pk_add_f16 v34, v34, v74
v_pk_add_f16 v35, v35, v75
ds_write_b128 v116, v[32:35] offset:11264
s_branch main_kernel_c7_m2
main_kernel_c7_m3_f:
s_waitcnt lgkmcnt(0)
s_xor_b32 s32, s18, 3072
buffer_load_dwordx4 v[48:51], v116, s[4:7], s32 offen sc1
s_xor_b32 s32, s19, 3072
buffer_load_dwordx4 v[76:79], v116, s[4:7], s32 offen sc1
s_sub_u32 s29, s29, 1
s_cbranch_scc1 main_kernel_end
s_waitcnt vmcnt(0)
v_max_u32 v126, v48, v50
v_max3_u32 v126, v126, v76, v78
v_cmp_eq_u32 vcc, -1, v126
s_cbranch_vccnz main_kernel_c7_m3_f
v_pk_add_f16 v48, v48, v76
v_pk_add_f16 v49, v49, v77
v_pk_add_f16 v50, v50, v78
v_pk_add_f16 v51, v51, v79
ds_write_b128 v116, v[48:51] offset:15360
s_branch main_kernel_c7_m3
main_kernel_c7_z_f:
buffer_load_dwordx4 v[8:11], v116, s[4:7], s20 offen offset:0 sc1
buffer_load_dwordx4 v[12:15], v116, s[4:7], s20 offen offset:1024 sc1
s_memtime s[32:33]
ds_read_b32 v126, v116 offset:18432
s_sub_u32 s34, s19, s54
s_xor_b32 s34, s34, 0x2000
s_lshl_b32 s35, s12, 15
s_add_u32 s34, s34, s35
s_lshl_b32 s35, s13, 8
s_add_u32 s35, s35, s34
s_add_u32 s34, s34, 0x4000
s_waitcnt lgkmcnt(0)
s_sub_u32 s32, s32, 450
v_sub_u32 v126, s32, v126
v_max_u32 v127, v126, v127
buffer_store_dword v127, off, s[4:7], s34 sc1
s_sub_u32 s29, s29, 1
s_cbranch_scc1 main_kernel_end
s_waitcnt vmcnt(1)
main_kernel_c7_z_g:
v_max_u32 v126, v8, v10
v_max3_u32 v126, v126, v12, v14
v_cmp_eq_u32 vcc, -1, v126
s_cbranch_vccnz main_kernel_c7_z_h
v_mfma_f32_16x16x32_bf16 v[88:91], v[8:11], v[8:11], v[92:95]
v_mfma_f32_16x16x32_bf16 v[0:3], v[16:19], v[8:11], v[80:83]
v_mfma_f32_16x16x32_bf16 v[4:7], v[20:23], v[8:11], v[84:87]
v_mfma_f32_16x16x32_bf16 v[88:91], v[12:15], v[12:15], v[88:91]
v_mfma_f32_16x16x32_bf16 v[0:3], v[24:27], v[12:15], v[0:3]
v_mfma_f32_16x16x32_bf16 v[4:7], v[28:31], v[12:15], v[4:7]
buffer_store_dword v127, off, s[4:7], s35 offset:132 sc1
s_mov_b32 vcc_lo, 0xcccccccc
s_mov_b32 vcc_hi, 0xcccccccc
s_branch main_kernel_c7_z
main_kernel_c7_z_h:
buffer_load_dwordx4 v[8:11], v116, s[4:7], s20 offen offset:0 sc1
buffer_load_dwordx4 v[12:15], v116, s[4:7], s20 offen offset:1024 sc1
s_sub_u32 s29, s29, 1
s_cbranch_scc1 main_kernel_end
v_add_u32 v127, 300, v127
s_waitcnt vmcnt(0)
s_branch main_kernel_c7_z_g
main_kernel_c7_sm_f:
s_waitcnt vmcnt(0) lgkmcnt(0)
buffer_load_dwordx4 v[8:11], v116, s[4:7], s20 offen offset:0 sc1
buffer_load_dwordx4 v[12:15], v116, s[4:7], s20 offen offset:1024 sc1
ds_read_b128 v[0:3], v116 offset:16384
ds_read_b128 v[4:7], v116 offset:17408
ds_read_b128 v[64:67], v116 offset:24576
ds_read_b128 v[68:71], v116 offset:28672
ds_read_b128 v[72:75], v116 offset:25600
ds_read_b128 v[76:79], v116 offset:29696
ds_read_b128 v[16:19], v116 offset:26624
ds_read_b128 v[20:23], v116 offset:30720
ds_read_b128 v[24:27], v116 offset:27648
ds_read_b128 v[28:31], v116 offset:31744
s_waitcnt vmcnt(0)
s_waitcnt lgkmcnt(0)
v_mfma_f32_16x16x32_bf16 v[80:83], v[64:67], v[0:3], 0
v_mfma_f32_16x16x32_bf16 v[84:87], v[68:71], v[0:3], 0
v_mfma_f32_16x16x32_bf16 v[92:95], v[0:3], v[0:3], 0
v_mfma_f32_16x16x32_bf16 v[80:83], v[72:75], v[4:7], v[80:83]
v_mfma_f32_16x16x32_bf16 v[84:87], v[76:79], v[4:7], v[84:87]
v_mfma_f32_16x16x32_bf16 v[92:95], v[4:7], v[4:7], v[92:95]
v_mfma_f32_16x16x32_bf16 v[0:3], v[16:19], v[8:11], v[80:83]
v_mfma_f32_16x16x32_bf16 v[4:7], v[20:23], v[8:11], v[84:87]
v_mfma_f32_16x16x32_bf16 v[88:91], v[8:11], v[8:11], v[92:95]
v_mfma_f32_16x16x32_bf16 v[0:3], v[24:27], v[12:15], v[0:3]
v_mfma_f32_16x16x32_bf16 v[4:7], v[28:31], v[12:15], v[4:7]
v_mfma_f32_16x16x32_bf16 v[88:91], v[12:15], v[12:15], v[88:91]
s_nop 7
v_mov_b32 v65, 0
v_max_f32 v126, v88, v89
v_mul_f32 v126, s30, v126
v_max3_f32 v126, v126, v0, v1
v_max3_f32 v126, v126, v2, v3
v_max3_f32 v126, v126, v4, v5
v_max3_f32 v126, v126, v6, v7
v_mov_b32 v127, v126
s_nop 1
v_permlane32_swap_b32 v126, v127
v_max_f32 v126, v126, v127
v_mov_b32 v127, v126
s_nop 1
v_permlane16_swap_b32 v126, v127
v_max_f32 v126, v126, v127
v_mul_f32 v127, 0x40faf233, v126
s_mov_b32 vcc_lo, 0xcccccccc
s_mov_b32 vcc_hi, 0xcccccccc
v_sub_f32 v0, v0, v126
v_sub_f32 v1, v1, v126
v_sub_f32 v2, v2, v126
v_sub_f32 v3, v3, v126
v_sub_f32 v4, v4, v126
v_sub_f32 v5, v5, v126
v_sub_f32 v6, v6, v126
v_sub_f32 v7, v7, v126
v_sub_f32 v88, v88, v127
v_sub_f32 v89, v89, v127
s_waitcnt lgkmcnt(0)
s_nop 0
v_mul_f32 v88, s30, v88
v_mul_f32 v89, s30, v89
v_exp_f32 v88, v88
v_exp_f32 v89, v89
v_cndmask_b32_dpp v0, v2, v0, vcc quad_perm:[2,3,2,3] row_mask:0xf bank_mask:0xf
v_cvt_pk_bf16_f32 v64, v88, v89
v_cndmask_b32_dpp v1, v3, v1, vcc quad_perm:[2,3,2,3] row_mask:0xf bank_mask:0xf
v_exp_f32 v0, v0
v_mfma_f32_16x16x16_bf16 v[16:19], v[100:101], v[64:65], 0
v_exp_f32 v1, v1
v_cndmask_b32_dpp v4, v6, v4, vcc quad_perm:[2,3,2,3] row_mask:0xf bank_mask:0xf
v_mfma_f32_16x16x16_bf16 v[8:11], v[124:125], v[64:65], 0
v_cndmask_b32_dpp v5, v7, v5, vcc quad_perm:[2,3,2,3] row_mask:0xf bank_mask:0xf
v_exp_f32 v4, v4
v_exp_f32 v5, v5
v_cvt_pk_bf16_f32 v92, v0, v1
v_cvt_pk_bf16_f32 v94, v4, v5
v_mov_b32 v80, 0
v_mov_b32_dpp v93, v92 quad_perm:[0,1,0,1] row_mask:0xf bank_mask:0xf
v_mov_b32_dpp v95, v94 quad_perm:[0,1,0,1] row_mask:0xf bank_mask:0xf
v_mov_b32 v81, 0
v_mov_b32 v82, 0
v_mfma_f32_16x16x32_bf16 v[16:19], v[100:103], v[92:95], v[16:19]
v_mov_b32 v83, 0
v_mov_b32 v84, 0
v_mfma_f32_16x16x32_bf16 v[8:11], v[96:99], v[92:95], v[8:11]
s_nop 1
v_mov_b32 v85, 0
v_mov_b32 v86, 0
v_mov_b32 v87, 0
v_rcp_f32 v126, v16
v_subrev_u32 v127, 0x21800000, v16
v_cmp_lt_u32 vcc, 0x3c000000, v127
v_pk_mul_f32 v[8:9], v[8:9], v[126:127] op_sel_hi:[1,0]
v_pk_mul_f32 v[10:11], v[10:11], v[126:127] op_sel_hi:[1,0]
s_and_b32 s32, vcc_lo, 0xcccc
v_cvt_pk_bf16_f32 v126, v8, v9
v_cvt_pk_bf16_f32 v127, v10, v11
s_andn2_b32 s35, s46, 0xff
v_bfe_u32 v68, v116, 1, 8
buffer_load_dwordx2 v[66:67], v68, s[4:7], s35 offen sc1
s_waitcnt vmcnt(0)
s_branch main_kernel_c7_ost
main_kernel_c7_o0_f:
s_nop 0
buffer_load_dwordx4 v[0:3], v116, s[4:7], s23 offen sc1
s_xor_b32 s32, s23, 1024
buffer_load_dwordx4 v[4:7], v116, s[4:7], s32 offen sc1
s_sub_u32 s29, s29, 1
s_cbranch_scc1 main_kernel_end
s_waitcnt vmcnt(0)
v_max_u32 v126, v0, v2
v_cmp_eq_u32 vcc, -1, v126
s_cbranch_vccnz main_kernel_c7_o0_f
s_branch main_kernel_c7_o0
main_kernel_c7_o1_f:
s_nop 0
s_xor_b32 s32, s23, 1024
buffer_load_dwordx4 v[4:7], v116, s[4:7], s32 offen sc1
s_xor_b32 s32, s23, 2048
buffer_load_dwordx4 v[8:11], v116, s[4:7], s32 offen sc1
s_sub_u32 s29, s29, 1
s_cbranch_scc1 main_kernel_end
s_waitcnt vmcnt(0)
v_max_u32 v126, v4, v6
v_cmp_eq_u32 vcc, -1, v126
s_cbranch_vccnz main_kernel_c7_o1_f
s_branch main_kernel_c7_o1
main_kernel_c7_o2_f:
s_nop 0
s_xor_b32 s32, s23, 2048
buffer_load_dwordx4 v[8:11], v116, s[4:7], s32 offen sc1
s_xor_b32 s32, s23, 3072
buffer_load_dwordx4 v[12:15], v116, s[4:7], s32 offen sc1
s_sub_u32 s29, s29, 1
s_cbranch_scc1 main_kernel_end
s_waitcnt vmcnt(0)
v_max_u32 v126, v8, v10
v_cmp_eq_u32 vcc, -1, v126
s_cbranch_vccnz main_kernel_c7_o2_f
s_branch main_kernel_c7_o2
main_kernel_c7_o3_f:
s_nop 0
s_xor_b32 s32, s23, 3072
buffer_load_dwordx4 v[12:15], v116, s[4:7], s32 offen sc1
s_xor_b32 s32, s23, 4096
buffer_load_dwordx4 v[16:19], v116, s[4:7], s32 offen sc1
s_sub_u32 s29, s29, 1
s_cbranch_scc1 main_kernel_end
s_waitcnt vmcnt(0)
v_max_u32 v126, v12, v14
v_cmp_eq_u32 vcc, -1, v126
s_cbranch_vccnz main_kernel_c7_o3_f
s_branch main_kernel_c7_o3
main_kernel_c7_o4_f:
s_nop 0
s_xor_b32 s32, s23, 4096
buffer_load_dwordx4 v[16:19], v116, s[4:7], s32 offen sc1
s_xor_b32 s32, s23, 5120
buffer_load_dwordx4 v[20:23], v116, s[4:7], s32 offen sc1
s_sub_u32 s29, s29, 1
s_cbranch_scc1 main_kernel_end
s_waitcnt vmcnt(0)
v_max_u32 v126, v16, v18
v_cmp_eq_u32 vcc, -1, v126
s_cbranch_vccnz main_kernel_c7_o4_f
s_branch main_kernel_c7_o4
main_kernel_c7_o5_f:
s_nop 0
s_xor_b32 s32, s23, 5120
buffer_load_dwordx4 v[20:23], v116, s[4:7], s32 offen sc1
s_xor_b32 s32, s23, 6144
buffer_load_dwordx4 v[24:27], v116, s[4:7], s32 offen sc1
s_sub_u32 s29, s29, 1
s_cbranch_scc1 main_kernel_end
s_waitcnt vmcnt(0)
v_max_u32 v126, v20, v22
v_cmp_eq_u32 vcc, -1, v126
s_cbranch_vccnz main_kernel_c7_o5_f
s_branch main_kernel_c7_o5
main_kernel_c7_o6_f:
s_nop 0
s_xor_b32 s32, s23, 6144
buffer_load_dwordx4 v[24:27], v116, s[4:7], s32 offen sc1
s_xor_b32 s32, s23, 7168
buffer_load_dwordx4 v[28:31], v116, s[4:7], s32 offen sc1
s_sub_u32 s29, s29, 1
s_cbranch_scc1 main_kernel_end
s_waitcnt vmcnt(0)
v_max_u32 v126, v24, v26
v_cmp_eq_u32 vcc, -1, v126
s_cbranch_vccnz main_kernel_c7_o6_f
s_branch main_kernel_c7_o6
main_kernel_c7_o7_f:
s_nop 0
s_xor_b32 s32, s23, 7168
buffer_load_dwordx4 v[28:31], v116, s[4:7], s32 offen sc1
s_sub_u32 s29, s29, 1
s_cbranch_scc1 main_kernel_end
s_waitcnt vmcnt(0)
v_max_u32 v126, v28, v30
v_cmp_eq_u32 vcc, -1, v126
s_cbranch_vccnz main_kernel_c7_o7_f
s_branch main_kernel_c7_o7
main_kernel_att:
s_cmp_gt_u32 s13, 1
s_cbranch_scc1 main_kernel_p_end
s_cmp_lg_u32 s14, 0
s_cbranch_scc1 main_kernel_p_bar
s_lshl_b32 s32, s13, 21
s_add_u32 s32, s32, 0x8c00000
v_lshlrev_b32 v2, 2, v250
v_mov_b32 v3, -1
s_mov_b64 s[20:21], -1
s_mov_b32 s34, 12
s_mov_b32 exec_hi, 0
s_waitcnt vmcnt(0)
main_kernel_p_lp:
s_memtime s[16:17]
s_waitcnt lgkmcnt(0)
buffer_store_dword v3, v2, s[4:7], s32 offen sc1
s_waitcnt vmcnt(0)
s_memtime s[18:19]
s_xor_b32 s32, s32, 0x2000
s_waitcnt lgkmcnt(0)
s_sub_u32 s33, s18, s16
s_min_u32 s20, s20, s33
s_memtime s[16:17]
s_waitcnt lgkmcnt(0)
buffer_store_dword v3, v2, s[4:7], s32 offen sc1
s_waitcnt vmcnt(0)
s_memtime s[18:19]
s_xor_b32 s32, s32, 0x2000
s_waitcnt lgkmcnt(0)
s_sub_u32 s33, s18, s16
s_min_u32 s21, s21, s33
s_add_u32 s32, s32, 128
s_sub_u32 s34, s34, 1
s_cmp_lg_u32 s34, 0
s_cbranch_scc1 main_kernel_p_lp
s_cmp_lt_u32 s21, s20
s_cselect_b32 s32, 3, 2
s_lshl_b32 s33, s13, 2
v_mov_b32 v3, s32
s_mov_b64 exec, 1
buffer_store_dword v3, off, s[60:63], s33 offset:16 sc1
s_mov_b64 exec, -1
main_kernel_p_bar:
s_barrier
main_kernel_p_end:
s_mov_b32 s8, s64
s_and_b32 s9, s65, 0xffff
s_mov_b32 s10, 0x200000
s_mov_b32 s11, 0x20000
s_mul_i32 s35, s13, 131072
buffer_load_dword v14, v12, s[8:11], s35 offen
s_add_u32 s35, s35, 32768
buffer_load_dword v14, v12, s[8:11], s35 offen
s_add_u32 s35, s35, 32768
buffer_load_dword v14, v12, s[8:11], s35 offen
s_add_u32 s35, s35, 32768
buffer_load_dword v14, v12, s[8:11], s35 offen
s_add_u32 s35, s35, 32768
s_mov_b32 s8, s66
s_and_b32 s9, s67, 0xffff
s_mov_b32 s10, 0x200000
s_mov_b32 s11, 0x20000
s_mul_i32 s35, s13, 131072
buffer_load_dword v14, v12, s[8:11], s35 offen
s_add_u32 s35, s35, 32768
buffer_load_dword v14, v12, s[8:11], s35 offen
s_add_u32 s35, s35, 32768
buffer_load_dword v14, v12, s[8:11], s35 offen
s_add_u32 s35, s35, 32768
buffer_load_dword v14, v12, s[8:11], s35 offen
s_add_u32 s35, s35, 32768
v_lshlrev_b32 v0, 2, v250
s_mov_b32 s32, 0x841f000
main_kernel_awf:
buffer_load_dword v2, v0, s[4:7], s32 offen sc1
s_waitcnt vmcnt(0)
v_cmp_eq_u32 vcc, 0, v2
s_cbranch_vccz main_kernel_awf_ok
s_sleep 4
s_sub_u32 s29, s29, 1
s_cbranch_scc0 main_kernel_awf
s_branch main_kernel_end
main_kernel_awf_ok:
main_kernel_att2:
s_lshl_b32 s28, s13, 1
s_lshr_b32 s31, s14, 1
s_add_u32 s28, s28, s31
s_and_b32 s30, s14, 1
v_lshlrev_b32 v204, 4, v250
v_and_b32 v200, 15, v250
v_lshrrev_b32 v201, 4, v250
v_and_b32 v202, 7, v250
v_lshl_add_u32 v202, v201, 3, v202
v_lshlrev_b32 v205, 4, v202
v_bfe_u32 v206, v204, 1, 8
v_min_u32 v207, 2, v250
v_lshlrev_b32 v207, 13, v207
s_lshl_b32 s31, s28, 2
s_sub_u32 s31, 82416, s31
s_cmp_eq_u32 s12, 7
s_cselect_b32 s25, 61, 0
s_cselect_b32 s32, 512, 0
s_sub_u32 s31, s31, s32
s_mov_b64 exec, 0xf0
v_lshl_add_u32 v207, v250, 2, s31
s_mov_b64 exec, -1
v_mov_b32 v208, 1
v_mov_b32 v209, 0
s_lshl_b32 s31, s30, 4
v_add_u32 v200, s31, v200
v_lshlrev_b32 v202, 2, v201
v_sub_u32 v200, v200, v202
v_mov_b32 v202, 0xf149f2ca
v_cmp_le_i32 vcc, 0, v200
s_nop 1
v_cndmask_b32 v124, v202, 0, vcc
v_cmp_le_i32 vcc, 1, v200
s_nop 1
v_cndmask_b32 v125, v202, 0, vcc
v_cmp_le_i32 vcc, 2, v200
s_nop 1
v_cndmask_b32 v126, v202, 0, vcc
v_cmp_le_i32 vcc, 3, v200
s_nop 1
v_cndmask_b32 v127, v202, 0, vcc
v_cmp_le_i32 vcc, 16, v200
s_nop 1
v_cndmask_b32 v128, v202, 0, vcc
v_cmp_le_i32 vcc, 17, v200
s_nop 1
v_cndmask_b32 v129, v202, 0, vcc
v_cmp_le_i32 vcc, 18, v200
s_nop 1
v_cndmask_b32 v130, v202, 0, vcc
v_cmp_le_i32 vcc, 19, v200
s_nop 1
v_cndmask_b32 v131, v202, 0, vcc
v_cmp_le_u32 vcc, 2, v201
s_nop 1
v_cndmask_b32 v132, v202, 0, vcc
v_mov_b32 v180, 0x3f803f80
v_cndmask_b32 v133, v202, 0, vcc
v_mov_b32 v181, 0x3f803f80
v_cndmask_b32 v134, v202, 0, vcc
v_mov_b32 v182, 0x3f803f80
v_cndmask_b32 v135, v202, 0, vcc
v_mov_b32 v183, 0x3f803f80
s_mov_b32 s26, 0x3e0293ee
s_mov_b32 s27, 0xbe0293ee
s_lshl_b32 s31, s28, 12
s_add_u32 s16, s31, 0x1800000
s_add_u32 s17, s16, 131072
s_cmp_eq_u32 s30, 0
s_cselect_b32 s17, 0x7f000000, s17
s_lshl_b32 s32, s30, 17
s_add_u32 s31, s31, s32
s_add_u32 s15, s31, 0x800000
s_add_u32 s22, s31, 0x3800000
s_lshl_b32 s31, s28, 13
s_add_u32 s18, s31, 0x2800000
s_add_u32 s19, s18, 4096
s_lshl_b32 s31, s28, 11
s_add_u32 s20, s31, 0x8000000
s_add_u32 s21, s31, 0x6e00000
s_lshl_b32 s31, s28, 2
s_add_u32 s23, s31, 0x8404000
s_lshl_b32 s31, s28, 3
s_lshl_b32 s32, s30, 2
s_add_u32 s31, s31, s32
s_add_u32 s24, s31, 0x8400000
s_lshl_b32 s31, s30, 7
v_and_b32 v210, 7, v250
v_lshl_add_u32 v210, v210, 8, s31
s_mov_b64 exec, 0xff00
v_add_u32 v210, 0x10000, v210
s_mov_b64 exec, 0x10000
v_add_u32 v210, 0x40000, v210
s_mov_b64 exec, -1
s_mov_b32 s33, 0x841ec00
s_lshl_b32 s31, s25, 18
s_add_u32 s15, s15, s31
s_add_u32 s16, s16, s31
s_add_u32 s17, s17, s31
s_add_u32 s18, s18, s31
s_add_u32 s19, s19, s31
s_add_u32 s22, s22, s31
s_lshl_b32 s31, s25, 16
s_add_u32 s20, s20, s31
s_add_u32 s21, s21, s31
s_lshl_b32 s31, s25, 8
s_add_u32 s24, s24, s31
s_lshl_b32 s31, s25, 2
s_add_u32 s33, s33, s31
s_lshl_b32 s31, s25, 7
s_add_u32 s23, s23, s31
s_cmp_eq_u32 s25, 0
s_cbranch_scc1 main_kernel_a_fp
s_sub_u32 s32, s24, 1280
main_kernel_a_gp:
buffer_load_dword v200, v209, s[4:7], s32 offen sc1
s_waitcnt vmcnt(0)
v_cmp_eq_u32 vcc, 0, v200
s_and_b32 s31, vcc_lo, 1
s_cbranch_scc0 main_kernel_a_fp
s_sleep 32
s_sub_u32 s29, s29, 1
s_cbranch_scc0 main_kernel_a_gp
s_branch main_kernel_end
main_kernel_a_fp:
buffer_load_dword v200, v207, s[4:7], s23 offen sc1
s_waitcnt vmcnt(0)
v_cmp_eq_u32 vcc, 0, v200
s_and_b32 s31, vcc_lo, -1
s_cbranch_scc0 main_kernel_a_fok
s_sleep 8
s_sub_u32 s29, s29, 1
s_cbranch_scc0 main_kernel_a_fp
s_branch main_kernel_end
main_kernel_a_fok:
buffer_load_dwordx4 v[0:3], v204, s[4:7], s15 offen offset:0 sc1
buffer_load_dwordx4 v[16:19], v204, s[4:7], s16 offen offset:0 sc1
buffer_load_dwordx4 v[32:35], v204, s[4:7], s17 offen offset:0 sc1
buffer_load_dwordx4 v[4:7], v204, s[4:7], s15 offen offset:1024 sc1
buffer_load_dwordx4 v[20:23], v204, s[4:7], s16 offen offset:1024 sc1
buffer_load_dwordx4 v[36:39], v204, s[4:7], s17 offen offset:1024 sc1
buffer_load_dwordx4 v[8:11], v204, s[4:7], s15 offen offset:2048 sc1
buffer_load_dwordx4 v[24:27], v204, s[4:7], s16 offen offset:2048 sc1
buffer_load_dwordx4 v[40:43], v204, s[4:7], s17 offen offset:2048 sc1
buffer_load_dwordx4 v[12:15], v204, s[4:7], s15 offen offset:3072 sc1
buffer_load_dwordx4 v[28:31], v204, s[4:7], s16 offen offset:3072 sc1
buffer_load_dwordx4 v[44:47], v204, s[4:7], s17 offen offset:3072 sc1
v_mov_b32 v211, 0
s_mov_b64 exec, 65535
buffer_atomic_add v211, v210, s[4:7], s21 offen sc0 sc1
s_mov_b64 exec, -1
buffer_load_dwordx4 v[48:51], v204, s[4:7], s18 offen offset:0 sc1
buffer_load_dwordx4 v[52:55], v204, s[4:7], s18 offen offset:1024 sc1
buffer_load_dwordx4 v[56:59], v204, s[4:7], s18 offen offset:2048 sc1
buffer_load_dwordx4 v[60:63], v204, s[4:7], s18 offen offset:3072 sc1
buffer_load_dwordx4 v[64:67], v204, s[4:7], s19 offen offset:0 sc1
buffer_load_dwordx4 v[68:71], v204, s[4:7], s19 offen offset:1024 sc1
buffer_load_dwordx4 v[72:75], v204, s[4:7], s19 offen offset:2048 sc1
buffer_load_dwordx4 v[76:79], v204, s[4:7], s19 offen offset:3072 sc1
s_waitcnt vmcnt(0)
main_kernel_a_top:
s_cmp_ge_u32 s25, 60
s_cselect_b32 s38, 2, 1
s_lshl_b32 s34, s38, 18
s_lshl_b32 s35, s38, 16
s_lshl_b32 s36, s38, 8
s_lshl_b32 s37, s38, 2
s_lshl_b32 s39, s38, 7
s_waitcnt vmcnt(19)
v_mfma_f32_16x16x32_bf16 v[112:115], v[16:19], v[0:3], v[124:127]
v_mfma_f32_16x16x32_bf16 v[116:119], v[32:35], v[0:3], v[128:131]
s_waitcnt vmcnt(16)
v_mfma_f32_16x16x32_bf16 v[112:115], v[20:23], v[4:7], v[112:115]
v_mfma_f32_16x16x32_bf16 v[116:119], v[36:39], v[4:7], v[116:119]
s_waitcnt vmcnt(13)
v_mfma_f32_16x16x32_bf16 v[112:115], v[24:27], v[8:11], v[112:115]
v_mfma_f32_16x16x32_bf16 v[116:119], v[40:43], v[8:11], v[116:119]
s_waitcnt vmcnt(10)
v_mfma_f32_16x16x32_bf16 v[112:115], v[28:31], v[12:15], v[112:115]
v_mfma_f32_16x16x32_bf16 v[116:119], v[44:47], v[12:15], v[116:119]
s_add_u32 s15, s15, s34
s_add_u32 s16, s16, s34
s_add_u32 s17, s17, s34
s_add_u32 s18, s18, s34
s_add_u32 s19, s19, s34
s_add_u32 s23, s23, s39
s_waitcnt vmcnt(9)
v_cmp_eq_u32 vcc, -1, v211
s_nop 0
v_max3_f32 v202, v112, v113, v114
s_nop 1
v_max3_f32 v202, v202, v115, v116
v_max3_f32 v202, v202, v117, v118
v_max_f32 v202, v202, v119
s_lshr_b32 s44, vcc_lo, 8
s_and_b32 s31, vcc_lo, 0xff
s_cbranch_scc0 main_kernel_a_mp
s_cmp_eq_u32 s25, 99
s_cbranch_scc1 main_kernel_a_mp
main_kernel_a_pp:
v_mov_b32 v211, 0
s_mov_b64 exec, 255
buffer_atomic_add v211, v210, s[4:7], s21 offen sc0 sc1
s_mov_b64 exec, -1
s_sub_u32 s29, s29, 1
s_cbranch_scc1 main_kernel_end
s_waitcnt vmcnt(0)
v_cmp_eq_u32 vcc, -1, v211
s_cbranch_vccnz main_kernel_a_pp
main_kernel_a_mp:
buffer_load_dwordx4 v[80:83], v205, s[4:7], s20 offen offset:0 sc1
buffer_load_dwordx4 v[84:87], v205, s[4:7], s20 offen offset:512 sc1
buffer_load_dwordx4 v[88:91], v205, s[4:7], s20 offen offset:1024 sc1
buffer_load_dwordx4 v[92:95], v205, s[4:7], s20 offen offset:1536 sc1
buffer_load_dwordx2 v[96:97], v206, s[4:7], s21 offen offset:0 sc1
buffer_load_dwordx2 v[98:99], v206, s[4:7], s21 offen offset:256 sc1
buffer_load_dwordx2 v[100:101], v206, s[4:7], s21 offen offset:512 sc1
buffer_load_dwordx2 v[102:103], v206, s[4:7], s21 offen offset:768 sc1
buffer_load_dwordx2 v[104:105], v206, s[4:7], s21 offen offset:1024 sc1
buffer_load_dwordx2 v[106:107], v206, s[4:7], s21 offen offset:1280 sc1
buffer_load_dwordx2 v[108:109], v206, s[4:7], s21 offen offset:1536 sc1
buffer_load_dwordx2 v[110:111], v206, s[4:7], s21 offen offset:1792 sc1
buffer_load_dword v211, v207, s[4:7], s23 offen sc1
s_waitcnt vmcnt(12)
v_mfma_f32_16x16x32_bf16 v[120:123], v[80:83], v[0:3], v[132:135]
v_max3_u32 v200, v80, v81, v82
v_max_u32 v200, v200, v83
s_waitcnt vmcnt(11)
v_mfma_f32_16x16x32_bf16 v[120:123], v[84:87], v[4:7], v[120:123]
v_max3_u32 v200, v200, v84, v85
v_max3_u32 v200, v200, v86, v87
s_waitcnt vmcnt(10)
v_mfma_f32_16x16x32_bf16 v[120:123], v[88:91], v[8:11], v[120:123]
v_max3_u32 v200, v200, v88, v89
v_max3_u32 v200, v200, v90, v91
s_waitcnt vmcnt(9)
v_mfma_f32_16x16x32_bf16 v[120:123], v[92:95], v[12:15], v[120:123]
v_max3_u32 v200, v200, v92, v93
v_max3_u32 v200, v200, v94, v95
s_waitcnt vmcnt(7)
v_max3_u32 v200, v200, v96, v97
v_max3_u32 v200, v200, v98, v99
s_waitcnt vmcnt(5)
v_max3_u32 v200, v200, v100, v101
v_max3_u32 v200, v200, v102, v103
s_waitcnt vmcnt(3)
v_max3_u32 v200, v200, v104, v105
v_max3_u32 v200, v200, v106, v107
s_waitcnt vmcnt(1)
v_max3_u32 v200, v200, v108, v109
v_max3_u32 v200, v200, v110, v111
v_cmp_eq_u32 vcc, -1, v200
s_cbranch_vccz main_kernel_a_mok
s_sleep 1
s_sub_u32 s29, s29, 1
s_cbranch_scc0 main_kernel_a_mp
s_branch main_kernel_end
main_kernel_a_mok:
s_cmp_eq_u32 s44, 0
s_cbranch_scc1 main_kernel_a_se
main_kernel_a_sn:
v_mul_f32 v120, s26, v120
v_mul_f32 v121, s26, v121
v_mul_f32 v122, s26, v122
v_mul_f32 v123, s26, v123
v_max3_f32 v200, v202, v120, v121
v_max3_f32 v200, v200, v122, v123
v_mov_b32 v201, v200
s_add_u32 s20, s20, s35
s_add_u32 s21, s21, s35
v_permlane32_swap_b32 v200, v201
v_max_f32 v200, v200, v201
v_mov_b32 v201, v200
s_nop 1
v_permlane16_swap_b32 v200, v201
v_max_f32 v200, v200, v201
v_sub_f32 v112, v112, v200
v_sub_f32 v113, v113, v200
v_sub_f32 v114, v114, v200
v_sub_f32 v115, v115, v200
v_sub_f32 v116, v116, v200
v_sub_f32 v117, v117, v200
v_sub_f32 v118, v118, v200
v_sub_f32 v119, v119, v200
v_sub_f32 v120, v120, v200
v_sub_f32 v121, v121, v200
v_sub_f32 v122, v122, v200
v_sub_f32 v123, v123, v200
v_exp_f32 v112, v112
v_exp_f32 v113, v113
v_exp_f32 v114, v114
v_cvt_pk_bf16_f32 v136, v112, v113
v_exp_f32 v115, v115
v_exp_f32 v116, v116
v_cvt_pk_bf16_f32 v137, v114, v115
v_exp_f32 v117, v117
v_exp_f32 v118, v118
v_cvt_pk_bf16_f32 v138, v116, v117
v_exp_f32 v119, v119
v_exp_f32 v120, v120
v_cvt_pk_bf16_f32 v139, v118, v119
v_exp_f32 v121, v121
v_exp_f32 v122, v122
v_cvt_pk_bf16_f32 v140, v120, v121
v_exp_f32 v123, v123
s_nop 0
v_cvt_pk_bf16_f32 v141, v122, v123
v_mfma_f32_16x16x32_bf16 v[144:147], v[180:183], v[136:139], 0
v_mfma_f32_16x16x32_bf16 v[148:151], v[48:51], v[136:139], 0
v_mfma_f32_16x16x16_bf16 v[144:147], v[180:181], v[140:141], v[144:147]
v_mfma_f32_16x16x32_bf16 v[152:155], v[52:55], v[136:139], 0
v_mfma_f32_16x16x32_bf16 v[156:159], v[56:59], v[136:139], 0
v_mfma_f32_16x16x32_bf16 v[160:163], v[60:63], v[136:139], 0
v_mfma_f32_16x16x32_bf16 v[164:167], v[64:67], v[136:139], 0
v_mfma_f32_16x16x32_bf16 v[168:171], v[68:71], v[136:139], 0
v_mfma_f32_16x16x32_bf16 v[172:175], v[72:75], v[136:139], 0
v_mfma_f32_16x16x32_bf16 v[176:179], v[76:79], v[136:139], 0
v_rcp_f32 v200, v144
v_mfma_f32_16x16x16_bf16 v[148:151], v[96:97], v[140:141], v[148:151]
v_mfma_f32_16x16x16_bf16 v[152:155], v[98:99], v[140:141], v[152:155]
v_mfma_f32_16x16x16_bf16 v[156:159], v[100:101], v[140:141], v[156:159]
v_mfma_f32_16x16x16_bf16 v[160:163], v[102:103], v[140:141], v[160:163]
v_mfma_f32_16x16x16_bf16 v[164:167], v[104:105], v[140:141], v[164:167]
v_mfma_f32_16x16x16_bf16 v[168:171], v[106:107], v[140:141], v[168:171]
v_mfma_f32_16x16x16_bf16 v[172:175], v[108:109], v[140:141], v[172:175]
v_mfma_f32_16x16x16_bf16 v[176:179], v[110:111], v[140:141], v[176:179]
v_mov_b32 v201, v200
s_waitcnt vmcnt(0)
v_cmp_eq_u32 vcc, 0, v211
v_pk_mul_f32 v[148:149], v[148:149], v[200:201]
v_pk_mul_f32 v[150:151], v[150:151], v[200:201]
v_pk_mul_f32 v[152:153], v[152:153], v[200:201]
v_pk_mul_f32 v[154:155], v[154:155], v[200:201]
v_cvt_pk_bf16_f32 v184, v148, v149
v_cvt_pk_bf16_f32 v185, v150, v151
v_cvt_pk_bf16_f32 v186, v152, v153
v_cvt_pk_bf16_f32 v187, v154, v155
buffer_store_dwordx4 v[184:187], v204, s[4:7], s22 offen offset:0 sc1
v_pk_mul_f32 v[156:157], v[156:157], v[200:201]
v_pk_mul_f32 v[158:159], v[158:159], v[200:201]
v_pk_mul_f32 v[160:161], v[160:161], v[200:201]
v_pk_mul_f32 v[162:163], v[162:163], v[200:201]
v_cvt_pk_bf16_f32 v188, v156, v157
v_cvt_pk_bf16_f32 v189, v158, v159
v_cvt_pk_bf16_f32 v190, v160, v161
v_cvt_pk_bf16_f32 v191, v162, v163
buffer_store_dwordx4 v[188:191], v204, s[4:7], s22 offen offset:1024 sc1
v_pk_mul_f32 v[164:165], v[164:165], v[200:201]
v_pk_mul_f32 v[166:167], v[166:167], v[200:201]
v_pk_mul_f32 v[168:169], v[168:169], v[200:201]
v_pk_mul_f32 v[170:171], v[170:171], v[200:201]
v_cvt_pk_bf16_f32 v192, v164, v165
v_cvt_pk_bf16_f32 v193, v166, v167
v_cvt_pk_bf16_f32 v194, v168, v169
v_cvt_pk_bf16_f32 v195, v170, v171
buffer_store_dwordx4 v[192:195], v204, s[4:7], s22 offen offset:2048 sc1
s_nop 0
v_pk_mul_f32 v[172:173], v[172:173], v[200:201]
v_pk_mul_f32 v[174:175], v[174:175], v[200:201]
v_pk_mul_f32 v[176:177], v[176:177], v[200:201]
v_pk_mul_f32 v[178:179], v[178:179], v[200:201]
v_cvt_pk_bf16_f32 v196, v172, v173
v_cvt_pk_bf16_f32 v197, v174, v175
v_cvt_pk_bf16_f32 v198, v176, v177
v_cvt_pk_bf16_f32 v199, v178, v179
buffer_store_dwordx4 v[196:199], v204, s[4:7], s22 offen offset:3072 sc1
s_add_u32 s22, s22, s34
s_add_u32 s33, s33, s37
s_add_u32 s25, s25, s38
s_cmp_ge_u32 s25, 64
s_cbranch_scc1 main_kernel_a_last
s_cbranch_vccnz main_kernel_a_slow
s_cmp_gt_u32 s25, 60
s_cbranch_scc1 main_kernel_a_slow
buffer_load_dwordx4 v[0:3], v204, s[4:7], s15 offen offset:0 sc1
buffer_load_dwordx4 v[16:19], v204, s[4:7], s16 offen offset:0 sc1
buffer_load_dwordx4 v[32:35], v204, s[4:7], s17 offen offset:0 sc1
buffer_load_dwordx4 v[4:7], v204, s[4:7], s15 offen offset:1024 sc1
buffer_load_dwordx4 v[20:23], v204, s[4:7], s16 offen offset:1024 sc1
buffer_load_dwordx4 v[36:39], v204, s[4:7], s17 offen offset:1024 sc1
buffer_load_dwordx4 v[8:11], v204, s[4:7], s15 offen offset:2048 sc1
buffer_load_dwordx4 v[24:27], v204, s[4:7], s16 offen offset:2048 sc1
buffer_load_dwordx4 v[40:43], v204, s[4:7], s17 offen offset:2048 sc1
buffer_load_dwordx4 v[12:15], v204, s[4:7], s15 offen offset:3072 sc1
buffer_load_dwordx4 v[28:31], v204, s[4:7], s16 offen offset:3072 sc1
buffer_load_dwordx4 v[44:47], v204, s[4:7], s17 offen offset:3072 sc1
v_mov_b32 v211, 0
s_mov_b64 exec, 65535
buffer_atomic_add v211, v210, s[4:7], s21 offen sc0 sc1
s_mov_b64 exec, -1
buffer_load_dwordx4 v[48:51], v204, s[4:7], s18 offen offset:0 sc1
buffer_load_dwordx4 v[52:55], v204, s[4:7], s18 offen offset:1024 sc1
buffer_load_dwordx4 v[56:59], v204, s[4:7], s18 offen offset:2048 sc1
buffer_load_dwordx4 v[60:63], v204, s[4:7], s18 offen offset:3072 sc1
buffer_load_dwordx4 v[64:67], v204, s[4:7], s19 offen offset:0 sc1
buffer_load_dwordx4 v[68:71], v204, s[4:7], s19 offen offset:1024 sc1
buffer_load_dwordx4 v[72:75], v204, s[4:7], s19 offen offset:2048 sc1
buffer_load_dwordx4 v[76:79], v204, s[4:7], s19 offen offset:3072 sc1
s_waitcnt vmcnt(21)
s_mov_b64 exec, 1
buffer_store_dword v208, v209, s[4:7], s24 offen sc1
s_mov_b64 exec, -1
s_add_u32 s24, s24, s36
s_branch main_kernel_a_top
main_kernel_a_slow:
s_waitcnt vmcnt(0)
s_mov_b64 exec, 1
buffer_store_dword v208, v209, s[4:7], s24 offen sc1
s_mov_b64 exec, -1
s_add_u32 s24, s24, s36
s_branch main_kernel_a_fp
main_kernel_a_last:
s_waitcnt vmcnt(0)
s_mov_b64 exec, 1
buffer_store_dword v208, v209, s[4:7], s24 offen sc1
s_mov_b64 exec, -1
s_add_u32 s24, s24, s36
s_branch main_kernel_end
main_kernel_a_se:
s_waitcnt vmcnt(0)
v_cmp_eq_u32 vcc, 0, v211
s_cmp_ge_u32 s25, 58
s_cbranch_scc1 main_kernel_a_sn
s_cbranch_vccnz main_kernel_a_sn
s_mov_b32 s45, 0x7f000000
s_mov_b32 s46, 0
main_kernel_a_E:
s_add_u32 s20, s20, 0x10000
s_add_u32 s21, s21, 0x10000
s_add_u32 s23, s23, 128
buffer_load_dwordx4 v[0:3], v204, s[4:7], s15 offen offset:0 sc1
buffer_load_dwordx4 v[16:19], v204, s[4:7], s16 offen offset:0 sc1
buffer_load_dwordx4 v[32:35], v204, s[4:7], s17 offen offset:0 sc1
buffer_load_dwordx4 v[80:83], v205, s[4:7], s20 offen offset:0 sc1
buffer_load_dwordx4 v[4:7], v204, s[4:7], s15 offen offset:1024 sc1
buffer_load_dwordx4 v[20:23], v204, s[4:7], s16 offen offset:1024 sc1
buffer_load_dwordx4 v[36:39], v204, s[4:7], s17 offen offset:1024 sc1
buffer_load_dwordx4 v[84:87], v205, s[4:7], s20 offen offset:512 sc1
buffer_load_dwordx4 v[8:11], v204, s[4:7], s15 offen offset:2048 sc1
buffer_load_dwordx4 v[24:27], v204, s[4:7], s16 offen offset:2048 sc1
buffer_load_dwordx4 v[40:43], v204, s[4:7], s17 offen offset:2048 sc1
buffer_load_dwordx4 v[88:91], v205, s[4:7], s20 offen offset:1024 sc1
buffer_load_dwordx4 v[12:15], v204, s[4:7], s15 offen offset:3072 sc1
buffer_load_dwordx4 v[28:31], v204, s[4:7], s16 offen offset:3072 sc1
buffer_load_dwordx4 v[44:47], v204, s[4:7], s17 offen offset:3072 sc1
buffer_load_dwordx4 v[92:95], v205, s[4:7], s20 offen offset:1536 sc1
s_cmp_eq_u32 s46, 0
s_cselect_b32 s47, s21, 0x7f000000
s_cselect_b32 s46, 4, s46
s_sub_u32 s46, s46, 1
v_mov_b32 v211, 0
s_mov_b64 exec, 130816
buffer_atomic_add v211, v210, s[4:7], s47 offen sc0 sc1
s_mov_b64 exec, -1
buffer_load_dword v212, v207, s[4:7], s23 offen sc1
v_mul_f32 v120, s26, v120
v_mul_f32 v121, s26, v121
v_mul_f32 v122, s26, v122
v_mul_f32 v123, s26, v123
v_max3_f32 v200, v202, v120, v121
v_max3_f32 v200, v200, v122, v123
v_mov_b32 v201, v200
s_nop 1
v_permlane32_swap_b32 v200, v201
v_max_f32 v200, v200, v201
v_mov_b32 v201, v200
s_nop 1
v_permlane16_swap_b32 v200, v201
v_max_f32 v200, v200, v201
v_sub_f32 v112, v112, v200
v_sub_f32 v113, v113, v200
v_sub_f32 v114, v114, v200
v_sub_f32 v115, v115, v200
v_sub_f32 v116, v116, v200
v_sub_f32 v117, v117, v200
v_sub_f32 v118, v118, v200
v_sub_f32 v119, v119, v200
v_sub_f32 v120, v120, v200
v_sub_f32 v121, v121, v200
v_sub_f32 v122, v122, v200
v_sub_f32 v123, v123, v200
v_exp_f32 v112, v112
v_exp_f32 v113, v113
v_exp_f32 v114, v114
v_cvt_pk_bf16_f32 v136, v112, v113
v_exp_f32 v115, v115
v_exp_f32 v116, v116
v_cvt_pk_bf16_f32 v137, v114, v115
v_exp_f32 v117, v117
v_exp_f32 v118, v118
v_cvt_pk_bf16_f32 v138, v116, v117
v_exp_f32 v119, v119
v_exp_f32 v120, v120
v_cvt_pk_bf16_f32 v139, v118, v119
v_exp_f32 v121, v121
v_exp_f32 v122, v122
v_cvt_pk_bf16_f32 v140, v120, v121
v_exp_f32 v123, v123
s_nop 0
v_cvt_pk_bf16_f32 v141, v122, v123
s_waitcnt vmcnt(19)
v_max_u32 v200, v96, v97
v_max3_u32 v200, v200, v98, v99
v_max3_u32 v200, v200, v100, v101
v_max3_u32 v200, v200, v102, v103
v_max3_u32 v200, v200, v104, v105
v_max3_u32 v200, v200, v106, v107
v_max3_u32 v200, v200, v108, v109
v_max3_u32 v200, v200, v110, v111
v_cmp_eq_u32 vcc, -1, v200
s_cbranch_vccnz main_kernel_a_vf
main_kernel_a_vo:
v_mfma_f32_16x16x32_bf16 v[144:147], v[180:183], v[136:139], 0
v_mfma_f32_16x16x32_bf16 v[148:151], v[48:51], v[136:139], 0
v_mfma_f32_16x16x16_bf16 v[144:147], v[180:181], v[140:141], v[144:147]
v_mfma_f32_16x16x32_bf16 v[152:155], v[52:55], v[136:139], 0
v_mfma_f32_16x16x32_bf16 v[156:159], v[56:59], v[136:139], 0
v_mfma_f32_16x16x32_bf16 v[160:163], v[60:63], v[136:139], 0
v_mfma_f32_16x16x32_bf16 v[164:167], v[64:67], v[136:139], 0
v_mfma_f32_16x16x32_bf16 v[168:171], v[68:71], v[136:139], 0
v_mfma_f32_16x16x32_bf16 v[172:175], v[72:75], v[136:139], 0
v_mfma_f32_16x16x32_bf16 v[176:179], v[76:79], v[136:139], 0
v_rcp_f32 v200, v144
v_mfma_f32_16x16x16_bf16 v[148:151], v[96:97], v[140:141], v[148:151]
v_mfma_f32_16x16x16_bf16 v[152:155], v[98:99], v[140:141], v[152:155]
v_mfma_f32_16x16x16_bf16 v[156:159], v[100:101], v[140:141], v[156:159]
v_mfma_f32_16x16x16_bf16 v[160:163], v[102:103], v[140:141], v[160:163]
v_mfma_f32_16x16x16_bf16 v[164:167], v[104:105], v[140:141], v[164:167]
v_mfma_f32_16x16x16_bf16 v[168:171], v[106:107], v[140:141], v[168:171]
v_mfma_f32_16x16x16_bf16 v[172:175], v[108:109], v[140:141], v[172:175]
v_mfma_f32_16x16x16_bf16 v[176:179], v[110:111], v[140:141], v[176:179]
v_mov_b32 v201, v200
s_nop 1
v_pk_mul_f32 v[148:149], v[148:149], v[200:201]
v_pk_mul_f32 v[150:151], v[150:151], v[200:201]
v_pk_mul_f32 v[152:153], v[152:153], v[200:201]
v_pk_mul_f32 v[154:155], v[154:155], v[200:201]
v_cvt_pk_bf16_f32 v184, v148, v149
v_cvt_pk_bf16_f32 v185, v150, v151
v_cvt_pk_bf16_f32 v186, v152, v153
v_cvt_pk_bf16_f32 v187, v154, v155
buffer_store_dwordx4 v[184:187], v204, s[4:7], s22 offen offset:0 sc1
v_pk_mul_f32 v[156:157], v[156:157], v[200:201]
v_pk_mul_f32 v[158:159], v[158:159], v[200:201]
v_pk_mul_f32 v[160:161], v[160:161], v[200:201]
v_pk_mul_f32 v[162:163], v[162:163], v[200:201]
v_cvt_pk_bf16_f32 v188, v156, v157
v_cvt_pk_bf16_f32 v189, v158, v159
v_cvt_pk_bf16_f32 v190, v160, v161
v_cvt_pk_bf16_f32 v191, v162, v163
buffer_store_dwordx4 v[188:191], v204, s[4:7], s22 offen offset:1024 sc1
v_pk_mul_f32 v[164:165], v[164:165], v[200:201]
v_pk_mul_f32 v[166:167], v[166:167], v[200:201]
v_pk_mul_f32 v[168:169], v[168:169], v[200:201]
v_pk_mul_f32 v[170:171], v[170:171], v[200:201]
v_cvt_pk_bf16_f32 v192, v164, v165
v_cvt_pk_bf16_f32 v193, v166, v167
v_cvt_pk_bf16_f32 v194, v168, v169
v_cvt_pk_bf16_f32 v195, v170, v171
buffer_store_dwordx4 v[192:195], v204, s[4:7], s22 offen offset:2048 sc1
s_nop 0
v_pk_mul_f32 v[172:173], v[172:173], v[200:201]
v_pk_mul_f32 v[174:175], v[174:175], v[200:201]
v_pk_mul_f32 v[176:177], v[176:177], v[200:201]
v_pk_mul_f32 v[178:179], v[178:179], v[200:201]
v_cvt_pk_bf16_f32 v196, v172, v173
v_cvt_pk_bf16_f32 v197, v174, v175
v_cvt_pk_bf16_f32 v198, v176, v177
v_cvt_pk_bf16_f32 v199, v178, v179
buffer_store_dwordx4 v[196:199], v204, s[4:7], s22 offen offset:3072 sc1
s_add_u32 s22, s22, s34
buffer_load_dwordx4 v[48:51], v204, s[4:7], s18 offen offset:0 sc1
buffer_load_dwordx4 v[52:55], v204, s[4:7], s18 offen offset:1024 sc1
buffer_load_dwordx4 v[56:59], v204, s[4:7], s18 offen offset:2048 sc1
buffer_load_dwordx4 v[60:63], v204, s[4:7], s18 offen offset:3072 sc1
buffer_load_dwordx4 v[64:67], v204, s[4:7], s19 offen offset:0 sc1
buffer_load_dwordx4 v[68:71], v204, s[4:7], s19 offen offset:1024 sc1
buffer_load_dwordx4 v[72:75], v204, s[4:7], s19 offen offset:2048 sc1
buffer_load_dwordx4 v[76:79], v204, s[4:7], s19 offen offset:3072 sc1
buffer_load_dwordx2 v[96:97], v206, s[4:7], s21 offen offset:0 sc1
buffer_load_dwordx2 v[98:99], v206, s[4:7], s21 offen offset:256 sc1
buffer_load_dwordx2 v[100:101], v206, s[4:7], s21 offen offset:512 sc1
buffer_load_dwordx2 v[102:103], v206, s[4:7], s21 offen offset:768 sc1
buffer_load_dwordx2 v[104:105], v206, s[4:7], s21 offen offset:1024 sc1
buffer_load_dwordx2 v[106:107], v206, s[4:7], s21 offen offset:1280 sc1
buffer_load_dwordx2 v[108:109], v206, s[4:7], s21 offen offset:1536 sc1
buffer_load_dwordx2 v[110:111], v206, s[4:7], s21 offen offset:1792 sc1
s_add_u32 s25, s25, 1
s_add_u32 s15, s15, 262144
s_add_u32 s16, s16, 262144
s_add_u32 s17, s17, 262144
s_add_u32 s18, s18, 262144
s_add_u32 s19, s19, 262144
s_waitcnt vmcnt(34)
v_mfma_f32_16x16x32_bf16 v[112:115], v[16:19], v[0:3], v[124:127]
v_mfma_f32_16x16x32_bf16 v[116:119], v[32:35], v[0:3], v[128:131]
v_mfma_f32_16x16x32_bf16 v[120:123], v[80:83], v[0:3], v[132:135]
s_mov_b64 exec, 1
buffer_store_dword v208, v209, s[4:7], s45 offen sc1
s_mov_b64 exec, -1
s_mov_b32 s45, s24
s_add_u32 s24, s24, 256
v_max3_u32 v200, v80, v81, v82
v_max_u32 v200, v200, v83
s_waitcnt vmcnt(31)
v_mfma_f32_16x16x32_bf16 v[112:115], v[20:23], v[4:7], v[112:115]
v_mfma_f32_16x16x32_bf16 v[116:119], v[36:39], v[4:7], v[116:119]
v_mfma_f32_16x16x32_bf16 v[120:123], v[84:87], v[4:7], v[120:123]
v_max3_u32 v200, v200, v84, v85
v_max3_u32 v200, v200, v86, v87
s_waitcnt vmcnt(27)
v_mfma_f32_16x16x32_bf16 v[112:115], v[24:27], v[8:11], v[112:115]
v_mfma_f32_16x16x32_bf16 v[116:119], v[40:43], v[8:11], v[116:119]
v_mfma_f32_16x16x32_bf16 v[120:123], v[88:91], v[8:11], v[120:123]
v_max3_u32 v200, v200, v88, v89
v_max3_u32 v200, v200, v90, v91
s_waitcnt vmcnt(23)
v_mfma_f32_16x16x32_bf16 v[112:115], v[28:31], v[12:15], v[112:115]
v_mfma_f32_16x16x32_bf16 v[116:119], v[44:47], v[12:15], v[116:119]
v_mfma_f32_16x16x32_bf16 v[120:123], v[92:95], v[12:15], v[120:123]
v_max3_u32 v200, v200, v92, v93
v_max3_u32 v200, v200, v94, v95
s_waitcnt vmcnt(21)
v_readlane_b32 s31, v211, 16
v_writelane_b32 v211, 0, 16
s_cmp_eq_u32 s31, -1
s_cselect_b32 s46, 0, s46
v_max_u32 v200, v200, v211
v_add_u32 v200, 1, v200
v_min_u32 v200, v200, v212
v_cmp_eq_u32 vcc, 0, v200
v_max3_f32 v202, v112, v113, v114
s_cmp_lt_u32 s25, 58
s_nop 1
v_max3_f32 v202, v202, v115, v116
v_max3_f32 v202, v202, v117, v118
v_max_f32 v202, v202, v119
s_cbranch_vccnz main_kernel_a_X
s_cbranch_scc1 main_kernel_a_E
main_kernel_a_X:
s_waitcnt vmcnt(0)
s_mov_b64 exec, 1
buffer_store_dword v208, v209, s[4:7], s45 offen sc1
s_mov_b64 exec, -1
s_mov_b32 s44, 1
s_branch main_kernel_a_mp
main_kernel_a_vf:
s_sub_u32 s31, s21, 0x10000
buffer_load_dwordx2 v[96:97], v206, s[4:7], s31 offen offset:0 sc1
buffer_load_dwordx2 v[98:99], v206, s[4:7], s31 offen offset:256 sc1
buffer_load_dwordx2 v[100:101], v206, s[4:7], s31 offen offset:512 sc1
buffer_load_dwordx2 v[102:103], v206, s[4:7], s31 offen offset:768 sc1
buffer_load_dwordx2 v[104:105], v206, s[4:7], s31 offen offset:1024 sc1
buffer_load_dwordx2 v[106:107], v206, s[4:7], s31 offen offset:1280 sc1
buffer_load_dwordx2 v[108:109], v206, s[4:7], s31 offen offset:1536 sc1
buffer_load_dwordx2 v[110:111], v206, s[4:7], s31 offen offset:1792 sc1
s_sub_u32 s29, s29, 1
s_cbranch_scc1 main_kernel_end
s_waitcnt vmcnt(0)
v_max_u32 v200, v96, v97
v_max3_u32 v200, v200, v98, v99
v_max3_u32 v200, v200, v100, v101
v_max3_u32 v200, v200, v102, v103
v_max3_u32 v200, v200, v104, v105
v_max3_u32 v200, v200, v106, v107
v_max3_u32 v200, v200, v108, v109
v_max3_u32 v200, v200, v110, v111
v_cmp_eq_u32 vcc, -1, v200
s_cbranch_vccnz main_kernel_a_vf
s_branch main_kernel_a_vo
main_kernel_wo:
s_mov_b32 s8, s46
s_and_b32 s9, s47, 0xffff
s_mov_b32 s10, 0x800000
s_mov_b32 s11, 0x20000
v_lshlrev_b32 v170, 4, v250
s_lshr_b32 s23, s12, 2
s_sub_u32 s21, s12, 5
s_cselect_b32 s23, s23, s21
s_cselect_b32 s18, 44, 63
v_lshrrev_b32 v178, 2, v250
v_and_b32 v179, 3, v250
v_lshlrev_b32 v0, 11, v178
v_lshl_add_u32 v0, v179, 4, v0
s_lshl_b32 s19, s14, 15
v_lshl_add_u32 v1, v178, 6, s19
v_lshl_add_u32 v1, v179, 3, v1
s_lshl_b32 s20, s14, 21
s_lshl_b32 s21, s13, 6
s_add_u32 s20, s20, s21
s_add_u32 s21, s20, 0x0
s_add_u32 m0, s19, 0
s_nop 0
buffer_load_dwordx4 v0, s[8:11], s21 offen lds
s_add_u32 s21, s20, 0x8000
s_add_u32 m0, s19, 1024
s_nop 0
buffer_load_dwordx4 v0, s[8:11], s21 offen lds
s_add_u32 s21, s20, 0x10000
s_add_u32 m0, s19, 2048
s_nop 0
buffer_load_dwordx4 v0, s[8:11], s21 offen lds
s_add_u32 s21, s20, 0x18000
s_add_u32 m0, s19, 3072
s_nop 0
buffer_load_dwordx4 v0, s[8:11], s21 offen lds
s_add_u32 s21, s20, 0x20000
s_add_u32 m0, s19, 4096
s_nop 0
buffer_load_dwordx4 v0, s[8:11], s21 offen lds
s_add_u32 s21, s20, 0x28000
s_add_u32 m0, s19, 5120
s_nop 0
buffer_load_dwordx4 v0, s[8:11], s21 offen lds
s_add_u32 s21, s20, 0x30000
s_add_u32 m0, s19, 6144
s_nop 0
buffer_load_dwordx4 v0, s[8:11], s21 offen lds
s_add_u32 s21, s20, 0x38000
s_add_u32 m0, s19, 7168
s_nop 0
buffer_load_dwordx4 v0, s[8:11], s21 offen lds
s_add_u32 s21, s20, 0x40000
s_add_u32 m0, s19, 8192
s_nop 0
buffer_load_dwordx4 v0, s[8:11], s21 offen lds
s_add_u32 s21, s20, 0x48000
s_add_u32 m0, s19, 9216
s_nop 0
buffer_load_dwordx4 v0, s[8:11], s21 offen lds
s_add_u32 s21, s20, 0x50000
s_add_u32 m0, s19, 10240
s_nop 0
buffer_load_dwordx4 v0, s[8:11], s21 offen lds
s_add_u32 s21, s20, 0x58000
s_add_u32 m0, s19, 11264
s_nop 0
buffer_load_dwordx4 v0, s[8:11], s21 offen lds
s_add_u32 s21, s20, 0x60000
s_add_u32 m0, s19, 12288
s_nop 0
buffer_load_dwordx4 v0, s[8:11], s21 offen lds
s_add_u32 s21, s20, 0x68000
s_add_u32 m0, s19, 13312
s_nop 0
buffer_load_dwordx4 v0, s[8:11], s21 offen lds
s_add_u32 s21, s20, 0x70000
s_add_u32 m0, s19, 14336
s_nop 0
buffer_load_dwordx4 v0, s[8:11], s21 offen lds
s_add_u32 s21, s20, 0x78000
s_add_u32 m0, s19, 15360
s_nop 0
buffer_load_dwordx4 v0, s[8:11], s21 offen lds
s_add_u32 s21, s20, 0x80000
s_add_u32 m0, s19, 16384
s_nop 0
buffer_load_dwordx4 v0, s[8:11], s21 offen lds
s_add_u32 s21, s20, 0x88000
s_add_u32 m0, s19, 17408
s_nop 0
buffer_load_dwordx4 v0, s[8:11], s21 offen lds
s_add_u32 s21, s20, 0x90000
s_add_u32 m0, s19, 18432
s_nop 0
buffer_load_dwordx4 v0, s[8:11], s21 offen lds
s_add_u32 s21, s20, 0x98000
s_add_u32 m0, s19, 19456
s_nop 0
buffer_load_dwordx4 v0, s[8:11], s21 offen lds
s_add_u32 s21, s20, 0xa0000
s_add_u32 m0, s19, 20480
s_nop 0
buffer_load_dwordx4 v0, s[8:11], s21 offen lds
s_add_u32 s21, s20, 0xa8000
s_add_u32 m0, s19, 21504
s_nop 0
buffer_load_dwordx4 v0, s[8:11], s21 offen lds
s_add_u32 s21, s20, 0xb0000
s_add_u32 m0, s19, 22528
s_nop 0
buffer_load_dwordx4 v0, s[8:11], s21 offen lds
s_add_u32 s21, s20, 0xb8000
s_add_u32 m0, s19, 23552
s_nop 0
buffer_load_dwordx4 v0, s[8:11], s21 offen lds
s_add_u32 s21, s20, 0xc0000
s_add_u32 m0, s19, 24576
s_nop 0
buffer_load_dwordx4 v0, s[8:11], s21 offen lds
s_add_u32 s21, s20, 0xc8000
s_add_u32 m0, s19, 25600
s_nop 0
buffer_load_dwordx4 v0, s[8:11], s21 offen lds
s_add_u32 s21, s20, 0xd0000
s_add_u32 m0, s19, 26624
s_nop 0
buffer_load_dwordx4 v0, s[8:11], s21 offen lds
s_add_u32 s21, s20, 0xd8000
s_add_u32 m0, s19, 27648
s_nop 0
buffer_load_dwordx4 v0, s[8:11], s21 offen lds
s_add_u32 s21, s20, 0xe0000
s_add_u32 m0, s19, 28672
s_nop 0
buffer_load_dwordx4 v0, s[8:11], s21 offen lds
s_add_u32 s21, s20, 0xe8000
s_add_u32 m0, s19, 29696
s_nop 0
buffer_load_dwordx4 v0, s[8:11], s21 offen lds
s_add_u32 s21, s20, 0xf0000
s_add_u32 m0, s19, 30720
s_nop 0
buffer_load_dwordx4 v0, s[8:11], s21 offen lds
s_add_u32 s21, s20, 0xf8000
s_add_u32 m0, s19, 31744
s_nop 0
buffer_load_dwordx4 v0, s[8:11], s21 offen lds
v_and_b32 v178, 15, v250
v_lshrrev_b32 v179, 4, v250
v_lshlrev_b32 v175, 11, v178
v_lshl_add_u32 v175, v179, 3, v175
s_lshl_b32 s21, s14, 11
s_add_u32 s21, s21, 131072
v_add_u32 v176, s21, v170
s_lshl_b32 s21, s14, 10
s_add_u32 s21, s21, 131072
v_add_u32 v177, s21, v170
s_lshr_b32 s21, s13, 2
s_lshl_b32 s21, s21, 2
s_add_u32 s21, s21, 0x8412000
s_lshl_b32 s22, s18, 7
s_add_u32 s21, s22, s21
v_mov_b32 v172, s21
v_mov_b32 v173, 128
s_lshl_b32 s21, s14, 4
s_add_u32 s21, s21, s23
s_lshl_b32 s21, s21, 2
s_add_u32 s21, s21, 0x8400000
s_lshl_b32 s22, s18, 8
s_add_u32 s21, s21, s22
s_mov_b64 exec, 0xff
v_lshl_add_u32 v172, v250, 3, s21
v_mov_b32 v173, 0x100
s_mov_b64 exec, -1
s_lshl_b32 s15, s14, 15
s_lshl_b32 s21, s23, 17
s_add_u32 s15, s15, s21
s_add_u32 s15, s15, 0x3800000
s_lshl_b32 s21, s18, 18
s_add_u32 s15, s15, s21
s_lshl_b32 s21, s23, 15
s_lshl_b32 s22, s18, 16
s_add_u32 s21, s21, s22
s_and_b32 s22, s14, 1
s_lshl_b32 s16, s13, 1
s_add_u32 s16, s16, s22
s_lshl_b32 s16, s16, 5
s_add_u32 s16, s16, s21
s_lshl_b32 s17, s13, 7
s_add_u32 s17, s17, s22
s_lshl_b32 s17, s17, 3
s_add_u32 s17, s17, s21
s_add_u32 s17, s17, 0x6400000
s_waitcnt vmcnt(24)
ds_read_b64_tr_b16 a[0:1], v1 offset:0
ds_read_b64_tr_b16 a[2:3], v1 offset:1024
ds_read_b64_tr_b16 a[128:129], v1 offset:32
ds_read_b64_tr_b16 a[130:131], v1 offset:1056
ds_read_b64_tr_b16 a[4:5], v1 offset:2048
ds_read_b64_tr_b16 a[6:7], v1 offset:3072
ds_read_b64_tr_b16 a[132:133], v1 offset:2080
ds_read_b64_tr_b16 a[134:135], v1 offset:3104
ds_read_b64_tr_b16 a[8:9], v1 offset:4096
ds_read_b64_tr_b16 a[10:11], v1 offset:5120
ds_read_b64_tr_b16 a[136:137], v1 offset:4128
ds_read_b64_tr_b16 a[138:139], v1 offset:5152
ds_read_b64_tr_b16 a[12:13], v1 offset:6144
ds_read_b64_tr_b16 a[14:15], v1 offset:7168
ds_read_b64_tr_b16 a[140:141], v1 offset:6176
ds_read_b64_tr_b16 a[142:143], v1 offset:7200
s_waitcnt lgkmcnt(0)
s_add_u32 s21, s20, 0x100000
s_add_u32 m0, s19, 0
s_nop 0
buffer_load_dwordx4 v0, s[8:11], s21 offen lds
s_add_u32 s21, s20, 0x108000
s_add_u32 m0, s19, 1024
s_nop 0
buffer_load_dwordx4 v0, s[8:11], s21 offen lds
s_add_u32 s21, s20, 0x110000
s_add_u32 m0, s19, 2048
s_nop 0
buffer_load_dwordx4 v0, s[8:11], s21 offen lds
s_add_u32 s21, s20, 0x118000
s_add_u32 m0, s19, 3072
s_nop 0
buffer_load_dwordx4 v0, s[8:11], s21 offen lds
s_add_u32 s21, s20, 0x120000
s_add_u32 m0, s19, 4096
s_nop 0
buffer_load_dwordx4 v0, s[8:11], s21 offen lds
s_add_u32 s21, s20, 0x128000
s_add_u32 m0, s19, 5120
s_nop 0
buffer_load_dwordx4 v0, s[8:11], s21 offen lds
s_add_u32 s21, s20, 0x130000
s_add_u32 m0, s19, 6144
s_nop 0
buffer_load_dwordx4 v0, s[8:11], s21 offen lds
s_add_u32 s21, s20, 0x138000
s_add_u32 m0, s19, 7168
s_nop 0
buffer_load_dwordx4 v0, s[8:11], s21 offen lds
s_waitcnt vmcnt(24)
ds_read_b64_tr_b16 a[16:17], v1 offset:8192
ds_read_b64_tr_b16 a[18:19], v1 offset:9216
ds_read_b64_tr_b16 a[144:145], v1 offset:8224
ds_read_b64_tr_b16 a[146:147], v1 offset:9248
ds_read_b64_tr_b16 a[20:21], v1 offset:10240
ds_read_b64_tr_b16 a[22:23], v1 offset:11264
ds_read_b64_tr_b16 a[148:149], v1 offset:10272
ds_read_b64_tr_b16 a[150:151], v1 offset:11296
ds_read_b64_tr_b16 a[24:25], v1 offset:12288
ds_read_b64_tr_b16 a[26:27], v1 offset:13312
ds_read_b64_tr_b16 a[152:153], v1 offset:12320
ds_read_b64_tr_b16 a[154:155], v1 offset:13344
ds_read_b64_tr_b16 a[28:29], v1 offset:14336
ds_read_b64_tr_b16 a[30:31], v1 offset:15360
ds_read_b64_tr_b16 a[156:157], v1 offset:14368
ds_read_b64_tr_b16 a[158:159], v1 offset:15392
s_waitcnt lgkmcnt(0)
s_add_u32 s21, s20, 0x140000
s_add_u32 m0, s19, 8192
s_nop 0
buffer_load_dwordx4 v0, s[8:11], s21 offen lds
s_add_u32 s21, s20, 0x148000
s_add_u32 m0, s19, 9216
s_nop 0
buffer_load_dwordx4 v0, s[8:11], s21 offen lds
s_add_u32 s21, s20, 0x150000
s_add_u32 m0, s19, 10240
s_nop 0
buffer_load_dwordx4 v0, s[8:11], s21 offen lds
s_add_u32 s21, s20, 0x158000
s_add_u32 m0, s19, 11264
s_nop 0
buffer_load_dwordx4 v0, s[8:11], s21 offen lds
s_add_u32 s21, s20, 0x160000
s_add_u32 m0, s19, 12288
s_nop 0
buffer_load_dwordx4 v0, s[8:11], s21 offen lds
s_add_u32 s21, s20, 0x168000
s_add_u32 m0, s19, 13312
s_nop 0
buffer_load_dwordx4 v0, s[8:11], s21 offen lds
s_add_u32 s21, s20, 0x170000
s_add_u32 m0, s19, 14336
s_nop 0
buffer_load_dwordx4 v0, s[8:11], s21 offen lds
s_add_u32 s21, s20, 0x178000
s_add_u32 m0, s19, 15360
s_nop 0
buffer_load_dwordx4 v0, s[8:11], s21 offen lds
s_waitcnt vmcnt(24)
ds_read_b64_tr_b16 a[32:33], v1 offset:16384
ds_read_b64_tr_b16 a[34:35], v1 offset:17408
ds_read_b64_tr_b16 a[160:161], v1 offset:16416
ds_read_b64_tr_b16 a[162:163], v1 offset:17440
ds_read_b64_tr_b16 a[36:37], v1 offset:18432
ds_read_b64_tr_b16 a[38:39], v1 offset:19456
ds_read_b64_tr_b16 a[164:165], v1 offset:18464
ds_read_b64_tr_b16 a[166:167], v1 offset:19488
ds_read_b64_tr_b16 a[40:41], v1 offset:20480
ds_read_b64_tr_b16 a[42:43], v1 offset:21504
ds_read_b64_tr_b16 a[168:169], v1 offset:20512
ds_read_b64_tr_b16 a[170:171], v1 offset:21536
ds_read_b64_tr_b16 a[44:45], v1 offset:22528
ds_read_b64_tr_b16 a[46:47], v1 offset:23552
ds_read_b64_tr_b16 a[172:173], v1 offset:22560
ds_read_b64_tr_b16 a[174:175], v1 offset:23584
s_waitcnt lgkmcnt(0)
s_add_u32 s21, s20, 0x180000
s_add_u32 m0, s19, 16384
s_nop 0
buffer_load_dwordx4 v0, s[8:11], s21 offen lds
s_add_u32 s21, s20, 0x188000
s_add_u32 m0, s19, 17408
s_nop 0
buffer_load_dwordx4 v0, s[8:11], s21 offen lds
s_add_u32 s21, s20, 0x190000
s_add_u32 m0, s19, 18432
s_nop 0
buffer_load_dwordx4 v0, s[8:11], s21 offen lds
s_add_u32 s21, s20, 0x198000
s_add_u32 m0, s19, 19456
s_nop 0
buffer_load_dwordx4 v0, s[8:11], s21 offen lds
s_add_u32 s21, s20, 0x1a0000
s_add_u32 m0, s19, 20480
s_nop 0
buffer_load_dwordx4 v0, s[8:11], s21 offen lds
s_add_u32 s21, s20, 0x1a8000
s_add_u32 m0, s19, 21504
s_nop 0
buffer_load_dwordx4 v0, s[8:11], s21 offen lds
s_add_u32 s21, s20, 0x1b0000
s_add_u32 m0, s19, 22528
s_nop 0
buffer_load_dwordx4 v0, s[8:11], s21 offen lds
s_add_u32 s21, s20, 0x1b8000
s_add_u32 m0, s19, 23552
s_nop 0
buffer_load_dwordx4 v0, s[8:11], s21 offen lds
s_waitcnt vmcnt(24)
ds_read_b64_tr_b16 a[48:49], v1 offset:24576
ds_read_b64_tr_b16 a[50:51], v1 offset:25600
ds_read_b64_tr_b16 a[176:177], v1 offset:24608
ds_read_b64_tr_b16 a[178:179], v1 offset:25632
ds_read_b64_tr_b16 a[52:53], v1 offset:26624
ds_read_b64_tr_b16 a[54:55], v1 offset:27648
ds_read_b64_tr_b16 a[180:181], v1 offset:26656
ds_read_b64_tr_b16 a[182:183], v1 offset:27680
ds_read_b64_tr_b16 a[56:57], v1 offset:28672
ds_read_b64_tr_b16 a[58:59], v1 offset:29696
ds_read_b64_tr_b16 a[184:185], v1 offset:28704
ds_read_b64_tr_b16 a[186:187], v1 offset:29728
ds_read_b64_tr_b16 a[60:61], v1 offset:30720
ds_read_b64_tr_b16 a[62:63], v1 offset:31744
ds_read_b64_tr_b16 a[188:189], v1 offset:30752
ds_read_b64_tr_b16 a[190:191], v1 offset:31776
s_waitcnt lgkmcnt(0)
s_add_u32 s21, s20, 0x1c0000
s_add_u32 m0, s19, 24576
s_nop 0
buffer_load_dwordx4 v0, s[8:11], s21 offen lds
s_add_u32 s21, s20, 0x1c8000
s_add_u32 m0, s19, 25600
s_nop 0
buffer_load_dwordx4 v0, s[8:11], s21 offen lds
s_add_u32 s21, s20, 0x1d0000
s_add_u32 m0, s19, 26624
s_nop 0
buffer_load_dwordx4 v0, s[8:11], s21 offen lds
s_add_u32 s21, s20, 0x1d8000
s_add_u32 m0, s19, 27648
s_nop 0
buffer_load_dwordx4 v0, s[8:11], s21 offen lds
s_add_u32 s21, s20, 0x1e0000
s_add_u32 m0, s19, 28672
s_nop 0
buffer_load_dwordx4 v0, s[8:11], s21 offen lds
s_add_u32 s21, s20, 0x1e8000
s_add_u32 m0, s19, 29696
s_nop 0
buffer_load_dwordx4 v0, s[8:11], s21 offen lds
s_add_u32 s21, s20, 0x1f0000
s_add_u32 m0, s19, 30720
s_nop 0
buffer_load_dwordx4 v0, s[8:11], s21 offen lds
s_add_u32 s21, s20, 0x1f8000
s_add_u32 m0, s19, 31744
s_nop 0
buffer_load_dwordx4 v0, s[8:11], s21 offen lds
s_waitcnt vmcnt(24)
ds_read_b64_tr_b16 a[64:65], v1 offset:0
ds_read_b64_tr_b16 a[66:67], v1 offset:1024
ds_read_b64_tr_b16 a[192:193], v1 offset:32
ds_read_b64_tr_b16 a[194:195], v1 offset:1056
ds_read_b64_tr_b16 a[68:69], v1 offset:2048
ds_read_b64_tr_b16 a[70:71], v1 offset:3072
ds_read_b64_tr_b16 a[196:197], v1 offset:2080
ds_read_b64_tr_b16 a[198:199], v1 offset:3104
ds_read_b64_tr_b16 a[72:73], v1 offset:4096
ds_read_b64_tr_b16 a[74:75], v1 offset:5120
ds_read_b64_tr_b16 a[200:201], v1 offset:4128
ds_read_b64_tr_b16 a[202:203], v1 offset:5152
ds_read_b64_tr_b16 a[76:77], v1 offset:6144
ds_read_b64_tr_b16 a[78:79], v1 offset:7168
ds_read_b64_tr_b16 a[204:205], v1 offset:6176
ds_read_b64_tr_b16 a[206:207], v1 offset:7200
s_waitcnt lgkmcnt(0)
s_waitcnt vmcnt(16)
ds_read_b64_tr_b16 a[80:81], v1 offset:8192
ds_read_b64_tr_b16 a[82:83], v1 offset:9216
ds_read_b64_tr_b16 a[208:209], v1 offset:8224
ds_read_b64_tr_b16 a[210:211], v1 offset:9248
ds_read_b64_tr_b16 a[84:85], v1 offset:10240
ds_read_b64_tr_b16 a[86:87], v1 offset:11264
ds_read_b64_tr_b16 a[212:213], v1 offset:10272
ds_read_b64_tr_b16 a[214:215], v1 offset:11296
ds_read_b64_tr_b16 a[88:89], v1 offset:12288
ds_read_b64_tr_b16 a[90:91], v1 offset:13312
ds_read_b64_tr_b16 a[216:217], v1 offset:12320
ds_read_b64_tr_b16 a[218:219], v1 offset:13344
ds_read_b64_tr_b16 a[92:93], v1 offset:14336
ds_read_b64_tr_b16 a[94:95], v1 offset:15360
ds_read_b64_tr_b16 a[220:221], v1 offset:14368
ds_read_b64_tr_b16 a[222:223], v1 offset:15392
s_waitcnt lgkmcnt(0)
s_waitcnt vmcnt(8)
ds_read_b64_tr_b16 a[96:97], v1 offset:16384
ds_read_b64_tr_b16 a[98:99], v1 offset:17408
ds_read_b64_tr_b16 a[224:225], v1 offset:16416
ds_read_b64_tr_b16 a[226:227], v1 offset:17440
ds_read_b64_tr_b16 a[100:101], v1 offset:18432
ds_read_b64_tr_b16 a[102:103], v1 offset:19456
ds_read_b64_tr_b16 a[228:229], v1 offset:18464
ds_read_b64_tr_b16 a[230:231], v1 offset:19488
ds_read_b64_tr_b16 a[104:105], v1 offset:20480
ds_read_b64_tr_b16 a[106:107], v1 offset:21504
ds_read_b64_tr_b16 a[232:233], v1 offset:20512
ds_read_b64_tr_b16 a[234:235], v1 offset:21536
ds_read_b64_tr_b16 a[108:109], v1 offset:22528
ds_read_b64_tr_b16 a[110:111], v1 offset:23552
ds_read_b64_tr_b16 a[236:237], v1 offset:22560
ds_read_b64_tr_b16 a[238:239], v1 offset:23584
s_waitcnt lgkmcnt(0)
s_waitcnt vmcnt(0)
ds_read_b64_tr_b16 a[112:113], v1 offset:24576
ds_read_b64_tr_b16 a[114:115], v1 offset:25600
ds_read_b64_tr_b16 a[240:241], v1 offset:24608
ds_read_b64_tr_b16 a[242:243], v1 offset:25632
ds_read_b64_tr_b16 a[116:117], v1 offset:26624
ds_read_b64_tr_b16 a[118:119], v1 offset:27648
ds_read_b64_tr_b16 a[244:245], v1 offset:26656
ds_read_b64_tr_b16 a[246:247], v1 offset:27680
ds_read_b64_tr_b16 a[120:121], v1 offset:28672
ds_read_b64_tr_b16 a[122:123], v1 offset:29696
ds_read_b64_tr_b16 a[248:249], v1 offset:28704
ds_read_b64_tr_b16 a[250:251], v1 offset:29728
ds_read_b64_tr_b16 a[124:125], v1 offset:30720
ds_read_b64_tr_b16 a[126:127], v1 offset:31744
ds_read_b64_tr_b16 a[252:253], v1 offset:30752
ds_read_b64_tr_b16 a[254:255], v1 offset:31776
s_waitcnt lgkmcnt(0)
s_cmp_lt_u32 s12, 5
s_cbranch_scc1 main_kernel_o_top
v_mul_u32_u24 v178, 2, v173
v_sub_u32 v171, v172, v178
main_kernel_o_gp:
buffer_load_dword v174, v171, s[4:7], 0 offen sc1
s_waitcnt vmcnt(0)
v_cmp_eq_u32 vcc, 0, v174
s_cbranch_vccz main_kernel_o_top
s_sleep 32
s_sub_u32 s29, s29, 1
s_cbranch_scc0 main_kernel_o_gp
s_branch main_kernel_end
main_kernel_o_top:
buffer_load_dword v174, v172, s[4:7], 0 offen sc1
s_waitcnt vmcnt(0)
v_cmp_eq_u32 vcc, 0, v174
s_cbranch_vccz main_kernel_o_go
s_sleep 1
s_sub_u32 s29, s29, 1
s_cbranch_scc0 main_kernel_o_top
s_branch main_kernel_end
main_kernel_o_go:
v_add_u32 v172, v172, v173
buffer_load_dword v174, v172, s[4:7], 0 offen sc1
buffer_load_dwordx4 v[0:3], v170, s[4:7], s15 offen offset:0 sc1
buffer_load_dwordx4 v[4:7], v170, s[4:7], s15 offen offset:1024 sc1
buffer_load_dwordx4 v[8:11], v170, s[4:7], s15 offen offset:2048 sc1
buffer_load_dwordx4 v[12:15], v170, s[4:7], s15 offen offset:3072 sc1
s_add_u32 s15, s15, 4096
buffer_load_dwordx4 v[16:19], v170, s[4:7], s15 offen offset:0 sc1
buffer_load_dwordx4 v[20:23], v170, s[4:7], s15 offen offset:1024 sc1
buffer_load_dwordx4 v[24:27], v170, s[4:7], s15 offen offset:2048 sc1
buffer_load_dwordx4 v[28:31], v170, s[4:7], s15 offen offset:3072 sc1
s_add_u32 s15, s15, 4096
buffer_load_dwordx4 v[32:35], v170, s[4:7], s15 offen offset:0 sc1
buffer_load_dwordx4 v[36:39], v170, s[4:7], s15 offen offset:1024 sc1
buffer_load_dwordx4 v[40:43], v170, s[4:7], s15 offen offset:2048 sc1
buffer_load_dwordx4 v[44:47], v170, s[4:7], s15 offen offset:3072 sc1
s_add_u32 s15, s15, 4096
buffer_load_dwordx4 v[48:51], v170, s[4:7], s15 offen offset:0 sc1
buffer_load_dwordx4 v[52:55], v170, s[4:7], s15 offen offset:1024 sc1
buffer_load_dwordx4 v[56:59], v170, s[4:7], s15 offen offset:2048 sc1
buffer_load_dwordx4 v[60:63], v170, s[4:7], s15 offen offset:3072 sc1
s_add_u32 s15, s15, 4096
buffer_load_dwordx4 v[64:67], v170, s[4:7], s15 offen offset:0 sc1
buffer_load_dwordx4 v[68:71], v170, s[4:7], s15 offen offset:1024 sc1
buffer_load_dwordx4 v[72:75], v170, s[4:7], s15 offen offset:2048 sc1
buffer_load_dwordx4 v[76:79], v170, s[4:7], s15 offen offset:3072 sc1
s_add_u32 s15, s15, 4096
buffer_load_dwordx4 v[80:83], v170, s[4:7], s15 offen offset:0 sc1
buffer_load_dwordx4 v[84:87], v170, s[4:7], s15 offen offset:1024 sc1
buffer_load_dwordx4 v[88:91], v170, s[4:7], s15 offen offset:2048 sc1
buffer_load_dwordx4 v[92:95], v170, s[4:7], s15 offen offset:3072 sc1
s_add_u32 s15, s15, 4096
buffer_load_dwordx4 v[96:99], v170, s[4:7], s15 offen offset:0 sc1
buffer_load_dwordx4 v[100:103], v170, s[4:7], s15 offen offset:1024 sc1
buffer_load_dwordx4 v[104:107], v170, s[4:7], s15 offen offset:2048 sc1
buffer_load_dwordx4 v[108:111], v170, s[4:7], s15 offen offset:3072 sc1
s_add_u32 s15, s15, 4096
buffer_load_dwordx4 v[112:115], v170, s[4:7], s15 offen offset:0 sc1
buffer_load_dwordx4 v[116:119], v170, s[4:7], s15 offen offset:1024 sc1
buffer_load_dwordx4 v[120:123], v170, s[4:7], s15 offen offset:2048 sc1
buffer_load_dwordx4 v[124:127], v170, s[4:7], s15 offen offset:3072 sc1
s_add_u32 s15, s15, 233472
buffer_load_dwordx2 v[180:181], v175, s[96:99], s16 offen
buffer_load_dwordx2 v[182:183], v170, s[4:7], s17 offen sc1
s_add_u32 s17, s17, 65536
main_kernel_o_body:
s_add_u32 s18, s18, 1
s_waitcnt vmcnt(34)
v_cmp_eq_u32 vcc, 0, v174
s_cmp_gt_u32 s18, 62
s_cbranch_scc1 main_kernel_o_b0
s_cbranch_vccnz main_kernel_o_b0
v_add_u32 v172, v172, v173
buffer_load_dword v174, v172, s[4:7], 0 offen sc1
s_add_u32 s21, s16, 65536
s_waitcnt vmcnt(34)
v_mfma_f32_16x16x32_bf16 v[128:131], a[0:3], v[0:3], 0
v_mfma_f32_16x16x32_bf16 v[132:135], a[128:131], v[0:3], 0
s_waitcnt vmcnt(33)
v_mfma_f32_16x16x32_bf16 v[128:131], a[4:7], v[4:7], v[128:131]
v_mfma_f32_16x16x32_bf16 v[132:135], a[132:135], v[4:7], v[132:135]
buffer_load_dwordx4 v[0:3], v170, s[4:7], s15 offen offset:0 sc1
s_waitcnt vmcnt(33)
v_mfma_f32_16x16x32_bf16 v[128:131], a[8:11], v[8:11], v[128:131]
v_mfma_f32_16x16x32_bf16 v[132:135], a[136:139], v[8:11], v[132:135]
buffer_load_dwordx4 v[4:7], v170, s[4:7], s15 offen offset:1024 sc1
s_waitcnt vmcnt(33)
v_mfma_f32_16x16x32_bf16 v[128:131], a[12:15], v[12:15], v[128:131]
v_mfma_f32_16x16x32_bf16 v[132:135], a[140:143], v[12:15], v[132:135]
buffer_load_dwordx4 v[8:11], v170, s[4:7], s15 offen offset:2048 sc1
s_waitcnt vmcnt(33)
v_mfma_f32_16x16x32_bf16 v[128:131], a[16:19], v[16:19], v[128:131]
v_mfma_f32_16x16x32_bf16 v[132:135], a[144:147], v[16:19], v[132:135]
buffer_load_dwordx4 v[12:15], v170, s[4:7], s15 offen offset:3072 sc1
s_add_u32 s15, s15, 4096
s_waitcnt vmcnt(33)
v_mfma_f32_16x16x32_bf16 v[128:131], a[20:23], v[20:23], v[128:131]
v_mfma_f32_16x16x32_bf16 v[132:135], a[148:151], v[20:23], v[132:135]
buffer_load_dwordx4 v[16:19], v170, s[4:7], s15 offen offset:0 sc1
s_waitcnt vmcnt(33)
v_mfma_f32_16x16x32_bf16 v[128:131], a[24:27], v[24:27], v[128:131]
v_mfma_f32_16x16x32_bf16 v[132:135], a[152:155], v[24:27], v[132:135]
buffer_load_dwordx4 v[20:23], v170, s[4:7], s15 offen offset:1024 sc1
s_waitcnt vmcnt(33)
v_mfma_f32_16x16x32_bf16 v[128:131], a[28:31], v[28:31], v[128:131]
v_mfma_f32_16x16x32_bf16 v[132:135], a[156:159], v[28:31], v[132:135]
buffer_load_dwordx4 v[24:27], v170, s[4:7], s15 offen offset:2048 sc1
s_waitcnt vmcnt(33)
v_mfma_f32_16x16x32_bf16 v[128:131], a[32:35], v[32:35], v[128:131]
v_mfma_f32_16x16x32_bf16 v[132:135], a[160:163], v[32:35], v[132:135]
buffer_load_dwordx4 v[28:31], v170, s[4:7], s15 offen offset:3072 sc1
s_add_u32 s15, s15, 4096
s_waitcnt vmcnt(33)
v_mfma_f32_16x16x32_bf16 v[128:131], a[36:39], v[36:39], v[128:131]
v_mfma_f32_16x16x32_bf16 v[132:135], a[164:167], v[36:39], v[132:135]
buffer_load_dwordx4 v[32:35], v170, s[4:7], s15 offen offset:0 sc1
s_waitcnt vmcnt(33)
v_mfma_f32_16x16x32_bf16 v[128:131], a[40:43], v[40:43], v[128:131]
v_mfma_f32_16x16x32_bf16 v[132:135], a[168:171], v[40:43], v[132:135]
buffer_load_dwordx4 v[36:39], v170, s[4:7], s15 offen offset:1024 sc1
s_waitcnt vmcnt(33)
v_mfma_f32_16x16x32_bf16 v[128:131], a[44:47], v[44:47], v[128:131]
v_mfma_f32_16x16x32_bf16 v[132:135], a[172:175], v[44:47], v[132:135]
buffer_load_dwordx4 v[40:43], v170, s[4:7], s15 offen offset:2048 sc1
s_waitcnt vmcnt(33)
v_mfma_f32_16x16x32_bf16 v[128:131], a[48:51], v[48:51], v[128:131]
v_mfma_f32_16x16x32_bf16 v[132:135], a[176:179], v[48:51], v[132:135]
buffer_load_dwordx4 v[44:47], v170, s[4:7], s15 offen offset:3072 sc1
s_add_u32 s15, s15, 4096
s_waitcnt vmcnt(33)
v_mfma_f32_16x16x32_bf16 v[128:131], a[52:55], v[52:55], v[128:131]
v_mfma_f32_16x16x32_bf16 v[132:135], a[180:183], v[52:55], v[132:135]
buffer_load_dwordx4 v[48:51], v170, s[4:7], s15 offen offset:0 sc1
s_waitcnt vmcnt(33)
v_mfma_f32_16x16x32_bf16 v[128:131], a[56:59], v[56:59], v[128:131]
v_mfma_f32_16x16x32_bf16 v[132:135], a[184:187], v[56:59], v[132:135]
buffer_load_dwordx4 v[52:55], v170, s[4:7], s15 offen offset:1024 sc1
s_waitcnt vmcnt(33)
v_mfma_f32_16x16x32_bf16 v[128:131], a[60:63], v[60:63], v[128:131]
v_mfma_f32_16x16x32_bf16 v[132:135], a[188:191], v[60:63], v[132:135]
buffer_load_dwordx4 v[56:59], v170, s[4:7], s15 offen offset:2048 sc1
s_waitcnt vmcnt(33)
v_mfma_f32_16x16x32_bf16 v[128:131], a[64:67], v[64:67], v[128:131]
v_mfma_f32_16x16x32_bf16 v[132:135], a[192:195], v[64:67], v[132:135]
buffer_load_dwordx4 v[60:63], v170, s[4:7], s15 offen offset:3072 sc1
s_add_u32 s15, s15, 4096
s_waitcnt vmcnt(33)
v_mfma_f32_16x16x32_bf16 v[128:131], a[68:71], v[68:71], v[128:131]
v_mfma_f32_16x16x32_bf16 v[132:135], a[196:199], v[68:71], v[132:135]
buffer_load_dwordx4 v[64:67], v170, s[4:7], s15 offen offset:0 sc1
s_waitcnt vmcnt(33)
v_mfma_f32_16x16x32_bf16 v[128:131], a[72:75], v[72:75], v[128:131]
v_mfma_f32_16x16x32_bf16 v[132:135], a[200:203], v[72:75], v[132:135]
buffer_load_dwordx4 v[68:71], v170, s[4:7], s15 offen offset:1024 sc1
s_waitcnt vmcnt(33)
v_mfma_f32_16x16x32_bf16 v[128:131], a[76:79], v[76:79], v[128:131]
v_mfma_f32_16x16x32_bf16 v[132:135], a[204:207], v[76:79], v[132:135]
buffer_load_dwordx4 v[72:75], v170, s[4:7], s15 offen offset:2048 sc1
s_waitcnt vmcnt(33)
v_mfma_f32_16x16x32_bf16 v[128:131], a[80:83], v[80:83], v[128:131]
v_mfma_f32_16x16x32_bf16 v[132:135], a[208:211], v[80:83], v[132:135]
buffer_load_dwordx4 v[76:79], v170, s[4:7], s15 offen offset:3072 sc1
s_add_u32 s15, s15, 4096
s_waitcnt vmcnt(33)
v_mfma_f32_16x16x32_bf16 v[128:131], a[84:87], v[84:87], v[128:131]
v_mfma_f32_16x16x32_bf16 v[132:135], a[212:215], v[84:87], v[132:135]
buffer_load_dwordx4 v[80:83], v170, s[4:7], s15 offen offset:0 sc1
s_waitcnt vmcnt(33)
v_mfma_f32_16x16x32_bf16 v[128:131], a[88:91], v[88:91], v[128:131]
v_mfma_f32_16x16x32_bf16 v[132:135], a[216:219], v[88:91], v[132:135]
buffer_load_dwordx4 v[84:87], v170, s[4:7], s15 offen offset:1024 sc1
s_waitcnt vmcnt(33)
v_mfma_f32_16x16x32_bf16 v[128:131], a[92:95], v[92:95], v[128:131]
v_mfma_f32_16x16x32_bf16 v[132:135], a[220:223], v[92:95], v[132:135]
buffer_load_dwordx4 v[88:91], v170, s[4:7], s15 offen offset:2048 sc1
s_waitcnt vmcnt(33)
v_mfma_f32_16x16x32_bf16 v[128:131], a[96:99], v[96:99], v[128:131]
v_mfma_f32_16x16x32_bf16 v[132:135], a[224:227], v[96:99], v[132:135]
buffer_load_dwordx4 v[92:95], v170, s[4:7], s15 offen offset:3072 sc1
s_add_u32 s15, s15, 4096
s_waitcnt vmcnt(33)
v_mfma_f32_16x16x32_bf16 v[128:131], a[100:103], v[100:103], v[128:131]
v_mfma_f32_16x16x32_bf16 v[132:135], a[228:231], v[100:103], v[132:135]
buffer_load_dwordx4 v[96:99], v170, s[4:7], s15 offen offset:0 sc1
s_waitcnt vmcnt(33)
v_mfma_f32_16x16x32_bf16 v[128:131], a[104:107], v[104:107], v[128:131]
v_mfma_f32_16x16x32_bf16 v[132:135], a[232:235], v[104:107], v[132:135]
buffer_load_dwordx4 v[100:103], v170, s[4:7], s15 offen offset:1024 sc1
s_waitcnt vmcnt(33)
v_mfma_f32_16x16x32_bf16 v[128:131], a[108:111], v[108:111], v[128:131]
v_mfma_f32_16x16x32_bf16 v[132:135], a[236:239], v[108:111], v[132:135]
buffer_load_dwordx4 v[104:107], v170, s[4:7], s15 offen offset:2048 sc1
s_waitcnt vmcnt(33)
v_mfma_f32_16x16x32_bf16 v[128:131], a[112:115], v[112:115], v[128:131]
v_mfma_f32_16x16x32_bf16 v[132:135], a[240:243], v[112:115], v[132:135]
buffer_load_dwordx4 v[108:111], v170, s[4:7], s15 offen offset:3072 sc1
s_add_u32 s15, s15, 4096
s_waitcnt vmcnt(33)
v_mfma_f32_16x16x32_bf16 v[128:131], a[116:119], v[116:119], v[128:131]
v_mfma_f32_16x16x32_bf16 v[132:135], a[244:247], v[116:119], v[132:135]
buffer_load_dwordx4 v[112:115], v170, s[4:7], s15 offen offset:0 sc1
s_waitcnt vmcnt(33)
v_mfma_f32_16x16x32_bf16 v[128:131], a[120:123], v[120:123], v[128:131]
v_mfma_f32_16x16x32_bf16 v[132:135], a[248:251], v[120:123], v[132:135]
buffer_load_dwordx4 v[116:119], v170, s[4:7], s15 offen offset:1024 sc1
s_waitcnt vmcnt(33)
v_mfma_f32_16x16x32_bf16 v[128:131], a[124:127], v[124:127], v[128:131]
v_mfma_f32_16x16x32_bf16 v[132:135], a[252:255], v[124:127], v[132:135]
buffer_load_dwordx4 v[120:123], v170, s[4:7], s15 offen offset:2048 sc1
s_waitcnt vmcnt(32)
v_lshlrev_b32 v164, 16, v180
v_and_b32 v165, 0xffff0000, v180
v_lshlrev_b32 v166, 16, v181
v_and_b32 v167, 0xffff0000, v181
v_lshlrev_b32 v160, 16, v182
v_and_b32 v161, 0xffff0000, v182
v_lshlrev_b32 v162, 16, v183
v_and_b32 v163, 0xffff0000, v183
buffer_load_dwordx4 v[124:127], v170, s[4:7], s15 offen offset:3072 sc1
s_add_u32 s15, s15, 233472
buffer_load_dwordx2 v[180:181], v175, s[96:99], s21 offen
buffer_load_dwordx2 v[182:183], v170, s[4:7], s17 offen sc1
s_add_u32 s17, s17, 65536
s_cmp_ge_u32 s14, 2
ds_write_b128 v176, v[128:131] offset:0
ds_write_b128 v176, v[132:135] offset:1024
v_xor_b32 v176, 0x4000, v176
s_waitcnt lgkmcnt(0)
s_barrier
s_cbranch_scc1 main_kernel_o_nx1
ds_read_b128 v[144:147], v177 offset:0
ds_read_b128 v[148:151], v177 offset:2048
ds_read_b128 v[152:155], v177 offset:4096
ds_read_b128 v[156:159], v177 offset:6144
v_xor_b32 v177, 0x4000, v177
s_waitcnt lgkmcnt(2)
v_pk_add_f32 v[144:145], v[144:145], v[148:149]
v_pk_add_f32 v[146:147], v[146:147], v[150:151]
s_waitcnt lgkmcnt(0)
v_pk_add_f32 v[152:153], v[152:153], v[156:157]
v_pk_add_f32 v[154:155], v[154:155], v[158:159]
v_pk_add_f32 v[144:145], v[144:145], v[152:153]
v_pk_add_f32 v[146:147], v[146:147], v[154:155]
v_pk_fma_f32 v[144:145], v[144:145], v[160:161], v[164:165]
v_pk_fma_f32 v[146:147], v[146:147], v[162:163], v[166:167]
v_cvt_pk_bf16_f32 v148, v144, v145
v_cvt_pk_bf16_f32 v149, v146, v147
buffer_store_dwordx2 v[148:149], v175, s[92:95], s16 offen
main_kernel_o_nx1:
s_add_u32 s16, s16, 65536
s_branch main_kernel_o_body
main_kernel_o_b0:
s_waitcnt vmcnt(33)
v_mfma_f32_16x16x32_bf16 v[128:131], a[0:3], v[0:3], 0
v_mfma_f32_16x16x32_bf16 v[132:135], a[128:131], v[0:3], 0
s_waitcnt vmcnt(32)
v_mfma_f32_16x16x32_bf16 v[128:131], a[4:7], v[4:7], v[128:131]
v_mfma_f32_16x16x32_bf16 v[132:135], a[132:135], v[4:7], v[132:135]
s_waitcnt vmcnt(31)
v_mfma_f32_16x16x32_bf16 v[128:131], a[8:11], v[8:11], v[128:131]
v_mfma_f32_16x16x32_bf16 v[132:135], a[136:139], v[8:11], v[132:135]
s_waitcnt vmcnt(30)
v_mfma_f32_16x16x32_bf16 v[128:131], a[12:15], v[12:15], v[128:131]
v_mfma_f32_16x16x32_bf16 v[132:135], a[140:143], v[12:15], v[132:135]
s_waitcnt vmcnt(29)
v_mfma_f32_16x16x32_bf16 v[128:131], a[16:19], v[16:19], v[128:131]
v_mfma_f32_16x16x32_bf16 v[132:135], a[144:147], v[16:19], v[132:135]
s_waitcnt vmcnt(28)
v_mfma_f32_16x16x32_bf16 v[128:131], a[20:23], v[20:23], v[128:131]
v_mfma_f32_16x16x32_bf16 v[132:135], a[148:151], v[20:23], v[132:135]
s_waitcnt vmcnt(27)
v_mfma_f32_16x16x32_bf16 v[128:131], a[24:27], v[24:27], v[128:131]
v_mfma_f32_16x16x32_bf16 v[132:135], a[152:155], v[24:27], v[132:135]
s_waitcnt vmcnt(26)
v_mfma_f32_16x16x32_bf16 v[128:131], a[28:31], v[28:31], v[128:131]
v_mfma_f32_16x16x32_bf16 v[132:135], a[156:159], v[28:31], v[132:135]
s_waitcnt vmcnt(25)
v_mfma_f32_16x16x32_bf16 v[128:131], a[32:35], v[32:35], v[128:131]
v_mfma_f32_16x16x32_bf16 v[132:135], a[160:163], v[32:35], v[132:135]
s_waitcnt vmcnt(24)
v_mfma_f32_16x16x32_bf16 v[128:131], a[36:39], v[36:39], v[128:131]
v_mfma_f32_16x16x32_bf16 v[132:135], a[164:167], v[36:39], v[132:135]
s_waitcnt vmcnt(23)
v_mfma_f32_16x16x32_bf16 v[128:131], a[40:43], v[40:43], v[128:131]
v_mfma_f32_16x16x32_bf16 v[132:135], a[168:171], v[40:43], v[132:135]
s_waitcnt vmcnt(22)
v_mfma_f32_16x16x32_bf16 v[128:131], a[44:47], v[44:47], v[128:131]
v_mfma_f32_16x16x32_bf16 v[132:135], a[172:175], v[44:47], v[132:135]
s_waitcnt vmcnt(21)
v_mfma_f32_16x16x32_bf16 v[128:131], a[48:51], v[48:51], v[128:131]
v_mfma_f32_16x16x32_bf16 v[132:135], a[176:179], v[48:51], v[132:135]
s_waitcnt vmcnt(20)
v_mfma_f32_16x16x32_bf16 v[128:131], a[52:55], v[52:55], v[128:131]
v_mfma_f32_16x16x32_bf16 v[132:135], a[180:183], v[52:55], v[132:135]
s_waitcnt vmcnt(19)
v_mfma_f32_16x16x32_bf16 v[128:131], a[56:59], v[56:59], v[128:131]
v_mfma_f32_16x16x32_bf16 v[132:135], a[184:187], v[56:59], v[132:135]
s_waitcnt vmcnt(18)
v_mfma_f32_16x16x32_bf16 v[128:131], a[60:63], v[60:63], v[128:131]
v_mfma_f32_16x16x32_bf16 v[132:135], a[188:191], v[60:63], v[132:135]
s_waitcnt vmcnt(17)
v_mfma_f32_16x16x32_bf16 v[128:131], a[64:67], v[64:67], v[128:131]
v_mfma_f32_16x16x32_bf16 v[132:135], a[192:195], v[64:67], v[132:135]
s_waitcnt vmcnt(16)
v_mfma_f32_16x16x32_bf16 v[128:131], a[68:71], v[68:71], v[128:131]
v_mfma_f32_16x16x32_bf16 v[132:135], a[196:199], v[68:71], v[132:135]
s_waitcnt vmcnt(15)
v_mfma_f32_16x16x32_bf16 v[128:131], a[72:75], v[72:75], v[128:131]
v_mfma_f32_16x16x32_bf16 v[132:135], a[200:203], v[72:75], v[132:135]
s_waitcnt vmcnt(14)
v_mfma_f32_16x16x32_bf16 v[128:131], a[76:79], v[76:79], v[128:131]
v_mfma_f32_16x16x32_bf16 v[132:135], a[204:207], v[76:79], v[132:135]
s_waitcnt vmcnt(13)
v_mfma_f32_16x16x32_bf16 v[128:131], a[80:83], v[80:83], v[128:131]
v_mfma_f32_16x16x32_bf16 v[132:135], a[208:211], v[80:83], v[132:135]
s_waitcnt vmcnt(12)
v_mfma_f32_16x16x32_bf16 v[128:131], a[84:87], v[84:87], v[128:131]
v_mfma_f32_16x16x32_bf16 v[132:135], a[212:215], v[84:87], v[132:135]
s_waitcnt vmcnt(11)
v_mfma_f32_16x16x32_bf16 v[128:131], a[88:91], v[88:91], v[128:131]
v_mfma_f32_16x16x32_bf16 v[132:135], a[216:219], v[88:91], v[132:135]
s_waitcnt vmcnt(10)
v_mfma_f32_16x16x32_bf16 v[128:131], a[92:95], v[92:95], v[128:131]
v_mfma_f32_16x16x32_bf16 v[132:135], a[220:223], v[92:95], v[132:135]
s_waitcnt vmcnt(9)
v_mfma_f32_16x16x32_bf16 v[128:131], a[96:99], v[96:99], v[128:131]
v_mfma_f32_16x16x32_bf16 v[132:135], a[224:227], v[96:99], v[132:135]
s_waitcnt vmcnt(8)
v_mfma_f32_16x16x32_bf16 v[128:131], a[100:103], v[100:103], v[128:131]
v_mfma_f32_16x16x32_bf16 v[132:135], a[228:231], v[100:103], v[132:135]
s_waitcnt vmcnt(7)
v_mfma_f32_16x16x32_bf16 v[128:131], a[104:107], v[104:107], v[128:131]
v_mfma_f32_16x16x32_bf16 v[132:135], a[232:235], v[104:107], v[132:135]
s_waitcnt vmcnt(6)
v_mfma_f32_16x16x32_bf16 v[128:131], a[108:111], v[108:111], v[128:131]
v_mfma_f32_16x16x32_bf16 v[132:135], a[236:239], v[108:111], v[132:135]
s_waitcnt vmcnt(5)
v_mfma_f32_16x16x32_bf16 v[128:131], a[112:115], v[112:115], v[128:131]
v_mfma_f32_16x16x32_bf16 v[132:135], a[240:243], v[112:115], v[132:135]
s_waitcnt vmcnt(4)
v_mfma_f32_16x16x32_bf16 v[128:131], a[116:119], v[116:119], v[128:131]
v_mfma_f32_16x16x32_bf16 v[132:135], a[244:247], v[116:119], v[132:135]
s_waitcnt vmcnt(3)
v_mfma_f32_16x16x32_bf16 v[128:131], a[120:123], v[120:123], v[128:131]
v_mfma_f32_16x16x32_bf16 v[132:135], a[248:251], v[120:123], v[132:135]
s_waitcnt vmcnt(2)
v_mfma_f32_16x16x32_bf16 v[128:131], a[124:127], v[124:127], v[128:131]
v_mfma_f32_16x16x32_bf16 v[132:135], a[252:255], v[124:127], v[132:135]
s_waitcnt vmcnt(0)
v_lshlrev_b32 v164, 16, v180
v_and_b32 v165, 0xffff0000, v180
v_lshlrev_b32 v166, 16, v181
v_and_b32 v167, 0xffff0000, v181
v_lshlrev_b32 v160, 16, v182
v_and_b32 v161, 0xffff0000, v182
v_lshlrev_b32 v162, 16, v183
v_and_b32 v163, 0xffff0000, v183
s_cmp_ge_u32 s14, 2
s_nop 0
ds_write_b128 v176, v[128:131] offset:0
ds_write_b128 v176, v[132:135] offset:1024
v_xor_b32 v176, 0x4000, v176
s_waitcnt lgkmcnt(0)
s_barrier
s_cbranch_scc1 main_kernel_o_nx0
ds_read_b128 v[144:147], v177 offset:0
ds_read_b128 v[148:151], v177 offset:2048
ds_read_b128 v[152:155], v177 offset:4096
ds_read_b128 v[156:159], v177 offset:6144
v_xor_b32 v177, 0x4000, v177
s_waitcnt lgkmcnt(2)
v_pk_add_f32 v[144:145], v[144:145], v[148:149]
v_pk_add_f32 v[146:147], v[146:147], v[150:151]
s_waitcnt lgkmcnt(0)
v_pk_add_f32 v[152:153], v[152:153], v[156:157]
v_pk_add_f32 v[154:155], v[154:155], v[158:159]
v_pk_add_f32 v[144:145], v[144:145], v[152:153]
v_pk_add_f32 v[146:147], v[146:147], v[154:155]
v_pk_fma_f32 v[144:145], v[144:145], v[160:161], v[164:165]
v_pk_fma_f32 v[146:147], v[146:147], v[162:163], v[166:167]
v_cvt_pk_bf16_f32 v148, v144, v145
v_cvt_pk_bf16_f32 v149, v146, v147
buffer_store_dwordx2 v[148:149], v175, s[92:95], s16 offen
main_kernel_o_nx0:
s_add_u32 s16, s16, 65536
s_cmp_le_u32 s18, 62
s_cbranch_scc1 main_kernel_o_top
v_add_u32 v172, v172, v173
s_add_u32 s17, s17, 65536
s_add_u32 s16, s16, 65536
s_add_u32 s15, s15, 262144
s_add_u32 s18, s18, 1
s_cmp_lt_u32 s18, 64
s_cbranch_scc1 main_kernel_o_top
s_branch main_kernel_end
main_kernel_end2:
s_endpgm
main_kernel_worker:
v_lshlrev_b32 v251, 4, v250
v_mov_b32 v240, 0xc0135761
v_mov_b32 v241, 0xc0135761
v_mov_b32 v242, 0xbdd2d3e8
v_mov_b32 v243, 0xbdd2d3e8
v_mov_b32 v244, 0x3f800000
v_mov_b32 v245, 0x3f800000
v_mov_b32 v246, 0xbfb8aa3b
v_mov_b32 v247, 0xbfb8aa3b
s_lshr_b32 s37, s14, 1
s_and_b32 s38, s14, 1
v_mov_b32 v252, 0
v_mov_b32 v224, 0
v_mov_b32 v225, 0
v_mov_b32 v226, 0
v_mov_b32 v227, 0
v_mov_b32 v228, 0
v_mov_b32 v229, 0
v_mov_b32 v230, 0
v_mov_b32 v231, 0
v_mov_b32 v232, 0
v_mov_b32 v233, 0
v_mov_b32 v234, 0
v_mov_b32 v235, 0
v_mov_b32 v249, 0
v_mov_b32 v248, 0
v_mov_b32 v128, 0
v_mov_b32 v129, 0
v_mov_b32 v130, 0
v_mov_b32 v131, 0
v_mov_b32 v132, 0
v_mov_b32 v133, 0
v_mov_b32 v134, 0
v_mov_b32 v135, 0
v_mov_b32 v136, 0
v_mov_b32 v137, 0
v_mov_b32 v138, 0
v_mov_b32 v139, 0
v_mov_b32 v140, 0
v_mov_b32 v141, 0
v_mov_b32 v142, 0
v_mov_b32 v143, 0
v_mov_b32 v144, 0
v_mov_b32 v145, 0
v_mov_b32 v146, 0
v_mov_b32 v147, 0
v_mov_b32 v148, 0
v_mov_b32 v149, 0
v_mov_b32 v150, 0
v_mov_b32 v151, 0
v_mov_b32 v152, 0
v_mov_b32 v153, 0
v_mov_b32 v154, 0
s_cmp_eq_u32 s14, 0
s_cselect_b64 s[100:101], -1, 0
s_mov_b32 s21, 0
s_mov_b32 s22, 0
s_mov_b32 s26, 0
s_mov_b32 s0, 0
s_mov_b32 s1, 0
s_mov_b32 s2, 0
s_mov_b32 s3, 0
s_mov_b32 s59, 0
s_mov_b32 s60, 0
s_mov_b32 s39, 0
s_mov_b32 s8, s40
s_and_b32 s9, s41, 0xffff
s_mov_b32 s10, 0x0
s_mov_b32 s11, 0x20000
s_cmp_lg_u32 s14, 0
s_cbranch_scc1 main_kernel_w_bar
main_kernel_w_selq:
s_lshl_b32 s32, s27, 8
s_add_u32 s32, s32, 0x841e000
s_mov_b64 exec, 1
v_mov_b32 v249, 1
buffer_atomic_add v249, off, s[4:7], s32 sc0 sc1
s_mov_b64 exec, -1
v_mov_b32 v230, 0x7fff
s_cmp_lg_u32 s27, 0
s_cbranch_scc1 main_kernel_w_q1
s_mov_b32 s32, 0x45800
v_writelane_b32 v230, s32, 0
s_mov_b32 s32, 0x6580e
v_writelane_b32 v230, s32, 1
s_mov_b32 s32, 0x404501c
v_writelane_b32 v230, s32, 2
s_mov_b32 s32, 0x49088024
v_writelane_b32 v230, s32, 3
s_mov_b32 s32, 0x49088834
v_writelane_b32 v230, s32, 4
s_mov_b32 s32, 0x48088044
v_writelane_b32 v230, s32, 5
s_mov_b32 s32, 0x40c2054
v_writelane_b32 v230, s32, 6
s_mov_b32 s32, 0x4102064
v_writelane_b32 v230, s32, 7
s_mov_b32 s32, 0x4182074
v_writelane_b32 v230, s32, 8
s_mov_b32 s32, 0x8082884
v_writelane_b32 v230, s32, 9
s_mov_b32 s32, 0x49108094
v_writelane_b32 v230, s32, 10
s_mov_b32 s32, 0x4a00b0a4
v_writelane_b32 v230, s32, 11
s_mov_b32 s32, 0x4a08b0b0
v_writelane_b32 v230, s32, 12
s_mov_b32 s32, 0x4800b0bc
v_writelane_b32 v230, s32, 13
s_mov_b32 s32, 0x4918b0cc
v_writelane_b32 v230, s32, 14
s_mov_b32 s32, 0x4a1888dc
v_writelane_b32 v230, s32, 15
s_mov_b32 s32, 0x81850ec
v_writelane_b32 v230, s32, 16
s_mov_b32 s32, 0x40838fc
v_writelane_b32 v230, s32, 17
s_mov_b32 s32, 0x4918910c
v_writelane_b32 v230, s32, 18
s_mov_b32 s32, 0x410391c
v_writelane_b32 v230, s32, 19
s_mov_b32 s32, 0x414392c
v_writelane_b32 v230, s32, 20
s_mov_b32 s32, 0x4b18813c
v_writelane_b32 v230, s32, 21
s_mov_b32 s32, 0x41c394c
v_writelane_b32 v230, s32, 22
s_mov_b32 s32, 0x795c
v_writelane_b32 v230, s32, 23
s_branch main_kernel_w_qe
main_kernel_w_q1:
s_cmp_lg_u32 s27, 1
s_cbranch_scc1 main_kernel_w_q2
s_mov_b32 s32, 0x25000
v_writelane_b32 v230, s32, 0
s_mov_b32 s32, 0x40069004
v_writelane_b32 v230, s32, 1
s_mov_b32 s32, 0x4206880c
v_writelane_b32 v230, s32, 2
s_mov_b32 s32, 0x7814
v_writelane_b32 v230, s32, 3
s_branch main_kernel_w_qe
main_kernel_w_q2:
s_cmp_lg_u32 s27, 2
s_cbranch_scc1 main_kernel_w_q3
s_mov_b32 s32, 0x800
v_writelane_b32 v230, s32, 0
s_mov_b32 s32, 0x1008
v_writelane_b32 v230, s32, 1
s_mov_b32 s32, 0x44028810
v_writelane_b32 v230, s32, 2
s_mov_b32 s32, 0x44029018
v_writelane_b32 v230, s32, 3
s_mov_b32 s32, 0x48109820
v_writelane_b32 v230, s32, 4
s_mov_b32 s32, 0x46008030
v_writelane_b32 v230, s32, 5
s_mov_b32 s32, 0x46048040
v_writelane_b32 v230, s32, 6
s_mov_b32 s32, 0x4a088850
v_writelane_b32 v230, s32, 7
s_mov_b32 s32, 0x48088860
v_writelane_b32 v230, s32, 8
s_mov_b32 s32, 0x4b109070
v_writelane_b32 v230, s32, 9
s_mov_b32 s32, 0x41c2080
v_writelane_b32 v230, s32, 10
s_mov_b32 s32, 0x4b108890
v_writelane_b32 v230, s32, 11
s_mov_b32 s32, 0x81050a0
v_writelane_b32 v230, s32, 12
s_mov_b32 s32, 0x4a1088b0
v_writelane_b32 v230, s32, 13
s_mov_b32 s32, 0x491088c0
v_writelane_b32 v230, s32, 14
s_mov_b32 s32, 0x481088d0
v_writelane_b32 v230, s32, 15
s_mov_b32 s32, 0x4908b0e0
v_writelane_b32 v230, s32, 16
s_mov_b32 s32, 0x4a1080f0
v_writelane_b32 v230, s32, 17
s_mov_b32 s32, 0x4ac0b100
v_writelane_b32 v230, s32, 18
s_mov_b32 s32, 0x4810b10c
v_writelane_b32 v230, s32, 19
s_mov_b32 s32, 0x4818b11c
v_writelane_b32 v230, s32, 20
s_mov_b32 s32, 0x4818892c
v_writelane_b32 v230, s32, 21
s_mov_b32 s32, 0x40c393c
v_writelane_b32 v230, s32, 22
s_mov_b32 s32, 0x404394c
v_writelane_b32 v230, s32, 23
s_mov_b32 s32, 0x4b18895c
v_writelane_b32 v230, s32, 24
s_mov_b32 s32, 0x796c
v_writelane_b32 v230, s32, 25
s_branch main_kernel_w_qe
main_kernel_w_q3:
s_cmp_lg_u32 s27, 3
s_cbranch_scc1 main_kernel_w_q4
s_mov_b32 s32, 0x1000800
v_writelane_b32 v230, s32, 0
s_mov_b32 s32, 0x1001008
v_writelane_b32 v230, s32, 1
s_mov_b32 s32, 0x45028810
v_writelane_b32 v230, s32, 2
s_mov_b32 s32, 0x45029018
v_writelane_b32 v230, s32, 3
s_mov_b32 s32, 0x48009820
v_writelane_b32 v230, s32, 4
s_mov_b32 s32, 0x44048030
v_writelane_b32 v230, s32, 5
s_mov_b32 s32, 0x4a089040
v_writelane_b32 v230, s32, 6
s_mov_b32 s32, 0x4b089050
v_writelane_b32 v230, s32, 7
s_mov_b32 s32, 0x4142060
v_writelane_b32 v230, s32, 8
s_mov_b32 s32, 0x4002070
v_writelane_b32 v230, s32, 9
s_mov_b32 s32, 0x4a109080
v_writelane_b32 v230, s32, 10
s_mov_b32 s32, 0x8102890
v_writelane_b32 v230, s32, 11
s_mov_b32 s32, 0x81828a0
v_writelane_b32 v230, s32, 12
s_mov_b32 s32, 0x4ac8b0b0
v_writelane_b32 v230, s32, 13
s_mov_b32 s32, 0x4910b0bc
v_writelane_b32 v230, s32, 14
s_mov_b32 s32, 0x4a10b0cc
v_writelane_b32 v230, s32, 15
s_mov_b32 s32, 0x4ad0b0d8
v_writelane_b32 v230, s32, 16
s_mov_b32 s32, 0x4ad8b0e4
v_writelane_b32 v230, s32, 17
s_mov_b32 s32, 0x4b1890f0
v_writelane_b32 v230, s32, 18
s_mov_b32 s32, 0x4a189100
v_writelane_b32 v230, s32, 19
s_mov_b32 s32, 0x48188110
v_writelane_b32 v230, s32, 20
s_mov_b32 s32, 0x4a188120
v_writelane_b32 v230, s32, 21
s_mov_b32 s32, 0x64130
v_writelane_b32 v230, s32, 22
s_mov_b32 s32, 0xe4138
v_writelane_b32 v230, s32, 23
s_mov_b32 s32, 0x44140
v_writelane_b32 v230, s32, 24
s_mov_b32 s32, 0x4148
v_writelane_b32 v230, s32, 25
s_mov_b32 s32, 0xa4150
v_writelane_b32 v230, s32, 26
s_mov_b32 s32, 0x84158
v_writelane_b32 v230, s32, 27
s_mov_b32 s32, 0x7960
v_writelane_b32 v230, s32, 28
s_branch main_kernel_w_qe
main_kernel_w_q4:
s_cmp_lg_u32 s27, 4
s_cbranch_scc1 main_kernel_w_q5
s_mov_b32 s32, 0x2000800
v_writelane_b32 v230, s32, 0
s_mov_b32 s32, 0x2001008
v_writelane_b32 v230, s32, 1
s_mov_b32 s32, 0x46028810
v_writelane_b32 v230, s32, 2
s_mov_b32 s32, 0x46029018
v_writelane_b32 v230, s32, 3
s_mov_b32 s32, 0x48089820
v_writelane_b32 v230, s32, 4
s_mov_b32 s32, 0x40068830
v_writelane_b32 v230, s32, 5
s_mov_b32 s32, 0x42069038
v_writelane_b32 v230, s32, 6
s_mov_b32 s32, 0x4b088840
v_writelane_b32 v230, s32, 7
s_mov_b32 s32, 0x49089050
v_writelane_b32 v230, s32, 8
s_mov_b32 s32, 0x4b088060
v_writelane_b32 v230, s32, 9
s_mov_b32 s32, 0x4a088070
v_writelane_b32 v230, s32, 10
s_mov_b32 s32, 0x49188880
v_writelane_b32 v230, s32, 11
s_mov_b32 s32, 0x8002890
v_writelane_b32 v230, s32, 12
s_mov_b32 s32, 0x4808b0a0
v_writelane_b32 v230, s32, 13
s_mov_b32 s32, 0x4900b0b0
v_writelane_b32 v230, s32, 14
s_mov_b32 s32, 0x481890c0
v_writelane_b32 v230, s32, 15
s_mov_b32 s32, 0x491880d0
v_writelane_b32 v230, s32, 16
s_mov_b32 s32, 0x40038e0
v_writelane_b32 v230, s32, 17
s_mov_b32 s32, 0x41838f0
v_writelane_b32 v230, s32, 18
s_mov_b32 s32, 0x124100
v_writelane_b32 v230, s32, 19
s_mov_b32 s32, 0x104108
v_writelane_b32 v230, s32, 20
s_mov_b32 s32, 0x24110
v_writelane_b32 v230, s32, 21
s_mov_b32 s32, 0xc4118
v_writelane_b32 v230, s32, 22
s_mov_b32 s32, 0x144120
v_writelane_b32 v230, s32, 23
s_mov_b32 s32, 0x7928
v_writelane_b32 v230, s32, 24
s_branch main_kernel_w_qe
main_kernel_w_q5:
s_mov_b32 s32, 0x3000800
v_writelane_b32 v230, s32, 0
s_mov_b32 s32, 0x3001008
v_writelane_b32 v230, s32, 1
s_mov_b32 s32, 0x47028810
v_writelane_b32 v230, s32, 2
s_mov_b32 s32, 0x47029018
v_writelane_b32 v230, s32, 3
s_mov_b32 s32, 0x8085020
v_writelane_b32 v230, s32, 4
s_mov_b32 s32, 0x48189830
v_writelane_b32 v230, s32, 5
s_mov_b32 s32, 0x44008040
v_writelane_b32 v230, s32, 6
s_mov_b32 s32, 0x48089050
v_writelane_b32 v230, s32, 7
s_mov_b32 s32, 0x4082060
v_writelane_b32 v230, s32, 8
s_mov_b32 s32, 0x4042070
v_writelane_b32 v230, s32, 9
s_mov_b32 s32, 0x48108080
v_writelane_b32 v230, s32, 10
s_mov_b32 s32, 0x49109090
v_writelane_b32 v230, s32, 11
s_mov_b32 s32, 0x481090a0
v_writelane_b32 v230, s32, 12
s_mov_b32 s32, 0x4b1080b0
v_writelane_b32 v230, s32, 13
s_mov_b32 s32, 0x4a18b0c0
v_writelane_b32 v230, s32, 14
s_mov_b32 s32, 0x78cc
v_writelane_b32 v230, s32, 15
main_kernel_w_qe:
v_and_b32 v229, 0x7ff, v230
main_kernel_w_dec:
s_waitcnt vmcnt(0)
v_readfirstlane_b32 s28, v249
s_nop 1
v_cmp_ge_u32 vcc, s28, v229
s_nop 1
s_bcnt1_i32_b64 s32, vcc
s_sub_u32 s32, s32, 1
v_readlane_b32 s36, v230, s32
s_nop 1
s_and_b32 s32, s36, 0x7ff
s_sub_u32 s28, s28, s32
s_bfe_u32 s32, s36, 0x3001a
s_lshr_b32 s25, s28, s32
s_lshl_b32 s33, s25, s32
s_sub_u32 s24, s28, s33
s_bfe_u32 s34, s36, 0x1001d
s_lshl_b32 s24, s24, s34
s_bfe_u32 s35, s36, 0x1001e
s_lshl_b32 s25, s25, s35
s_bfe_u32 s32, s36, 0x40011
s_add_u32 s24, s24, s32
s_bfe_u32 s32, s36, 0x50015
s_add_u32 s25, s25, s32
s_bfe_u32 s23, s36, 0x4000b
s_bfe_u32 s36, s36, 0x6000b
s_lshl_b32 s32, s24, 8
s_or_b32 s36, s36, s32
s_lshl_b32 s32, s25, 16
s_or_b32 s36, s36, s32
s_cmp_eq_u32 s23, 4
s_cselect_b32 s32, 1, 0
s_sub_u32 s48, s24, s32
s_max_i32 s48, s48, 0
s_add_u32 s49, s24, s34
s_add_u32 s49, s49, s32
s_min_u32 s49, s49, 15
s_cmp_eq_u32 s23, 6
s_cselect_b32 s51, 3, 7
s_cmp_eq_u32 s23, 7
s_cselect_b32 s51, 27, s51
s_cselect_b32 s50, 5, 4
s_add_u32 s33, s25, s35
s_lshl_b32 s34, s24, 9
s_cmp_eq_u32 s23, 8
s_cselect_b32 s51, 0, s51
s_cselect_b32 s48, s25, s48
s_cselect_b32 s49, s33, s49
s_cmp_eq_u32 s23, 8
s_cselect_b32 s63, 2, 9
s_cselect_b32 s61, 0, 0x7f000000
s_cselect_b32 s34, s34, 0
v_lshrrev_b32 v228, s50, v250
v_lshlrev_b32 v254, s50, v228
v_sub_u32 v254, v250, v254
s_cmp_lt_u32 s23, 4
s_cselect_b32 s39, 10, s23
v_min_u32 v254, s51, v254
s_lshl_b32 s39, s39, 13
s_cmp_eq_u32 s23, 3
s_cselect_b32 s34, 4, s34
v_add_u32 v228, s48, v228
s_add_u32 s39, s39, s34
s_add_u32 s39, s39, 0x8402000
v_min_u32 v228, s49, v228
s_lshl_b32 s60, s24, 10
s_add_u32 s60, s60, 0x8400000
v_lshlrev_b32 v228, s63, v228
v_lshl_add_u32 v228, v254, 4, v228
v_or_b32 v146, s61, v251
main_kernel_w_chk:
s_and_b32 s23, s36, 15
s_cmp_lg_u32 s23, 15
s_cbranch_scc1 main_kernel_w_got
s_add_u32 s27, s27, 1
s_cmp_ge_u32 s27, 6
s_cselect_b32 s27, 0, s27
s_add_u32 s52, s52, 1
s_mov_b32 s36, -1
s_lshl_b32 s32, 1, s12
s_and_b32 s32, s32, 116
s_cselect_b32 s36, -2, -1
s_cbranch_scc1 main_kernel_w_pub
s_cmp_lt_u32 s52, 6
s_cbranch_scc1 main_kernel_w_selq
s_lshl_b32 s32, s12, 5
s_add_u32 s32, s32, s13
s_sub_u32 s32, s32, 160
s_cmp_lt_u32 s32, 80
s_cselect_b32 s36, -3, -1
s_cmp_lt_u32 s32, 64
s_cselect_b32 s36, -2, s36
s_branch main_kernel_w_pub
main_kernel_w_got:
s_cmp_ge_u32 s23, 10
s_cbranch_scc1 main_kernel_w_pub
main_kernel_w_poll:
buffer_load_dword v231, v228, s[4:7], s39 offen sc1
buffer_load_dwordx4 v[232:235], v146, s[4:7], s60 offen sc1
s_waitcnt vmcnt(0)
v_min3_u32 v253, v232, v233, v234
v_min_u32 v253, v253, v235
v_or_b32 v253, s61, v253
v_min_u32 v253, v253, v231
v_cmp_eq_u32 vcc, 0, v253
s_cbranch_vccz main_kernel_w_pub
s_sleep 8
s_sub_u32 s29, s29, 1
s_cbranch_scc0 main_kernel_w_poll
s_mov_b32 s36, -1
main_kernel_w_pub:
v_mov_b32 v253, 131072
v_mov_b32 v254, s36
ds_write_b32 v253, v254
s_waitcnt lgkmcnt(0)
main_kernel_w_bar:
s_barrier
v_mov_b32 v253, 131072
ds_read_b32 v254, v253
s_mov_b32 s56, 0
s_mov_b32 s73, -1
s_mov_b32 s58, -2
s_waitcnt lgkmcnt(0)
v_readfirstlane_b32 s62, v254
s_nop 3
s_cmp_eq_u32 s62, -1
s_cbranch_scc1 main_kernel_end2
s_cmp_eq_u32 s62, -2
s_cbranch_scc1 main_kernel_wo
s_cmp_eq_u32 s62, -3
s_cbranch_scc1 main_kernel_att2
s_and_b32 s23, s62, 15
s_bfe_u32 s54, s62, 0x20004
s_bfe_u32 s24, s62, 0x80008
s_lshr_b32 s25, s62, 16
s_cmp_eq_u32 s23, 5
s_cbranch_scc1 main_kernel_w_ln2
s_cmp_eq_u32 s23, 10
s_cbranch_scc1 main_kernel_w_fill
s_cmp_eq_u32 s23, 11
s_cbranch_scc1 main_kernel_w_pref
main_kernel_w_gemm:
s_cmp_eq_u32 s54, 1
s_cbranch_scc1 main_kernel_w_c1_task
main_kernel_w_c0_task:
s_cmp_eq_u32 s23, 1
s_cbranch_scc1 main_kernel_w_c0_set1
s_cmp_eq_u32 s23, 2
s_cbranch_scc1 main_kernel_w_c0_set2
s_cmp_eq_u32 s23, 4
s_cbranch_scc1 main_kernel_w_c0_set4
s_cmp_eq_u32 s23, 7
s_cbranch_scc1 main_kernel_w_c0_set7
s_cmp_eq_u32 s23, 8
s_cbranch_scc1 main_kernel_w_c0_set8
s_branch main_kernel_end2
main_kernel_w_c0_set1:
s_mov_b32 s57, 1
s_lshl_b32 s32, s25, 8
s_add_u32 s8, s42, s32
s_addc_u32 s9, s43, 0
s_and_b32 s9, s9, 0xffff
s_sub_u32 s10, 0x800000, s32
s_mov_b32 s11, 0x20000
s_mov_b32 s30, 8192
s_mov_b32 s31, 32768
s_mul_i32 s16, s24, 262144
s_add_u32 s16, s16, 0x0
s_mov_b32 s18, 3
s_lshl_b32 s32, s24, 3
s_mul_i32 s33, s38, 4
s_add_u32 s32, s32, s33
s_mul_i32 s32, s32, 131072
s_lshl_b32 s33, s25, 12
s_add_u32 s32, s32, s33
s_mul_i32 s33, s37, 2048
s_add_u32 s32, s32, s33
s_add_u32 s21, s32, 0x1800000
s_mov_b32 s22, 131072
s_mov_b32 s26, 0x7f000000
s_branch main_kernel_w_c0_go
main_kernel_w_c0_set2:
s_mov_b32 s57, 2
s_lshl_b32 s32, s25, 8
s_add_u32 s8, s44, s32
s_addc_u32 s9, s45, 0
s_and_b32 s9, s9, 0xffff
s_sub_u32 s10, 0x800000, s32
s_mov_b32 s11, 0x20000
s_mov_b32 s30, 8192
s_mov_b32 s31, 32768
s_mul_i32 s16, s24, 262144
s_add_u32 s16, s16, 0x0
s_mov_b32 s18, 3
s_lshl_b32 s32, s24, 2
s_mul_i32 s33, s38, 2
s_add_u32 s32, s32, s33
s_lshl_b32 s32, s32, 18
s_lshl_b32 s33, s25, 13
s_add_u32 s32, s32, s33
s_mul_i32 s33, s37, 4096
s_add_u32 s32, s32, s33
s_add_u32 s21, s32, 0x2800000
s_branch main_kernel_w_c0_gov
main_kernel_w_c0_set4:
s_mov_b32 s57, 3
s_lshl_b32 s32, s25, 8
s_add_u32 s8, s66, s32
s_addc_u32 s9, s67, 0
s_and_b32 s9, s9, 0xffff
s_sub_u32 s10, 0x200000, s32
s_mov_b32 s11, 0x20000
s_mov_b32 s30, 2048
s_mov_b32 s31, 32768
s_mul_i32 s16, s24, 262144
s_add_u32 s16, s16, 0x4808000
s_mov_b32 s18, 3
s_lshl_b32 s32, s24, 3
s_mul_i32 s33, s38, 4
s_add_u32 s32, s32, s33
s_mul_i32 s32, s32, 32768
s_lshl_b32 s33, s25, 12
s_add_u32 s32, s32, s33
s_mul_i32 s33, s37, 2048
s_add_u32 s32, s32, s33
s_add_u32 s21, s32, 0x5000000
s_mov_b32 s22, 32768
s_add_u32 s26, s32, 0x0
s_branch main_kernel_w_c0_go
main_kernel_w_c0_set7:
s_mov_b32 s57, 4
s_lshl_b32 s32, s25, 8
s_add_u32 s8, s70, s32
s_addc_u32 s9, s71, 0
s_and_b32 s9, s9, 0xffff
s_sub_u32 s10, 0x700000, s32
s_mov_b32 s11, 0x20000
s_mov_b32 s30, 2048
s_mov_b32 s31, 114688
s_mul_i32 s16, s24, 917504
s_add_u32 s16, s16, 0x5400000
s_mov_b32 s18, 13
s_lshl_b32 s32, s24, 3
s_mul_i32 s33, s38, 4
s_add_u32 s32, s32, s33
s_mul_i32 s32, s32, 32768
s_lshl_b32 s33, s25, 12
s_add_u32 s32, s32, s33
s_mul_i32 s33, s37, 2048
s_add_u32 s32, s32, s33
s_add_u32 s21, s32, 0x6400000
s_mov_b32 s22, 32768
s_add_u32 s26, s32, 0x5000000
s_branch main_kernel_w_c0_go
main_kernel_w_c0_set8:
s_mov_b32 s57, 5
s_lshl_b32 s32, s25, 8
s_add_u32 s8, s46, s32
s_addc_u32 s9, s47, 0
s_and_b32 s9, s9, 0xffff
s_sub_u32 s10, 0x800000, s32
s_mov_b32 s11, 0x20000
s_mov_b32 s30, 2048
s_mov_b32 s31, 131072
s_mul_i32 s16, s24, 1048576
s_add_u32 s16, s16, 0x3800000
s_mov_b32 s18, 15
s_lshl_b32 s32, s24, 3
s_mul_i32 s33, s38, 4
s_add_u32 s32, s32, s33
s_mul_i32 s32, s32, 32768
s_lshl_b32 s33, s25, 8
s_add_u32 s34, s32, s33
s_mul_i32 s33, s37, 128
s_add_u32 s34, s34, s33
s_lshl_b32 s33, s25, 12
s_add_u32 s32, s32, s33
s_mul_i32 s33, s37, 2048
s_add_u32 s32, s32, s33
s_add_u32 s21, s32, 0x0
s_mov_b32 s22, 32768
s_add_u32 s26, s32, 0x6400000
s_mov_b32 s21, s34
v_and_b32 v253, 15, v250
v_and_b32 v254, 48, v250
v_lshl_add_u32 v252, v253, 11, v254
s_branch main_kernel_w_c0_go
main_kernel_w_c0_str:
s_mul_i32 s32, s14, 2
s_mul_i32 s32, s32, s31
v_mad_u32_u24 v137, v147, s30, v151
v_mad_u32_u24 v138, v148, s30, v152
v_mad_u32_u24 v139, v149, s30, v153
v_mad_u32_u24 v140, v150, s30, v154
v_add_u32 v141, s32, v251
s_add_u32 s32, s32, s31
s_sub_u32 s32, s32, 2048
v_add_u32 v142, s32, v251
s_mul_i32 s17, s30, 64
s_mov_b32 s15, 0
s_mov_b32 s18, 1
s_cmp_eq_u32 s73, 0
s_cbranch_scc1 main_kernel_w_c0_n_mid
s_branch main_kernel_w_c0_v_mid
main_kernel_w_c0_go:
s_mov_b32 s58, 0
s_mov_b32 s72, s18
s_cmp_lg_u32 s73, -1
s_cbranch_scc1 main_kernel_w_c0_str
s_waitcnt lgkmcnt(0)
v_lshrrev_b32 v0, 4, v250
v_bfe_u32 v1, v250, 2, 2
v_lshl_add_u32 v4, v0, 2, v1
v_and_b32 v5, 7, v4
v_mul_u32_u24 v4, 256, v4
v_and_b32 v6, 3, v250
v_lshl_add_u32 v4, v6, 3, v4
s_mul_i32 s32, s37, 4
v_xor_b32 v5, s32, v5
v_lshl_add_u32 v128, v5, 5, v4
v_xor_b32 v129, 32, v128
v_xor_b32 v130, 64, v128
v_xor_b32 v131, 96, v128
s_mul_i32 s32, s38, 8192
s_add_u32 s32, s32, 65536
v_add_u32 v136, s32, v251
v_lshrrev_b32 v2, 4, v250
v_and_b32 v3, 15, v250
s_mul_i32 s32, s14, 16
v_add_u32 v147, s32, v2
v_and_b32 v6, 7, v147
v_lshlrev_b32 v6, 1, v6
v_xor_b32 v6, v6, v3
v_lshlrev_b32 v151, 4, v6
v_add_u32 v148, 4, v147
v_and_b32 v6, 7, v148
v_lshlrev_b32 v6, 1, v6
v_xor_b32 v6, v6, v3
v_lshlrev_b32 v152, 4, v6
v_subrev_u32 v152, 1024, v152
v_add_u32 v149, 8, v147
v_and_b32 v6, 7, v149
v_lshlrev_b32 v6, 1, v6
v_xor_b32 v6, v6, v3
v_lshlrev_b32 v153, 4, v6
v_subrev_u32 v153, 2048, v153
v_add_u32 v150, 12, v147
v_and_b32 v6, 7, v150
v_lshlrev_b32 v6, 1, v6
v_xor_b32 v6, v6, v3
v_lshlrev_b32 v154, 4, v6
v_subrev_u32 v154, 3072, v154
s_mul_i32 s19, s14, 4096
s_mul_i32 s20, s14, 4096
s_add_u32 s20, s20, 65536
s_mul_i32 s32, s14, 2
s_mul_i32 s32, s32, s31
v_mad_u32_u24 v137, v147, s30, v151
v_mad_u32_u24 v138, v148, s30, v152
v_mad_u32_u24 v139, v149, s30, v153
v_mad_u32_u24 v140, v150, s30, v154
v_add_u32 v141, s32, v251
s_add_u32 s32, s32, s31
s_sub_u32 s32, s32, 2048
v_add_u32 v142, s32, v251
s_mul_i32 s17, s30, 64
s_mov_b32 s15, 0
s_waitcnt vmcnt(0)
s_add_u32 m0, s20, 0
s_nop 0
buffer_load_dwordx4 v141, s[4:7], s16 offen offset:0 sc1 lds
buffer_load_dwordx4 v141, s[4:7], s16 offen offset:1024 sc1 lds
buffer_load_dwordx4 v142, s[4:7], s16 offen offset:2048 sc1 lds
buffer_load_dwordx4 v142, s[4:7], s16 offen offset:3072 sc1 lds
s_add_u32 s16, s16, 2048
s_add_u32 m0, s19, 0
s_nop 0
buffer_load_dwordx4 v137, s[8:11], s15 offen offset:0 lds
buffer_load_dwordx4 v138, s[8:11], s15 offen offset:1024 lds
buffer_load_dwordx4 v139, s[8:11], s15 offen offset:2048 lds
buffer_load_dwordx4 v140, s[8:11], s15 offen offset:3072 lds
s_add_u32 s15, s15, s17
s_add_u32 m0, s20, 16384
s_nop 0
buffer_load_dwordx4 v141, s[4:7], s16 offen offset:0 sc1 lds
buffer_load_dwordx4 v141, s[4:7], s16 offen offset:1024 sc1 lds
buffer_load_dwordx4 v142, s[4:7], s16 offen offset:2048 sc1 lds
buffer_load_dwordx4 v142, s[4:7], s16 offen offset:3072 sc1 lds
s_add_u32 s16, s16, 2048
s_add_u32 m0, s19, 16384
s_nop 0
buffer_load_dwordx4 v137, s[8:11], s15 offen offset:0 lds
buffer_load_dwordx4 v138, s[8:11], s15 offen offset:1024 lds
buffer_load_dwordx4 v139, s[8:11], s15 offen offset:2048 lds
buffer_load_dwordx4 v140, s[8:11], s15 offen offset:3072 lds
s_add_u32 s15, s15, s17
s_add_u32 m0, s20, 32768
s_nop 0
buffer_load_dwordx4 v141, s[4:7], s16 offen offset:0 sc1 lds
buffer_load_dwordx4 v141, s[4:7], s16 offen offset:1024 sc1 lds
buffer_load_dwordx4 v142, s[4:7], s16 offen offset:2048 sc1 lds
buffer_load_dwordx4 v142, s[4:7], s16 offen offset:3072 sc1 lds
s_add_u32 s16, s16, 2048
s_add_u32 m0, s19, 32768
s_nop 0
buffer_load_dwordx4 v137, s[8:11], s15 offen offset:0 lds
buffer_load_dwordx4 v138, s[8:11], s15 offen offset:1024 lds
buffer_load_dwordx4 v139, s[8:11], s15 offen offset:2048 lds
buffer_load_dwordx4 v140, s[8:11], s15 offen offset:3072 lds
s_add_u32 s15, s15, s17
s_add_u32 m0, s20, 49152
s_nop 0
buffer_load_dwordx4 v141, s[4:7], s16 offen offset:0 sc1 lds
buffer_load_dwordx4 v141, s[4:7], s16 offen offset:1024 sc1 lds
buffer_load_dwordx4 v142, s[4:7], s16 offen offset:2048 sc1 lds
buffer_load_dwordx4 v142, s[4:7], s16 offen offset:3072 sc1 lds
s_add_u32 s16, s16, 2048
s_cmp_lg_u32 s56, 0
s_cbranch_scc1 main_kernel_w_epi
main_kernel_w_c0_n_ent:
v_mfma_f32_32x32x16_bf16 v[64:79], v[224:227], v[224:227], 0
s_waitcnt vmcnt(20)
s_barrier
ds_read_b128 v[16:19], v136 offset:0
ds_read_b64_tr_b16 v[0:1], v128 offset:0
ds_read_b64_tr_b16 v[2:3], v128 offset:4096
v_mfma_f32_32x32x16_bf16 v[80:95], v[224:227], v[224:227], 0
ds_read_b64_tr_b16 v[4:5], v129 offset:0
ds_read_b64_tr_b16 v[6:7], v129 offset:4096
ds_read_b64_tr_b16 v[8:9], v130 offset:0
v_mfma_f32_32x32x16_bf16 v[96:111], v[224:227], v[224:227], 0
ds_read_b64_tr_b16 v[10:11], v130 offset:4096
ds_read_b64_tr_b16 v[12:13], v131 offset:0
ds_read_b64_tr_b16 v[14:15], v131 offset:4096
v_mfma_f32_32x32x16_bf16 v[112:127], v[224:227], v[224:227], 0
ds_read_b128 v[20:23], v136 offset:2048
ds_read_b128 v[24:27], v136 offset:4096
ds_read_b128 v[28:31], v136 offset:6144
s_sub_u32 s18, s72, 1
s_sub_u32 s55, s72, 2
s_orn2_b32 s55, s55, s100
s_mov_b32 s73, -1
s_nop 0
main_kernel_w_c0_n_loop:
s_waitcnt lgkmcnt(0)
ds_read_b128 v[48:51], v136 offset:1024
s_add_u32 m0, s19, 49152
s_nop 0
v_mfma_f32_16x16x32_bf16 v[64:67], v[0:3], v[16:19], v[64:67]
ds_read_b64_tr_b16 v[32:33], v128 offset:8192
v_mfma_f32_16x16x32_bf16 v[68:71], v[4:7], v[16:19], v[68:71]
ds_read_b64_tr_b16 v[34:35], v128 offset:12288
buffer_load_dwordx4 v137, s[8:11], s15 offen offset:0 lds
v_mfma_f32_16x16x32_bf16 v[72:75], v[8:11], v[16:19], v[72:75]
ds_read_b64_tr_b16 v[36:37], v129 offset:8192
v_mfma_f32_16x16x32_bf16 v[76:79], v[12:15], v[16:19], v[76:79]
ds_read_b64_tr_b16 v[38:39], v129 offset:12288
v_mfma_f32_16x16x32_bf16 v[80:83], v[0:3], v[20:23], v[80:83]
ds_read_b64_tr_b16 v[40:41], v130 offset:8192
buffer_load_dwordx4 v138, s[8:11], s15 offen offset:1024 lds
v_mfma_f32_16x16x32_bf16 v[84:87], v[4:7], v[20:23], v[84:87]
ds_read_b64_tr_b16 v[42:43], v130 offset:12288
v_mfma_f32_16x16x32_bf16 v[88:91], v[8:11], v[20:23], v[88:91]
ds_read_b64_tr_b16 v[44:45], v131 offset:8192
v_mfma_f32_16x16x32_bf16 v[92:95], v[12:15], v[20:23], v[92:95]
ds_read_b64_tr_b16 v[46:47], v131 offset:12288
buffer_load_dwordx4 v139, s[8:11], s15 offen offset:2048 lds
v_mfma_f32_16x16x32_bf16 v[96:99], v[0:3], v[24:27], v[96:99]
ds_read_b128 v[52:55], v136 offset:3072
v_mfma_f32_16x16x32_bf16 v[100:103], v[4:7], v[24:27], v[100:103]
ds_read_b128 v[56:59], v136 offset:5120
buffer_load_dwordx4 v140, s[8:11], s15 offen offset:3072 lds
v_mfma_f32_16x16x32_bf16 v[104:107], v[8:11], v[24:27], v[104:107]
ds_read_b128 v[60:63], v136 offset:7168
v_mfma_f32_16x16x32_bf16 v[108:111], v[12:15], v[24:27], v[108:111]
v_mfma_f32_16x16x32_bf16 v[112:115], v[0:3], v[28:31], v[112:115]
s_add_u32 s15, s15, s17
v_mfma_f32_16x16x32_bf16 v[116:119], v[4:7], v[28:31], v[116:119]
v_mfma_f32_16x16x32_bf16 v[120:123], v[8:11], v[28:31], v[120:123]
v_mfma_f32_16x16x32_bf16 v[124:127], v[12:15], v[28:31], v[124:127]
main_kernel_w_c0_n_mid:
s_waitcnt lgkmcnt(0)
v_mfma_f32_16x16x32_bf16 v[64:67], v[32:35], v[48:51], v[64:67]
s_waitcnt vmcnt(16)
s_barrier
ds_read_b128 v[16:19], v136 offset:16384
s_add_u32 m0, s20, 0
s_nop 0
v_mfma_f32_16x16x32_bf16 v[68:71], v[36:39], v[48:51], v[68:71]
ds_read_b64_tr_b16 v[0:1], v128 offset:16384
v_mfma_f32_16x16x32_bf16 v[72:75], v[40:43], v[48:51], v[72:75]
ds_read_b64_tr_b16 v[2:3], v128 offset:20480
buffer_load_dwordx4 v141, s[4:7], s16 offen offset:0 sc1 lds
v_mfma_f32_16x16x32_bf16 v[76:79], v[44:47], v[48:51], v[76:79]
ds_read_b64_tr_b16 v[4:5], v129 offset:16384
v_mfma_f32_16x16x32_bf16 v[80:83], v[32:35], v[52:55], v[80:83]
ds_read_b64_tr_b16 v[6:7], v129 offset:20480
v_mfma_f32_16x16x32_bf16 v[84:87], v[36:39], v[52:55], v[84:87]
ds_read_b64_tr_b16 v[8:9], v130 offset:16384
buffer_load_dwordx4 v141, s[4:7], s16 offen offset:1024 sc1 lds
v_mfma_f32_16x16x32_bf16 v[88:91], v[40:43], v[52:55], v[88:91]
ds_read_b64_tr_b16 v[10:11], v130 offset:20480
v_mfma_f32_16x16x32_bf16 v[92:95], v[44:47], v[52:55], v[92:95]
ds_read_b64_tr_b16 v[12:13], v131 offset:16384
buffer_load_dwordx4 v142, s[4:7], s16 offen offset:2048 sc1 lds
v_mfma_f32_16x16x32_bf16 v[96:99], v[32:35], v[56:59], v[96:99]
ds_read_b64_tr_b16 v[14:15], v131 offset:20480
v_mfma_f32_16x16x32_bf16 v[100:103], v[36:39], v[56:59], v[100:103]
ds_read_b128 v[20:23], v136 offset:18432
v_mfma_f32_16x16x32_bf16 v[104:107], v[40:43], v[56:59], v[104:107]
ds_read_b128 v[24:27], v136 offset:20480
buffer_load_dwordx4 v142, s[4:7], s16 offen offset:3072 sc1 lds
v_mfma_f32_16x16x32_bf16 v[108:111], v[44:47], v[56:59], v[108:111]
ds_read_b128 v[28:31], v136 offset:22528
v_mfma_f32_16x16x32_bf16 v[112:115], v[32:35], v[60:63], v[112:115]
s_add_u32 s16, s16, 2048
v_mfma_f32_16x16x32_bf16 v[116:119], v[36:39], v[60:63], v[116:119]
v_mfma_f32_16x16x32_bf16 v[120:123], v[40:43], v[60:63], v[120:123]
v_mfma_f32_16x16x32_bf16 v[124:127], v[44:47], v[60:63], v[124:127]
s_waitcnt lgkmcnt(0)
ds_read_b128 v[48:51], v136 offset:17408
s_add_u32 m0, s19, 0
s_nop 0
v_mfma_f32_16x16x32_bf16 v[64:67], v[0:3], v[16:19], v[64:67]
ds_read_b64_tr_b16 v[32:33], v128 offset:24576
v_mfma_f32_16x16x32_bf16 v[68:71], v[4:7], v[16:19], v[68:71]
ds_read_b64_tr_b16 v[34:35], v128 offset:28672
buffer_load_dwordx4 v137, s[8:11], s15 offen offset:0 lds
v_mfma_f32_16x16x32_bf16 v[72:75], v[8:11], v[16:19], v[72:75]
ds_read_b64_tr_b16 v[36:37], v129 offset:24576
v_mfma_f32_16x16x32_bf16 v[76:79], v[12:15], v[16:19], v[76:79]
ds_read_b64_tr_b16 v[38:39], v129 offset:28672
v_mfma_f32_16x16x32_bf16 v[80:83], v[0:3], v[20:23], v[80:83]
ds_read_b64_tr_b16 v[40:41], v130 offset:24576
buffer_load_dwordx4 v138, s[8:11], s15 offen offset:1024 lds
v_mfma_f32_16x16x32_bf16 v[84:87], v[4:7], v[20:23], v[84:87]
ds_read_b64_tr_b16 v[42:43], v130 offset:28672
v_mfma_f32_16x16x32_bf16 v[88:91], v[8:11], v[20:23], v[88:91]
ds_read_b64_tr_b16 v[44:45], v131 offset:24576
v_mfma_f32_16x16x32_bf16 v[92:95], v[12:15], v[20:23], v[92:95]
ds_read_b64_tr_b16 v[46:47], v131 offset:28672
buffer_load_dwordx4 v139, s[8:11], s15 offen offset:2048 lds
v_mfma_f32_16x16x32_bf16 v[96:99], v[0:3], v[24:27], v[96:99]
ds_read_b128 v[52:55], v136 offset:19456
v_mfma_f32_16x16x32_bf16 v[100:103], v[4:7], v[24:27], v[100:103]
ds_read_b128 v[56:59], v136 offset:21504
buffer_load_dwordx4 v140, s[8:11], s15 offen offset:3072 lds
v_mfma_f32_16x16x32_bf16 v[104:107], v[8:11], v[24:27], v[104:107]
ds_read_b128 v[60:63], v136 offset:23552
v_mfma_f32_16x16x32_bf16 v[108:111], v[12:15], v[24:27], v[108:111]
v_mfma_f32_16x16x32_bf16 v[112:115], v[0:3], v[28:31], v[112:115]
s_add_u32 s15, s15, s17
v_mfma_f32_16x16x32_bf16 v[116:119], v[4:7], v[28:31], v[116:119]
v_mfma_f32_16x16x32_bf16 v[120:123], v[8:11], v[28:31], v[120:123]
v_mfma_f32_16x16x32_bf16 v[124:127], v[12:15], v[28:31], v[124:127]
s_waitcnt lgkmcnt(0)
v_mfma_f32_16x16x32_bf16 v[64:67], v[32:35], v[48:51], v[64:67]
s_waitcnt vmcnt(16)
s_barrier
ds_read_b128 v[16:19], v136 offset:32768
s_add_u32 m0, s20, 16384
s_nop 0
v_mfma_f32_16x16x32_bf16 v[68:71], v[36:39], v[48:51], v[68:71]
ds_read_b64_tr_b16 v[0:1], v128 offset:32768
v_mfma_f32_16x16x32_bf16 v[72:75], v[40:43], v[48:51], v[72:75]
ds_read_b64_tr_b16 v[2:3], v128 offset:36864
buffer_load_dwordx4 v141, s[4:7], s16 offen offset:0 sc1 lds
v_mfma_f32_16x16x32_bf16 v[76:79], v[44:47], v[48:51], v[76:79]
ds_read_b64_tr_b16 v[4:5], v129 offset:32768
v_mfma_f32_16x16x32_bf16 v[80:83], v[32:35], v[52:55], v[80:83]
ds_read_b64_tr_b16 v[6:7], v129 offset:36864
v_mfma_f32_16x16x32_bf16 v[84:87], v[36:39], v[52:55], v[84:87]
ds_read_b64_tr_b16 v[8:9], v130 offset:32768
buffer_load_dwordx4 v141, s[4:7], s16 offen offset:1024 sc1 lds
v_mfma_f32_16x16x32_bf16 v[88:91], v[40:43], v[52:55], v[88:91]
ds_read_b64_tr_b16 v[10:11], v130 offset:36864
v_mfma_f32_16x16x32_bf16 v[92:95], v[44:47], v[52:55], v[92:95]
ds_read_b64_tr_b16 v[12:13], v131 offset:32768
buffer_load_dwordx4 v142, s[4:7], s16 offen offset:2048 sc1 lds
v_mfma_f32_16x16x32_bf16 v[96:99], v[32:35], v[56:59], v[96:99]
ds_read_b64_tr_b16 v[14:15], v131 offset:36864
v_mfma_f32_16x16x32_bf16 v[100:103], v[36:39], v[56:59], v[100:103]
ds_read_b128 v[20:23], v136 offset:34816
v_mfma_f32_16x16x32_bf16 v[104:107], v[40:43], v[56:59], v[104:107]
ds_read_b128 v[24:27], v136 offset:36864
buffer_load_dwordx4 v142, s[4:7], s16 offen offset:3072 sc1 lds
v_mfma_f32_16x16x32_bf16 v[108:111], v[44:47], v[56:59], v[108:111]
ds_read_b128 v[28:31], v136 offset:38912
v_mfma_f32_16x16x32_bf16 v[112:115], v[32:35], v[60:63], v[112:115]
s_add_u32 s16, s16, 2048
v_mfma_f32_16x16x32_bf16 v[116:119], v[36:39], v[60:63], v[116:119]
v_mfma_f32_16x16x32_bf16 v[120:123], v[40:43], v[60:63], v[120:123]
v_mfma_f32_16x16x32_bf16 v[124:127], v[44:47], v[60:63], v[124:127]
s_waitcnt lgkmcnt(0)
ds_read_b128 v[48:51], v136 offset:33792
s_add_u32 m0, s19, 16384
s_nop 0
v_mfma_f32_16x16x32_bf16 v[64:67], v[0:3], v[16:19], v[64:67]
ds_read_b64_tr_b16 v[32:33], v128 offset:40960
v_mfma_f32_16x16x32_bf16 v[68:71], v[4:7], v[16:19], v[68:71]
ds_read_b64_tr_b16 v[34:35], v128 offset:45056
buffer_load_dwordx4 v137, s[8:11], s15 offen offset:0 lds
v_mfma_f32_16x16x32_bf16 v[72:75], v[8:11], v[16:19], v[72:75]
ds_read_b64_tr_b16 v[36:37], v129 offset:40960
v_mfma_f32_16x16x32_bf16 v[76:79], v[12:15], v[16:19], v[76:79]
ds_read_b64_tr_b16 v[38:39], v129 offset:45056
v_mfma_f32_16x16x32_bf16 v[80:83], v[0:3], v[20:23], v[80:83]
ds_read_b64_tr_b16 v[40:41], v130 offset:40960
buffer_load_dwordx4 v138, s[8:11], s15 offen offset:1024 lds
v_mfma_f32_16x16x32_bf16 v[84:87], v[4:7], v[20:23], v[84:87]
ds_read_b64_tr_b16 v[42:43], v130 offset:45056
v_mfma_f32_16x16x32_bf16 v[88:91], v[8:11], v[20:23], v[88:91]
ds_read_b64_tr_b16 v[44:45], v131 offset:40960
v_mfma_f32_16x16x32_bf16 v[92:95], v[12:15], v[20:23], v[92:95]
ds_read_b64_tr_b16 v[46:47], v131 offset:45056
buffer_load_dwordx4 v139, s[8:11], s15 offen offset:2048 lds
v_mfma_f32_16x16x32_bf16 v[96:99], v[0:3], v[24:27], v[96:99]
ds_read_b128 v[52:55], v136 offset:35840
v_mfma_f32_16x16x32_bf16 v[100:103], v[4:7], v[24:27], v[100:103]
ds_read_b128 v[56:59], v136 offset:37888
buffer_load_dwordx4 v140, s[8:11], s15 offen offset:3072 lds
v_mfma_f32_16x16x32_bf16 v[104:107], v[8:11], v[24:27], v[104:107]
ds_read_b128 v[60:63], v136 offset:39936
v_mfma_f32_16x16x32_bf16 v[108:111], v[12:15], v[24:27], v[108:111]
v_mfma_f32_16x16x32_bf16 v[112:115], v[0:3], v[28:31], v[112:115]
s_add_u32 s15, s15, s17
v_mfma_f32_16x16x32_bf16 v[116:119], v[4:7], v[28:31], v[116:119]
v_mfma_f32_16x16x32_bf16 v[120:123], v[8:11], v[28:31], v[120:123]
v_mfma_f32_16x16x32_bf16 v[124:127], v[12:15], v[28:31], v[124:127]
s_waitcnt lgkmcnt(0)
v_mfma_f32_16x16x32_bf16 v[64:67], v[32:35], v[48:51], v[64:67]
s_waitcnt vmcnt(16)
s_barrier
ds_read_b128 v[16:19], v136 offset:49152
s_add_u32 m0, s20, 32768
s_nop 0
v_mfma_f32_16x16x32_bf16 v[68:71], v[36:39], v[48:51], v[68:71]
ds_read_b64_tr_b16 v[0:1], v128 offset:49152
v_mfma_f32_16x16x32_bf16 v[72:75], v[40:43], v[48:51], v[72:75]
ds_read_b64_tr_b16 v[2:3], v128 offset:53248
buffer_load_dwordx4 v141, s[4:7], s16 offen offset:0 sc1 lds
v_mfma_f32_16x16x32_bf16 v[76:79], v[44:47], v[48:51], v[76:79]
ds_read_b64_tr_b16 v[4:5], v129 offset:49152
v_mfma_f32_16x16x32_bf16 v[80:83], v[32:35], v[52:55], v[80:83]
ds_read_b64_tr_b16 v[6:7], v129 offset:53248
v_mfma_f32_16x16x32_bf16 v[84:87], v[36:39], v[52:55], v[84:87]
ds_read_b64_tr_b16 v[8:9], v130 offset:49152
buffer_load_dwordx4 v141, s[4:7], s16 offen offset:1024 sc1 lds
v_mfma_f32_16x16x32_bf16 v[88:91], v[40:43], v[52:55], v[88:91]
ds_read_b64_tr_b16 v[10:11], v130 offset:53248
v_mfma_f32_16x16x32_bf16 v[92:95], v[44:47], v[52:55], v[92:95]
ds_read_b64_tr_b16 v[12:13], v131 offset:49152
buffer_load_dwordx4 v142, s[4:7], s16 offen offset:2048 sc1 lds
v_mfma_f32_16x16x32_bf16 v[96:99], v[32:35], v[56:59], v[96:99]
ds_read_b64_tr_b16 v[14:15], v131 offset:53248
v_mfma_f32_16x16x32_bf16 v[100:103], v[36:39], v[56:59], v[100:103]
ds_read_b128 v[20:23], v136 offset:51200
v_mfma_f32_16x16x32_bf16 v[104:107], v[40:43], v[56:59], v[104:107]
ds_read_b128 v[24:27], v136 offset:53248
buffer_load_dwordx4 v142, s[4:7], s16 offen offset:3072 sc1 lds
v_mfma_f32_16x16x32_bf16 v[108:111], v[44:47], v[56:59], v[108:111]
ds_read_b128 v[28:31], v136 offset:55296
v_mfma_f32_16x16x32_bf16 v[112:115], v[32:35], v[60:63], v[112:115]
s_add_u32 s16, s16, 2048
v_mfma_f32_16x16x32_bf16 v[116:119], v[36:39], v[60:63], v[116:119]
v_mfma_f32_16x16x32_bf16 v[120:123], v[40:43], v[60:63], v[120:123]
v_mfma_f32_16x16x32_bf16 v[124:127], v[44:47], v[60:63], v[124:127]
s_waitcnt lgkmcnt(0)
ds_read_b128 v[48:51], v136 offset:50176
s_add_u32 m0, s19, 32768
s_nop 0
v_mfma_f32_16x16x32_bf16 v[64:67], v[0:3], v[16:19], v[64:67]
ds_read_b64_tr_b16 v[32:33], v128 offset:57344
v_mfma_f32_16x16x32_bf16 v[68:71], v[4:7], v[16:19], v[68:71]
ds_read_b64_tr_b16 v[34:35], v128 offset:61440
buffer_load_dwordx4 v137, s[8:11], s15 offen offset:0 lds
v_mfma_f32_16x16x32_bf16 v[72:75], v[8:11], v[16:19], v[72:75]
ds_read_b64_tr_b16 v[36:37], v129 offset:57344
v_mfma_f32_16x16x32_bf16 v[76:79], v[12:15], v[16:19], v[76:79]
ds_read_b64_tr_b16 v[38:39], v129 offset:61440
v_mfma_f32_16x16x32_bf16 v[80:83], v[0:3], v[20:23], v[80:83]
ds_read_b64_tr_b16 v[40:41], v130 offset:57344
buffer_load_dwordx4 v138, s[8:11], s15 offen offset:1024 lds
v_mfma_f32_16x16x32_bf16 v[84:87], v[4:7], v[20:23], v[84:87]
ds_read_b64_tr_b16 v[42:43], v130 offset:61440
v_mfma_f32_16x16x32_bf16 v[88:91], v[8:11], v[20:23], v[88:91]
ds_read_b64_tr_b16 v[44:45], v131 offset:57344
v_mfma_f32_16x16x32_bf16 v[92:95], v[12:15], v[20:23], v[92:95]
ds_read_b64_tr_b16 v[46:47], v131 offset:61440
buffer_load_dwordx4 v139, s[8:11], s15 offen offset:2048 lds
v_mfma_f32_16x16x32_bf16 v[96:99], v[0:3], v[24:27], v[96:99]
ds_read_b128 v[52:55], v136 offset:52224
v_mfma_f32_16x16x32_bf16 v[100:103], v[4:7], v[24:27], v[100:103]
ds_read_b128 v[56:59], v136 offset:54272
buffer_load_dwordx4 v140, s[8:11], s15 offen offset:3072 lds
v_mfma_f32_16x16x32_bf16 v[104:107], v[8:11], v[24:27], v[104:107]
ds_read_b128 v[60:63], v136 offset:56320
v_mfma_f32_16x16x32_bf16 v[108:111], v[12:15], v[24:27], v[108:111]
v_mfma_f32_16x16x32_bf16 v[112:115], v[0:3], v[28:31], v[112:115]
s_add_u32 s15, s15, s17
v_mfma_f32_16x16x32_bf16 v[116:119], v[4:7], v[28:31], v[116:119]
v_mfma_f32_16x16x32_bf16 v[120:123], v[8:11], v[28:31], v[120:123]
v_mfma_f32_16x16x32_bf16 v[124:127], v[12:15], v[28:31], v[124:127]
s_waitcnt lgkmcnt(0)
v_mfma_f32_16x16x32_bf16 v[64:67], v[32:35], v[48:51], v[64:67]
s_waitcnt vmcnt(16)
s_barrier
ds_read_b128 v[16:19], v136 offset:0
s_add_u32 m0, s20, 49152
s_nop 0
v_mfma_f32_16x16x32_bf16 v[68:71], v[36:39], v[48:51], v[68:71]
ds_read_b64_tr_b16 v[0:1], v128 offset:0
v_mfma_f32_16x16x32_bf16 v[72:75], v[40:43], v[48:51], v[72:75]
ds_read_b64_tr_b16 v[2:3], v128 offset:4096
buffer_load_dwordx4 v141, s[4:7], s16 offen offset:0 sc1 lds
v_mfma_f32_16x16x32_bf16 v[76:79], v[44:47], v[48:51], v[76:79]
ds_read_b64_tr_b16 v[4:5], v129 offset:0
v_mfma_f32_16x16x32_bf16 v[80:83], v[32:35], v[52:55], v[80:83]
ds_read_b64_tr_b16 v[6:7], v129 offset:4096
v_mfma_f32_16x16x32_bf16 v[84:87], v[36:39], v[52:55], v[84:87]
ds_read_b64_tr_b16 v[8:9], v130 offset:0
buffer_load_dwordx4 v141, s[4:7], s16 offen offset:1024 sc1 lds
v_mfma_f32_16x16x32_bf16 v[88:91], v[40:43], v[52:55], v[88:91]
ds_read_b64_tr_b16 v[10:11], v130 offset:4096
v_mfma_f32_16x16x32_bf16 v[92:95], v[44:47], v[52:55], v[92:95]
ds_read_b64_tr_b16 v[12:13], v131 offset:0
buffer_load_dwordx4 v142, s[4:7], s16 offen offset:2048 sc1 lds
v_mfma_f32_16x16x32_bf16 v[96:99], v[32:35], v[56:59], v[96:99]
ds_read_b64_tr_b16 v[14:15], v131 offset:4096
v_mfma_f32_16x16x32_bf16 v[100:103], v[36:39], v[56:59], v[100:103]
ds_read_b128 v[20:23], v136 offset:2048
v_mfma_f32_16x16x32_bf16 v[104:107], v[40:43], v[56:59], v[104:107]
ds_read_b128 v[24:27], v136 offset:4096
buffer_load_dwordx4 v142, s[4:7], s16 offen offset:3072 sc1 lds
v_mfma_f32_16x16x32_bf16 v[108:111], v[44:47], v[56:59], v[108:111]
ds_read_b128 v[28:31], v136 offset:6144
v_mfma_f32_16x16x32_bf16 v[112:115], v[32:35], v[60:63], v[112:115]
s_add_u32 s16, s16, 2048
v_mfma_f32_16x16x32_bf16 v[116:119], v[36:39], v[60:63], v[116:119]
v_mfma_f32_16x16x32_bf16 v[120:123], v[40:43], v[60:63], v[120:123]
v_mfma_f32_16x16x32_bf16 v[124:127], v[44:47], v[60:63], v[124:127]
s_sub_u32 s18, s18, 1
s_cmp_eq_u32 s18, s55
s_cbranch_scc1 main_kernel_w_c0_n_ev
s_cmp_lg_u32 s18, 0
s_cbranch_scc1 main_kernel_w_c0_n_loop
s_cmp_lg_u32 s73, -1
s_cbranch_scc1 main_kernel_w_epn
s_waitcnt lgkmcnt(0)
ds_read_b128 v[48:51], v136 offset:1024
s_add_u32 m0, s19, 49152
s_nop 0
v_mfma_f32_16x16x32_bf16 v[64:67], v[0:3], v[16:19], v[64:67]
ds_read_b64_tr_b16 v[32:33], v128 offset:8192
s_add_u32 s32, s23, 1
s_bitcmp0_b32 s32, 2
s_cselect_b32 s34, 7, 2
s_cselect_b32 s35, 2, 4
s_lshl_b32 s59, s23, 13
s_add_u32 s59, s59, 0x8404000
v_mfma_f32_16x16x32_bf16 v[68:71], v[4:7], v[16:19], v[68:71]
ds_read_b64_tr_b16 v[34:35], v128 offset:12288
buffer_load_dwordx4 v137, s[8:11], s15 offen offset:0 lds
v_lshrrev_b32 v253, 3, v250
v_add_lshl_u32 v253, s24, v253, 9
v_mfma_f32_16x16x32_bf16 v[72:75], v[8:11], v[16:19], v[72:75]
ds_read_b64_tr_b16 v[36:37], v129 offset:8192
v_and_b32 v254, 3, v250
v_lshl_add_u32 v253, v254, s34, v253
v_mfma_f32_16x16x32_bf16 v[76:79], v[12:15], v[16:19], v[76:79]
ds_read_b64_tr_b16 v[38:39], v129 offset:12288
v_bfe_u32 v254, v250, 2, 1
v_add_u32 v254, s25, v254
v_lshl_add_u32 v248, v254, s35, v253
v_mfma_f32_16x16x32_bf16 v[80:83], v[0:3], v[20:23], v[80:83]
ds_read_b64_tr_b16 v[40:41], v130 offset:8192
buffer_load_dwordx4 v138, s[8:11], s15 offen offset:1024 lds
s_lshl_b32 s0, 4, s54
v_readfirstlane_b32 s28, v249
v_mfma_f32_16x16x32_bf16 v[84:87], v[4:7], v[20:23], v[84:87]
ds_read_b64_tr_b16 v[42:43], v130 offset:12288
s_nop 1
v_cmp_ge_u32 vcc, s28, v229
v_mfma_f32_16x16x32_bf16 v[88:91], v[8:11], v[20:23], v[88:91]
ds_read_b64_tr_b16 v[44:45], v131 offset:8192
s_nop 1
s_bcnt1_i32_b64 s32, vcc
v_mfma_f32_16x16x32_bf16 v[92:95], v[12:15], v[20:23], v[92:95]
ds_read_b64_tr_b16 v[46:47], v131 offset:12288
buffer_load_dwordx4 v139, s[8:11], s15 offen offset:2048 lds
s_sub_u32 s32, s32, 1
v_readlane_b32 s36, v230, s32
s_nop 1
v_mfma_f32_16x16x32_bf16 v[96:99], v[0:3], v[24:27], v[96:99]
ds_read_b128 v[52:55], v136 offset:3072
s_and_b32 s32, s36, 0x7ff
s_sub_u32 s28, s28, s32
v_mfma_f32_16x16x32_bf16 v[100:103], v[4:7], v[24:27], v[100:103]
ds_read_b128 v[56:59], v136 offset:5120
buffer_load_dwordx4 v140, s[8:11], s15 offen offset:3072 lds
s_bfe_u32 s32, s36, 0x3001a
s_lshr_b32 s25, s28, s32
v_mfma_f32_16x16x32_bf16 v[104:107], v[8:11], v[24:27], v[104:107]
ds_read_b128 v[60:63], v136 offset:7168
s_lshl_b32 s33, s25, s32
s_sub_u32 s24, s28, s33
v_mfma_f32_16x16x32_bf16 v[108:111], v[12:15], v[24:27], v[108:111]
s_bfe_u32 s34, s36, 0x1001d
s_lshl_b32 s24, s24, s34
s_bfe_u32 s35, s36, 0x1001e
v_mfma_f32_16x16x32_bf16 v[112:115], v[0:3], v[28:31], v[112:115]
s_add_u32 s15, s15, s17
s_lshl_b32 s25, s25, s35
s_bfe_u32 s32, s36, 0x40011
v_mfma_f32_16x16x32_bf16 v[116:119], v[4:7], v[28:31], v[116:119]
s_add_u32 s24, s24, s32
s_bfe_u32 s32, s36, 0x50015
v_mfma_f32_16x16x32_bf16 v[120:123], v[8:11], v[28:31], v[120:123]
s_add_u32 s25, s25, s32
s_bfe_u32 s23, s36, 0x4000b
v_mfma_f32_16x16x32_bf16 v[124:127], v[12:15], v[28:31], v[124:127]
s_waitcnt lgkmcnt(0)
v_mfma_f32_16x16x32_bf16 v[64:67], v[32:35], v[48:51], v[64:67]
s_waitcnt vmcnt(16)
s_barrier
ds_read_b128 v[16:19], v136 offset:16384
s_add_u32 m0, s20, 0
s_nop 0
s_bfe_u32 s36, s36, 0x6000b
s_lshl_b32 s32, s24, 8
s_or_b32 s36, s36, s32
v_mfma_f32_16x16x32_bf16 v[68:71], v[36:39], v[48:51], v[68:71]
ds_read_b64_tr_b16 v[0:1], v128 offset:16384
s_lshl_b32 s32, s25, 16
s_or_b32 s36, s36, s32
v_mfma_f32_16x16x32_bf16 v[72:75], v[40:43], v[48:51], v[72:75]
ds_read_b64_tr_b16 v[2:3], v128 offset:20480
buffer_load_dwordx4 v141, s[4:7], s16 offen offset:0 sc1 lds
s_cmp_eq_u32 s23, 4
s_cselect_b32 s32, 1, 0
s_sub_u32 s48, s24, s32
v_mfma_f32_16x16x32_bf16 v[76:79], v[44:47], v[48:51], v[76:79]
ds_read_b64_tr_b16 v[4:5], v129 offset:16384
s_max_i32 s48, s48, 0
s_add_u32 s49, s24, s34
s_add_u32 s49, s49, s32
v_mfma_f32_16x16x32_bf16 v[80:83], v[32:35], v[52:55], v[80:83]
ds_read_b64_tr_b16 v[6:7], v129 offset:20480
s_min_u32 s49, s49, 15
s_cmp_eq_u32 s23, 6
s_cselect_b32 s51, 3, 7
v_mfma_f32_16x16x32_bf16 v[84:87], v[36:39], v[52:55], v[84:87]
ds_read_b64_tr_b16 v[8:9], v130 offset:16384
buffer_load_dwordx4 v141, s[4:7], s16 offen offset:1024 sc1 lds
s_cmp_eq_u32 s23, 7
s_cselect_b32 s51, 27, s51
s_cselect_b32 s50, 5, 4
s_add_u32 s33, s25, s35
v_mfma_f32_16x16x32_bf16 v[88:91], v[40:43], v[52:55], v[88:91]
ds_read_b64_tr_b16 v[10:11], v130 offset:20480
s_lshl_b32 s34, s24, 9
s_cmp_eq_u32 s23, 8
s_cselect_b32 s51, 0, s51
s_cselect_b32 s48, s25, s48
s_cselect_b32 s49, s33, s49
v_mfma_f32_16x16x32_bf16 v[92:95], v[44:47], v[52:55], v[92:95]
ds_read_b64_tr_b16 v[12:13], v131 offset:16384
buffer_load_dwordx4 v142, s[4:7], s16 offen offset:2048 sc1 lds
s_cmp_eq_u32 s23, 8
s_cselect_b32 s63, 2, 9
s_cselect_b32 s61, 0, 0x7f000000
s_cselect_b32 s34, s34, 0
v_lshrrev_b32 v228, s50, v250
v_lshlrev_b32 v254, s50, v228
v_mfma_f32_16x16x32_bf16 v[96:99], v[32:35], v[56:59], v[96:99]
ds_read_b64_tr_b16 v[14:15], v131 offset:20480
v_sub_u32 v254, v250, v254
s_cmp_lt_u32 s23, 4
s_cselect_b32 s39, 10, s23
v_mfma_f32_16x16x32_bf16 v[100:103], v[36:39], v[56:59], v[100:103]
ds_read_b128 v[20:23], v136 offset:18432
v_min_u32 v254, s51, v254
s_lshl_b32 s39, s39, 13
v_mfma_f32_16x16x32_bf16 v[104:107], v[40:43], v[56:59], v[104:107]
ds_read_b128 v[24:27], v136 offset:20480
buffer_load_dwordx4 v142, s[4:7], s16 offen offset:3072 sc1 lds
s_cmp_eq_u32 s23, 3
s_cselect_b32 s34, 4, s34
v_add_u32 v228, s48, v228
v_mfma_f32_16x16x32_bf16 v[108:111], v[44:47], v[56:59], v[108:111]
ds_read_b128 v[28:31], v136 offset:22528
s_add_u32 s39, s39, s34
s_add_u32 s39, s39, 0x8402000
v_min_u32 v228, s49, v228
v_mfma_f32_16x16x32_bf16 v[112:115], v[32:35], v[60:63], v[112:115]
s_add_u32 s16, s16, 2048
s_lshl_b32 s60, s24, 10
s_add_u32 s60, s60, 0x8400000
v_mfma_f32_16x16x32_bf16 v[116:119], v[36:39], v[60:63], v[116:119]
v_lshlrev_b32 v228, s63, v228
v_lshl_add_u32 v228, v254, 4, v228
v_mfma_f32_16x16x32_bf16 v[120:123], v[40:43], v[60:63], v[120:123]
v_or_b32 v146, s61, v251
s_mov_b64 exec, s[100:101]
buffer_load_dword v231, v228, s[4:7], s39 offen sc1
buffer_load_dwordx4 v[232:235], v146, s[4:7], s60 offen sc1
s_mov_b64 exec, -1
v_mfma_f32_16x16x32_bf16 v[124:127], v[44:47], v[60:63], v[124:127]
s_waitcnt lgkmcnt(0)
ds_read_b128 v[48:51], v136 offset:17408
s_add_u32 m0, s19, 0
s_nop 0
v_mfma_f32_16x16x32_bf16 v[64:67], v[0:3], v[16:19], v[64:67]
ds_read_b64_tr_b16 v[32:33], v128 offset:24576
s_mov_b32 s1, s21
v_mfma_f32_16x16x32_bf16 v[68:71], v[4:7], v[16:19], v[68:71]
ds_read_b64_tr_b16 v[34:35], v128 offset:28672
buffer_load_dwordx4 v137, s[8:11], s15 offen offset:0 lds
s_mov_b32 s2, s22
v_mfma_f32_16x16x32_bf16 v[72:75], v[8:11], v[16:19], v[72:75]
ds_read_b64_tr_b16 v[36:37], v129 offset:24576
s_mov_b32 s3, s26
v_mfma_f32_16x16x32_bf16 v[76:79], v[12:15], v[16:19], v[76:79]
ds_read_b64_tr_b16 v[38:39], v129 offset:28672
s_mov_b32 s56, s57
v_mfma_f32_16x16x32_bf16 v[80:83], v[0:3], v[20:23], v[80:83]
ds_read_b64_tr_b16 v[40:41], v130 offset:24576
buffer_load_dwordx4 v138, s[8:11], s15 offen offset:1024 lds
v_mfma_f32_16x16x32_bf16 v[84:87], v[4:7], v[20:23], v[84:87]
ds_read_b64_tr_b16 v[42:43], v130 offset:28672
v_mov_b32 v145, v252
v_mfma_f32_16x16x32_bf16 v[88:91], v[8:11], v[20:23], v[88:91]
ds_read_b64_tr_b16 v[44:45], v131 offset:24576
v_mov_b32 v255, 131072
v_mfma_f32_16x16x32_bf16 v[92:95], v[12:15], v[20:23], v[92:95]
ds_read_b64_tr_b16 v[46:47], v131 offset:28672
buffer_load_dwordx4 v139, s[8:11], s15 offen offset:2048 lds
s_add_u32 s32, s3, 0
v_mfma_f32_16x16x32_bf16 v[96:99], v[0:3], v[24:27], v[96:99]
ds_read_b128 v[52:55], v136 offset:19456
buffer_load_dwordx4 v[192:195], v251, s[4:7], s32 offen offset:0 sc1
v_mfma_f32_16x16x32_bf16 v[100:103], v[4:7], v[24:27], v[100:103]
ds_read_b128 v[56:59], v136 offset:21504
buffer_load_dwordx4 v140, s[8:11], s15 offen offset:3072 lds
v_mfma_f32_16x16x32_bf16 v[104:107], v[8:11], v[24:27], v[104:107]
ds_read_b128 v[60:63], v136 offset:23552
buffer_load_dwordx4 v[196:199], v251, s[4:7], s32 offen offset:1024 sc1
v_mfma_f32_16x16x32_bf16 v[108:111], v[12:15], v[24:27], v[108:111]
s_add_u32 s32, s3, 32768
v_mfma_f32_16x16x32_bf16 v[112:115], v[0:3], v[28:31], v[112:115]
s_add_u32 s15, s15, s17
buffer_load_dwordx4 v[200:203], v251, s[4:7], s32 offen offset:0 sc1
v_mfma_f32_16x16x32_bf16 v[116:119], v[4:7], v[28:31], v[116:119]
buffer_load_dwordx4 v[204:207], v251, s[4:7], s32 offen offset:1024 sc1
v_mfma_f32_16x16x32_bf16 v[120:123], v[8:11], v[28:31], v[120:123]
v_mfma_f32_16x16x32_bf16 v[124:127], v[12:15], v[28:31], v[124:127]
s_waitcnt lgkmcnt(0)
v_mfma_f32_16x16x32_bf16 v[64:67], v[32:35], v[48:51], v[64:67]
s_waitcnt vmcnt(20)
s_barrier
ds_read_b128 v[16:19], v136 offset:32768
s_add_u32 m0, s20, 16384
s_nop 0
s_add_u32 s32, s3, 65536
v_mfma_f32_16x16x32_bf16 v[68:71], v[36:39], v[48:51], v[68:71]
ds_read_b64_tr_b16 v[0:1], v128 offset:32768
v_mfma_f32_16x16x32_bf16 v[72:75], v[40:43], v[48:51], v[72:75]
ds_read_b64_tr_b16 v[2:3], v128 offset:36864
buffer_load_dwordx4 v141, s[4:7], s16 offen offset:0 sc1 lds
buffer_load_dwordx4 v[208:211], v251, s[4:7], s32 offen offset:0 sc1
v_mfma_f32_16x16x32_bf16 v[76:79], v[44:47], v[48:51], v[76:79]
ds_read_b64_tr_b16 v[4:5], v129 offset:32768
v_mfma_f32_16x16x32_bf16 v[80:83], v[32:35], v[52:55], v[80:83]
ds_read_b64_tr_b16 v[6:7], v129 offset:36864
v_mfma_f32_16x16x32_bf16 v[84:87], v[36:39], v[52:55], v[84:87]
ds_read_b64_tr_b16 v[8:9], v130 offset:32768
buffer_load_dwordx4 v141, s[4:7], s16 offen offset:1024 sc1 lds
buffer_load_dwordx4 v[212:215], v251, s[4:7], s32 offen offset:1024 sc1
v_mfma_f32_16x16x32_bf16 v[88:91], v[40:43], v[52:55], v[88:91]
ds_read_b64_tr_b16 v[10:11], v130 offset:36864
v_mfma_f32_16x16x32_bf16 v[92:95], v[44:47], v[52:55], v[92:95]
ds_read_b64_tr_b16 v[12:13], v131 offset:32768
buffer_load_dwordx4 v142, s[4:7], s16 offen offset:2048 sc1 lds
s_add_u32 s32, s3, 98304
v_mfma_f32_16x16x32_bf16 v[96:99], v[32:35], v[56:59], v[96:99]
ds_read_b64_tr_b16 v[14:15], v131 offset:36864
v_mfma_f32_16x16x32_bf16 v[100:103], v[36:39], v[56:59], v[100:103]
ds_read_b128 v[20:23], v136 offset:34816
v_mfma_f32_16x16x32_bf16 v[104:107], v[40:43], v[56:59], v[104:107]
ds_read_b128 v[24:27], v136 offset:36864
buffer_load_dwordx4 v142, s[4:7], s16 offen offset:3072 sc1 lds
buffer_load_dwordx4 v[216:219], v251, s[4:7], s32 offen offset:0 sc1
v_mfma_f32_16x16x32_bf16 v[108:111], v[44:47], v[56:59], v[108:111]
ds_read_b128 v[28:31], v136 offset:38912
v_mfma_f32_16x16x32_bf16 v[112:115], v[32:35], v[60:63], v[112:115]
s_add_u32 s16, s16, 2048
buffer_load_dwordx4 v[220:223], v251, s[4:7], s32 offen offset:1024 sc1
v_mfma_f32_16x16x32_bf16 v[116:119], v[36:39], v[60:63], v[116:119]
v_mfma_f32_16x16x32_bf16 v[120:123], v[40:43], v[60:63], v[120:123]
v_mfma_f32_16x16x32_bf16 v[124:127], v[44:47], v[60:63], v[124:127]
s_cmp_lg_u32 s56, 5
s_cbranch_scc1 main_kernel_w_c0_n_nox
s_add_u32 s32, s1, 0
buffer_load_dwordx4 v[160:163], v145, s[96:99], s32 offen offset:0
buffer_load_dwordx4 v[164:167], v145, s[96:99], s32 offen offset:64
s_add_u32 s32, s1, 32768
buffer_load_dwordx4 v[168:171], v145, s[96:99], s32 offen offset:0
buffer_load_dwordx4 v[172:175], v145, s[96:99], s32 offen offset:64
s_add_u32 s32, s1, 65536
buffer_load_dwordx4 v[176:179], v145, s[96:99], s32 offen offset:0
buffer_load_dwordx4 v[180:183], v145, s[96:99], s32 offen offset:64
s_add_u32 s32, s1, 98304
buffer_load_dwordx4 v[184:187], v145, s[96:99], s32 offen offset:0
buffer_load_dwordx4 v[188:191], v145, s[96:99], s32 offen offset:64
main_kernel_w_c0_n_nox:
s_waitcnt lgkmcnt(0)
ds_read_b128 v[48:51], v136 offset:33792
s_add_u32 m0, s19, 16384
s_nop 0
v_mfma_f32_16x16x32_bf16 v[64:67], v[0:3], v[16:19], v[64:67]
ds_read_b64_tr_b16 v[32:33], v128 offset:40960
v_mfma_f32_16x16x32_bf16 v[68:71], v[4:7], v[16:19], v[68:71]
ds_read_b64_tr_b16 v[34:35], v128 offset:45056
buffer_load_dwordx4 v137, s[8:11], s15 offen offset:0 lds
v_mfma_f32_16x16x32_bf16 v[72:75], v[8:11], v[16:19], v[72:75]
ds_read_b64_tr_b16 v[36:37], v129 offset:40960
v_mfma_f32_16x16x32_bf16 v[76:79], v[12:15], v[16:19], v[76:79]
ds_read_b64_tr_b16 v[38:39], v129 offset:45056
v_mfma_f32_16x16x32_bf16 v[80:83], v[0:3], v[20:23], v[80:83]
ds_read_b64_tr_b16 v[40:41], v130 offset:40960
buffer_load_dwordx4 v138, s[8:11], s15 offen offset:1024 lds
v_mfma_f32_16x16x32_bf16 v[84:87], v[4:7], v[20:23], v[84:87]
ds_read_b64_tr_b16 v[42:43], v130 offset:45056
v_mfma_f32_16x16x32_bf16 v[88:91], v[8:11], v[20:23], v[88:91]
ds_read_b64_tr_b16 v[44:45], v131 offset:40960
v_mfma_f32_16x16x32_bf16 v[92:95], v[12:15], v[20:23], v[92:95]
ds_read_b64_tr_b16 v[46:47], v131 offset:45056
buffer_load_dwordx4 v139, s[8:11], s15 offen offset:2048 lds
v_mfma_f32_16x16x32_bf16 v[96:99], v[0:3], v[24:27], v[96:99]
ds_read_b128 v[52:55], v136 offset:35840
v_mfma_f32_16x16x32_bf16 v[100:103], v[4:7], v[24:27], v[100:103]
ds_read_b128 v[56:59], v136 offset:37888
buffer_load_dwordx4 v140, s[8:11], s15 offen offset:3072 lds
v_mfma_f32_16x16x32_bf16 v[104:107], v[8:11], v[24:27], v[104:107]
ds_read_b128 v[60:63], v136 offset:39936
v_mfma_f32_16x16x32_bf16 v[108:111], v[12:15], v[24:27], v[108:111]
v_mfma_f32_16x16x32_bf16 v[112:115], v[0:3], v[28:31], v[112:115]
s_add_u32 s15, s15, s17
v_mfma_f32_16x16x32_bf16 v[116:119], v[4:7], v[28:31], v[116:119]
v_mfma_f32_16x16x32_bf16 v[120:123], v[8:11], v[28:31], v[120:123]
v_mfma_f32_16x16x32_bf16 v[124:127], v[12:15], v[28:31], v[124:127]
s_waitcnt lgkmcnt(0)
v_mfma_f32_16x16x32_bf16 v[64:67], v[32:35], v[48:51], v[64:67]
s_waitcnt vmcnt(24)
s_barrier
ds_read_b128 v[16:19], v136 offset:49152
s_add_u32 m0, s20, 32768
s_nop 0
v_mfma_f32_16x16x32_bf16 v[68:71], v[36:39], v[48:51], v[68:71]
ds_read_b64_tr_b16 v[0:1], v128 offset:49152
v_mfma_f32_16x16x32_bf16 v[72:75], v[40:43], v[48:51], v[72:75]
ds_read_b64_tr_b16 v[2:3], v128 offset:53248
buffer_load_dwordx4 v141, s[4:7], s16 offen offset:0 sc1 lds
v_mfma_f32_16x16x32_bf16 v[76:79], v[44:47], v[48:51], v[76:79]
ds_read_b64_tr_b16 v[4:5], v129 offset:49152
v_mfma_f32_16x16x32_bf16 v[80:83], v[32:35], v[52:55], v[80:83]
ds_read_b64_tr_b16 v[6:7], v129 offset:53248
s_waitcnt vmcnt(21)
v_mfma_f32_16x16x32_bf16 v[84:87], v[36:39], v[52:55], v[84:87]
ds_read_b64_tr_b16 v[8:9], v130 offset:49152
buffer_load_dwordx4 v141, s[4:7], s16 offen offset:1024 sc1 lds
v_min3_u32 v253, v232, v233, v234
v_mfma_f32_16x16x32_bf16 v[88:91], v[40:43], v[52:55], v[88:91]
ds_read_b64_tr_b16 v[10:11], v130 offset:53248
v_min_u32 v253, v253, v235
v_mfma_f32_16x16x32_bf16 v[92:95], v[44:47], v[52:55], v[92:95]
ds_read_b64_tr_b16 v[12:13], v131 offset:49152
buffer_load_dwordx4 v142, s[4:7], s16 offen offset:2048 sc1 lds
v_or_b32 v253, s61, v253
v_mfma_f32_16x16x32_bf16 v[96:99], v[32:35], v[56:59], v[96:99]
ds_read_b64_tr_b16 v[14:15], v131 offset:53248
v_min_u32 v253, v253, v231
v_mfma_f32_16x16x32_bf16 v[100:103], v[36:39], v[56:59], v[100:103]
ds_read_b128 v[20:23], v136 offset:51200
v_cmp_eq_u32 vcc, 0, v253
v_mfma_f32_16x16x32_bf16 v[104:107], v[40:43], v[56:59], v[104:107]
ds_read_b128 v[24:27], v136 offset:53248
buffer_load_dwordx4 v142, s[4:7], s16 offen offset:3072 sc1 lds
s_nop 1
v_mfma_f32_16x16x32_bf16 v[108:111], v[44:47], v[56:59], v[108:111]
ds_read_b128 v[28:31], v136 offset:55296
s_cmp_eq_u64 vcc, 0
s_cselect_b32 s32, s36, -4
v_mfma_f32_16x16x32_bf16 v[112:115], v[32:35], v[60:63], v[112:115]
s_add_u32 s16, s16, 2048
s_bitcmp1_b32 0x1df, s23
s_cselect_b32 s32, s32, -4
v_mfma_f32_16x16x32_bf16 v[116:119], v[36:39], v[60:63], v[116:119]
v_mov_b32 v254, s32
v_mfma_f32_16x16x32_bf16 v[120:123], v[40:43], v[60:63], v[120:123]
s_mov_b64 exec, s[100:101]
ds_write_b32 v255, v254
s_mov_b64 exec, -1
v_mfma_f32_16x16x32_bf16 v[124:127], v[44:47], v[60:63], v[124:127]
s_waitcnt lgkmcnt(0)
ds_read_b128 v[48:51], v136 offset:50176
s_add_u32 m0, s19, 32768
s_nop 0
v_mfma_f32_16x16x32_bf16 v[64:67], v[0:3], v[16:19], v[64:67]
ds_read_b64_tr_b16 v[32:33], v128 offset:57344
v_mfma_f32_16x16x32_bf16 v[68:71], v[4:7], v[16:19], v[68:71]
ds_read_b64_tr_b16 v[34:35], v128 offset:61440
buffer_load_dwordx4 v137, s[8:11], s15 offen offset:0 lds
v_mfma_f32_16x16x32_bf16 v[72:75], v[8:11], v[16:19], v[72:75]
ds_read_b64_tr_b16 v[36:37], v129 offset:57344
v_mfma_f32_16x16x32_bf16 v[76:79], v[12:15], v[16:19], v[76:79]
ds_read_b64_tr_b16 v[38:39], v129 offset:61440
v_mfma_f32_16x16x32_bf16 v[80:83], v[0:3], v[20:23], v[80:83]
ds_read_b64_tr_b16 v[40:41], v130 offset:57344
buffer_load_dwordx4 v138, s[8:11], s15 offen offset:1024 lds
v_mfma_f32_16x16x32_bf16 v[84:87], v[4:7], v[20:23], v[84:87]
ds_read_b64_tr_b16 v[42:43], v130 offset:61440
v_mfma_f32_16x16x32_bf16 v[88:91], v[8:11], v[20:23], v[88:91]
ds_read_b64_tr_b16 v[44:45], v131 offset:57344
v_mfma_f32_16x16x32_bf16 v[92:95], v[12:15], v[20:23], v[92:95]
ds_read_b64_tr_b16 v[46:47], v131 offset:61440
buffer_load_dwordx4 v139, s[8:11], s15 offen offset:2048 lds
v_mfma_f32_16x16x32_bf16 v[96:99], v[0:3], v[24:27], v[96:99]
ds_read_b128 v[52:55], v136 offset:52224
v_mfma_f32_16x16x32_bf16 v[100:103], v[4:7], v[24:27], v[100:103]
ds_read_b128 v[56:59], v136 offset:54272
buffer_load_dwordx4 v140, s[8:11], s15 offen offset:3072 lds
v_mfma_f32_16x16x32_bf16 v[104:107], v[8:11], v[24:27], v[104:107]
ds_read_b128 v[60:63], v136 offset:56320
v_mfma_f32_16x16x32_bf16 v[108:111], v[12:15], v[24:27], v[108:111]
v_mfma_f32_16x16x32_bf16 v[112:115], v[0:3], v[28:31], v[112:115]
s_add_u32 s15, s15, s17
v_mfma_f32_16x16x32_bf16 v[116:119], v[4:7], v[28:31], v[116:119]
v_mfma_f32_16x16x32_bf16 v[120:123], v[8:11], v[28:31], v[120:123]
v_mfma_f32_16x16x32_bf16 v[124:127], v[12:15], v[28:31], v[124:127]
s_waitcnt lgkmcnt(0)
v_mfma_f32_16x16x32_bf16 v[64:67], v[32:35], v[48:51], v[64:67]
s_waitcnt vmcnt(23)
s_barrier
ds_read_b128 v[16:19], v136 offset:0
s_add_u32 m0, s20, 49152
s_nop 0
ds_read_b32 v254, v255
v_mfma_f32_16x16x32_bf16 v[68:71], v[36:39], v[48:51], v[68:71]
ds_read_b64_tr_b16 v[0:1], v128 offset:0
v_mfma_f32_16x16x32_bf16 v[72:75], v[40:43], v[48:51], v[72:75]
ds_read_b64_tr_b16 v[2:3], v128 offset:4096
buffer_load_dwordx4 v141, s[4:7], s16 offen offset:0 sc1 lds
v_mfma_f32_16x16x32_bf16 v[76:79], v[44:47], v[48:51], v[76:79]
ds_read_b64_tr_b16 v[4:5], v129 offset:0
v_mfma_f32_16x16x32_bf16 v[80:83], v[32:35], v[52:55], v[80:83]
ds_read_b64_tr_b16 v[6:7], v129 offset:4096
v_mfma_f32_16x16x32_bf16 v[84:87], v[36:39], v[52:55], v[84:87]
ds_read_b64_tr_b16 v[8:9], v130 offset:0
buffer_load_dwordx4 v141, s[4:7], s16 offen offset:1024 sc1 lds
v_mfma_f32_16x16x32_bf16 v[88:91], v[40:43], v[52:55], v[88:91]
ds_read_b64_tr_b16 v[10:11], v130 offset:4096
v_mfma_f32_16x16x32_bf16 v[92:95], v[44:47], v[52:55], v[92:95]
ds_read_b64_tr_b16 v[12:13], v131 offset:0
buffer_load_dwordx4 v142, s[4:7], s16 offen offset:2048 sc1 lds
v_mfma_f32_16x16x32_bf16 v[96:99], v[32:35], v[56:59], v[96:99]
ds_read_b64_tr_b16 v[14:15], v131 offset:4096
v_mfma_f32_16x16x32_bf16 v[100:103], v[36:39], v[56:59], v[100:103]
ds_read_b128 v[20:23], v136 offset:2048
v_mfma_f32_16x16x32_bf16 v[104:107], v[40:43], v[56:59], v[104:107]
ds_read_b128 v[24:27], v136 offset:4096
buffer_load_dwordx4 v142, s[4:7], s16 offen offset:3072 sc1 lds
v_mfma_f32_16x16x32_bf16 v[108:111], v[44:47], v[56:59], v[108:111]
ds_read_b128 v[28:31], v136 offset:6144
v_mfma_f32_16x16x32_bf16 v[112:115], v[32:35], v[60:63], v[112:115]
s_add_u32 s16, s16, 2048
v_mfma_f32_16x16x32_bf16 v[116:119], v[36:39], v[60:63], v[116:119]
v_mfma_f32_16x16x32_bf16 v[120:123], v[40:43], v[60:63], v[120:123]
v_mfma_f32_16x16x32_bf16 v[124:127], v[44:47], v[60:63], v[124:127]
s_waitcnt lgkmcnt(0)
ds_read_b128 v[48:51], v136 offset:1024
s_add_u32 m0, s19, 49152
s_nop 0
v_mfma_f32_16x16x32_bf16 v[64:67], v[0:3], v[16:19], v[64:67]
ds_read_b64_tr_b16 v[32:33], v128 offset:8192
v_readfirstlane_b32 s62, v254
v_mfma_f32_16x16x32_bf16 v[68:71], v[4:7], v[16:19], v[68:71]
ds_read_b64_tr_b16 v[34:35], v128 offset:12288
buffer_load_dwordx4 v137, s[8:11], s15 offen offset:0 lds
v_mfma_f32_16x16x32_bf16 v[72:75], v[8:11], v[16:19], v[72:75]
ds_read_b64_tr_b16 v[36:37], v129 offset:8192
s_nop 1
v_mfma_f32_16x16x32_bf16 v[76:79], v[12:15], v[16:19], v[76:79]
ds_read_b64_tr_b16 v[38:39], v129 offset:12288
v_mfma_f32_16x16x32_bf16 v[80:83], v[0:3], v[20:23], v[80:83]
ds_read_b64_tr_b16 v[40:41], v130 offset:8192
buffer_load_dwordx4 v138, s[8:11], s15 offen offset:1024 lds
v_mfma_f32_16x16x32_bf16 v[84:87], v[4:7], v[20:23], v[84:87]
ds_read_b64_tr_b16 v[42:43], v130 offset:12288
s_and_b32 s23, s62, 15
v_mfma_f32_16x16x32_bf16 v[88:91], v[8:11], v[20:23], v[88:91]
ds_read_b64_tr_b16 v[44:45], v131 offset:8192
v_mfma_f32_16x16x32_bf16 v[92:95], v[12:15], v[20:23], v[92:95]
ds_read_b64_tr_b16 v[46:47], v131 offset:12288
buffer_load_dwordx4 v139, s[8:11], s15 offen offset:2048 lds
s_bfe_u32 s54, s62, 0x20004
v_mfma_f32_16x16x32_bf16 v[96:99], v[0:3], v[24:27], v[96:99]
ds_read_b128 v[52:55], v136 offset:3072
v_mfma_f32_16x16x32_bf16 v[100:103], v[4:7], v[24:27], v[100:103]
ds_read_b128 v[56:59], v136 offset:5120
buffer_load_dwordx4 v140, s[8:11], s15 offen offset:3072 lds
v_mfma_f32_16x16x32_bf16 v[104:107], v[8:11], v[24:27], v[104:107]
ds_read_b128 v[60:63], v136 offset:7168
s_bfe_u32 s24, s62, 0x80008
v_mfma_f32_16x16x32_bf16 v[108:111], v[12:15], v[24:27], v[108:111]
v_mfma_f32_16x16x32_bf16 v[112:115], v[0:3], v[28:31], v[112:115]
s_add_u32 s15, s15, s17
s_lshr_b32 s25, s62, 16
v_mfma_f32_16x16x32_bf16 v[116:119], v[4:7], v[28:31], v[116:119]
v_mfma_f32_16x16x32_bf16 v[120:123], v[8:11], v[28:31], v[120:123]
v_mfma_f32_16x16x32_bf16 v[124:127], v[12:15], v[28:31], v[124:127]
s_cmp_eq_u32 s54, 0
s_cselect_b32 s73, 0, -1
s_cbranch_scc1 main_kernel_w_c0_task
s_waitcnt lgkmcnt(0)
v_mfma_f32_16x16x32_bf16 v[64:67], v[32:35], v[48:51], v[64:67]
s_waitcnt vmcnt(16)
s_barrier
ds_read_b128 v[16:19], v136 offset:16384
v_mfma_f32_16x16x32_bf16 v[68:71], v[36:39], v[48:51], v[68:71]
ds_read_b64_tr_b16 v[0:1], v128 offset:16384
v_mfma_f32_16x16x32_bf16 v[72:75], v[40:43], v[48:51], v[72:75]
ds_read_b64_tr_b16 v[2:3], v128 offset:20480
v_mfma_f32_16x16x32_bf16 v[76:79], v[44:47], v[48:51], v[76:79]
ds_read_b64_tr_b16 v[4:5], v129 offset:16384
v_mfma_f32_16x16x32_bf16 v[80:83], v[32:35], v[52:55], v[80:83]
ds_read_b64_tr_b16 v[6:7], v129 offset:20480
v_mfma_f32_16x16x32_bf16 v[84:87], v[36:39], v[52:55], v[84:87]
ds_read_b64_tr_b16 v[8:9], v130 offset:16384
v_mfma_f32_16x16x32_bf16 v[88:91], v[40:43], v[52:55], v[88:91]
ds_read_b64_tr_b16 v[10:11], v130 offset:20480
v_mfma_f32_16x16x32_bf16 v[92:95], v[44:47], v[52:55], v[92:95]
ds_read_b64_tr_b16 v[12:13], v131 offset:16384
v_mfma_f32_16x16x32_bf16 v[96:99], v[32:35], v[56:59], v[96:99]
ds_read_b64_tr_b16 v[14:15], v131 offset:20480
v_mfma_f32_16x16x32_bf16 v[100:103], v[36:39], v[56:59], v[100:103]
ds_read_b128 v[20:23], v136 offset:18432
v_mfma_f32_16x16x32_bf16 v[104:107], v[40:43], v[56:59], v[104:107]
ds_read_b128 v[24:27], v136 offset:20480
v_mfma_f32_16x16x32_bf16 v[108:111], v[44:47], v[56:59], v[108:111]
ds_read_b128 v[28:31], v136 offset:22528
v_mfma_f32_16x16x32_bf16 v[112:115], v[32:35], v[60:63], v[112:115]
v_mfma_f32_16x16x32_bf16 v[116:119], v[36:39], v[60:63], v[116:119]
v_mfma_f32_16x16x32_bf16 v[120:123], v[40:43], v[60:63], v[120:123]
v_mfma_f32_16x16x32_bf16 v[124:127], v[44:47], v[60:63], v[124:127]
s_waitcnt lgkmcnt(0)
ds_read_b128 v[48:51], v136 offset:17408
v_mfma_f32_16x16x32_bf16 v[64:67], v[0:3], v[16:19], v[64:67]
ds_read_b64_tr_b16 v[32:33], v128 offset:24576
v_mfma_f32_16x16x32_bf16 v[68:71], v[4:7], v[16:19], v[68:71]
ds_read_b64_tr_b16 v[34:35], v128 offset:28672
v_mfma_f32_16x16x32_bf16 v[72:75], v[8:11], v[16:19], v[72:75]
ds_read_b64_tr_b16 v[36:37], v129 offset:24576
v_mfma_f32_16x16x32_bf16 v[76:79], v[12:15], v[16:19], v[76:79]
ds_read_b64_tr_b16 v[38:39], v129 offset:28672
v_mfma_f32_16x16x32_bf16 v[80:83], v[0:3], v[20:23], v[80:83]
ds_read_b64_tr_b16 v[40:41], v130 offset:24576
v_mfma_f32_16x16x32_bf16 v[84:87], v[4:7], v[20:23], v[84:87]
ds_read_b64_tr_b16 v[42:43], v130 offset:28672
v_mfma_f32_16x16x32_bf16 v[88:91], v[8:11], v[20:23], v[88:91]
ds_read_b64_tr_b16 v[44:45], v131 offset:24576
v_mfma_f32_16x16x32_bf16 v[92:95], v[12:15], v[20:23], v[92:95]
ds_read_b64_tr_b16 v[46:47], v131 offset:28672
v_mfma_f32_16x16x32_bf16 v[96:99], v[0:3], v[24:27], v[96:99]
ds_read_b128 v[52:55], v136 offset:19456
v_mfma_f32_16x16x32_bf16 v[100:103], v[4:7], v[24:27], v[100:103]
ds_read_b128 v[56:59], v136 offset:21504
v_mfma_f32_16x16x32_bf16 v[104:107], v[8:11], v[24:27], v[104:107]
ds_read_b128 v[60:63], v136 offset:23552
v_mfma_f32_16x16x32_bf16 v[108:111], v[12:15], v[24:27], v[108:111]
v_mfma_f32_16x16x32_bf16 v[112:115], v[0:3], v[28:31], v[112:115]
v_mfma_f32_16x16x32_bf16 v[116:119], v[4:7], v[28:31], v[116:119]
v_mfma_f32_16x16x32_bf16 v[120:123], v[8:11], v[28:31], v[120:123]
v_mfma_f32_16x16x32_bf16 v[124:127], v[12:15], v[28:31], v[124:127]
s_waitcnt lgkmcnt(0)
v_mfma_f32_16x16x32_bf16 v[64:67], v[32:35], v[48:51], v[64:67]
s_waitcnt vmcnt(8)
s_barrier
ds_read_b128 v[16:19], v136 offset:32768
v_mfma_f32_16x16x32_bf16 v[68:71], v[36:39], v[48:51], v[68:71]
ds_read_b64_tr_b16 v[0:1], v128 offset:32768
v_mfma_f32_16x16x32_bf16 v[72:75], v[40:43], v[48:51], v[72:75]
ds_read_b64_tr_b16 v[2:3], v128 offset:36864
v_mfma_f32_16x16x32_bf16 v[76:79], v[44:47], v[48:51], v[76:79]
ds_read_b64_tr_b16 v[4:5], v129 offset:32768
v_mfma_f32_16x16x32_bf16 v[80:83], v[32:35], v[52:55], v[80:83]
ds_read_b64_tr_b16 v[6:7], v129 offset:36864
v_mfma_f32_16x16x32_bf16 v[84:87], v[36:39], v[52:55], v[84:87]
ds_read_b64_tr_b16 v[8:9], v130 offset:32768
v_mfma_f32_16x16x32_bf16 v[88:91], v[40:43], v[52:55], v[88:91]
ds_read_b64_tr_b16 v[10:11], v130 offset:36864
v_mfma_f32_16x16x32_bf16 v[92:95], v[44:47], v[52:55], v[92:95]
ds_read_b64_tr_b16 v[12:13], v131 offset:32768
v_mfma_f32_16x16x32_bf16 v[96:99], v[32:35], v[56:59], v[96:99]
ds_read_b64_tr_b16 v[14:15], v131 offset:36864
v_mfma_f32_16x16x32_bf16 v[100:103], v[36:39], v[56:59], v[100:103]
ds_read_b128 v[20:23], v136 offset:34816
v_mfma_f32_16x16x32_bf16 v[104:107], v[40:43], v[56:59], v[104:107]
ds_read_b128 v[24:27], v136 offset:36864
v_mfma_f32_16x16x32_bf16 v[108:111], v[44:47], v[56:59], v[108:111]
ds_read_b128 v[28:31], v136 offset:38912
v_mfma_f32_16x16x32_bf16 v[112:115], v[32:35], v[60:63], v[112:115]
v_mfma_f32_16x16x32_bf16 v[116:119], v[36:39], v[60:63], v[116:119]
v_mfma_f32_16x16x32_bf16 v[120:123], v[40:43], v[60:63], v[120:123]
v_mfma_f32_16x16x32_bf16 v[124:127], v[44:47], v[60:63], v[124:127]
s_waitcnt lgkmcnt(0)
ds_read_b128 v[48:51], v136 offset:33792
v_mfma_f32_16x16x32_bf16 v[64:67], v[0:3], v[16:19], v[64:67]
ds_read_b64_tr_b16 v[32:33], v128 offset:40960
v_mfma_f32_16x16x32_bf16 v[68:71], v[4:7], v[16:19], v[68:71]
ds_read_b64_tr_b16 v[34:35], v128 offset:45056
v_mfma_f32_16x16x32_bf16 v[72:75], v[8:11], v[16:19], v[72:75]
ds_read_b64_tr_b16 v[36:37], v129 offset:40960
v_mfma_f32_16x16x32_bf16 v[76:79], v[12:15], v[16:19], v[76:79]
ds_read_b64_tr_b16 v[38:39], v129 offset:45056
v_mfma_f32_16x16x32_bf16 v[80:83], v[0:3], v[20:23], v[80:83]
ds_read_b64_tr_b16 v[40:41], v130 offset:40960
v_mfma_f32_16x16x32_bf16 v[84:87], v[4:7], v[20:23], v[84:87]
ds_read_b64_tr_b16 v[42:43], v130 offset:45056
v_mfma_f32_16x16x32_bf16 v[88:91], v[8:11], v[20:23], v[88:91]
ds_read_b64_tr_b16 v[44:45], v131 offset:40960
v_mfma_f32_16x16x32_bf16 v[92:95], v[12:15], v[20:23], v[92:95]
ds_read_b64_tr_b16 v[46:47], v131 offset:45056
v_mfma_f32_16x16x32_bf16 v[96:99], v[0:3], v[24:27], v[96:99]
ds_read_b128 v[52:55], v136 offset:35840
v_mfma_f32_16x16x32_bf16 v[100:103], v[4:7], v[24:27], v[100:103]
ds_read_b128 v[56:59], v136 offset:37888
v_mfma_f32_16x16x32_bf16 v[104:107], v[8:11], v[24:27], v[104:107]
ds_read_b128 v[60:63], v136 offset:39936
v_mfma_f32_16x16x32_bf16 v[108:111], v[12:15], v[24:27], v[108:111]
v_mfma_f32_16x16x32_bf16 v[112:115], v[0:3], v[28:31], v[112:115]
v_mfma_f32_16x16x32_bf16 v[116:119], v[4:7], v[28:31], v[116:119]
v_mfma_f32_16x16x32_bf16 v[120:123], v[8:11], v[28:31], v[120:123]
v_mfma_f32_16x16x32_bf16 v[124:127], v[12:15], v[28:31], v[124:127]
s_waitcnt lgkmcnt(0)
v_mfma_f32_16x16x32_bf16 v[64:67], v[32:35], v[48:51], v[64:67]
s_waitcnt vmcnt(0)
s_barrier
ds_read_b128 v[16:19], v136 offset:49152
v_mfma_f32_16x16x32_bf16 v[68:71], v[36:39], v[48:51], v[68:71]
ds_read_b64_tr_b16 v[0:1], v128 offset:49152
v_mfma_f32_16x16x32_bf16 v[72:75], v[40:43], v[48:51], v[72:75]
ds_read_b64_tr_b16 v[2:3], v128 offset:53248
v_mfma_f32_16x16x32_bf16 v[76:79], v[44:47], v[48:51], v[76:79]
ds_read_b64_tr_b16 v[4:5], v129 offset:49152
v_mfma_f32_16x16x32_bf16 v[80:83], v[32:35], v[52:55], v[80:83]
ds_read_b64_tr_b16 v[6:7], v129 offset:53248
v_mfma_f32_16x16x32_bf16 v[84:87], v[36:39], v[52:55], v[84:87]
ds_read_b64_tr_b16 v[8:9], v130 offset:49152
v_mfma_f32_16x16x32_bf16 v[88:91], v[40:43], v[52:55], v[88:91]
ds_read_b64_tr_b16 v[10:11], v130 offset:53248
v_mfma_f32_16x16x32_bf16 v[92:95], v[44:47], v[52:55], v[92:95]
ds_read_b64_tr_b16 v[12:13], v131 offset:49152
v_mfma_f32_16x16x32_bf16 v[96:99], v[32:35], v[56:59], v[96:99]
ds_read_b64_tr_b16 v[14:15], v131 offset:53248
v_mfma_f32_16x16x32_bf16 v[100:103], v[36:39], v[56:59], v[100:103]
ds_read_b128 v[20:23], v136 offset:51200
v_mfma_f32_16x16x32_bf16 v[104:107], v[40:43], v[56:59], v[104:107]
ds_read_b128 v[24:27], v136 offset:53248
v_mfma_f32_16x16x32_bf16 v[108:111], v[44:47], v[56:59], v[108:111]
ds_read_b128 v[28:31], v136 offset:55296
v_mfma_f32_16x16x32_bf16 v[112:115], v[32:35], v[60:63], v[112:115]
v_mfma_f32_16x16x32_bf16 v[116:119], v[36:39], v[60:63], v[116:119]
v_mfma_f32_16x16x32_bf16 v[120:123], v[40:43], v[60:63], v[120:123]
v_mfma_f32_16x16x32_bf16 v[124:127], v[44:47], v[60:63], v[124:127]
s_waitcnt lgkmcnt(0)
ds_read_b128 v[48:51], v136 offset:50176
v_mfma_f32_16x16x32_bf16 v[64:67], v[0:3], v[16:19], v[64:67]
ds_read_b64_tr_b16 v[32:33], v128 offset:57344
v_mfma_f32_16x16x32_bf16 v[68:71], v[4:7], v[16:19], v[68:71]
ds_read_b64_tr_b16 v[34:35], v128 offset:61440
v_mfma_f32_16x16x32_bf16 v[72:75], v[8:11], v[16:19], v[72:75]
ds_read_b64_tr_b16 v[36:37], v129 offset:57344
v_mfma_f32_16x16x32_bf16 v[76:79], v[12:15], v[16:19], v[76:79]
ds_read_b64_tr_b16 v[38:39], v129 offset:61440
v_mfma_f32_16x16x32_bf16 v[80:83], v[0:3], v[20:23], v[80:83]
ds_read_b64_tr_b16 v[40:41], v130 offset:57344
v_mfma_f32_16x16x32_bf16 v[84:87], v[4:7], v[20:23], v[84:87]
ds_read_b64_tr_b16 v[42:43], v130 offset:61440
v_mfma_f32_16x16x32_bf16 v[88:91], v[8:11], v[20:23], v[88:91]
ds_read_b64_tr_b16 v[44:45], v131 offset:57344
v_mfma_f32_16x16x32_bf16 v[92:95], v[12:15], v[20:23], v[92:95]
ds_read_b64_tr_b16 v[46:47], v131 offset:61440
v_mfma_f32_16x16x32_bf16 v[96:99], v[0:3], v[24:27], v[96:99]
ds_read_b128 v[52:55], v136 offset:52224
v_mfma_f32_16x16x32_bf16 v[100:103], v[4:7], v[24:27], v[100:103]
ds_read_b128 v[56:59], v136 offset:54272
v_mfma_f32_16x16x32_bf16 v[104:107], v[8:11], v[24:27], v[104:107]
ds_read_b128 v[60:63], v136 offset:56320
v_mfma_f32_16x16x32_bf16 v[108:111], v[12:15], v[24:27], v[108:111]
v_mfma_f32_16x16x32_bf16 v[112:115], v[0:3], v[28:31], v[112:115]
v_mfma_f32_16x16x32_bf16 v[116:119], v[4:7], v[28:31], v[116:119]
v_mfma_f32_16x16x32_bf16 v[120:123], v[8:11], v[28:31], v[120:123]
v_mfma_f32_16x16x32_bf16 v[124:127], v[12:15], v[28:31], v[124:127]
s_waitcnt lgkmcnt(0)
v_mfma_f32_16x16x32_bf16 v[64:67], v[32:35], v[48:51], v[64:67]
s_barrier
v_mfma_f32_16x16x32_bf16 v[68:71], v[36:39], v[48:51], v[68:71]
v_mfma_f32_16x16x32_bf16 v[72:75], v[40:43], v[48:51], v[72:75]
v_mfma_f32_16x16x32_bf16 v[76:79], v[44:47], v[48:51], v[76:79]
v_mfma_f32_16x16x32_bf16 v[80:83], v[32:35], v[52:55], v[80:83]
v_mfma_f32_16x16x32_bf16 v[84:87], v[36:39], v[52:55], v[84:87]
v_mfma_f32_16x16x32_bf16 v[88:91], v[40:43], v[52:55], v[88:91]
v_mfma_f32_16x16x32_bf16 v[92:95], v[44:47], v[52:55], v[92:95]
v_mfma_f32_16x16x32_bf16 v[96:99], v[32:35], v[56:59], v[96:99]
v_mfma_f32_16x16x32_bf16 v[100:103], v[36:39], v[56:59], v[100:103]
v_mfma_f32_16x16x32_bf16 v[104:107], v[40:43], v[56:59], v[104:107]
v_mfma_f32_16x16x32_bf16 v[108:111], v[44:47], v[56:59], v[108:111]
v_mfma_f32_16x16x32_bf16 v[112:115], v[32:35], v[60:63], v[112:115]
v_mfma_f32_16x16x32_bf16 v[116:119], v[36:39], v[60:63], v[116:119]
v_mfma_f32_16x16x32_bf16 v[120:123], v[40:43], v[60:63], v[120:123]
v_mfma_f32_16x16x32_bf16 v[124:127], v[44:47], v[60:63], v[124:127]
s_cmp_lg_u32 s62, -4
s_cbranch_scc1 main_kernel_w_gemm
s_branch main_kernel_w_slow
main_kernel_w_c0_n_ev:
s_mov_b32 s55, 1
s_cmp_eq_u32 s56, 0
s_cbranch_scc1 main_kernel_w_c0_n_et
s_bfm_b64 exec, s0, 0
buffer_store_dword v244, v248, s[4:7], s59 offen sc1
s_mov_b64 exec, -1
s_mov_b32 s56, 0
main_kernel_w_c0_n_et:
s_cmp_lg_u32 s18, 1
s_cbranch_scc1 main_kernel_w_c0_n_loop
s_lshl_b32 s32, s27, 8
s_add_u32 s32, s32, 0x841e000
s_mov_b64 exec, 1
v_mov_b32 v249, 1
buffer_atomic_add v249, off, s[4:7], s32 sc0 sc1
s_mov_b64 exec, -1
s_branch main_kernel_w_c0_n_loop
main_kernel_w_c0_gov:
s_mov_b32 s58, 1
s_mov_b32 s72, s18
s_cmp_lg_u32 s73, -1
s_cbranch_scc1 main_kernel_w_c0_str
s_waitcnt lgkmcnt(0)
v_lshrrev_b32 v0, 4, v250
v_bfe_u32 v1, v250, 2, 2
v_lshl_add_u32 v4, v0, 2, v1
v_and_b32 v5, 7, v4
v_mul_u32_u24 v4, 256, v4
v_and_b32 v6, 3, v250
v_lshl_add_u32 v4, v6, 3, v4
s_mul_i32 s32, s37, 4
v_xor_b32 v5, s32, v5
v_lshl_add_u32 v128, v5, 5, v4
v_xor_b32 v129, 32, v128
v_xor_b32 v130, 64, v128
v_xor_b32 v131, 96, v128
s_mul_i32 s32, s38, 8192
s_add_u32 s32, s32, 65536
v_add_u32 v136, s32, v251
v_lshrrev_b32 v2, 4, v250
v_and_b32 v3, 15, v250
s_mul_i32 s32, s14, 16
v_add_u32 v147, s32, v2
v_and_b32 v6, 7, v147
v_lshlrev_b32 v6, 1, v6
v_xor_b32 v6, v6, v3
v_lshlrev_b32 v151, 4, v6
v_add_u32 v148, 4, v147
v_and_b32 v6, 7, v148
v_lshlrev_b32 v6, 1, v6
v_xor_b32 v6, v6, v3
v_lshlrev_b32 v152, 4, v6
v_subrev_u32 v152, 1024, v152
v_add_u32 v149, 8, v147
v_and_b32 v6, 7, v149
v_lshlrev_b32 v6, 1, v6
v_xor_b32 v6, v6, v3
v_lshlrev_b32 v153, 4, v6
v_subrev_u32 v153, 2048, v153
v_add_u32 v150, 12, v147
v_and_b32 v6, 7, v150
v_lshlrev_b32 v6, 1, v6
v_xor_b32 v6, v6, v3
v_lshlrev_b32 v154, 4, v6
v_subrev_u32 v154, 3072, v154
s_mul_i32 s19, s14, 4096
s_mul_i32 s20, s14, 4096
s_add_u32 s20, s20, 65536
s_mul_i32 s32, s14, 2
s_mul_i32 s32, s32, s31
v_mad_u32_u24 v137, v147, s30, v151
v_mad_u32_u24 v138, v148, s30, v152
v_mad_u32_u24 v139, v149, s30, v153
v_mad_u32_u24 v140, v150, s30, v154
v_add_u32 v141, s32, v251
s_add_u32 s32, s32, s31
s_sub_u32 s32, s32, 2048
v_add_u32 v142, s32, v251
s_mul_i32 s17, s30, 64
s_mov_b32 s15, 0
s_waitcnt vmcnt(0)
s_add_u32 m0, s20, 0
s_nop 0
buffer_load_dwordx4 v141, s[4:7], s16 offen offset:0 sc1 lds
buffer_load_dwordx4 v141, s[4:7], s16 offen offset:1024 sc1 lds
buffer_load_dwordx4 v142, s[4:7], s16 offen offset:2048 sc1 lds
buffer_load_dwordx4 v142, s[4:7], s16 offen offset:3072 sc1 lds
s_add_u32 s16, s16, 2048
s_add_u32 m0, s19, 0
s_nop 0
buffer_load_dwordx4 v137, s[8:11], s15 offen offset:0 lds
buffer_load_dwordx4 v138, s[8:11], s15 offen offset:1024 lds
buffer_load_dwordx4 v139, s[8:11], s15 offen offset:2048 lds
buffer_load_dwordx4 v140, s[8:11], s15 offen offset:3072 lds
s_add_u32 s15, s15, s17
s_add_u32 m0, s20, 16384
s_nop 0
buffer_load_dwordx4 v141, s[4:7], s16 offen offset:0 sc1 lds
buffer_load_dwordx4 v141, s[4:7], s16 offen offset:1024 sc1 lds
buffer_load_dwordx4 v142, s[4:7], s16 offen offset:2048 sc1 lds
buffer_load_dwordx4 v142, s[4:7], s16 offen offset:3072 sc1 lds
s_add_u32 s16, s16, 2048
s_add_u32 m0, s19, 16384
s_nop 0
buffer_load_dwordx4 v137, s[8:11], s15 offen offset:0 lds
buffer_load_dwordx4 v138, s[8:11], s15 offen offset:1024 lds
buffer_load_dwordx4 v139, s[8:11], s15 offen offset:2048 lds
buffer_load_dwordx4 v140, s[8:11], s15 offen offset:3072 lds
s_add_u32 s15, s15, s17
s_add_u32 m0, s20, 32768
s_nop 0
buffer_load_dwordx4 v141, s[4:7], s16 offen offset:0 sc1 lds
buffer_load_dwordx4 v141, s[4:7], s16 offen offset:1024 sc1 lds
buffer_load_dwordx4 v142, s[4:7], s16 offen offset:2048 sc1 lds
buffer_load_dwordx4 v142, s[4:7], s16 offen offset:3072 sc1 lds
s_add_u32 s16, s16, 2048
s_add_u32 m0, s19, 32768
s_nop 0
buffer_load_dwordx4 v137, s[8:11], s15 offen offset:0 lds
buffer_load_dwordx4 v138, s[8:11], s15 offen offset:1024 lds
buffer_load_dwordx4 v139, s[8:11], s15 offen offset:2048 lds
buffer_load_dwordx4 v140, s[8:11], s15 offen offset:3072 lds
s_add_u32 s15, s15, s17
s_add_u32 m0, s20, 49152
s_nop 0
buffer_load_dwordx4 v141, s[4:7], s16 offen offset:0 sc1 lds
buffer_load_dwordx4 v141, s[4:7], s16 offen offset:1024 sc1 lds
buffer_load_dwordx4 v142, s[4:7], s16 offen offset:2048 sc1 lds
buffer_load_dwordx4 v142, s[4:7], s16 offen offset:3072 sc1 lds
s_add_u32 s16, s16, 2048
s_cmp_lg_u32 s56, 0
s_cbranch_scc1 main_kernel_w_epi
main_kernel_w_c0_v_ent:
v_mfma_f32_32x32x16_bf16 v[64:79], v[224:227], v[224:227], 0
s_waitcnt vmcnt(20)
s_barrier
ds_read_b128 v[16:19], v136 offset:0
ds_read_b64_tr_b16 v[0:1], v128 offset:0
ds_read_b64_tr_b16 v[2:3], v128 offset:4096
v_mfma_f32_32x32x16_bf16 v[80:95], v[224:227], v[224:227], 0
ds_read_b64_tr_b16 v[4:5], v129 offset:0
ds_read_b64_tr_b16 v[6:7], v129 offset:4096
ds_read_b64_tr_b16 v[8:9], v130 offset:0
v_mfma_f32_32x32x16_bf16 v[96:111], v[224:227], v[224:227], 0
ds_read_b64_tr_b16 v[10:11], v130 offset:4096
ds_read_b64_tr_b16 v[12:13], v131 offset:0
ds_read_b64_tr_b16 v[14:15], v131 offset:4096
v_mfma_f32_32x32x16_bf16 v[112:127], v[224:227], v[224:227], 0
ds_read_b128 v[20:23], v136 offset:2048
ds_read_b128 v[24:27], v136 offset:4096
ds_read_b128 v[28:31], v136 offset:6144
s_sub_u32 s18, s72, 1
s_sub_u32 s55, s72, 2
s_orn2_b32 s55, s55, s100
s_mov_b32 s73, -1
s_nop 0
main_kernel_w_c0_v_loop:
s_waitcnt lgkmcnt(0)
ds_read_b128 v[48:51], v136 offset:1024
s_add_u32 m0, s19, 49152
s_nop 0
v_mfma_f32_16x16x32_bf16 v[64:67], v[16:19], v[0:3], v[64:67]
ds_read_b64_tr_b16 v[32:33], v128 offset:8192
v_mfma_f32_16x16x32_bf16 v[68:71], v[16:19], v[4:7], v[68:71]
ds_read_b64_tr_b16 v[34:35], v128 offset:12288
buffer_load_dwordx4 v137, s[8:11], s15 offen offset:0 lds
v_mfma_f32_16x16x32_bf16 v[72:75], v[16:19], v[8:11], v[72:75]
ds_read_b64_tr_b16 v[36:37], v129 offset:8192
v_mfma_f32_16x16x32_bf16 v[76:79], v[16:19], v[12:15], v[76:79]
ds_read_b64_tr_b16 v[38:39], v129 offset:12288
v_mfma_f32_16x16x32_bf16 v[80:83], v[20:23], v[0:3], v[80:83]
ds_read_b64_tr_b16 v[40:41], v130 offset:8192
buffer_load_dwordx4 v138, s[8:11], s15 offen offset:1024 lds
v_mfma_f32_16x16x32_bf16 v[84:87], v[20:23], v[4:7], v[84:87]
ds_read_b64_tr_b16 v[42:43], v130 offset:12288
v_mfma_f32_16x16x32_bf16 v[88:91], v[20:23], v[8:11], v[88:91]
ds_read_b64_tr_b16 v[44:45], v131 offset:8192
v_mfma_f32_16x16x32_bf16 v[92:95], v[20:23], v[12:15], v[92:95]
ds_read_b64_tr_b16 v[46:47], v131 offset:12288
buffer_load_dwordx4 v139, s[8:11], s15 offen offset:2048 lds
v_mfma_f32_16x16x32_bf16 v[96:99], v[24:27], v[0:3], v[96:99]
ds_read_b128 v[52:55], v136 offset:3072
v_mfma_f32_16x16x32_bf16 v[100:103], v[24:27], v[4:7], v[100:103]
ds_read_b128 v[56:59], v136 offset:5120
buffer_load_dwordx4 v140, s[8:11], s15 offen offset:3072 lds
v_mfma_f32_16x16x32_bf16 v[104:107], v[24:27], v[8:11], v[104:107]
ds_read_b128 v[60:63], v136 offset:7168
v_mfma_f32_16x16x32_bf16 v[108:111], v[24:27], v[12:15], v[108:111]
v_mfma_f32_16x16x32_bf16 v[112:115], v[28:31], v[0:3], v[112:115]
s_add_u32 s15, s15, s17
v_mfma_f32_16x16x32_bf16 v[116:119], v[28:31], v[4:7], v[116:119]
v_mfma_f32_16x16x32_bf16 v[120:123], v[28:31], v[8:11], v[120:123]
v_mfma_f32_16x16x32_bf16 v[124:127], v[28:31], v[12:15], v[124:127]
main_kernel_w_c0_v_mid:
s_waitcnt lgkmcnt(0)
v_mfma_f32_16x16x32_bf16 v[64:67], v[48:51], v[32:35], v[64:67]
s_waitcnt vmcnt(16)
s_barrier
ds_read_b128 v[16:19], v136 offset:16384
s_add_u32 m0, s20, 0
s_nop 0
v_mfma_f32_16x16x32_bf16 v[68:71], v[48:51], v[36:39], v[68:71]
ds_read_b64_tr_b16 v[0:1], v128 offset:16384
v_mfma_f32_16x16x32_bf16 v[72:75], v[48:51], v[40:43], v[72:75]
ds_read_b64_tr_b16 v[2:3], v128 offset:20480
buffer_load_dwordx4 v141, s[4:7], s16 offen offset:0 sc1 lds
v_mfma_f32_16x16x32_bf16 v[76:79], v[48:51], v[44:47], v[76:79]
ds_read_b64_tr_b16 v[4:5], v129 offset:16384
v_mfma_f32_16x16x32_bf16 v[80:83], v[52:55], v[32:35], v[80:83]
ds_read_b64_tr_b16 v[6:7], v129 offset:20480
v_mfma_f32_16x16x32_bf16 v[84:87], v[52:55], v[36:39], v[84:87]
ds_read_b64_tr_b16 v[8:9], v130 offset:16384
buffer_load_dwordx4 v141, s[4:7], s16 offen offset:1024 sc1 lds
v_mfma_f32_16x16x32_bf16 v[88:91], v[52:55], v[40:43], v[88:91]
ds_read_b64_tr_b16 v[10:11], v130 offset:20480
v_mfma_f32_16x16x32_bf16 v[92:95], v[52:55], v[44:47], v[92:95]
ds_read_b64_tr_b16 v[12:13], v131 offset:16384
buffer_load_dwordx4 v142, s[4:7], s16 offen offset:2048 sc1 lds
v_mfma_f32_16x16x32_bf16 v[96:99], v[56:59], v[32:35], v[96:99]
ds_read_b64_tr_b16 v[14:15], v131 offset:20480
v_mfma_f32_16x16x32_bf16 v[100:103], v[56:59], v[36:39], v[100:103]
ds_read_b128 v[20:23], v136 offset:18432
v_mfma_f32_16x16x32_bf16 v[104:107], v[56:59], v[40:43], v[104:107]
ds_read_b128 v[24:27], v136 offset:20480
buffer_load_dwordx4 v142, s[4:7], s16 offen offset:3072 sc1 lds
v_mfma_f32_16x16x32_bf16 v[108:111], v[56:59], v[44:47], v[108:111]
ds_read_b128 v[28:31], v136 offset:22528
v_mfma_f32_16x16x32_bf16 v[112:115], v[60:63], v[32:35], v[112:115]
s_add_u32 s16, s16, 2048
v_mfma_f32_16x16x32_bf16 v[116:119], v[60:63], v[36:39], v[116:119]
v_mfma_f32_16x16x32_bf16 v[120:123], v[60:63], v[40:43], v[120:123]
v_mfma_f32_16x16x32_bf16 v[124:127], v[60:63], v[44:47], v[124:127]
s_waitcnt lgkmcnt(0)
ds_read_b128 v[48:51], v136 offset:17408
s_add_u32 m0, s19, 0
s_nop 0
v_mfma_f32_16x16x32_bf16 v[64:67], v[16:19], v[0:3], v[64:67]
ds_read_b64_tr_b16 v[32:33], v128 offset:24576
v_mfma_f32_16x16x32_bf16 v[68:71], v[16:19], v[4:7], v[68:71]
ds_read_b64_tr_b16 v[34:35], v128 offset:28672
buffer_load_dwordx4 v137, s[8:11], s15 offen offset:0 lds
v_mfma_f32_16x16x32_bf16 v[72:75], v[16:19], v[8:11], v[72:75]
ds_read_b64_tr_b16 v[36:37], v129 offset:24576
v_mfma_f32_16x16x32_bf16 v[76:79], v[16:19], v[12:15], v[76:79]
ds_read_b64_tr_b16 v[38:39], v129 offset:28672
v_mfma_f32_16x16x32_bf16 v[80:83], v[20:23], v[0:3], v[80:83]
ds_read_b64_tr_b16 v[40:41], v130 offset:24576
buffer_load_dwordx4 v138, s[8:11], s15 offen offset:1024 lds
v_mfma_f32_16x16x32_bf16 v[84:87], v[20:23], v[4:7], v[84:87]
ds_read_b64_tr_b16 v[42:43], v130 offset:28672
v_mfma_f32_16x16x32_bf16 v[88:91], v[20:23], v[8:11], v[88:91]
ds_read_b64_tr_b16 v[44:45], v131 offset:24576
v_mfma_f32_16x16x32_bf16 v[92:95], v[20:23], v[12:15], v[92:95]
ds_read_b64_tr_b16 v[46:47], v131 offset:28672
buffer_load_dwordx4 v139, s[8:11], s15 offen offset:2048 lds
v_mfma_f32_16x16x32_bf16 v[96:99], v[24:27], v[0:3], v[96:99]
ds_read_b128 v[52:55], v136 offset:19456
v_mfma_f32_16x16x32_bf16 v[100:103], v[24:27], v[4:7], v[100:103]
ds_read_b128 v[56:59], v136 offset:21504
buffer_load_dwordx4 v140, s[8:11], s15 offen offset:3072 lds
v_mfma_f32_16x16x32_bf16 v[104:107], v[24:27], v[8:11], v[104:107]
ds_read_b128 v[60:63], v136 offset:23552
v_mfma_f32_16x16x32_bf16 v[108:111], v[24:27], v[12:15], v[108:111]
v_mfma_f32_16x16x32_bf16 v[112:115], v[28:31], v[0:3], v[112:115]
s_add_u32 s15, s15, s17
v_mfma_f32_16x16x32_bf16 v[116:119], v[28:31], v[4:7], v[116:119]
v_mfma_f32_16x16x32_bf16 v[120:123], v[28:31], v[8:11], v[120:123]
v_mfma_f32_16x16x32_bf16 v[124:127], v[28:31], v[12:15], v[124:127]
s_waitcnt lgkmcnt(0)
v_mfma_f32_16x16x32_bf16 v[64:67], v[48:51], v[32:35], v[64:67]
s_waitcnt vmcnt(16)
s_barrier
ds_read_b128 v[16:19], v136 offset:32768
s_add_u32 m0, s20, 16384
s_nop 0
v_mfma_f32_16x16x32_bf16 v[68:71], v[48:51], v[36:39], v[68:71]
ds_read_b64_tr_b16 v[0:1], v128 offset:32768
v_mfma_f32_16x16x32_bf16 v[72:75], v[48:51], v[40:43], v[72:75]
ds_read_b64_tr_b16 v[2:3], v128 offset:36864
buffer_load_dwordx4 v141, s[4:7], s16 offen offset:0 sc1 lds
v_mfma_f32_16x16x32_bf16 v[76:79], v[48:51], v[44:47], v[76:79]
ds_read_b64_tr_b16 v[4:5], v129 offset:32768
v_mfma_f32_16x16x32_bf16 v[80:83], v[52:55], v[32:35], v[80:83]
ds_read_b64_tr_b16 v[6:7], v129 offset:36864
v_mfma_f32_16x16x32_bf16 v[84:87], v[52:55], v[36:39], v[84:87]
ds_read_b64_tr_b16 v[8:9], v130 offset:32768
buffer_load_dwordx4 v141, s[4:7], s16 offen offset:1024 sc1 lds
v_mfma_f32_16x16x32_bf16 v[88:91], v[52:55], v[40:43], v[88:91]
ds_read_b64_tr_b16 v[10:11], v130 offset:36864
v_mfma_f32_16x16x32_bf16 v[92:95], v[52:55], v[44:47], v[92:95]
ds_read_b64_tr_b16 v[12:13], v131 offset:32768
buffer_load_dwordx4 v142, s[4:7], s16 offen offset:2048 sc1 lds
v_mfma_f32_16x16x32_bf16 v[96:99], v[56:59], v[32:35], v[96:99]
ds_read_b64_tr_b16 v[14:15], v131 offset:36864
v_mfma_f32_16x16x32_bf16 v[100:103], v[56:59], v[36:39], v[100:103]
ds_read_b128 v[20:23], v136 offset:34816
v_mfma_f32_16x16x32_bf16 v[104:107], v[56:59], v[40:43], v[104:107]
ds_read_b128 v[24:27], v136 offset:36864
buffer_load_dwordx4 v142, s[4:7], s16 offen offset:3072 sc1 lds
v_mfma_f32_16x16x32_bf16 v[108:111], v[56:59], v[44:47], v[108:111]
ds_read_b128 v[28:31], v136 offset:38912
v_mfma_f32_16x16x32_bf16 v[112:115], v[60:63], v[32:35], v[112:115]
s_add_u32 s16, s16, 2048
v_mfma_f32_16x16x32_bf16 v[116:119], v[60:63], v[36:39], v[116:119]
v_mfma_f32_16x16x32_bf16 v[120:123], v[60:63], v[40:43], v[120:123]
v_mfma_f32_16x16x32_bf16 v[124:127], v[60:63], v[44:47], v[124:127]
s_waitcnt lgkmcnt(0)
ds_read_b128 v[48:51], v136 offset:33792
s_add_u32 m0, s19, 16384
s_nop 0
v_mfma_f32_16x16x32_bf16 v[64:67], v[16:19], v[0:3], v[64:67]
ds_read_b64_tr_b16 v[32:33], v128 offset:40960
v_mfma_f32_16x16x32_bf16 v[68:71], v[16:19], v[4:7], v[68:71]
ds_read_b64_tr_b16 v[34:35], v128 offset:45056
buffer_load_dwordx4 v137, s[8:11], s15 offen offset:0 lds
v_mfma_f32_16x16x32_bf16 v[72:75], v[16:19], v[8:11], v[72:75]
ds_read_b64_tr_b16 v[36:37], v129 offset:40960
v_mfma_f32_16x16x32_bf16 v[76:79], v[16:19], v[12:15], v[76:79]
ds_read_b64_tr_b16 v[38:39], v129 offset:45056
v_mfma_f32_16x16x32_bf16 v[80:83], v[20:23], v[0:3], v[80:83]
ds_read_b64_tr_b16 v[40:41], v130 offset:40960
buffer_load_dwordx4 v138, s[8:11], s15 offen offset:1024 lds
v_mfma_f32_16x16x32_bf16 v[84:87], v[20:23], v[4:7], v[84:87]
ds_read_b64_tr_b16 v[42:43], v130 offset:45056
v_mfma_f32_16x16x32_bf16 v[88:91], v[20:23], v[8:11], v[88:91]
ds_read_b64_tr_b16 v[44:45], v131 offset:40960
v_mfma_f32_16x16x32_bf16 v[92:95], v[20:23], v[12:15], v[92:95]
ds_read_b64_tr_b16 v[46:47], v131 offset:45056
buffer_load_dwordx4 v139, s[8:11], s15 offen offset:2048 lds
v_mfma_f32_16x16x32_bf16 v[96:99], v[24:27], v[0:3], v[96:99]
ds_read_b128 v[52:55], v136 offset:35840
v_mfma_f32_16x16x32_bf16 v[100:103], v[24:27], v[4:7], v[100:103]
ds_read_b128 v[56:59], v136 offset:37888
buffer_load_dwordx4 v140, s[8:11], s15 offen offset:3072 lds
v_mfma_f32_16x16x32_bf16 v[104:107], v[24:27], v[8:11], v[104:107]
ds_read_b128 v[60:63], v136 offset:39936
v_mfma_f32_16x16x32_bf16 v[108:111], v[24:27], v[12:15], v[108:111]
v_mfma_f32_16x16x32_bf16 v[112:115], v[28:31], v[0:3], v[112:115]
s_add_u32 s15, s15, s17
v_mfma_f32_16x16x32_bf16 v[116:119], v[28:31], v[4:7], v[116:119]
v_mfma_f32_16x16x32_bf16 v[120:123], v[28:31], v[8:11], v[120:123]
v_mfma_f32_16x16x32_bf16 v[124:127], v[28:31], v[12:15], v[124:127]
s_waitcnt lgkmcnt(0)
v_mfma_f32_16x16x32_bf16 v[64:67], v[48:51], v[32:35], v[64:67]
s_waitcnt vmcnt(16)
s_barrier
ds_read_b128 v[16:19], v136 offset:49152
s_add_u32 m0, s20, 32768
s_nop 0
v_mfma_f32_16x16x32_bf16 v[68:71], v[48:51], v[36:39], v[68:71]
ds_read_b64_tr_b16 v[0:1], v128 offset:49152
v_mfma_f32_16x16x32_bf16 v[72:75], v[48:51], v[40:43], v[72:75]
ds_read_b64_tr_b16 v[2:3], v128 offset:53248
buffer_load_dwordx4 v141, s[4:7], s16 offen offset:0 sc1 lds
v_mfma_f32_16x16x32_bf16 v[76:79], v[48:51], v[44:47], v[76:79]
ds_read_b64_tr_b16 v[4:5], v129 offset:49152
v_mfma_f32_16x16x32_bf16 v[80:83], v[52:55], v[32:35], v[80:83]
ds_read_b64_tr_b16 v[6:7], v129 offset:53248
v_mfma_f32_16x16x32_bf16 v[84:87], v[52:55], v[36:39], v[84:87]
ds_read_b64_tr_b16 v[8:9], v130 offset:49152
buffer_load_dwordx4 v141, s[4:7], s16 offen offset:1024 sc1 lds
v_mfma_f32_16x16x32_bf16 v[88:91], v[52:55], v[40:43], v[88:91]
ds_read_b64_tr_b16 v[10:11], v130 offset:53248
v_mfma_f32_16x16x32_bf16 v[92:95], v[52:55], v[44:47], v[92:95]
ds_read_b64_tr_b16 v[12:13], v131 offset:49152
buffer_load_dwordx4 v142, s[4:7], s16 offen offset:2048 sc1 lds
v_mfma_f32_16x16x32_bf16 v[96:99], v[56:59], v[32:35], v[96:99]
ds_read_b64_tr_b16 v[14:15], v131 offset:53248
v_mfma_f32_16x16x32_bf16 v[100:103], v[56:59], v[36:39], v[100:103]
ds_read_b128 v[20:23], v136 offset:51200
v_mfma_f32_16x16x32_bf16 v[104:107], v[56:59], v[40:43], v[104:107]
ds_read_b128 v[24:27], v136 offset:53248
buffer_load_dwordx4 v142, s[4:7], s16 offen offset:3072 sc1 lds
v_mfma_f32_16x16x32_bf16 v[108:111], v[56:59], v[44:47], v[108:111]
ds_read_b128 v[28:31], v136 offset:55296
v_mfma_f32_16x16x32_bf16 v[112:115], v[60:63], v[32:35], v[112:115]
s_add_u32 s16, s16, 2048
v_mfma_f32_16x16x32_bf16 v[116:119], v[60:63], v[36:39], v[116:119]
v_mfma_f32_16x16x32_bf16 v[120:123], v[60:63], v[40:43], v[120:123]
v_mfma_f32_16x16x32_bf16 v[124:127], v[60:63], v[44:47], v[124:127]
s_waitcnt lgkmcnt(0)
ds_read_b128 v[48:51], v136 offset:50176
s_add_u32 m0, s19, 32768
s_nop 0
v_mfma_f32_16x16x32_bf16 v[64:67], v[16:19], v[0:3], v[64:67]
ds_read_b64_tr_b16 v[32:33], v128 offset:57344
v_mfma_f32_16x16x32_bf16 v[68:71], v[16:19], v[4:7], v[68:71]
ds_read_b64_tr_b16 v[34:35], v128 offset:61440
buffer_load_dwordx4 v137, s[8:11], s15 offen offset:0 lds
v_mfma_f32_16x16x32_bf16 v[72:75], v[16:19], v[8:11], v[72:75]
ds_read_b64_tr_b16 v[36:37], v129 offset:57344
v_mfma_f32_16x16x32_bf16 v[76:79], v[16:19], v[12:15], v[76:79]
ds_read_b64_tr_b16 v[38:39], v129 offset:61440
v_mfma_f32_16x16x32_bf16 v[80:83], v[20:23], v[0:3], v[80:83]
ds_read_b64_tr_b16 v[40:41], v130 offset:57344
buffer_load_dwordx4 v138, s[8:11], s15 offen offset:1024 lds
v_mfma_f32_16x16x32_bf16 v[84:87], v[20:23], v[4:7], v[84:87]
ds_read_b64_tr_b16 v[42:43], v130 offset:61440
v_mfma_f32_16x16x32_bf16 v[88:91], v[20:23], v[8:11], v[88:91]
ds_read_b64_tr_b16 v[44:45], v131 offset:57344
v_mfma_f32_16x16x32_bf16 v[92:95], v[20:23], v[12:15], v[92:95]
ds_read_b64_tr_b16 v[46:47], v131 offset:61440
buffer_load_dwordx4 v139, s[8:11], s15 offen offset:2048 lds
v_mfma_f32_16x16x32_bf16 v[96:99], v[24:27], v[0:3], v[96:99]
ds_read_b128 v[52:55], v136 offset:52224
v_mfma_f32_16x16x32_bf16 v[100:103], v[24:27], v[4:7], v[100:103]
ds_read_b128 v[56:59], v136 offset:54272
buffer_load_dwordx4 v140, s[8:11], s15 offen offset:3072 lds
v_mfma_f32_16x16x32_bf16 v[104:107], v[24:27], v[8:11], v[104:107]
ds_read_b128 v[60:63], v136 offset:56320
v_mfma_f32_16x16x32_bf16 v[108:111], v[24:27], v[12:15], v[108:111]
v_mfma_f32_16x16x32_bf16 v[112:115], v[28:31], v[0:3], v[112:115]
s_add_u32 s15, s15, s17
v_mfma_f32_16x16x32_bf16 v[116:119], v[28:31], v[4:7], v[116:119]
v_mfma_f32_16x16x32_bf16 v[120:123], v[28:31], v[8:11], v[120:123]
v_mfma_f32_16x16x32_bf16 v[124:127], v[28:31], v[12:15], v[124:127]
s_waitcnt lgkmcnt(0)
v_mfma_f32_16x16x32_bf16 v[64:67], v[48:51], v[32:35], v[64:67]
s_waitcnt vmcnt(16)
s_barrier
ds_read_b128 v[16:19], v136 offset:0
s_add_u32 m0, s20, 49152
s_nop 0
v_mfma_f32_16x16x32_bf16 v[68:71], v[48:51], v[36:39], v[68:71]
ds_read_b64_tr_b16 v[0:1], v128 offset:0
v_mfma_f32_16x16x32_bf16 v[72:75], v[48:51], v[40:43], v[72:75]
ds_read_b64_tr_b16 v[2:3], v128 offset:4096
buffer_load_dwordx4 v141, s[4:7], s16 offen offset:0 sc1 lds
v_mfma_f32_16x16x32_bf16 v[76:79], v[48:51], v[44:47], v[76:79]
ds_read_b64_tr_b16 v[4:5], v129 offset:0
v_mfma_f32_16x16x32_bf16 v[80:83], v[52:55], v[32:35], v[80:83]
ds_read_b64_tr_b16 v[6:7], v129 offset:4096
v_mfma_f32_16x16x32_bf16 v[84:87], v[52:55], v[36:39], v[84:87]
ds_read_b64_tr_b16 v[8:9], v130 offset:0
buffer_load_dwordx4 v141, s[4:7], s16 offen offset:1024 sc1 lds
v_mfma_f32_16x16x32_bf16 v[88:91], v[52:55], v[40:43], v[88:91]
ds_read_b64_tr_b16 v[10:11], v130 offset:4096
v_mfma_f32_16x16x32_bf16 v[92:95], v[52:55], v[44:47], v[92:95]
ds_read_b64_tr_b16 v[12:13], v131 offset:0
buffer_load_dwordx4 v142, s[4:7], s16 offen offset:2048 sc1 lds
v_mfma_f32_16x16x32_bf16 v[96:99], v[56:59], v[32:35], v[96:99]
ds_read_b64_tr_b16 v[14:15], v131 offset:4096
v_mfma_f32_16x16x32_bf16 v[100:103], v[56:59], v[36:39], v[100:103]
ds_read_b128 v[20:23], v136 offset:2048
v_mfma_f32_16x16x32_bf16 v[104:107], v[56:59], v[40:43], v[104:107]
ds_read_b128 v[24:27], v136 offset:4096
buffer_load_dwordx4 v142, s[4:7], s16 offen offset:3072 sc1 lds
v_mfma_f32_16x16x32_bf16 v[108:111], v[56:59], v[44:47], v[108:111]
ds_read_b128 v[28:31], v136 offset:6144
v_mfma_f32_16x16x32_bf16 v[112:115], v[60:63], v[32:35], v[112:115]
s_add_u32 s16, s16, 2048
v_mfma_f32_16x16x32_bf16 v[116:119], v[60:63], v[36:39], v[116:119]
v_mfma_f32_16x16x32_bf16 v[120:123], v[60:63], v[40:43], v[120:123]
v_mfma_f32_16x16x32_bf16 v[124:127], v[60:63], v[44:47], v[124:127]
s_sub_u32 s18, s18, 1
s_cmp_eq_u32 s18, s55
s_cbranch_scc1 main_kernel_w_c0_v_ev
s_cmp_lg_u32 s18, 0
s_cbranch_scc1 main_kernel_w_c0_v_loop
s_cmp_lg_u32 s73, -1
s_cbranch_scc1 main_kernel_w_epn
s_waitcnt lgkmcnt(0)
ds_read_b128 v[48:51], v136 offset:1024
s_add_u32 m0, s19, 49152
s_nop 0
v_mfma_f32_16x16x32_bf16 v[64:67], v[16:19], v[0:3], v[64:67]
ds_read_b64_tr_b16 v[32:33], v128 offset:8192
s_add_u32 s32, s23, 1
s_bitcmp0_b32 s32, 2
s_cselect_b32 s34, 7, 2
s_cselect_b32 s35, 2, 4
s_lshl_b32 s59, s23, 13
s_add_u32 s59, s59, 0x8404000
v_mfma_f32_16x16x32_bf16 v[68:71], v[16:19], v[4:7], v[68:71]
ds_read_b64_tr_b16 v[34:35], v128 offset:12288
buffer_load_dwordx4 v137, s[8:11], s15 offen offset:0 lds
v_lshrrev_b32 v253, 3, v250
v_add_lshl_u32 v253, s24, v253, 9
v_mfma_f32_16x16x32_bf16 v[72:75], v[16:19], v[8:11], v[72:75]
ds_read_b64_tr_b16 v[36:37], v129 offset:8192
v_and_b32 v254, 3, v250
v_lshl_add_u32 v253, v254, s34, v253
v_mfma_f32_16x16x32_bf16 v[76:79], v[16:19], v[12:15], v[76:79]
ds_read_b64_tr_b16 v[38:39], v129 offset:12288
v_bfe_u32 v254, v250, 2, 1
v_add_u32 v254, s25, v254
v_lshl_add_u32 v248, v254, s35, v253
v_mfma_f32_16x16x32_bf16 v[80:83], v[20:23], v[0:3], v[80:83]
ds_read_b64_tr_b16 v[40:41], v130 offset:8192
buffer_load_dwordx4 v138, s[8:11], s15 offen offset:1024 lds
s_lshl_b32 s0, 4, s54
v_readfirstlane_b32 s28, v249
v_mfma_f32_16x16x32_bf16 v[84:87], v[20:23], v[4:7], v[84:87]
ds_read_b64_tr_b16 v[42:43], v130 offset:12288
s_nop 1
v_cmp_ge_u32 vcc, s28, v229
v_mfma_f32_16x16x32_bf16 v[88:91], v[20:23], v[8:11], v[88:91]
ds_read_b64_tr_b16 v[44:45], v131 offset:8192
s_nop 1
s_bcnt1_i32_b64 s32, vcc
v_mfma_f32_16x16x32_bf16 v[92:95], v[20:23], v[12:15], v[92:95]
ds_read_b64_tr_b16 v[46:47], v131 offset:12288
buffer_load_dwordx4 v139, s[8:11], s15 offen offset:2048 lds
s_sub_u32 s32, s32, 1
v_readlane_b32 s36, v230, s32
s_nop 1
v_mfma_f32_16x16x32_bf16 v[96:99], v[24:27], v[0:3], v[96:99]
ds_read_b128 v[52:55], v136 offset:3072
s_and_b32 s32, s36, 0x7ff
s_sub_u32 s28, s28, s32
v_mfma_f32_16x16x32_bf16 v[100:103], v[24:27], v[4:7], v[100:103]
ds_read_b128 v[56:59], v136 offset:5120
buffer_load_dwordx4 v140, s[8:11], s15 offen offset:3072 lds
s_bfe_u32 s32, s36, 0x3001a
s_lshr_b32 s25, s28, s32
v_mfma_f32_16x16x32_bf16 v[104:107], v[24:27], v[8:11], v[104:107]
ds_read_b128 v[60:63], v136 offset:7168
s_lshl_b32 s33, s25, s32
s_sub_u32 s24, s28, s33
v_mfma_f32_16x16x32_bf16 v[108:111], v[24:27], v[12:15], v[108:111]
s_bfe_u32 s34, s36, 0x1001d
s_lshl_b32 s24, s24, s34
s_bfe_u32 s35, s36, 0x1001e
v_mfma_f32_16x16x32_bf16 v[112:115], v[28:31], v[0:3], v[112:115]
s_add_u32 s15, s15, s17
s_lshl_b32 s25, s25, s35
s_bfe_u32 s32, s36, 0x40011
v_mfma_f32_16x16x32_bf16 v[116:119], v[28:31], v[4:7], v[116:119]
s_add_u32 s24, s24, s32
s_bfe_u32 s32, s36, 0x50015
v_mfma_f32_16x16x32_bf16 v[120:123], v[28:31], v[8:11], v[120:123]
s_add_u32 s25, s25, s32
s_bfe_u32 s23, s36, 0x4000b
v_mfma_f32_16x16x32_bf16 v[124:127], v[28:31], v[12:15], v[124:127]
s_waitcnt lgkmcnt(0)
v_mfma_f32_16x16x32_bf16 v[64:67], v[48:51], v[32:35], v[64:67]
s_waitcnt vmcnt(16)
s_barrier
ds_read_b128 v[16:19], v136 offset:16384
s_add_u32 m0, s20, 0
s_nop 0
s_bfe_u32 s36, s36, 0x6000b
s_lshl_b32 s32, s24, 8
s_or_b32 s36, s36, s32
v_mfma_f32_16x16x32_bf16 v[68:71], v[48:51], v[36:39], v[68:71]
ds_read_b64_tr_b16 v[0:1], v128 offset:16384
s_lshl_b32 s32, s25, 16
s_or_b32 s36, s36, s32
v_mfma_f32_16x16x32_bf16 v[72:75], v[48:51], v[40:43], v[72:75]
ds_read_b64_tr_b16 v[2:3], v128 offset:20480
buffer_load_dwordx4 v141, s[4:7], s16 offen offset:0 sc1 lds
s_cmp_eq_u32 s23, 4
s_cselect_b32 s32, 1, 0
s_sub_u32 s48, s24, s32
v_mfma_f32_16x16x32_bf16 v[76:79], v[48:51], v[44:47], v[76:79]
ds_read_b64_tr_b16 v[4:5], v129 offset:16384
s_max_i32 s48, s48, 0
s_add_u32 s49, s24, s34
s_add_u32 s49, s49, s32
v_mfma_f32_16x16x32_bf16 v[80:83], v[52:55], v[32:35], v[80:83]
ds_read_b64_tr_b16 v[6:7], v129 offset:20480
s_min_u32 s49, s49, 15
s_cmp_eq_u32 s23, 6
s_cselect_b32 s51, 3, 7
v_mfma_f32_16x16x32_bf16 v[84:87], v[52:55], v[36:39], v[84:87]
ds_read_b64_tr_b16 v[8:9], v130 offset:16384
buffer_load_dwordx4 v141, s[4:7], s16 offen offset:1024 sc1 lds
s_cmp_eq_u32 s23, 7
s_cselect_b32 s51, 27, s51
s_cselect_b32 s50, 5, 4
s_add_u32 s33, s25, s35
v_mfma_f32_16x16x32_bf16 v[88:91], v[52:55], v[40:43], v[88:91]
ds_read_b64_tr_b16 v[10:11], v130 offset:20480
s_lshl_b32 s34, s24, 9
s_cmp_eq_u32 s23, 8
s_cselect_b32 s51, 0, s51
s_cselect_b32 s48, s25, s48
s_cselect_b32 s49, s33, s49
v_mfma_f32_16x16x32_bf16 v[92:95], v[52:55], v[44:47], v[92:95]
ds_read_b64_tr_b16 v[12:13], v131 offset:16384
buffer_load_dwordx4 v142, s[4:7], s16 offen offset:2048 sc1 lds
s_cmp_eq_u32 s23, 8
s_cselect_b32 s63, 2, 9
s_cselect_b32 s61, 0, 0x7f000000
s_cselect_b32 s34, s34, 0
v_lshrrev_b32 v228, s50, v250
v_lshlrev_b32 v254, s50, v228
v_mfma_f32_16x16x32_bf16 v[96:99], v[56:59], v[32:35], v[96:99]
ds_read_b64_tr_b16 v[14:15], v131 offset:20480
v_sub_u32 v254, v250, v254
s_cmp_lt_u32 s23, 4
s_cselect_b32 s39, 10, s23
v_mfma_f32_16x16x32_bf16 v[100:103], v[56:59], v[36:39], v[100:103]
ds_read_b128 v[20:23], v136 offset:18432
v_min_u32 v254, s51, v254
s_lshl_b32 s39, s39, 13
v_mfma_f32_16x16x32_bf16 v[104:107], v[56:59], v[40:43], v[104:107]
ds_read_b128 v[24:27], v136 offset:20480
buffer_load_dwordx4 v142, s[4:7], s16 offen offset:3072 sc1 lds
s_cmp_eq_u32 s23, 3
s_cselect_b32 s34, 4, s34
v_add_u32 v228, s48, v228
v_mfma_f32_16x16x32_bf16 v[108:111], v[56:59], v[44:47], v[108:111]
ds_read_b128 v[28:31], v136 offset:22528
s_add_u32 s39, s39, s34
s_add_u32 s39, s39, 0x8402000
v_min_u32 v228, s49, v228
v_mfma_f32_16x16x32_bf16 v[112:115], v[60:63], v[32:35], v[112:115]
s_add_u32 s16, s16, 2048
s_lshl_b32 s60, s24, 10
s_add_u32 s60, s60, 0x8400000
v_mfma_f32_16x16x32_bf16 v[116:119], v[60:63], v[36:39], v[116:119]
v_lshlrev_b32 v228, s63, v228
v_lshl_add_u32 v228, v254, 4, v228
v_mfma_f32_16x16x32_bf16 v[120:123], v[60:63], v[40:43], v[120:123]
v_or_b32 v146, s61, v251
s_mov_b64 exec, s[100:101]
buffer_load_dword v231, v228, s[4:7], s39 offen sc1
buffer_load_dwordx4 v[232:235], v146, s[4:7], s60 offen sc1
s_mov_b64 exec, -1
v_mfma_f32_16x16x32_bf16 v[124:127], v[60:63], v[44:47], v[124:127]
s_waitcnt lgkmcnt(0)
ds_read_b128 v[48:51], v136 offset:17408
s_add_u32 m0, s19, 0
s_nop 0
v_mfma_f32_16x16x32_bf16 v[64:67], v[16:19], v[0:3], v[64:67]
ds_read_b64_tr_b16 v[32:33], v128 offset:24576
s_mov_b32 s1, s21
v_mfma_f32_16x16x32_bf16 v[68:71], v[16:19], v[4:7], v[68:71]
ds_read_b64_tr_b16 v[34:35], v128 offset:28672
buffer_load_dwordx4 v137, s[8:11], s15 offen offset:0 lds
v_mfma_f32_16x16x32_bf16 v[72:75], v[16:19], v[8:11], v[72:75]
ds_read_b64_tr_b16 v[36:37], v129 offset:24576
v_mfma_f32_16x16x32_bf16 v[76:79], v[16:19], v[12:15], v[76:79]
ds_read_b64_tr_b16 v[38:39], v129 offset:28672
s_mov_b32 s2, s22
v_mfma_f32_16x16x32_bf16 v[80:83], v[20:23], v[0:3], v[80:83]
ds_read_b64_tr_b16 v[40:41], v130 offset:24576
buffer_load_dwordx4 v138, s[8:11], s15 offen offset:1024 lds
v_mfma_f32_16x16x32_bf16 v[84:87], v[20:23], v[4:7], v[84:87]
ds_read_b64_tr_b16 v[42:43], v130 offset:28672
v_mfma_f32_16x16x32_bf16 v[88:91], v[20:23], v[8:11], v[88:91]
ds_read_b64_tr_b16 v[44:45], v131 offset:24576
v_mfma_f32_16x16x32_bf16 v[92:95], v[20:23], v[12:15], v[92:95]
ds_read_b64_tr_b16 v[46:47], v131 offset:28672
buffer_load_dwordx4 v139, s[8:11], s15 offen offset:2048 lds
s_mov_b32 s3, s26
v_mfma_f32_16x16x32_bf16 v[96:99], v[24:27], v[0:3], v[96:99]
ds_read_b128 v[52:55], v136 offset:19456
v_mfma_f32_16x16x32_bf16 v[100:103], v[24:27], v[4:7], v[100:103]
ds_read_b128 v[56:59], v136 offset:21504
buffer_load_dwordx4 v140, s[8:11], s15 offen offset:3072 lds
v_mfma_f32_16x16x32_bf16 v[104:107], v[24:27], v[8:11], v[104:107]
ds_read_b128 v[60:63], v136 offset:23552
v_mfma_f32_16x16x32_bf16 v[108:111], v[24:27], v[12:15], v[108:111]
s_mov_b32 s56, s57
v_mfma_f32_16x16x32_bf16 v[112:115], v[28:31], v[0:3], v[112:115]
s_add_u32 s15, s15, s17
v_mfma_f32_16x16x32_bf16 v[116:119], v[28:31], v[4:7], v[116:119]
v_mfma_f32_16x16x32_bf16 v[120:123], v[28:31], v[8:11], v[120:123]
v_mfma_f32_16x16x32_bf16 v[124:127], v[28:31], v[12:15], v[124:127]
s_waitcnt lgkmcnt(0)
v_mfma_f32_16x16x32_bf16 v[64:67], v[48:51], v[32:35], v[64:67]
s_waitcnt vmcnt(16)
s_barrier
ds_read_b128 v[16:19], v136 offset:32768
s_add_u32 m0, s20, 16384
s_nop 0
v_mov_b32 v145, v252
v_mfma_f32_16x16x32_bf16 v[68:71], v[48:51], v[36:39], v[68:71]
ds_read_b64_tr_b16 v[0:1], v128 offset:32768
v_mfma_f32_16x16x32_bf16 v[72:75], v[48:51], v[40:43], v[72:75]
ds_read_b64_tr_b16 v[2:3], v128 offset:36864
buffer_load_dwordx4 v141, s[4:7], s16 offen offset:0 sc1 lds
v_mfma_f32_16x16x32_bf16 v[76:79], v[48:51], v[44:47], v[76:79]
ds_read_b64_tr_b16 v[4:5], v129 offset:32768
v_mfma_f32_16x16x32_bf16 v[80:83], v[52:55], v[32:35], v[80:83]
ds_read_b64_tr_b16 v[6:7], v129 offset:36864
v_mfma_f32_16x16x32_bf16 v[84:87], v[52:55], v[36:39], v[84:87]
ds_read_b64_tr_b16 v[8:9], v130 offset:32768
buffer_load_dwordx4 v141, s[4:7], s16 offen offset:1024 sc1 lds
v_mfma_f32_16x16x32_bf16 v[88:91], v[52:55], v[40:43], v[88:91]
ds_read_b64_tr_b16 v[10:11], v130 offset:36864
v_mfma_f32_16x16x32_bf16 v[92:95], v[52:55], v[44:47], v[92:95]
ds_read_b64_tr_b16 v[12:13], v131 offset:32768
buffer_load_dwordx4 v142, s[4:7], s16 offen offset:2048 sc1 lds
v_mov_b32 v255, 131072
v_mfma_f32_16x16x32_bf16 v[96:99], v[56:59], v[32:35], v[96:99]
ds_read_b64_tr_b16 v[14:15], v131 offset:36864
v_mfma_f32_16x16x32_bf16 v[100:103], v[56:59], v[36:39], v[100:103]
ds_read_b128 v[20:23], v136 offset:34816
v_mfma_f32_16x16x32_bf16 v[104:107], v[56:59], v[40:43], v[104:107]
ds_read_b128 v[24:27], v136 offset:36864
buffer_load_dwordx4 v142, s[4:7], s16 offen offset:3072 sc1 lds
v_mfma_f32_16x16x32_bf16 v[108:111], v[56:59], v[44:47], v[108:111]
ds_read_b128 v[28:31], v136 offset:38912
v_mfma_f32_16x16x32_bf16 v[112:115], v[60:63], v[32:35], v[112:115]
s_add_u32 s16, s16, 2048
v_mfma_f32_16x16x32_bf16 v[116:119], v[60:63], v[36:39], v[116:119]
v_mfma_f32_16x16x32_bf16 v[120:123], v[60:63], v[40:43], v[120:123]
v_mfma_f32_16x16x32_bf16 v[124:127], v[60:63], v[44:47], v[124:127]
s_waitcnt lgkmcnt(0)
ds_read_b128 v[48:51], v136 offset:33792
s_add_u32 m0, s19, 16384
s_nop 0
v_mfma_f32_16x16x32_bf16 v[64:67], v[16:19], v[0:3], v[64:67]
ds_read_b64_tr_b16 v[32:33], v128 offset:40960
v_mfma_f32_16x16x32_bf16 v[68:71], v[16:19], v[4:7], v[68:71]
ds_read_b64_tr_b16 v[34:35], v128 offset:45056
buffer_load_dwordx4 v137, s[8:11], s15 offen offset:0 lds
v_mfma_f32_16x16x32_bf16 v[72:75], v[16:19], v[8:11], v[72:75]
ds_read_b64_tr_b16 v[36:37], v129 offset:40960
v_mfma_f32_16x16x32_bf16 v[76:79], v[16:19], v[12:15], v[76:79]
ds_read_b64_tr_b16 v[38:39], v129 offset:45056
v_mfma_f32_16x16x32_bf16 v[80:83], v[20:23], v[0:3], v[80:83]
ds_read_b64_tr_b16 v[40:41], v130 offset:40960
buffer_load_dwordx4 v138, s[8:11], s15 offen offset:1024 lds
v_mfma_f32_16x16x32_bf16 v[84:87], v[20:23], v[4:7], v[84:87]
ds_read_b64_tr_b16 v[42:43], v130 offset:45056
v_mfma_f32_16x16x32_bf16 v[88:91], v[20:23], v[8:11], v[88:91]
ds_read_b64_tr_b16 v[44:45], v131 offset:40960
v_mfma_f32_16x16x32_bf16 v[92:95], v[20:23], v[12:15], v[92:95]
ds_read_b64_tr_b16 v[46:47], v131 offset:45056
buffer_load_dwordx4 v139, s[8:11], s15 offen offset:2048 lds
v_mfma_f32_16x16x32_bf16 v[96:99], v[24:27], v[0:3], v[96:99]
ds_read_b128 v[52:55], v136 offset:35840
v_mfma_f32_16x16x32_bf16 v[100:103], v[24:27], v[4:7], v[100:103]
ds_read_b128 v[56:59], v136 offset:37888
buffer_load_dwordx4 v140, s[8:11], s15 offen offset:3072 lds
v_mfma_f32_16x16x32_bf16 v[104:107], v[24:27], v[8:11], v[104:107]
ds_read_b128 v[60:63], v136 offset:39936
v_mfma_f32_16x16x32_bf16 v[108:111], v[24:27], v[12:15], v[108:111]
v_mfma_f32_16x16x32_bf16 v[112:115], v[28:31], v[0:3], v[112:115]
s_add_u32 s15, s15, s17
v_mfma_f32_16x16x32_bf16 v[116:119], v[28:31], v[4:7], v[116:119]
v_mfma_f32_16x16x32_bf16 v[120:123], v[28:31], v[8:11], v[120:123]
v_mfma_f32_16x16x32_bf16 v[124:127], v[28:31], v[12:15], v[124:127]
s_waitcnt lgkmcnt(0)
v_mfma_f32_16x16x32_bf16 v[64:67], v[48:51], v[32:35], v[64:67]
s_waitcnt vmcnt(16)
s_barrier
ds_read_b128 v[16:19], v136 offset:49152
s_add_u32 m0, s20, 32768
s_nop 0
v_mfma_f32_16x16x32_bf16 v[68:71], v[48:51], v[36:39], v[68:71]
ds_read_b64_tr_b16 v[0:1], v128 offset:49152
v_mfma_f32_16x16x32_bf16 v[72:75], v[48:51], v[40:43], v[72:75]
ds_read_b64_tr_b16 v[2:3], v128 offset:53248
buffer_load_dwordx4 v141, s[4:7], s16 offen offset:0 sc1 lds
v_mfma_f32_16x16x32_bf16 v[76:79], v[48:51], v[44:47], v[76:79]
ds_read_b64_tr_b16 v[4:5], v129 offset:49152
v_mfma_f32_16x16x32_bf16 v[80:83], v[52:55], v[32:35], v[80:83]
ds_read_b64_tr_b16 v[6:7], v129 offset:53248
s_waitcnt vmcnt(13)
v_mfma_f32_16x16x32_bf16 v[84:87], v[52:55], v[36:39], v[84:87]
ds_read_b64_tr_b16 v[8:9], v130 offset:49152
buffer_load_dwordx4 v141, s[4:7], s16 offen offset:1024 sc1 lds
v_min3_u32 v253, v232, v233, v234
v_mfma_f32_16x16x32_bf16 v[88:91], v[52:55], v[40:43], v[88:91]
ds_read_b64_tr_b16 v[10:11], v130 offset:53248
v_min_u32 v253, v253, v235
v_mfma_f32_16x16x32_bf16 v[92:95], v[52:55], v[44:47], v[92:95]
ds_read_b64_tr_b16 v[12:13], v131 offset:49152
buffer_load_dwordx4 v142, s[4:7], s16 offen offset:2048 sc1 lds
v_or_b32 v253, s61, v253
v_mfma_f32_16x16x32_bf16 v[96:99], v[56:59], v[32:35], v[96:99]
ds_read_b64_tr_b16 v[14:15], v131 offset:53248
v_min_u32 v253, v253, v231
v_mfma_f32_16x16x32_bf16 v[100:103], v[56:59], v[36:39], v[100:103]
ds_read_b128 v[20:23], v136 offset:51200
v_cmp_eq_u32 vcc, 0, v253
v_mfma_f32_16x16x32_bf16 v[104:107], v[56:59], v[40:43], v[104:107]
ds_read_b128 v[24:27], v136 offset:53248
buffer_load_dwordx4 v142, s[4:7], s16 offen offset:3072 sc1 lds
s_nop 1
v_mfma_f32_16x16x32_bf16 v[108:111], v[56:59], v[44:47], v[108:111]
ds_read_b128 v[28:31], v136 offset:55296
s_cmp_eq_u64 vcc, 0
s_cselect_b32 s32, s36, -4
v_mfma_f32_16x16x32_bf16 v[112:115], v[60:63], v[32:35], v[112:115]
s_add_u32 s16, s16, 2048
s_bitcmp1_b32 0x1df, s23
s_cselect_b32 s32, s32, -4
v_mfma_f32_16x16x32_bf16 v[116:119], v[60:63], v[36:39], v[116:119]
v_mov_b32 v254, s32
v_mfma_f32_16x16x32_bf16 v[120:123], v[60:63], v[40:43], v[120:123]
s_mov_b64 exec, s[100:101]
ds_write_b32 v255, v254
s_mov_b64 exec, -1
v_mfma_f32_16x16x32_bf16 v[124:127], v[60:63], v[44:47], v[124:127]
s_waitcnt lgkmcnt(0)
ds_read_b128 v[48:51], v136 offset:50176
s_add_u32 m0, s19, 32768
s_nop 0
v_mfma_f32_16x16x32_bf16 v[64:67], v[16:19], v[0:3], v[64:67]
ds_read_b64_tr_b16 v[32:33], v128 offset:57344
v_mfma_f32_16x16x32_bf16 v[68:71], v[16:19], v[4:7], v[68:71]
ds_read_b64_tr_b16 v[34:35], v128 offset:61440
buffer_load_dwordx4 v137, s[8:11], s15 offen offset:0 lds
v_mfma_f32_16x16x32_bf16 v[72:75], v[16:19], v[8:11], v[72:75]
ds_read_b64_tr_b16 v[36:37], v129 offset:57344
v_mfma_f32_16x16x32_bf16 v[76:79], v[16:19], v[12:15], v[76:79]
ds_read_b64_tr_b16 v[38:39], v129 offset:61440
v_mfma_f32_16x16x32_bf16 v[80:83], v[20:23], v[0:3], v[80:83]
ds_read_b64_tr_b16 v[40:41], v130 offset:57344
buffer_load_dwordx4 v138, s[8:11], s15 offen offset:1024 lds
v_mfma_f32_16x16x32_bf16 v[84:87], v[20:23], v[4:7], v[84:87]
ds_read_b64_tr_b16 v[42:43], v130 offset:61440
v_mfma_f32_16x16x32_bf16 v[88:91], v[20:23], v[8:11], v[88:91]
ds_read_b64_tr_b16 v[44:45], v131 offset:57344
v_mfma_f32_16x16x32_bf16 v[92:95], v[20:23], v[12:15], v[92:95]
ds_read_b64_tr_b16 v[46:47], v131 offset:61440
buffer_load_dwordx4 v139, s[8:11], s15 offen offset:2048 lds
v_mfma_f32_16x16x32_bf16 v[96:99], v[24:27], v[0:3], v[96:99]
ds_read_b128 v[52:55], v136 offset:52224
v_mfma_f32_16x16x32_bf16 v[100:103], v[24:27], v[4:7], v[100:103]
ds_read_b128 v[56:59], v136 offset:54272
buffer_load_dwordx4 v140, s[8:11], s15 offen offset:3072 lds
v_mfma_f32_16x16x32_bf16 v[104:107], v[24:27], v[8:11], v[104:107]
ds_read_b128 v[60:63], v136 offset:56320
v_mfma_f32_16x16x32_bf16 v[108:111], v[24:27], v[12:15], v[108:111]
v_mfma_f32_16x16x32_bf16 v[112:115], v[28:31], v[0:3], v[112:115]
s_add_u32 s15, s15, s17
v_mfma_f32_16x16x32_bf16 v[116:119], v[28:31], v[4:7], v[116:119]
v_mfma_f32_16x16x32_bf16 v[120:123], v[28:31], v[8:11], v[120:123]
v_mfma_f32_16x16x32_bf16 v[124:127], v[28:31], v[12:15], v[124:127]
s_waitcnt lgkmcnt(0)
v_mfma_f32_16x16x32_bf16 v[64:67], v[48:51], v[32:35], v[64:67]
s_waitcnt vmcnt(16)
s_barrier
ds_read_b128 v[16:19], v136 offset:0
s_add_u32 m0, s20, 49152
s_nop 0
ds_read_b32 v254, v255
v_mfma_f32_16x16x32_bf16 v[68:71], v[48:51], v[36:39], v[68:71]
ds_read_b64_tr_b16 v[0:1], v128 offset:0
v_mfma_f32_16x16x32_bf16 v[72:75], v[48:51], v[40:43], v[72:75]
ds_read_b64_tr_b16 v[2:3], v128 offset:4096
buffer_load_dwordx4 v141, s[4:7], s16 offen offset:0 sc1 lds
v_mfma_f32_16x16x32_bf16 v[76:79], v[48:51], v[44:47], v[76:79]
ds_read_b64_tr_b16 v[4:5], v129 offset:0
v_mfma_f32_16x16x32_bf16 v[80:83], v[52:55], v[32:35], v[80:83]
ds_read_b64_tr_b16 v[6:7], v129 offset:4096
v_mfma_f32_16x16x32_bf16 v[84:87], v[52:55], v[36:39], v[84:87]
ds_read_b64_tr_b16 v[8:9], v130 offset:0
buffer_load_dwordx4 v141, s[4:7], s16 offen offset:1024 sc1 lds
v_mfma_f32_16x16x32_bf16 v[88:91], v[52:55], v[40:43], v[88:91]
ds_read_b64_tr_b16 v[10:11], v130 offset:4096
v_mfma_f32_16x16x32_bf16 v[92:95], v[52:55], v[44:47], v[92:95]
ds_read_b64_tr_b16 v[12:13], v131 offset:0
buffer_load_dwordx4 v142, s[4:7], s16 offen offset:2048 sc1 lds
v_mfma_f32_16x16x32_bf16 v[96:99], v[56:59], v[32:35], v[96:99]
ds_read_b64_tr_b16 v[14:15], v131 offset:4096
v_mfma_f32_16x16x32_bf16 v[100:103], v[56:59], v[36:39], v[100:103]
ds_read_b128 v[20:23], v136 offset:2048
v_mfma_f32_16x16x32_bf16 v[104:107], v[56:59], v[40:43], v[104:107]
ds_read_b128 v[24:27], v136 offset:4096
buffer_load_dwordx4 v142, s[4:7], s16 offen offset:3072 sc1 lds
v_mfma_f32_16x16x32_bf16 v[108:111], v[56:59], v[44:47], v[108:111]
ds_read_b128 v[28:31], v136 offset:6144
v_mfma_f32_16x16x32_bf16 v[112:115], v[60:63], v[32:35], v[112:115]
s_add_u32 s16, s16, 2048
v_mfma_f32_16x16x32_bf16 v[116:119], v[60:63], v[36:39], v[116:119]
v_mfma_f32_16x16x32_bf16 v[120:123], v[60:63], v[40:43], v[120:123]
v_mfma_f32_16x16x32_bf16 v[124:127], v[60:63], v[44:47], v[124:127]
s_waitcnt lgkmcnt(0)
ds_read_b128 v[48:51], v136 offset:1024
s_add_u32 m0, s19, 49152
s_nop 0
v_mfma_f32_16x16x32_bf16 v[64:67], v[16:19], v[0:3], v[64:67]
ds_read_b64_tr_b16 v[32:33], v128 offset:8192
v_readfirstlane_b32 s62, v254
v_mfma_f32_16x16x32_bf16 v[68:71], v[16:19], v[4:7], v[68:71]
ds_read_b64_tr_b16 v[34:35], v128 offset:12288
buffer_load_dwordx4 v137, s[8:11], s15 offen offset:0 lds
v_mfma_f32_16x16x32_bf16 v[72:75], v[16:19], v[8:11], v[72:75]
ds_read_b64_tr_b16 v[36:37], v129 offset:8192
s_nop 1
v_mfma_f32_16x16x32_bf16 v[76:79], v[16:19], v[12:15], v[76:79]
ds_read_b64_tr_b16 v[38:39], v129 offset:12288
v_mfma_f32_16x16x32_bf16 v[80:83], v[20:23], v[0:3], v[80:83]
ds_read_b64_tr_b16 v[40:41], v130 offset:8192
buffer_load_dwordx4 v138, s[8:11], s15 offen offset:1024 lds
v_mfma_f32_16x16x32_bf16 v[84:87], v[20:23], v[4:7], v[84:87]
ds_read_b64_tr_b16 v[42:43], v130 offset:12288
s_and_b32 s23, s62, 15
v_mfma_f32_16x16x32_bf16 v[88:91], v[20:23], v[8:11], v[88:91]
ds_read_b64_tr_b16 v[44:45], v131 offset:8192
v_mfma_f32_16x16x32_bf16 v[92:95], v[20:23], v[12:15], v[92:95]
ds_read_b64_tr_b16 v[46:47], v131 offset:12288
buffer_load_dwordx4 v139, s[8:11], s15 offen offset:2048 lds
s_bfe_u32 s54, s62, 0x20004
v_mfma_f32_16x16x32_bf16 v[96:99], v[24:27], v[0:3], v[96:99]
ds_read_b128 v[52:55], v136 offset:3072
v_mfma_f32_16x16x32_bf16 v[100:103], v[24:27], v[4:7], v[100:103]
ds_read_b128 v[56:59], v136 offset:5120
buffer_load_dwordx4 v140, s[8:11], s15 offen offset:3072 lds
v_mfma_f32_16x16x32_bf16 v[104:107], v[24:27], v[8:11], v[104:107]
ds_read_b128 v[60:63], v136 offset:7168
s_bfe_u32 s24, s62, 0x80008
v_mfma_f32_16x16x32_bf16 v[108:111], v[24:27], v[12:15], v[108:111]
v_mfma_f32_16x16x32_bf16 v[112:115], v[28:31], v[0:3], v[112:115]
s_add_u32 s15, s15, s17
s_lshr_b32 s25, s62, 16
v_mfma_f32_16x16x32_bf16 v[116:119], v[28:31], v[4:7], v[116:119]
v_mfma_f32_16x16x32_bf16 v[120:123], v[28:31], v[8:11], v[120:123]
v_mfma_f32_16x16x32_bf16 v[124:127], v[28:31], v[12:15], v[124:127]
s_cmp_eq_u32 s54, 0
s_cselect_b32 s73, 1, -1
s_cbranch_scc1 main_kernel_w_c0_task
s_waitcnt lgkmcnt(0)
v_mfma_f32_16x16x32_bf16 v[64:67], v[48:51], v[32:35], v[64:67]
s_waitcnt vmcnt(16)
s_barrier
ds_read_b128 v[16:19], v136 offset:16384
v_mfma_f32_16x16x32_bf16 v[68:71], v[48:51], v[36:39], v[68:71]
ds_read_b64_tr_b16 v[0:1], v128 offset:16384
v_mfma_f32_16x16x32_bf16 v[72:75], v[48:51], v[40:43], v[72:75]
ds_read_b64_tr_b16 v[2:3], v128 offset:20480
v_mfma_f32_16x16x32_bf16 v[76:79], v[48:51], v[44:47], v[76:79]
ds_read_b64_tr_b16 v[4:5], v129 offset:16384
v_mfma_f32_16x16x32_bf16 v[80:83], v[52:55], v[32:35], v[80:83]
ds_read_b64_tr_b16 v[6:7], v129 offset:20480
v_mfma_f32_16x16x32_bf16 v[84:87], v[52:55], v[36:39], v[84:87]
ds_read_b64_tr_b16 v[8:9], v130 offset:16384
v_mfma_f32_16x16x32_bf16 v[88:91], v[52:55], v[40:43], v[88:91]
ds_read_b64_tr_b16 v[10:11], v130 offset:20480
v_mfma_f32_16x16x32_bf16 v[92:95], v[52:55], v[44:47], v[92:95]
ds_read_b64_tr_b16 v[12:13], v131 offset:16384
v_mfma_f32_16x16x32_bf16 v[96:99], v[56:59], v[32:35], v[96:99]
ds_read_b64_tr_b16 v[14:15], v131 offset:20480
v_mfma_f32_16x16x32_bf16 v[100:103], v[56:59], v[36:39], v[100:103]
ds_read_b128 v[20:23], v136 offset:18432
v_mfma_f32_16x16x32_bf16 v[104:107], v[56:59], v[40:43], v[104:107]
ds_read_b128 v[24:27], v136 offset:20480
v_mfma_f32_16x16x32_bf16 v[108:111], v[56:59], v[44:47], v[108:111]
ds_read_b128 v[28:31], v136 offset:22528
v_mfma_f32_16x16x32_bf16 v[112:115], v[60:63], v[32:35], v[112:115]
v_mfma_f32_16x16x32_bf16 v[116:119], v[60:63], v[36:39], v[116:119]
v_mfma_f32_16x16x32_bf16 v[120:123], v[60:63], v[40:43], v[120:123]
v_mfma_f32_16x16x32_bf16 v[124:127], v[60:63], v[44:47], v[124:127]
s_waitcnt lgkmcnt(0)
ds_read_b128 v[48:51], v136 offset:17408
v_mfma_f32_16x16x32_bf16 v[64:67], v[16:19], v[0:3], v[64:67]
ds_read_b64_tr_b16 v[32:33], v128 offset:24576
v_mfma_f32_16x16x32_bf16 v[68:71], v[16:19], v[4:7], v[68:71]
ds_read_b64_tr_b16 v[34:35], v128 offset:28672
v_mfma_f32_16x16x32_bf16 v[72:75], v[16:19], v[8:11], v[72:75]
ds_read_b64_tr_b16 v[36:37], v129 offset:24576
v_mfma_f32_16x16x32_bf16 v[76:79], v[16:19], v[12:15], v[76:79]
ds_read_b64_tr_b16 v[38:39], v129 offset:28672
v_mfma_f32_16x16x32_bf16 v[80:83], v[20:23], v[0:3], v[80:83]
ds_read_b64_tr_b16 v[40:41], v130 offset:24576
v_mfma_f32_16x16x32_bf16 v[84:87], v[20:23], v[4:7], v[84:87]
ds_read_b64_tr_b16 v[42:43], v130 offset:28672
v_mfma_f32_16x16x32_bf16 v[88:91], v[20:23], v[8:11], v[88:91]
ds_read_b64_tr_b16 v[44:45], v131 offset:24576
v_mfma_f32_16x16x32_bf16 v[92:95], v[20:23], v[12:15], v[92:95]
ds_read_b64_tr_b16 v[46:47], v131 offset:28672
v_mfma_f32_16x16x32_bf16 v[96:99], v[24:27], v[0:3], v[96:99]
ds_read_b128 v[52:55], v136 offset:19456
v_mfma_f32_16x16x32_bf16 v[100:103], v[24:27], v[4:7], v[100:103]
ds_read_b128 v[56:59], v136 offset:21504
v_mfma_f32_16x16x32_bf16 v[104:107], v[24:27], v[8:11], v[104:107]
ds_read_b128 v[60:63], v136 offset:23552
v_mfma_f32_16x16x32_bf16 v[108:111], v[24:27], v[12:15], v[108:111]
v_mfma_f32_16x16x32_bf16 v[112:115], v[28:31], v[0:3], v[112:115]
v_mfma_f32_16x16x32_bf16 v[116:119], v[28:31], v[4:7], v[116:119]
v_mfma_f32_16x16x32_bf16 v[120:123], v[28:31], v[8:11], v[120:123]
v_mfma_f32_16x16x32_bf16 v[124:127], v[28:31], v[12:15], v[124:127]
s_waitcnt lgkmcnt(0)
v_mfma_f32_16x16x32_bf16 v[64:67], v[48:51], v[32:35], v[64:67]
s_waitcnt vmcnt(8)
s_barrier
ds_read_b128 v[16:19], v136 offset:32768
v_mfma_f32_16x16x32_bf16 v[68:71], v[48:51], v[36:39], v[68:71]
ds_read_b64_tr_b16 v[0:1], v128 offset:32768
v_mfma_f32_16x16x32_bf16 v[72:75], v[48:51], v[40:43], v[72:75]
ds_read_b64_tr_b16 v[2:3], v128 offset:36864
v_mfma_f32_16x16x32_bf16 v[76:79], v[48:51], v[44:47], v[76:79]
ds_read_b64_tr_b16 v[4:5], v129 offset:32768
v_mfma_f32_16x16x32_bf16 v[80:83], v[52:55], v[32:35], v[80:83]
ds_read_b64_tr_b16 v[6:7], v129 offset:36864
v_mfma_f32_16x16x32_bf16 v[84:87], v[52:55], v[36:39], v[84:87]
ds_read_b64_tr_b16 v[8:9], v130 offset:32768
v_mfma_f32_16x16x32_bf16 v[88:91], v[52:55], v[40:43], v[88:91]
ds_read_b64_tr_b16 v[10:11], v130 offset:36864
v_mfma_f32_16x16x32_bf16 v[92:95], v[52:55], v[44:47], v[92:95]
ds_read_b64_tr_b16 v[12:13], v131 offset:32768
v_mfma_f32_16x16x32_bf16 v[96:99], v[56:59], v[32:35], v[96:99]
ds_read_b64_tr_b16 v[14:15], v131 offset:36864
v_mfma_f32_16x16x32_bf16 v[100:103], v[56:59], v[36:39], v[100:103]
ds_read_b128 v[20:23], v136 offset:34816
v_mfma_f32_16x16x32_bf16 v[104:107], v[56:59], v[40:43], v[104:107]
ds_read_b128 v[24:27], v136 offset:36864
v_mfma_f32_16x16x32_bf16 v[108:111], v[56:59], v[44:47], v[108:111]
ds_read_b128 v[28:31], v136 offset:38912
v_mfma_f32_16x16x32_bf16 v[112:115], v[60:63], v[32:35], v[112:115]
v_mfma_f32_16x16x32_bf16 v[116:119], v[60:63], v[36:39], v[116:119]
v_mfma_f32_16x16x32_bf16 v[120:123], v[60:63], v[40:43], v[120:123]
v_mfma_f32_16x16x32_bf16 v[124:127], v[60:63], v[44:47], v[124:127]
s_waitcnt lgkmcnt(0)
ds_read_b128 v[48:51], v136 offset:33792
v_mfma_f32_16x16x32_bf16 v[64:67], v[16:19], v[0:3], v[64:67]
ds_read_b64_tr_b16 v[32:33], v128 offset:40960
v_mfma_f32_16x16x32_bf16 v[68:71], v[16:19], v[4:7], v[68:71]
ds_read_b64_tr_b16 v[34:35], v128 offset:45056
v_mfma_f32_16x16x32_bf16 v[72:75], v[16:19], v[8:11], v[72:75]
ds_read_b64_tr_b16 v[36:37], v129 offset:40960
v_mfma_f32_16x16x32_bf16 v[76:79], v[16:19], v[12:15], v[76:79]
ds_read_b64_tr_b16 v[38:39], v129 offset:45056
v_mfma_f32_16x16x32_bf16 v[80:83], v[20:23], v[0:3], v[80:83]
ds_read_b64_tr_b16 v[40:41], v130 offset:40960
v_mfma_f32_16x16x32_bf16 v[84:87], v[20:23], v[4:7], v[84:87]
ds_read_b64_tr_b16 v[42:43], v130 offset:45056
v_mfma_f32_16x16x32_bf16 v[88:91], v[20:23], v[8:11], v[88:91]
ds_read_b64_tr_b16 v[44:45], v131 offset:40960
v_mfma_f32_16x16x32_bf16 v[92:95], v[20:23], v[12:15], v[92:95]
ds_read_b64_tr_b16 v[46:47], v131 offset:45056
v_mfma_f32_16x16x32_bf16 v[96:99], v[24:27], v[0:3], v[96:99]
ds_read_b128 v[52:55], v136 offset:35840
v_mfma_f32_16x16x32_bf16 v[100:103], v[24:27], v[4:7], v[100:103]
ds_read_b128 v[56:59], v136 offset:37888
v_mfma_f32_16x16x32_bf16 v[104:107], v[24:27], v[8:11], v[104:107]
ds_read_b128 v[60:63], v136 offset:39936
v_mfma_f32_16x16x32_bf16 v[108:111], v[24:27], v[12:15], v[108:111]
v_mfma_f32_16x16x32_bf16 v[112:115], v[28:31], v[0:3], v[112:115]
v_mfma_f32_16x16x32_bf16 v[116:119], v[28:31], v[4:7], v[116:119]
v_mfma_f32_16x16x32_bf16 v[120:123], v[28:31], v[8:11], v[120:123]
v_mfma_f32_16x16x32_bf16 v[124:127], v[28:31], v[12:15], v[124:127]
s_waitcnt lgkmcnt(0)
v_mfma_f32_16x16x32_bf16 v[64:67], v[48:51], v[32:35], v[64:67]
s_waitcnt vmcnt(0)
s_barrier
ds_read_b128 v[16:19], v136 offset:49152
v_mfma_f32_16x16x32_bf16 v[68:71], v[48:51], v[36:39], v[68:71]
ds_read_b64_tr_b16 v[0:1], v128 offset:49152
v_mfma_f32_16x16x32_bf16 v[72:75], v[48:51], v[40:43], v[72:75]
ds_read_b64_tr_b16 v[2:3], v128 offset:53248
v_mfma_f32_16x16x32_bf16 v[76:79], v[48:51], v[44:47], v[76:79]
ds_read_b64_tr_b16 v[4:5], v129 offset:49152
v_mfma_f32_16x16x32_bf16 v[80:83], v[52:55], v[32:35], v[80:83]
ds_read_b64_tr_b16 v[6:7], v129 offset:53248
v_mfma_f32_16x16x32_bf16 v[84:87], v[52:55], v[36:39], v[84:87]
ds_read_b64_tr_b16 v[8:9], v130 offset:49152
v_mfma_f32_16x16x32_bf16 v[88:91], v[52:55], v[40:43], v[88:91]
ds_read_b64_tr_b16 v[10:11], v130 offset:53248
v_mfma_f32_16x16x32_bf16 v[92:95], v[52:55], v[44:47], v[92:95]
ds_read_b64_tr_b16 v[12:13], v131 offset:49152
v_mfma_f32_16x16x32_bf16 v[96:99], v[56:59], v[32:35], v[96:99]
ds_read_b64_tr_b16 v[14:15], v131 offset:53248
v_mfma_f32_16x16x32_bf16 v[100:103], v[56:59], v[36:39], v[100:103]
ds_read_b128 v[20:23], v136 offset:51200
v_mfma_f32_16x16x32_bf16 v[104:107], v[56:59], v[40:43], v[104:107]
ds_read_b128 v[24:27], v136 offset:53248
v_mfma_f32_16x16x32_bf16 v[108:111], v[56:59], v[44:47], v[108:111]
ds_read_b128 v[28:31], v136 offset:55296
v_mfma_f32_16x16x32_bf16 v[112:115], v[60:63], v[32:35], v[112:115]
v_mfma_f32_16x16x32_bf16 v[116:119], v[60:63], v[36:39], v[116:119]
v_mfma_f32_16x16x32_bf16 v[120:123], v[60:63], v[40:43], v[120:123]
v_mfma_f32_16x16x32_bf16 v[124:127], v[60:63], v[44:47], v[124:127]
s_waitcnt lgkmcnt(0)
ds_read_b128 v[48:51], v136 offset:50176
v_mfma_f32_16x16x32_bf16 v[64:67], v[16:19], v[0:3], v[64:67]
ds_read_b64_tr_b16 v[32:33], v128 offset:57344
v_mfma_f32_16x16x32_bf16 v[68:71], v[16:19], v[4:7], v[68:71]
ds_read_b64_tr_b16 v[34:35], v128 offset:61440
v_mfma_f32_16x16x32_bf16 v[72:75], v[16:19], v[8:11], v[72:75]
ds_read_b64_tr_b16 v[36:37], v129 offset:57344
v_mfma_f32_16x16x32_bf16 v[76:79], v[16:19], v[12:15], v[76:79]
ds_read_b64_tr_b16 v[38:39], v129 offset:61440
v_mfma_f32_16x16x32_bf16 v[80:83], v[20:23], v[0:3], v[80:83]
ds_read_b64_tr_b16 v[40:41], v130 offset:57344
v_mfma_f32_16x16x32_bf16 v[84:87], v[20:23], v[4:7], v[84:87]
ds_read_b64_tr_b16 v[42:43], v130 offset:61440
v_mfma_f32_16x16x32_bf16 v[88:91], v[20:23], v[8:11], v[88:91]
ds_read_b64_tr_b16 v[44:45], v131 offset:57344
v_mfma_f32_16x16x32_bf16 v[92:95], v[20:23], v[12:15], v[92:95]
ds_read_b64_tr_b16 v[46:47], v131 offset:61440
v_mfma_f32_16x16x32_bf16 v[96:99], v[24:27], v[0:3], v[96:99]
ds_read_b128 v[52:55], v136 offset:52224
v_mfma_f32_16x16x32_bf16 v[100:103], v[24:27], v[4:7], v[100:103]
ds_read_b128 v[56:59], v136 offset:54272
v_mfma_f32_16x16x32_bf16 v[104:107], v[24:27], v[8:11], v[104:107]
ds_read_b128 v[60:63], v136 offset:56320
v_mfma_f32_16x16x32_bf16 v[108:111], v[24:27], v[12:15], v[108:111]
v_mfma_f32_16x16x32_bf16 v[112:115], v[28:31], v[0:3], v[112:115]
v_mfma_f32_16x16x32_bf16 v[116:119], v[28:31], v[4:7], v[116:119]
v_mfma_f32_16x16x32_bf16 v[120:123], v[28:31], v[8:11], v[120:123]
v_mfma_f32_16x16x32_bf16 v[124:127], v[28:31], v[12:15], v[124:127]
s_waitcnt lgkmcnt(0)
v_mfma_f32_16x16x32_bf16 v[64:67], v[48:51], v[32:35], v[64:67]
s_barrier
v_mfma_f32_16x16x32_bf16 v[68:71], v[48:51], v[36:39], v[68:71]
v_mfma_f32_16x16x32_bf16 v[72:75], v[48:51], v[40:43], v[72:75]
v_mfma_f32_16x16x32_bf16 v[76:79], v[48:51], v[44:47], v[76:79]
v_mfma_f32_16x16x32_bf16 v[80:83], v[52:55], v[32:35], v[80:83]
v_mfma_f32_16x16x32_bf16 v[84:87], v[52:55], v[36:39], v[84:87]
v_mfma_f32_16x16x32_bf16 v[88:91], v[52:55], v[40:43], v[88:91]
v_mfma_f32_16x16x32_bf16 v[92:95], v[52:55], v[44:47], v[92:95]
v_mfma_f32_16x16x32_bf16 v[96:99], v[56:59], v[32:35], v[96:99]
v_mfma_f32_16x16x32_bf16 v[100:103], v[56:59], v[36:39], v[100:103]
v_mfma_f32_16x16x32_bf16 v[104:107], v[56:59], v[40:43], v[104:107]
v_mfma_f32_16x16x32_bf16 v[108:111], v[56:59], v[44:47], v[108:111]
v_mfma_f32_16x16x32_bf16 v[112:115], v[60:63], v[32:35], v[112:115]
v_mfma_f32_16x16x32_bf16 v[116:119], v[60:63], v[36:39], v[116:119]
v_mfma_f32_16x16x32_bf16 v[120:123], v[60:63], v[40:43], v[120:123]
v_mfma_f32_16x16x32_bf16 v[124:127], v[60:63], v[44:47], v[124:127]
s_cmp_lg_u32 s62, -4
s_cbranch_scc1 main_kernel_w_gemm
s_branch main_kernel_w_slow
main_kernel_w_c0_v_ev:
s_mov_b32 s55, 1
s_cmp_eq_u32 s56, 0
s_cbranch_scc1 main_kernel_w_c0_v_et
s_bfm_b64 exec, s0, 0
buffer_store_dword v244, v248, s[4:7], s59 offen sc1
s_mov_b64 exec, -1
s_mov_b32 s56, 0
main_kernel_w_c0_v_et:
s_cmp_lg_u32 s18, 1
s_cbranch_scc1 main_kernel_w_c0_v_loop
s_lshl_b32 s32, s27, 8
s_add_u32 s32, s32, 0x841e000
s_mov_b64 exec, 1
v_mov_b32 v249, 1
buffer_atomic_add v249, off, s[4:7], s32 sc0 sc1
s_mov_b64 exec, -1
s_branch main_kernel_w_c0_v_loop
main_kernel_w_c1_task:
s_cmp_eq_u32 s23, 0
s_cbranch_scc1 main_kernel_w_c1_set0
s_cmp_eq_u32 s23, 1
s_cbranch_scc1 main_kernel_w_c1_set1
s_cmp_eq_u32 s23, 2
s_cbranch_scc1 main_kernel_w_c1_set2
s_cmp_eq_u32 s23, 3
s_cbranch_scc1 main_kernel_w_c1_set3
s_cmp_eq_u32 s23, 6
s_cbranch_scc1 main_kernel_w_c1_set6
s_branch main_kernel_end2
main_kernel_w_c1_set0:
s_mov_b32 s57, 6
s_lshl_b32 s32, s25, 8
s_add_u32 s8, s40, s32
s_addc_u32 s9, s41, 0
s_and_b32 s9, s9, 0xffff
s_sub_u32 s10, 0x800000, s32
s_mov_b32 s11, 0x20000
s_mov_b32 s30, 8192
s_mov_b32 s31, 32768
s_mul_i32 s16, s24, 262144
s_add_u32 s16, s16, 0x0
s_mov_b32 s18, 7
s_lshl_b32 s32, s24, 3
s_mul_i32 s33, s38, 4
s_add_u32 s32, s32, s33
s_mul_i32 s32, s32, 131072
s_lshl_b32 s33, s25, 12
s_add_u32 s32, s32, s33
s_mul_i32 s33, s37, 4096
s_add_u32 s32, s32, s33
s_add_u32 s21, s32, 0x800000
s_mov_b32 s22, 131072
s_mov_b32 s26, 0x7f000000
s_branch main_kernel_w_c1_go
main_kernel_w_c1_set1:
s_mov_b32 s57, 7
s_lshl_b32 s32, s25, 8
s_add_u32 s8, s42, s32
s_addc_u32 s9, s43, 0
s_and_b32 s9, s9, 0xffff
s_sub_u32 s10, 0x800000, s32
s_mov_b32 s11, 0x20000
s_mov_b32 s30, 8192
s_mov_b32 s31, 32768
s_mul_i32 s16, s24, 262144
s_add_u32 s16, s16, 0x0
s_mov_b32 s18, 7
s_lshl_b32 s32, s24, 3
s_mul_i32 s33, s38, 4
s_add_u32 s32, s32, s33
s_mul_i32 s32, s32, 131072
s_lshl_b32 s33, s25, 12
s_add_u32 s32, s32, s33
s_mul_i32 s33, s37, 4096
s_add_u32 s32, s32, s33
s_add_u32 s21, s32, 0x1800000
s_mov_b32 s22, 131072
s_mov_b32 s26, 0x7f000000
s_branch main_kernel_w_c1_go
main_kernel_w_c1_set2:
s_mov_b32 s57, 8
s_lshl_b32 s32, s25, 8
s_add_u32 s8, s44, s32
s_addc_u32 s9, s45, 0
s_and_b32 s9, s9, 0xffff
s_sub_u32 s10, 0x800000, s32
s_mov_b32 s11, 0x20000
s_mov_b32 s30, 8192
s_mov_b32 s31, 32768
s_mul_i32 s16, s24, 262144
s_add_u32 s16, s16, 0x0
s_mov_b32 s18, 7
s_lshl_b32 s32, s24, 2
s_mul_i32 s33, s38, 2
s_add_u32 s32, s32, s33
s_lshl_b32 s32, s32, 18
s_lshl_b32 s33, s25, 13
s_add_u32 s32, s32, s33
s_mul_i32 s33, s37, 8192
s_add_u32 s32, s32, s33
s_add_u32 s21, s32, 0x2800000
s_branch main_kernel_w_c1_gov
main_kernel_w_c1_set3:
s_mov_b32 s57, 9
s_lshl_b32 s32, s25, 8
s_add_u32 s8, s64, s32
s_addc_u32 s9, s65, 0
s_and_b32 s9, s9, 0xffff
s_sub_u32 s10, 0x200000, s32
s_mov_b32 s11, 0x20000
s_mov_b32 s30, 2048
s_mov_b32 s31, 32768
s_mul_i32 s16, s24, 262144
s_add_u32 s16, s16, 0x400000
s_mov_b32 s18, 7
s_lshl_b32 s32, s24, 3
s_mul_i32 s33, s38, 4
s_add_u32 s32, s32, s33
s_mul_i32 s32, s32, 32768
s_lshl_b32 s33, s25, 12
s_add_u32 s32, s32, s33
s_mul_i32 s33, s37, 4096
s_add_u32 s32, s32, s33
s_add_u32 s21, s32, 0x4800000
s_mov_b32 s22, 32768
s_mov_b32 s26, 0x7f000000
s_lshr_b32 s32, s25, 2
s_add_u32 s32, s32, 1
s_sub_u32 s33, 0, s32
s_bitcmp1_b32 s25, 1
s_cselect_b32 s32, s33, s32
s_add_u32 s32, s32, 16
v_and_b32 v253, 15, v250
v_add_u32 v253, s32, v253
v_lshrrev_b32 v254, 4, v253
v_lshlrev_b32 v254, 15, v254
v_and_b32 v253, 15, v253
v_lshl_add_u32 v254, v253, 4, v254
v_and_b32 v253, 0x300, v251
v_add_u32 v252, v253, v254
s_branch main_kernel_w_c1_go
main_kernel_w_c1_set6:
s_mov_b32 s57, 10
s_lshl_b32 s32, s25, 8
s_add_u32 s8, s68, s32
s_addc_u32 s9, s69, 0
s_and_b32 s9, s9, 0xffff
s_sub_u32 s10, 0x700000, s32
s_mov_b32 s11, 0x20000
s_mov_b32 s30, 7168
s_mov_b32 s31, 32768
s_mul_i32 s16, s24, 262144
s_add_u32 s16, s16, 0x6800000
s_mov_b32 s18, 7
s_lshl_b32 s32, s24, 3
s_mul_i32 s33, s38, 4
s_add_u32 s32, s32, s33
s_mul_i32 s32, s32, 114688
s_lshl_b32 s33, s25, 12
s_add_u32 s32, s32, s33
s_mul_i32 s33, s37, 4096
s_add_u32 s32, s32, s33
s_add_u32 s21, s32, 0x5400000
s_mov_b32 s22, 114688
s_mov_b32 s26, 0x7f000000
s_branch main_kernel_w_c1_go
main_kernel_w_c1_str:
s_mul_i32 s32, s14, 2
s_mul_i32 s32, s32, s31
v_mad_u32_u24 v137, v147, s30, v151
v_mad_u32_u24 v138, v148, s30, v152
v_mad_u32_u24 v139, v149, s30, v153
v_mad_u32_u24 v140, v150, s30, v154
v_add_u32 v141, s32, v251
s_add_u32 s32, s32, s31
s_sub_u32 s32, s32, 1024
v_add_u32 v142, s32, v251
s_mul_i32 s17, s30, 32
s_mov_b32 s15, 0
s_mov_b32 s18, 1
s_cmp_eq_u32 s73, 2
s_cbranch_scc1 main_kernel_w_c1_n_mid
s_branch main_kernel_w_c1_v_mid
main_kernel_w_c1_go:
s_mov_b32 s58, 2
s_mov_b32 s72, s18
s_cmp_lg_u32 s73, -1
s_cbranch_scc1 main_kernel_w_c1_str
s_waitcnt lgkmcnt(0)
v_lshrrev_b32 v0, 4, v250
v_bfe_u32 v1, v250, 2, 2
v_lshl_add_u32 v4, v0, 2, v1
v_and_b32 v5, 7, v4
v_mul_u32_u24 v4, 512, v4
v_and_b32 v6, 3, v250
v_lshl_add_u32 v4, v6, 3, v4
s_mul_i32 s32, s37, 8
v_xor_b32 v5, s32, v5
v_lshl_add_u32 v128, v5, 5, v4
v_xor_b32 v129, 32, v128
v_xor_b32 v130, 64, v128
v_xor_b32 v131, 96, v128
v_xor_b32 v132, 128, v128
v_xor_b32 v133, 160, v128
v_xor_b32 v134, 192, v128
v_xor_b32 v135, 224, v128
s_mul_i32 s32, s38, 4096
s_add_u32 s32, s32, 65536
v_add_u32 v136, s32, v251
v_lshrrev_b32 v2, 5, v250
v_and_b32 v3, 31, v250
s_mul_i32 s32, s14, 8
v_add_u32 v147, s32, v2
v_and_b32 v6, 7, v147
v_lshlrev_b32 v6, 1, v6
v_xor_b32 v6, v6, v3
v_lshlrev_b32 v151, 4, v6
v_add_u32 v148, 2, v147
v_and_b32 v6, 7, v148
v_lshlrev_b32 v6, 1, v6
v_xor_b32 v6, v6, v3
v_lshlrev_b32 v152, 4, v6
v_subrev_u32 v152, 1024, v152
v_add_u32 v149, 4, v147
v_and_b32 v6, 7, v149
v_lshlrev_b32 v6, 1, v6
v_xor_b32 v6, v6, v3
v_lshlrev_b32 v153, 4, v6
v_subrev_u32 v153, 2048, v153
v_add_u32 v150, 6, v147
v_and_b32 v6, 7, v150
v_lshlrev_b32 v6, 1, v6
v_xor_b32 v6, v6, v3
v_lshlrev_b32 v154, 4, v6
v_subrev_u32 v154, 3072, v154
s_mul_i32 s19, s14, 4096
s_mul_i32 s20, s14, 2048
s_add_u32 s20, s20, 65536
s_mul_i32 s32, s14, 2
s_mul_i32 s32, s32, s31
v_mad_u32_u24 v137, v147, s30, v151
v_mad_u32_u24 v138, v148, s30, v152
v_mad_u32_u24 v139, v149, s30, v153
v_mad_u32_u24 v140, v150, s30, v154
v_add_u32 v141, s32, v251
s_add_u32 s32, s32, s31
s_sub_u32 s32, s32, 1024
v_add_u32 v142, s32, v251
s_mul_i32 s17, s30, 32
s_mov_b32 s15, 0
s_waitcnt vmcnt(0)
s_add_u32 m0, s20, 0
s_nop 0
buffer_load_dwordx4 v141, s[4:7], s16 offen offset:0 sc1 lds
buffer_load_dwordx4 v142, s[4:7], s16 offen offset:1024 sc1 lds
s_add_u32 s16, s16, 1024
s_add_u32 m0, s19, 0
s_nop 0
buffer_load_dwordx4 v137, s[8:11], s15 offen offset:0 lds
buffer_load_dwordx4 v138, s[8:11], s15 offen offset:1024 lds
buffer_load_dwordx4 v139, s[8:11], s15 offen offset:2048 lds
buffer_load_dwordx4 v140, s[8:11], s15 offen offset:3072 lds
s_add_u32 s15, s15, s17
s_add_u32 m0, s20, 8192
s_nop 0
buffer_load_dwordx4 v141, s[4:7], s16 offen offset:0 sc1 lds
buffer_load_dwordx4 v142, s[4:7], s16 offen offset:1024 sc1 lds
s_add_u32 s16, s16, 1024
s_add_u32 m0, s19, 16384
s_nop 0
buffer_load_dwordx4 v137, s[8:11], s15 offen offset:0 lds
buffer_load_dwordx4 v138, s[8:11], s15 offen offset:1024 lds
buffer_load_dwordx4 v139, s[8:11], s15 offen offset:2048 lds
buffer_load_dwordx4 v140, s[8:11], s15 offen offset:3072 lds
s_add_u32 s15, s15, s17
s_add_u32 m0, s20, 16384
s_nop 0
buffer_load_dwordx4 v141, s[4:7], s16 offen offset:0 sc1 lds
buffer_load_dwordx4 v142, s[4:7], s16 offen offset:1024 sc1 lds
s_add_u32 s16, s16, 1024
s_add_u32 m0, s19, 32768
s_nop 0
buffer_load_dwordx4 v137, s[8:11], s15 offen offset:0 lds
buffer_load_dwordx4 v138, s[8:11], s15 offen offset:1024 lds
buffer_load_dwordx4 v139, s[8:11], s15 offen offset:2048 lds
buffer_load_dwordx4 v140, s[8:11], s15 offen offset:3072 lds
s_add_u32 s15, s15, s17
s_add_u32 m0, s20, 24576
s_nop 0
buffer_load_dwordx4 v141, s[4:7], s16 offen offset:0 sc1 lds
buffer_load_dwordx4 v142, s[4:7], s16 offen offset:1024 sc1 lds
s_add_u32 s16, s16, 1024
s_add_u32 m0, s19, 49152
s_nop 0
buffer_load_dwordx4 v137, s[8:11], s15 offen offset:0 lds
buffer_load_dwordx4 v138, s[8:11], s15 offen offset:1024 lds
buffer_load_dwordx4 v139, s[8:11], s15 offen offset:2048 lds
buffer_load_dwordx4 v140, s[8:11], s15 offen offset:3072 lds
s_add_u32 s15, s15, s17
s_cmp_lg_u32 s56, 0
s_cbranch_scc1 main_kernel_w_epi
main_kernel_w_c1_n_ent:
v_mfma_f32_32x32x16_bf16 a[0:15], v[224:227], v[224:227], 0
s_waitcnt vmcnt(18)
s_barrier
ds_read_b128 v[32:35], v136 offset:0
ds_read_b64_tr_b16 v[0:1], v128 offset:0
ds_read_b64_tr_b16 v[2:3], v128 offset:8192
v_mfma_f32_32x32x16_bf16 a[16:31], v[224:227], v[224:227], 0
ds_read_b64_tr_b16 v[4:5], v129 offset:0
ds_read_b64_tr_b16 v[6:7], v129 offset:8192
ds_read_b64_tr_b16 v[8:9], v130 offset:0
v_mfma_f32_32x32x16_bf16 a[32:47], v[224:227], v[224:227], 0
ds_read_b64_tr_b16 v[10:11], v130 offset:8192
ds_read_b64_tr_b16 v[12:13], v131 offset:0
ds_read_b64_tr_b16 v[14:15], v131 offset:8192
v_mfma_f32_32x32x16_bf16 a[48:63], v[224:227], v[224:227], 0
ds_read_b64_tr_b16 v[16:17], v132 offset:0
ds_read_b64_tr_b16 v[18:19], v132 offset:8192
ds_read_b64_tr_b16 v[20:21], v133 offset:0
v_mfma_f32_32x32x16_bf16 a[64:79], v[224:227], v[224:227], 0
ds_read_b64_tr_b16 v[22:23], v133 offset:8192
ds_read_b64_tr_b16 v[24:25], v134 offset:0
ds_read_b64_tr_b16 v[26:27], v134 offset:8192
v_mfma_f32_32x32x16_bf16 a[80:95], v[224:227], v[224:227], 0
ds_read_b64_tr_b16 v[28:29], v135 offset:0
ds_read_b64_tr_b16 v[30:31], v135 offset:8192
ds_read_b128 v[36:39], v136 offset:1024
v_mfma_f32_32x32x16_bf16 a[96:111], v[224:227], v[224:227], 0
ds_read_b128 v[40:43], v136 offset:2048
ds_read_b128 v[44:47], v136 offset:3072
v_mfma_f32_32x32x16_bf16 a[112:127], v[224:227], v[224:227], 0
s_sub_u32 s18, s72, 1
s_sub_u32 s55, s72, 2
s_orn2_b32 s55, s55, s100
s_mov_b32 s73, -1
s_nop 0
main_kernel_w_c1_n_loop:
main_kernel_w_c1_n_mid:
s_waitcnt lgkmcnt(0)
v_mfma_f32_16x16x32_bf16 a[0:3], v[0:3], v[32:35], a[0:3]
s_waitcnt vmcnt(12)
s_barrier
ds_read_b128 v[80:83], v136 offset:8192
s_add_u32 m0, s20, 0
s_nop 0
v_mfma_f32_16x16x32_bf16 a[4:7], v[4:7], v[32:35], a[4:7]
ds_read_b64_tr_b16 v[48:49], v128 offset:16384
v_mfma_f32_16x16x32_bf16 a[8:11], v[8:11], v[32:35], a[8:11]
ds_read_b64_tr_b16 v[50:51], v128 offset:24576
v_mfma_f32_16x16x32_bf16 a[12:15], v[12:15], v[32:35], a[12:15]
ds_read_b64_tr_b16 v[52:53], v129 offset:16384
buffer_load_dwordx4 v141, s[4:7], s16 offen offset:0 sc1 lds
v_mfma_f32_16x16x32_bf16 a[16:19], v[16:19], v[32:35], a[16:19]
ds_read_b64_tr_b16 v[54:55], v129 offset:24576
v_mfma_f32_16x16x32_bf16 a[20:23], v[20:23], v[32:35], a[20:23]
ds_read_b64_tr_b16 v[56:57], v130 offset:16384
v_mfma_f32_16x16x32_bf16 a[24:27], v[24:27], v[32:35], a[24:27]
ds_read_b64_tr_b16 v[58:59], v130 offset:24576
buffer_load_dwordx4 v142, s[4:7], s16 offen offset:1024 sc1 lds
v_mfma_f32_16x16x32_bf16 a[28:31], v[28:31], v[32:35], a[28:31]
ds_read_b64_tr_b16 v[60:61], v131 offset:16384
v_mfma_f32_16x16x32_bf16 a[32:35], v[0:3], v[36:39], a[32:35]
ds_read_b64_tr_b16 v[62:63], v131 offset:24576
v_mfma_f32_16x16x32_bf16 a[36:39], v[4:7], v[36:39], a[36:39]
ds_read_b64_tr_b16 v[64:65], v132 offset:16384
s_add_u32 s16, s16, 1024
v_mfma_f32_16x16x32_bf16 a[40:43], v[8:11], v[36:39], a[40:43]
ds_read_b64_tr_b16 v[66:67], v132 offset:24576
v_mfma_f32_16x16x32_bf16 a[44:47], v[12:15], v[36:39], a[44:47]
ds_read_b64_tr_b16 v[68:69], v133 offset:16384
v_mfma_f32_16x16x32_bf16 a[48:51], v[16:19], v[36:39], a[48:51]
ds_read_b64_tr_b16 v[70:71], v133 offset:24576
s_add_u32 m0, s19, 0
s_nop 0
v_mfma_f32_16x16x32_bf16 a[52:55], v[20:23], v[36:39], a[52:55]
ds_read_b64_tr_b16 v[72:73], v134 offset:16384
v_mfma_f32_16x16x32_bf16 a[56:59], v[24:27], v[36:39], a[56:59]
ds_read_b64_tr_b16 v[74:75], v134 offset:24576
v_mfma_f32_16x16x32_bf16 a[60:63], v[28:31], v[36:39], a[60:63]
ds_read_b64_tr_b16 v[76:77], v135 offset:16384
buffer_load_dwordx4 v137, s[8:11], s15 offen offset:0 lds
v_mfma_f32_16x16x32_bf16 a[64:67], v[0:3], v[40:43], a[64:67]
ds_read_b64_tr_b16 v[78:79], v135 offset:24576
v_mfma_f32_16x16x32_bf16 a[68:71], v[4:7], v[40:43], a[68:71]
ds_read_b128 v[84:87], v136 offset:9216
v_mfma_f32_16x16x32_bf16 a[72:75], v[8:11], v[40:43], a[72:75]
ds_read_b128 v[88:91], v136 offset:10240
buffer_load_dwordx4 v138, s[8:11], s15 offen offset:1024 lds
v_mfma_f32_16x16x32_bf16 a[76:79], v[12:15], v[40:43], a[76:79]
ds_read_b128 v[92:95], v136 offset:11264
v_mfma_f32_16x16x32_bf16 a[80:83], v[16:19], v[40:43], a[80:83]
v_mfma_f32_16x16x32_bf16 a[84:87], v[20:23], v[40:43], a[84:87]
buffer_load_dwordx4 v139, s[8:11], s15 offen offset:2048 lds
v_mfma_f32_16x16x32_bf16 a[88:91], v[24:27], v[40:43], a[88:91]
v_mfma_f32_16x16x32_bf16 a[92:95], v[28:31], v[40:43], a[92:95]
v_mfma_f32_16x16x32_bf16 a[96:99], v[0:3], v[44:47], a[96:99]
buffer_load_dwordx4 v140, s[8:11], s15 offen offset:3072 lds
v_mfma_f32_16x16x32_bf16 a[100:103], v[4:7], v[44:47], a[100:103]
v_mfma_f32_16x16x32_bf16 a[104:107], v[8:11], v[44:47], a[104:107]
v_mfma_f32_16x16x32_bf16 a[108:111], v[12:15], v[44:47], a[108:111]
s_add_u32 s15, s15, s17
v_mfma_f32_16x16x32_bf16 a[112:115], v[16:19], v[44:47], a[112:115]
v_mfma_f32_16x16x32_bf16 a[116:119], v[20:23], v[44:47], a[116:119]
v_mfma_f32_16x16x32_bf16 a[120:123], v[24:27], v[44:47], a[120:123]
v_mfma_f32_16x16x32_bf16 a[124:127], v[28:31], v[44:47], a[124:127]
s_waitcnt lgkmcnt(0)
v_mfma_f32_16x16x32_bf16 a[0:3], v[48:51], v[80:83], a[0:3]
s_waitcnt vmcnt(12)
s_barrier
ds_read_b128 v[32:35], v136 offset:16384
s_add_u32 m0, s20, 8192
s_nop 0
v_mfma_f32_16x16x32_bf16 a[4:7], v[52:55], v[80:83], a[4:7]
ds_read_b64_tr_b16 v[0:1], v128 offset:32768
v_mfma_f32_16x16x32_bf16 a[8:11], v[56:59], v[80:83], a[8:11]
ds_read_b64_tr_b16 v[2:3], v128 offset:40960
v_mfma_f32_16x16x32_bf16 a[12:15], v[60:63], v[80:83], a[12:15]
ds_read_b64_tr_b16 v[4:5], v129 offset:32768
buffer_load_dwordx4 v141, s[4:7], s16 offen offset:0 sc1 lds
v_mfma_f32_16x16x32_bf16 a[16:19], v[64:67], v[80:83], a[16:19]
ds_read_b64_tr_b16 v[6:7], v129 offset:40960
v_mfma_f32_16x16x32_bf16 a[20:23], v[68:71], v[80:83], a[20:23]
ds_read_b64_tr_b16 v[8:9], v130 offset:32768
v_mfma_f32_16x16x32_bf16 a[24:27], v[72:75], v[80:83], a[24:27]
ds_read_b64_tr_b16 v[10:11], v130 offset:40960
buffer_load_dwordx4 v142, s[4:7], s16 offen offset:1024 sc1 lds
v_mfma_f32_16x16x32_bf16 a[28:31], v[76:79], v[80:83], a[28:31]
ds_read_b64_tr_b16 v[12:13], v131 offset:32768
v_mfma_f32_16x16x32_bf16 a[32:35], v[48:51], v[84:87], a[32:35]
ds_read_b64_tr_b16 v[14:15], v131 offset:40960
v_mfma_f32_16x16x32_bf16 a[36:39], v[52:55], v[84:87], a[36:39]
ds_read_b64_tr_b16 v[16:17], v132 offset:32768
s_add_u32 s16, s16, 1024
v_mfma_f32_16x16x32_bf16 a[40:43], v[56:59], v[84:87], a[40:43]
ds_read_b64_tr_b16 v[18:19], v132 offset:40960
v_mfma_f32_16x16x32_bf16 a[44:47], v[60:63], v[84:87], a[44:47]
ds_read_b64_tr_b16 v[20:21], v133 offset:32768
v_mfma_f32_16x16x32_bf16 a[48:51], v[64:67], v[84:87], a[48:51]
ds_read_b64_tr_b16 v[22:23], v133 offset:40960
s_add_u32 m0, s19, 16384
s_nop 0
v_mfma_f32_16x16x32_bf16 a[52:55], v[68:71], v[84:87], a[52:55]
ds_read_b64_tr_b16 v[24:25], v134 offset:32768
v_mfma_f32_16x16x32_bf16 a[56:59], v[72:75], v[84:87], a[56:59]
ds_read_b64_tr_b16 v[26:27], v134 offset:40960
v_mfma_f32_16x16x32_bf16 a[60:63], v[76:79], v[84:87], a[60:63]
ds_read_b64_tr_b16 v[28:29], v135 offset:32768
buffer_load_dwordx4 v137, s[8:11], s15 offen offset:0 lds
v_mfma_f32_16x16x32_bf16 a[64:67], v[48:51], v[88:91], a[64:67]
ds_read_b64_tr_b16 v[30:31], v135 offset:40960
v_mfma_f32_16x16x32_bf16 a[68:71], v[52:55], v[88:91], a[68:71]
ds_read_b128 v[36:39], v136 offset:17408
v_mfma_f32_16x16x32_bf16 a[72:75], v[56:59], v[88:91], a[72:75]
ds_read_b128 v[40:43], v136 offset:18432
buffer_load_dwordx4 v138, s[8:11], s15 offen offset:1024 lds
v_mfma_f32_16x16x32_bf16 a[76:79], v[60:63], v[88:91], a[76:79]
ds_read_b128 v[44:47], v136 offset:19456
v_mfma_f32_16x16x32_bf16 a[80:83], v[64:67], v[88:91], a[80:83]
v_mfma_f32_16x16x32_bf16 a[84:87], v[68:71], v[88:91], a[84:87]
buffer_load_dwordx4 v139, s[8:11], s15 offen offset:2048 lds
v_mfma_f32_16x16x32_bf16 a[88:91], v[72:75], v[88:91], a[88:91]
v_mfma_f32_16x16x32_bf16 a[92:95], v[76:79], v[88:91], a[92:95]
v_mfma_f32_16x16x32_bf16 a[96:99], v[48:51], v[92:95], a[96:99]
buffer_load_dwordx4 v140, s[8:11], s15 offen offset:3072 lds
v_mfma_f32_16x16x32_bf16 a[100:103], v[52:55], v[92:95], a[100:103]
v_mfma_f32_16x16x32_bf16 a[104:107], v[56:59], v[92:95], a[104:107]
v_mfma_f32_16x16x32_bf16 a[108:111], v[60:63], v[92:95], a[108:111]
s_add_u32 s15, s15, s17
v_mfma_f32_16x16x32_bf16 a[112:115], v[64:67], v[92:95], a[112:115]
v_mfma_f32_16x16x32_bf16 a[116:119], v[68:71], v[92:95], a[116:119]
v_mfma_f32_16x16x32_bf16 a[120:123], v[72:75], v[92:95], a[120:123]
v_mfma_f32_16x16x32_bf16 a[124:127], v[76:79], v[92:95], a[124:127]
s_waitcnt lgkmcnt(0)
v_mfma_f32_16x16x32_bf16 a[0:3], v[0:3], v[32:35], a[0:3]
s_waitcnt vmcnt(12)
s_barrier
ds_read_b128 v[80:83], v136 offset:24576
s_add_u32 m0, s20, 16384
s_nop 0
v_mfma_f32_16x16x32_bf16 a[4:7], v[4:7], v[32:35], a[4:7]
ds_read_b64_tr_b16 v[48:49], v128 offset:49152
v_mfma_f32_16x16x32_bf16 a[8:11], v[8:11], v[32:35], a[8:11]
ds_read_b64_tr_b16 v[50:51], v128 offset:57344
v_mfma_f32_16x16x32_bf16 a[12:15], v[12:15], v[32:35], a[12:15]
ds_read_b64_tr_b16 v[52:53], v129 offset:49152
buffer_load_dwordx4 v141, s[4:7], s16 offen offset:0 sc1 lds
v_mfma_f32_16x16x32_bf16 a[16:19], v[16:19], v[32:35], a[16:19]
ds_read_b64_tr_b16 v[54:55], v129 offset:57344
v_mfma_f32_16x16x32_bf16 a[20:23], v[20:23], v[32:35], a[20:23]
ds_read_b64_tr_b16 v[56:57], v130 offset:49152
v_mfma_f32_16x16x32_bf16 a[24:27], v[24:27], v[32:35], a[24:27]
ds_read_b64_tr_b16 v[58:59], v130 offset:57344
buffer_load_dwordx4 v142, s[4:7], s16 offen offset:1024 sc1 lds
v_mfma_f32_16x16x32_bf16 a[28:31], v[28:31], v[32:35], a[28:31]
ds_read_b64_tr_b16 v[60:61], v131 offset:49152
v_mfma_f32_16x16x32_bf16 a[32:35], v[0:3], v[36:39], a[32:35]
ds_read_b64_tr_b16 v[62:63], v131 offset:57344
v_mfma_f32_16x16x32_bf16 a[36:39], v[4:7], v[36:39], a[36:39]
ds_read_b64_tr_b16 v[64:65], v132 offset:49152
s_add_u32 s16, s16, 1024
v_mfma_f32_16x16x32_bf16 a[40:43], v[8:11], v[36:39], a[40:43]
ds_read_b64_tr_b16 v[66:67], v132 offset:57344
v_mfma_f32_16x16x32_bf16 a[44:47], v[12:15], v[36:39], a[44:47]
ds_read_b64_tr_b16 v[68:69], v133 offset:49152
v_mfma_f32_16x16x32_bf16 a[48:51], v[16:19], v[36:39], a[48:51]
ds_read_b64_tr_b16 v[70:71], v133 offset:57344
s_add_u32 m0, s19, 32768
s_nop 0
v_mfma_f32_16x16x32_bf16 a[52:55], v[20:23], v[36:39], a[52:55]
ds_read_b64_tr_b16 v[72:73], v134 offset:49152
v_mfma_f32_16x16x32_bf16 a[56:59], v[24:27], v[36:39], a[56:59]
ds_read_b64_tr_b16 v[74:75], v134 offset:57344
v_mfma_f32_16x16x32_bf16 a[60:63], v[28:31], v[36:39], a[60:63]
ds_read_b64_tr_b16 v[76:77], v135 offset:49152
buffer_load_dwordx4 v137, s[8:11], s15 offen offset:0 lds
v_mfma_f32_16x16x32_bf16 a[64:67], v[0:3], v[40:43], a[64:67]
ds_read_b64_tr_b16 v[78:79], v135 offset:57344
v_mfma_f32_16x16x32_bf16 a[68:71], v[4:7], v[40:43], a[68:71]
ds_read_b128 v[84:87], v136 offset:25600
v_mfma_f32_16x16x32_bf16 a[72:75], v[8:11], v[40:43], a[72:75]
ds_read_b128 v[88:91], v136 offset:26624
buffer_load_dwordx4 v138, s[8:11], s15 offen offset:1024 lds
v_mfma_f32_16x16x32_bf16 a[76:79], v[12:15], v[40:43], a[76:79]
ds_read_b128 v[92:95], v136 offset:27648
v_mfma_f32_16x16x32_bf16 a[80:83], v[16:19], v[40:43], a[80:83]
v_mfma_f32_16x16x32_bf16 a[84:87], v[20:23], v[40:43], a[84:87]
buffer_load_dwordx4 v139, s[8:11], s15 offen offset:2048 lds
v_mfma_f32_16x16x32_bf16 a[88:91], v[24:27], v[40:43], a[88:91]
v_mfma_f32_16x16x32_bf16 a[92:95], v[28:31], v[40:43], a[92:95]
v_mfma_f32_16x16x32_bf16 a[96:99], v[0:3], v[44:47], a[96:99]
buffer_load_dwordx4 v140, s[8:11], s15 offen offset:3072 lds
v_mfma_f32_16x16x32_bf16 a[100:103], v[4:7], v[44:47], a[100:103]
v_mfma_f32_16x16x32_bf16 a[104:107], v[8:11], v[44:47], a[104:107]
v_mfma_f32_16x16x32_bf16 a[108:111], v[12:15], v[44:47], a[108:111]
s_add_u32 s15, s15, s17
v_mfma_f32_16x16x32_bf16 a[112:115], v[16:19], v[44:47], a[112:115]
v_mfma_f32_16x16x32_bf16 a[116:119], v[20:23], v[44:47], a[116:119]
v_mfma_f32_16x16x32_bf16 a[120:123], v[24:27], v[44:47], a[120:123]
v_mfma_f32_16x16x32_bf16 a[124:127], v[28:31], v[44:47], a[124:127]
s_waitcnt lgkmcnt(0)
v_mfma_f32_16x16x32_bf16 a[0:3], v[48:51], v[80:83], a[0:3]
s_waitcnt vmcnt(12)
s_barrier
ds_read_b128 v[32:35], v136 offset:0
s_add_u32 m0, s20, 24576
s_nop 0
v_mfma_f32_16x16x32_bf16 a[4:7], v[52:55], v[80:83], a[4:7]
ds_read_b64_tr_b16 v[0:1], v128 offset:0
v_mfma_f32_16x16x32_bf16 a[8:11], v[56:59], v[80:83], a[8:11]
ds_read_b64_tr_b16 v[2:3], v128 offset:8192
v_mfma_f32_16x16x32_bf16 a[12:15], v[60:63], v[80:83], a[12:15]
ds_read_b64_tr_b16 v[4:5], v129 offset:0
buffer_load_dwordx4 v141, s[4:7], s16 offen offset:0 sc1 lds
v_mfma_f32_16x16x32_bf16 a[16:19], v[64:67], v[80:83], a[16:19]
ds_read_b64_tr_b16 v[6:7], v129 offset:8192
v_mfma_f32_16x16x32_bf16 a[20:23], v[68:71], v[80:83], a[20:23]
ds_read_b64_tr_b16 v[8:9], v130 offset:0
v_mfma_f32_16x16x32_bf16 a[24:27], v[72:75], v[80:83], a[24:27]
ds_read_b64_tr_b16 v[10:11], v130 offset:8192
buffer_load_dwordx4 v142, s[4:7], s16 offen offset:1024 sc1 lds
v_mfma_f32_16x16x32_bf16 a[28:31], v[76:79], v[80:83], a[28:31]
ds_read_b64_tr_b16 v[12:13], v131 offset:0
v_mfma_f32_16x16x32_bf16 a[32:35], v[48:51], v[84:87], a[32:35]
ds_read_b64_tr_b16 v[14:15], v131 offset:8192
v_mfma_f32_16x16x32_bf16 a[36:39], v[52:55], v[84:87], a[36:39]
ds_read_b64_tr_b16 v[16:17], v132 offset:0
s_add_u32 s16, s16, 1024
v_mfma_f32_16x16x32_bf16 a[40:43], v[56:59], v[84:87], a[40:43]
ds_read_b64_tr_b16 v[18:19], v132 offset:8192
v_mfma_f32_16x16x32_bf16 a[44:47], v[60:63], v[84:87], a[44:47]
ds_read_b64_tr_b16 v[20:21], v133 offset:0
v_mfma_f32_16x16x32_bf16 a[48:51], v[64:67], v[84:87], a[48:51]
ds_read_b64_tr_b16 v[22:23], v133 offset:8192
s_add_u32 m0, s19, 49152
s_nop 0
v_mfma_f32_16x16x32_bf16 a[52:55], v[68:71], v[84:87], a[52:55]
ds_read_b64_tr_b16 v[24:25], v134 offset:0
v_mfma_f32_16x16x32_bf16 a[56:59], v[72:75], v[84:87], a[56:59]
ds_read_b64_tr_b16 v[26:27], v134 offset:8192
v_mfma_f32_16x16x32_bf16 a[60:63], v[76:79], v[84:87], a[60:63]
ds_read_b64_tr_b16 v[28:29], v135 offset:0
buffer_load_dwordx4 v137, s[8:11], s15 offen offset:0 lds
v_mfma_f32_16x16x32_bf16 a[64:67], v[48:51], v[88:91], a[64:67]
ds_read_b64_tr_b16 v[30:31], v135 offset:8192
v_mfma_f32_16x16x32_bf16 a[68:71], v[52:55], v[88:91], a[68:71]
ds_read_b128 v[36:39], v136 offset:1024
v_mfma_f32_16x16x32_bf16 a[72:75], v[56:59], v[88:91], a[72:75]
ds_read_b128 v[40:43], v136 offset:2048
buffer_load_dwordx4 v138, s[8:11], s15 offen offset:1024 lds
v_mfma_f32_16x16x32_bf16 a[76:79], v[60:63], v[88:91], a[76:79]
ds_read_b128 v[44:47], v136 offset:3072
v_mfma_f32_16x16x32_bf16 a[80:83], v[64:67], v[88:91], a[80:83]
v_mfma_f32_16x16x32_bf16 a[84:87], v[68:71], v[88:91], a[84:87]
buffer_load_dwordx4 v139, s[8:11], s15 offen offset:2048 lds
v_mfma_f32_16x16x32_bf16 a[88:91], v[72:75], v[88:91], a[88:91]
v_mfma_f32_16x16x32_bf16 a[92:95], v[76:79], v[88:91], a[92:95]
v_mfma_f32_16x16x32_bf16 a[96:99], v[48:51], v[92:95], a[96:99]
buffer_load_dwordx4 v140, s[8:11], s15 offen offset:3072 lds
v_mfma_f32_16x16x32_bf16 a[100:103], v[52:55], v[92:95], a[100:103]
v_mfma_f32_16x16x32_bf16 a[104:107], v[56:59], v[92:95], a[104:107]
v_mfma_f32_16x16x32_bf16 a[108:111], v[60:63], v[92:95], a[108:111]
s_add_u32 s15, s15, s17
v_mfma_f32_16x16x32_bf16 a[112:115], v[64:67], v[92:95], a[112:115]
v_mfma_f32_16x16x32_bf16 a[116:119], v[68:71], v[92:95], a[116:119]
v_mfma_f32_16x16x32_bf16 a[120:123], v[72:75], v[92:95], a[120:123]
v_mfma_f32_16x16x32_bf16 a[124:127], v[76:79], v[92:95], a[124:127]
s_sub_u32 s18, s18, 1
s_cmp_eq_u32 s18, s55
s_cbranch_scc1 main_kernel_w_c1_n_ev
s_cmp_lg_u32 s18, 0
s_cbranch_scc1 main_kernel_w_c1_n_loop
s_cmp_lg_u32 s73, -1
s_cbranch_scc1 main_kernel_w_epn
s_waitcnt lgkmcnt(0)
v_mfma_f32_16x16x32_bf16 a[0:3], v[0:3], v[32:35], a[0:3]
s_waitcnt vmcnt(12)
s_barrier
ds_read_b128 v[80:83], v136 offset:8192
s_add_u32 m0, s20, 0
s_nop 0
s_add_u32 s32, s23, 1
s_bitcmp0_b32 s32, 2
s_cselect_b32 s34, 7, 2
s_cselect_b32 s35, 2, 4
s_lshl_b32 s59, s23, 13
s_add_u32 s59, s59, 0x8404000
v_mfma_f32_16x16x32_bf16 a[4:7], v[4:7], v[32:35], a[4:7]
ds_read_b64_tr_b16 v[48:49], v128 offset:16384
v_lshrrev_b32 v253, 3, v250
v_add_lshl_u32 v253, s24, v253, 9
v_mfma_f32_16x16x32_bf16 a[8:11], v[8:11], v[32:35], a[8:11]
ds_read_b64_tr_b16 v[50:51], v128 offset:24576
v_and_b32 v254, 3, v250
v_lshl_add_u32 v253, v254, s34, v253
v_mfma_f32_16x16x32_bf16 a[12:15], v[12:15], v[32:35], a[12:15]
ds_read_b64_tr_b16 v[52:53], v129 offset:16384
buffer_load_dwordx4 v141, s[4:7], s16 offen offset:0 sc1 lds
v_bfe_u32 v254, v250, 2, 1
v_add_u32 v254, s25, v254
v_mfma_f32_16x16x32_bf16 a[16:19], v[16:19], v[32:35], a[16:19]
ds_read_b64_tr_b16 v[54:55], v129 offset:24576
v_lshl_add_u32 v248, v254, s35, v253
s_lshl_b32 s0, 4, s54
v_mfma_f32_16x16x32_bf16 a[20:23], v[20:23], v[32:35], a[20:23]
ds_read_b64_tr_b16 v[56:57], v130 offset:16384
v_readfirstlane_b32 s28, v249
s_nop 1
v_cmp_ge_u32 vcc, s28, v229
v_mfma_f32_16x16x32_bf16 a[24:27], v[24:27], v[32:35], a[24:27]
ds_read_b64_tr_b16 v[58:59], v130 offset:24576
buffer_load_dwordx4 v142, s[4:7], s16 offen offset:1024 sc1 lds
s_nop 1
s_bcnt1_i32_b64 s32, vcc
v_mfma_f32_16x16x32_bf16 a[28:31], v[28:31], v[32:35], a[28:31]
ds_read_b64_tr_b16 v[60:61], v131 offset:16384
s_sub_u32 s32, s32, 1
v_readlane_b32 s36, v230, s32
v_mfma_f32_16x16x32_bf16 a[32:35], v[0:3], v[36:39], a[32:35]
ds_read_b64_tr_b16 v[62:63], v131 offset:24576
s_nop 1
s_and_b32 s32, s36, 0x7ff
v_mfma_f32_16x16x32_bf16 a[36:39], v[4:7], v[36:39], a[36:39]
ds_read_b64_tr_b16 v[64:65], v132 offset:16384
s_add_u32 s16, s16, 1024
s_sub_u32 s28, s28, s32
s_bfe_u32 s32, s36, 0x3001a
v_mfma_f32_16x16x32_bf16 a[40:43], v[8:11], v[36:39], a[40:43]
ds_read_b64_tr_b16 v[66:67], v132 offset:24576
s_lshr_b32 s25, s28, s32
s_lshl_b32 s33, s25, s32
s_sub_u32 s24, s28, s33
v_mfma_f32_16x16x32_bf16 a[44:47], v[12:15], v[36:39], a[44:47]
ds_read_b64_tr_b16 v[68:69], v133 offset:16384
s_bfe_u32 s34, s36, 0x1001d
s_lshl_b32 s24, s24, s34
v_mfma_f32_16x16x32_bf16 a[48:51], v[16:19], v[36:39], a[48:51]
ds_read_b64_tr_b16 v[70:71], v133 offset:24576
s_add_u32 m0, s19, 0
s_nop 0
s_bfe_u32 s35, s36, 0x1001e
s_lshl_b32 s25, s25, s35
v_mfma_f32_16x16x32_bf16 a[52:55], v[20:23], v[36:39], a[52:55]
ds_read_b64_tr_b16 v[72:73], v134 offset:16384
s_bfe_u32 s32, s36, 0x40011
s_add_u32 s24, s24, s32
v_mfma_f32_16x16x32_bf16 a[56:59], v[24:27], v[36:39], a[56:59]
ds_read_b64_tr_b16 v[74:75], v134 offset:24576
s_bfe_u32 s32, s36, 0x50015
s_add_u32 s25, s25, s32
v_mfma_f32_16x16x32_bf16 a[60:63], v[28:31], v[36:39], a[60:63]
ds_read_b64_tr_b16 v[76:77], v135 offset:16384
buffer_load_dwordx4 v137, s[8:11], s15 offen offset:0 lds
s_bfe_u32 s23, s36, 0x4000b
s_bfe_u32 s36, s36, 0x6000b
s_lshl_b32 s32, s24, 8
v_mfma_f32_16x16x32_bf16 a[64:67], v[0:3], v[40:43], a[64:67]
ds_read_b64_tr_b16 v[78:79], v135 offset:24576
s_or_b32 s36, s36, s32
s_lshl_b32 s32, s25, 16
v_mfma_f32_16x16x32_bf16 a[68:71], v[4:7], v[40:43], a[68:71]
ds_read_b128 v[84:87], v136 offset:9216
s_or_b32 s36, s36, s32
s_cmp_eq_u32 s23, 4
s_cselect_b32 s32, 1, 0
v_mfma_f32_16x16x32_bf16 a[72:75], v[8:11], v[40:43], a[72:75]
ds_read_b128 v[88:91], v136 offset:10240
buffer_load_dwordx4 v138, s[8:11], s15 offen offset:1024 lds
s_sub_u32 s48, s24, s32
s_max_i32 s48, s48, 0
v_mfma_f32_16x16x32_bf16 a[76:79], v[12:15], v[40:43], a[76:79]
ds_read_b128 v[92:95], v136 offset:11264
s_add_u32 s49, s24, s34
s_add_u32 s49, s49, s32
v_mfma_f32_16x16x32_bf16 a[80:83], v[16:19], v[40:43], a[80:83]
s_min_u32 s49, s49, 15
s_cmp_eq_u32 s23, 6
s_cselect_b32 s51, 3, 7
s_cmp_eq_u32 s23, 7
s_cselect_b32 s51, 27, s51
s_cselect_b32 s50, 5, 4
v_mfma_f32_16x16x32_bf16 a[84:87], v[20:23], v[40:43], a[84:87]
buffer_load_dwordx4 v139, s[8:11], s15 offen offset:2048 lds
s_add_u32 s33, s25, s35
s_lshl_b32 s34, s24, 9
v_mfma_f32_16x16x32_bf16 a[88:91], v[24:27], v[40:43], a[88:91]
s_cmp_eq_u32 s23, 8
s_cselect_b32 s51, 0, s51
s_cselect_b32 s48, s25, s48
s_cselect_b32 s49, s33, s49
s_cmp_eq_u32 s23, 8
s_cselect_b32 s63, 2, 9
s_cselect_b32 s61, 0, 0x7f000000
s_cselect_b32 s34, s34, 0
v_mfma_f32_16x16x32_bf16 a[92:95], v[28:31], v[40:43], a[92:95]
v_lshrrev_b32 v228, s50, v250
v_lshlrev_b32 v254, s50, v228
v_mfma_f32_16x16x32_bf16 a[96:99], v[0:3], v[44:47], a[96:99]
buffer_load_dwordx4 v140, s[8:11], s15 offen offset:3072 lds
v_sub_u32 v254, v250, v254
s_cmp_lt_u32 s23, 4
s_cselect_b32 s39, 10, s23
v_mfma_f32_16x16x32_bf16 a[100:103], v[4:7], v[44:47], a[100:103]
v_min_u32 v254, s51, v254
s_lshl_b32 s39, s39, 13
s_cmp_eq_u32 s23, 3
s_cselect_b32 s34, 4, s34
v_mfma_f32_16x16x32_bf16 a[104:107], v[8:11], v[44:47], a[104:107]
v_add_u32 v228, s48, v228
s_add_u32 s39, s39, s34
v_mfma_f32_16x16x32_bf16 a[108:111], v[12:15], v[44:47], a[108:111]
s_add_u32 s15, s15, s17
s_add_u32 s39, s39, 0x8402000
v_min_u32 v228, s49, v228
v_mfma_f32_16x16x32_bf16 a[112:115], v[16:19], v[44:47], a[112:115]
s_lshl_b32 s60, s24, 10
s_add_u32 s60, s60, 0x8400000
v_mfma_f32_16x16x32_bf16 a[116:119], v[20:23], v[44:47], a[116:119]
v_lshlrev_b32 v228, s63, v228
v_lshl_add_u32 v228, v254, 4, v228
v_mfma_f32_16x16x32_bf16 a[120:123], v[24:27], v[44:47], a[120:123]
v_or_b32 v146, s61, v251
s_mov_b64 exec, s[100:101]
buffer_load_dword v231, v228, s[4:7], s39 offen sc1
buffer_load_dwordx4 v[232:235], v146, s[4:7], s60 offen sc1
s_mov_b64 exec, -1
v_mfma_f32_16x16x32_bf16 a[124:127], v[28:31], v[44:47], a[124:127]
s_waitcnt lgkmcnt(0)
v_mfma_f32_16x16x32_bf16 a[0:3], v[48:51], v[80:83], a[0:3]
s_waitcnt vmcnt(12)
s_barrier
ds_read_b128 v[32:35], v136 offset:16384
s_add_u32 m0, s20, 8192
s_nop 0
s_mov_b32 s1, s21
v_mfma_f32_16x16x32_bf16 a[4:7], v[52:55], v[80:83], a[4:7]
ds_read_b64_tr_b16 v[0:1], v128 offset:32768
v_mfma_f32_16x16x32_bf16 a[8:11], v[56:59], v[80:83], a[8:11]
ds_read_b64_tr_b16 v[2:3], v128 offset:40960
v_mfma_f32_16x16x32_bf16 a[12:15], v[60:63], v[80:83], a[12:15]
ds_read_b64_tr_b16 v[4:5], v129 offset:32768
buffer_load_dwordx4 v141, s[4:7], s16 offen offset:0 sc1 lds
v_mfma_f32_16x16x32_bf16 a[16:19], v[64:67], v[80:83], a[16:19]
ds_read_b64_tr_b16 v[6:7], v129 offset:40960
v_mfma_f32_16x16x32_bf16 a[20:23], v[68:71], v[80:83], a[20:23]
ds_read_b64_tr_b16 v[8:9], v130 offset:32768
s_mov_b32 s2, s22
v_mfma_f32_16x16x32_bf16 a[24:27], v[72:75], v[80:83], a[24:27]
ds_read_b64_tr_b16 v[10:11], v130 offset:40960
buffer_load_dwordx4 v142, s[4:7], s16 offen offset:1024 sc1 lds
v_mfma_f32_16x16x32_bf16 a[28:31], v[76:79], v[80:83], a[28:31]
ds_read_b64_tr_b16 v[12:13], v131 offset:32768
v_mfma_f32_16x16x32_bf16 a[32:35], v[48:51], v[84:87], a[32:35]
ds_read_b64_tr_b16 v[14:15], v131 offset:40960
v_mfma_f32_16x16x32_bf16 a[36:39], v[52:55], v[84:87], a[36:39]
ds_read_b64_tr_b16 v[16:17], v132 offset:32768
s_add_u32 s16, s16, 1024
v_mfma_f32_16x16x32_bf16 a[40:43], v[56:59], v[84:87], a[40:43]
ds_read_b64_tr_b16 v[18:19], v132 offset:40960
s_mov_b32 s3, s26
v_mfma_f32_16x16x32_bf16 a[44:47], v[60:63], v[84:87], a[44:47]
ds_read_b64_tr_b16 v[20:21], v133 offset:32768
v_mfma_f32_16x16x32_bf16 a[48:51], v[64:67], v[84:87], a[48:51]
ds_read_b64_tr_b16 v[22:23], v133 offset:40960
s_add_u32 m0, s19, 16384
s_nop 0
v_mfma_f32_16x16x32_bf16 a[52:55], v[68:71], v[84:87], a[52:55]
ds_read_b64_tr_b16 v[24:25], v134 offset:32768
v_mfma_f32_16x16x32_bf16 a[56:59], v[72:75], v[84:87], a[56:59]
ds_read_b64_tr_b16 v[26:27], v134 offset:40960
v_mfma_f32_16x16x32_bf16 a[60:63], v[76:79], v[84:87], a[60:63]
ds_read_b64_tr_b16 v[28:29], v135 offset:32768
buffer_load_dwordx4 v137, s[8:11], s15 offen offset:0 lds
s_mov_b32 s56, s57
v_mfma_f32_16x16x32_bf16 a[64:67], v[48:51], v[88:91], a[64:67]
ds_read_b64_tr_b16 v[30:31], v135 offset:40960
v_mfma_f32_16x16x32_bf16 a[68:71], v[52:55], v[88:91], a[68:71]
ds_read_b128 v[36:39], v136 offset:17408
v_mfma_f32_16x16x32_bf16 a[72:75], v[56:59], v[88:91], a[72:75]
ds_read_b128 v[40:43], v136 offset:18432
buffer_load_dwordx4 v138, s[8:11], s15 offen offset:1024 lds
v_mfma_f32_16x16x32_bf16 a[76:79], v[60:63], v[88:91], a[76:79]
ds_read_b128 v[44:47], v136 offset:19456
v_mfma_f32_16x16x32_bf16 a[80:83], v[64:67], v[88:91], a[80:83]
v_mov_b32 v145, v252
v_mfma_f32_16x16x32_bf16 a[84:87], v[68:71], v[88:91], a[84:87]
buffer_load_dwordx4 v139, s[8:11], s15 offen offset:2048 lds
v_mfma_f32_16x16x32_bf16 a[88:91], v[72:75], v[88:91], a[88:91]
v_mfma_f32_16x16x32_bf16 a[92:95], v[76:79], v[88:91], a[92:95]
v_mfma_f32_16x16x32_bf16 a[96:99], v[48:51], v[92:95], a[96:99]
buffer_load_dwordx4 v140, s[8:11], s15 offen offset:3072 lds
v_mfma_f32_16x16x32_bf16 a[100:103], v[52:55], v[92:95], a[100:103]
v_mov_b32 v255, 131072
v_mfma_f32_16x16x32_bf16 a[104:107], v[56:59], v[92:95], a[104:107]
v_mfma_f32_16x16x32_bf16 a[108:111], v[60:63], v[92:95], a[108:111]
s_add_u32 s15, s15, s17
v_mfma_f32_16x16x32_bf16 a[112:115], v[64:67], v[92:95], a[112:115]
v_mfma_f32_16x16x32_bf16 a[116:119], v[68:71], v[92:95], a[116:119]
v_mfma_f32_16x16x32_bf16 a[120:123], v[72:75], v[92:95], a[120:123]
v_mfma_f32_16x16x32_bf16 a[124:127], v[76:79], v[92:95], a[124:127]
s_waitcnt lgkmcnt(0)
v_mfma_f32_16x16x32_bf16 a[0:3], v[0:3], v[32:35], a[0:3]
s_waitcnt vmcnt(12)
s_barrier
ds_read_b128 v[80:83], v136 offset:24576
s_add_u32 m0, s20, 16384
s_nop 0
v_mfma_f32_16x16x32_bf16 a[4:7], v[4:7], v[32:35], a[4:7]
ds_read_b64_tr_b16 v[48:49], v128 offset:49152
v_mfma_f32_16x16x32_bf16 a[8:11], v[8:11], v[32:35], a[8:11]
ds_read_b64_tr_b16 v[50:51], v128 offset:57344
v_mfma_f32_16x16x32_bf16 a[12:15], v[12:15], v[32:35], a[12:15]
ds_read_b64_tr_b16 v[52:53], v129 offset:49152
buffer_load_dwordx4 v141, s[4:7], s16 offen offset:0 sc1 lds
v_mfma_f32_16x16x32_bf16 a[16:19], v[16:19], v[32:35], a[16:19]
ds_read_b64_tr_b16 v[54:55], v129 offset:57344
v_mfma_f32_16x16x32_bf16 a[20:23], v[20:23], v[32:35], a[20:23]
ds_read_b64_tr_b16 v[56:57], v130 offset:49152
v_mfma_f32_16x16x32_bf16 a[24:27], v[24:27], v[32:35], a[24:27]
ds_read_b64_tr_b16 v[58:59], v130 offset:57344
buffer_load_dwordx4 v142, s[4:7], s16 offen offset:1024 sc1 lds
v_mfma_f32_16x16x32_bf16 a[28:31], v[28:31], v[32:35], a[28:31]
ds_read_b64_tr_b16 v[60:61], v131 offset:49152
v_mfma_f32_16x16x32_bf16 a[32:35], v[0:3], v[36:39], a[32:35]
ds_read_b64_tr_b16 v[62:63], v131 offset:57344
v_mfma_f32_16x16x32_bf16 a[36:39], v[4:7], v[36:39], a[36:39]
ds_read_b64_tr_b16 v[64:65], v132 offset:49152
s_add_u32 s16, s16, 1024
v_mfma_f32_16x16x32_bf16 a[40:43], v[8:11], v[36:39], a[40:43]
ds_read_b64_tr_b16 v[66:67], v132 offset:57344
v_mfma_f32_16x16x32_bf16 a[44:47], v[12:15], v[36:39], a[44:47]
ds_read_b64_tr_b16 v[68:69], v133 offset:49152
v_mfma_f32_16x16x32_bf16 a[48:51], v[16:19], v[36:39], a[48:51]
ds_read_b64_tr_b16 v[70:71], v133 offset:57344
s_add_u32 m0, s19, 32768
s_nop 0
v_mfma_f32_16x16x32_bf16 a[52:55], v[20:23], v[36:39], a[52:55]
ds_read_b64_tr_b16 v[72:73], v134 offset:49152
v_mfma_f32_16x16x32_bf16 a[56:59], v[24:27], v[36:39], a[56:59]
ds_read_b64_tr_b16 v[74:75], v134 offset:57344
v_mfma_f32_16x16x32_bf16 a[60:63], v[28:31], v[36:39], a[60:63]
ds_read_b64_tr_b16 v[76:77], v135 offset:49152
buffer_load_dwordx4 v137, s[8:11], s15 offen offset:0 lds
v_mfma_f32_16x16x32_bf16 a[64:67], v[0:3], v[40:43], a[64:67]
ds_read_b64_tr_b16 v[78:79], v135 offset:57344
v_mfma_f32_16x16x32_bf16 a[68:71], v[4:7], v[40:43], a[68:71]
ds_read_b128 v[84:87], v136 offset:25600
v_mfma_f32_16x16x32_bf16 a[72:75], v[8:11], v[40:43], a[72:75]
ds_read_b128 v[88:91], v136 offset:26624
buffer_load_dwordx4 v138, s[8:11], s15 offen offset:1024 lds
v_mfma_f32_16x16x32_bf16 a[76:79], v[12:15], v[40:43], a[76:79]
ds_read_b128 v[92:95], v136 offset:27648
v_mfma_f32_16x16x32_bf16 a[80:83], v[16:19], v[40:43], a[80:83]
s_waitcnt vmcnt(10)
v_mfma_f32_16x16x32_bf16 a[84:87], v[20:23], v[40:43], a[84:87]
buffer_load_dwordx4 v139, s[8:11], s15 offen offset:2048 lds
v_min3_u32 v253, v232, v233, v234
v_mfma_f32_16x16x32_bf16 a[88:91], v[24:27], v[40:43], a[88:91]
v_min_u32 v253, v253, v235
v_mfma_f32_16x16x32_bf16 a[92:95], v[28:31], v[40:43], a[92:95]
v_or_b32 v253, s61, v253
v_mfma_f32_16x16x32_bf16 a[96:99], v[0:3], v[44:47], a[96:99]
buffer_load_dwordx4 v140, s[8:11], s15 offen offset:3072 lds
v_min_u32 v253, v253, v231
v_mfma_f32_16x16x32_bf16 a[100:103], v[4:7], v[44:47], a[100:103]
v_cmp_eq_u32 vcc, 0, v253
v_mfma_f32_16x16x32_bf16 a[104:107], v[8:11], v[44:47], a[104:107]
s_nop 1
v_mfma_f32_16x16x32_bf16 a[108:111], v[12:15], v[44:47], a[108:111]
s_add_u32 s15, s15, s17
s_cmp_eq_u64 vcc, 0
s_cselect_b32 s32, s36, -4
v_mfma_f32_16x16x32_bf16 a[112:115], v[16:19], v[44:47], a[112:115]
s_bitcmp1_b32 0x1df, s23
s_cselect_b32 s32, s32, -4
v_mfma_f32_16x16x32_bf16 a[116:119], v[20:23], v[44:47], a[116:119]
v_mov_b32 v254, s32
v_mfma_f32_16x16x32_bf16 a[120:123], v[24:27], v[44:47], a[120:123]
s_mov_b64 exec, s[100:101]
ds_write_b32 v255, v254
s_mov_b64 exec, -1
v_mfma_f32_16x16x32_bf16 a[124:127], v[28:31], v[44:47], a[124:127]
s_waitcnt lgkmcnt(0)
v_mfma_f32_16x16x32_bf16 a[0:3], v[48:51], v[80:83], a[0:3]
s_waitcnt vmcnt(12)
s_barrier
ds_read_b128 v[32:35], v136 offset:0
s_add_u32 m0, s20, 24576
s_nop 0
ds_read_b32 v254, v255
v_mfma_f32_16x16x32_bf16 a[4:7], v[52:55], v[80:83], a[4:7]
ds_read_b64_tr_b16 v[0:1], v128 offset:0
v_mfma_f32_16x16x32_bf16 a[8:11], v[56:59], v[80:83], a[8:11]
ds_read_b64_tr_b16 v[2:3], v128 offset:8192
v_mfma_f32_16x16x32_bf16 a[12:15], v[60:63], v[80:83], a[12:15]
ds_read_b64_tr_b16 v[4:5], v129 offset:0
buffer_load_dwordx4 v141, s[4:7], s16 offen offset:0 sc1 lds
v_mfma_f32_16x16x32_bf16 a[16:19], v[64:67], v[80:83], a[16:19]
ds_read_b64_tr_b16 v[6:7], v129 offset:8192
v_mfma_f32_16x16x32_bf16 a[20:23], v[68:71], v[80:83], a[20:23]
ds_read_b64_tr_b16 v[8:9], v130 offset:0
v_mfma_f32_16x16x32_bf16 a[24:27], v[72:75], v[80:83], a[24:27]
ds_read_b64_tr_b16 v[10:11], v130 offset:8192
buffer_load_dwordx4 v142, s[4:7], s16 offen offset:1024 sc1 lds
v_mfma_f32_16x16x32_bf16 a[28:31], v[76:79], v[80:83], a[28:31]
ds_read_b64_tr_b16 v[12:13], v131 offset:0
v_mfma_f32_16x16x32_bf16 a[32:35], v[48:51], v[84:87], a[32:35]
ds_read_b64_tr_b16 v[14:15], v131 offset:8192
v_mfma_f32_16x16x32_bf16 a[36:39], v[52:55], v[84:87], a[36:39]
ds_read_b64_tr_b16 v[16:17], v132 offset:0
s_add_u32 s16, s16, 1024
v_mfma_f32_16x16x32_bf16 a[40:43], v[56:59], v[84:87], a[40:43]
ds_read_b64_tr_b16 v[18:19], v132 offset:8192
v_mfma_f32_16x16x32_bf16 a[44:47], v[60:63], v[84:87], a[44:47]
ds_read_b64_tr_b16 v[20:21], v133 offset:0
v_mfma_f32_16x16x32_bf16 a[48:51], v[64:67], v[84:87], a[48:51]
ds_read_b64_tr_b16 v[22:23], v133 offset:8192
s_add_u32 m0, s19, 49152
s_nop 0
v_mfma_f32_16x16x32_bf16 a[52:55], v[68:71], v[84:87], a[52:55]
ds_read_b64_tr_b16 v[24:25], v134 offset:0
v_mfma_f32_16x16x32_bf16 a[56:59], v[72:75], v[84:87], a[56:59]
ds_read_b64_tr_b16 v[26:27], v134 offset:8192
v_mfma_f32_16x16x32_bf16 a[60:63], v[76:79], v[84:87], a[60:63]
ds_read_b64_tr_b16 v[28:29], v135 offset:0
buffer_load_dwordx4 v137, s[8:11], s15 offen offset:0 lds
v_mfma_f32_16x16x32_bf16 a[64:67], v[48:51], v[88:91], a[64:67]
ds_read_b64_tr_b16 v[30:31], v135 offset:8192
v_mfma_f32_16x16x32_bf16 a[68:71], v[52:55], v[88:91], a[68:71]
ds_read_b128 v[36:39], v136 offset:1024
v_mfma_f32_16x16x32_bf16 a[72:75], v[56:59], v[88:91], a[72:75]
ds_read_b128 v[40:43], v136 offset:2048
buffer_load_dwordx4 v138, s[8:11], s15 offen offset:1024 lds
v_mfma_f32_16x16x32_bf16 a[76:79], v[60:63], v[88:91], a[76:79]
ds_read_b128 v[44:47], v136 offset:3072
v_mfma_f32_16x16x32_bf16 a[80:83], v[64:67], v[88:91], a[80:83]
s_waitcnt lgkmcnt(8)
v_mfma_f32_16x16x32_bf16 a[84:87], v[68:71], v[88:91], a[84:87]
buffer_load_dwordx4 v139, s[8:11], s15 offen offset:2048 lds
v_readfirstlane_b32 s62, v254
v_mfma_f32_16x16x32_bf16 a[88:91], v[72:75], v[88:91], a[88:91]
v_mfma_f32_16x16x32_bf16 a[92:95], v[76:79], v[88:91], a[92:95]
s_nop 1
v_mfma_f32_16x16x32_bf16 a[96:99], v[48:51], v[92:95], a[96:99]
buffer_load_dwordx4 v140, s[8:11], s15 offen offset:3072 lds
s_and_b32 s23, s62, 15
v_mfma_f32_16x16x32_bf16 a[100:103], v[52:55], v[92:95], a[100:103]
v_mfma_f32_16x16x32_bf16 a[104:107], v[56:59], v[92:95], a[104:107]
s_bfe_u32 s54, s62, 0x20004
v_mfma_f32_16x16x32_bf16 a[108:111], v[60:63], v[92:95], a[108:111]
s_add_u32 s15, s15, s17
s_bfe_u32 s24, s62, 0x80008
v_mfma_f32_16x16x32_bf16 a[112:115], v[64:67], v[92:95], a[112:115]
v_mfma_f32_16x16x32_bf16 a[116:119], v[68:71], v[92:95], a[116:119]
s_lshr_b32 s25, s62, 16
v_mfma_f32_16x16x32_bf16 a[120:123], v[72:75], v[92:95], a[120:123]
v_mfma_f32_16x16x32_bf16 a[124:127], v[76:79], v[92:95], a[124:127]
s_cmp_eq_u32 s54, 1
s_cselect_b32 s73, 2, -1
s_cbranch_scc1 main_kernel_w_c1_task
s_waitcnt lgkmcnt(0)
v_mfma_f32_16x16x32_bf16 a[0:3], v[0:3], v[32:35], a[0:3]
s_waitcnt vmcnt(12)
s_barrier
ds_read_b128 v[80:83], v136 offset:8192
v_mfma_f32_16x16x32_bf16 a[4:7], v[4:7], v[32:35], a[4:7]
ds_read_b64_tr_b16 v[48:49], v128 offset:16384
v_mfma_f32_16x16x32_bf16 a[8:11], v[8:11], v[32:35], a[8:11]
ds_read_b64_tr_b16 v[50:51], v128 offset:24576
v_mfma_f32_16x16x32_bf16 a[12:15], v[12:15], v[32:35], a[12:15]
ds_read_b64_tr_b16 v[52:53], v129 offset:16384
v_mfma_f32_16x16x32_bf16 a[16:19], v[16:19], v[32:35], a[16:19]
ds_read_b64_tr_b16 v[54:55], v129 offset:24576
v_mfma_f32_16x16x32_bf16 a[20:23], v[20:23], v[32:35], a[20:23]
ds_read_b64_tr_b16 v[56:57], v130 offset:16384
v_mfma_f32_16x16x32_bf16 a[24:27], v[24:27], v[32:35], a[24:27]
ds_read_b64_tr_b16 v[58:59], v130 offset:24576
v_mfma_f32_16x16x32_bf16 a[28:31], v[28:31], v[32:35], a[28:31]
ds_read_b64_tr_b16 v[60:61], v131 offset:16384
v_mfma_f32_16x16x32_bf16 a[32:35], v[0:3], v[36:39], a[32:35]
ds_read_b64_tr_b16 v[62:63], v131 offset:24576
v_mfma_f32_16x16x32_bf16 a[36:39], v[4:7], v[36:39], a[36:39]
ds_read_b64_tr_b16 v[64:65], v132 offset:16384
v_mfma_f32_16x16x32_bf16 a[40:43], v[8:11], v[36:39], a[40:43]
ds_read_b64_tr_b16 v[66:67], v132 offset:24576
v_mfma_f32_16x16x32_bf16 a[44:47], v[12:15], v[36:39], a[44:47]
ds_read_b64_tr_b16 v[68:69], v133 offset:16384
v_mfma_f32_16x16x32_bf16 a[48:51], v[16:19], v[36:39], a[48:51]
ds_read_b64_tr_b16 v[70:71], v133 offset:24576
v_mfma_f32_16x16x32_bf16 a[52:55], v[20:23], v[36:39], a[52:55]
ds_read_b64_tr_b16 v[72:73], v134 offset:16384
v_mfma_f32_16x16x32_bf16 a[56:59], v[24:27], v[36:39], a[56:59]
ds_read_b64_tr_b16 v[74:75], v134 offset:24576
v_mfma_f32_16x16x32_bf16 a[60:63], v[28:31], v[36:39], a[60:63]
ds_read_b64_tr_b16 v[76:77], v135 offset:16384
v_mfma_f32_16x16x32_bf16 a[64:67], v[0:3], v[40:43], a[64:67]
ds_read_b64_tr_b16 v[78:79], v135 offset:24576
v_mfma_f32_16x16x32_bf16 a[68:71], v[4:7], v[40:43], a[68:71]
ds_read_b128 v[84:87], v136 offset:9216
v_mfma_f32_16x16x32_bf16 a[72:75], v[8:11], v[40:43], a[72:75]
ds_read_b128 v[88:91], v136 offset:10240
v_mfma_f32_16x16x32_bf16 a[76:79], v[12:15], v[40:43], a[76:79]
ds_read_b128 v[92:95], v136 offset:11264
v_mfma_f32_16x16x32_bf16 a[80:83], v[16:19], v[40:43], a[80:83]
v_mfma_f32_16x16x32_bf16 a[84:87], v[20:23], v[40:43], a[84:87]
v_mfma_f32_16x16x32_bf16 a[88:91], v[24:27], v[40:43], a[88:91]
v_mfma_f32_16x16x32_bf16 a[92:95], v[28:31], v[40:43], a[92:95]
v_mfma_f32_16x16x32_bf16 a[96:99], v[0:3], v[44:47], a[96:99]
v_mfma_f32_16x16x32_bf16 a[100:103], v[4:7], v[44:47], a[100:103]
v_mfma_f32_16x16x32_bf16 a[104:107], v[8:11], v[44:47], a[104:107]
v_mfma_f32_16x16x32_bf16 a[108:111], v[12:15], v[44:47], a[108:111]
v_mfma_f32_16x16x32_bf16 a[112:115], v[16:19], v[44:47], a[112:115]
v_mfma_f32_16x16x32_bf16 a[116:119], v[20:23], v[44:47], a[116:119]
v_mfma_f32_16x16x32_bf16 a[120:123], v[24:27], v[44:47], a[120:123]
v_mfma_f32_16x16x32_bf16 a[124:127], v[28:31], v[44:47], a[124:127]
s_waitcnt lgkmcnt(0)
v_mfma_f32_16x16x32_bf16 a[0:3], v[48:51], v[80:83], a[0:3]
s_waitcnt vmcnt(6)
s_barrier
ds_read_b128 v[32:35], v136 offset:16384
v_mfma_f32_16x16x32_bf16 a[4:7], v[52:55], v[80:83], a[4:7]
ds_read_b64_tr_b16 v[0:1], v128 offset:32768
v_mfma_f32_16x16x32_bf16 a[8:11], v[56:59], v[80:83], a[8:11]
ds_read_b64_tr_b16 v[2:3], v128 offset:40960
v_mfma_f32_16x16x32_bf16 a[12:15], v[60:63], v[80:83], a[12:15]
ds_read_b64_tr_b16 v[4:5], v129 offset:32768
v_mfma_f32_16x16x32_bf16 a[16:19], v[64:67], v[80:83], a[16:19]
ds_read_b64_tr_b16 v[6:7], v129 offset:40960
v_mfma_f32_16x16x32_bf16 a[20:23], v[68:71], v[80:83], a[20:23]
ds_read_b64_tr_b16 v[8:9], v130 offset:32768
v_mfma_f32_16x16x32_bf16 a[24:27], v[72:75], v[80:83], a[24:27]
ds_read_b64_tr_b16 v[10:11], v130 offset:40960
v_mfma_f32_16x16x32_bf16 a[28:31], v[76:79], v[80:83], a[28:31]
ds_read_b64_tr_b16 v[12:13], v131 offset:32768
v_mfma_f32_16x16x32_bf16 a[32:35], v[48:51], v[84:87], a[32:35]
ds_read_b64_tr_b16 v[14:15], v131 offset:40960
v_mfma_f32_16x16x32_bf16 a[36:39], v[52:55], v[84:87], a[36:39]
ds_read_b64_tr_b16 v[16:17], v132 offset:32768
v_mfma_f32_16x16x32_bf16 a[40:43], v[56:59], v[84:87], a[40:43]
ds_read_b64_tr_b16 v[18:19], v132 offset:40960
v_mfma_f32_16x16x32_bf16 a[44:47], v[60:63], v[84:87], a[44:47]
ds_read_b64_tr_b16 v[20:21], v133 offset:32768
v_mfma_f32_16x16x32_bf16 a[48:51], v[64:67], v[84:87], a[48:51]
ds_read_b64_tr_b16 v[22:23], v133 offset:40960
v_mfma_f32_16x16x32_bf16 a[52:55], v[68:71], v[84:87], a[52:55]
ds_read_b64_tr_b16 v[24:25], v134 offset:32768
v_mfma_f32_16x16x32_bf16 a[56:59], v[72:75], v[84:87], a[56:59]
ds_read_b64_tr_b16 v[26:27], v134 offset:40960
v_mfma_f32_16x16x32_bf16 a[60:63], v[76:79], v[84:87], a[60:63]
ds_read_b64_tr_b16 v[28:29], v135 offset:32768
v_mfma_f32_16x16x32_bf16 a[64:67], v[48:51], v[88:91], a[64:67]
ds_read_b64_tr_b16 v[30:31], v135 offset:40960
v_mfma_f32_16x16x32_bf16 a[68:71], v[52:55], v[88:91], a[68:71]
ds_read_b128 v[36:39], v136 offset:17408
v_mfma_f32_16x16x32_bf16 a[72:75], v[56:59], v[88:91], a[72:75]
ds_read_b128 v[40:43], v136 offset:18432
v_mfma_f32_16x16x32_bf16 a[76:79], v[60:63], v[88:91], a[76:79]
ds_read_b128 v[44:47], v136 offset:19456
v_mfma_f32_16x16x32_bf16 a[80:83], v[64:67], v[88:91], a[80:83]
v_mfma_f32_16x16x32_bf16 a[84:87], v[68:71], v[88:91], a[84:87]
v_mfma_f32_16x16x32_bf16 a[88:91], v[72:75], v[88:91], a[88:91]
v_mfma_f32_16x16x32_bf16 a[92:95], v[76:79], v[88:91], a[92:95]
v_mfma_f32_16x16x32_bf16 a[96:99], v[48:51], v[92:95], a[96:99]
v_mfma_f32_16x16x32_bf16 a[100:103], v[52:55], v[92:95], a[100:103]
v_mfma_f32_16x16x32_bf16 a[104:107], v[56:59], v[92:95], a[104:107]
v_mfma_f32_16x16x32_bf16 a[108:111], v[60:63], v[92:95], a[108:111]
v_mfma_f32_16x16x32_bf16 a[112:115], v[64:67], v[92:95], a[112:115]
v_mfma_f32_16x16x32_bf16 a[116:119], v[68:71], v[92:95], a[116:119]
v_mfma_f32_16x16x32_bf16 a[120:123], v[72:75], v[92:95], a[120:123]
v_mfma_f32_16x16x32_bf16 a[124:127], v[76:79], v[92:95], a[124:127]
s_waitcnt lgkmcnt(0)
v_mfma_f32_16x16x32_bf16 a[0:3], v[0:3], v[32:35], a[0:3]
s_waitcnt vmcnt(0)
s_barrier
ds_read_b128 v[80:83], v136 offset:24576
v_mfma_f32_16x16x32_bf16 a[4:7], v[4:7], v[32:35], a[4:7]
ds_read_b64_tr_b16 v[48:49], v128 offset:49152
v_mfma_f32_16x16x32_bf16 a[8:11], v[8:11], v[32:35], a[8:11]
ds_read_b64_tr_b16 v[50:51], v128 offset:57344
v_mfma_f32_16x16x32_bf16 a[12:15], v[12:15], v[32:35], a[12:15]
ds_read_b64_tr_b16 v[52:53], v129 offset:49152
v_mfma_f32_16x16x32_bf16 a[16:19], v[16:19], v[32:35], a[16:19]
ds_read_b64_tr_b16 v[54:55], v129 offset:57344
v_mfma_f32_16x16x32_bf16 a[20:23], v[20:23], v[32:35], a[20:23]
ds_read_b64_tr_b16 v[56:57], v130 offset:49152
v_mfma_f32_16x16x32_bf16 a[24:27], v[24:27], v[32:35], a[24:27]
ds_read_b64_tr_b16 v[58:59], v130 offset:57344
v_mfma_f32_16x16x32_bf16 a[28:31], v[28:31], v[32:35], a[28:31]
ds_read_b64_tr_b16 v[60:61], v131 offset:49152
v_mfma_f32_16x16x32_bf16 a[32:35], v[0:3], v[36:39], a[32:35]
ds_read_b64_tr_b16 v[62:63], v131 offset:57344
v_mfma_f32_16x16x32_bf16 a[36:39], v[4:7], v[36:39], a[36:39]
ds_read_b64_tr_b16 v[64:65], v132 offset:49152
v_mfma_f32_16x16x32_bf16 a[40:43], v[8:11], v[36:39], a[40:43]
ds_read_b64_tr_b16 v[66:67], v132 offset:57344
v_mfma_f32_16x16x32_bf16 a[44:47], v[12:15], v[36:39], a[44:47]
ds_read_b64_tr_b16 v[68:69], v133 offset:49152
v_mfma_f32_16x16x32_bf16 a[48:51], v[16:19], v[36:39], a[48:51]
ds_read_b64_tr_b16 v[70:71], v133 offset:57344
v_mfma_f32_16x16x32_bf16 a[52:55], v[20:23], v[36:39], a[52:55]
ds_read_b64_tr_b16 v[72:73], v134 offset:49152
v_mfma_f32_16x16x32_bf16 a[56:59], v[24:27], v[36:39], a[56:59]
ds_read_b64_tr_b16 v[74:75], v134 offset:57344
v_mfma_f32_16x16x32_bf16 a[60:63], v[28:31], v[36:39], a[60:63]
ds_read_b64_tr_b16 v[76:77], v135 offset:49152
v_mfma_f32_16x16x32_bf16 a[64:67], v[0:3], v[40:43], a[64:67]
ds_read_b64_tr_b16 v[78:79], v135 offset:57344
v_mfma_f32_16x16x32_bf16 a[68:71], v[4:7], v[40:43], a[68:71]
ds_read_b128 v[84:87], v136 offset:25600
v_mfma_f32_16x16x32_bf16 a[72:75], v[8:11], v[40:43], a[72:75]
ds_read_b128 v[88:91], v136 offset:26624
v_mfma_f32_16x16x32_bf16 a[76:79], v[12:15], v[40:43], a[76:79]
ds_read_b128 v[92:95], v136 offset:27648
v_mfma_f32_16x16x32_bf16 a[80:83], v[16:19], v[40:43], a[80:83]
v_mfma_f32_16x16x32_bf16 a[84:87], v[20:23], v[40:43], a[84:87]
v_mfma_f32_16x16x32_bf16 a[88:91], v[24:27], v[40:43], a[88:91]
v_mfma_f32_16x16x32_bf16 a[92:95], v[28:31], v[40:43], a[92:95]
v_mfma_f32_16x16x32_bf16 a[96:99], v[0:3], v[44:47], a[96:99]
v_mfma_f32_16x16x32_bf16 a[100:103], v[4:7], v[44:47], a[100:103]
v_mfma_f32_16x16x32_bf16 a[104:107], v[8:11], v[44:47], a[104:107]
v_mfma_f32_16x16x32_bf16 a[108:111], v[12:15], v[44:47], a[108:111]
v_mfma_f32_16x16x32_bf16 a[112:115], v[16:19], v[44:47], a[112:115]
v_mfma_f32_16x16x32_bf16 a[116:119], v[20:23], v[44:47], a[116:119]
v_mfma_f32_16x16x32_bf16 a[120:123], v[24:27], v[44:47], a[120:123]
v_mfma_f32_16x16x32_bf16 a[124:127], v[28:31], v[44:47], a[124:127]
s_waitcnt lgkmcnt(0)
v_mfma_f32_16x16x32_bf16 a[0:3], v[48:51], v[80:83], a[0:3]
s_barrier
v_mfma_f32_16x16x32_bf16 a[4:7], v[52:55], v[80:83], a[4:7]
v_mfma_f32_16x16x32_bf16 a[8:11], v[56:59], v[80:83], a[8:11]
v_mfma_f32_16x16x32_bf16 a[12:15], v[60:63], v[80:83], a[12:15]
v_mfma_f32_16x16x32_bf16 a[16:19], v[64:67], v[80:83], a[16:19]
v_mfma_f32_16x16x32_bf16 a[20:23], v[68:71], v[80:83], a[20:23]
v_mfma_f32_16x16x32_bf16 a[24:27], v[72:75], v[80:83], a[24:27]
v_mfma_f32_16x16x32_bf16 a[28:31], v[76:79], v[80:83], a[28:31]
v_mfma_f32_16x16x32_bf16 a[32:35], v[48:51], v[84:87], a[32:35]
v_mfma_f32_16x16x32_bf16 a[36:39], v[52:55], v[84:87], a[36:39]
v_mfma_f32_16x16x32_bf16 a[40:43], v[56:59], v[84:87], a[40:43]
v_mfma_f32_16x16x32_bf16 a[44:47], v[60:63], v[84:87], a[44:47]
v_mfma_f32_16x16x32_bf16 a[48:51], v[64:67], v[84:87], a[48:51]
v_mfma_f32_16x16x32_bf16 a[52:55], v[68:71], v[84:87], a[52:55]
v_mfma_f32_16x16x32_bf16 a[56:59], v[72:75], v[84:87], a[56:59]
v_mfma_f32_16x16x32_bf16 a[60:63], v[76:79], v[84:87], a[60:63]
v_mfma_f32_16x16x32_bf16 a[64:67], v[48:51], v[88:91], a[64:67]
v_mfma_f32_16x16x32_bf16 a[68:71], v[52:55], v[88:91], a[68:71]
v_mfma_f32_16x16x32_bf16 a[72:75], v[56:59], v[88:91], a[72:75]
v_mfma_f32_16x16x32_bf16 a[76:79], v[60:63], v[88:91], a[76:79]
v_mfma_f32_16x16x32_bf16 a[80:83], v[64:67], v[88:91], a[80:83]
v_mfma_f32_16x16x32_bf16 a[84:87], v[68:71], v[88:91], a[84:87]
v_mfma_f32_16x16x32_bf16 a[88:91], v[72:75], v[88:91], a[88:91]
v_mfma_f32_16x16x32_bf16 a[92:95], v[76:79], v[88:91], a[92:95]
v_mfma_f32_16x16x32_bf16 a[96:99], v[48:51], v[92:95], a[96:99]
v_mfma_f32_16x16x32_bf16 a[100:103], v[52:55], v[92:95], a[100:103]
v_mfma_f32_16x16x32_bf16 a[104:107], v[56:59], v[92:95], a[104:107]
v_mfma_f32_16x16x32_bf16 a[108:111], v[60:63], v[92:95], a[108:111]
v_mfma_f32_16x16x32_bf16 a[112:115], v[64:67], v[92:95], a[112:115]
v_mfma_f32_16x16x32_bf16 a[116:119], v[68:71], v[92:95], a[116:119]
v_mfma_f32_16x16x32_bf16 a[120:123], v[72:75], v[92:95], a[120:123]
v_mfma_f32_16x16x32_bf16 a[124:127], v[76:79], v[92:95], a[124:127]
s_cmp_lg_u32 s62, -4
s_cbranch_scc1 main_kernel_w_gemm
s_branch main_kernel_w_slow
main_kernel_w_c1_n_ev:
s_mov_b32 s55, 1
s_cmp_eq_u32 s56, 0
s_cbranch_scc1 main_kernel_w_c1_n_et
s_bfm_b64 exec, s0, 0
buffer_store_dword v244, v248, s[4:7], s59 offen sc1
s_mov_b64 exec, -1
s_mov_b32 s56, 0
main_kernel_w_c1_n_et:
s_cmp_lg_u32 s18, 1
s_cbranch_scc1 main_kernel_w_c1_n_loop
s_lshl_b32 s32, s27, 8
s_add_u32 s32, s32, 0x841e000
s_mov_b64 exec, 1
v_mov_b32 v249, 1
buffer_atomic_add v249, off, s[4:7], s32 sc0 sc1
s_mov_b64 exec, -1
s_branch main_kernel_w_c1_n_loop
main_kernel_w_c1_gov:
s_mov_b32 s58, 3
s_mov_b32 s72, s18
s_cmp_lg_u32 s73, -1
s_cbranch_scc1 main_kernel_w_c1_str
s_waitcnt lgkmcnt(0)
v_lshrrev_b32 v0, 4, v250
v_bfe_u32 v1, v250, 2, 2
v_lshl_add_u32 v4, v0, 2, v1
v_and_b32 v5, 7, v4
v_mul_u32_u24 v4, 512, v4
v_and_b32 v6, 3, v250
v_lshl_add_u32 v4, v6, 3, v4
s_mul_i32 s32, s37, 8
v_xor_b32 v5, s32, v5
v_lshl_add_u32 v128, v5, 5, v4
v_xor_b32 v129, 32, v128
v_xor_b32 v130, 64, v128
v_xor_b32 v131, 96, v128
v_xor_b32 v132, 128, v128
v_xor_b32 v133, 160, v128
v_xor_b32 v134, 192, v128
v_xor_b32 v135, 224, v128
s_mul_i32 s32, s38, 4096
s_add_u32 s32, s32, 65536
v_add_u32 v136, s32, v251
v_lshrrev_b32 v2, 5, v250
v_and_b32 v3, 31, v250
s_mul_i32 s32, s14, 8
v_add_u32 v147, s32, v2
v_and_b32 v6, 7, v147
v_lshlrev_b32 v6, 1, v6
v_xor_b32 v6, v6, v3
v_lshlrev_b32 v151, 4, v6
v_add_u32 v148, 2, v147
v_and_b32 v6, 7, v148
v_lshlrev_b32 v6, 1, v6
v_xor_b32 v6, v6, v3
v_lshlrev_b32 v152, 4, v6
v_subrev_u32 v152, 1024, v152
v_add_u32 v149, 4, v147
v_and_b32 v6, 7, v149
v_lshlrev_b32 v6, 1, v6
v_xor_b32 v6, v6, v3
v_lshlrev_b32 v153, 4, v6
v_subrev_u32 v153, 2048, v153
v_add_u32 v150, 6, v147
v_and_b32 v6, 7, v150
v_lshlrev_b32 v6, 1, v6
v_xor_b32 v6, v6, v3
v_lshlrev_b32 v154, 4, v6
v_subrev_u32 v154, 3072, v154
s_mul_i32 s19, s14, 4096
s_mul_i32 s20, s14, 2048
s_add_u32 s20, s20, 65536
s_mul_i32 s32, s14, 2
s_mul_i32 s32, s32, s31
v_mad_u32_u24 v137, v147, s30, v151
v_mad_u32_u24 v138, v148, s30, v152
v_mad_u32_u24 v139, v149, s30, v153
v_mad_u32_u24 v140, v150, s30, v154
v_add_u32 v141, s32, v251
s_add_u32 s32, s32, s31
s_sub_u32 s32, s32, 1024
v_add_u32 v142, s32, v251
s_mul_i32 s17, s30, 32
s_mov_b32 s15, 0
s_waitcnt vmcnt(0)
s_add_u32 m0, s20, 0
s_nop 0
buffer_load_dwordx4 v141, s[4:7], s16 offen offset:0 sc1 lds
buffer_load_dwordx4 v142, s[4:7], s16 offen offset:1024 sc1 lds
s_add_u32 s16, s16, 1024
s_add_u32 m0, s19, 0
s_nop 0
buffer_load_dwordx4 v137, s[8:11], s15 offen offset:0 lds
buffer_load_dwordx4 v138, s[8:11], s15 offen offset:1024 lds
buffer_load_dwordx4 v139, s[8:11], s15 offen offset:2048 lds
buffer_load_dwordx4 v140, s[8:11], s15 offen offset:3072 lds
s_add_u32 s15, s15, s17
s_add_u32 m0, s20, 8192
s_nop 0
buffer_load_dwordx4 v141, s[4:7], s16 offen offset:0 sc1 lds
buffer_load_dwordx4 v142, s[4:7], s16 offen offset:1024 sc1 lds
s_add_u32 s16, s16, 1024
s_add_u32 m0, s19, 16384
s_nop 0
buffer_load_dwordx4 v137, s[8:11], s15 offen offset:0 lds
buffer_load_dwordx4 v138, s[8:11], s15 offen offset:1024 lds
buffer_load_dwordx4 v139, s[8:11], s15 offen offset:2048 lds
buffer_load_dwordx4 v140, s[8:11], s15 offen offset:3072 lds
s_add_u32 s15, s15, s17
s_add_u32 m0, s20, 16384
s_nop 0
buffer_load_dwordx4 v141, s[4:7], s16 offen offset:0 sc1 lds
buffer_load_dwordx4 v142, s[4:7], s16 offen offset:1024 sc1 lds
s_add_u32 s16, s16, 1024
s_add_u32 m0, s19, 32768
s_nop 0
buffer_load_dwordx4 v137, s[8:11], s15 offen offset:0 lds
buffer_load_dwordx4 v138, s[8:11], s15 offen offset:1024 lds
buffer_load_dwordx4 v139, s[8:11], s15 offen offset:2048 lds
buffer_load_dwordx4 v140, s[8:11], s15 offen offset:3072 lds
s_add_u32 s15, s15, s17
s_add_u32 m0, s20, 24576
s_nop 0
buffer_load_dwordx4 v141, s[4:7], s16 offen offset:0 sc1 lds
buffer_load_dwordx4 v142, s[4:7], s16 offen offset:1024 sc1 lds
s_add_u32 s16, s16, 1024
s_add_u32 m0, s19, 49152
s_nop 0
buffer_load_dwordx4 v137, s[8:11], s15 offen offset:0 lds
buffer_load_dwordx4 v138, s[8:11], s15 offen offset:1024 lds
buffer_load_dwordx4 v139, s[8:11], s15 offen offset:2048 lds
buffer_load_dwordx4 v140, s[8:11], s15 offen offset:3072 lds
s_add_u32 s15, s15, s17
s_cmp_lg_u32 s56, 0
s_cbranch_scc1 main_kernel_w_epi
main_kernel_w_c1_v_ent:
v_mfma_f32_32x32x16_bf16 a[0:15], v[224:227], v[224:227], 0
s_waitcnt vmcnt(18)
s_barrier
ds_read_b128 v[32:35], v136 offset:0
ds_read_b64_tr_b16 v[0:1], v128 offset:0
ds_read_b64_tr_b16 v[2:3], v128 offset:8192
v_mfma_f32_32x32x16_bf16 a[16:31], v[224:227], v[224:227], 0
ds_read_b64_tr_b16 v[4:5], v129 offset:0
ds_read_b64_tr_b16 v[6:7], v129 offset:8192
ds_read_b64_tr_b16 v[8:9], v130 offset:0
v_mfma_f32_32x32x16_bf16 a[32:47], v[224:227], v[224:227], 0
ds_read_b64_tr_b16 v[10:11], v130 offset:8192
ds_read_b64_tr_b16 v[12:13], v131 offset:0
ds_read_b64_tr_b16 v[14:15], v131 offset:8192
v_mfma_f32_32x32x16_bf16 a[48:63], v[224:227], v[224:227], 0
ds_read_b64_tr_b16 v[16:17], v132 offset:0
ds_read_b64_tr_b16 v[18:19], v132 offset:8192
ds_read_b64_tr_b16 v[20:21], v133 offset:0
v_mfma_f32_32x32x16_bf16 a[64:79], v[224:227], v[224:227], 0
ds_read_b64_tr_b16 v[22:23], v133 offset:8192
ds_read_b64_tr_b16 v[24:25], v134 offset:0
ds_read_b64_tr_b16 v[26:27], v134 offset:8192
v_mfma_f32_32x32x16_bf16 a[80:95], v[224:227], v[224:227], 0
ds_read_b64_tr_b16 v[28:29], v135 offset:0
ds_read_b64_tr_b16 v[30:31], v135 offset:8192
ds_read_b128 v[36:39], v136 offset:1024
v_mfma_f32_32x32x16_bf16 a[96:111], v[224:227], v[224:227], 0
ds_read_b128 v[40:43], v136 offset:2048
ds_read_b128 v[44:47], v136 offset:3072
v_mfma_f32_32x32x16_bf16 a[112:127], v[224:227], v[224:227], 0
s_sub_u32 s18, s72, 1
s_sub_u32 s55, s72, 2
s_orn2_b32 s55, s55, s100
s_mov_b32 s73, -1
s_nop 0
main_kernel_w_c1_v_loop:
main_kernel_w_c1_v_mid:
s_waitcnt lgkmcnt(0)
v_mfma_f32_16x16x32_bf16 a[0:3], v[32:35], v[0:3], a[0:3]
s_waitcnt vmcnt(12)
s_barrier
ds_read_b128 v[80:83], v136 offset:8192
s_add_u32 m0, s20, 0
s_nop 0
v_mfma_f32_16x16x32_bf16 a[4:7], v[32:35], v[4:7], a[4:7]
ds_read_b64_tr_b16 v[48:49], v128 offset:16384
v_mfma_f32_16x16x32_bf16 a[8:11], v[32:35], v[8:11], a[8:11]
ds_read_b64_tr_b16 v[50:51], v128 offset:24576
v_mfma_f32_16x16x32_bf16 a[12:15], v[32:35], v[12:15], a[12:15]
ds_read_b64_tr_b16 v[52:53], v129 offset:16384
buffer_load_dwordx4 v141, s[4:7], s16 offen offset:0 sc1 lds
v_mfma_f32_16x16x32_bf16 a[16:19], v[32:35], v[16:19], a[16:19]
ds_read_b64_tr_b16 v[54:55], v129 offset:24576
v_mfma_f32_16x16x32_bf16 a[20:23], v[32:35], v[20:23], a[20:23]
ds_read_b64_tr_b16 v[56:57], v130 offset:16384
v_mfma_f32_16x16x32_bf16 a[24:27], v[32:35], v[24:27], a[24:27]
ds_read_b64_tr_b16 v[58:59], v130 offset:24576
buffer_load_dwordx4 v142, s[4:7], s16 offen offset:1024 sc1 lds
v_mfma_f32_16x16x32_bf16 a[28:31], v[32:35], v[28:31], a[28:31]
ds_read_b64_tr_b16 v[60:61], v131 offset:16384
v_mfma_f32_16x16x32_bf16 a[32:35], v[36:39], v[0:3], a[32:35]
ds_read_b64_tr_b16 v[62:63], v131 offset:24576
v_mfma_f32_16x16x32_bf16 a[36:39], v[36:39], v[4:7], a[36:39]
ds_read_b64_tr_b16 v[64:65], v132 offset:16384
s_add_u32 s16, s16, 1024
v_mfma_f32_16x16x32_bf16 a[40:43], v[36:39], v[8:11], a[40:43]
ds_read_b64_tr_b16 v[66:67], v132 offset:24576
v_mfma_f32_16x16x32_bf16 a[44:47], v[36:39], v[12:15], a[44:47]
ds_read_b64_tr_b16 v[68:69], v133 offset:16384
v_mfma_f32_16x16x32_bf16 a[48:51], v[36:39], v[16:19], a[48:51]
ds_read_b64_tr_b16 v[70:71], v133 offset:24576
s_add_u32 m0, s19, 0
s_nop 0
v_mfma_f32_16x16x32_bf16 a[52:55], v[36:39], v[20:23], a[52:55]
ds_read_b64_tr_b16 v[72:73], v134 offset:16384
v_mfma_f32_16x16x32_bf16 a[56:59], v[36:39], v[24:27], a[56:59]
ds_read_b64_tr_b16 v[74:75], v134 offset:24576
v_mfma_f32_16x16x32_bf16 a[60:63], v[36:39], v[28:31], a[60:63]
ds_read_b64_tr_b16 v[76:77], v135 offset:16384
buffer_load_dwordx4 v137, s[8:11], s15 offen offset:0 lds
v_mfma_f32_16x16x32_bf16 a[64:67], v[40:43], v[0:3], a[64:67]
ds_read_b64_tr_b16 v[78:79], v135 offset:24576
v_mfma_f32_16x16x32_bf16 a[68:71], v[40:43], v[4:7], a[68:71]
ds_read_b128 v[84:87], v136 offset:9216
v_mfma_f32_16x16x32_bf16 a[72:75], v[40:43], v[8:11], a[72:75]
ds_read_b128 v[88:91], v136 offset:10240
buffer_load_dwordx4 v138, s[8:11], s15 offen offset:1024 lds
v_mfma_f32_16x16x32_bf16 a[76:79], v[40:43], v[12:15], a[76:79]
ds_read_b128 v[92:95], v136 offset:11264
v_mfma_f32_16x16x32_bf16 a[80:83], v[40:43], v[16:19], a[80:83]
v_mfma_f32_16x16x32_bf16 a[84:87], v[40:43], v[20:23], a[84:87]
buffer_load_dwordx4 v139, s[8:11], s15 offen offset:2048 lds
v_mfma_f32_16x16x32_bf16 a[88:91], v[40:43], v[24:27], a[88:91]
v_mfma_f32_16x16x32_bf16 a[92:95], v[40:43], v[28:31], a[92:95]
v_mfma_f32_16x16x32_bf16 a[96:99], v[44:47], v[0:3], a[96:99]
buffer_load_dwordx4 v140, s[8:11], s15 offen offset:3072 lds
v_mfma_f32_16x16x32_bf16 a[100:103], v[44:47], v[4:7], a[100:103]
v_mfma_f32_16x16x32_bf16 a[104:107], v[44:47], v[8:11], a[104:107]
v_mfma_f32_16x16x32_bf16 a[108:111], v[44:47], v[12:15], a[108:111]
s_add_u32 s15, s15, s17
v_mfma_f32_16x16x32_bf16 a[112:115], v[44:47], v[16:19], a[112:115]
v_mfma_f32_16x16x32_bf16 a[116:119], v[44:47], v[20:23], a[116:119]
v_mfma_f32_16x16x32_bf16 a[120:123], v[44:47], v[24:27], a[120:123]
v_mfma_f32_16x16x32_bf16 a[124:127], v[44:47], v[28:31], a[124:127]
s_waitcnt lgkmcnt(0)
v_mfma_f32_16x16x32_bf16 a[0:3], v[80:83], v[48:51], a[0:3]
s_waitcnt vmcnt(12)
s_barrier
ds_read_b128 v[32:35], v136 offset:16384
s_add_u32 m0, s20, 8192
s_nop 0
v_mfma_f32_16x16x32_bf16 a[4:7], v[80:83], v[52:55], a[4:7]
ds_read_b64_tr_b16 v[0:1], v128 offset:32768
v_mfma_f32_16x16x32_bf16 a[8:11], v[80:83], v[56:59], a[8:11]
ds_read_b64_tr_b16 v[2:3], v128 offset:40960
v_mfma_f32_16x16x32_bf16 a[12:15], v[80:83], v[60:63], a[12:15]
ds_read_b64_tr_b16 v[4:5], v129 offset:32768
buffer_load_dwordx4 v141, s[4:7], s16 offen offset:0 sc1 lds
v_mfma_f32_16x16x32_bf16 a[16:19], v[80:83], v[64:67], a[16:19]
ds_read_b64_tr_b16 v[6:7], v129 offset:40960
v_mfma_f32_16x16x32_bf16 a[20:23], v[80:83], v[68:71], a[20:23]
ds_read_b64_tr_b16 v[8:9], v130 offset:32768
v_mfma_f32_16x16x32_bf16 a[24:27], v[80:83], v[72:75], a[24:27]
ds_read_b64_tr_b16 v[10:11], v130 offset:40960
buffer_load_dwordx4 v142, s[4:7], s16 offen offset:1024 sc1 lds
v_mfma_f32_16x16x32_bf16 a[28:31], v[80:83], v[76:79], a[28:31]
ds_read_b64_tr_b16 v[12:13], v131 offset:32768
v_mfma_f32_16x16x32_bf16 a[32:35], v[84:87], v[48:51], a[32:35]
ds_read_b64_tr_b16 v[14:15], v131 offset:40960
v_mfma_f32_16x16x32_bf16 a[36:39], v[84:87], v[52:55], a[36:39]
ds_read_b64_tr_b16 v[16:17], v132 offset:32768
s_add_u32 s16, s16, 1024
v_mfma_f32_16x16x32_bf16 a[40:43], v[84:87], v[56:59], a[40:43]
ds_read_b64_tr_b16 v[18:19], v132 offset:40960
v_mfma_f32_16x16x32_bf16 a[44:47], v[84:87], v[60:63], a[44:47]
ds_read_b64_tr_b16 v[20:21], v133 offset:32768
v_mfma_f32_16x16x32_bf16 a[48:51], v[84:87], v[64:67], a[48:51]
ds_read_b64_tr_b16 v[22:23], v133 offset:40960
s_add_u32 m0, s19, 16384
s_nop 0
v_mfma_f32_16x16x32_bf16 a[52:55], v[84:87], v[68:71], a[52:55]
ds_read_b64_tr_b16 v[24:25], v134 offset:32768
v_mfma_f32_16x16x32_bf16 a[56:59], v[84:87], v[72:75], a[56:59]
ds_read_b64_tr_b16 v[26:27], v134 offset:40960
v_mfma_f32_16x16x32_bf16 a[60:63], v[84:87], v[76:79], a[60:63]
ds_read_b64_tr_b16 v[28:29], v135 offset:32768
buffer_load_dwordx4 v137, s[8:11], s15 offen offset:0 lds
v_mfma_f32_16x16x32_bf16 a[64:67], v[88:91], v[48:51], a[64:67]
ds_read_b64_tr_b16 v[30:31], v135 offset:40960
v_mfma_f32_16x16x32_bf16 a[68:71], v[88:91], v[52:55], a[68:71]
ds_read_b128 v[36:39], v136 offset:17408
v_mfma_f32_16x16x32_bf16 a[72:75], v[88:91], v[56:59], a[72:75]
ds_read_b128 v[40:43], v136 offset:18432
buffer_load_dwordx4 v138, s[8:11], s15 offen offset:1024 lds
v_mfma_f32_16x16x32_bf16 a[76:79], v[88:91], v[60:63], a[76:79]
ds_read_b128 v[44:47], v136 offset:19456
v_mfma_f32_16x16x32_bf16 a[80:83], v[88:91], v[64:67], a[80:83]
v_mfma_f32_16x16x32_bf16 a[84:87], v[88:91], v[68:71], a[84:87]
buffer_load_dwordx4 v139, s[8:11], s15 offen offset:2048 lds
v_mfma_f32_16x16x32_bf16 a[88:91], v[88:91], v[72:75], a[88:91]
v_mfma_f32_16x16x32_bf16 a[92:95], v[88:91], v[76:79], a[92:95]
v_mfma_f32_16x16x32_bf16 a[96:99], v[92:95], v[48:51], a[96:99]
buffer_load_dwordx4 v140, s[8:11], s15 offen offset:3072 lds
v_mfma_f32_16x16x32_bf16 a[100:103], v[92:95], v[52:55], a[100:103]
v_mfma_f32_16x16x32_bf16 a[104:107], v[92:95], v[56:59], a[104:107]
v_mfma_f32_16x16x32_bf16 a[108:111], v[92:95], v[60:63], a[108:111]
s_add_u32 s15, s15, s17
v_mfma_f32_16x16x32_bf16 a[112:115], v[92:95], v[64:67], a[112:115]
v_mfma_f32_16x16x32_bf16 a[116:119], v[92:95], v[68:71], a[116:119]
v_mfma_f32_16x16x32_bf16 a[120:123], v[92:95], v[72:75], a[120:123]
v_mfma_f32_16x16x32_bf16 a[124:127], v[92:95], v[76:79], a[124:127]
s_waitcnt lgkmcnt(0)
v_mfma_f32_16x16x32_bf16 a[0:3], v[32:35], v[0:3], a[0:3]
s_waitcnt vmcnt(12)
s_barrier
ds_read_b128 v[80:83], v136 offset:24576
s_add_u32 m0, s20, 16384
s_nop 0
v_mfma_f32_16x16x32_bf16 a[4:7], v[32:35], v[4:7], a[4:7]
ds_read_b64_tr_b16 v[48:49], v128 offset:49152
v_mfma_f32_16x16x32_bf16 a[8:11], v[32:35], v[8:11], a[8:11]
ds_read_b64_tr_b16 v[50:51], v128 offset:57344
v_mfma_f32_16x16x32_bf16 a[12:15], v[32:35], v[12:15], a[12:15]
ds_read_b64_tr_b16 v[52:53], v129 offset:49152
buffer_load_dwordx4 v141, s[4:7], s16 offen offset:0 sc1 lds
v_mfma_f32_16x16x32_bf16 a[16:19], v[32:35], v[16:19], a[16:19]
ds_read_b64_tr_b16 v[54:55], v129 offset:57344
v_mfma_f32_16x16x32_bf16 a[20:23], v[32:35], v[20:23], a[20:23]
ds_read_b64_tr_b16 v[56:57], v130 offset:49152
v_mfma_f32_16x16x32_bf16 a[24:27], v[32:35], v[24:27], a[24:27]
ds_read_b64_tr_b16 v[58:59], v130 offset:57344
buffer_load_dwordx4 v142, s[4:7], s16 offen offset:1024 sc1 lds
v_mfma_f32_16x16x32_bf16 a[28:31], v[32:35], v[28:31], a[28:31]
ds_read_b64_tr_b16 v[60:61], v131 offset:49152
v_mfma_f32_16x16x32_bf16 a[32:35], v[36:39], v[0:3], a[32:35]
ds_read_b64_tr_b16 v[62:63], v131 offset:57344
v_mfma_f32_16x16x32_bf16 a[36:39], v[36:39], v[4:7], a[36:39]
ds_read_b64_tr_b16 v[64:65], v132 offset:49152
s_add_u32 s16, s16, 1024
v_mfma_f32_16x16x32_bf16 a[40:43], v[36:39], v[8:11], a[40:43]
ds_read_b64_tr_b16 v[66:67], v132 offset:57344
v_mfma_f32_16x16x32_bf16 a[44:47], v[36:39], v[12:15], a[44:47]
ds_read_b64_tr_b16 v[68:69], v133 offset:49152
v_mfma_f32_16x16x32_bf16 a[48:51], v[36:39], v[16:19], a[48:51]
ds_read_b64_tr_b16 v[70:71], v133 offset:57344
s_add_u32 m0, s19, 32768
s_nop 0
v_mfma_f32_16x16x32_bf16 a[52:55], v[36:39], v[20:23], a[52:55]
ds_read_b64_tr_b16 v[72:73], v134 offset:49152
v_mfma_f32_16x16x32_bf16 a[56:59], v[36:39], v[24:27], a[56:59]
ds_read_b64_tr_b16 v[74:75], v134 offset:57344
v_mfma_f32_16x16x32_bf16 a[60:63], v[36:39], v[28:31], a[60:63]
ds_read_b64_tr_b16 v[76:77], v135 offset:49152
buffer_load_dwordx4 v137, s[8:11], s15 offen offset:0 lds
v_mfma_f32_16x16x32_bf16 a[64:67], v[40:43], v[0:3], a[64:67]
ds_read_b64_tr_b16 v[78:79], v135 offset:57344
v_mfma_f32_16x16x32_bf16 a[68:71], v[40:43], v[4:7], a[68:71]
ds_read_b128 v[84:87], v136 offset:25600
v_mfma_f32_16x16x32_bf16 a[72:75], v[40:43], v[8:11], a[72:75]
ds_read_b128 v[88:91], v136 offset:26624
buffer_load_dwordx4 v138, s[8:11], s15 offen offset:1024 lds
v_mfma_f32_16x16x32_bf16 a[76:79], v[40:43], v[12:15], a[76:79]
ds_read_b128 v[92:95], v136 offset:27648
v_mfma_f32_16x16x32_bf16 a[80:83], v[40:43], v[16:19], a[80:83]
v_mfma_f32_16x16x32_bf16 a[84:87], v[40:43], v[20:23], a[84:87]
buffer_load_dwordx4 v139, s[8:11], s15 offen offset:2048 lds
v_mfma_f32_16x16x32_bf16 a[88:91], v[40:43], v[24:27], a[88:91]
v_mfma_f32_16x16x32_bf16 a[92:95], v[40:43], v[28:31], a[92:95]
v_mfma_f32_16x16x32_bf16 a[96:99], v[44:47], v[0:3], a[96:99]
buffer_load_dwordx4 v140, s[8:11], s15 offen offset:3072 lds
v_mfma_f32_16x16x32_bf16 a[100:103], v[44:47], v[4:7], a[100:103]
v_mfma_f32_16x16x32_bf16 a[104:107], v[44:47], v[8:11], a[104:107]
v_mfma_f32_16x16x32_bf16 a[108:111], v[44:47], v[12:15], a[108:111]
s_add_u32 s15, s15, s17
v_mfma_f32_16x16x32_bf16 a[112:115], v[44:47], v[16:19], a[112:115]
v_mfma_f32_16x16x32_bf16 a[116:119], v[44:47], v[20:23], a[116:119]
v_mfma_f32_16x16x32_bf16 a[120:123], v[44:47], v[24:27], a[120:123]
v_mfma_f32_16x16x32_bf16 a[124:127], v[44:47], v[28:31], a[124:127]
s_waitcnt lgkmcnt(0)
v_mfma_f32_16x16x32_bf16 a[0:3], v[80:83], v[48:51], a[0:3]
s_waitcnt vmcnt(12)
s_barrier
ds_read_b128 v[32:35], v136 offset:0
s_add_u32 m0, s20, 24576
s_nop 0
v_mfma_f32_16x16x32_bf16 a[4:7], v[80:83], v[52:55], a[4:7]
ds_read_b64_tr_b16 v[0:1], v128 offset:0
v_mfma_f32_16x16x32_bf16 a[8:11], v[80:83], v[56:59], a[8:11]
ds_read_b64_tr_b16 v[2:3], v128 offset:8192
v_mfma_f32_16x16x32_bf16 a[12:15], v[80:83], v[60:63], a[12:15]
ds_read_b64_tr_b16 v[4:5], v129 offset:0
buffer_load_dwordx4 v141, s[4:7], s16 offen offset:0 sc1 lds
v_mfma_f32_16x16x32_bf16 a[16:19], v[80:83], v[64:67], a[16:19]
ds_read_b64_tr_b16 v[6:7], v129 offset:8192
v_mfma_f32_16x16x32_bf16 a[20:23], v[80:83], v[68:71], a[20:23]
ds_read_b64_tr_b16 v[8:9], v130 offset:0
v_mfma_f32_16x16x32_bf16 a[24:27], v[80:83], v[72:75], a[24:27]
ds_read_b64_tr_b16 v[10:11], v130 offset:8192
buffer_load_dwordx4 v142, s[4:7], s16 offen offset:1024 sc1 lds
v_mfma_f32_16x16x32_bf16 a[28:31], v[80:83], v[76:79], a[28:31]
ds_read_b64_tr_b16 v[12:13], v131 offset:0
v_mfma_f32_16x16x32_bf16 a[32:35], v[84:87], v[48:51], a[32:35]
ds_read_b64_tr_b16 v[14:15], v131 offset:8192
v_mfma_f32_16x16x32_bf16 a[36:39], v[84:87], v[52:55], a[36:39]
ds_read_b64_tr_b16 v[16:17], v132 offset:0
s_add_u32 s16, s16, 1024
v_mfma_f32_16x16x32_bf16 a[40:43], v[84:87], v[56:59], a[40:43]
ds_read_b64_tr_b16 v[18:19], v132 offset:8192
v_mfma_f32_16x16x32_bf16 a[44:47], v[84:87], v[60:63], a[44:47]
ds_read_b64_tr_b16 v[20:21], v133 offset:0
v_mfma_f32_16x16x32_bf16 a[48:51], v[84:87], v[64:67], a[48:51]
ds_read_b64_tr_b16 v[22:23], v133 offset:8192
s_add_u32 m0, s19, 49152
s_nop 0
v_mfma_f32_16x16x32_bf16 a[52:55], v[84:87], v[68:71], a[52:55]
ds_read_b64_tr_b16 v[24:25], v134 offset:0
v_mfma_f32_16x16x32_bf16 a[56:59], v[84:87], v[72:75], a[56:59]
ds_read_b64_tr_b16 v[26:27], v134 offset:8192
v_mfma_f32_16x16x32_bf16 a[60:63], v[84:87], v[76:79], a[60:63]
ds_read_b64_tr_b16 v[28:29], v135 offset:0
buffer_load_dwordx4 v137, s[8:11], s15 offen offset:0 lds
v_mfma_f32_16x16x32_bf16 a[64:67], v[88:91], v[48:51], a[64:67]
ds_read_b64_tr_b16 v[30:31], v135 offset:8192
v_mfma_f32_16x16x32_bf16 a[68:71], v[88:91], v[52:55], a[68:71]
ds_read_b128 v[36:39], v136 offset:1024
v_mfma_f32_16x16x32_bf16 a[72:75], v[88:91], v[56:59], a[72:75]
ds_read_b128 v[40:43], v136 offset:2048
buffer_load_dwordx4 v138, s[8:11], s15 offen offset:1024 lds
v_mfma_f32_16x16x32_bf16 a[76:79], v[88:91], v[60:63], a[76:79]
ds_read_b128 v[44:47], v136 offset:3072
v_mfma_f32_16x16x32_bf16 a[80:83], v[88:91], v[64:67], a[80:83]
v_mfma_f32_16x16x32_bf16 a[84:87], v[88:91], v[68:71], a[84:87]
buffer_load_dwordx4 v139, s[8:11], s15 offen offset:2048 lds
v_mfma_f32_16x16x32_bf16 a[88:91], v[88:91], v[72:75], a[88:91]
v_mfma_f32_16x16x32_bf16 a[92:95], v[88:91], v[76:79], a[92:95]
v_mfma_f32_16x16x32_bf16 a[96:99], v[92:95], v[48:51], a[96:99]
buffer_load_dwordx4 v140, s[8:11], s15 offen offset:3072 lds
v_mfma_f32_16x16x32_bf16 a[100:103], v[92:95], v[52:55], a[100:103]
v_mfma_f32_16x16x32_bf16 a[104:107], v[92:95], v[56:59], a[104:107]
v_mfma_f32_16x16x32_bf16 a[108:111], v[92:95], v[60:63], a[108:111]
s_add_u32 s15, s15, s17
v_mfma_f32_16x16x32_bf16 a[112:115], v[92:95], v[64:67], a[112:115]
v_mfma_f32_16x16x32_bf16 a[116:119], v[92:95], v[68:71], a[116:119]
v_mfma_f32_16x16x32_bf16 a[120:123], v[92:95], v[72:75], a[120:123]
v_mfma_f32_16x16x32_bf16 a[124:127], v[92:95], v[76:79], a[124:127]
s_sub_u32 s18, s18, 1
s_cmp_eq_u32 s18, s55
s_cbranch_scc1 main_kernel_w_c1_v_ev
s_cmp_lg_u32 s18, 0
s_cbranch_scc1 main_kernel_w_c1_v_loop
s_cmp_lg_u32 s73, -1
s_cbranch_scc1 main_kernel_w_epn
s_waitcnt lgkmcnt(0)
v_mfma_f32_16x16x32_bf16 a[0:3], v[32:35], v[0:3], a[0:3]
s_waitcnt vmcnt(12)
s_barrier
ds_read_b128 v[80:83], v136 offset:8192
s_add_u32 m0, s20, 0
s_nop 0
s_add_u32 s32, s23, 1
s_bitcmp0_b32 s32, 2
s_cselect_b32 s34, 7, 2
s_cselect_b32 s35, 2, 4
s_lshl_b32 s59, s23, 13
s_add_u32 s59, s59, 0x8404000
v_mfma_f32_16x16x32_bf16 a[4:7], v[32:35], v[4:7], a[4:7]
ds_read_b64_tr_b16 v[48:49], v128 offset:16384
v_lshrrev_b32 v253, 3, v250
v_add_lshl_u32 v253, s24, v253, 9
v_mfma_f32_16x16x32_bf16 a[8:11], v[32:35], v[8:11], a[8:11]
ds_read_b64_tr_b16 v[50:51], v128 offset:24576
v_and_b32 v254, 3, v250
v_lshl_add_u32 v253, v254, s34, v253
v_mfma_f32_16x16x32_bf16 a[12:15], v[32:35], v[12:15], a[12:15]
ds_read_b64_tr_b16 v[52:53], v129 offset:16384
buffer_load_dwordx4 v141, s[4:7], s16 offen offset:0 sc1 lds
v_bfe_u32 v254, v250, 2, 1
v_add_u32 v254, s25, v254
v_mfma_f32_16x16x32_bf16 a[16:19], v[32:35], v[16:19], a[16:19]
ds_read_b64_tr_b16 v[54:55], v129 offset:24576
v_lshl_add_u32 v248, v254, s35, v253
s_lshl_b32 s0, 4, s54
v_mfma_f32_16x16x32_bf16 a[20:23], v[32:35], v[20:23], a[20:23]
ds_read_b64_tr_b16 v[56:57], v130 offset:16384
v_readfirstlane_b32 s28, v249
s_nop 1
v_cmp_ge_u32 vcc, s28, v229
v_mfma_f32_16x16x32_bf16 a[24:27], v[32:35], v[24:27], a[24:27]
ds_read_b64_tr_b16 v[58:59], v130 offset:24576
buffer_load_dwordx4 v142, s[4:7], s16 offen offset:1024 sc1 lds
s_nop 1
s_bcnt1_i32_b64 s32, vcc
v_mfma_f32_16x16x32_bf16 a[28:31], v[32:35], v[28:31], a[28:31]
ds_read_b64_tr_b16 v[60:61], v131 offset:16384
s_sub_u32 s32, s32, 1
v_readlane_b32 s36, v230, s32
v_mfma_f32_16x16x32_bf16 a[32:35], v[36:39], v[0:3], a[32:35]
ds_read_b64_tr_b16 v[62:63], v131 offset:24576
s_nop 1
s_and_b32 s32, s36, 0x7ff
v_mfma_f32_16x16x32_bf16 a[36:39], v[36:39], v[4:7], a[36:39]
ds_read_b64_tr_b16 v[64:65], v132 offset:16384
s_add_u32 s16, s16, 1024
s_sub_u32 s28, s28, s32
s_bfe_u32 s32, s36, 0x3001a
v_mfma_f32_16x16x32_bf16 a[40:43], v[36:39], v[8:11], a[40:43]
ds_read_b64_tr_b16 v[66:67], v132 offset:24576
s_lshr_b32 s25, s28, s32
s_lshl_b32 s33, s25, s32
s_sub_u32 s24, s28, s33
v_mfma_f32_16x16x32_bf16 a[44:47], v[36:39], v[12:15], a[44:47]
ds_read_b64_tr_b16 v[68:69], v133 offset:16384
s_bfe_u32 s34, s36, 0x1001d
s_lshl_b32 s24, s24, s34
v_mfma_f32_16x16x32_bf16 a[48:51], v[36:39], v[16:19], a[48:51]
ds_read_b64_tr_b16 v[70:71], v133 offset:24576
s_add_u32 m0, s19, 0
s_nop 0
s_bfe_u32 s35, s36, 0x1001e
s_lshl_b32 s25, s25, s35
v_mfma_f32_16x16x32_bf16 a[52:55], v[36:39], v[20:23], a[52:55]
ds_read_b64_tr_b16 v[72:73], v134 offset:16384
s_bfe_u32 s32, s36, 0x40011
s_add_u32 s24, s24, s32
v_mfma_f32_16x16x32_bf16 a[56:59], v[36:39], v[24:27], a[56:59]
ds_read_b64_tr_b16 v[74:75], v134 offset:24576
s_bfe_u32 s32, s36, 0x50015
s_add_u32 s25, s25, s32
v_mfma_f32_16x16x32_bf16 a[60:63], v[36:39], v[28:31], a[60:63]
ds_read_b64_tr_b16 v[76:77], v135 offset:16384
buffer_load_dwordx4 v137, s[8:11], s15 offen offset:0 lds
s_bfe_u32 s23, s36, 0x4000b
s_bfe_u32 s36, s36, 0x6000b
s_lshl_b32 s32, s24, 8
v_mfma_f32_16x16x32_bf16 a[64:67], v[40:43], v[0:3], a[64:67]
ds_read_b64_tr_b16 v[78:79], v135 offset:24576
s_or_b32 s36, s36, s32
s_lshl_b32 s32, s25, 16
v_mfma_f32_16x16x32_bf16 a[68:71], v[40:43], v[4:7], a[68:71]
ds_read_b128 v[84:87], v136 offset:9216
s_or_b32 s36, s36, s32
s_cmp_eq_u32 s23, 4
s_cselect_b32 s32, 1, 0
v_mfma_f32_16x16x32_bf16 a[72:75], v[40:43], v[8:11], a[72:75]
ds_read_b128 v[88:91], v136 offset:10240
buffer_load_dwordx4 v138, s[8:11], s15 offen offset:1024 lds
s_sub_u32 s48, s24, s32
s_max_i32 s48, s48, 0
v_mfma_f32_16x16x32_bf16 a[76:79], v[40:43], v[12:15], a[76:79]
ds_read_b128 v[92:95], v136 offset:11264
s_add_u32 s49, s24, s34
s_add_u32 s49, s49, s32
v_mfma_f32_16x16x32_bf16 a[80:83], v[40:43], v[16:19], a[80:83]
s_min_u32 s49, s49, 15
s_cmp_eq_u32 s23, 6
s_cselect_b32 s51, 3, 7
s_cmp_eq_u32 s23, 7
s_cselect_b32 s51, 27, s51
s_cselect_b32 s50, 5, 4
v_mfma_f32_16x16x32_bf16 a[84:87], v[40:43], v[20:23], a[84:87]
buffer_load_dwordx4 v139, s[8:11], s15 offen offset:2048 lds
s_add_u32 s33, s25, s35
s_lshl_b32 s34, s24, 9
v_mfma_f32_16x16x32_bf16 a[88:91], v[40:43], v[24:27], a[88:91]
s_cmp_eq_u32 s23, 8
s_cselect_b32 s51, 0, s51
s_cselect_b32 s48, s25, s48
s_cselect_b32 s49, s33, s49
s_cmp_eq_u32 s23, 8
s_cselect_b32 s63, 2, 9
s_cselect_b32 s61, 0, 0x7f000000
s_cselect_b32 s34, s34, 0
v_mfma_f32_16x16x32_bf16 a[92:95], v[40:43], v[28:31], a[92:95]
v_lshrrev_b32 v228, s50, v250
v_lshlrev_b32 v254, s50, v228
v_mfma_f32_16x16x32_bf16 a[96:99], v[44:47], v[0:3], a[96:99]
buffer_load_dwordx4 v140, s[8:11], s15 offen offset:3072 lds
v_sub_u32 v254, v250, v254
s_cmp_lt_u32 s23, 4
s_cselect_b32 s39, 10, s23
v_mfma_f32_16x16x32_bf16 a[100:103], v[44:47], v[4:7], a[100:103]
v_min_u32 v254, s51, v254
s_lshl_b32 s39, s39, 13
s_cmp_eq_u32 s23, 3
s_cselect_b32 s34, 4, s34
v_mfma_f32_16x16x32_bf16 a[104:107], v[44:47], v[8:11], a[104:107]
v_add_u32 v228, s48, v228
s_add_u32 s39, s39, s34
v_mfma_f32_16x16x32_bf16 a[108:111], v[44:47], v[12:15], a[108:111]
s_add_u32 s15, s15, s17
s_add_u32 s39, s39, 0x8402000
v_min_u32 v228, s49, v228
v_mfma_f32_16x16x32_bf16 a[112:115], v[44:47], v[16:19], a[112:115]
s_lshl_b32 s60, s24, 10
s_add_u32 s60, s60, 0x8400000
v_mfma_f32_16x16x32_bf16 a[116:119], v[44:47], v[20:23], a[116:119]
v_lshlrev_b32 v228, s63, v228
v_lshl_add_u32 v228, v254, 4, v228
v_mfma_f32_16x16x32_bf16 a[120:123], v[44:47], v[24:27], a[120:123]
v_or_b32 v146, s61, v251
s_mov_b64 exec, s[100:101]
buffer_load_dword v231, v228, s[4:7], s39 offen sc1
buffer_load_dwordx4 v[232:235], v146, s[4:7], s60 offen sc1
s_mov_b64 exec, -1
v_mfma_f32_16x16x32_bf16 a[124:127], v[44:47], v[28:31], a[124:127]
s_waitcnt lgkmcnt(0)
v_mfma_f32_16x16x32_bf16 a[0:3], v[80:83], v[48:51], a[0:3]
s_waitcnt vmcnt(12)
s_barrier
ds_read_b128 v[32:35], v136 offset:16384
s_add_u32 m0, s20, 8192
s_nop 0
s_mov_b32 s1, s21
v_mfma_f32_16x16x32_bf16 a[4:7], v[80:83], v[52:55], a[4:7]
ds_read_b64_tr_b16 v[0:1], v128 offset:32768
v_mfma_f32_16x16x32_bf16 a[8:11], v[80:83], v[56:59], a[8:11]
ds_read_b64_tr_b16 v[2:3], v128 offset:40960
v_mfma_f32_16x16x32_bf16 a[12:15], v[80:83], v[60:63], a[12:15]
ds_read_b64_tr_b16 v[4:5], v129 offset:32768
buffer_load_dwordx4 v141, s[4:7], s16 offen offset:0 sc1 lds
v_mfma_f32_16x16x32_bf16 a[16:19], v[80:83], v[64:67], a[16:19]
ds_read_b64_tr_b16 v[6:7], v129 offset:40960
v_mfma_f32_16x16x32_bf16 a[20:23], v[80:83], v[68:71], a[20:23]
ds_read_b64_tr_b16 v[8:9], v130 offset:32768
s_mov_b32 s2, s22
v_mfma_f32_16x16x32_bf16 a[24:27], v[80:83], v[72:75], a[24:27]
ds_read_b64_tr_b16 v[10:11], v130 offset:40960
buffer_load_dwordx4 v142, s[4:7], s16 offen offset:1024 sc1 lds
v_mfma_f32_16x16x32_bf16 a[28:31], v[80:83], v[76:79], a[28:31]
ds_read_b64_tr_b16 v[12:13], v131 offset:32768
v_mfma_f32_16x16x32_bf16 a[32:35], v[84:87], v[48:51], a[32:35]
ds_read_b64_tr_b16 v[14:15], v131 offset:40960
v_mfma_f32_16x16x32_bf16 a[36:39], v[84:87], v[52:55], a[36:39]
ds_read_b64_tr_b16 v[16:17], v132 offset:32768
s_add_u32 s16, s16, 1024
v_mfma_f32_16x16x32_bf16 a[40:43], v[84:87], v[56:59], a[40:43]
ds_read_b64_tr_b16 v[18:19], v132 offset:40960
s_mov_b32 s3, s26
v_mfma_f32_16x16x32_bf16 a[44:47], v[84:87], v[60:63], a[44:47]
ds_read_b64_tr_b16 v[20:21], v133 offset:32768
v_mfma_f32_16x16x32_bf16 a[48:51], v[84:87], v[64:67], a[48:51]
ds_read_b64_tr_b16 v[22:23], v133 offset:40960
s_add_u32 m0, s19, 16384
s_nop 0
v_mfma_f32_16x16x32_bf16 a[52:55], v[84:87], v[68:71], a[52:55]
ds_read_b64_tr_b16 v[24:25], v134 offset:32768
v_mfma_f32_16x16x32_bf16 a[56:59], v[84:87], v[72:75], a[56:59]
ds_read_b64_tr_b16 v[26:27], v134 offset:40960
v_mfma_f32_16x16x32_bf16 a[60:63], v[84:87], v[76:79], a[60:63]
ds_read_b64_tr_b16 v[28:29], v135 offset:32768
buffer_load_dwordx4 v137, s[8:11], s15 offen offset:0 lds
s_mov_b32 s56, s57
v_mfma_f32_16x16x32_bf16 a[64:67], v[88:91], v[48:51], a[64:67]
ds_read_b64_tr_b16 v[30:31], v135 offset:40960
v_mfma_f32_16x16x32_bf16 a[68:71], v[88:91], v[52:55], a[68:71]
ds_read_b128 v[36:39], v136 offset:17408
v_mfma_f32_16x16x32_bf16 a[72:75], v[88:91], v[56:59], a[72:75]
ds_read_b128 v[40:43], v136 offset:18432
buffer_load_dwordx4 v138, s[8:11], s15 offen offset:1024 lds
v_mfma_f32_16x16x32_bf16 a[76:79], v[88:91], v[60:63], a[76:79]
ds_read_b128 v[44:47], v136 offset:19456
v_mfma_f32_16x16x32_bf16 a[80:83], v[88:91], v[64:67], a[80:83]
v_mov_b32 v145, v252
v_mfma_f32_16x16x32_bf16 a[84:87], v[88:91], v[68:71], a[84:87]
buffer_load_dwordx4 v139, s[8:11], s15 offen offset:2048 lds
v_mfma_f32_16x16x32_bf16 a[88:91], v[88:91], v[72:75], a[88:91]
v_mfma_f32_16x16x32_bf16 a[92:95], v[88:91], v[76:79], a[92:95]
v_mfma_f32_16x16x32_bf16 a[96:99], v[92:95], v[48:51], a[96:99]
buffer_load_dwordx4 v140, s[8:11], s15 offen offset:3072 lds
v_mfma_f32_16x16x32_bf16 a[100:103], v[92:95], v[52:55], a[100:103]
v_mov_b32 v255, 131072
v_mfma_f32_16x16x32_bf16 a[104:107], v[92:95], v[56:59], a[104:107]
v_mfma_f32_16x16x32_bf16 a[108:111], v[92:95], v[60:63], a[108:111]
s_add_u32 s15, s15, s17
v_mfma_f32_16x16x32_bf16 a[112:115], v[92:95], v[64:67], a[112:115]
v_mfma_f32_16x16x32_bf16 a[116:119], v[92:95], v[68:71], a[116:119]
v_mfma_f32_16x16x32_bf16 a[120:123], v[92:95], v[72:75], a[120:123]
v_mfma_f32_16x16x32_bf16 a[124:127], v[92:95], v[76:79], a[124:127]
s_waitcnt lgkmcnt(0)
v_mfma_f32_16x16x32_bf16 a[0:3], v[32:35], v[0:3], a[0:3]
s_waitcnt vmcnt(12)
s_barrier
ds_read_b128 v[80:83], v136 offset:24576
s_add_u32 m0, s20, 16384
s_nop 0
v_mfma_f32_16x16x32_bf16 a[4:7], v[32:35], v[4:7], a[4:7]
ds_read_b64_tr_b16 v[48:49], v128 offset:49152
v_mfma_f32_16x16x32_bf16 a[8:11], v[32:35], v[8:11], a[8:11]
ds_read_b64_tr_b16 v[50:51], v128 offset:57344
v_mfma_f32_16x16x32_bf16 a[12:15], v[32:35], v[12:15], a[12:15]
ds_read_b64_tr_b16 v[52:53], v129 offset:49152
buffer_load_dwordx4 v141, s[4:7], s16 offen offset:0 sc1 lds
v_mfma_f32_16x16x32_bf16 a[16:19], v[32:35], v[16:19], a[16:19]
ds_read_b64_tr_b16 v[54:55], v129 offset:57344
v_mfma_f32_16x16x32_bf16 a[20:23], v[32:35], v[20:23], a[20:23]
ds_read_b64_tr_b16 v[56:57], v130 offset:49152
v_mfma_f32_16x16x32_bf16 a[24:27], v[32:35], v[24:27], a[24:27]
ds_read_b64_tr_b16 v[58:59], v130 offset:57344
buffer_load_dwordx4 v142, s[4:7], s16 offen offset:1024 sc1 lds
v_mfma_f32_16x16x32_bf16 a[28:31], v[32:35], v[28:31], a[28:31]
ds_read_b64_tr_b16 v[60:61], v131 offset:49152
v_mfma_f32_16x16x32_bf16 a[32:35], v[36:39], v[0:3], a[32:35]
ds_read_b64_tr_b16 v[62:63], v131 offset:57344
v_mfma_f32_16x16x32_bf16 a[36:39], v[36:39], v[4:7], a[36:39]
ds_read_b64_tr_b16 v[64:65], v132 offset:49152
s_add_u32 s16, s16, 1024
v_mfma_f32_16x16x32_bf16 a[40:43], v[36:39], v[8:11], a[40:43]
ds_read_b64_tr_b16 v[66:67], v132 offset:57344
v_mfma_f32_16x16x32_bf16 a[44:47], v[36:39], v[12:15], a[44:47]
ds_read_b64_tr_b16 v[68:69], v133 offset:49152
v_mfma_f32_16x16x32_bf16 a[48:51], v[36:39], v[16:19], a[48:51]
ds_read_b64_tr_b16 v[70:71], v133 offset:57344
s_add_u32 m0, s19, 32768
s_nop 0
v_mfma_f32_16x16x32_bf16 a[52:55], v[36:39], v[20:23], a[52:55]
ds_read_b64_tr_b16 v[72:73], v134 offset:49152
v_mfma_f32_16x16x32_bf16 a[56:59], v[36:39], v[24:27], a[56:59]
ds_read_b64_tr_b16 v[74:75], v134 offset:57344
v_mfma_f32_16x16x32_bf16 a[60:63], v[36:39], v[28:31], a[60:63]
ds_read_b64_tr_b16 v[76:77], v135 offset:49152
buffer_load_dwordx4 v137, s[8:11], s15 offen offset:0 lds
v_mfma_f32_16x16x32_bf16 a[64:67], v[40:43], v[0:3], a[64:67]
ds_read_b64_tr_b16 v[78:79], v135 offset:57344
v_mfma_f32_16x16x32_bf16 a[68:71], v[40:43], v[4:7], a[68:71]
ds_read_b128 v[84:87], v136 offset:25600
v_mfma_f32_16x16x32_bf16 a[72:75], v[40:43], v[8:11], a[72:75]
ds_read_b128 v[88:91], v136 offset:26624
buffer_load_dwordx4 v138, s[8:11], s15 offen offset:1024 lds
v_mfma_f32_16x16x32_bf16 a[76:79], v[40:43], v[12:15], a[76:79]
ds_read_b128 v[92:95], v136 offset:27648
v_mfma_f32_16x16x32_bf16 a[80:83], v[40:43], v[16:19], a[80:83]
s_waitcnt vmcnt(10)
v_mfma_f32_16x16x32_bf16 a[84:87], v[40:43], v[20:23], a[84:87]
buffer_load_dwordx4 v139, s[8:11], s15 offen offset:2048 lds
v_min3_u32 v253, v232, v233, v234
v_mfma_f32_16x16x32_bf16 a[88:91], v[40:43], v[24:27], a[88:91]
v_min_u32 v253, v253, v235
v_mfma_f32_16x16x32_bf16 a[92:95], v[40:43], v[28:31], a[92:95]
v_or_b32 v253, s61, v253
v_mfma_f32_16x16x32_bf16 a[96:99], v[44:47], v[0:3], a[96:99]
buffer_load_dwordx4 v140, s[8:11], s15 offen offset:3072 lds
v_min_u32 v253, v253, v231
v_mfma_f32_16x16x32_bf16 a[100:103], v[44:47], v[4:7], a[100:103]
v_cmp_eq_u32 vcc, 0, v253
v_mfma_f32_16x16x32_bf16 a[104:107], v[44:47], v[8:11], a[104:107]
s_nop 1
v_mfma_f32_16x16x32_bf16 a[108:111], v[44:47], v[12:15], a[108:111]
s_add_u32 s15, s15, s17
s_cmp_eq_u64 vcc, 0
s_cselect_b32 s32, s36, -4
v_mfma_f32_16x16x32_bf16 a[112:115], v[44:47], v[16:19], a[112:115]
s_bitcmp1_b32 0x1df, s23
s_cselect_b32 s32, s32, -4
v_mfma_f32_16x16x32_bf16 a[116:119], v[44:47], v[20:23], a[116:119]
v_mov_b32 v254, s32
v_mfma_f32_16x16x32_bf16 a[120:123], v[44:47], v[24:27], a[120:123]
s_mov_b64 exec, s[100:101]
ds_write_b32 v255, v254
s_mov_b64 exec, -1
v_mfma_f32_16x16x32_bf16 a[124:127], v[44:47], v[28:31], a[124:127]
s_waitcnt lgkmcnt(0)
v_mfma_f32_16x16x32_bf16 a[0:3], v[80:83], v[48:51], a[0:3]
s_waitcnt vmcnt(12)
s_barrier
ds_read_b128 v[32:35], v136 offset:0
s_add_u32 m0, s20, 24576
s_nop 0
ds_read_b32 v254, v255
v_mfma_f32_16x16x32_bf16 a[4:7], v[80:83], v[52:55], a[4:7]
ds_read_b64_tr_b16 v[0:1], v128 offset:0
v_mfma_f32_16x16x32_bf16 a[8:11], v[80:83], v[56:59], a[8:11]
ds_read_b64_tr_b16 v[2:3], v128 offset:8192
v_mfma_f32_16x16x32_bf16 a[12:15], v[80:83], v[60:63], a[12:15]
ds_read_b64_tr_b16 v[4:5], v129 offset:0
buffer_load_dwordx4 v141, s[4:7], s16 offen offset:0 sc1 lds
v_mfma_f32_16x16x32_bf16 a[16:19], v[80:83], v[64:67], a[16:19]
ds_read_b64_tr_b16 v[6:7], v129 offset:8192
v_mfma_f32_16x16x32_bf16 a[20:23], v[80:83], v[68:71], a[20:23]
ds_read_b64_tr_b16 v[8:9], v130 offset:0
v_mfma_f32_16x16x32_bf16 a[24:27], v[80:83], v[72:75], a[24:27]
ds_read_b64_tr_b16 v[10:11], v130 offset:8192
buffer_load_dwordx4 v142, s[4:7], s16 offen offset:1024 sc1 lds
v_mfma_f32_16x16x32_bf16 a[28:31], v[80:83], v[76:79], a[28:31]
ds_read_b64_tr_b16 v[12:13], v131 offset:0
v_mfma_f32_16x16x32_bf16 a[32:35], v[84:87], v[48:51], a[32:35]
ds_read_b64_tr_b16 v[14:15], v131 offset:8192
v_mfma_f32_16x16x32_bf16 a[36:39], v[84:87], v[52:55], a[36:39]
ds_read_b64_tr_b16 v[16:17], v132 offset:0
s_add_u32 s16, s16, 1024
v_mfma_f32_16x16x32_bf16 a[40:43], v[84:87], v[56:59], a[40:43]
ds_read_b64_tr_b16 v[18:19], v132 offset:8192
v_mfma_f32_16x16x32_bf16 a[44:47], v[84:87], v[60:63], a[44:47]
ds_read_b64_tr_b16 v[20:21], v133 offset:0
v_mfma_f32_16x16x32_bf16 a[48:51], v[84:87], v[64:67], a[48:51]
ds_read_b64_tr_b16 v[22:23], v133 offset:8192
s_add_u32 m0, s19, 49152
s_nop 0
v_mfma_f32_16x16x32_bf16 a[52:55], v[84:87], v[68:71], a[52:55]
ds_read_b64_tr_b16 v[24:25], v134 offset:0
v_mfma_f32_16x16x32_bf16 a[56:59], v[84:87], v[72:75], a[56:59]
ds_read_b64_tr_b16 v[26:27], v134 offset:8192
v_mfma_f32_16x16x32_bf16 a[60:63], v[84:87], v[76:79], a[60:63]
ds_read_b64_tr_b16 v[28:29], v135 offset:0
buffer_load_dwordx4 v137, s[8:11], s15 offen offset:0 lds
v_mfma_f32_16x16x32_bf16 a[64:67], v[88:91], v[48:51], a[64:67]
ds_read_b64_tr_b16 v[30:31], v135 offset:8192
v_mfma_f32_16x16x32_bf16 a[68:71], v[88:91], v[52:55], a[68:71]
ds_read_b128 v[36:39], v136 offset:1024
v_mfma_f32_16x16x32_bf16 a[72:75], v[88:91], v[56:59], a[72:75]
ds_read_b128 v[40:43], v136 offset:2048
buffer_load_dwordx4 v138, s[8:11], s15 offen offset:1024 lds
v_mfma_f32_16x16x32_bf16 a[76:79], v[88:91], v[60:63], a[76:79]
ds_read_b128 v[44:47], v136 offset:3072
v_mfma_f32_16x16x32_bf16 a[80:83], v[88:91], v[64:67], a[80:83]
s_waitcnt lgkmcnt(8)
v_mfma_f32_16x16x32_bf16 a[84:87], v[88:91], v[68:71], a[84:87]
buffer_load_dwordx4 v139, s[8:11], s15 offen offset:2048 lds
v_readfirstlane_b32 s62, v254
v_mfma_f32_16x16x32_bf16 a[88:91], v[88:91], v[72:75], a[88:91]
v_mfma_f32_16x16x32_bf16 a[92:95], v[88:91], v[76:79], a[92:95]
s_nop 1
v_mfma_f32_16x16x32_bf16 a[96:99], v[92:95], v[48:51], a[96:99]
buffer_load_dwordx4 v140, s[8:11], s15 offen offset:3072 lds
s_and_b32 s23, s62, 15
v_mfma_f32_16x16x32_bf16 a[100:103], v[92:95], v[52:55], a[100:103]
v_mfma_f32_16x16x32_bf16 a[104:107], v[92:95], v[56:59], a[104:107]
s_bfe_u32 s54, s62, 0x20004
v_mfma_f32_16x16x32_bf16 a[108:111], v[92:95], v[60:63], a[108:111]
s_add_u32 s15, s15, s17
s_bfe_u32 s24, s62, 0x80008
v_mfma_f32_16x16x32_bf16 a[112:115], v[92:95], v[64:67], a[112:115]
v_mfma_f32_16x16x32_bf16 a[116:119], v[92:95], v[68:71], a[116:119]
s_lshr_b32 s25, s62, 16
v_mfma_f32_16x16x32_bf16 a[120:123], v[92:95], v[72:75], a[120:123]
v_mfma_f32_16x16x32_bf16 a[124:127], v[92:95], v[76:79], a[124:127]
s_cmp_eq_u32 s54, 1
s_cselect_b32 s73, 3, -1
s_cbranch_scc1 main_kernel_w_c1_task
s_waitcnt lgkmcnt(0)
v_mfma_f32_16x16x32_bf16 a[0:3], v[32:35], v[0:3], a[0:3]
s_waitcnt vmcnt(12)
s_barrier
ds_read_b128 v[80:83], v136 offset:8192
v_mfma_f32_16x16x32_bf16 a[4:7], v[32:35], v[4:7], a[4:7]
ds_read_b64_tr_b16 v[48:49], v128 offset:16384
v_mfma_f32_16x16x32_bf16 a[8:11], v[32:35], v[8:11], a[8:11]
ds_read_b64_tr_b16 v[50:51], v128 offset:24576
v_mfma_f32_16x16x32_bf16 a[12:15], v[32:35], v[12:15], a[12:15]
ds_read_b64_tr_b16 v[52:53], v129 offset:16384
v_mfma_f32_16x16x32_bf16 a[16:19], v[32:35], v[16:19], a[16:19]
ds_read_b64_tr_b16 v[54:55], v129 offset:24576
v_mfma_f32_16x16x32_bf16 a[20:23], v[32:35], v[20:23], a[20:23]
ds_read_b64_tr_b16 v[56:57], v130 offset:16384
v_mfma_f32_16x16x32_bf16 a[24:27], v[32:35], v[24:27], a[24:27]
ds_read_b64_tr_b16 v[58:59], v130 offset:24576
v_mfma_f32_16x16x32_bf16 a[28:31], v[32:35], v[28:31], a[28:31]
ds_read_b64_tr_b16 v[60:61], v131 offset:16384
v_mfma_f32_16x16x32_bf16 a[32:35], v[36:39], v[0:3], a[32:35]
ds_read_b64_tr_b16 v[62:63], v131 offset:24576
v_mfma_f32_16x16x32_bf16 a[36:39], v[36:39], v[4:7], a[36:39]
ds_read_b64_tr_b16 v[64:65], v132 offset:16384
v_mfma_f32_16x16x32_bf16 a[40:43], v[36:39], v[8:11], a[40:43]
ds_read_b64_tr_b16 v[66:67], v132 offset:24576
v_mfma_f32_16x16x32_bf16 a[44:47], v[36:39], v[12:15], a[44:47]
ds_read_b64_tr_b16 v[68:69], v133 offset:16384
v_mfma_f32_16x16x32_bf16 a[48:51], v[36:39], v[16:19], a[48:51]
ds_read_b64_tr_b16 v[70:71], v133 offset:24576
v_mfma_f32_16x16x32_bf16 a[52:55], v[36:39], v[20:23], a[52:55]
ds_read_b64_tr_b16 v[72:73], v134 offset:16384
v_mfma_f32_16x16x32_bf16 a[56:59], v[36:39], v[24:27], a[56:59]
ds_read_b64_tr_b16 v[74:75], v134 offset:24576
v_mfma_f32_16x16x32_bf16 a[60:63], v[36:39], v[28:31], a[60:63]
ds_read_b64_tr_b16 v[76:77], v135 offset:16384
v_mfma_f32_16x16x32_bf16 a[64:67], v[40:43], v[0:3], a[64:67]
ds_read_b64_tr_b16 v[78:79], v135 offset:24576
v_mfma_f32_16x16x32_bf16 a[68:71], v[40:43], v[4:7], a[68:71]
ds_read_b128 v[84:87], v136 offset:9216
v_mfma_f32_16x16x32_bf16 a[72:75], v[40:43], v[8:11], a[72:75]
ds_read_b128 v[88:91], v136 offset:10240
v_mfma_f32_16x16x32_bf16 a[76:79], v[40:43], v[12:15], a[76:79]
ds_read_b128 v[92:95], v136 offset:11264
v_mfma_f32_16x16x32_bf16 a[80:83], v[40:43], v[16:19], a[80:83]
v_mfma_f32_16x16x32_bf16 a[84:87], v[40:43], v[20:23], a[84:87]
v_mfma_f32_16x16x32_bf16 a[88:91], v[40:43], v[24:27], a[88:91]
v_mfma_f32_16x16x32_bf16 a[92:95], v[40:43], v[28:31], a[92:95]
v_mfma_f32_16x16x32_bf16 a[96:99], v[44:47], v[0:3], a[96:99]
v_mfma_f32_16x16x32_bf16 a[100:103], v[44:47], v[4:7], a[100:103]
v_mfma_f32_16x16x32_bf16 a[104:107], v[44:47], v[8:11], a[104:107]
v_mfma_f32_16x16x32_bf16 a[108:111], v[44:47], v[12:15], a[108:111]
v_mfma_f32_16x16x32_bf16 a[112:115], v[44:47], v[16:19], a[112:115]
v_mfma_f32_16x16x32_bf16 a[116:119], v[44:47], v[20:23], a[116:119]
v_mfma_f32_16x16x32_bf16 a[120:123], v[44:47], v[24:27], a[120:123]
v_mfma_f32_16x16x32_bf16 a[124:127], v[44:47], v[28:31], a[124:127]
s_waitcnt lgkmcnt(0)
v_mfma_f32_16x16x32_bf16 a[0:3], v[80:83], v[48:51], a[0:3]
s_waitcnt vmcnt(6)
s_barrier
ds_read_b128 v[32:35], v136 offset:16384
v_mfma_f32_16x16x32_bf16 a[4:7], v[80:83], v[52:55], a[4:7]
ds_read_b64_tr_b16 v[0:1], v128 offset:32768
v_mfma_f32_16x16x32_bf16 a[8:11], v[80:83], v[56:59], a[8:11]
ds_read_b64_tr_b16 v[2:3], v128 offset:40960
v_mfma_f32_16x16x32_bf16 a[12:15], v[80:83], v[60:63], a[12:15]
ds_read_b64_tr_b16 v[4:5], v129 offset:32768
v_mfma_f32_16x16x32_bf16 a[16:19], v[80:83], v[64:67], a[16:19]
ds_read_b64_tr_b16 v[6:7], v129 offset:40960
v_mfma_f32_16x16x32_bf16 a[20:23], v[80:83], v[68:71], a[20:23]
ds_read_b64_tr_b16 v[8:9], v130 offset:32768
v_mfma_f32_16x16x32_bf16 a[24:27], v[80:83], v[72:75], a[24:27]
ds_read_b64_tr_b16 v[10:11], v130 offset:40960
v_mfma_f32_16x16x32_bf16 a[28:31], v[80:83], v[76:79], a[28:31]
ds_read_b64_tr_b16 v[12:13], v131 offset:32768
v_mfma_f32_16x16x32_bf16 a[32:35], v[84:87], v[48:51], a[32:35]
ds_read_b64_tr_b16 v[14:15], v131 offset:40960
v_mfma_f32_16x16x32_bf16 a[36:39], v[84:87], v[52:55], a[36:39]
ds_read_b64_tr_b16 v[16:17], v132 offset:32768
v_mfma_f32_16x16x32_bf16 a[40:43], v[84:87], v[56:59], a[40:43]
ds_read_b64_tr_b16 v[18:19], v132 offset:40960
v_mfma_f32_16x16x32_bf16 a[44:47], v[84:87], v[60:63], a[44:47]
ds_read_b64_tr_b16 v[20:21], v133 offset:32768
v_mfma_f32_16x16x32_bf16 a[48:51], v[84:87], v[64:67], a[48:51]
ds_read_b64_tr_b16 v[22:23], v133 offset:40960
v_mfma_f32_16x16x32_bf16 a[52:55], v[84:87], v[68:71], a[52:55]
ds_read_b64_tr_b16 v[24:25], v134 offset:32768
v_mfma_f32_16x16x32_bf16 a[56:59], v[84:87], v[72:75], a[56:59]
ds_read_b64_tr_b16 v[26:27], v134 offset:40960
v_mfma_f32_16x16x32_bf16 a[60:63], v[84:87], v[76:79], a[60:63]
ds_read_b64_tr_b16 v[28:29], v135 offset:32768
v_mfma_f32_16x16x32_bf16 a[64:67], v[88:91], v[48:51], a[64:67]
ds_read_b64_tr_b16 v[30:31], v135 offset:40960
v_mfma_f32_16x16x32_bf16 a[68:71], v[88:91], v[52:55], a[68:71]
ds_read_b128 v[36:39], v136 offset:17408
v_mfma_f32_16x16x32_bf16 a[72:75], v[88:91], v[56:59], a[72:75]
ds_read_b128 v[40:43], v136 offset:18432
v_mfma_f32_16x16x32_bf16 a[76:79], v[88:91], v[60:63], a[76:79]
ds_read_b128 v[44:47], v136 offset:19456
v_mfma_f32_16x16x32_bf16 a[80:83], v[88:91], v[64:67], a[80:83]
v_mfma_f32_16x16x32_bf16 a[84:87], v[88:91], v[68:71], a[84:87]
v_mfma_f32_16x16x32_bf16 a[88:91], v[88:91], v[72:75], a[88:91]
v_mfma_f32_16x16x32_bf16 a[92:95], v[88:91], v[76:79], a[92:95]
v_mfma_f32_16x16x32_bf16 a[96:99], v[92:95], v[48:51], a[96:99]
v_mfma_f32_16x16x32_bf16 a[100:103], v[92:95], v[52:55], a[100:103]
v_mfma_f32_16x16x32_bf16 a[104:107], v[92:95], v[56:59], a[104:107]
v_mfma_f32_16x16x32_bf16 a[108:111], v[92:95], v[60:63], a[108:111]
v_mfma_f32_16x16x32_bf16 a[112:115], v[92:95], v[64:67], a[112:115]
v_mfma_f32_16x16x32_bf16 a[116:119], v[92:95], v[68:71], a[116:119]
v_mfma_f32_16x16x32_bf16 a[120:123], v[92:95], v[72:75], a[120:123]
v_mfma_f32_16x16x32_bf16 a[124:127], v[92:95], v[76:79], a[124:127]
s_waitcnt lgkmcnt(0)
v_mfma_f32_16x16x32_bf16 a[0:3], v[32:35], v[0:3], a[0:3]
s_waitcnt vmcnt(0)
s_barrier
ds_read_b128 v[80:83], v136 offset:24576
v_mfma_f32_16x16x32_bf16 a[4:7], v[32:35], v[4:7], a[4:7]
ds_read_b64_tr_b16 v[48:49], v128 offset:49152
v_mfma_f32_16x16x32_bf16 a[8:11], v[32:35], v[8:11], a[8:11]
ds_read_b64_tr_b16 v[50:51], v128 offset:57344
v_mfma_f32_16x16x32_bf16 a[12:15], v[32:35], v[12:15], a[12:15]
ds_read_b64_tr_b16 v[52:53], v129 offset:49152
v_mfma_f32_16x16x32_bf16 a[16:19], v[32:35], v[16:19], a[16:19]
ds_read_b64_tr_b16 v[54:55], v129 offset:57344
v_mfma_f32_16x16x32_bf16 a[20:23], v[32:35], v[20:23], a[20:23]
ds_read_b64_tr_b16 v[56:57], v130 offset:49152
v_mfma_f32_16x16x32_bf16 a[24:27], v[32:35], v[24:27], a[24:27]
ds_read_b64_tr_b16 v[58:59], v130 offset:57344
v_mfma_f32_16x16x32_bf16 a[28:31], v[32:35], v[28:31], a[28:31]
ds_read_b64_tr_b16 v[60:61], v131 offset:49152
v_mfma_f32_16x16x32_bf16 a[32:35], v[36:39], v[0:3], a[32:35]
ds_read_b64_tr_b16 v[62:63], v131 offset:57344
v_mfma_f32_16x16x32_bf16 a[36:39], v[36:39], v[4:7], a[36:39]
ds_read_b64_tr_b16 v[64:65], v132 offset:49152
v_mfma_f32_16x16x32_bf16 a[40:43], v[36:39], v[8:11], a[40:43]
ds_read_b64_tr_b16 v[66:67], v132 offset:57344
v_mfma_f32_16x16x32_bf16 a[44:47], v[36:39], v[12:15], a[44:47]
ds_read_b64_tr_b16 v[68:69], v133 offset:49152
v_mfma_f32_16x16x32_bf16 a[48:51], v[36:39], v[16:19], a[48:51]
ds_read_b64_tr_b16 v[70:71], v133 offset:57344
v_mfma_f32_16x16x32_bf16 a[52:55], v[36:39], v[20:23], a[52:55]
ds_read_b64_tr_b16 v[72:73], v134 offset:49152
v_mfma_f32_16x16x32_bf16 a[56:59], v[36:39], v[24:27], a[56:59]
ds_read_b64_tr_b16 v[74:75], v134 offset:57344
v_mfma_f32_16x16x32_bf16 a[60:63], v[36:39], v[28:31], a[60:63]
ds_read_b64_tr_b16 v[76:77], v135 offset:49152
v_mfma_f32_16x16x32_bf16 a[64:67], v[40:43], v[0:3], a[64:67]
ds_read_b64_tr_b16 v[78:79], v135 offset:57344
v_mfma_f32_16x16x32_bf16 a[68:71], v[40:43], v[4:7], a[68:71]
ds_read_b128 v[84:87], v136 offset:25600
v_mfma_f32_16x16x32_bf16 a[72:75], v[40:43], v[8:11], a[72:75]
ds_read_b128 v[88:91], v136 offset:26624
v_mfma_f32_16x16x32_bf16 a[76:79], v[40:43], v[12:15], a[76:79]
ds_read_b128 v[92:95], v136 offset:27648
v_mfma_f32_16x16x32_bf16 a[80:83], v[40:43], v[16:19], a[80:83]
v_mfma_f32_16x16x32_bf16 a[84:87], v[40:43], v[20:23], a[84:87]
v_mfma_f32_16x16x32_bf16 a[88:91], v[40:43], v[24:27], a[88:91]
v_mfma_f32_16x16x32_bf16 a[92:95], v[40:43], v[28:31], a[92:95]
v_mfma_f32_16x16x32_bf16 a[96:99], v[44:47], v[0:3], a[96:99]
v_mfma_f32_16x16x32_bf16 a[100:103], v[44:47], v[4:7], a[100:103]
v_mfma_f32_16x16x32_bf16 a[104:107], v[44:47], v[8:11], a[104:107]
v_mfma_f32_16x16x32_bf16 a[108:111], v[44:47], v[12:15], a[108:111]
v_mfma_f32_16x16x32_bf16 a[112:115], v[44:47], v[16:19], a[112:115]
v_mfma_f32_16x16x32_bf16 a[116:119], v[44:47], v[20:23], a[116:119]
v_mfma_f32_16x16x32_bf16 a[120:123], v[44:47], v[24:27], a[120:123]
v_mfma_f32_16x16x32_bf16 a[124:127], v[44:47], v[28:31], a[124:127]
s_waitcnt lgkmcnt(0)
v_mfma_f32_16x16x32_bf16 a[0:3], v[80:83], v[48:51], a[0:3]
s_barrier
v_mfma_f32_16x16x32_bf16 a[4:7], v[80:83], v[52:55], a[4:7]
v_mfma_f32_16x16x32_bf16 a[8:11], v[80:83], v[56:59], a[8:11]
v_mfma_f32_16x16x32_bf16 a[12:15], v[80:83], v[60:63], a[12:15]
v_mfma_f32_16x16x32_bf16 a[16:19], v[80:83], v[64:67], a[16:19]
v_mfma_f32_16x16x32_bf16 a[20:23], v[80:83], v[68:71], a[20:23]
v_mfma_f32_16x16x32_bf16 a[24:27], v[80:83], v[72:75], a[24:27]
v_mfma_f32_16x16x32_bf16 a[28:31], v[80:83], v[76:79], a[28:31]
v_mfma_f32_16x16x32_bf16 a[32:35], v[84:87], v[48:51], a[32:35]
v_mfma_f32_16x16x32_bf16 a[36:39], v[84:87], v[52:55], a[36:39]
v_mfma_f32_16x16x32_bf16 a[40:43], v[84:87], v[56:59], a[40:43]
v_mfma_f32_16x16x32_bf16 a[44:47], v[84:87], v[60:63], a[44:47]
v_mfma_f32_16x16x32_bf16 a[48:51], v[84:87], v[64:67], a[48:51]
v_mfma_f32_16x16x32_bf16 a[52:55], v[84:87], v[68:71], a[52:55]
v_mfma_f32_16x16x32_bf16 a[56:59], v[84:87], v[72:75], a[56:59]
v_mfma_f32_16x16x32_bf16 a[60:63], v[84:87], v[76:79], a[60:63]
v_mfma_f32_16x16x32_bf16 a[64:67], v[88:91], v[48:51], a[64:67]
v_mfma_f32_16x16x32_bf16 a[68:71], v[88:91], v[52:55], a[68:71]
v_mfma_f32_16x16x32_bf16 a[72:75], v[88:91], v[56:59], a[72:75]
v_mfma_f32_16x16x32_bf16 a[76:79], v[88:91], v[60:63], a[76:79]
v_mfma_f32_16x16x32_bf16 a[80:83], v[88:91], v[64:67], a[80:83]
v_mfma_f32_16x16x32_bf16 a[84:87], v[88:91], v[68:71], a[84:87]
v_mfma_f32_16x16x32_bf16 a[88:91], v[88:91], v[72:75], a[88:91]
v_mfma_f32_16x16x32_bf16 a[92:95], v[88:91], v[76:79], a[92:95]
v_mfma_f32_16x16x32_bf16 a[96:99], v[92:95], v[48:51], a[96:99]
v_mfma_f32_16x16x32_bf16 a[100:103], v[92:95], v[52:55], a[100:103]
v_mfma_f32_16x16x32_bf16 a[104:107], v[92:95], v[56:59], a[104:107]
v_mfma_f32_16x16x32_bf16 a[108:111], v[92:95], v[60:63], a[108:111]
v_mfma_f32_16x16x32_bf16 a[112:115], v[92:95], v[64:67], a[112:115]
v_mfma_f32_16x16x32_bf16 a[116:119], v[92:95], v[68:71], a[116:119]
v_mfma_f32_16x16x32_bf16 a[120:123], v[92:95], v[72:75], a[120:123]
v_mfma_f32_16x16x32_bf16 a[124:127], v[92:95], v[76:79], a[124:127]
s_cmp_lg_u32 s62, -4
s_cbranch_scc1 main_kernel_w_gemm
s_branch main_kernel_w_slow
main_kernel_w_c1_v_ev:
s_mov_b32 s55, 1
s_cmp_eq_u32 s56, 0
s_cbranch_scc1 main_kernel_w_c1_v_et
s_bfm_b64 exec, s0, 0
buffer_store_dword v244, v248, s[4:7], s59 offen sc1
s_mov_b64 exec, -1
s_mov_b32 s56, 0
main_kernel_w_c1_v_et:
s_cmp_lg_u32 s18, 1
s_cbranch_scc1 main_kernel_w_c1_v_loop
s_lshl_b32 s32, s27, 8
s_add_u32 s32, s32, 0x841e000
s_mov_b64 exec, 1
v_mov_b32 v249, 1
buffer_atomic_add v249, off, s[4:7], s32 sc0 sc1
s_mov_b64 exec, -1
s_branch main_kernel_w_c1_v_loop
main_kernel_w_epn:
s_waitcnt lgkmcnt(0)
s_branch main_kernel_w_epw
main_kernel_w_slow:
s_mov_b32 s58, -1
main_kernel_w_epw:
s_nop 5
main_kernel_w_epi:
s_cmp_eq_u32 s56, 2
s_cbranch_scc1 main_kernel_w_e2
s_cmp_eq_u32 s56, 3
s_cbranch_scc1 main_kernel_w_e3
s_cmp_eq_u32 s56, 4
s_cbranch_scc1 main_kernel_w_e4
s_cmp_eq_u32 s56, 5
s_cbranch_scc1 main_kernel_w_e5
s_cmp_eq_u32 s56, 6
s_cbranch_scc1 main_kernel_w_e6
s_cmp_eq_u32 s56, 7
s_cbranch_scc1 main_kernel_w_e7
s_cmp_eq_u32 s56, 8
s_cbranch_scc1 main_kernel_w_e8
s_cmp_eq_u32 s56, 9
s_cbranch_scc1 main_kernel_w_e9
s_cmp_eq_u32 s56, 10
s_cbranch_scc1 main_kernel_w_e10
main_kernel_w_e1:
s_mov_b32 s53, s1
v_mul_f32 v64, 0x3e0293ee, v64
v_mul_f32 v65, 0x3e0293ee, v65
v_mul_f32 v66, 0x3e0293ee, v66
v_mul_f32 v67, 0x3e0293ee, v67
v_mul_f32 v68, 0x3e0293ee, v68
v_mul_f32 v69, 0x3e0293ee, v69
v_mul_f32 v70, 0x3e0293ee, v70
v_mul_f32 v71, 0x3e0293ee, v71
v_cvt_pk_bf16_f32 v16, v64, v65
v_cvt_pk_bf16_f32 v17, v66, v67
v_cvt_pk_bf16_f32 v18, v68, v69
v_cvt_pk_bf16_f32 v19, v70, v71
buffer_store_dwordx4 v[16:19], v251, s[4:7], s53 offen offset:0 sc1
v_mul_f32 v72, 0x3e0293ee, v72
v_mul_f32 v73, 0x3e0293ee, v73
v_mul_f32 v74, 0x3e0293ee, v74
v_mul_f32 v75, 0x3e0293ee, v75
v_mul_f32 v76, 0x3e0293ee, v76
v_mul_f32 v77, 0x3e0293ee, v77
v_mul_f32 v78, 0x3e0293ee, v78
v_mul_f32 v79, 0x3e0293ee, v79
v_cvt_pk_bf16_f32 v36, v72, v73
v_cvt_pk_bf16_f32 v37, v74, v75
v_cvt_pk_bf16_f32 v38, v76, v77
v_cvt_pk_bf16_f32 v39, v78, v79
buffer_store_dwordx4 v[36:39], v251, s[4:7], s53 offen offset:1024 sc1
s_add_u32 s53, s53, s2
v_mul_f32 v80, 0x3e0293ee, v80
v_mul_f32 v81, 0x3e0293ee, v81
v_mul_f32 v82, 0x3e0293ee, v82
v_mul_f32 v83, 0x3e0293ee, v83
v_mul_f32 v84, 0x3e0293ee, v84
v_mul_f32 v85, 0x3e0293ee, v85
v_mul_f32 v86, 0x3e0293ee, v86
v_mul_f32 v87, 0x3e0293ee, v87
v_cvt_pk_bf16_f32 v56, v80, v81
v_cvt_pk_bf16_f32 v57, v82, v83
v_cvt_pk_bf16_f32 v58, v84, v85
v_cvt_pk_bf16_f32 v59, v86, v87
buffer_store_dwordx4 v[56:59], v251, s[4:7], s53 offen offset:0 sc1
v_mul_f32 v88, 0x3e0293ee, v88
v_mul_f32 v89, 0x3e0293ee, v89
v_mul_f32 v90, 0x3e0293ee, v90
v_mul_f32 v91, 0x3e0293ee, v91
v_mul_f32 v92, 0x3e0293ee, v92
v_mul_f32 v93, 0x3e0293ee, v93
v_mul_f32 v94, 0x3e0293ee, v94
v_mul_f32 v95, 0x3e0293ee, v95
v_cvt_pk_bf16_f32 v16, v88, v89
v_cvt_pk_bf16_f32 v17, v90, v91
v_cvt_pk_bf16_f32 v18, v92, v93
v_cvt_pk_bf16_f32 v19, v94, v95
buffer_store_dwordx4 v[16:19], v251, s[4:7], s53 offen offset:1024 sc1
s_add_u32 s53, s53, s2
v_mul_f32 v96, 0x3e0293ee, v96
v_mul_f32 v97, 0x3e0293ee, v97
v_mul_f32 v98, 0x3e0293ee, v98
v_mul_f32 v99, 0x3e0293ee, v99
v_mul_f32 v100, 0x3e0293ee, v100
v_mul_f32 v101, 0x3e0293ee, v101
v_mul_f32 v102, 0x3e0293ee, v102
v_mul_f32 v103, 0x3e0293ee, v103
v_cvt_pk_bf16_f32 v36, v96, v97
v_cvt_pk_bf16_f32 v37, v98, v99
v_cvt_pk_bf16_f32 v38, v100, v101
v_cvt_pk_bf16_f32 v39, v102, v103
buffer_store_dwordx4 v[36:39], v251, s[4:7], s53 offen offset:0 sc1
v_mul_f32 v104, 0x3e0293ee, v104
v_mul_f32 v105, 0x3e0293ee, v105
v_mul_f32 v106, 0x3e0293ee, v106
v_mul_f32 v107, 0x3e0293ee, v107
v_mul_f32 v108, 0x3e0293ee, v108
v_mul_f32 v109, 0x3e0293ee, v109
v_mul_f32 v110, 0x3e0293ee, v110
v_mul_f32 v111, 0x3e0293ee, v111
v_cvt_pk_bf16_f32 v56, v104, v105
v_cvt_pk_bf16_f32 v57, v106, v107
v_cvt_pk_bf16_f32 v58, v108, v109
v_cvt_pk_bf16_f32 v59, v110, v111
buffer_store_dwordx4 v[56:59], v251, s[4:7], s53 offen offset:1024 sc1
s_add_u32 s53, s53, s2
v_mul_f32 v112, 0x3e0293ee, v112
v_mul_f32 v113, 0x3e0293ee, v113
v_mul_f32 v114, 0x3e0293ee, v114
v_mul_f32 v115, 0x3e0293ee, v115
v_mul_f32 v116, 0x3e0293ee, v116
v_mul_f32 v117, 0x3e0293ee, v117
v_mul_f32 v118, 0x3e0293ee, v118
v_mul_f32 v119, 0x3e0293ee, v119
v_cvt_pk_bf16_f32 v16, v112, v113
v_cvt_pk_bf16_f32 v17, v114, v115
v_cvt_pk_bf16_f32 v18, v116, v117
v_cvt_pk_bf16_f32 v19, v118, v119
buffer_store_dwordx4 v[16:19], v251, s[4:7], s53 offen offset:0 sc1
v_mul_f32 v120, 0x3e0293ee, v120
v_mul_f32 v121, 0x3e0293ee, v121
v_mul_f32 v122, 0x3e0293ee, v122
v_mul_f32 v123, 0x3e0293ee, v123
v_mul_f32 v124, 0x3e0293ee, v124
v_mul_f32 v125, 0x3e0293ee, v125
v_mul_f32 v126, 0x3e0293ee, v126
v_mul_f32 v127, 0x3e0293ee, v127
v_cvt_pk_bf16_f32 v36, v120, v121
v_cvt_pk_bf16_f32 v37, v122, v123
v_cvt_pk_bf16_f32 v38, v124, v125
v_cvt_pk_bf16_f32 v39, v126, v127
buffer_store_dwordx4 v[36:39], v251, s[4:7], s53 offen offset:1024 sc1
s_branch main_kernel_w_ee
main_kernel_w_e2:
s_mov_b32 s53, s1
v_cvt_pk_bf16_f32 v8, v64, v65
v_cvt_pk_bf16_f32 v9, v66, v67
v_cvt_pk_bf16_f32 v10, v80, v81
v_cvt_pk_bf16_f32 v11, v82, v83
buffer_store_dwordx4 v[8:11], v251, s[4:7], s53 offen offset:0 sc1
v_cvt_pk_bf16_f32 v24, v68, v69
v_cvt_pk_bf16_f32 v25, v70, v71
v_cvt_pk_bf16_f32 v26, v84, v85
v_cvt_pk_bf16_f32 v27, v86, v87
buffer_store_dwordx4 v[24:27], v251, s[4:7], s53 offen offset:1024 sc1
v_cvt_pk_bf16_f32 v40, v72, v73
v_cvt_pk_bf16_f32 v41, v74, v75
v_cvt_pk_bf16_f32 v42, v88, v89
v_cvt_pk_bf16_f32 v43, v90, v91
buffer_store_dwordx4 v[40:43], v251, s[4:7], s53 offen offset:2048 sc1
v_cvt_pk_bf16_f32 v56, v76, v77
v_cvt_pk_bf16_f32 v57, v78, v79
v_cvt_pk_bf16_f32 v58, v92, v93
v_cvt_pk_bf16_f32 v59, v94, v95
buffer_store_dwordx4 v[56:59], v251, s[4:7], s53 offen offset:3072 sc1
s_add_u32 s53, s53, 262144
v_cvt_pk_bf16_f32 v8, v96, v97
v_cvt_pk_bf16_f32 v9, v98, v99
v_cvt_pk_bf16_f32 v10, v112, v113
v_cvt_pk_bf16_f32 v11, v114, v115
buffer_store_dwordx4 v[8:11], v251, s[4:7], s53 offen offset:0 sc1
v_cvt_pk_bf16_f32 v24, v100, v101
v_cvt_pk_bf16_f32 v25, v102, v103
v_cvt_pk_bf16_f32 v26, v116, v117
v_cvt_pk_bf16_f32 v27, v118, v119
buffer_store_dwordx4 v[24:27], v251, s[4:7], s53 offen offset:1024 sc1
v_cvt_pk_bf16_f32 v40, v104, v105
v_cvt_pk_bf16_f32 v41, v106, v107
v_cvt_pk_bf16_f32 v42, v120, v121
v_cvt_pk_bf16_f32 v43, v122, v123
buffer_store_dwordx4 v[40:43], v251, s[4:7], s53 offen offset:2048 sc1
v_cvt_pk_bf16_f32 v56, v108, v109
v_cvt_pk_bf16_f32 v57, v110, v111
v_cvt_pk_bf16_f32 v58, v124, v125
v_cvt_pk_bf16_f32 v59, v126, v127
buffer_store_dwordx4 v[56:59], v251, s[4:7], s53 offen offset:3072 sc1
s_add_u32 s53, s53, 262144
s_branch main_kernel_w_ee
main_kernel_w_e3:
s_mov_b32 s53, s1
v_lshlrev_b32 v8, 16, v192
v_and_b32 v9, 0xffff0000, v192
v_lshlrev_b32 v10, 16, v193
v_and_b32 v11, 0xffff0000, v193
v_lshlrev_b32 v12, 16, v194
v_and_b32 v13, 0xffff0000, v194
v_lshlrev_b32 v14, 16, v195
v_and_b32 v15, 0xffff0000, v195
v_pk_add_f32 v[64:65], v[64:65], v[8:9]
v_pk_add_f32 v[66:67], v[66:67], v[10:11]
v_pk_add_f32 v[68:69], v[68:69], v[12:13]
v_pk_add_f32 v[70:71], v[70:71], v[14:15]
v_cvt_pk_bf16_f32 v16, v64, v65
v_cvt_pk_bf16_f32 v17, v66, v67
v_cvt_pk_bf16_f32 v18, v68, v69
v_cvt_pk_bf16_f32 v19, v70, v71
buffer_store_dwordx4 v[16:19], v251, s[4:7], s53 offen offset:0 sc1
v_lshlrev_b32 v28, 16, v196
v_and_b32 v29, 0xffff0000, v196
v_lshlrev_b32 v30, 16, v197
v_and_b32 v31, 0xffff0000, v197
v_lshlrev_b32 v32, 16, v198
v_and_b32 v33, 0xffff0000, v198
v_lshlrev_b32 v34, 16, v199
v_and_b32 v35, 0xffff0000, v199
v_pk_add_f32 v[72:73], v[72:73], v[28:29]
v_pk_add_f32 v[74:75], v[74:75], v[30:31]
v_pk_add_f32 v[76:77], v[76:77], v[32:33]
v_pk_add_f32 v[78:79], v[78:79], v[34:35]
v_cvt_pk_bf16_f32 v36, v72, v73
v_cvt_pk_bf16_f32 v37, v74, v75
v_cvt_pk_bf16_f32 v38, v76, v77
v_cvt_pk_bf16_f32 v39, v78, v79
buffer_store_dwordx4 v[36:39], v251, s[4:7], s53 offen offset:1024 sc1
s_add_u32 s53, s53, s2
v_lshlrev_b32 v48, 16, v200
v_and_b32 v49, 0xffff0000, v200
v_lshlrev_b32 v50, 16, v201
v_and_b32 v51, 0xffff0000, v201
v_lshlrev_b32 v52, 16, v202
v_and_b32 v53, 0xffff0000, v202
v_lshlrev_b32 v54, 16, v203
v_and_b32 v55, 0xffff0000, v203
v_pk_add_f32 v[80:81], v[80:81], v[48:49]
v_pk_add_f32 v[82:83], v[82:83], v[50:51]
v_pk_add_f32 v[84:85], v[84:85], v[52:53]
v_pk_add_f32 v[86:87], v[86:87], v[54:55]
v_cvt_pk_bf16_f32 v56, v80, v81
v_cvt_pk_bf16_f32 v57, v82, v83
v_cvt_pk_bf16_f32 v58, v84, v85
v_cvt_pk_bf16_f32 v59, v86, v87
buffer_store_dwordx4 v[56:59], v251, s[4:7], s53 offen offset:0 sc1
v_lshlrev_b32 v8, 16, v204
v_and_b32 v9, 0xffff0000, v204
v_lshlrev_b32 v10, 16, v205
v_and_b32 v11, 0xffff0000, v205
v_lshlrev_b32 v12, 16, v206
v_and_b32 v13, 0xffff0000, v206
v_lshlrev_b32 v14, 16, v207
v_and_b32 v15, 0xffff0000, v207
v_pk_add_f32 v[88:89], v[88:89], v[8:9]
v_pk_add_f32 v[90:91], v[90:91], v[10:11]
v_pk_add_f32 v[92:93], v[92:93], v[12:13]
v_pk_add_f32 v[94:95], v[94:95], v[14:15]
v_cvt_pk_bf16_f32 v16, v88, v89
v_cvt_pk_bf16_f32 v17, v90, v91
v_cvt_pk_bf16_f32 v18, v92, v93
v_cvt_pk_bf16_f32 v19, v94, v95
buffer_store_dwordx4 v[16:19], v251, s[4:7], s53 offen offset:1024 sc1
s_add_u32 s53, s53, s2
v_lshlrev_b32 v28, 16, v208
v_and_b32 v29, 0xffff0000, v208
v_lshlrev_b32 v30, 16, v209
v_and_b32 v31, 0xffff0000, v209
v_lshlrev_b32 v32, 16, v210
v_and_b32 v33, 0xffff0000, v210
v_lshlrev_b32 v34, 16, v211
v_and_b32 v35, 0xffff0000, v211
v_pk_add_f32 v[96:97], v[96:97], v[28:29]
v_pk_add_f32 v[98:99], v[98:99], v[30:31]
v_pk_add_f32 v[100:101], v[100:101], v[32:33]
v_pk_add_f32 v[102:103], v[102:103], v[34:35]
v_cvt_pk_bf16_f32 v36, v96, v97
v_cvt_pk_bf16_f32 v37, v98, v99
v_cvt_pk_bf16_f32 v38, v100, v101
v_cvt_pk_bf16_f32 v39, v102, v103
buffer_store_dwordx4 v[36:39], v251, s[4:7], s53 offen offset:0 sc1
v_lshlrev_b32 v48, 16, v212
v_and_b32 v49, 0xffff0000, v212
v_lshlrev_b32 v50, 16, v213
v_and_b32 v51, 0xffff0000, v213
v_lshlrev_b32 v52, 16, v214
v_and_b32 v53, 0xffff0000, v214
v_lshlrev_b32 v54, 16, v215
v_and_b32 v55, 0xffff0000, v215
v_pk_add_f32 v[104:105], v[104:105], v[48:49]
v_pk_add_f32 v[106:107], v[106:107], v[50:51]
v_pk_add_f32 v[108:109], v[108:109], v[52:53]
v_pk_add_f32 v[110:111], v[110:111], v[54:55]
v_cvt_pk_bf16_f32 v56, v104, v105
v_cvt_pk_bf16_f32 v57, v106, v107
v_cvt_pk_bf16_f32 v58, v108, v109
v_cvt_pk_bf16_f32 v59, v110, v111
buffer_store_dwordx4 v[56:59], v251, s[4:7], s53 offen offset:1024 sc1
s_add_u32 s53, s53, s2
v_lshlrev_b32 v8, 16, v216
v_and_b32 v9, 0xffff0000, v216
v_lshlrev_b32 v10, 16, v217
v_and_b32 v11, 0xffff0000, v217
v_lshlrev_b32 v12, 16, v218
v_and_b32 v13, 0xffff0000, v218
v_lshlrev_b32 v14, 16, v219
v_and_b32 v15, 0xffff0000, v219
v_pk_add_f32 v[112:113], v[112:113], v[8:9]
v_pk_add_f32 v[114:115], v[114:115], v[10:11]
v_pk_add_f32 v[116:117], v[116:117], v[12:13]
v_pk_add_f32 v[118:119], v[118:119], v[14:15]
v_cvt_pk_bf16_f32 v16, v112, v113
v_cvt_pk_bf16_f32 v17, v114, v115
v_cvt_pk_bf16_f32 v18, v116, v117
v_cvt_pk_bf16_f32 v19, v118, v119
buffer_store_dwordx4 v[16:19], v251, s[4:7], s53 offen offset:0 sc1
v_lshlrev_b32 v28, 16, v220
v_and_b32 v29, 0xffff0000, v220
v_lshlrev_b32 v30, 16, v221
v_and_b32 v31, 0xffff0000, v221
v_lshlrev_b32 v32, 16, v222
v_and_b32 v33, 0xffff0000, v222
v_lshlrev_b32 v34, 16, v223
v_and_b32 v35, 0xffff0000, v223
v_pk_add_f32 v[120:121], v[120:121], v[28:29]
v_pk_add_f32 v[122:123], v[122:123], v[30:31]
v_pk_add_f32 v[124:125], v[124:125], v[32:33]
v_pk_add_f32 v[126:127], v[126:127], v[34:35]
v_cvt_pk_bf16_f32 v36, v120, v121
v_cvt_pk_bf16_f32 v37, v122, v123
v_cvt_pk_bf16_f32 v38, v124, v125
v_cvt_pk_bf16_f32 v39, v126, v127
buffer_store_dwordx4 v[36:39], v251, s[4:7], s53 offen offset:1024 sc1
s_branch main_kernel_w_ee
main_kernel_w_e4:
s_mov_b32 s53, s1
v_lshlrev_b32 v8, 16, v192
v_and_b32 v9, 0xffff0000, v192
v_lshlrev_b32 v10, 16, v193
v_and_b32 v11, 0xffff0000, v193
v_lshlrev_b32 v12, 16, v194
v_and_b32 v13, 0xffff0000, v194
v_lshlrev_b32 v14, 16, v195
v_and_b32 v15, 0xffff0000, v195
v_pk_add_f32 v[64:65], v[64:65], v[8:9]
v_pk_add_f32 v[66:67], v[66:67], v[10:11]
v_pk_add_f32 v[68:69], v[68:69], v[12:13]
v_pk_add_f32 v[70:71], v[70:71], v[14:15]
v_pk_mul_f32 v[8:9], v[64:65], v[246:247]
v_pk_mul_f32 v[10:11], v[66:67], v[246:247]
v_pk_mul_f32 v[12:13], v[68:69], v[246:247]
v_pk_mul_f32 v[14:15], v[70:71], v[246:247]
v_exp_f32 v8, v8
v_exp_f32 v9, v9
v_exp_f32 v10, v10
v_exp_f32 v11, v11
v_exp_f32 v12, v12
v_exp_f32 v13, v13
v_exp_f32 v14, v14
v_exp_f32 v15, v15
v_pk_add_f32 v[8:9], v[8:9], v[244:245]
v_pk_add_f32 v[10:11], v[10:11], v[244:245]
v_pk_add_f32 v[12:13], v[12:13], v[244:245]
v_pk_add_f32 v[14:15], v[14:15], v[244:245]
v_rcp_f32 v8, v8
v_rcp_f32 v9, v9
v_rcp_f32 v10, v10
v_rcp_f32 v11, v11
v_rcp_f32 v12, v12
v_rcp_f32 v13, v13
v_rcp_f32 v14, v14
v_rcp_f32 v15, v15
v_pk_mul_f32 v[64:65], v[8:9], v[64:65]
v_pk_mul_f32 v[66:67], v[10:11], v[66:67]
v_pk_mul_f32 v[68:69], v[12:13], v[68:69]
v_pk_mul_f32 v[70:71], v[14:15], v[70:71]
v_cvt_pk_bf16_f32 v16, v64, v65
v_cvt_pk_bf16_f32 v17, v66, v67
v_cvt_pk_bf16_f32 v18, v68, v69
v_cvt_pk_bf16_f32 v19, v70, v71
buffer_store_dwordx4 v[16:19], v251, s[4:7], s53 offen offset:0 sc1
v_lshlrev_b32 v28, 16, v196
v_and_b32 v29, 0xffff0000, v196
v_lshlrev_b32 v30, 16, v197
v_and_b32 v31, 0xffff0000, v197
v_lshlrev_b32 v32, 16, v198
v_and_b32 v33, 0xffff0000, v198
v_lshlrev_b32 v34, 16, v199
v_and_b32 v35, 0xffff0000, v199
v_pk_add_f32 v[72:73], v[72:73], v[28:29]
v_pk_add_f32 v[74:75], v[74:75], v[30:31]
v_pk_add_f32 v[76:77], v[76:77], v[32:33]
v_pk_add_f32 v[78:79], v[78:79], v[34:35]
v_pk_mul_f32 v[28:29], v[72:73], v[246:247]
v_pk_mul_f32 v[30:31], v[74:75], v[246:247]
v_pk_mul_f32 v[32:33], v[76:77], v[246:247]
v_pk_mul_f32 v[34:35], v[78:79], v[246:247]
v_exp_f32 v28, v28
v_exp_f32 v29, v29
v_exp_f32 v30, v30
v_exp_f32 v31, v31
v_exp_f32 v32, v32
v_exp_f32 v33, v33
v_exp_f32 v34, v34
v_exp_f32 v35, v35
v_pk_add_f32 v[28:29], v[28:29], v[244:245]
v_pk_add_f32 v[30:31], v[30:31], v[244:245]
v_pk_add_f32 v[32:33], v[32:33], v[244:245]
v_pk_add_f32 v[34:35], v[34:35], v[244:245]
v_rcp_f32 v28, v28
v_rcp_f32 v29, v29
v_rcp_f32 v30, v30
v_rcp_f32 v31, v31
v_rcp_f32 v32, v32
v_rcp_f32 v33, v33
v_rcp_f32 v34, v34
v_rcp_f32 v35, v35
v_pk_mul_f32 v[72:73], v[28:29], v[72:73]
v_pk_mul_f32 v[74:75], v[30:31], v[74:75]
v_pk_mul_f32 v[76:77], v[32:33], v[76:77]
v_pk_mul_f32 v[78:79], v[34:35], v[78:79]
v_cvt_pk_bf16_f32 v36, v72, v73
v_cvt_pk_bf16_f32 v37, v74, v75
v_cvt_pk_bf16_f32 v38, v76, v77
v_cvt_pk_bf16_f32 v39, v78, v79
buffer_store_dwordx4 v[36:39], v251, s[4:7], s53 offen offset:1024 sc1
s_add_u32 s53, s53, s2
v_lshlrev_b32 v48, 16, v200
v_and_b32 v49, 0xffff0000, v200
v_lshlrev_b32 v50, 16, v201
v_and_b32 v51, 0xffff0000, v201
v_lshlrev_b32 v52, 16, v202
v_and_b32 v53, 0xffff0000, v202
v_lshlrev_b32 v54, 16, v203
v_and_b32 v55, 0xffff0000, v203
v_pk_add_f32 v[80:81], v[80:81], v[48:49]
v_pk_add_f32 v[82:83], v[82:83], v[50:51]
v_pk_add_f32 v[84:85], v[84:85], v[52:53]
v_pk_add_f32 v[86:87], v[86:87], v[54:55]
v_pk_mul_f32 v[48:49], v[80:81], v[246:247]
v_pk_mul_f32 v[50:51], v[82:83], v[246:247]
v_pk_mul_f32 v[52:53], v[84:85], v[246:247]
v_pk_mul_f32 v[54:55], v[86:87], v[246:247]
v_exp_f32 v48, v48
v_exp_f32 v49, v49
v_exp_f32 v50, v50
v_exp_f32 v51, v51
v_exp_f32 v52, v52
v_exp_f32 v53, v53
v_exp_f32 v54, v54
v_exp_f32 v55, v55
v_pk_add_f32 v[48:49], v[48:49], v[244:245]
v_pk_add_f32 v[50:51], v[50:51], v[244:245]
v_pk_add_f32 v[52:53], v[52:53], v[244:245]
v_pk_add_f32 v[54:55], v[54:55], v[244:245]
v_rcp_f32 v48, v48
v_rcp_f32 v49, v49
v_rcp_f32 v50, v50
v_rcp_f32 v51, v51
v_rcp_f32 v52, v52
v_rcp_f32 v53, v53
v_rcp_f32 v54, v54
v_rcp_f32 v55, v55
v_pk_mul_f32 v[80:81], v[48:49], v[80:81]
v_pk_mul_f32 v[82:83], v[50:51], v[82:83]
v_pk_mul_f32 v[84:85], v[52:53], v[84:85]
v_pk_mul_f32 v[86:87], v[54:55], v[86:87]
v_cvt_pk_bf16_f32 v56, v80, v81
v_cvt_pk_bf16_f32 v57, v82, v83
v_cvt_pk_bf16_f32 v58, v84, v85
v_cvt_pk_bf16_f32 v59, v86, v87
buffer_store_dwordx4 v[56:59], v251, s[4:7], s53 offen offset:0 sc1
v_lshlrev_b32 v8, 16, v204
v_and_b32 v9, 0xffff0000, v204
v_lshlrev_b32 v10, 16, v205
v_and_b32 v11, 0xffff0000, v205
v_lshlrev_b32 v12, 16, v206
v_and_b32 v13, 0xffff0000, v206
v_lshlrev_b32 v14, 16, v207
v_and_b32 v15, 0xffff0000, v207
v_pk_add_f32 v[88:89], v[88:89], v[8:9]
v_pk_add_f32 v[90:91], v[90:91], v[10:11]
v_pk_add_f32 v[92:93], v[92:93], v[12:13]
v_pk_add_f32 v[94:95], v[94:95], v[14:15]
v_pk_mul_f32 v[8:9], v[88:89], v[246:247]
v_pk_mul_f32 v[10:11], v[90:91], v[246:247]
v_pk_mul_f32 v[12:13], v[92:93], v[246:247]
v_pk_mul_f32 v[14:15], v[94:95], v[246:247]
v_exp_f32 v8, v8
v_exp_f32 v9, v9
v_exp_f32 v10, v10
v_exp_f32 v11, v11
v_exp_f32 v12, v12
v_exp_f32 v13, v13
v_exp_f32 v14, v14
v_exp_f32 v15, v15
v_pk_add_f32 v[8:9], v[8:9], v[244:245]
v_pk_add_f32 v[10:11], v[10:11], v[244:245]
v_pk_add_f32 v[12:13], v[12:13], v[244:245]
v_pk_add_f32 v[14:15], v[14:15], v[244:245]
v_rcp_f32 v8, v8
v_rcp_f32 v9, v9
v_rcp_f32 v10, v10
v_rcp_f32 v11, v11
v_rcp_f32 v12, v12
v_rcp_f32 v13, v13
v_rcp_f32 v14, v14
v_rcp_f32 v15, v15
v_pk_mul_f32 v[88:89], v[8:9], v[88:89]
v_pk_mul_f32 v[90:91], v[10:11], v[90:91]
v_pk_mul_f32 v[92:93], v[12:13], v[92:93]
v_pk_mul_f32 v[94:95], v[14:15], v[94:95]
v_cvt_pk_bf16_f32 v16, v88, v89
v_cvt_pk_bf16_f32 v17, v90, v91
v_cvt_pk_bf16_f32 v18, v92, v93
v_cvt_pk_bf16_f32 v19, v94, v95
buffer_store_dwordx4 v[16:19], v251, s[4:7], s53 offen offset:1024 sc1
s_add_u32 s53, s53, s2
v_lshlrev_b32 v28, 16, v208
v_and_b32 v29, 0xffff0000, v208
v_lshlrev_b32 v30, 16, v209
v_and_b32 v31, 0xffff0000, v209
v_lshlrev_b32 v32, 16, v210
v_and_b32 v33, 0xffff0000, v210
v_lshlrev_b32 v34, 16, v211
v_and_b32 v35, 0xffff0000, v211
v_pk_add_f32 v[96:97], v[96:97], v[28:29]
v_pk_add_f32 v[98:99], v[98:99], v[30:31]
v_pk_add_f32 v[100:101], v[100:101], v[32:33]
v_pk_add_f32 v[102:103], v[102:103], v[34:35]
v_pk_mul_f32 v[28:29], v[96:97], v[246:247]
v_pk_mul_f32 v[30:31], v[98:99], v[246:247]
v_pk_mul_f32 v[32:33], v[100:101], v[246:247]
v_pk_mul_f32 v[34:35], v[102:103], v[246:247]
v_exp_f32 v28, v28
v_exp_f32 v29, v29
v_exp_f32 v30, v30
v_exp_f32 v31, v31
v_exp_f32 v32, v32
v_exp_f32 v33, v33
v_exp_f32 v34, v34
v_exp_f32 v35, v35
v_pk_add_f32 v[28:29], v[28:29], v[244:245]
v_pk_add_f32 v[30:31], v[30:31], v[244:245]
v_pk_add_f32 v[32:33], v[32:33], v[244:245]
v_pk_add_f32 v[34:35], v[34:35], v[244:245]
v_rcp_f32 v28, v28
v_rcp_f32 v29, v29
v_rcp_f32 v30, v30
v_rcp_f32 v31, v31
v_rcp_f32 v32, v32
v_rcp_f32 v33, v33
v_rcp_f32 v34, v34
v_rcp_f32 v35, v35
v_pk_mul_f32 v[96:97], v[28:29], v[96:97]
v_pk_mul_f32 v[98:99], v[30:31], v[98:99]
v_pk_mul_f32 v[100:101], v[32:33], v[100:101]
v_pk_mul_f32 v[102:103], v[34:35], v[102:103]
v_cvt_pk_bf16_f32 v36, v96, v97
v_cvt_pk_bf16_f32 v37, v98, v99
v_cvt_pk_bf16_f32 v38, v100, v101
v_cvt_pk_bf16_f32 v39, v102, v103
buffer_store_dwordx4 v[36:39], v251, s[4:7], s53 offen offset:0 sc1
v_lshlrev_b32 v48, 16, v212
v_and_b32 v49, 0xffff0000, v212
v_lshlrev_b32 v50, 16, v213
v_and_b32 v51, 0xffff0000, v213
v_lshlrev_b32 v52, 16, v214
v_and_b32 v53, 0xffff0000, v214
v_lshlrev_b32 v54, 16, v215
v_and_b32 v55, 0xffff0000, v215
v_pk_add_f32 v[104:105], v[104:105], v[48:49]
v_pk_add_f32 v[106:107], v[106:107], v[50:51]
v_pk_add_f32 v[108:109], v[108:109], v[52:53]
v_pk_add_f32 v[110:111], v[110:111], v[54:55]
v_pk_mul_f32 v[48:49], v[104:105], v[246:247]
v_pk_mul_f32 v[50:51], v[106:107], v[246:247]
v_pk_mul_f32 v[52:53], v[108:109], v[246:247]
v_pk_mul_f32 v[54:55], v[110:111], v[246:247]
v_exp_f32 v48, v48
v_exp_f32 v49, v49
v_exp_f32 v50, v50
v_exp_f32 v51, v51
v_exp_f32 v52, v52
v_exp_f32 v53, v53
v_exp_f32 v54, v54
v_exp_f32 v55, v55
v_pk_add_f32 v[48:49], v[48:49], v[244:245]
v_pk_add_f32 v[50:51], v[50:51], v[244:245]
v_pk_add_f32 v[52:53], v[52:53], v[244:245]
v_pk_add_f32 v[54:55], v[54:55], v[244:245]
v_rcp_f32 v48, v48
v_rcp_f32 v49, v49
v_rcp_f32 v50, v50
v_rcp_f32 v51, v51
v_rcp_f32 v52, v52
v_rcp_f32 v53, v53
v_rcp_f32 v54, v54
v_rcp_f32 v55, v55
v_pk_mul_f32 v[104:105], v[48:49], v[104:105]
v_pk_mul_f32 v[106:107], v[50:51], v[106:107]
v_pk_mul_f32 v[108:109], v[52:53], v[108:109]
v_pk_mul_f32 v[110:111], v[54:55], v[110:111]
v_cvt_pk_bf16_f32 v56, v104, v105
v_cvt_pk_bf16_f32 v57, v106, v107
v_cvt_pk_bf16_f32 v58, v108, v109
v_cvt_pk_bf16_f32 v59, v110, v111
buffer_store_dwordx4 v[56:59], v251, s[4:7], s53 offen offset:1024 sc1
s_add_u32 s53, s53, s2
v_lshlrev_b32 v8, 16, v216
v_and_b32 v9, 0xffff0000, v216
v_lshlrev_b32 v10, 16, v217
v_and_b32 v11, 0xffff0000, v217
v_lshlrev_b32 v12, 16, v218
v_and_b32 v13, 0xffff0000, v218
v_lshlrev_b32 v14, 16, v219
v_and_b32 v15, 0xffff0000, v219
v_pk_add_f32 v[112:113], v[112:113], v[8:9]
v_pk_add_f32 v[114:115], v[114:115], v[10:11]
v_pk_add_f32 v[116:117], v[116:117], v[12:13]
v_pk_add_f32 v[118:119], v[118:119], v[14:15]
v_pk_mul_f32 v[8:9], v[112:113], v[246:247]
v_pk_mul_f32 v[10:11], v[114:115], v[246:247]
v_pk_mul_f32 v[12:13], v[116:117], v[246:247]
v_pk_mul_f32 v[14:15], v[118:119], v[246:247]
v_exp_f32 v8, v8
v_exp_f32 v9, v9
v_exp_f32 v10, v10
v_exp_f32 v11, v11
v_exp_f32 v12, v12
v_exp_f32 v13, v13
v_exp_f32 v14, v14
v_exp_f32 v15, v15
v_pk_add_f32 v[8:9], v[8:9], v[244:245]
v_pk_add_f32 v[10:11], v[10:11], v[244:245]
v_pk_add_f32 v[12:13], v[12:13], v[244:245]
v_pk_add_f32 v[14:15], v[14:15], v[244:245]
v_rcp_f32 v8, v8
v_rcp_f32 v9, v9
v_rcp_f32 v10, v10
v_rcp_f32 v11, v11
v_rcp_f32 v12, v12
v_rcp_f32 v13, v13
v_rcp_f32 v14, v14
v_rcp_f32 v15, v15
v_pk_mul_f32 v[112:113], v[8:9], v[112:113]
v_pk_mul_f32 v[114:115], v[10:11], v[114:115]
v_pk_mul_f32 v[116:117], v[12:13], v[116:117]
v_pk_mul_f32 v[118:119], v[14:15], v[118:119]
v_cvt_pk_bf16_f32 v16, v112, v113
v_cvt_pk_bf16_f32 v17, v114, v115
v_cvt_pk_bf16_f32 v18, v116, v117
v_cvt_pk_bf16_f32 v19, v118, v119
buffer_store_dwordx4 v[16:19], v251, s[4:7], s53 offen offset:0 sc1
v_lshlrev_b32 v28, 16, v220
v_and_b32 v29, 0xffff0000, v220
v_lshlrev_b32 v30, 16, v221
v_and_b32 v31, 0xffff0000, v221
v_lshlrev_b32 v32, 16, v222
v_and_b32 v33, 0xffff0000, v222
v_lshlrev_b32 v34, 16, v223
v_and_b32 v35, 0xffff0000, v223
v_pk_add_f32 v[120:121], v[120:121], v[28:29]
v_pk_add_f32 v[122:123], v[122:123], v[30:31]
v_pk_add_f32 v[124:125], v[124:125], v[32:33]
v_pk_add_f32 v[126:127], v[126:127], v[34:35]
v_pk_mul_f32 v[28:29], v[120:121], v[246:247]
v_pk_mul_f32 v[30:31], v[122:123], v[246:247]
v_pk_mul_f32 v[32:33], v[124:125], v[246:247]
v_pk_mul_f32 v[34:35], v[126:127], v[246:247]
v_exp_f32 v28, v28
v_exp_f32 v29, v29
v_exp_f32 v30, v30
v_exp_f32 v31, v31
v_exp_f32 v32, v32
v_exp_f32 v33, v33
v_exp_f32 v34, v34
v_exp_f32 v35, v35
v_pk_add_f32 v[28:29], v[28:29], v[244:245]
v_pk_add_f32 v[30:31], v[30:31], v[244:245]
v_pk_add_f32 v[32:33], v[32:33], v[244:245]
v_pk_add_f32 v[34:35], v[34:35], v[244:245]
v_rcp_f32 v28, v28
v_rcp_f32 v29, v29
v_rcp_f32 v30, v30
v_rcp_f32 v31, v31
v_rcp_f32 v32, v32
v_rcp_f32 v33, v33
v_rcp_f32 v34, v34
v_rcp_f32 v35, v35
v_pk_mul_f32 v[120:121], v[28:29], v[120:121]
v_pk_mul_f32 v[122:123], v[30:31], v[122:123]
v_pk_mul_f32 v[124:125], v[32:33], v[124:125]
v_pk_mul_f32 v[126:127], v[34:35], v[126:127]
v_cvt_pk_bf16_f32 v36, v120, v121
v_cvt_pk_bf16_f32 v37, v122, v123
v_cvt_pk_bf16_f32 v38, v124, v125
v_cvt_pk_bf16_f32 v39, v126, v127
buffer_store_dwordx4 v[36:39], v251, s[4:7], s53 offen offset:1024 sc1
s_branch main_kernel_w_ee
main_kernel_w_e5:
s_mov_b32 s53, s1
v_permlane16_swap_b32 v160, v162
v_permlane16_swap_b32 v161, v163
v_lshlrev_b32 v8, 16, v192
v_and_b32 v9, 0xffff0000, v192
v_lshlrev_b32 v10, 16, v193
v_and_b32 v11, 0xffff0000, v193
v_lshlrev_b32 v12, 16, v194
v_and_b32 v13, 0xffff0000, v194
v_lshlrev_b32 v14, 16, v195
v_and_b32 v15, 0xffff0000, v195
v_permlane32_swap_b32 v160, v162
v_permlane32_swap_b32 v161, v163
v_lshlrev_b32 v16, 16, v160
v_and_b32 v17, 0xffff0000, v160
v_lshlrev_b32 v18, 16, v161
v_and_b32 v19, 0xffff0000, v161
v_lshlrev_b32 v20, 16, v162
v_and_b32 v21, 0xffff0000, v162
v_lshlrev_b32 v22, 16, v163
v_and_b32 v23, 0xffff0000, v163
v_pk_fma_f32 v[8:9], v[64:65], v[8:9], v[16:17]
v_pk_fma_f32 v[10:11], v[66:67], v[10:11], v[18:19]
v_pk_fma_f32 v[12:13], v[68:69], v[12:13], v[20:21]
v_pk_fma_f32 v[14:15], v[70:71], v[14:15], v[22:23]
v_cvt_pk_bf16_f32 v24, v8, v9
v_cvt_pk_bf16_f32 v25, v10, v11
v_cvt_pk_bf16_f32 v26, v12, v13
v_cvt_pk_bf16_f32 v27, v14, v15
s_nop 0
v_permlane32_swap_b32 v24, v26
v_permlane32_swap_b32 v25, v27
s_nop 0
v_permlane16_swap_b32 v24, v26
v_permlane16_swap_b32 v25, v27
buffer_store_dwordx4 v[24:27], v145, s[92:95], s53 offen offset:0
v_permlane16_swap_b32 v164, v166
v_permlane16_swap_b32 v165, v167
v_lshlrev_b32 v36, 16, v196
v_and_b32 v37, 0xffff0000, v196
v_lshlrev_b32 v38, 16, v197
v_and_b32 v39, 0xffff0000, v197
v_lshlrev_b32 v40, 16, v198
v_and_b32 v41, 0xffff0000, v198
v_lshlrev_b32 v42, 16, v199
v_and_b32 v43, 0xffff0000, v199
v_permlane32_swap_b32 v164, v166
v_permlane32_swap_b32 v165, v167
v_lshlrev_b32 v44, 16, v164
v_and_b32 v45, 0xffff0000, v164
v_lshlrev_b32 v46, 16, v165
v_and_b32 v47, 0xffff0000, v165
v_lshlrev_b32 v48, 16, v166
v_and_b32 v49, 0xffff0000, v166
v_lshlrev_b32 v50, 16, v167
v_and_b32 v51, 0xffff0000, v167
v_pk_fma_f32 v[36:37], v[72:73], v[36:37], v[44:45]
v_pk_fma_f32 v[38:39], v[74:75], v[38:39], v[46:47]
v_pk_fma_f32 v[40:41], v[76:77], v[40:41], v[48:49]
v_pk_fma_f32 v[42:43], v[78:79], v[42:43], v[50:51]
v_cvt_pk_bf16_f32 v52, v36, v37
v_cvt_pk_bf16_f32 v53, v38, v39
v_cvt_pk_bf16_f32 v54, v40, v41
v_cvt_pk_bf16_f32 v55, v42, v43
s_nop 0
v_permlane32_swap_b32 v52, v54
v_permlane32_swap_b32 v53, v55
s_nop 0
v_permlane16_swap_b32 v52, v54
v_permlane16_swap_b32 v53, v55
buffer_store_dwordx4 v[52:55], v145, s[92:95], s53 offen offset:64
s_add_u32 s53, s53, 32768
v_permlane16_swap_b32 v168, v170
v_permlane16_swap_b32 v169, v171
v_lshlrev_b32 v8, 16, v200
v_and_b32 v9, 0xffff0000, v200
v_lshlrev_b32 v10, 16, v201
v_and_b32 v11, 0xffff0000, v201
v_lshlrev_b32 v12, 16, v202
v_and_b32 v13, 0xffff0000, v202
v_lshlrev_b32 v14, 16, v203
v_and_b32 v15, 0xffff0000, v203
v_permlane32_swap_b32 v168, v170
v_permlane32_swap_b32 v169, v171
v_lshlrev_b32 v16, 16, v168
v_and_b32 v17, 0xffff0000, v168
v_lshlrev_b32 v18, 16, v169
v_and_b32 v19, 0xffff0000, v169
v_lshlrev_b32 v20, 16, v170
v_and_b32 v21, 0xffff0000, v170
v_lshlrev_b32 v22, 16, v171
v_and_b32 v23, 0xffff0000, v171
v_pk_fma_f32 v[8:9], v[80:81], v[8:9], v[16:17]
v_pk_fma_f32 v[10:11], v[82:83], v[10:11], v[18:19]
v_pk_fma_f32 v[12:13], v[84:85], v[12:13], v[20:21]
v_pk_fma_f32 v[14:15], v[86:87], v[14:15], v[22:23]
v_cvt_pk_bf16_f32 v24, v8, v9
v_cvt_pk_bf16_f32 v25, v10, v11
v_cvt_pk_bf16_f32 v26, v12, v13
v_cvt_pk_bf16_f32 v27, v14, v15
s_nop 0
v_permlane32_swap_b32 v24, v26
v_permlane32_swap_b32 v25, v27
s_nop 0
v_permlane16_swap_b32 v24, v26
v_permlane16_swap_b32 v25, v27
buffer_store_dwordx4 v[24:27], v145, s[92:95], s53 offen offset:0
v_permlane16_swap_b32 v172, v174
v_permlane16_swap_b32 v173, v175
v_lshlrev_b32 v36, 16, v204
v_and_b32 v37, 0xffff0000, v204
v_lshlrev_b32 v38, 16, v205
v_and_b32 v39, 0xffff0000, v205
v_lshlrev_b32 v40, 16, v206
v_and_b32 v41, 0xffff0000, v206
v_lshlrev_b32 v42, 16, v207
v_and_b32 v43, 0xffff0000, v207
v_permlane32_swap_b32 v172, v174
v_permlane32_swap_b32 v173, v175
v_lshlrev_b32 v44, 16, v172
v_and_b32 v45, 0xffff0000, v172
v_lshlrev_b32 v46, 16, v173
v_and_b32 v47, 0xffff0000, v173
v_lshlrev_b32 v48, 16, v174
v_and_b32 v49, 0xffff0000, v174
v_lshlrev_b32 v50, 16, v175
v_and_b32 v51, 0xffff0000, v175
v_pk_fma_f32 v[36:37], v[88:89], v[36:37], v[44:45]
v_pk_fma_f32 v[38:39], v[90:91], v[38:39], v[46:47]
v_pk_fma_f32 v[40:41], v[92:93], v[40:41], v[48:49]
v_pk_fma_f32 v[42:43], v[94:95], v[42:43], v[50:51]
v_cvt_pk_bf16_f32 v52, v36, v37
v_cvt_pk_bf16_f32 v53, v38, v39
v_cvt_pk_bf16_f32 v54, v40, v41
v_cvt_pk_bf16_f32 v55, v42, v43
s_nop 0
v_permlane32_swap_b32 v52, v54
v_permlane32_swap_b32 v53, v55
s_nop 0
v_permlane16_swap_b32 v52, v54
v_permlane16_swap_b32 v53, v55
buffer_store_dwordx4 v[52:55], v145, s[92:95], s53 offen offset:64
s_add_u32 s53, s53, 32768
v_permlane16_swap_b32 v176, v178
v_permlane16_swap_b32 v177, v179
v_lshlrev_b32 v8, 16, v208
v_and_b32 v9, 0xffff0000, v208
v_lshlrev_b32 v10, 16, v209
v_and_b32 v11, 0xffff0000, v209
v_lshlrev_b32 v12, 16, v210
v_and_b32 v13, 0xffff0000, v210
v_lshlrev_b32 v14, 16, v211
v_and_b32 v15, 0xffff0000, v211
v_permlane32_swap_b32 v176, v178
v_permlane32_swap_b32 v177, v179
v_lshlrev_b32 v16, 16, v176
v_and_b32 v17, 0xffff0000, v176
v_lshlrev_b32 v18, 16, v177
v_and_b32 v19, 0xffff0000, v177
v_lshlrev_b32 v20, 16, v178
v_and_b32 v21, 0xffff0000, v178
v_lshlrev_b32 v22, 16, v179
v_and_b32 v23, 0xffff0000, v179
v_pk_fma_f32 v[8:9], v[96:97], v[8:9], v[16:17]
v_pk_fma_f32 v[10:11], v[98:99], v[10:11], v[18:19]
v_pk_fma_f32 v[12:13], v[100:101], v[12:13], v[20:21]
v_pk_fma_f32 v[14:15], v[102:103], v[14:15], v[22:23]
v_cvt_pk_bf16_f32 v24, v8, v9
v_cvt_pk_bf16_f32 v25, v10, v11
v_cvt_pk_bf16_f32 v26, v12, v13
v_cvt_pk_bf16_f32 v27, v14, v15
s_nop 0
v_permlane32_swap_b32 v24, v26
v_permlane32_swap_b32 v25, v27
s_nop 0
v_permlane16_swap_b32 v24, v26
v_permlane16_swap_b32 v25, v27
buffer_store_dwordx4 v[24:27], v145, s[92:95], s53 offen offset:0
v_permlane16_swap_b32 v180, v182
v_permlane16_swap_b32 v181, v183
v_lshlrev_b32 v36, 16, v212
v_and_b32 v37, 0xffff0000, v212
v_lshlrev_b32 v38, 16, v213
v_and_b32 v39, 0xffff0000, v213
v_lshlrev_b32 v40, 16, v214
v_and_b32 v41, 0xffff0000, v214
v_lshlrev_b32 v42, 16, v215
v_and_b32 v43, 0xffff0000, v215
v_permlane32_swap_b32 v180, v182
v_permlane32_swap_b32 v181, v183
v_lshlrev_b32 v44, 16, v180
v_and_b32 v45, 0xffff0000, v180
v_lshlrev_b32 v46, 16, v181
v_and_b32 v47, 0xffff0000, v181
v_lshlrev_b32 v48, 16, v182
v_and_b32 v49, 0xffff0000, v182
v_lshlrev_b32 v50, 16, v183
v_and_b32 v51, 0xffff0000, v183
v_pk_fma_f32 v[36:37], v[104:105], v[36:37], v[44:45]
v_pk_fma_f32 v[38:39], v[106:107], v[38:39], v[46:47]
v_pk_fma_f32 v[40:41], v[108:109], v[40:41], v[48:49]
v_pk_fma_f32 v[42:43], v[110:111], v[42:43], v[50:51]
v_cvt_pk_bf16_f32 v52, v36, v37
v_cvt_pk_bf16_f32 v53, v38, v39
v_cvt_pk_bf16_f32 v54, v40, v41
v_cvt_pk_bf16_f32 v55, v42, v43
s_nop 0
v_permlane32_swap_b32 v52, v54
v_permlane32_swap_b32 v53, v55
s_nop 0
v_permlane16_swap_b32 v52, v54
v_permlane16_swap_b32 v53, v55
buffer_store_dwordx4 v[52:55], v145, s[92:95], s53 offen offset:64
s_add_u32 s53, s53, 32768
v_permlane16_swap_b32 v184, v186
v_permlane16_swap_b32 v185, v187
v_lshlrev_b32 v8, 16, v216
v_and_b32 v9, 0xffff0000, v216
v_lshlrev_b32 v10, 16, v217
v_and_b32 v11, 0xffff0000, v217
v_lshlrev_b32 v12, 16, v218
v_and_b32 v13, 0xffff0000, v218
v_lshlrev_b32 v14, 16, v219
v_and_b32 v15, 0xffff0000, v219
v_permlane32_swap_b32 v184, v186
v_permlane32_swap_b32 v185, v187
v_lshlrev_b32 v16, 16, v184
v_and_b32 v17, 0xffff0000, v184
v_lshlrev_b32 v18, 16, v185
v_and_b32 v19, 0xffff0000, v185
v_lshlrev_b32 v20, 16, v186
v_and_b32 v21, 0xffff0000, v186
v_lshlrev_b32 v22, 16, v187
v_and_b32 v23, 0xffff0000, v187
v_pk_fma_f32 v[8:9], v[112:113], v[8:9], v[16:17]
v_pk_fma_f32 v[10:11], v[114:115], v[10:11], v[18:19]
v_pk_fma_f32 v[12:13], v[116:117], v[12:13], v[20:21]
v_pk_fma_f32 v[14:15], v[118:119], v[14:15], v[22:23]
v_cvt_pk_bf16_f32 v24, v8, v9
v_cvt_pk_bf16_f32 v25, v10, v11
v_cvt_pk_bf16_f32 v26, v12, v13
v_cvt_pk_bf16_f32 v27, v14, v15
s_nop 0
v_permlane32_swap_b32 v24, v26
v_permlane32_swap_b32 v25, v27
s_nop 0
v_permlane16_swap_b32 v24, v26
v_permlane16_swap_b32 v25, v27
buffer_store_dwordx4 v[24:27], v145, s[92:95], s53 offen offset:0
v_permlane16_swap_b32 v188, v190
v_permlane16_swap_b32 v189, v191
v_lshlrev_b32 v36, 16, v220
v_and_b32 v37, 0xffff0000, v220
v_lshlrev_b32 v38, 16, v221
v_and_b32 v39, 0xffff0000, v221
v_lshlrev_b32 v40, 16, v222
v_and_b32 v41, 0xffff0000, v222
v_lshlrev_b32 v42, 16, v223
v_and_b32 v43, 0xffff0000, v223
v_permlane32_swap_b32 v188, v190
v_permlane32_swap_b32 v189, v191
v_lshlrev_b32 v44, 16, v188
v_and_b32 v45, 0xffff0000, v188
v_lshlrev_b32 v46, 16, v189
v_and_b32 v47, 0xffff0000, v189
v_lshlrev_b32 v48, 16, v190
v_and_b32 v49, 0xffff0000, v190
v_lshlrev_b32 v50, 16, v191
v_and_b32 v51, 0xffff0000, v191
v_pk_fma_f32 v[36:37], v[120:121], v[36:37], v[44:45]
v_pk_fma_f32 v[38:39], v[122:123], v[38:39], v[46:47]
v_pk_fma_f32 v[40:41], v[124:125], v[40:41], v[48:49]
v_pk_fma_f32 v[42:43], v[126:127], v[42:43], v[50:51]
v_cvt_pk_bf16_f32 v52, v36, v37
v_cvt_pk_bf16_f32 v53, v38, v39
v_cvt_pk_bf16_f32 v54, v40, v41
v_cvt_pk_bf16_f32 v55, v42, v43
s_nop 0
v_permlane32_swap_b32 v52, v54
v_permlane32_swap_b32 v53, v55
s_nop 0
v_permlane16_swap_b32 v52, v54
v_permlane16_swap_b32 v53, v55
buffer_store_dwordx4 v[52:55], v145, s[92:95], s53 offen offset:64
s_branch main_kernel_w_ee
main_kernel_w_e6:
s_mov_b32 s53, s1
v_accvgpr_read_b32 v0, a0
v_accvgpr_read_b32 v1, a1
v_accvgpr_read_b32 v2, a2
v_accvgpr_read_b32 v3, a3
v_accvgpr_read_b32 v4, a4
v_accvgpr_read_b32 v5, a5
v_accvgpr_read_b32 v6, a6
v_accvgpr_read_b32 v7, a7
v_cvt_pk_bf16_f32 v16, v0, v1
v_cvt_pk_bf16_f32 v17, v2, v3
v_cvt_pk_bf16_f32 v18, v4, v5
v_cvt_pk_bf16_f32 v19, v6, v7
buffer_store_dwordx4 v[16:19], v251, s[4:7], s53 offen offset:0 sc1
v_accvgpr_read_b32 v20, a8
v_accvgpr_read_b32 v21, a9
v_accvgpr_read_b32 v22, a10
v_accvgpr_read_b32 v23, a11
v_accvgpr_read_b32 v24, a12
v_accvgpr_read_b32 v25, a13
v_accvgpr_read_b32 v26, a14
v_accvgpr_read_b32 v27, a15
v_cvt_pk_bf16_f32 v36, v20, v21
v_cvt_pk_bf16_f32 v37, v22, v23
v_cvt_pk_bf16_f32 v38, v24, v25
v_cvt_pk_bf16_f32 v39, v26, v27
buffer_store_dwordx4 v[36:39], v251, s[4:7], s53 offen offset:1024 sc1
v_accvgpr_read_b32 v40, a16
v_accvgpr_read_b32 v41, a17
v_accvgpr_read_b32 v42, a18
v_accvgpr_read_b32 v43, a19
v_accvgpr_read_b32 v44, a20
v_accvgpr_read_b32 v45, a21
v_accvgpr_read_b32 v46, a22
v_accvgpr_read_b32 v47, a23
v_cvt_pk_bf16_f32 v56, v40, v41
v_cvt_pk_bf16_f32 v57, v42, v43
v_cvt_pk_bf16_f32 v58, v44, v45
v_cvt_pk_bf16_f32 v59, v46, v47
buffer_store_dwordx4 v[56:59], v251, s[4:7], s53 offen offset:2048 sc1
v_accvgpr_read_b32 v0, a24
v_accvgpr_read_b32 v1, a25
v_accvgpr_read_b32 v2, a26
v_accvgpr_read_b32 v3, a27
v_accvgpr_read_b32 v4, a28
v_accvgpr_read_b32 v5, a29
v_accvgpr_read_b32 v6, a30
v_accvgpr_read_b32 v7, a31
v_cvt_pk_bf16_f32 v16, v0, v1
v_cvt_pk_bf16_f32 v17, v2, v3
v_cvt_pk_bf16_f32 v18, v4, v5
v_cvt_pk_bf16_f32 v19, v6, v7
buffer_store_dwordx4 v[16:19], v251, s[4:7], s53 offen offset:3072 sc1
s_add_u32 s53, s53, s2
v_accvgpr_read_b32 v20, a32
v_accvgpr_read_b32 v21, a33
v_accvgpr_read_b32 v22, a34
v_accvgpr_read_b32 v23, a35
v_accvgpr_read_b32 v24, a36
v_accvgpr_read_b32 v25, a37
v_accvgpr_read_b32 v26, a38
v_accvgpr_read_b32 v27, a39
v_cvt_pk_bf16_f32 v36, v20, v21
v_cvt_pk_bf16_f32 v37, v22, v23
v_cvt_pk_bf16_f32 v38, v24, v25
v_cvt_pk_bf16_f32 v39, v26, v27
buffer_store_dwordx4 v[36:39], v251, s[4:7], s53 offen offset:0 sc1
v_accvgpr_read_b32 v40, a40
v_accvgpr_read_b32 v41, a41
v_accvgpr_read_b32 v42, a42
v_accvgpr_read_b32 v43, a43
v_accvgpr_read_b32 v44, a44
v_accvgpr_read_b32 v45, a45
v_accvgpr_read_b32 v46, a46
v_accvgpr_read_b32 v47, a47
v_cvt_pk_bf16_f32 v56, v40, v41
v_cvt_pk_bf16_f32 v57, v42, v43
v_cvt_pk_bf16_f32 v58, v44, v45
v_cvt_pk_bf16_f32 v59, v46, v47
buffer_store_dwordx4 v[56:59], v251, s[4:7], s53 offen offset:1024 sc1
v_accvgpr_read_b32 v0, a48
v_accvgpr_read_b32 v1, a49
v_accvgpr_read_b32 v2, a50
v_accvgpr_read_b32 v3, a51
v_accvgpr_read_b32 v4, a52
v_accvgpr_read_b32 v5, a53
v_accvgpr_read_b32 v6, a54
v_accvgpr_read_b32 v7, a55
v_cvt_pk_bf16_f32 v16, v0, v1
v_cvt_pk_bf16_f32 v17, v2, v3
v_cvt_pk_bf16_f32 v18, v4, v5
v_cvt_pk_bf16_f32 v19, v6, v7
buffer_store_dwordx4 v[16:19], v251, s[4:7], s53 offen offset:2048 sc1
v_accvgpr_read_b32 v20, a56
v_accvgpr_read_b32 v21, a57
v_accvgpr_read_b32 v22, a58
v_accvgpr_read_b32 v23, a59
v_accvgpr_read_b32 v24, a60
v_accvgpr_read_b32 v25, a61
v_accvgpr_read_b32 v26, a62
v_accvgpr_read_b32 v27, a63
v_cvt_pk_bf16_f32 v36, v20, v21
v_cvt_pk_bf16_f32 v37, v22, v23
v_cvt_pk_bf16_f32 v38, v24, v25
v_cvt_pk_bf16_f32 v39, v26, v27
buffer_store_dwordx4 v[36:39], v251, s[4:7], s53 offen offset:3072 sc1
s_add_u32 s53, s53, s2
v_accvgpr_read_b32 v40, a64
v_accvgpr_read_b32 v41, a65
v_accvgpr_read_b32 v42, a66
v_accvgpr_read_b32 v43, a67
v_accvgpr_read_b32 v44, a68
v_accvgpr_read_b32 v45, a69
v_accvgpr_read_b32 v46, a70
v_accvgpr_read_b32 v47, a71
v_cvt_pk_bf16_f32 v56, v40, v41
v_cvt_pk_bf16_f32 v57, v42, v43
v_cvt_pk_bf16_f32 v58, v44, v45
v_cvt_pk_bf16_f32 v59, v46, v47
buffer_store_dwordx4 v[56:59], v251, s[4:7], s53 offen offset:0 sc1
v_accvgpr_read_b32 v0, a72
v_accvgpr_read_b32 v1, a73
v_accvgpr_read_b32 v2, a74
v_accvgpr_read_b32 v3, a75
v_accvgpr_read_b32 v4, a76
v_accvgpr_read_b32 v5, a77
v_accvgpr_read_b32 v6, a78
v_accvgpr_read_b32 v7, a79
v_cvt_pk_bf16_f32 v16, v0, v1
v_cvt_pk_bf16_f32 v17, v2, v3
v_cvt_pk_bf16_f32 v18, v4, v5
v_cvt_pk_bf16_f32 v19, v6, v7
buffer_store_dwordx4 v[16:19], v251, s[4:7], s53 offen offset:1024 sc1
v_accvgpr_read_b32 v20, a80
v_accvgpr_read_b32 v21, a81
v_accvgpr_read_b32 v22, a82
v_accvgpr_read_b32 v23, a83
v_accvgpr_read_b32 v24, a84
v_accvgpr_read_b32 v25, a85
v_accvgpr_read_b32 v26, a86
v_accvgpr_read_b32 v27, a87
v_cvt_pk_bf16_f32 v36, v20, v21
v_cvt_pk_bf16_f32 v37, v22, v23
v_cvt_pk_bf16_f32 v38, v24, v25
v_cvt_pk_bf16_f32 v39, v26, v27
buffer_store_dwordx4 v[36:39], v251, s[4:7], s53 offen offset:2048 sc1
v_accvgpr_read_b32 v40, a88
v_accvgpr_read_b32 v41, a89
v_accvgpr_read_b32 v42, a90
v_accvgpr_read_b32 v43, a91
v_accvgpr_read_b32 v44, a92
v_accvgpr_read_b32 v45, a93
v_accvgpr_read_b32 v46, a94
v_accvgpr_read_b32 v47, a95
v_cvt_pk_bf16_f32 v56, v40, v41
v_cvt_pk_bf16_f32 v57, v42, v43
v_cvt_pk_bf16_f32 v58, v44, v45
v_cvt_pk_bf16_f32 v59, v46, v47
buffer_store_dwordx4 v[56:59], v251, s[4:7], s53 offen offset:3072 sc1
s_add_u32 s53, s53, s2
v_accvgpr_read_b32 v0, a96
v_accvgpr_read_b32 v1, a97
v_accvgpr_read_b32 v2, a98
v_accvgpr_read_b32 v3, a99
v_accvgpr_read_b32 v4, a100
v_accvgpr_read_b32 v5, a101
v_accvgpr_read_b32 v6, a102
v_accvgpr_read_b32 v7, a103
v_cvt_pk_bf16_f32 v16, v0, v1
v_cvt_pk_bf16_f32 v17, v2, v3
v_cvt_pk_bf16_f32 v18, v4, v5
v_cvt_pk_bf16_f32 v19, v6, v7
buffer_store_dwordx4 v[16:19], v251, s[4:7], s53 offen offset:0 sc1
v_accvgpr_read_b32 v20, a104
v_accvgpr_read_b32 v21, a105
v_accvgpr_read_b32 v22, a106
v_accvgpr_read_b32 v23, a107
v_accvgpr_read_b32 v24, a108
v_accvgpr_read_b32 v25, a109
v_accvgpr_read_b32 v26, a110
v_accvgpr_read_b32 v27, a111
v_cvt_pk_bf16_f32 v36, v20, v21
v_cvt_pk_bf16_f32 v37, v22, v23
v_cvt_pk_bf16_f32 v38, v24, v25
v_cvt_pk_bf16_f32 v39, v26, v27
buffer_store_dwordx4 v[36:39], v251, s[4:7], s53 offen offset:1024 sc1
v_accvgpr_read_b32 v40, a112
v_accvgpr_read_b32 v41, a113
v_accvgpr_read_b32 v42, a114
v_accvgpr_read_b32 v43, a115
v_accvgpr_read_b32 v44, a116
v_accvgpr_read_b32 v45, a117
v_accvgpr_read_b32 v46, a118
v_accvgpr_read_b32 v47, a119
v_cvt_pk_bf16_f32 v56, v40, v41
v_cvt_pk_bf16_f32 v57, v42, v43
v_cvt_pk_bf16_f32 v58, v44, v45
v_cvt_pk_bf16_f32 v59, v46, v47
buffer_store_dwordx4 v[56:59], v251, s[4:7], s53 offen offset:2048 sc1
v_accvgpr_read_b32 v0, a120
v_accvgpr_read_b32 v1, a121
v_accvgpr_read_b32 v2, a122
v_accvgpr_read_b32 v3, a123
v_accvgpr_read_b32 v4, a124
v_accvgpr_read_b32 v5, a125
v_accvgpr_read_b32 v6, a126
v_accvgpr_read_b32 v7, a127
v_cvt_pk_bf16_f32 v16, v0, v1
v_cvt_pk_bf16_f32 v17, v2, v3
v_cvt_pk_bf16_f32 v18, v4, v5
v_cvt_pk_bf16_f32 v19, v6, v7
buffer_store_dwordx4 v[16:19], v251, s[4:7], s53 offen offset:3072 sc1
s_branch main_kernel_w_ee
main_kernel_w_e7:
s_mov_b32 s53, s1
v_accvgpr_read_b32 v0, a0
v_accvgpr_read_b32 v1, a1
v_accvgpr_read_b32 v2, a2
v_accvgpr_read_b32 v3, a3
v_accvgpr_read_b32 v4, a4
v_accvgpr_read_b32 v5, a5
v_accvgpr_read_b32 v6, a6
v_accvgpr_read_b32 v7, a7
v_mul_f32 v0, 0x3e0293ee, v0
v_mul_f32 v1, 0x3e0293ee, v1
v_mul_f32 v2, 0x3e0293ee, v2
v_mul_f32 v3, 0x3e0293ee, v3
v_mul_f32 v4, 0x3e0293ee, v4
v_mul_f32 v5, 0x3e0293ee, v5
v_mul_f32 v6, 0x3e0293ee, v6
v_mul_f32 v7, 0x3e0293ee, v7
v_cvt_pk_bf16_f32 v16, v0, v1
v_cvt_pk_bf16_f32 v17, v2, v3
v_cvt_pk_bf16_f32 v18, v4, v5
v_cvt_pk_bf16_f32 v19, v6, v7
buffer_store_dwordx4 v[16:19], v251, s[4:7], s53 offen offset:0 sc1
v_accvgpr_read_b32 v20, a8
v_accvgpr_read_b32 v21, a9
v_accvgpr_read_b32 v22, a10
v_accvgpr_read_b32 v23, a11
v_accvgpr_read_b32 v24, a12
v_accvgpr_read_b32 v25, a13
v_accvgpr_read_b32 v26, a14
v_accvgpr_read_b32 v27, a15
v_mul_f32 v20, 0x3e0293ee, v20
v_mul_f32 v21, 0x3e0293ee, v21
v_mul_f32 v22, 0x3e0293ee, v22
v_mul_f32 v23, 0x3e0293ee, v23
v_mul_f32 v24, 0x3e0293ee, v24
v_mul_f32 v25, 0x3e0293ee, v25
v_mul_f32 v26, 0x3e0293ee, v26
v_mul_f32 v27, 0x3e0293ee, v27
v_cvt_pk_bf16_f32 v36, v20, v21
v_cvt_pk_bf16_f32 v37, v22, v23
v_cvt_pk_bf16_f32 v38, v24, v25
v_cvt_pk_bf16_f32 v39, v26, v27
buffer_store_dwordx4 v[36:39], v251, s[4:7], s53 offen offset:1024 sc1
v_accvgpr_read_b32 v40, a16
v_accvgpr_read_b32 v41, a17
v_accvgpr_read_b32 v42, a18
v_accvgpr_read_b32 v43, a19
v_accvgpr_read_b32 v44, a20
v_accvgpr_read_b32 v45, a21
v_accvgpr_read_b32 v46, a22
v_accvgpr_read_b32 v47, a23
v_mul_f32 v40, 0x3e0293ee, v40
v_mul_f32 v41, 0x3e0293ee, v41
v_mul_f32 v42, 0x3e0293ee, v42
v_mul_f32 v43, 0x3e0293ee, v43
v_mul_f32 v44, 0x3e0293ee, v44
v_mul_f32 v45, 0x3e0293ee, v45
v_mul_f32 v46, 0x3e0293ee, v46
v_mul_f32 v47, 0x3e0293ee, v47
v_cvt_pk_bf16_f32 v56, v40, v41
v_cvt_pk_bf16_f32 v57, v42, v43
v_cvt_pk_bf16_f32 v58, v44, v45
v_cvt_pk_bf16_f32 v59, v46, v47
buffer_store_dwordx4 v[56:59], v251, s[4:7], s53 offen offset:2048 sc1
v_accvgpr_read_b32 v0, a24
v_accvgpr_read_b32 v1, a25
v_accvgpr_read_b32 v2, a26
v_accvgpr_read_b32 v3, a27
v_accvgpr_read_b32 v4, a28
v_accvgpr_read_b32 v5, a29
v_accvgpr_read_b32 v6, a30
v_accvgpr_read_b32 v7, a31
v_mul_f32 v0, 0x3e0293ee, v0
v_mul_f32 v1, 0x3e0293ee, v1
v_mul_f32 v2, 0x3e0293ee, v2
v_mul_f32 v3, 0x3e0293ee, v3
v_mul_f32 v4, 0x3e0293ee, v4
v_mul_f32 v5, 0x3e0293ee, v5
v_mul_f32 v6, 0x3e0293ee, v6
v_mul_f32 v7, 0x3e0293ee, v7
v_cvt_pk_bf16_f32 v16, v0, v1
v_cvt_pk_bf16_f32 v17, v2, v3
v_cvt_pk_bf16_f32 v18, v4, v5
v_cvt_pk_bf16_f32 v19, v6, v7
buffer_store_dwordx4 v[16:19], v251, s[4:7], s53 offen offset:3072 sc1
s_add_u32 s53, s53, s2
v_accvgpr_read_b32 v20, a32
v_accvgpr_read_b32 v21, a33
v_accvgpr_read_b32 v22, a34
v_accvgpr_read_b32 v23, a35
v_accvgpr_read_b32 v24, a36
v_accvgpr_read_b32 v25, a37
v_accvgpr_read_b32 v26, a38
v_accvgpr_read_b32 v27, a39
v_mul_f32 v20, 0x3e0293ee, v20
v_mul_f32 v21, 0x3e0293ee, v21
v_mul_f32 v22, 0x3e0293ee, v22
v_mul_f32 v23, 0x3e0293ee, v23
v_mul_f32 v24, 0x3e0293ee, v24
v_mul_f32 v25, 0x3e0293ee, v25
v_mul_f32 v26, 0x3e0293ee, v26
v_mul_f32 v27, 0x3e0293ee, v27
v_cvt_pk_bf16_f32 v36, v20, v21
v_cvt_pk_bf16_f32 v37, v22, v23
v_cvt_pk_bf16_f32 v38, v24, v25
v_cvt_pk_bf16_f32 v39, v26, v27
buffer_store_dwordx4 v[36:39], v251, s[4:7], s53 offen offset:0 sc1
v_accvgpr_read_b32 v40, a40
v_accvgpr_read_b32 v41, a41
v_accvgpr_read_b32 v42, a42
v_accvgpr_read_b32 v43, a43
v_accvgpr_read_b32 v44, a44
v_accvgpr_read_b32 v45, a45
v_accvgpr_read_b32 v46, a46
v_accvgpr_read_b32 v47, a47
v_mul_f32 v40, 0x3e0293ee, v40
v_mul_f32 v41, 0x3e0293ee, v41
v_mul_f32 v42, 0x3e0293ee, v42
v_mul_f32 v43, 0x3e0293ee, v43
v_mul_f32 v44, 0x3e0293ee, v44
v_mul_f32 v45, 0x3e0293ee, v45
v_mul_f32 v46, 0x3e0293ee, v46
v_mul_f32 v47, 0x3e0293ee, v47
v_cvt_pk_bf16_f32 v56, v40, v41
v_cvt_pk_bf16_f32 v57, v42, v43
v_cvt_pk_bf16_f32 v58, v44, v45
v_cvt_pk_bf16_f32 v59, v46, v47
buffer_store_dwordx4 v[56:59], v251, s[4:7], s53 offen offset:1024 sc1
v_accvgpr_read_b32 v0, a48
v_accvgpr_read_b32 v1, a49
v_accvgpr_read_b32 v2, a50
v_accvgpr_read_b32 v3, a51
v_accvgpr_read_b32 v4, a52
v_accvgpr_read_b32 v5, a53
v_accvgpr_read_b32 v6, a54
v_accvgpr_read_b32 v7, a55
v_mul_f32 v0, 0x3e0293ee, v0
v_mul_f32 v1, 0x3e0293ee, v1
v_mul_f32 v2, 0x3e0293ee, v2
v_mul_f32 v3, 0x3e0293ee, v3
v_mul_f32 v4, 0x3e0293ee, v4
v_mul_f32 v5, 0x3e0293ee, v5
v_mul_f32 v6, 0x3e0293ee, v6
v_mul_f32 v7, 0x3e0293ee, v7
v_cvt_pk_bf16_f32 v16, v0, v1
v_cvt_pk_bf16_f32 v17, v2, v3
v_cvt_pk_bf16_f32 v18, v4, v5
v_cvt_pk_bf16_f32 v19, v6, v7
buffer_store_dwordx4 v[16:19], v251, s[4:7], s53 offen offset:2048 sc1
v_accvgpr_read_b32 v20, a56
v_accvgpr_read_b32 v21, a57
v_accvgpr_read_b32 v22, a58
v_accvgpr_read_b32 v23, a59
v_accvgpr_read_b32 v24, a60
v_accvgpr_read_b32 v25, a61
v_accvgpr_read_b32 v26, a62
v_accvgpr_read_b32 v27, a63
v_mul_f32 v20, 0x3e0293ee, v20
v_mul_f32 v21, 0x3e0293ee, v21
v_mul_f32 v22, 0x3e0293ee, v22
v_mul_f32 v23, 0x3e0293ee, v23
v_mul_f32 v24, 0x3e0293ee, v24
v_mul_f32 v25, 0x3e0293ee, v25
v_mul_f32 v26, 0x3e0293ee, v26
v_mul_f32 v27, 0x3e0293ee, v27
v_cvt_pk_bf16_f32 v36, v20, v21
v_cvt_pk_bf16_f32 v37, v22, v23
v_cvt_pk_bf16_f32 v38, v24, v25
v_cvt_pk_bf16_f32 v39, v26, v27
buffer_store_dwordx4 v[36:39], v251, s[4:7], s53 offen offset:3072 sc1
s_add_u32 s53, s53, s2
v_accvgpr_read_b32 v40, a64
v_accvgpr_read_b32 v41, a65
v_accvgpr_read_b32 v42, a66
v_accvgpr_read_b32 v43, a67
v_accvgpr_read_b32 v44, a68
v_accvgpr_read_b32 v45, a69
v_accvgpr_read_b32 v46, a70
v_accvgpr_read_b32 v47, a71
v_mul_f32 v40, 0x3e0293ee, v40
v_mul_f32 v41, 0x3e0293ee, v41
v_mul_f32 v42, 0x3e0293ee, v42
v_mul_f32 v43, 0x3e0293ee, v43
v_mul_f32 v44, 0x3e0293ee, v44
v_mul_f32 v45, 0x3e0293ee, v45
v_mul_f32 v46, 0x3e0293ee, v46
v_mul_f32 v47, 0x3e0293ee, v47
v_cvt_pk_bf16_f32 v56, v40, v41
v_cvt_pk_bf16_f32 v57, v42, v43
v_cvt_pk_bf16_f32 v58, v44, v45
v_cvt_pk_bf16_f32 v59, v46, v47
buffer_store_dwordx4 v[56:59], v251, s[4:7], s53 offen offset:0 sc1
v_accvgpr_read_b32 v0, a72
v_accvgpr_read_b32 v1, a73
v_accvgpr_read_b32 v2, a74
v_accvgpr_read_b32 v3, a75
v_accvgpr_read_b32 v4, a76
v_accvgpr_read_b32 v5, a77
v_accvgpr_read_b32 v6, a78
v_accvgpr_read_b32 v7, a79
v_mul_f32 v0, 0x3e0293ee, v0
v_mul_f32 v1, 0x3e0293ee, v1
v_mul_f32 v2, 0x3e0293ee, v2
v_mul_f32 v3, 0x3e0293ee, v3
v_mul_f32 v4, 0x3e0293ee, v4
v_mul_f32 v5, 0x3e0293ee, v5
v_mul_f32 v6, 0x3e0293ee, v6
v_mul_f32 v7, 0x3e0293ee, v7
v_cvt_pk_bf16_f32 v16, v0, v1
v_cvt_pk_bf16_f32 v17, v2, v3
v_cvt_pk_bf16_f32 v18, v4, v5
v_cvt_pk_bf16_f32 v19, v6, v7
buffer_store_dwordx4 v[16:19], v251, s[4:7], s53 offen offset:1024 sc1
v_accvgpr_read_b32 v20, a80
v_accvgpr_read_b32 v21, a81
v_accvgpr_read_b32 v22, a82
v_accvgpr_read_b32 v23, a83
v_accvgpr_read_b32 v24, a84
v_accvgpr_read_b32 v25, a85
v_accvgpr_read_b32 v26, a86
v_accvgpr_read_b32 v27, a87
v_mul_f32 v20, 0x3e0293ee, v20
v_mul_f32 v21, 0x3e0293ee, v21
v_mul_f32 v22, 0x3e0293ee, v22
v_mul_f32 v23, 0x3e0293ee, v23
v_mul_f32 v24, 0x3e0293ee, v24
v_mul_f32 v25, 0x3e0293ee, v25
v_mul_f32 v26, 0x3e0293ee, v26
v_mul_f32 v27, 0x3e0293ee, v27
v_cvt_pk_bf16_f32 v36, v20, v21
v_cvt_pk_bf16_f32 v37, v22, v23
v_cvt_pk_bf16_f32 v38, v24, v25
v_cvt_pk_bf16_f32 v39, v26, v27
buffer_store_dwordx4 v[36:39], v251, s[4:7], s53 offen offset:2048 sc1
v_accvgpr_read_b32 v40, a88
v_accvgpr_read_b32 v41, a89
v_accvgpr_read_b32 v42, a90
v_accvgpr_read_b32 v43, a91
v_accvgpr_read_b32 v44, a92
v_accvgpr_read_b32 v45, a93
v_accvgpr_read_b32 v46, a94
v_accvgpr_read_b32 v47, a95
v_mul_f32 v40, 0x3e0293ee, v40
v_mul_f32 v41, 0x3e0293ee, v41
v_mul_f32 v42, 0x3e0293ee, v42
v_mul_f32 v43, 0x3e0293ee, v43
v_mul_f32 v44, 0x3e0293ee, v44
v_mul_f32 v45, 0x3e0293ee, v45
v_mul_f32 v46, 0x3e0293ee, v46
v_mul_f32 v47, 0x3e0293ee, v47
v_cvt_pk_bf16_f32 v56, v40, v41
v_cvt_pk_bf16_f32 v57, v42, v43
v_cvt_pk_bf16_f32 v58, v44, v45
v_cvt_pk_bf16_f32 v59, v46, v47
buffer_store_dwordx4 v[56:59], v251, s[4:7], s53 offen offset:3072 sc1
s_add_u32 s53, s53, s2
v_accvgpr_read_b32 v0, a96
v_accvgpr_read_b32 v1, a97
v_accvgpr_read_b32 v2, a98
v_accvgpr_read_b32 v3, a99
v_accvgpr_read_b32 v4, a100
v_accvgpr_read_b32 v5, a101
v_accvgpr_read_b32 v6, a102
v_accvgpr_read_b32 v7, a103
v_mul_f32 v0, 0x3e0293ee, v0
v_mul_f32 v1, 0x3e0293ee, v1
v_mul_f32 v2, 0x3e0293ee, v2
v_mul_f32 v3, 0x3e0293ee, v3
v_mul_f32 v4, 0x3e0293ee, v4
v_mul_f32 v5, 0x3e0293ee, v5
v_mul_f32 v6, 0x3e0293ee, v6
v_mul_f32 v7, 0x3e0293ee, v7
v_cvt_pk_bf16_f32 v16, v0, v1
v_cvt_pk_bf16_f32 v17, v2, v3
v_cvt_pk_bf16_f32 v18, v4, v5
v_cvt_pk_bf16_f32 v19, v6, v7
buffer_store_dwordx4 v[16:19], v251, s[4:7], s53 offen offset:0 sc1
v_accvgpr_read_b32 v20, a104
v_accvgpr_read_b32 v21, a105
v_accvgpr_read_b32 v22, a106
v_accvgpr_read_b32 v23, a107
v_accvgpr_read_b32 v24, a108
v_accvgpr_read_b32 v25, a109
v_accvgpr_read_b32 v26, a110
v_accvgpr_read_b32 v27, a111
v_mul_f32 v20, 0x3e0293ee, v20
v_mul_f32 v21, 0x3e0293ee, v21
v_mul_f32 v22, 0x3e0293ee, v22
v_mul_f32 v23, 0x3e0293ee, v23
v_mul_f32 v24, 0x3e0293ee, v24
v_mul_f32 v25, 0x3e0293ee, v25
v_mul_f32 v26, 0x3e0293ee, v26
v_mul_f32 v27, 0x3e0293ee, v27
v_cvt_pk_bf16_f32 v36, v20, v21
v_cvt_pk_bf16_f32 v37, v22, v23
v_cvt_pk_bf16_f32 v38, v24, v25
v_cvt_pk_bf16_f32 v39, v26, v27
buffer_store_dwordx4 v[36:39], v251, s[4:7], s53 offen offset:1024 sc1
v_accvgpr_read_b32 v40, a112
v_accvgpr_read_b32 v41, a113
v_accvgpr_read_b32 v42, a114
v_accvgpr_read_b32 v43, a115
v_accvgpr_read_b32 v44, a116
v_accvgpr_read_b32 v45, a117
v_accvgpr_read_b32 v46, a118
v_accvgpr_read_b32 v47, a119
v_mul_f32 v40, 0x3e0293ee, v40
v_mul_f32 v41, 0x3e0293ee, v41
v_mul_f32 v42, 0x3e0293ee, v42
v_mul_f32 v43, 0x3e0293ee, v43
v_mul_f32 v44, 0x3e0293ee, v44
v_mul_f32 v45, 0x3e0293ee, v45
v_mul_f32 v46, 0x3e0293ee, v46
v_mul_f32 v47, 0x3e0293ee, v47
v_cvt_pk_bf16_f32 v56, v40, v41
v_cvt_pk_bf16_f32 v57, v42, v43
v_cvt_pk_bf16_f32 v58, v44, v45
v_cvt_pk_bf16_f32 v59, v46, v47
buffer_store_dwordx4 v[56:59], v251, s[4:7], s53 offen offset:2048 sc1
v_accvgpr_read_b32 v0, a120
v_accvgpr_read_b32 v1, a121
v_accvgpr_read_b32 v2, a122
v_accvgpr_read_b32 v3, a123
v_accvgpr_read_b32 v4, a124
v_accvgpr_read_b32 v5, a125
v_accvgpr_read_b32 v6, a126
v_accvgpr_read_b32 v7, a127
v_mul_f32 v0, 0x3e0293ee, v0
v_mul_f32 v1, 0x3e0293ee, v1
v_mul_f32 v2, 0x3e0293ee, v2
v_mul_f32 v3, 0x3e0293ee, v3
v_mul_f32 v4, 0x3e0293ee, v4
v_mul_f32 v5, 0x3e0293ee, v5
v_mul_f32 v6, 0x3e0293ee, v6
v_mul_f32 v7, 0x3e0293ee, v7
v_cvt_pk_bf16_f32 v16, v0, v1
v_cvt_pk_bf16_f32 v17, v2, v3
v_cvt_pk_bf16_f32 v18, v4, v5
v_cvt_pk_bf16_f32 v19, v6, v7
buffer_store_dwordx4 v[16:19], v251, s[4:7], s53 offen offset:3072 sc1
s_branch main_kernel_w_ee
main_kernel_w_e8:
s_mov_b32 s53, s1
v_accvgpr_read_b32 v0, a0
v_accvgpr_read_b32 v1, a1
v_accvgpr_read_b32 v2, a2
v_accvgpr_read_b32 v3, a3
v_accvgpr_read_b32 v4, a32
v_accvgpr_read_b32 v5, a33
v_accvgpr_read_b32 v6, a34
v_accvgpr_read_b32 v7, a35
v_cvt_pk_bf16_f32 v8, v0, v1
v_cvt_pk_bf16_f32 v9, v2, v3
v_cvt_pk_bf16_f32 v10, v4, v5
v_cvt_pk_bf16_f32 v11, v6, v7
buffer_store_dwordx4 v[8:11], v251, s[4:7], s53 offen offset:0 sc1
v_accvgpr_read_b32 v16, a4
v_accvgpr_read_b32 v17, a5
v_accvgpr_read_b32 v18, a6
v_accvgpr_read_b32 v19, a7
v_accvgpr_read_b32 v20, a36
v_accvgpr_read_b32 v21, a37
v_accvgpr_read_b32 v22, a38
v_accvgpr_read_b32 v23, a39
v_cvt_pk_bf16_f32 v24, v16, v17
v_cvt_pk_bf16_f32 v25, v18, v19
v_cvt_pk_bf16_f32 v26, v20, v21
v_cvt_pk_bf16_f32 v27, v22, v23
buffer_store_dwordx4 v[24:27], v251, s[4:7], s53 offen offset:1024 sc1
v_accvgpr_read_b32 v32, a8
v_accvgpr_read_b32 v33, a9
v_accvgpr_read_b32 v34, a10
v_accvgpr_read_b32 v35, a11
v_accvgpr_read_b32 v36, a40
v_accvgpr_read_b32 v37, a41
v_accvgpr_read_b32 v38, a42
v_accvgpr_read_b32 v39, a43
v_cvt_pk_bf16_f32 v40, v32, v33
v_cvt_pk_bf16_f32 v41, v34, v35
v_cvt_pk_bf16_f32 v42, v36, v37
v_cvt_pk_bf16_f32 v43, v38, v39
buffer_store_dwordx4 v[40:43], v251, s[4:7], s53 offen offset:2048 sc1
v_accvgpr_read_b32 v48, a12
v_accvgpr_read_b32 v49, a13
v_accvgpr_read_b32 v50, a14
v_accvgpr_read_b32 v51, a15
v_accvgpr_read_b32 v52, a44
v_accvgpr_read_b32 v53, a45
v_accvgpr_read_b32 v54, a46
v_accvgpr_read_b32 v55, a47
v_cvt_pk_bf16_f32 v56, v48, v49
v_cvt_pk_bf16_f32 v57, v50, v51
v_cvt_pk_bf16_f32 v58, v52, v53
v_cvt_pk_bf16_f32 v59, v54, v55
buffer_store_dwordx4 v[56:59], v251, s[4:7], s53 offen offset:3072 sc1
s_add_u32 s53, s53, 4096
v_accvgpr_read_b32 v0, a16
v_accvgpr_read_b32 v1, a17
v_accvgpr_read_b32 v2, a18
v_accvgpr_read_b32 v3, a19
v_accvgpr_read_b32 v4, a48
v_accvgpr_read_b32 v5, a49
v_accvgpr_read_b32 v6, a50
v_accvgpr_read_b32 v7, a51
v_cvt_pk_bf16_f32 v8, v0, v1
v_cvt_pk_bf16_f32 v9, v2, v3
v_cvt_pk_bf16_f32 v10, v4, v5
v_cvt_pk_bf16_f32 v11, v6, v7
buffer_store_dwordx4 v[8:11], v251, s[4:7], s53 offen offset:0 sc1
v_accvgpr_read_b32 v16, a20
v_accvgpr_read_b32 v17, a21
v_accvgpr_read_b32 v18, a22
v_accvgpr_read_b32 v19, a23
v_accvgpr_read_b32 v20, a52
v_accvgpr_read_b32 v21, a53
v_accvgpr_read_b32 v22, a54
v_accvgpr_read_b32 v23, a55
v_cvt_pk_bf16_f32 v24, v16, v17
v_cvt_pk_bf16_f32 v25, v18, v19
v_cvt_pk_bf16_f32 v26, v20, v21
v_cvt_pk_bf16_f32 v27, v22, v23
buffer_store_dwordx4 v[24:27], v251, s[4:7], s53 offen offset:1024 sc1
v_accvgpr_read_b32 v32, a24
v_accvgpr_read_b32 v33, a25
v_accvgpr_read_b32 v34, a26
v_accvgpr_read_b32 v35, a27
v_accvgpr_read_b32 v36, a56
v_accvgpr_read_b32 v37, a57
v_accvgpr_read_b32 v38, a58
v_accvgpr_read_b32 v39, a59
v_cvt_pk_bf16_f32 v40, v32, v33
v_cvt_pk_bf16_f32 v41, v34, v35
v_cvt_pk_bf16_f32 v42, v36, v37
v_cvt_pk_bf16_f32 v43, v38, v39
buffer_store_dwordx4 v[40:43], v251, s[4:7], s53 offen offset:2048 sc1
v_accvgpr_read_b32 v48, a28
v_accvgpr_read_b32 v49, a29
v_accvgpr_read_b32 v50, a30
v_accvgpr_read_b32 v51, a31
v_accvgpr_read_b32 v52, a60
v_accvgpr_read_b32 v53, a61
v_accvgpr_read_b32 v54, a62
v_accvgpr_read_b32 v55, a63
v_cvt_pk_bf16_f32 v56, v48, v49
v_cvt_pk_bf16_f32 v57, v50, v51
v_cvt_pk_bf16_f32 v58, v52, v53
v_cvt_pk_bf16_f32 v59, v54, v55
buffer_store_dwordx4 v[56:59], v251, s[4:7], s53 offen offset:3072 sc1
s_add_u32 s53, s53, 258048
v_accvgpr_read_b32 v0, a64
v_accvgpr_read_b32 v1, a65
v_accvgpr_read_b32 v2, a66
v_accvgpr_read_b32 v3, a67
v_accvgpr_read_b32 v4, a96
v_accvgpr_read_b32 v5, a97
v_accvgpr_read_b32 v6, a98
v_accvgpr_read_b32 v7, a99
v_cvt_pk_bf16_f32 v8, v0, v1
v_cvt_pk_bf16_f32 v9, v2, v3
v_cvt_pk_bf16_f32 v10, v4, v5
v_cvt_pk_bf16_f32 v11, v6, v7
buffer_store_dwordx4 v[8:11], v251, s[4:7], s53 offen offset:0 sc1
v_accvgpr_read_b32 v16, a68
v_accvgpr_read_b32 v17, a69
v_accvgpr_read_b32 v18, a70
v_accvgpr_read_b32 v19, a71
v_accvgpr_read_b32 v20, a100
v_accvgpr_read_b32 v21, a101
v_accvgpr_read_b32 v22, a102
v_accvgpr_read_b32 v23, a103
v_cvt_pk_bf16_f32 v24, v16, v17
v_cvt_pk_bf16_f32 v25, v18, v19
v_cvt_pk_bf16_f32 v26, v20, v21
v_cvt_pk_bf16_f32 v27, v22, v23
buffer_store_dwordx4 v[24:27], v251, s[4:7], s53 offen offset:1024 sc1
v_accvgpr_read_b32 v32, a72
v_accvgpr_read_b32 v33, a73
v_accvgpr_read_b32 v34, a74
v_accvgpr_read_b32 v35, a75
v_accvgpr_read_b32 v36, a104
v_accvgpr_read_b32 v37, a105
v_accvgpr_read_b32 v38, a106
v_accvgpr_read_b32 v39, a107
v_cvt_pk_bf16_f32 v40, v32, v33
v_cvt_pk_bf16_f32 v41, v34, v35
v_cvt_pk_bf16_f32 v42, v36, v37
v_cvt_pk_bf16_f32 v43, v38, v39
buffer_store_dwordx4 v[40:43], v251, s[4:7], s53 offen offset:2048 sc1
v_accvgpr_read_b32 v48, a76
v_accvgpr_read_b32 v49, a77
v_accvgpr_read_b32 v50, a78
v_accvgpr_read_b32 v51, a79
v_accvgpr_read_b32 v52, a108
v_accvgpr_read_b32 v53, a109
v_accvgpr_read_b32 v54, a110
v_accvgpr_read_b32 v55, a111
v_cvt_pk_bf16_f32 v56, v48, v49
v_cvt_pk_bf16_f32 v57, v50, v51
v_cvt_pk_bf16_f32 v58, v52, v53
v_cvt_pk_bf16_f32 v59, v54, v55
buffer_store_dwordx4 v[56:59], v251, s[4:7], s53 offen offset:3072 sc1
s_add_u32 s53, s53, 4096
v_accvgpr_read_b32 v0, a80
v_accvgpr_read_b32 v1, a81
v_accvgpr_read_b32 v2, a82
v_accvgpr_read_b32 v3, a83
v_accvgpr_read_b32 v4, a112
v_accvgpr_read_b32 v5, a113
v_accvgpr_read_b32 v6, a114
v_accvgpr_read_b32 v7, a115
v_cvt_pk_bf16_f32 v8, v0, v1
v_cvt_pk_bf16_f32 v9, v2, v3
v_cvt_pk_bf16_f32 v10, v4, v5
v_cvt_pk_bf16_f32 v11, v6, v7
buffer_store_dwordx4 v[8:11], v251, s[4:7], s53 offen offset:0 sc1
v_accvgpr_read_b32 v16, a84
v_accvgpr_read_b32 v17, a85
v_accvgpr_read_b32 v18, a86
v_accvgpr_read_b32 v19, a87
v_accvgpr_read_b32 v20, a116
v_accvgpr_read_b32 v21, a117
v_accvgpr_read_b32 v22, a118
v_accvgpr_read_b32 v23, a119
v_cvt_pk_bf16_f32 v24, v16, v17
v_cvt_pk_bf16_f32 v25, v18, v19
v_cvt_pk_bf16_f32 v26, v20, v21
v_cvt_pk_bf16_f32 v27, v22, v23
buffer_store_dwordx4 v[24:27], v251, s[4:7], s53 offen offset:1024 sc1
v_accvgpr_read_b32 v32, a88
v_accvgpr_read_b32 v33, a89
v_accvgpr_read_b32 v34, a90
v_accvgpr_read_b32 v35, a91
v_accvgpr_read_b32 v36, a120
v_accvgpr_read_b32 v37, a121
v_accvgpr_read_b32 v38, a122
v_accvgpr_read_b32 v39, a123
v_cvt_pk_bf16_f32 v40, v32, v33
v_cvt_pk_bf16_f32 v41, v34, v35
v_cvt_pk_bf16_f32 v42, v36, v37
v_cvt_pk_bf16_f32 v43, v38, v39
buffer_store_dwordx4 v[40:43], v251, s[4:7], s53 offen offset:2048 sc1
v_accvgpr_read_b32 v48, a92
v_accvgpr_read_b32 v49, a93
v_accvgpr_read_b32 v50, a94
v_accvgpr_read_b32 v51, a95
v_accvgpr_read_b32 v52, a124
v_accvgpr_read_b32 v53, a125
v_accvgpr_read_b32 v54, a126
v_accvgpr_read_b32 v55, a127
v_cvt_pk_bf16_f32 v56, v48, v49
v_cvt_pk_bf16_f32 v57, v50, v51
v_cvt_pk_bf16_f32 v58, v52, v53
v_cvt_pk_bf16_f32 v59, v54, v55
buffer_store_dwordx4 v[56:59], v251, s[4:7], s53 offen offset:3072 sc1
s_add_u32 s53, s53, 258048
s_branch main_kernel_w_ee
main_kernel_w_e9:
s_mov_b32 s53, s1
v_accvgpr_read_b32 v0, a0
v_accvgpr_read_b32 v1, a1
v_accvgpr_read_b32 v2, a2
v_accvgpr_read_b32 v3, a3
v_accvgpr_read_b32 v4, a4
v_accvgpr_read_b32 v5, a5
v_accvgpr_read_b32 v6, a6
v_accvgpr_read_b32 v7, a7
v_pk_mul_f32 v[8:9], v[0:1], v[0:1]
v_pk_mul_f32 v[10:11], v[2:3], v[2:3]
v_pk_mul_f32 v[12:13], v[4:5], v[4:5]
v_pk_mul_f32 v[14:15], v[6:7], v[6:7]
v_pk_fma_f32 v[8:9], v[8:9], v[242:243], v[240:241]
v_pk_fma_f32 v[10:11], v[10:11], v[242:243], v[240:241]
v_pk_fma_f32 v[12:13], v[12:13], v[242:243], v[240:241]
v_pk_fma_f32 v[14:15], v[14:15], v[242:243], v[240:241]
v_pk_mul_f32 v[8:9], v[8:9], v[0:1]
v_pk_mul_f32 v[10:11], v[10:11], v[2:3]
v_pk_mul_f32 v[12:13], v[12:13], v[4:5]
v_pk_mul_f32 v[14:15], v[14:15], v[6:7]
v_exp_f32 v8, v8
v_exp_f32 v9, v9
v_exp_f32 v10, v10
v_exp_f32 v11, v11
v_exp_f32 v12, v12
v_exp_f32 v13, v13
v_exp_f32 v14, v14
v_exp_f32 v15, v15
v_pk_add_f32 v[8:9], v[8:9], v[244:245]
v_pk_add_f32 v[10:11], v[10:11], v[244:245]
v_pk_add_f32 v[12:13], v[12:13], v[244:245]
v_pk_add_f32 v[14:15], v[14:15], v[244:245]
v_rcp_f32 v8, v8
v_rcp_f32 v9, v9
v_rcp_f32 v10, v10
v_rcp_f32 v11, v11
v_rcp_f32 v12, v12
v_rcp_f32 v13, v13
v_rcp_f32 v14, v14
v_rcp_f32 v15, v15
v_pk_mul_f32 v[0:1], v[8:9], v[0:1]
v_pk_mul_f32 v[2:3], v[10:11], v[2:3]
v_pk_mul_f32 v[4:5], v[12:13], v[4:5]
v_pk_mul_f32 v[6:7], v[14:15], v[6:7]
v_cvt_pk_bf16_f32 v16, v0, v1
v_cvt_pk_bf16_f32 v17, v2, v3
v_cvt_pk_bf16_f32 v18, v4, v5
v_cvt_pk_bf16_f32 v19, v6, v7
buffer_store_dwordx4 v[16:19], v145, s[4:7], s53 offen offset:0 sc1
v_accvgpr_read_b32 v20, a8
v_accvgpr_read_b32 v21, a9
v_accvgpr_read_b32 v22, a10
v_accvgpr_read_b32 v23, a11
v_accvgpr_read_b32 v24, a12
v_accvgpr_read_b32 v25, a13
v_accvgpr_read_b32 v26, a14
v_accvgpr_read_b32 v27, a15
v_pk_mul_f32 v[28:29], v[20:21], v[20:21]
v_pk_mul_f32 v[30:31], v[22:23], v[22:23]
v_pk_mul_f32 v[32:33], v[24:25], v[24:25]
v_pk_mul_f32 v[34:35], v[26:27], v[26:27]
v_pk_fma_f32 v[28:29], v[28:29], v[242:243], v[240:241]
v_pk_fma_f32 v[30:31], v[30:31], v[242:243], v[240:241]
v_pk_fma_f32 v[32:33], v[32:33], v[242:243], v[240:241]
v_pk_fma_f32 v[34:35], v[34:35], v[242:243], v[240:241]
v_pk_mul_f32 v[28:29], v[28:29], v[20:21]
v_pk_mul_f32 v[30:31], v[30:31], v[22:23]
v_pk_mul_f32 v[32:33], v[32:33], v[24:25]
v_pk_mul_f32 v[34:35], v[34:35], v[26:27]
v_exp_f32 v28, v28
v_exp_f32 v29, v29
v_exp_f32 v30, v30
v_exp_f32 v31, v31
v_exp_f32 v32, v32
v_exp_f32 v33, v33
v_exp_f32 v34, v34
v_exp_f32 v35, v35
v_pk_add_f32 v[28:29], v[28:29], v[244:245]
v_pk_add_f32 v[30:31], v[30:31], v[244:245]
v_pk_add_f32 v[32:33], v[32:33], v[244:245]
v_pk_add_f32 v[34:35], v[34:35], v[244:245]
v_rcp_f32 v28, v28
v_rcp_f32 v29, v29
v_rcp_f32 v30, v30
v_rcp_f32 v31, v31
v_rcp_f32 v32, v32
v_rcp_f32 v33, v33
v_rcp_f32 v34, v34
v_rcp_f32 v35, v35
v_pk_mul_f32 v[20:21], v[28:29], v[20:21]
v_pk_mul_f32 v[22:23], v[30:31], v[22:23]
v_pk_mul_f32 v[24:25], v[32:33], v[24:25]
v_pk_mul_f32 v[26:27], v[34:35], v[26:27]
v_cvt_pk_bf16_f32 v36, v20, v21
v_cvt_pk_bf16_f32 v37, v22, v23
v_cvt_pk_bf16_f32 v38, v24, v25
v_cvt_pk_bf16_f32 v39, v26, v27
buffer_store_dwordx4 v[36:39], v145, s[4:7], s53 offen offset:1024 sc1
v_accvgpr_read_b32 v40, a16
v_accvgpr_read_b32 v41, a17
v_accvgpr_read_b32 v42, a18
v_accvgpr_read_b32 v43, a19
v_accvgpr_read_b32 v44, a20
v_accvgpr_read_b32 v45, a21
v_accvgpr_read_b32 v46, a22
v_accvgpr_read_b32 v47, a23
v_pk_mul_f32 v[48:49], v[40:41], v[40:41]
v_pk_mul_f32 v[50:51], v[42:43], v[42:43]
v_pk_mul_f32 v[52:53], v[44:45], v[44:45]
v_pk_mul_f32 v[54:55], v[46:47], v[46:47]
v_pk_fma_f32 v[48:49], v[48:49], v[242:243], v[240:241]
v_pk_fma_f32 v[50:51], v[50:51], v[242:243], v[240:241]
v_pk_fma_f32 v[52:53], v[52:53], v[242:243], v[240:241]
v_pk_fma_f32 v[54:55], v[54:55], v[242:243], v[240:241]
v_pk_mul_f32 v[48:49], v[48:49], v[40:41]
v_pk_mul_f32 v[50:51], v[50:51], v[42:43]
v_pk_mul_f32 v[52:53], v[52:53], v[44:45]
v_pk_mul_f32 v[54:55], v[54:55], v[46:47]
v_exp_f32 v48, v48
v_exp_f32 v49, v49
v_exp_f32 v50, v50
v_exp_f32 v51, v51
v_exp_f32 v52, v52
v_exp_f32 v53, v53
v_exp_f32 v54, v54
v_exp_f32 v55, v55
v_pk_add_f32 v[48:49], v[48:49], v[244:245]
v_pk_add_f32 v[50:51], v[50:51], v[244:245]
v_pk_add_f32 v[52:53], v[52:53], v[244:245]
v_pk_add_f32 v[54:55], v[54:55], v[244:245]
v_rcp_f32 v48, v48
v_rcp_f32 v49, v49
v_rcp_f32 v50, v50
v_rcp_f32 v51, v51
v_rcp_f32 v52, v52
v_rcp_f32 v53, v53
v_rcp_f32 v54, v54
v_rcp_f32 v55, v55
v_pk_mul_f32 v[40:41], v[48:49], v[40:41]
v_pk_mul_f32 v[42:43], v[50:51], v[42:43]
v_pk_mul_f32 v[44:45], v[52:53], v[44:45]
v_pk_mul_f32 v[46:47], v[54:55], v[46:47]
v_cvt_pk_bf16_f32 v56, v40, v41
v_cvt_pk_bf16_f32 v57, v42, v43
v_cvt_pk_bf16_f32 v58, v44, v45
v_cvt_pk_bf16_f32 v59, v46, v47
buffer_store_dwordx4 v[56:59], v145, s[4:7], s53 offen offset:2048 sc1
v_accvgpr_read_b32 v0, a24
v_accvgpr_read_b32 v1, a25
v_accvgpr_read_b32 v2, a26
v_accvgpr_read_b32 v3, a27
v_accvgpr_read_b32 v4, a28
v_accvgpr_read_b32 v5, a29
v_accvgpr_read_b32 v6, a30
v_accvgpr_read_b32 v7, a31
v_pk_mul_f32 v[8:9], v[0:1], v[0:1]
v_pk_mul_f32 v[10:11], v[2:3], v[2:3]
v_pk_mul_f32 v[12:13], v[4:5], v[4:5]
v_pk_mul_f32 v[14:15], v[6:7], v[6:7]
v_pk_fma_f32 v[8:9], v[8:9], v[242:243], v[240:241]
v_pk_fma_f32 v[10:11], v[10:11], v[242:243], v[240:241]
v_pk_fma_f32 v[12:13], v[12:13], v[242:243], v[240:241]
v_pk_fma_f32 v[14:15], v[14:15], v[242:243], v[240:241]
v_pk_mul_f32 v[8:9], v[8:9], v[0:1]
v_pk_mul_f32 v[10:11], v[10:11], v[2:3]
v_pk_mul_f32 v[12:13], v[12:13], v[4:5]
v_pk_mul_f32 v[14:15], v[14:15], v[6:7]
v_exp_f32 v8, v8
v_exp_f32 v9, v9
v_exp_f32 v10, v10
v_exp_f32 v11, v11
v_exp_f32 v12, v12
v_exp_f32 v13, v13
v_exp_f32 v14, v14
v_exp_f32 v15, v15
v_pk_add_f32 v[8:9], v[8:9], v[244:245]
v_pk_add_f32 v[10:11], v[10:11], v[244:245]
v_pk_add_f32 v[12:13], v[12:13], v[244:245]
v_pk_add_f32 v[14:15], v[14:15], v[244:245]
v_rcp_f32 v8, v8
v_rcp_f32 v9, v9
v_rcp_f32 v10, v10
v_rcp_f32 v11, v11
v_rcp_f32 v12, v12
v_rcp_f32 v13, v13
v_rcp_f32 v14, v14
v_rcp_f32 v15, v15
v_pk_mul_f32 v[0:1], v[8:9], v[0:1]
v_pk_mul_f32 v[2:3], v[10:11], v[2:3]
v_pk_mul_f32 v[4:5], v[12:13], v[4:5]
v_pk_mul_f32 v[6:7], v[14:15], v[6:7]
v_cvt_pk_bf16_f32 v16, v0, v1
v_cvt_pk_bf16_f32 v17, v2, v3
v_cvt_pk_bf16_f32 v18, v4, v5
v_cvt_pk_bf16_f32 v19, v6, v7
buffer_store_dwordx4 v[16:19], v145, s[4:7], s53 offen offset:3072 sc1
s_add_u32 s53, s53, s2
v_accvgpr_read_b32 v20, a32
v_accvgpr_read_b32 v21, a33
v_accvgpr_read_b32 v22, a34
v_accvgpr_read_b32 v23, a35
v_accvgpr_read_b32 v24, a36
v_accvgpr_read_b32 v25, a37
v_accvgpr_read_b32 v26, a38
v_accvgpr_read_b32 v27, a39
v_pk_mul_f32 v[28:29], v[20:21], v[20:21]
v_pk_mul_f32 v[30:31], v[22:23], v[22:23]
v_pk_mul_f32 v[32:33], v[24:25], v[24:25]
v_pk_mul_f32 v[34:35], v[26:27], v[26:27]
v_pk_fma_f32 v[28:29], v[28:29], v[242:243], v[240:241]
v_pk_fma_f32 v[30:31], v[30:31], v[242:243], v[240:241]
v_pk_fma_f32 v[32:33], v[32:33], v[242:243], v[240:241]
v_pk_fma_f32 v[34:35], v[34:35], v[242:243], v[240:241]
v_pk_mul_f32 v[28:29], v[28:29], v[20:21]
v_pk_mul_f32 v[30:31], v[30:31], v[22:23]
v_pk_mul_f32 v[32:33], v[32:33], v[24:25]
v_pk_mul_f32 v[34:35], v[34:35], v[26:27]
v_exp_f32 v28, v28
v_exp_f32 v29, v29
v_exp_f32 v30, v30
v_exp_f32 v31, v31
v_exp_f32 v32, v32
v_exp_f32 v33, v33
v_exp_f32 v34, v34
v_exp_f32 v35, v35
v_pk_add_f32 v[28:29], v[28:29], v[244:245]
v_pk_add_f32 v[30:31], v[30:31], v[244:245]
v_pk_add_f32 v[32:33], v[32:33], v[244:245]
v_pk_add_f32 v[34:35], v[34:35], v[244:245]
v_rcp_f32 v28, v28
v_rcp_f32 v29, v29
v_rcp_f32 v30, v30
v_rcp_f32 v31, v31
v_rcp_f32 v32, v32
v_rcp_f32 v33, v33
v_rcp_f32 v34, v34
v_rcp_f32 v35, v35
v_pk_mul_f32 v[20:21], v[28:29], v[20:21]
v_pk_mul_f32 v[22:23], v[30:31], v[22:23]
v_pk_mul_f32 v[24:25], v[32:33], v[24:25]
v_pk_mul_f32 v[26:27], v[34:35], v[26:27]
v_cvt_pk_bf16_f32 v36, v20, v21
v_cvt_pk_bf16_f32 v37, v22, v23
v_cvt_pk_bf16_f32 v38, v24, v25
v_cvt_pk_bf16_f32 v39, v26, v27
buffer_store_dwordx4 v[36:39], v145, s[4:7], s53 offen offset:0 sc1
v_accvgpr_read_b32 v40, a40
v_accvgpr_read_b32 v41, a41
v_accvgpr_read_b32 v42, a42
v_accvgpr_read_b32 v43, a43
v_accvgpr_read_b32 v44, a44
v_accvgpr_read_b32 v45, a45
v_accvgpr_read_b32 v46, a46
v_accvgpr_read_b32 v47, a47
v_pk_mul_f32 v[48:49], v[40:41], v[40:41]
v_pk_mul_f32 v[50:51], v[42:43], v[42:43]
v_pk_mul_f32 v[52:53], v[44:45], v[44:45]
v_pk_mul_f32 v[54:55], v[46:47], v[46:47]
v_pk_fma_f32 v[48:49], v[48:49], v[242:243], v[240:241]
v_pk_fma_f32 v[50:51], v[50:51], v[242:243], v[240:241]
v_pk_fma_f32 v[52:53], v[52:53], v[242:243], v[240:241]
v_pk_fma_f32 v[54:55], v[54:55], v[242:243], v[240:241]
v_pk_mul_f32 v[48:49], v[48:49], v[40:41]
v_pk_mul_f32 v[50:51], v[50:51], v[42:43]
v_pk_mul_f32 v[52:53], v[52:53], v[44:45]
v_pk_mul_f32 v[54:55], v[54:55], v[46:47]
v_exp_f32 v48, v48
v_exp_f32 v49, v49
v_exp_f32 v50, v50
v_exp_f32 v51, v51
v_exp_f32 v52, v52
v_exp_f32 v53, v53
v_exp_f32 v54, v54
v_exp_f32 v55, v55
v_pk_add_f32 v[48:49], v[48:49], v[244:245]
v_pk_add_f32 v[50:51], v[50:51], v[244:245]
v_pk_add_f32 v[52:53], v[52:53], v[244:245]
v_pk_add_f32 v[54:55], v[54:55], v[244:245]
v_rcp_f32 v48, v48
v_rcp_f32 v49, v49
v_rcp_f32 v50, v50
v_rcp_f32 v51, v51
v_rcp_f32 v52, v52
v_rcp_f32 v53, v53
v_rcp_f32 v54, v54
v_rcp_f32 v55, v55
v_pk_mul_f32 v[40:41], v[48:49], v[40:41]
v_pk_mul_f32 v[42:43], v[50:51], v[42:43]
v_pk_mul_f32 v[44:45], v[52:53], v[44:45]
v_pk_mul_f32 v[46:47], v[54:55], v[46:47]
v_cvt_pk_bf16_f32 v56, v40, v41
v_cvt_pk_bf16_f32 v57, v42, v43
v_cvt_pk_bf16_f32 v58, v44, v45
v_cvt_pk_bf16_f32 v59, v46, v47
buffer_store_dwordx4 v[56:59], v145, s[4:7], s53 offen offset:1024 sc1
v_accvgpr_read_b32 v0, a48
v_accvgpr_read_b32 v1, a49
v_accvgpr_read_b32 v2, a50
v_accvgpr_read_b32 v3, a51
v_accvgpr_read_b32 v4, a52
v_accvgpr_read_b32 v5, a53
v_accvgpr_read_b32 v6, a54
v_accvgpr_read_b32 v7, a55
v_pk_mul_f32 v[8:9], v[0:1], v[0:1]
v_pk_mul_f32 v[10:11], v[2:3], v[2:3]
v_pk_mul_f32 v[12:13], v[4:5], v[4:5]
v_pk_mul_f32 v[14:15], v[6:7], v[6:7]
v_pk_fma_f32 v[8:9], v[8:9], v[242:243], v[240:241]
v_pk_fma_f32 v[10:11], v[10:11], v[242:243], v[240:241]
v_pk_fma_f32 v[12:13], v[12:13], v[242:243], v[240:241]
v_pk_fma_f32 v[14:15], v[14:15], v[242:243], v[240:241]
v_pk_mul_f32 v[8:9], v[8:9], v[0:1]
v_pk_mul_f32 v[10:11], v[10:11], v[2:3]
v_pk_mul_f32 v[12:13], v[12:13], v[4:5]
v_pk_mul_f32 v[14:15], v[14:15], v[6:7]
v_exp_f32 v8, v8
v_exp_f32 v9, v9
v_exp_f32 v10, v10
v_exp_f32 v11, v11
v_exp_f32 v12, v12
v_exp_f32 v13, v13
v_exp_f32 v14, v14
v_exp_f32 v15, v15
v_pk_add_f32 v[8:9], v[8:9], v[244:245]
v_pk_add_f32 v[10:11], v[10:11], v[244:245]
v_pk_add_f32 v[12:13], v[12:13], v[244:245]
v_pk_add_f32 v[14:15], v[14:15], v[244:245]
v_rcp_f32 v8, v8
v_rcp_f32 v9, v9
v_rcp_f32 v10, v10
v_rcp_f32 v11, v11
v_rcp_f32 v12, v12
v_rcp_f32 v13, v13
v_rcp_f32 v14, v14
v_rcp_f32 v15, v15
v_pk_mul_f32 v[0:1], v[8:9], v[0:1]
v_pk_mul_f32 v[2:3], v[10:11], v[2:3]
v_pk_mul_f32 v[4:5], v[12:13], v[4:5]
v_pk_mul_f32 v[6:7], v[14:15], v[6:7]
v_cvt_pk_bf16_f32 v16, v0, v1
v_cvt_pk_bf16_f32 v17, v2, v3
v_cvt_pk_bf16_f32 v18, v4, v5
v_cvt_pk_bf16_f32 v19, v6, v7
buffer_store_dwordx4 v[16:19], v145, s[4:7], s53 offen offset:2048 sc1
v_accvgpr_read_b32 v20, a56
v_accvgpr_read_b32 v21, a57
v_accvgpr_read_b32 v22, a58
v_accvgpr_read_b32 v23, a59
v_accvgpr_read_b32 v24, a60
v_accvgpr_read_b32 v25, a61
v_accvgpr_read_b32 v26, a62
v_accvgpr_read_b32 v27, a63
v_pk_mul_f32 v[28:29], v[20:21], v[20:21]
v_pk_mul_f32 v[30:31], v[22:23], v[22:23]
v_pk_mul_f32 v[32:33], v[24:25], v[24:25]
v_pk_mul_f32 v[34:35], v[26:27], v[26:27]
v_pk_fma_f32 v[28:29], v[28:29], v[242:243], v[240:241]
v_pk_fma_f32 v[30:31], v[30:31], v[242:243], v[240:241]
v_pk_fma_f32 v[32:33], v[32:33], v[242:243], v[240:241]
v_pk_fma_f32 v[34:35], v[34:35], v[242:243], v[240:241]
v_pk_mul_f32 v[28:29], v[28:29], v[20:21]
v_pk_mul_f32 v[30:31], v[30:31], v[22:23]
v_pk_mul_f32 v[32:33], v[32:33], v[24:25]
v_pk_mul_f32 v[34:35], v[34:35], v[26:27]
v_exp_f32 v28, v28
v_exp_f32 v29, v29
v_exp_f32 v30, v30
v_exp_f32 v31, v31
v_exp_f32 v32, v32
v_exp_f32 v33, v33
v_exp_f32 v34, v34
v_exp_f32 v35, v35
v_pk_add_f32 v[28:29], v[28:29], v[244:245]
v_pk_add_f32 v[30:31], v[30:31], v[244:245]
v_pk_add_f32 v[32:33], v[32:33], v[244:245]
v_pk_add_f32 v[34:35], v[34:35], v[244:245]
v_rcp_f32 v28, v28
v_rcp_f32 v29, v29
v_rcp_f32 v30, v30
v_rcp_f32 v31, v31
v_rcp_f32 v32, v32
v_rcp_f32 v33, v33
v_rcp_f32 v34, v34
v_rcp_f32 v35, v35
v_pk_mul_f32 v[20:21], v[28:29], v[20:21]
v_pk_mul_f32 v[22:23], v[30:31], v[22:23]
v_pk_mul_f32 v[24:25], v[32:33], v[24:25]
v_pk_mul_f32 v[26:27], v[34:35], v[26:27]
v_cvt_pk_bf16_f32 v36, v20, v21
v_cvt_pk_bf16_f32 v37, v22, v23
v_cvt_pk_bf16_f32 v38, v24, v25
v_cvt_pk_bf16_f32 v39, v26, v27
buffer_store_dwordx4 v[36:39], v145, s[4:7], s53 offen offset:3072 sc1
s_add_u32 s53, s53, s2
v_accvgpr_read_b32 v40, a64
v_accvgpr_read_b32 v41, a65
v_accvgpr_read_b32 v42, a66
v_accvgpr_read_b32 v43, a67
v_accvgpr_read_b32 v44, a68
v_accvgpr_read_b32 v45, a69
v_accvgpr_read_b32 v46, a70
v_accvgpr_read_b32 v47, a71
v_pk_mul_f32 v[48:49], v[40:41], v[40:41]
v_pk_mul_f32 v[50:51], v[42:43], v[42:43]
v_pk_mul_f32 v[52:53], v[44:45], v[44:45]
v_pk_mul_f32 v[54:55], v[46:47], v[46:47]
v_pk_fma_f32 v[48:49], v[48:49], v[242:243], v[240:241]
v_pk_fma_f32 v[50:51], v[50:51], v[242:243], v[240:241]
v_pk_fma_f32 v[52:53], v[52:53], v[242:243], v[240:241]
v_pk_fma_f32 v[54:55], v[54:55], v[242:243], v[240:241]
v_pk_mul_f32 v[48:49], v[48:49], v[40:41]
v_pk_mul_f32 v[50:51], v[50:51], v[42:43]
v_pk_mul_f32 v[52:53], v[52:53], v[44:45]
v_pk_mul_f32 v[54:55], v[54:55], v[46:47]
v_exp_f32 v48, v48
v_exp_f32 v49, v49
v_exp_f32 v50, v50
v_exp_f32 v51, v51
v_exp_f32 v52, v52
v_exp_f32 v53, v53
v_exp_f32 v54, v54
v_exp_f32 v55, v55
v_pk_add_f32 v[48:49], v[48:49], v[244:245]
v_pk_add_f32 v[50:51], v[50:51], v[244:245]
v_pk_add_f32 v[52:53], v[52:53], v[244:245]
v_pk_add_f32 v[54:55], v[54:55], v[244:245]
v_rcp_f32 v48, v48
v_rcp_f32 v49, v49
v_rcp_f32 v50, v50
v_rcp_f32 v51, v51
v_rcp_f32 v52, v52
v_rcp_f32 v53, v53
v_rcp_f32 v54, v54
v_rcp_f32 v55, v55
v_pk_mul_f32 v[40:41], v[48:49], v[40:41]
v_pk_mul_f32 v[42:43], v[50:51], v[42:43]
v_pk_mul_f32 v[44:45], v[52:53], v[44:45]
v_pk_mul_f32 v[46:47], v[54:55], v[46:47]
v_cvt_pk_bf16_f32 v56, v40, v41
v_cvt_pk_bf16_f32 v57, v42, v43
v_cvt_pk_bf16_f32 v58, v44, v45
v_cvt_pk_bf16_f32 v59, v46, v47
buffer_store_dwordx4 v[56:59], v145, s[4:7], s53 offen offset:0 sc1
v_accvgpr_read_b32 v0, a72
v_accvgpr_read_b32 v1, a73
v_accvgpr_read_b32 v2, a74
v_accvgpr_read_b32 v3, a75
v_accvgpr_read_b32 v4, a76
v_accvgpr_read_b32 v5, a77
v_accvgpr_read_b32 v6, a78
v_accvgpr_read_b32 v7, a79
v_pk_mul_f32 v[8:9], v[0:1], v[0:1]
v_pk_mul_f32 v[10:11], v[2:3], v[2:3]
v_pk_mul_f32 v[12:13], v[4:5], v[4:5]
v_pk_mul_f32 v[14:15], v[6:7], v[6:7]
v_pk_fma_f32 v[8:9], v[8:9], v[242:243], v[240:241]
v_pk_fma_f32 v[10:11], v[10:11], v[242:243], v[240:241]
v_pk_fma_f32 v[12:13], v[12:13], v[242:243], v[240:241]
v_pk_fma_f32 v[14:15], v[14:15], v[242:243], v[240:241]
v_pk_mul_f32 v[8:9], v[8:9], v[0:1]
v_pk_mul_f32 v[10:11], v[10:11], v[2:3]
v_pk_mul_f32 v[12:13], v[12:13], v[4:5]
v_pk_mul_f32 v[14:15], v[14:15], v[6:7]
v_exp_f32 v8, v8
v_exp_f32 v9, v9
v_exp_f32 v10, v10
v_exp_f32 v11, v11
v_exp_f32 v12, v12
v_exp_f32 v13, v13
v_exp_f32 v14, v14
v_exp_f32 v15, v15
v_pk_add_f32 v[8:9], v[8:9], v[244:245]
v_pk_add_f32 v[10:11], v[10:11], v[244:245]
v_pk_add_f32 v[12:13], v[12:13], v[244:245]
v_pk_add_f32 v[14:15], v[14:15], v[244:245]
v_rcp_f32 v8, v8
v_rcp_f32 v9, v9
v_rcp_f32 v10, v10
v_rcp_f32 v11, v11
v_rcp_f32 v12, v12
v_rcp_f32 v13, v13
v_rcp_f32 v14, v14
v_rcp_f32 v15, v15
v_pk_mul_f32 v[0:1], v[8:9], v[0:1]
v_pk_mul_f32 v[2:3], v[10:11], v[2:3]
v_pk_mul_f32 v[4:5], v[12:13], v[4:5]
v_pk_mul_f32 v[6:7], v[14:15], v[6:7]
v_cvt_pk_bf16_f32 v16, v0, v1
v_cvt_pk_bf16_f32 v17, v2, v3
v_cvt_pk_bf16_f32 v18, v4, v5
v_cvt_pk_bf16_f32 v19, v6, v7
buffer_store_dwordx4 v[16:19], v145, s[4:7], s53 offen offset:1024 sc1
v_accvgpr_read_b32 v20, a80
v_accvgpr_read_b32 v21, a81
v_accvgpr_read_b32 v22, a82
v_accvgpr_read_b32 v23, a83
v_accvgpr_read_b32 v24, a84
v_accvgpr_read_b32 v25, a85
v_accvgpr_read_b32 v26, a86
v_accvgpr_read_b32 v27, a87
v_pk_mul_f32 v[28:29], v[20:21], v[20:21]
v_pk_mul_f32 v[30:31], v[22:23], v[22:23]
v_pk_mul_f32 v[32:33], v[24:25], v[24:25]
v_pk_mul_f32 v[34:35], v[26:27], v[26:27]
v_pk_fma_f32 v[28:29], v[28:29], v[242:243], v[240:241]
v_pk_fma_f32 v[30:31], v[30:31], v[242:243], v[240:241]
v_pk_fma_f32 v[32:33], v[32:33], v[242:243], v[240:241]
v_pk_fma_f32 v[34:35], v[34:35], v[242:243], v[240:241]
v_pk_mul_f32 v[28:29], v[28:29], v[20:21]
v_pk_mul_f32 v[30:31], v[30:31], v[22:23]
v_pk_mul_f32 v[32:33], v[32:33], v[24:25]
v_pk_mul_f32 v[34:35], v[34:35], v[26:27]
v_exp_f32 v28, v28
v_exp_f32 v29, v29
v_exp_f32 v30, v30
v_exp_f32 v31, v31
v_exp_f32 v32, v32
v_exp_f32 v33, v33
v_exp_f32 v34, v34
v_exp_f32 v35, v35
v_pk_add_f32 v[28:29], v[28:29], v[244:245]
v_pk_add_f32 v[30:31], v[30:31], v[244:245]
v_pk_add_f32 v[32:33], v[32:33], v[244:245]
v_pk_add_f32 v[34:35], v[34:35], v[244:245]
v_rcp_f32 v28, v28
v_rcp_f32 v29, v29
v_rcp_f32 v30, v30
v_rcp_f32 v31, v31
v_rcp_f32 v32, v32
v_rcp_f32 v33, v33
v_rcp_f32 v34, v34
v_rcp_f32 v35, v35
v_pk_mul_f32 v[20:21], v[28:29], v[20:21]
v_pk_mul_f32 v[22:23], v[30:31], v[22:23]
v_pk_mul_f32 v[24:25], v[32:33], v[24:25]
v_pk_mul_f32 v[26:27], v[34:35], v[26:27]
v_cvt_pk_bf16_f32 v36, v20, v21
v_cvt_pk_bf16_f32 v37, v22, v23
v_cvt_pk_bf16_f32 v38, v24, v25
v_cvt_pk_bf16_f32 v39, v26, v27
buffer_store_dwordx4 v[36:39], v145, s[4:7], s53 offen offset:2048 sc1
v_accvgpr_read_b32 v40, a88
v_accvgpr_read_b32 v41, a89
v_accvgpr_read_b32 v42, a90
v_accvgpr_read_b32 v43, a91
v_accvgpr_read_b32 v44, a92
v_accvgpr_read_b32 v45, a93
v_accvgpr_read_b32 v46, a94
v_accvgpr_read_b32 v47, a95
v_pk_mul_f32 v[48:49], v[40:41], v[40:41]
v_pk_mul_f32 v[50:51], v[42:43], v[42:43]
v_pk_mul_f32 v[52:53], v[44:45], v[44:45]
v_pk_mul_f32 v[54:55], v[46:47], v[46:47]
v_pk_fma_f32 v[48:49], v[48:49], v[242:243], v[240:241]
v_pk_fma_f32 v[50:51], v[50:51], v[242:243], v[240:241]
v_pk_fma_f32 v[52:53], v[52:53], v[242:243], v[240:241]
v_pk_fma_f32 v[54:55], v[54:55], v[242:243], v[240:241]
v_pk_mul_f32 v[48:49], v[48:49], v[40:41]
v_pk_mul_f32 v[50:51], v[50:51], v[42:43]
v_pk_mul_f32 v[52:53], v[52:53], v[44:45]
v_pk_mul_f32 v[54:55], v[54:55], v[46:47]
v_exp_f32 v48, v48
v_exp_f32 v49, v49
v_exp_f32 v50, v50
v_exp_f32 v51, v51
v_exp_f32 v52, v52
v_exp_f32 v53, v53
v_exp_f32 v54, v54
v_exp_f32 v55, v55
v_pk_add_f32 v[48:49], v[48:49], v[244:245]
v_pk_add_f32 v[50:51], v[50:51], v[244:245]
v_pk_add_f32 v[52:53], v[52:53], v[244:245]
v_pk_add_f32 v[54:55], v[54:55], v[244:245]
v_rcp_f32 v48, v48
v_rcp_f32 v49, v49
v_rcp_f32 v50, v50
v_rcp_f32 v51, v51
v_rcp_f32 v52, v52
v_rcp_f32 v53, v53
v_rcp_f32 v54, v54
v_rcp_f32 v55, v55
v_pk_mul_f32 v[40:41], v[48:49], v[40:41]
v_pk_mul_f32 v[42:43], v[50:51], v[42:43]
v_pk_mul_f32 v[44:45], v[52:53], v[44:45]
v_pk_mul_f32 v[46:47], v[54:55], v[46:47]
v_cvt_pk_bf16_f32 v56, v40, v41
v_cvt_pk_bf16_f32 v57, v42, v43
v_cvt_pk_bf16_f32 v58, v44, v45
v_cvt_pk_bf16_f32 v59, v46, v47
buffer_store_dwordx4 v[56:59], v145, s[4:7], s53 offen offset:3072 sc1
s_add_u32 s53, s53, s2
v_accvgpr_read_b32 v0, a96
v_accvgpr_read_b32 v1, a97
v_accvgpr_read_b32 v2, a98
v_accvgpr_read_b32 v3, a99
v_accvgpr_read_b32 v4, a100
v_accvgpr_read_b32 v5, a101
v_accvgpr_read_b32 v6, a102
v_accvgpr_read_b32 v7, a103
v_pk_mul_f32 v[8:9], v[0:1], v[0:1]
v_pk_mul_f32 v[10:11], v[2:3], v[2:3]
v_pk_mul_f32 v[12:13], v[4:5], v[4:5]
v_pk_mul_f32 v[14:15], v[6:7], v[6:7]
v_pk_fma_f32 v[8:9], v[8:9], v[242:243], v[240:241]
v_pk_fma_f32 v[10:11], v[10:11], v[242:243], v[240:241]
v_pk_fma_f32 v[12:13], v[12:13], v[242:243], v[240:241]
v_pk_fma_f32 v[14:15], v[14:15], v[242:243], v[240:241]
v_pk_mul_f32 v[8:9], v[8:9], v[0:1]
v_pk_mul_f32 v[10:11], v[10:11], v[2:3]
v_pk_mul_f32 v[12:13], v[12:13], v[4:5]
v_pk_mul_f32 v[14:15], v[14:15], v[6:7]
v_exp_f32 v8, v8
v_exp_f32 v9, v9
v_exp_f32 v10, v10
v_exp_f32 v11, v11
v_exp_f32 v12, v12
v_exp_f32 v13, v13
v_exp_f32 v14, v14
v_exp_f32 v15, v15
v_pk_add_f32 v[8:9], v[8:9], v[244:245]
v_pk_add_f32 v[10:11], v[10:11], v[244:245]
v_pk_add_f32 v[12:13], v[12:13], v[244:245]
v_pk_add_f32 v[14:15], v[14:15], v[244:245]
v_rcp_f32 v8, v8
v_rcp_f32 v9, v9
v_rcp_f32 v10, v10
v_rcp_f32 v11, v11
v_rcp_f32 v12, v12
v_rcp_f32 v13, v13
v_rcp_f32 v14, v14
v_rcp_f32 v15, v15
v_pk_mul_f32 v[0:1], v[8:9], v[0:1]
v_pk_mul_f32 v[2:3], v[10:11], v[2:3]
v_pk_mul_f32 v[4:5], v[12:13], v[4:5]
v_pk_mul_f32 v[6:7], v[14:15], v[6:7]
v_cvt_pk_bf16_f32 v16, v0, v1
v_cvt_pk_bf16_f32 v17, v2, v3
v_cvt_pk_bf16_f32 v18, v4, v5
v_cvt_pk_bf16_f32 v19, v6, v7
buffer_store_dwordx4 v[16:19], v145, s[4:7], s53 offen offset:0 sc1
v_accvgpr_read_b32 v20, a104
v_accvgpr_read_b32 v21, a105
v_accvgpr_read_b32 v22, a106
v_accvgpr_read_b32 v23, a107
v_accvgpr_read_b32 v24, a108
v_accvgpr_read_b32 v25, a109
v_accvgpr_read_b32 v26, a110
v_accvgpr_read_b32 v27, a111
v_pk_mul_f32 v[28:29], v[20:21], v[20:21]
v_pk_mul_f32 v[30:31], v[22:23], v[22:23]
v_pk_mul_f32 v[32:33], v[24:25], v[24:25]
v_pk_mul_f32 v[34:35], v[26:27], v[26:27]
v_pk_fma_f32 v[28:29], v[28:29], v[242:243], v[240:241]
v_pk_fma_f32 v[30:31], v[30:31], v[242:243], v[240:241]
v_pk_fma_f32 v[32:33], v[32:33], v[242:243], v[240:241]
v_pk_fma_f32 v[34:35], v[34:35], v[242:243], v[240:241]
v_pk_mul_f32 v[28:29], v[28:29], v[20:21]
v_pk_mul_f32 v[30:31], v[30:31], v[22:23]
v_pk_mul_f32 v[32:33], v[32:33], v[24:25]
v_pk_mul_f32 v[34:35], v[34:35], v[26:27]
v_exp_f32 v28, v28
v_exp_f32 v29, v29
v_exp_f32 v30, v30
v_exp_f32 v31, v31
v_exp_f32 v32, v32
v_exp_f32 v33, v33
v_exp_f32 v34, v34
v_exp_f32 v35, v35
v_pk_add_f32 v[28:29], v[28:29], v[244:245]
v_pk_add_f32 v[30:31], v[30:31], v[244:245]
v_pk_add_f32 v[32:33], v[32:33], v[244:245]
v_pk_add_f32 v[34:35], v[34:35], v[244:245]
v_rcp_f32 v28, v28
v_rcp_f32 v29, v29
v_rcp_f32 v30, v30
v_rcp_f32 v31, v31
v_rcp_f32 v32, v32
v_rcp_f32 v33, v33
v_rcp_f32 v34, v34
v_rcp_f32 v35, v35
v_pk_mul_f32 v[20:21], v[28:29], v[20:21]
v_pk_mul_f32 v[22:23], v[30:31], v[22:23]
v_pk_mul_f32 v[24:25], v[32:33], v[24:25]
v_pk_mul_f32 v[26:27], v[34:35], v[26:27]
v_cvt_pk_bf16_f32 v36, v20, v21
v_cvt_pk_bf16_f32 v37, v22, v23
v_cvt_pk_bf16_f32 v38, v24, v25
v_cvt_pk_bf16_f32 v39, v26, v27
buffer_store_dwordx4 v[36:39], v145, s[4:7], s53 offen offset:1024 sc1
v_accvgpr_read_b32 v40, a112
v_accvgpr_read_b32 v41, a113
v_accvgpr_read_b32 v42, a114
v_accvgpr_read_b32 v43, a115
v_accvgpr_read_b32 v44, a116
v_accvgpr_read_b32 v45, a117
v_accvgpr_read_b32 v46, a118
v_accvgpr_read_b32 v47, a119
v_pk_mul_f32 v[48:49], v[40:41], v[40:41]
v_pk_mul_f32 v[50:51], v[42:43], v[42:43]
v_pk_mul_f32 v[52:53], v[44:45], v[44:45]
v_pk_mul_f32 v[54:55], v[46:47], v[46:47]
v_pk_fma_f32 v[48:49], v[48:49], v[242:243], v[240:241]
v_pk_fma_f32 v[50:51], v[50:51], v[242:243], v[240:241]
v_pk_fma_f32 v[52:53], v[52:53], v[242:243], v[240:241]
v_pk_fma_f32 v[54:55], v[54:55], v[242:243], v[240:241]
v_pk_mul_f32 v[48:49], v[48:49], v[40:41]
v_pk_mul_f32 v[50:51], v[50:51], v[42:43]
v_pk_mul_f32 v[52:53], v[52:53], v[44:45]
v_pk_mul_f32 v[54:55], v[54:55], v[46:47]
v_exp_f32 v48, v48
v_exp_f32 v49, v49
v_exp_f32 v50, v50
v_exp_f32 v51, v51
v_exp_f32 v52, v52
v_exp_f32 v53, v53
v_exp_f32 v54, v54
v_exp_f32 v55, v55
v_pk_add_f32 v[48:49], v[48:49], v[244:245]
v_pk_add_f32 v[50:51], v[50:51], v[244:245]
v_pk_add_f32 v[52:53], v[52:53], v[244:245]
v_pk_add_f32 v[54:55], v[54:55], v[244:245]
v_rcp_f32 v48, v48
v_rcp_f32 v49, v49
v_rcp_f32 v50, v50
v_rcp_f32 v51, v51
v_rcp_f32 v52, v52
v_rcp_f32 v53, v53
v_rcp_f32 v54, v54
v_rcp_f32 v55, v55
v_pk_mul_f32 v[40:41], v[48:49], v[40:41]
v_pk_mul_f32 v[42:43], v[50:51], v[42:43]
v_pk_mul_f32 v[44:45], v[52:53], v[44:45]
v_pk_mul_f32 v[46:47], v[54:55], v[46:47]
v_cvt_pk_bf16_f32 v56, v40, v41
v_cvt_pk_bf16_f32 v57, v42, v43
v_cvt_pk_bf16_f32 v58, v44, v45
v_cvt_pk_bf16_f32 v59, v46, v47
buffer_store_dwordx4 v[56:59], v145, s[4:7], s53 offen offset:2048 sc1
v_accvgpr_read_b32 v0, a120
v_accvgpr_read_b32 v1, a121
v_accvgpr_read_b32 v2, a122
v_accvgpr_read_b32 v3, a123
v_accvgpr_read_b32 v4, a124
v_accvgpr_read_b32 v5, a125
v_accvgpr_read_b32 v6, a126
v_accvgpr_read_b32 v7, a127
v_pk_mul_f32 v[8:9], v[0:1], v[0:1]
v_pk_mul_f32 v[10:11], v[2:3], v[2:3]
v_pk_mul_f32 v[12:13], v[4:5], v[4:5]
v_pk_mul_f32 v[14:15], v[6:7], v[6:7]
v_pk_fma_f32 v[8:9], v[8:9], v[242:243], v[240:241]
v_pk_fma_f32 v[10:11], v[10:11], v[242:243], v[240:241]
v_pk_fma_f32 v[12:13], v[12:13], v[242:243], v[240:241]
v_pk_fma_f32 v[14:15], v[14:15], v[242:243], v[240:241]
v_pk_mul_f32 v[8:9], v[8:9], v[0:1]
v_pk_mul_f32 v[10:11], v[10:11], v[2:3]
v_pk_mul_f32 v[12:13], v[12:13], v[4:5]
v_pk_mul_f32 v[14:15], v[14:15], v[6:7]
v_exp_f32 v8, v8
v_exp_f32 v9, v9
v_exp_f32 v10, v10
v_exp_f32 v11, v11
v_exp_f32 v12, v12
v_exp_f32 v13, v13
v_exp_f32 v14, v14
v_exp_f32 v15, v15
v_pk_add_f32 v[8:9], v[8:9], v[244:245]
v_pk_add_f32 v[10:11], v[10:11], v[244:245]
v_pk_add_f32 v[12:13], v[12:13], v[244:245]
v_pk_add_f32 v[14:15], v[14:15], v[244:245]
v_rcp_f32 v8, v8
v_rcp_f32 v9, v9
v_rcp_f32 v10, v10
v_rcp_f32 v11, v11
v_rcp_f32 v12, v12
v_rcp_f32 v13, v13
v_rcp_f32 v14, v14
v_rcp_f32 v15, v15
v_pk_mul_f32 v[0:1], v[8:9], v[0:1]
v_pk_mul_f32 v[2:3], v[10:11], v[2:3]
v_pk_mul_f32 v[4:5], v[12:13], v[4:5]
v_pk_mul_f32 v[6:7], v[14:15], v[6:7]
v_cvt_pk_bf16_f32 v16, v0, v1
v_cvt_pk_bf16_f32 v17, v2, v3
v_cvt_pk_bf16_f32 v18, v4, v5
v_cvt_pk_bf16_f32 v19, v6, v7
buffer_store_dwordx4 v[16:19], v145, s[4:7], s53 offen offset:3072 sc1
s_branch main_kernel_w_ee
main_kernel_w_e10:
s_mov_b32 s53, s1
v_accvgpr_read_b32 v0, a0
v_accvgpr_read_b32 v1, a1
v_accvgpr_read_b32 v2, a2
v_accvgpr_read_b32 v3, a3
v_accvgpr_read_b32 v4, a4
v_accvgpr_read_b32 v5, a5
v_accvgpr_read_b32 v6, a6
v_accvgpr_read_b32 v7, a7
v_pk_mul_f32 v[8:9], v[0:1], v[0:1]
v_pk_mul_f32 v[10:11], v[2:3], v[2:3]
v_pk_mul_f32 v[12:13], v[4:5], v[4:5]
v_pk_mul_f32 v[14:15], v[6:7], v[6:7]
v_pk_fma_f32 v[8:9], v[8:9], v[242:243], v[240:241]
v_pk_fma_f32 v[10:11], v[10:11], v[242:243], v[240:241]
v_pk_fma_f32 v[12:13], v[12:13], v[242:243], v[240:241]
v_pk_fma_f32 v[14:15], v[14:15], v[242:243], v[240:241]
v_pk_mul_f32 v[8:9], v[8:9], v[0:1]
v_pk_mul_f32 v[10:11], v[10:11], v[2:3]
v_pk_mul_f32 v[12:13], v[12:13], v[4:5]
v_pk_mul_f32 v[14:15], v[14:15], v[6:7]
v_exp_f32 v8, v8
v_exp_f32 v9, v9
v_exp_f32 v10, v10
v_exp_f32 v11, v11
v_exp_f32 v12, v12
v_exp_f32 v13, v13
v_exp_f32 v14, v14
v_exp_f32 v15, v15
v_pk_add_f32 v[8:9], v[8:9], v[244:245]
v_pk_add_f32 v[10:11], v[10:11], v[244:245]
v_pk_add_f32 v[12:13], v[12:13], v[244:245]
v_pk_add_f32 v[14:15], v[14:15], v[244:245]
v_rcp_f32 v8, v8
v_rcp_f32 v9, v9
v_rcp_f32 v10, v10
v_rcp_f32 v11, v11
v_rcp_f32 v12, v12
v_rcp_f32 v13, v13
v_rcp_f32 v14, v14
v_rcp_f32 v15, v15
v_pk_mul_f32 v[0:1], v[8:9], v[0:1]
v_pk_mul_f32 v[2:3], v[10:11], v[2:3]
v_pk_mul_f32 v[4:5], v[12:13], v[4:5]
v_pk_mul_f32 v[6:7], v[14:15], v[6:7]
v_cvt_pk_bf16_f32 v16, v0, v1
v_cvt_pk_bf16_f32 v17, v2, v3
v_cvt_pk_bf16_f32 v18, v4, v5
v_cvt_pk_bf16_f32 v19, v6, v7
buffer_store_dwordx4 v[16:19], v251, s[4:7], s53 offen offset:0 sc1
v_accvgpr_read_b32 v20, a8
v_accvgpr_read_b32 v21, a9
v_accvgpr_read_b32 v22, a10
v_accvgpr_read_b32 v23, a11
v_accvgpr_read_b32 v24, a12
v_accvgpr_read_b32 v25, a13
v_accvgpr_read_b32 v26, a14
v_accvgpr_read_b32 v27, a15
v_pk_mul_f32 v[28:29], v[20:21], v[20:21]
v_pk_mul_f32 v[30:31], v[22:23], v[22:23]
v_pk_mul_f32 v[32:33], v[24:25], v[24:25]
v_pk_mul_f32 v[34:35], v[26:27], v[26:27]
v_pk_fma_f32 v[28:29], v[28:29], v[242:243], v[240:241]
v_pk_fma_f32 v[30:31], v[30:31], v[242:243], v[240:241]
v_pk_fma_f32 v[32:33], v[32:33], v[242:243], v[240:241]
v_pk_fma_f32 v[34:35], v[34:35], v[242:243], v[240:241]
v_pk_mul_f32 v[28:29], v[28:29], v[20:21]
v_pk_mul_f32 v[30:31], v[30:31], v[22:23]
v_pk_mul_f32 v[32:33], v[32:33], v[24:25]
v_pk_mul_f32 v[34:35], v[34:35], v[26:27]
v_exp_f32 v28, v28
v_exp_f32 v29, v29
v_exp_f32 v30, v30
v_exp_f32 v31, v31
v_exp_f32 v32, v32
v_exp_f32 v33, v33
v_exp_f32 v34, v34
v_exp_f32 v35, v35
v_pk_add_f32 v[28:29], v[28:29], v[244:245]
v_pk_add_f32 v[30:31], v[30:31], v[244:245]
v_pk_add_f32 v[32:33], v[32:33], v[244:245]
v_pk_add_f32 v[34:35], v[34:35], v[244:245]
v_rcp_f32 v28, v28
v_rcp_f32 v29, v29
v_rcp_f32 v30, v30
v_rcp_f32 v31, v31
v_rcp_f32 v32, v32
v_rcp_f32 v33, v33
v_rcp_f32 v34, v34
v_rcp_f32 v35, v35
v_pk_mul_f32 v[20:21], v[28:29], v[20:21]
v_pk_mul_f32 v[22:23], v[30:31], v[22:23]
v_pk_mul_f32 v[24:25], v[32:33], v[24:25]
v_pk_mul_f32 v[26:27], v[34:35], v[26:27]
v_cvt_pk_bf16_f32 v36, v20, v21
v_cvt_pk_bf16_f32 v37, v22, v23
v_cvt_pk_bf16_f32 v38, v24, v25
v_cvt_pk_bf16_f32 v39, v26, v27
buffer_store_dwordx4 v[36:39], v251, s[4:7], s53 offen offset:1024 sc1
v_accvgpr_read_b32 v40, a16
v_accvgpr_read_b32 v41, a17
v_accvgpr_read_b32 v42, a18
v_accvgpr_read_b32 v43, a19
v_accvgpr_read_b32 v44, a20
v_accvgpr_read_b32 v45, a21
v_accvgpr_read_b32 v46, a22
v_accvgpr_read_b32 v47, a23
v_pk_mul_f32 v[48:49], v[40:41], v[40:41]
v_pk_mul_f32 v[50:51], v[42:43], v[42:43]
v_pk_mul_f32 v[52:53], v[44:45], v[44:45]
v_pk_mul_f32 v[54:55], v[46:47], v[46:47]
v_pk_fma_f32 v[48:49], v[48:49], v[242:243], v[240:241]
v_pk_fma_f32 v[50:51], v[50:51], v[242:243], v[240:241]
v_pk_fma_f32 v[52:53], v[52:53], v[242:243], v[240:241]
v_pk_fma_f32 v[54:55], v[54:55], v[242:243], v[240:241]
v_pk_mul_f32 v[48:49], v[48:49], v[40:41]
v_pk_mul_f32 v[50:51], v[50:51], v[42:43]
v_pk_mul_f32 v[52:53], v[52:53], v[44:45]
v_pk_mul_f32 v[54:55], v[54:55], v[46:47]
v_exp_f32 v48, v48
v_exp_f32 v49, v49
v_exp_f32 v50, v50
v_exp_f32 v51, v51
v_exp_f32 v52, v52
v_exp_f32 v53, v53
v_exp_f32 v54, v54
v_exp_f32 v55, v55
v_pk_add_f32 v[48:49], v[48:49], v[244:245]
v_pk_add_f32 v[50:51], v[50:51], v[244:245]
v_pk_add_f32 v[52:53], v[52:53], v[244:245]
v_pk_add_f32 v[54:55], v[54:55], v[244:245]
v_rcp_f32 v48, v48
v_rcp_f32 v49, v49
v_rcp_f32 v50, v50
v_rcp_f32 v51, v51
v_rcp_f32 v52, v52
v_rcp_f32 v53, v53
v_rcp_f32 v54, v54
v_rcp_f32 v55, v55
v_pk_mul_f32 v[40:41], v[48:49], v[40:41]
v_pk_mul_f32 v[42:43], v[50:51], v[42:43]
v_pk_mul_f32 v[44:45], v[52:53], v[44:45]
v_pk_mul_f32 v[46:47], v[54:55], v[46:47]
v_cvt_pk_bf16_f32 v56, v40, v41
v_cvt_pk_bf16_f32 v57, v42, v43
v_cvt_pk_bf16_f32 v58, v44, v45
v_cvt_pk_bf16_f32 v59, v46, v47
buffer_store_dwordx4 v[56:59], v251, s[4:7], s53 offen offset:2048 sc1
v_accvgpr_read_b32 v0, a24
v_accvgpr_read_b32 v1, a25
v_accvgpr_read_b32 v2, a26
v_accvgpr_read_b32 v3, a27
v_accvgpr_read_b32 v4, a28
v_accvgpr_read_b32 v5, a29
v_accvgpr_read_b32 v6, a30
v_accvgpr_read_b32 v7, a31
v_pk_mul_f32 v[8:9], v[0:1], v[0:1]
v_pk_mul_f32 v[10:11], v[2:3], v[2:3]
v_pk_mul_f32 v[12:13], v[4:5], v[4:5]
v_pk_mul_f32 v[14:15], v[6:7], v[6:7]
v_pk_fma_f32 v[8:9], v[8:9], v[242:243], v[240:241]
v_pk_fma_f32 v[10:11], v[10:11], v[242:243], v[240:241]
v_pk_fma_f32 v[12:13], v[12:13], v[242:243], v[240:241]
v_pk_fma_f32 v[14:15], v[14:15], v[242:243], v[240:241]
v_pk_mul_f32 v[8:9], v[8:9], v[0:1]
v_pk_mul_f32 v[10:11], v[10:11], v[2:3]
v_pk_mul_f32 v[12:13], v[12:13], v[4:5]
v_pk_mul_f32 v[14:15], v[14:15], v[6:7]
v_exp_f32 v8, v8
v_exp_f32 v9, v9
v_exp_f32 v10, v10
v_exp_f32 v11, v11
v_exp_f32 v12, v12
v_exp_f32 v13, v13
v_exp_f32 v14, v14
v_exp_f32 v15, v15
v_pk_add_f32 v[8:9], v[8:9], v[244:245]
v_pk_add_f32 v[10:11], v[10:11], v[244:245]
v_pk_add_f32 v[12:13], v[12:13], v[244:245]
v_pk_add_f32 v[14:15], v[14:15], v[244:245]
v_rcp_f32 v8, v8
v_rcp_f32 v9, v9
v_rcp_f32 v10, v10
v_rcp_f32 v11, v11
v_rcp_f32 v12, v12
v_rcp_f32 v13, v13
v_rcp_f32 v14, v14
v_rcp_f32 v15, v15
v_pk_mul_f32 v[0:1], v[8:9], v[0:1]
v_pk_mul_f32 v[2:3], v[10:11], v[2:3]
v_pk_mul_f32 v[4:5], v[12:13], v[4:5]
v_pk_mul_f32 v[6:7], v[14:15], v[6:7]
v_cvt_pk_bf16_f32 v16, v0, v1
v_cvt_pk_bf16_f32 v17, v2, v3
v_cvt_pk_bf16_f32 v18, v4, v5
v_cvt_pk_bf16_f32 v19, v6, v7
buffer_store_dwordx4 v[16:19], v251, s[4:7], s53 offen offset:3072 sc1
s_add_u32 s53, s53, s2
v_accvgpr_read_b32 v20, a32
v_accvgpr_read_b32 v21, a33
v_accvgpr_read_b32 v22, a34
v_accvgpr_read_b32 v23, a35
v_accvgpr_read_b32 v24, a36
v_accvgpr_read_b32 v25, a37
v_accvgpr_read_b32 v26, a38
v_accvgpr_read_b32 v27, a39
v_pk_mul_f32 v[28:29], v[20:21], v[20:21]
v_pk_mul_f32 v[30:31], v[22:23], v[22:23]
v_pk_mul_f32 v[32:33], v[24:25], v[24:25]
v_pk_mul_f32 v[34:35], v[26:27], v[26:27]
v_pk_fma_f32 v[28:29], v[28:29], v[242:243], v[240:241]
v_pk_fma_f32 v[30:31], v[30:31], v[242:243], v[240:241]
v_pk_fma_f32 v[32:33], v[32:33], v[242:243], v[240:241]
v_pk_fma_f32 v[34:35], v[34:35], v[242:243], v[240:241]
v_pk_mul_f32 v[28:29], v[28:29], v[20:21]
v_pk_mul_f32 v[30:31], v[30:31], v[22:23]
v_pk_mul_f32 v[32:33], v[32:33], v[24:25]
v_pk_mul_f32 v[34:35], v[34:35], v[26:27]
v_exp_f32 v28, v28
v_exp_f32 v29, v29
v_exp_f32 v30, v30
v_exp_f32 v31, v31
v_exp_f32 v32, v32
v_exp_f32 v33, v33
v_exp_f32 v34, v34
v_exp_f32 v35, v35
v_pk_add_f32 v[28:29], v[28:29], v[244:245]
v_pk_add_f32 v[30:31], v[30:31], v[244:245]
v_pk_add_f32 v[32:33], v[32:33], v[244:245]
v_pk_add_f32 v[34:35], v[34:35], v[244:245]
v_rcp_f32 v28, v28
v_rcp_f32 v29, v29
v_rcp_f32 v30, v30
v_rcp_f32 v31, v31
v_rcp_f32 v32, v32
v_rcp_f32 v33, v33
v_rcp_f32 v34, v34
v_rcp_f32 v35, v35
v_pk_mul_f32 v[20:21], v[28:29], v[20:21]
v_pk_mul_f32 v[22:23], v[30:31], v[22:23]
v_pk_mul_f32 v[24:25], v[32:33], v[24:25]
v_pk_mul_f32 v[26:27], v[34:35], v[26:27]
v_cvt_pk_bf16_f32 v36, v20, v21
v_cvt_pk_bf16_f32 v37, v22, v23
v_cvt_pk_bf16_f32 v38, v24, v25
v_cvt_pk_bf16_f32 v39, v26, v27
buffer_store_dwordx4 v[36:39], v251, s[4:7], s53 offen offset:0 sc1
v_accvgpr_read_b32 v40, a40
v_accvgpr_read_b32 v41, a41
v_accvgpr_read_b32 v42, a42
v_accvgpr_read_b32 v43, a43
v_accvgpr_read_b32 v44, a44
v_accvgpr_read_b32 v45, a45
v_accvgpr_read_b32 v46, a46
v_accvgpr_read_b32 v47, a47
v_pk_mul_f32 v[48:49], v[40:41], v[40:41]
v_pk_mul_f32 v[50:51], v[42:43], v[42:43]
v_pk_mul_f32 v[52:53], v[44:45], v[44:45]
v_pk_mul_f32 v[54:55], v[46:47], v[46:47]
v_pk_fma_f32 v[48:49], v[48:49], v[242:243], v[240:241]
v_pk_fma_f32 v[50:51], v[50:51], v[242:243], v[240:241]
v_pk_fma_f32 v[52:53], v[52:53], v[242:243], v[240:241]
v_pk_fma_f32 v[54:55], v[54:55], v[242:243], v[240:241]
v_pk_mul_f32 v[48:49], v[48:49], v[40:41]
v_pk_mul_f32 v[50:51], v[50:51], v[42:43]
v_pk_mul_f32 v[52:53], v[52:53], v[44:45]
v_pk_mul_f32 v[54:55], v[54:55], v[46:47]
v_exp_f32 v48, v48
v_exp_f32 v49, v49
v_exp_f32 v50, v50
v_exp_f32 v51, v51
v_exp_f32 v52, v52
v_exp_f32 v53, v53
v_exp_f32 v54, v54
v_exp_f32 v55, v55
v_pk_add_f32 v[48:49], v[48:49], v[244:245]
v_pk_add_f32 v[50:51], v[50:51], v[244:245]
v_pk_add_f32 v[52:53], v[52:53], v[244:245]
v_pk_add_f32 v[54:55], v[54:55], v[244:245]
v_rcp_f32 v48, v48
v_rcp_f32 v49, v49
v_rcp_f32 v50, v50
v_rcp_f32 v51, v51
v_rcp_f32 v52, v52
v_rcp_f32 v53, v53
v_rcp_f32 v54, v54
v_rcp_f32 v55, v55
v_pk_mul_f32 v[40:41], v[48:49], v[40:41]
v_pk_mul_f32 v[42:43], v[50:51], v[42:43]
v_pk_mul_f32 v[44:45], v[52:53], v[44:45]
v_pk_mul_f32 v[46:47], v[54:55], v[46:47]
v_cvt_pk_bf16_f32 v56, v40, v41
v_cvt_pk_bf16_f32 v57, v42, v43
v_cvt_pk_bf16_f32 v58, v44, v45
v_cvt_pk_bf16_f32 v59, v46, v47
buffer_store_dwordx4 v[56:59], v251, s[4:7], s53 offen offset:1024 sc1
v_accvgpr_read_b32 v0, a48
v_accvgpr_read_b32 v1, a49
v_accvgpr_read_b32 v2, a50
v_accvgpr_read_b32 v3, a51
v_accvgpr_read_b32 v4, a52
v_accvgpr_read_b32 v5, a53
v_accvgpr_read_b32 v6, a54
v_accvgpr_read_b32 v7, a55
v_pk_mul_f32 v[8:9], v[0:1], v[0:1]
v_pk_mul_f32 v[10:11], v[2:3], v[2:3]
v_pk_mul_f32 v[12:13], v[4:5], v[4:5]
v_pk_mul_f32 v[14:15], v[6:7], v[6:7]
v_pk_fma_f32 v[8:9], v[8:9], v[242:243], v[240:241]
v_pk_fma_f32 v[10:11], v[10:11], v[242:243], v[240:241]
v_pk_fma_f32 v[12:13], v[12:13], v[242:243], v[240:241]
v_pk_fma_f32 v[14:15], v[14:15], v[242:243], v[240:241]
v_pk_mul_f32 v[8:9], v[8:9], v[0:1]
v_pk_mul_f32 v[10:11], v[10:11], v[2:3]
v_pk_mul_f32 v[12:13], v[12:13], v[4:5]
v_pk_mul_f32 v[14:15], v[14:15], v[6:7]
v_exp_f32 v8, v8
v_exp_f32 v9, v9
v_exp_f32 v10, v10
v_exp_f32 v11, v11
v_exp_f32 v12, v12
v_exp_f32 v13, v13
v_exp_f32 v14, v14
v_exp_f32 v15, v15
v_pk_add_f32 v[8:9], v[8:9], v[244:245]
v_pk_add_f32 v[10:11], v[10:11], v[244:245]
v_pk_add_f32 v[12:13], v[12:13], v[244:245]
v_pk_add_f32 v[14:15], v[14:15], v[244:245]
v_rcp_f32 v8, v8
v_rcp_f32 v9, v9
v_rcp_f32 v10, v10
v_rcp_f32 v11, v11
v_rcp_f32 v12, v12
v_rcp_f32 v13, v13
v_rcp_f32 v14, v14
v_rcp_f32 v15, v15
v_pk_mul_f32 v[0:1], v[8:9], v[0:1]
v_pk_mul_f32 v[2:3], v[10:11], v[2:3]
v_pk_mul_f32 v[4:5], v[12:13], v[4:5]
v_pk_mul_f32 v[6:7], v[14:15], v[6:7]
v_cvt_pk_bf16_f32 v16, v0, v1
v_cvt_pk_bf16_f32 v17, v2, v3
v_cvt_pk_bf16_f32 v18, v4, v5
v_cvt_pk_bf16_f32 v19, v6, v7
buffer_store_dwordx4 v[16:19], v251, s[4:7], s53 offen offset:2048 sc1
v_accvgpr_read_b32 v20, a56
v_accvgpr_read_b32 v21, a57
v_accvgpr_read_b32 v22, a58
v_accvgpr_read_b32 v23, a59
v_accvgpr_read_b32 v24, a60
v_accvgpr_read_b32 v25, a61
v_accvgpr_read_b32 v26, a62
v_accvgpr_read_b32 v27, a63
v_pk_mul_f32 v[28:29], v[20:21], v[20:21]
v_pk_mul_f32 v[30:31], v[22:23], v[22:23]
v_pk_mul_f32 v[32:33], v[24:25], v[24:25]
v_pk_mul_f32 v[34:35], v[26:27], v[26:27]
v_pk_fma_f32 v[28:29], v[28:29], v[242:243], v[240:241]
v_pk_fma_f32 v[30:31], v[30:31], v[242:243], v[240:241]
v_pk_fma_f32 v[32:33], v[32:33], v[242:243], v[240:241]
v_pk_fma_f32 v[34:35], v[34:35], v[242:243], v[240:241]
v_pk_mul_f32 v[28:29], v[28:29], v[20:21]
v_pk_mul_f32 v[30:31], v[30:31], v[22:23]
v_pk_mul_f32 v[32:33], v[32:33], v[24:25]
v_pk_mul_f32 v[34:35], v[34:35], v[26:27]
v_exp_f32 v28, v28
v_exp_f32 v29, v29
v_exp_f32 v30, v30
v_exp_f32 v31, v31
v_exp_f32 v32, v32
v_exp_f32 v33, v33
v_exp_f32 v34, v34
v_exp_f32 v35, v35
v_pk_add_f32 v[28:29], v[28:29], v[244:245]
v_pk_add_f32 v[30:31], v[30:31], v[244:245]
v_pk_add_f32 v[32:33], v[32:33], v[244:245]
v_pk_add_f32 v[34:35], v[34:35], v[244:245]
v_rcp_f32 v28, v28
v_rcp_f32 v29, v29
v_rcp_f32 v30, v30
v_rcp_f32 v31, v31
v_rcp_f32 v32, v32
v_rcp_f32 v33, v33
v_rcp_f32 v34, v34
v_rcp_f32 v35, v35
v_pk_mul_f32 v[20:21], v[28:29], v[20:21]
v_pk_mul_f32 v[22:23], v[30:31], v[22:23]
v_pk_mul_f32 v[24:25], v[32:33], v[24:25]
v_pk_mul_f32 v[26:27], v[34:35], v[26:27]
v_cvt_pk_bf16_f32 v36, v20, v21
v_cvt_pk_bf16_f32 v37, v22, v23
v_cvt_pk_bf16_f32 v38, v24, v25
v_cvt_pk_bf16_f32 v39, v26, v27
buffer_store_dwordx4 v[36:39], v251, s[4:7], s53 offen offset:3072 sc1
s_add_u32 s53, s53, s2
v_accvgpr_read_b32 v40, a64
v_accvgpr_read_b32 v41, a65
v_accvgpr_read_b32 v42, a66
v_accvgpr_read_b32 v43, a67
v_accvgpr_read_b32 v44, a68
v_accvgpr_read_b32 v45, a69
v_accvgpr_read_b32 v46, a70
v_accvgpr_read_b32 v47, a71
v_pk_mul_f32 v[48:49], v[40:41], v[40:41]
v_pk_mul_f32 v[50:51], v[42:43], v[42:43]
v_pk_mul_f32 v[52:53], v[44:45], v[44:45]
v_pk_mul_f32 v[54:55], v[46:47], v[46:47]
v_pk_fma_f32 v[48:49], v[48:49], v[242:243], v[240:241]
v_pk_fma_f32 v[50:51], v[50:51], v[242:243], v[240:241]
v_pk_fma_f32 v[52:53], v[52:53], v[242:243], v[240:241]
v_pk_fma_f32 v[54:55], v[54:55], v[242:243], v[240:241]
v_pk_mul_f32 v[48:49], v[48:49], v[40:41]
v_pk_mul_f32 v[50:51], v[50:51], v[42:43]
v_pk_mul_f32 v[52:53], v[52:53], v[44:45]
v_pk_mul_f32 v[54:55], v[54:55], v[46:47]
v_exp_f32 v48, v48
v_exp_f32 v49, v49
v_exp_f32 v50, v50
v_exp_f32 v51, v51
v_exp_f32 v52, v52
v_exp_f32 v53, v53
v_exp_f32 v54, v54
v_exp_f32 v55, v55
v_pk_add_f32 v[48:49], v[48:49], v[244:245]
v_pk_add_f32 v[50:51], v[50:51], v[244:245]
v_pk_add_f32 v[52:53], v[52:53], v[244:245]
v_pk_add_f32 v[54:55], v[54:55], v[244:245]
v_rcp_f32 v48, v48
v_rcp_f32 v49, v49
v_rcp_f32 v50, v50
v_rcp_f32 v51, v51
v_rcp_f32 v52, v52
v_rcp_f32 v53, v53
v_rcp_f32 v54, v54
v_rcp_f32 v55, v55
v_pk_mul_f32 v[40:41], v[48:49], v[40:41]
v_pk_mul_f32 v[42:43], v[50:51], v[42:43]
v_pk_mul_f32 v[44:45], v[52:53], v[44:45]
v_pk_mul_f32 v[46:47], v[54:55], v[46:47]
v_cvt_pk_bf16_f32 v56, v40, v41
v_cvt_pk_bf16_f32 v57, v42, v43
v_cvt_pk_bf16_f32 v58, v44, v45
v_cvt_pk_bf16_f32 v59, v46, v47
buffer_store_dwordx4 v[56:59], v251, s[4:7], s53 offen offset:0 sc1
v_accvgpr_read_b32 v0, a72
v_accvgpr_read_b32 v1, a73
v_accvgpr_read_b32 v2, a74
v_accvgpr_read_b32 v3, a75
v_accvgpr_read_b32 v4, a76
v_accvgpr_read_b32 v5, a77
v_accvgpr_read_b32 v6, a78
v_accvgpr_read_b32 v7, a79
v_pk_mul_f32 v[8:9], v[0:1], v[0:1]
v_pk_mul_f32 v[10:11], v[2:3], v[2:3]
v_pk_mul_f32 v[12:13], v[4:5], v[4:5]
v_pk_mul_f32 v[14:15], v[6:7], v[6:7]
v_pk_fma_f32 v[8:9], v[8:9], v[242:243], v[240:241]
v_pk_fma_f32 v[10:11], v[10:11], v[242:243], v[240:241]
v_pk_fma_f32 v[12:13], v[12:13], v[242:243], v[240:241]
v_pk_fma_f32 v[14:15], v[14:15], v[242:243], v[240:241]
v_pk_mul_f32 v[8:9], v[8:9], v[0:1]
v_pk_mul_f32 v[10:11], v[10:11], v[2:3]
v_pk_mul_f32 v[12:13], v[12:13], v[4:5]
v_pk_mul_f32 v[14:15], v[14:15], v[6:7]
v_exp_f32 v8, v8
v_exp_f32 v9, v9
v_exp_f32 v10, v10
v_exp_f32 v11, v11
v_exp_f32 v12, v12
v_exp_f32 v13, v13
v_exp_f32 v14, v14
v_exp_f32 v15, v15
v_pk_add_f32 v[8:9], v[8:9], v[244:245]
v_pk_add_f32 v[10:11], v[10:11], v[244:245]
v_pk_add_f32 v[12:13], v[12:13], v[244:245]
v_pk_add_f32 v[14:15], v[14:15], v[244:245]
v_rcp_f32 v8, v8
v_rcp_f32 v9, v9
v_rcp_f32 v10, v10
v_rcp_f32 v11, v11
v_rcp_f32 v12, v12
v_rcp_f32 v13, v13
v_rcp_f32 v14, v14
v_rcp_f32 v15, v15
v_pk_mul_f32 v[0:1], v[8:9], v[0:1]
v_pk_mul_f32 v[2:3], v[10:11], v[2:3]
v_pk_mul_f32 v[4:5], v[12:13], v[4:5]
v_pk_mul_f32 v[6:7], v[14:15], v[6:7]
v_cvt_pk_bf16_f32 v16, v0, v1
v_cvt_pk_bf16_f32 v17, v2, v3
v_cvt_pk_bf16_f32 v18, v4, v5
v_cvt_pk_bf16_f32 v19, v6, v7
buffer_store_dwordx4 v[16:19], v251, s[4:7], s53 offen offset:1024 sc1
v_accvgpr_read_b32 v20, a80
v_accvgpr_read_b32 v21, a81
v_accvgpr_read_b32 v22, a82
v_accvgpr_read_b32 v23, a83
v_accvgpr_read_b32 v24, a84
v_accvgpr_read_b32 v25, a85
v_accvgpr_read_b32 v26, a86
v_accvgpr_read_b32 v27, a87
v_pk_mul_f32 v[28:29], v[20:21], v[20:21]
v_pk_mul_f32 v[30:31], v[22:23], v[22:23]
v_pk_mul_f32 v[32:33], v[24:25], v[24:25]
v_pk_mul_f32 v[34:35], v[26:27], v[26:27]
v_pk_fma_f32 v[28:29], v[28:29], v[242:243], v[240:241]
v_pk_fma_f32 v[30:31], v[30:31], v[242:243], v[240:241]
v_pk_fma_f32 v[32:33], v[32:33], v[242:243], v[240:241]
v_pk_fma_f32 v[34:35], v[34:35], v[242:243], v[240:241]
v_pk_mul_f32 v[28:29], v[28:29], v[20:21]
v_pk_mul_f32 v[30:31], v[30:31], v[22:23]
v_pk_mul_f32 v[32:33], v[32:33], v[24:25]
v_pk_mul_f32 v[34:35], v[34:35], v[26:27]
v_exp_f32 v28, v28
v_exp_f32 v29, v29
v_exp_f32 v30, v30
v_exp_f32 v31, v31
v_exp_f32 v32, v32
v_exp_f32 v33, v33
v_exp_f32 v34, v34
v_exp_f32 v35, v35
v_pk_add_f32 v[28:29], v[28:29], v[244:245]
v_pk_add_f32 v[30:31], v[30:31], v[244:245]
v_pk_add_f32 v[32:33], v[32:33], v[244:245]
v_pk_add_f32 v[34:35], v[34:35], v[244:245]
v_rcp_f32 v28, v28
v_rcp_f32 v29, v29
v_rcp_f32 v30, v30
v_rcp_f32 v31, v31
v_rcp_f32 v32, v32
v_rcp_f32 v33, v33
v_rcp_f32 v34, v34
v_rcp_f32 v35, v35
v_pk_mul_f32 v[20:21], v[28:29], v[20:21]
v_pk_mul_f32 v[22:23], v[30:31], v[22:23]
v_pk_mul_f32 v[24:25], v[32:33], v[24:25]
v_pk_mul_f32 v[26:27], v[34:35], v[26:27]
v_cvt_pk_bf16_f32 v36, v20, v21
v_cvt_pk_bf16_f32 v37, v22, v23
v_cvt_pk_bf16_f32 v38, v24, v25
v_cvt_pk_bf16_f32 v39, v26, v27
buffer_store_dwordx4 v[36:39], v251, s[4:7], s53 offen offset:2048 sc1
v_accvgpr_read_b32 v40, a88
v_accvgpr_read_b32 v41, a89
v_accvgpr_read_b32 v42, a90
v_accvgpr_read_b32 v43, a91
v_accvgpr_read_b32 v44, a92
v_accvgpr_read_b32 v45, a93
v_accvgpr_read_b32 v46, a94
v_accvgpr_read_b32 v47, a95
v_pk_mul_f32 v[48:49], v[40:41], v[40:41]
v_pk_mul_f32 v[50:51], v[42:43], v[42:43]
v_pk_mul_f32 v[52:53], v[44:45], v[44:45]
v_pk_mul_f32 v[54:55], v[46:47], v[46:47]
v_pk_fma_f32 v[48:49], v[48:49], v[242:243], v[240:241]
v_pk_fma_f32 v[50:51], v[50:51], v[242:243], v[240:241]
v_pk_fma_f32 v[52:53], v[52:53], v[242:243], v[240:241]
v_pk_fma_f32 v[54:55], v[54:55], v[242:243], v[240:241]
v_pk_mul_f32 v[48:49], v[48:49], v[40:41]
v_pk_mul_f32 v[50:51], v[50:51], v[42:43]
v_pk_mul_f32 v[52:53], v[52:53], v[44:45]
v_pk_mul_f32 v[54:55], v[54:55], v[46:47]
v_exp_f32 v48, v48
v_exp_f32 v49, v49
v_exp_f32 v50, v50
v_exp_f32 v51, v51
v_exp_f32 v52, v52
v_exp_f32 v53, v53
v_exp_f32 v54, v54
v_exp_f32 v55, v55
v_pk_add_f32 v[48:49], v[48:49], v[244:245]
v_pk_add_f32 v[50:51], v[50:51], v[244:245]
v_pk_add_f32 v[52:53], v[52:53], v[244:245]
v_pk_add_f32 v[54:55], v[54:55], v[244:245]
v_rcp_f32 v48, v48
v_rcp_f32 v49, v49
v_rcp_f32 v50, v50
v_rcp_f32 v51, v51
v_rcp_f32 v52, v52
v_rcp_f32 v53, v53
v_rcp_f32 v54, v54
v_rcp_f32 v55, v55
v_pk_mul_f32 v[40:41], v[48:49], v[40:41]
v_pk_mul_f32 v[42:43], v[50:51], v[42:43]
v_pk_mul_f32 v[44:45], v[52:53], v[44:45]
v_pk_mul_f32 v[46:47], v[54:55], v[46:47]
v_cvt_pk_bf16_f32 v56, v40, v41
v_cvt_pk_bf16_f32 v57, v42, v43
v_cvt_pk_bf16_f32 v58, v44, v45
v_cvt_pk_bf16_f32 v59, v46, v47
buffer_store_dwordx4 v[56:59], v251, s[4:7], s53 offen offset:3072 sc1
s_add_u32 s53, s53, s2
v_accvgpr_read_b32 v0, a96
v_accvgpr_read_b32 v1, a97
v_accvgpr_read_b32 v2, a98
v_accvgpr_read_b32 v3, a99
v_accvgpr_read_b32 v4, a100
v_accvgpr_read_b32 v5, a101
v_accvgpr_read_b32 v6, a102
v_accvgpr_read_b32 v7, a103
v_pk_mul_f32 v[8:9], v[0:1], v[0:1]
v_pk_mul_f32 v[10:11], v[2:3], v[2:3]
v_pk_mul_f32 v[12:13], v[4:5], v[4:5]
v_pk_mul_f32 v[14:15], v[6:7], v[6:7]
v_pk_fma_f32 v[8:9], v[8:9], v[242:243], v[240:241]
v_pk_fma_f32 v[10:11], v[10:11], v[242:243], v[240:241]
v_pk_fma_f32 v[12:13], v[12:13], v[242:243], v[240:241]
v_pk_fma_f32 v[14:15], v[14:15], v[242:243], v[240:241]
v_pk_mul_f32 v[8:9], v[8:9], v[0:1]
v_pk_mul_f32 v[10:11], v[10:11], v[2:3]
v_pk_mul_f32 v[12:13], v[12:13], v[4:5]
v_pk_mul_f32 v[14:15], v[14:15], v[6:7]
v_exp_f32 v8, v8
v_exp_f32 v9, v9
v_exp_f32 v10, v10
v_exp_f32 v11, v11
v_exp_f32 v12, v12
v_exp_f32 v13, v13
v_exp_f32 v14, v14
v_exp_f32 v15, v15
v_pk_add_f32 v[8:9], v[8:9], v[244:245]
v_pk_add_f32 v[10:11], v[10:11], v[244:245]
v_pk_add_f32 v[12:13], v[12:13], v[244:245]
v_pk_add_f32 v[14:15], v[14:15], v[244:245]
v_rcp_f32 v8, v8
v_rcp_f32 v9, v9
v_rcp_f32 v10, v10
v_rcp_f32 v11, v11
v_rcp_f32 v12, v12
v_rcp_f32 v13, v13
v_rcp_f32 v14, v14
v_rcp_f32 v15, v15
v_pk_mul_f32 v[0:1], v[8:9], v[0:1]
v_pk_mul_f32 v[2:3], v[10:11], v[2:3]
v_pk_mul_f32 v[4:5], v[12:13], v[4:5]
v_pk_mul_f32 v[6:7], v[14:15], v[6:7]
v_cvt_pk_bf16_f32 v16, v0, v1
v_cvt_pk_bf16_f32 v17, v2, v3
v_cvt_pk_bf16_f32 v18, v4, v5
v_cvt_pk_bf16_f32 v19, v6, v7
buffer_store_dwordx4 v[16:19], v251, s[4:7], s53 offen offset:0 sc1
v_accvgpr_read_b32 v20, a104
v_accvgpr_read_b32 v21, a105
v_accvgpr_read_b32 v22, a106
v_accvgpr_read_b32 v23, a107
v_accvgpr_read_b32 v24, a108
v_accvgpr_read_b32 v25, a109
v_accvgpr_read_b32 v26, a110
v_accvgpr_read_b32 v27, a111
v_pk_mul_f32 v[28:29], v[20:21], v[20:21]
v_pk_mul_f32 v[30:31], v[22:23], v[22:23]
v_pk_mul_f32 v[32:33], v[24:25], v[24:25]
v_pk_mul_f32 v[34:35], v[26:27], v[26:27]
v_pk_fma_f32 v[28:29], v[28:29], v[242:243], v[240:241]
v_pk_fma_f32 v[30:31], v[30:31], v[242:243], v[240:241]
v_pk_fma_f32 v[32:33], v[32:33], v[242:243], v[240:241]
v_pk_fma_f32 v[34:35], v[34:35], v[242:243], v[240:241]
v_pk_mul_f32 v[28:29], v[28:29], v[20:21]
v_pk_mul_f32 v[30:31], v[30:31], v[22:23]
v_pk_mul_f32 v[32:33], v[32:33], v[24:25]
v_pk_mul_f32 v[34:35], v[34:35], v[26:27]
v_exp_f32 v28, v28
v_exp_f32 v29, v29
v_exp_f32 v30, v30
v_exp_f32 v31, v31
v_exp_f32 v32, v32
v_exp_f32 v33, v33
v_exp_f32 v34, v34
v_exp_f32 v35, v35
v_pk_add_f32 v[28:29], v[28:29], v[244:245]
v_pk_add_f32 v[30:31], v[30:31], v[244:245]
v_pk_add_f32 v[32:33], v[32:33], v[244:245]
v_pk_add_f32 v[34:35], v[34:35], v[244:245]
v_rcp_f32 v28, v28
v_rcp_f32 v29, v29
v_rcp_f32 v30, v30
v_rcp_f32 v31, v31
v_rcp_f32 v32, v32
v_rcp_f32 v33, v33
v_rcp_f32 v34, v34
v_rcp_f32 v35, v35
v_pk_mul_f32 v[20:21], v[28:29], v[20:21]
v_pk_mul_f32 v[22:23], v[30:31], v[22:23]
v_pk_mul_f32 v[24:25], v[32:33], v[24:25]
v_pk_mul_f32 v[26:27], v[34:35], v[26:27]
v_cvt_pk_bf16_f32 v36, v20, v21
v_cvt_pk_bf16_f32 v37, v22, v23
v_cvt_pk_bf16_f32 v38, v24, v25
v_cvt_pk_bf16_f32 v39, v26, v27
buffer_store_dwordx4 v[36:39], v251, s[4:7], s53 offen offset:1024 sc1
v_accvgpr_read_b32 v40, a112
v_accvgpr_read_b32 v41, a113
v_accvgpr_read_b32 v42, a114
v_accvgpr_read_b32 v43, a115
v_accvgpr_read_b32 v44, a116
v_accvgpr_read_b32 v45, a117
v_accvgpr_read_b32 v46, a118
v_accvgpr_read_b32 v47, a119
v_pk_mul_f32 v[48:49], v[40:41], v[40:41]
v_pk_mul_f32 v[50:51], v[42:43], v[42:43]
v_pk_mul_f32 v[52:53], v[44:45], v[44:45]
v_pk_mul_f32 v[54:55], v[46:47], v[46:47]
v_pk_fma_f32 v[48:49], v[48:49], v[242:243], v[240:241]
v_pk_fma_f32 v[50:51], v[50:51], v[242:243], v[240:241]
v_pk_fma_f32 v[52:53], v[52:53], v[242:243], v[240:241]
v_pk_fma_f32 v[54:55], v[54:55], v[242:243], v[240:241]
v_pk_mul_f32 v[48:49], v[48:49], v[40:41]
v_pk_mul_f32 v[50:51], v[50:51], v[42:43]
v_pk_mul_f32 v[52:53], v[52:53], v[44:45]
v_pk_mul_f32 v[54:55], v[54:55], v[46:47]
v_exp_f32 v48, v48
v_exp_f32 v49, v49
v_exp_f32 v50, v50
v_exp_f32 v51, v51
v_exp_f32 v52, v52
v_exp_f32 v53, v53
v_exp_f32 v54, v54
v_exp_f32 v55, v55
v_pk_add_f32 v[48:49], v[48:49], v[244:245]
v_pk_add_f32 v[50:51], v[50:51], v[244:245]
v_pk_add_f32 v[52:53], v[52:53], v[244:245]
v_pk_add_f32 v[54:55], v[54:55], v[244:245]
v_rcp_f32 v48, v48
v_rcp_f32 v49, v49
v_rcp_f32 v50, v50
v_rcp_f32 v51, v51
v_rcp_f32 v52, v52
v_rcp_f32 v53, v53
v_rcp_f32 v54, v54
v_rcp_f32 v55, v55
v_pk_mul_f32 v[40:41], v[48:49], v[40:41]
v_pk_mul_f32 v[42:43], v[50:51], v[42:43]
v_pk_mul_f32 v[44:45], v[52:53], v[44:45]
v_pk_mul_f32 v[46:47], v[54:55], v[46:47]
v_cvt_pk_bf16_f32 v56, v40, v41
v_cvt_pk_bf16_f32 v57, v42, v43
v_cvt_pk_bf16_f32 v58, v44, v45
v_cvt_pk_bf16_f32 v59, v46, v47
buffer_store_dwordx4 v[56:59], v251, s[4:7], s53 offen offset:2048 sc1
v_accvgpr_read_b32 v0, a120
v_accvgpr_read_b32 v1, a121
v_accvgpr_read_b32 v2, a122
v_accvgpr_read_b32 v3, a123
v_accvgpr_read_b32 v4, a124
v_accvgpr_read_b32 v5, a125
v_accvgpr_read_b32 v6, a126
v_accvgpr_read_b32 v7, a127
v_pk_mul_f32 v[8:9], v[0:1], v[0:1]
v_pk_mul_f32 v[10:11], v[2:3], v[2:3]
v_pk_mul_f32 v[12:13], v[4:5], v[4:5]
v_pk_mul_f32 v[14:15], v[6:7], v[6:7]
v_pk_fma_f32 v[8:9], v[8:9], v[242:243], v[240:241]
v_pk_fma_f32 v[10:11], v[10:11], v[242:243], v[240:241]
v_pk_fma_f32 v[12:13], v[12:13], v[242:243], v[240:241]
v_pk_fma_f32 v[14:15], v[14:15], v[242:243], v[240:241]
v_pk_mul_f32 v[8:9], v[8:9], v[0:1]
v_pk_mul_f32 v[10:11], v[10:11], v[2:3]
v_pk_mul_f32 v[12:13], v[12:13], v[4:5]
v_pk_mul_f32 v[14:15], v[14:15], v[6:7]
v_exp_f32 v8, v8
v_exp_f32 v9, v9
v_exp_f32 v10, v10
v_exp_f32 v11, v11
v_exp_f32 v12, v12
v_exp_f32 v13, v13
v_exp_f32 v14, v14
v_exp_f32 v15, v15
v_pk_add_f32 v[8:9], v[8:9], v[244:245]
v_pk_add_f32 v[10:11], v[10:11], v[244:245]
v_pk_add_f32 v[12:13], v[12:13], v[244:245]
v_pk_add_f32 v[14:15], v[14:15], v[244:245]
v_rcp_f32 v8, v8
v_rcp_f32 v9, v9
v_rcp_f32 v10, v10
v_rcp_f32 v11, v11
v_rcp_f32 v12, v12
v_rcp_f32 v13, v13
v_rcp_f32 v14, v14
v_rcp_f32 v15, v15
v_pk_mul_f32 v[0:1], v[8:9], v[0:1]
v_pk_mul_f32 v[2:3], v[10:11], v[2:3]
v_pk_mul_f32 v[4:5], v[12:13], v[4:5]
v_pk_mul_f32 v[6:7], v[14:15], v[6:7]
v_cvt_pk_bf16_f32 v16, v0, v1
v_cvt_pk_bf16_f32 v17, v2, v3
v_cvt_pk_bf16_f32 v18, v4, v5
v_cvt_pk_bf16_f32 v19, v6, v7
buffer_store_dwordx4 v[16:19], v251, s[4:7], s53 offen offset:3072 sc1
main_kernel_w_ee:
s_cmp_eq_u32 s58, 0
s_cbranch_scc1 main_kernel_w_c0_n_ent
s_cmp_eq_u32 s58, 1
s_cbranch_scc1 main_kernel_w_c0_v_ent
s_cmp_eq_u32 s58, 2
s_cbranch_scc1 main_kernel_w_c1_n_ent
s_cmp_eq_u32 s58, 3
s_cbranch_scc1 main_kernel_w_c1_v_ent
s_branch main_kernel_w_drain
main_kernel_w_pref:
s_cmp_lg_u32 s24, 0
s_cbranch_scc1 main_kernel_w_pf0
s_mov_b32 s8, s64
s_and_b32 s9, s65, 0xffff
s_mov_b32 s10, 0x200000
s_mov_b32 s11, 0x20000
s_branch main_kernel_w_pfg
main_kernel_w_pf0:
s_cmp_lg_u32 s24, 1
s_cbranch_scc1 main_kernel_w_pf1
s_mov_b32 s8, s66
s_and_b32 s9, s67, 0xffff
s_mov_b32 s10, 0x200000
s_mov_b32 s11, 0x20000
s_branch main_kernel_w_pfg
main_kernel_w_pf1:
s_cmp_lg_u32 s24, 2
s_cbranch_scc1 main_kernel_w_pf2
s_mov_b32 s8, s68
s_and_b32 s9, s69, 0xffff
s_mov_b32 s10, 0x700000
s_mov_b32 s11, 0x20000
s_branch main_kernel_w_pfg
main_kernel_w_pf2:
s_mov_b32 s8, s70
s_and_b32 s9, s71, 0xffff
s_mov_b32 s10, 0x700000
s_mov_b32 s11, 0x20000
main_kernel_w_pfg:
s_lshl_b32 s32, s25, 19
s_lshl_b32 s33, s14, 17
s_add_u32 s32, s32, s33
v_lshlrev_b32 v253, 7, v250
buffer_load_dword v0, v253, s[8:11], s32 offen
s_add_u32 s32, s32, 8192
buffer_load_dword v0, v253, s[8:11], s32 offen
s_add_u32 s32, s32, 8192
buffer_load_dword v0, v253, s[8:11], s32 offen
s_add_u32 s32, s32, 8192
buffer_load_dword v0, v253, s[8:11], s32 offen
s_add_u32 s32, s32, 8192
buffer_load_dword v0, v253, s[8:11], s32 offen
s_add_u32 s32, s32, 8192
buffer_load_dword v0, v253, s[8:11], s32 offen
s_add_u32 s32, s32, 8192
buffer_load_dword v0, v253, s[8:11], s32 offen
s_add_u32 s32, s32, 8192
buffer_load_dword v0, v253, s[8:11], s32 offen
s_add_u32 s32, s32, 8192
buffer_load_dword v0, v253, s[8:11], s32 offen
s_add_u32 s32, s32, 8192
buffer_load_dword v0, v253, s[8:11], s32 offen
s_add_u32 s32, s32, 8192
buffer_load_dword v0, v253, s[8:11], s32 offen
s_add_u32 s32, s32, 8192
buffer_load_dword v0, v253, s[8:11], s32 offen
s_add_u32 s32, s32, 8192
buffer_load_dword v0, v253, s[8:11], s32 offen
s_add_u32 s32, s32, 8192
buffer_load_dword v0, v253, s[8:11], s32 offen
s_add_u32 s32, s32, 8192
buffer_load_dword v0, v253, s[8:11], s32 offen
s_add_u32 s32, s32, 8192
buffer_load_dword v0, v253, s[8:11], s32 offen
s_add_u32 s32, s32, 8192
s_branch main_kernel_w_done
main_kernel_w_fill:
s_lshl_b32 s32, s24, 2
s_add_u32 s32, s32, s25
s_lshl_b32 s33, s32, 16
s_add_u32 s32, s33, 0x6e00000
s_add_u32 s35, s33, 0x8c00000
s_add_u32 s33, s33, 0x8000000
s_lshl_b32 s34, s14, 12
v_add_u32 v253, s34, v251
v_mov_b32 v0, -1
v_mov_b32 v1, -1
v_mov_b32 v2, -1
v_mov_b32 v3, -1
s_mov_b32 s18, 4
main_kernel_w_fl:
buffer_store_dwordx4 v[0:3], v253, s[4:7], s32 offen offset:0 sc1
buffer_store_dwordx4 v[0:3], v253, s[4:7], s32 offen offset:1024 sc1
buffer_store_dwordx4 v[0:3], v253, s[4:7], s32 offen offset:2048 sc1
buffer_store_dwordx4 v[0:3], v253, s[4:7], s32 offen offset:3072 sc1
s_add_u32 s32, s32, 16384
buffer_store_dwordx4 v[0:3], v253, s[4:7], s33 offen offset:0 sc1
buffer_store_dwordx4 v[0:3], v253, s[4:7], s33 offen offset:1024 sc1
buffer_store_dwordx4 v[0:3], v253, s[4:7], s33 offen offset:2048 sc1
buffer_store_dwordx4 v[0:3], v253, s[4:7], s33 offen offset:3072 sc1
s_add_u32 s33, s33, 16384
buffer_store_dwordx4 v[0:3], v253, s[4:7], s35 offen offset:0 sc1
buffer_store_dwordx4 v[0:3], v253, s[4:7], s35 offen offset:1024 sc1
buffer_store_dwordx4 v[0:3], v253, s[4:7], s35 offen offset:2048 sc1
buffer_store_dwordx4 v[0:3], v253, s[4:7], s35 offen offset:3072 sc1
s_add_u32 s35, s35, 16384
s_sub_u32 s18, s18, 1
s_cmp_lg_u32 s18, 0
s_cbranch_scc1 main_kernel_w_fl
s_branch main_kernel_w_done
main_kernel_w_ln2:
s_lshl_b32 s32, s24, 3
s_mul_i32 s33, s25, 2
s_add_u32 s32, s32, s33
s_lshl_b32 s32, s32, 15
s_lshl_b32 s33, s14, 13
s_add_u32 s32, s32, s33
s_add_u32 s21, s32, 0x6800000
s_add_u32 s32, s32, 0x5000000
buffer_load_dwordx4 v[0:3], v251, s[4:7], s32 offen offset:0 sc1
buffer_load_dwordx4 v[4:7], v251, s[4:7], s32 offen offset:1024 sc1
buffer_load_dwordx4 v[8:11], v251, s[4:7], s32 offen offset:2048 sc1
buffer_load_dwordx4 v[12:15], v251, s[4:7], s32 offen offset:3072 sc1
s_add_u32 s32, s32, 4096
buffer_load_dwordx4 v[16:19], v251, s[4:7], s32 offen offset:0 sc1
buffer_load_dwordx4 v[20:23], v251, s[4:7], s32 offen offset:1024 sc1
buffer_load_dwordx4 v[24:27], v251, s[4:7], s32 offen offset:2048 sc1
buffer_load_dwordx4 v[28:31], v251, s[4:7], s32 offen offset:3072 sc1
s_add_u32 s32, s32, 28672
buffer_load_dwordx4 v[32:35], v251, s[4:7], s32 offen offset:0 sc1
buffer_load_dwordx4 v[36:39], v251, s[4:7], s32 offen offset:1024 sc1
buffer_load_dwordx4 v[40:43], v251, s[4:7], s32 offen offset:2048 sc1
buffer_load_dwordx4 v[44:47], v251, s[4:7], s32 offen offset:3072 sc1
s_add_u32 s32, s32, 4096
buffer_load_dwordx4 v[48:51], v251, s[4:7], s32 offen offset:0 sc1
buffer_load_dwordx4 v[52:55], v251, s[4:7], s32 offen offset:1024 sc1
buffer_load_dwordx4 v[56:59], v251, s[4:7], s32 offen offset:2048 sc1
buffer_load_dwordx4 v[60:63], v251, s[4:7], s32 offen offset:3072 sc1
s_add_u32 s32, s32, 28672
v_and_b32 v255, 15, v250
v_lshlrev_b32 v254, 6, v255
v_add_u32 v254, 132096, v254
v_lshrrev_b32 v255, 4, v250
v_lshl_add_u32 v253, v255, 2, v254
v_lshl_add_u32 v253, s14, 4, v253
s_waitcnt vmcnt(8)
v_lshlrev_b32 v128, 16, v0
v_and_b32 v129, 0xffff0000, v0
v_lshlrev_b32 v130, 16, v1
v_and_b32 v131, 0xffff0000, v1
v_lshlrev_b32 v132, 16, v2
v_and_b32 v133, 0xffff0000, v2
v_lshlrev_b32 v134, 16, v3
v_and_b32 v135, 0xffff0000, v3
v_lshlrev_b32 v136, 16, v4
v_and_b32 v137, 0xffff0000, v4
v_lshlrev_b32 v138, 16, v5
v_and_b32 v139, 0xffff0000, v5
v_lshlrev_b32 v140, 16, v6
v_and_b32 v141, 0xffff0000, v6
v_lshlrev_b32 v142, 16, v7
v_and_b32 v143, 0xffff0000, v7
v_lshlrev_b32 v144, 16, v8
v_and_b32 v145, 0xffff0000, v8
v_lshlrev_b32 v146, 16, v9
v_and_b32 v147, 0xffff0000, v9
v_lshlrev_b32 v148, 16, v10
v_and_b32 v149, 0xffff0000, v10
v_lshlrev_b32 v150, 16, v11
v_and_b32 v151, 0xffff0000, v11
v_lshlrev_b32 v152, 16, v12
v_and_b32 v153, 0xffff0000, v12
v_lshlrev_b32 v154, 16, v13
v_and_b32 v155, 0xffff0000, v13
v_lshlrev_b32 v156, 16, v14
v_and_b32 v157, 0xffff0000, v14
v_lshlrev_b32 v158, 16, v15
v_and_b32 v159, 0xffff0000, v15
v_lshlrev_b32 v160, 16, v16
v_and_b32 v161, 0xffff0000, v16
v_lshlrev_b32 v162, 16, v17
v_and_b32 v163, 0xffff0000, v17
v_lshlrev_b32 v164, 16, v18
v_and_b32 v165, 0xffff0000, v18
v_lshlrev_b32 v166, 16, v19
v_and_b32 v167, 0xffff0000, v19
v_lshlrev_b32 v168, 16, v20
v_and_b32 v169, 0xffff0000, v20
v_lshlrev_b32 v170, 16, v21
v_and_b32 v171, 0xffff0000, v21
v_lshlrev_b32 v172, 16, v22
v_and_b32 v173, 0xffff0000, v22
v_lshlrev_b32 v174, 16, v23
v_and_b32 v175, 0xffff0000, v23
v_lshlrev_b32 v176, 16, v24
v_and_b32 v177, 0xffff0000, v24
v_lshlrev_b32 v178, 16, v25
v_and_b32 v179, 0xffff0000, v25
v_lshlrev_b32 v180, 16, v26
v_and_b32 v181, 0xffff0000, v26
v_lshlrev_b32 v182, 16, v27
v_and_b32 v183, 0xffff0000, v27
v_lshlrev_b32 v184, 16, v28
v_and_b32 v185, 0xffff0000, v28
v_lshlrev_b32 v186, 16, v29
v_and_b32 v187, 0xffff0000, v29
v_lshlrev_b32 v188, 16, v30
v_and_b32 v189, 0xffff0000, v30
v_lshlrev_b32 v190, 16, v31
v_and_b32 v191, 0xffff0000, v31
v_pk_add_f32 v[192:193], v[128:129], v[136:137]
v_pk_add_f32 v[194:195], v[130:131], v[138:139]
v_pk_add_f32 v[196:197], v[132:133], v[140:141]
v_pk_add_f32 v[198:199], v[134:135], v[142:143]
v_pk_add_f32 v[192:193], v[192:193], v[144:145]
v_pk_add_f32 v[194:195], v[194:195], v[146:147]
v_pk_add_f32 v[196:197], v[196:197], v[148:149]
v_pk_add_f32 v[198:199], v[198:199], v[150:151]
v_pk_add_f32 v[192:193], v[192:193], v[152:153]
v_pk_add_f32 v[194:195], v[194:195], v[154:155]
v_pk_add_f32 v[196:197], v[196:197], v[156:157]
v_pk_add_f32 v[198:199], v[198:199], v[158:159]
v_pk_add_f32 v[192:193], v[192:193], v[160:161]
v_pk_add_f32 v[194:195], v[194:195], v[162:163]
v_pk_add_f32 v[196:197], v[196:197], v[164:165]
v_pk_add_f32 v[198:199], v[198:199], v[166:167]
v_pk_add_f32 v[192:193], v[192:193], v[168:169]
v_pk_add_f32 v[194:195], v[194:195], v[170:171]
v_pk_add_f32 v[196:197], v[196:197], v[172:173]
v_pk_add_f32 v[198:199], v[198:199], v[174:175]
v_pk_add_f32 v[192:193], v[192:193], v[176:177]
v_pk_add_f32 v[194:195], v[194:195], v[178:179]
v_pk_add_f32 v[196:197], v[196:197], v[180:181]
v_pk_add_f32 v[198:199], v[198:199], v[182:183]
v_pk_add_f32 v[192:193], v[192:193], v[184:185]
v_pk_add_f32 v[194:195], v[194:195], v[186:187]
v_pk_add_f32 v[196:197], v[196:197], v[188:189]
v_pk_add_f32 v[198:199], v[198:199], v[190:191]
v_pk_add_f32 v[192:193], v[192:193], v[194:195]
v_pk_add_f32 v[196:197], v[196:197], v[198:199]
v_pk_add_f32 v[192:193], v[192:193], v[196:197]
v_add_f32 v192, v192, v193
ds_write_b32 v253, v192 offset:0
s_waitcnt lgkmcnt(0)
s_barrier
ds_read_b128 v[192:195], v254 offset:0
ds_read_b128 v[196:199], v254 offset:16
ds_read_b128 v[200:203], v254 offset:32
ds_read_b128 v[204:207], v254 offset:48
s_waitcnt lgkmcnt(2)
v_pk_add_f32 v[192:193], v[192:193], v[194:195]
v_pk_add_f32 v[196:197], v[196:197], v[198:199]
s_waitcnt lgkmcnt(0)
v_pk_add_f32 v[200:201], v[200:201], v[202:203]
v_pk_add_f32 v[204:205], v[204:205], v[206:207]
v_pk_add_f32 v[192:193], v[192:193], v[196:197]
v_pk_add_f32 v[200:201], v[200:201], v[204:205]
v_pk_add_f32 v[192:193], v[192:193], v[200:201]
v_add_f32 v192, v192, v193
v_mul_f32 v192, 0xba800000, v192
v_mov_b32 v193, v192
v_pk_add_f32 v[128:129], v[128:129], v[192:193]
v_pk_add_f32 v[130:131], v[130:131], v[192:193]
v_pk_add_f32 v[132:133], v[132:133], v[192:193]
v_pk_add_f32 v[134:135], v[134:135], v[192:193]
v_pk_add_f32 v[136:137], v[136:137], v[192:193]
v_pk_add_f32 v[138:139], v[138:139], v[192:193]
v_pk_add_f32 v[140:141], v[140:141], v[192:193]
v_pk_add_f32 v[142:143], v[142:143], v[192:193]
v_pk_add_f32 v[144:145], v[144:145], v[192:193]
v_pk_add_f32 v[146:147], v[146:147], v[192:193]
v_pk_add_f32 v[148:149], v[148:149], v[192:193]
v_pk_add_f32 v[150:151], v[150:151], v[192:193]
v_pk_add_f32 v[152:153], v[152:153], v[192:193]
v_pk_add_f32 v[154:155], v[154:155], v[192:193]
v_pk_add_f32 v[156:157], v[156:157], v[192:193]
v_pk_add_f32 v[158:159], v[158:159], v[192:193]
v_pk_add_f32 v[160:161], v[160:161], v[192:193]
v_pk_add_f32 v[162:163], v[162:163], v[192:193]
v_pk_add_f32 v[164:165], v[164:165], v[192:193]
v_pk_add_f32 v[166:167], v[166:167], v[192:193]
v_pk_add_f32 v[168:169], v[168:169], v[192:193]
v_pk_add_f32 v[170:171], v[170:171], v[192:193]
v_pk_add_f32 v[172:173], v[172:173], v[192:193]
v_pk_add_f32 v[174:175], v[174:175], v[192:193]
v_pk_add_f32 v[176:177], v[176:177], v[192:193]
v_pk_add_f32 v[178:179], v[178:179], v[192:193]
v_pk_add_f32 v[180:181], v[180:181], v[192:193]
v_pk_add_f32 v[182:183], v[182:183], v[192:193]
v_pk_add_f32 v[184:185], v[184:185], v[192:193]
v_pk_add_f32 v[186:187], v[186:187], v[192:193]
v_pk_add_f32 v[188:189], v[188:189], v[192:193]
v_pk_add_f32 v[190:191], v[190:191], v[192:193]
v_pk_mul_f32 v[192:193], v[128:129], v[128:129]
v_pk_mul_f32 v[194:195], v[130:131], v[130:131]
v_pk_mul_f32 v[196:197], v[132:133], v[132:133]
v_pk_mul_f32 v[198:199], v[134:135], v[134:135]
v_pk_fma_f32 v[192:193], v[136:137], v[136:137], v[192:193]
v_pk_fma_f32 v[194:195], v[138:139], v[138:139], v[194:195]
v_pk_fma_f32 v[196:197], v[140:141], v[140:141], v[196:197]
v_pk_fma_f32 v[198:199], v[142:143], v[142:143], v[198:199]
v_pk_fma_f32 v[192:193], v[144:145], v[144:145], v[192:193]
v_pk_fma_f32 v[194:195], v[146:147], v[146:147], v[194:195]
v_pk_fma_f32 v[196:197], v[148:149], v[148:149], v[196:197]
v_pk_fma_f32 v[198:199], v[150:151], v[150:151], v[198:199]
v_pk_fma_f32 v[192:193], v[152:153], v[152:153], v[192:193]
v_pk_fma_f32 v[194:195], v[154:155], v[154:155], v[194:195]
v_pk_fma_f32 v[196:197], v[156:157], v[156:157], v[196:197]
v_pk_fma_f32 v[198:199], v[158:159], v[158:159], v[198:199]
v_pk_fma_f32 v[192:193], v[160:161], v[160:161], v[192:193]
v_pk_fma_f32 v[194:195], v[162:163], v[162:163], v[194:195]
v_pk_fma_f32 v[196:197], v[164:165], v[164:165], v[196:197]
v_pk_fma_f32 v[198:199], v[166:167], v[166:167], v[198:199]
v_pk_fma_f32 v[192:193], v[168:169], v[168:169], v[192:193]
v_pk_fma_f32 v[194:195], v[170:171], v[170:171], v[194:195]
v_pk_fma_f32 v[196:197], v[172:173], v[172:173], v[196:197]
v_pk_fma_f32 v[198:199], v[174:175], v[174:175], v[198:199]
v_pk_fma_f32 v[192:193], v[176:177], v[176:177], v[192:193]
v_pk_fma_f32 v[194:195], v[178:179], v[178:179], v[194:195]
v_pk_fma_f32 v[196:197], v[180:181], v[180:181], v[196:197]
v_pk_fma_f32 v[198:199], v[182:183], v[182:183], v[198:199]
v_pk_fma_f32 v[192:193], v[184:185], v[184:185], v[192:193]
v_pk_fma_f32 v[194:195], v[186:187], v[186:187], v[194:195]
v_pk_fma_f32 v[196:197], v[188:189], v[188:189], v[196:197]
v_pk_fma_f32 v[198:199], v[190:191], v[190:191], v[198:199]
v_pk_add_f32 v[192:193], v[192:193], v[194:195]
v_pk_add_f32 v[196:197], v[196:197], v[198:199]
v_pk_add_f32 v[192:193], v[192:193], v[196:197]
v_add_f32 v192, v192, v193
ds_write_b32 v253, v192 offset:1024
s_waitcnt lgkmcnt(0)
s_barrier
ds_read_b128 v[192:195], v254 offset:1024
ds_read_b128 v[196:199], v254 offset:1040
ds_read_b128 v[200:203], v254 offset:1056
ds_read_b128 v[204:207], v254 offset:1072
s_waitcnt lgkmcnt(2)
v_pk_add_f32 v[192:193], v[192:193], v[194:195]
v_pk_add_f32 v[196:197], v[196:197], v[198:199]
s_waitcnt lgkmcnt(0)
v_pk_add_f32 v[200:201], v[200:201], v[202:203]
v_pk_add_f32 v[204:205], v[204:205], v[206:207]
v_pk_add_f32 v[192:193], v[192:193], v[196:197]
v_pk_add_f32 v[200:201], v[200:201], v[204:205]
v_pk_add_f32 v[192:193], v[192:193], v[200:201]
v_add_f32 v192, v192, v193
v_mov_b32 v193, 0x3727c5ac
v_fmac_f32 v193, 0x3a800000, v192
v_rsq_f32 v192, v193
s_nop 0
v_mov_b32 v193, v192
v_pk_mul_f32 v[128:129], v[128:129], v[192:193]
v_pk_mul_f32 v[130:131], v[130:131], v[192:193]
v_pk_mul_f32 v[132:133], v[132:133], v[192:193]
v_pk_mul_f32 v[134:135], v[134:135], v[192:193]
v_pk_mul_f32 v[136:137], v[136:137], v[192:193]
v_pk_mul_f32 v[138:139], v[138:139], v[192:193]
v_pk_mul_f32 v[140:141], v[140:141], v[192:193]
v_pk_mul_f32 v[142:143], v[142:143], v[192:193]
v_pk_mul_f32 v[144:145], v[144:145], v[192:193]
v_pk_mul_f32 v[146:147], v[146:147], v[192:193]
v_pk_mul_f32 v[148:149], v[148:149], v[192:193]
v_pk_mul_f32 v[150:151], v[150:151], v[192:193]
v_pk_mul_f32 v[152:153], v[152:153], v[192:193]
v_pk_mul_f32 v[154:155], v[154:155], v[192:193]
v_pk_mul_f32 v[156:157], v[156:157], v[192:193]
v_pk_mul_f32 v[158:159], v[158:159], v[192:193]
v_pk_mul_f32 v[160:161], v[160:161], v[192:193]
v_pk_mul_f32 v[162:163], v[162:163], v[192:193]
v_pk_mul_f32 v[164:165], v[164:165], v[192:193]
v_pk_mul_f32 v[166:167], v[166:167], v[192:193]
v_pk_mul_f32 v[168:169], v[168:169], v[192:193]
v_pk_mul_f32 v[170:171], v[170:171], v[192:193]
v_pk_mul_f32 v[172:173], v[172:173], v[192:193]
v_pk_mul_f32 v[174:175], v[174:175], v[192:193]
v_pk_mul_f32 v[176:177], v[176:177], v[192:193]
v_pk_mul_f32 v[178:179], v[178:179], v[192:193]
v_pk_mul_f32 v[180:181], v[180:181], v[192:193]
v_pk_mul_f32 v[182:183], v[182:183], v[192:193]
v_pk_mul_f32 v[184:185], v[184:185], v[192:193]
v_pk_mul_f32 v[186:187], v[186:187], v[192:193]
v_pk_mul_f32 v[188:189], v[188:189], v[192:193]
v_pk_mul_f32 v[190:191], v[190:191], v[192:193]
v_cvt_pk_bf16_f32 v0, v128, v129
v_cvt_pk_bf16_f32 v1, v130, v131
v_cvt_pk_bf16_f32 v2, v132, v133
v_cvt_pk_bf16_f32 v3, v134, v135
v_cvt_pk_bf16_f32 v4, v136, v137
v_cvt_pk_bf16_f32 v5, v138, v139
v_cvt_pk_bf16_f32 v6, v140, v141
v_cvt_pk_bf16_f32 v7, v142, v143
v_cvt_pk_bf16_f32 v8, v144, v145
v_cvt_pk_bf16_f32 v9, v146, v147
v_cvt_pk_bf16_f32 v10, v148, v149
v_cvt_pk_bf16_f32 v11, v150, v151
v_cvt_pk_bf16_f32 v12, v152, v153
v_cvt_pk_bf16_f32 v13, v154, v155
v_cvt_pk_bf16_f32 v14, v156, v157
v_cvt_pk_bf16_f32 v15, v158, v159
v_cvt_pk_bf16_f32 v16, v160, v161
v_cvt_pk_bf16_f32 v17, v162, v163
v_cvt_pk_bf16_f32 v18, v164, v165
v_cvt_pk_bf16_f32 v19, v166, v167
v_cvt_pk_bf16_f32 v20, v168, v169
v_cvt_pk_bf16_f32 v21, v170, v171
v_cvt_pk_bf16_f32 v22, v172, v173
v_cvt_pk_bf16_f32 v23, v174, v175
v_cvt_pk_bf16_f32 v24, v176, v177
v_cvt_pk_bf16_f32 v25, v178, v179
v_cvt_pk_bf16_f32 v26, v180, v181
v_cvt_pk_bf16_f32 v27, v182, v183
v_cvt_pk_bf16_f32 v28, v184, v185
v_cvt_pk_bf16_f32 v29, v186, v187
v_cvt_pk_bf16_f32 v30, v188, v189
v_cvt_pk_bf16_f32 v31, v190, v191
buffer_store_dwordx4 v[0:3], v251, s[4:7], s21 offen offset:0 sc1
buffer_store_dwordx4 v[4:7], v251, s[4:7], s21 offen offset:1024 sc1
buffer_store_dwordx4 v[8:11], v251, s[4:7], s21 offen offset:2048 sc1
buffer_store_dwordx4 v[12:15], v251, s[4:7], s21 offen offset:3072 sc1
s_add_u32 s21, s21, 4096
buffer_store_dwordx4 v[16:19], v251, s[4:7], s21 offen offset:0 sc1
buffer_store_dwordx4 v[20:23], v251, s[4:7], s21 offen offset:1024 sc1
buffer_store_dwordx4 v[24:27], v251, s[4:7], s21 offen offset:2048 sc1
buffer_store_dwordx4 v[28:31], v251, s[4:7], s21 offen offset:3072 sc1
s_add_u32 s21, s21, 28672
s_waitcnt vmcnt(8)
v_lshlrev_b32 v128, 16, v32
v_and_b32 v129, 0xffff0000, v32
v_lshlrev_b32 v130, 16, v33
v_and_b32 v131, 0xffff0000, v33
v_lshlrev_b32 v132, 16, v34
v_and_b32 v133, 0xffff0000, v34
v_lshlrev_b32 v134, 16, v35
v_and_b32 v135, 0xffff0000, v35
v_lshlrev_b32 v136, 16, v36
v_and_b32 v137, 0xffff0000, v36
v_lshlrev_b32 v138, 16, v37
v_and_b32 v139, 0xffff0000, v37
v_lshlrev_b32 v140, 16, v38
v_and_b32 v141, 0xffff0000, v38
v_lshlrev_b32 v142, 16, v39
v_and_b32 v143, 0xffff0000, v39
v_lshlrev_b32 v144, 16, v40
v_and_b32 v145, 0xffff0000, v40
v_lshlrev_b32 v146, 16, v41
v_and_b32 v147, 0xffff0000, v41
v_lshlrev_b32 v148, 16, v42
v_and_b32 v149, 0xffff0000, v42
v_lshlrev_b32 v150, 16, v43
v_and_b32 v151, 0xffff0000, v43
v_lshlrev_b32 v152, 16, v44
v_and_b32 v153, 0xffff0000, v44
v_lshlrev_b32 v154, 16, v45
v_and_b32 v155, 0xffff0000, v45
v_lshlrev_b32 v156, 16, v46
v_and_b32 v157, 0xffff0000, v46
v_lshlrev_b32 v158, 16, v47
v_and_b32 v159, 0xffff0000, v47
v_lshlrev_b32 v160, 16, v48
v_and_b32 v161, 0xffff0000, v48
v_lshlrev_b32 v162, 16, v49
v_and_b32 v163, 0xffff0000, v49
v_lshlrev_b32 v164, 16, v50
v_and_b32 v165, 0xffff0000, v50
v_lshlrev_b32 v166, 16, v51
v_and_b32 v167, 0xffff0000, v51
v_lshlrev_b32 v168, 16, v52
v_and_b32 v169, 0xffff0000, v52
v_lshlrev_b32 v170, 16, v53
v_and_b32 v171, 0xffff0000, v53
v_lshlrev_b32 v172, 16, v54
v_and_b32 v173, 0xffff0000, v54
v_lshlrev_b32 v174, 16, v55
v_and_b32 v175, 0xffff0000, v55
v_lshlrev_b32 v176, 16, v56
v_and_b32 v177, 0xffff0000, v56
v_lshlrev_b32 v178, 16, v57
v_and_b32 v179, 0xffff0000, v57
v_lshlrev_b32 v180, 16, v58
v_and_b32 v181, 0xffff0000, v58
v_lshlrev_b32 v182, 16, v59
v_and_b32 v183, 0xffff0000, v59
v_lshlrev_b32 v184, 16, v60
v_and_b32 v185, 0xffff0000, v60
v_lshlrev_b32 v186, 16, v61
v_and_b32 v187, 0xffff0000, v61
v_lshlrev_b32 v188, 16, v62
v_and_b32 v189, 0xffff0000, v62
v_lshlrev_b32 v190, 16, v63
v_and_b32 v191, 0xffff0000, v63
v_pk_add_f32 v[192:193], v[128:129], v[136:137]
v_pk_add_f32 v[194:195], v[130:131], v[138:139]
v_pk_add_f32 v[196:197], v[132:133], v[140:141]
v_pk_add_f32 v[198:199], v[134:135], v[142:143]
v_pk_add_f32 v[192:193], v[192:193], v[144:145]
v_pk_add_f32 v[194:195], v[194:195], v[146:147]
v_pk_add_f32 v[196:197], v[196:197], v[148:149]
v_pk_add_f32 v[198:199], v[198:199], v[150:151]
v_pk_add_f32 v[192:193], v[192:193], v[152:153]
v_pk_add_f32 v[194:195], v[194:195], v[154:155]
v_pk_add_f32 v[196:197], v[196:197], v[156:157]
v_pk_add_f32 v[198:199], v[198:199], v[158:159]
v_pk_add_f32 v[192:193], v[192:193], v[160:161]
v_pk_add_f32 v[194:195], v[194:195], v[162:163]
v_pk_add_f32 v[196:197], v[196:197], v[164:165]
v_pk_add_f32 v[198:199], v[198:199], v[166:167]
v_pk_add_f32 v[192:193], v[192:193], v[168:169]
v_pk_add_f32 v[194:195], v[194:195], v[170:171]
v_pk_add_f32 v[196:197], v[196:197], v[172:173]
v_pk_add_f32 v[198:199], v[198:199], v[174:175]
v_pk_add_f32 v[192:193], v[192:193], v[176:177]
v_pk_add_f32 v[194:195], v[194:195], v[178:179]
v_pk_add_f32 v[196:197], v[196:197], v[180:181]
v_pk_add_f32 v[198:199], v[198:199], v[182:183]
v_pk_add_f32 v[192:193], v[192:193], v[184:185]
v_pk_add_f32 v[194:195], v[194:195], v[186:187]
v_pk_add_f32 v[196:197], v[196:197], v[188:189]
v_pk_add_f32 v[198:199], v[198:199], v[190:191]
v_pk_add_f32 v[192:193], v[192:193], v[194:195]
v_pk_add_f32 v[196:197], v[196:197], v[198:199]
v_pk_add_f32 v[192:193], v[192:193], v[196:197]
v_add_f32 v192, v192, v193
ds_write_b32 v253, v192 offset:0
s_waitcnt lgkmcnt(0)
s_barrier
ds_read_b128 v[192:195], v254 offset:0
ds_read_b128 v[196:199], v254 offset:16
ds_read_b128 v[200:203], v254 offset:32
ds_read_b128 v[204:207], v254 offset:48
s_waitcnt lgkmcnt(2)
v_pk_add_f32 v[192:193], v[192:193], v[194:195]
v_pk_add_f32 v[196:197], v[196:197], v[198:199]
s_waitcnt lgkmcnt(0)
v_pk_add_f32 v[200:201], v[200:201], v[202:203]
v_pk_add_f32 v[204:205], v[204:205], v[206:207]
v_pk_add_f32 v[192:193], v[192:193], v[196:197]
v_pk_add_f32 v[200:201], v[200:201], v[204:205]
v_pk_add_f32 v[192:193], v[192:193], v[200:201]
v_add_f32 v192, v192, v193
v_mul_f32 v192, 0xba800000, v192
v_mov_b32 v193, v192
v_pk_add_f32 v[128:129], v[128:129], v[192:193]
v_pk_add_f32 v[130:131], v[130:131], v[192:193]
v_pk_add_f32 v[132:133], v[132:133], v[192:193]
v_pk_add_f32 v[134:135], v[134:135], v[192:193]
v_pk_add_f32 v[136:137], v[136:137], v[192:193]
v_pk_add_f32 v[138:139], v[138:139], v[192:193]
v_pk_add_f32 v[140:141], v[140:141], v[192:193]
v_pk_add_f32 v[142:143], v[142:143], v[192:193]
v_pk_add_f32 v[144:145], v[144:145], v[192:193]
v_pk_add_f32 v[146:147], v[146:147], v[192:193]
v_pk_add_f32 v[148:149], v[148:149], v[192:193]
v_pk_add_f32 v[150:151], v[150:151], v[192:193]
v_pk_add_f32 v[152:153], v[152:153], v[192:193]
v_pk_add_f32 v[154:155], v[154:155], v[192:193]
v_pk_add_f32 v[156:157], v[156:157], v[192:193]
v_pk_add_f32 v[158:159], v[158:159], v[192:193]
v_pk_add_f32 v[160:161], v[160:161], v[192:193]
v_pk_add_f32 v[162:163], v[162:163], v[192:193]
v_pk_add_f32 v[164:165], v[164:165], v[192:193]
v_pk_add_f32 v[166:167], v[166:167], v[192:193]
v_pk_add_f32 v[168:169], v[168:169], v[192:193]
v_pk_add_f32 v[170:171], v[170:171], v[192:193]
v_pk_add_f32 v[172:173], v[172:173], v[192:193]
v_pk_add_f32 v[174:175], v[174:175], v[192:193]
v_pk_add_f32 v[176:177], v[176:177], v[192:193]
v_pk_add_f32 v[178:179], v[178:179], v[192:193]
v_pk_add_f32 v[180:181], v[180:181], v[192:193]
v_pk_add_f32 v[182:183], v[182:183], v[192:193]
v_pk_add_f32 v[184:185], v[184:185], v[192:193]
v_pk_add_f32 v[186:187], v[186:187], v[192:193]
v_pk_add_f32 v[188:189], v[188:189], v[192:193]
v_pk_add_f32 v[190:191], v[190:191], v[192:193]
v_pk_mul_f32 v[192:193], v[128:129], v[128:129]
v_pk_mul_f32 v[194:195], v[130:131], v[130:131]
v_pk_mul_f32 v[196:197], v[132:133], v[132:133]
v_pk_mul_f32 v[198:199], v[134:135], v[134:135]
v_pk_fma_f32 v[192:193], v[136:137], v[136:137], v[192:193]
v_pk_fma_f32 v[194:195], v[138:139], v[138:139], v[194:195]
v_pk_fma_f32 v[196:197], v[140:141], v[140:141], v[196:197]
v_pk_fma_f32 v[198:199], v[142:143], v[142:143], v[198:199]
v_pk_fma_f32 v[192:193], v[144:145], v[144:145], v[192:193]
v_pk_fma_f32 v[194:195], v[146:147], v[146:147], v[194:195]
v_pk_fma_f32 v[196:197], v[148:149], v[148:149], v[196:197]
v_pk_fma_f32 v[198:199], v[150:151], v[150:151], v[198:199]
v_pk_fma_f32 v[192:193], v[152:153], v[152:153], v[192:193]
v_pk_fma_f32 v[194:195], v[154:155], v[154:155], v[194:195]
v_pk_fma_f32 v[196:197], v[156:157], v[156:157], v[196:197]
v_pk_fma_f32 v[198:199], v[158:159], v[158:159], v[198:199]
v_pk_fma_f32 v[192:193], v[160:161], v[160:161], v[192:193]
v_pk_fma_f32 v[194:195], v[162:163], v[162:163], v[194:195]
v_pk_fma_f32 v[196:197], v[164:165], v[164:165], v[196:197]
v_pk_fma_f32 v[198:199], v[166:167], v[166:167], v[198:199]
v_pk_fma_f32 v[192:193], v[168:169], v[168:169], v[192:193]
v_pk_fma_f32 v[194:195], v[170:171], v[170:171], v[194:195]
v_pk_fma_f32 v[196:197], v[172:173], v[172:173], v[196:197]
v_pk_fma_f32 v[198:199], v[174:175], v[174:175], v[198:199]
v_pk_fma_f32 v[192:193], v[176:177], v[176:177], v[192:193]
v_pk_fma_f32 v[194:195], v[178:179], v[178:179], v[194:195]
v_pk_fma_f32 v[196:197], v[180:181], v[180:181], v[196:197]
v_pk_fma_f32 v[198:199], v[182:183], v[182:183], v[198:199]
v_pk_fma_f32 v[192:193], v[184:185], v[184:185], v[192:193]
v_pk_fma_f32 v[194:195], v[186:187], v[186:187], v[194:195]
v_pk_fma_f32 v[196:197], v[188:189], v[188:189], v[196:197]
v_pk_fma_f32 v[198:199], v[190:191], v[190:191], v[198:199]
v_pk_add_f32 v[192:193], v[192:193], v[194:195]
v_pk_add_f32 v[196:197], v[196:197], v[198:199]
v_pk_add_f32 v[192:193], v[192:193], v[196:197]
v_add_f32 v192, v192, v193
ds_write_b32 v253, v192 offset:1024
s_waitcnt lgkmcnt(0)
s_barrier
ds_read_b128 v[192:195], v254 offset:1024
ds_read_b128 v[196:199], v254 offset:1040
ds_read_b128 v[200:203], v254 offset:1056
ds_read_b128 v[204:207], v254 offset:1072
s_waitcnt lgkmcnt(2)
v_pk_add_f32 v[192:193], v[192:193], v[194:195]
v_pk_add_f32 v[196:197], v[196:197], v[198:199]
s_waitcnt lgkmcnt(0)
v_pk_add_f32 v[200:201], v[200:201], v[202:203]
v_pk_add_f32 v[204:205], v[204:205], v[206:207]
v_pk_add_f32 v[192:193], v[192:193], v[196:197]
v_pk_add_f32 v[200:201], v[200:201], v[204:205]
v_pk_add_f32 v[192:193], v[192:193], v[200:201]
v_add_f32 v192, v192, v193
v_mov_b32 v193, 0x3727c5ac
v_fmac_f32 v193, 0x3a800000, v192
v_rsq_f32 v192, v193
s_nop 0
v_mov_b32 v193, v192
v_pk_mul_f32 v[128:129], v[128:129], v[192:193]
v_pk_mul_f32 v[130:131], v[130:131], v[192:193]
v_pk_mul_f32 v[132:133], v[132:133], v[192:193]
v_pk_mul_f32 v[134:135], v[134:135], v[192:193]
v_pk_mul_f32 v[136:137], v[136:137], v[192:193]
v_pk_mul_f32 v[138:139], v[138:139], v[192:193]
v_pk_mul_f32 v[140:141], v[140:141], v[192:193]
v_pk_mul_f32 v[142:143], v[142:143], v[192:193]
v_pk_mul_f32 v[144:145], v[144:145], v[192:193]
v_pk_mul_f32 v[146:147], v[146:147], v[192:193]
v_pk_mul_f32 v[148:149], v[148:149], v[192:193]
v_pk_mul_f32 v[150:151], v[150:151], v[192:193]
v_pk_mul_f32 v[152:153], v[152:153], v[192:193]
v_pk_mul_f32 v[154:155], v[154:155], v[192:193]
v_pk_mul_f32 v[156:157], v[156:157], v[192:193]
v_pk_mul_f32 v[158:159], v[158:159], v[192:193]
v_pk_mul_f32 v[160:161], v[160:161], v[192:193]
v_pk_mul_f32 v[162:163], v[162:163], v[192:193]
v_pk_mul_f32 v[164:165], v[164:165], v[192:193]
v_pk_mul_f32 v[166:167], v[166:167], v[192:193]
v_pk_mul_f32 v[168:169], v[168:169], v[192:193]
v_pk_mul_f32 v[170:171], v[170:171], v[192:193]
v_pk_mul_f32 v[172:173], v[172:173], v[192:193]
v_pk_mul_f32 v[174:175], v[174:175], v[192:193]
v_pk_mul_f32 v[176:177], v[176:177], v[192:193]
v_pk_mul_f32 v[178:179], v[178:179], v[192:193]
v_pk_mul_f32 v[180:181], v[180:181], v[192:193]
v_pk_mul_f32 v[182:183], v[182:183], v[192:193]
v_pk_mul_f32 v[184:185], v[184:185], v[192:193]
v_pk_mul_f32 v[186:187], v[186:187], v[192:193]
v_pk_mul_f32 v[188:189], v[188:189], v[192:193]
v_pk_mul_f32 v[190:191], v[190:191], v[192:193]
v_cvt_pk_bf16_f32 v32, v128, v129
v_cvt_pk_bf16_f32 v33, v130, v131
v_cvt_pk_bf16_f32 v34, v132, v133
v_cvt_pk_bf16_f32 v35, v134, v135
v_cvt_pk_bf16_f32 v36, v136, v137
v_cvt_pk_bf16_f32 v37, v138, v139
v_cvt_pk_bf16_f32 v38, v140, v141
v_cvt_pk_bf16_f32 v39, v142, v143
v_cvt_pk_bf16_f32 v40, v144, v145
v_cvt_pk_bf16_f32 v41, v146, v147
v_cvt_pk_bf16_f32 v42, v148, v149
v_cvt_pk_bf16_f32 v43, v150, v151
v_cvt_pk_bf16_f32 v44, v152, v153
v_cvt_pk_bf16_f32 v45, v154, v155
v_cvt_pk_bf16_f32 v46, v156, v157
v_cvt_pk_bf16_f32 v47, v158, v159
v_cvt_pk_bf16_f32 v48, v160, v161
v_cvt_pk_bf16_f32 v49, v162, v163
v_cvt_pk_bf16_f32 v50, v164, v165
v_cvt_pk_bf16_f32 v51, v166, v167
v_cvt_pk_bf16_f32 v52, v168, v169
v_cvt_pk_bf16_f32 v53, v170, v171
v_cvt_pk_bf16_f32 v54, v172, v173
v_cvt_pk_bf16_f32 v55, v174, v175
v_cvt_pk_bf16_f32 v56, v176, v177
v_cvt_pk_bf16_f32 v57, v178, v179
v_cvt_pk_bf16_f32 v58, v180, v181
v_cvt_pk_bf16_f32 v59, v182, v183
v_cvt_pk_bf16_f32 v60, v184, v185
v_cvt_pk_bf16_f32 v61, v186, v187
v_cvt_pk_bf16_f32 v62, v188, v189
v_cvt_pk_bf16_f32 v63, v190, v191
buffer_store_dwordx4 v[32:35], v251, s[4:7], s21 offen offset:0 sc1
buffer_store_dwordx4 v[36:39], v251, s[4:7], s21 offen offset:1024 sc1
buffer_store_dwordx4 v[40:43], v251, s[4:7], s21 offen offset:2048 sc1
buffer_store_dwordx4 v[44:47], v251, s[4:7], s21 offen offset:3072 sc1
s_add_u32 s21, s21, 4096
buffer_store_dwordx4 v[48:51], v251, s[4:7], s21 offen offset:0 sc1
buffer_store_dwordx4 v[52:55], v251, s[4:7], s21 offen offset:1024 sc1
buffer_store_dwordx4 v[56:59], v251, s[4:7], s21 offen offset:2048 sc1
buffer_store_dwordx4 v[60:63], v251, s[4:7], s21 offen offset:3072 sc1
s_add_u32 s21, s21, 28672
s_mov_b32 s54, 0
main_kernel_w_done:
s_add_u32 s32, s23, 1
s_bitcmp0_b32 s32, 2
s_cselect_b32 s34, 7, 2
s_cselect_b32 s35, 2, 4
s_lshl_b32 s59, s23, 13
s_add_u32 s59, s59, 0x8404000
v_lshrrev_b32 v253, 3, v250
v_add_lshl_u32 v253, s24, v253, 9
v_and_b32 v254, 3, v250
v_lshl_add_u32 v253, v254, s34, v253
v_bfe_u32 v254, v250, 2, 1
v_add_u32 v254, s25, v254
v_lshl_add_u32 v248, v254, s35, v253
s_lshl_b32 s0, 4, s54
main_kernel_w_drain:
s_waitcnt vmcnt(0)
s_barrier
s_cmp_lg_u32 s14, 0
s_cbranch_scc1 main_kernel_w_bar
s_bfm_b64 exec, s0, 0
buffer_store_dword v244, v248, s[4:7], s59 offen sc1
s_mov_b64 exec, -1
s_cmp_eq_u32 s58, -1
s_cbranch_scc1 main_kernel_w_chk
s_lshl_b32 s32, s27, 8
s_add_u32 s32, s32, 0x841e000
s_mov_b64 exec, 1
v_mov_b32 v249, 1
buffer_atomic_add v249, off, s[4:7], s32 sc0 sc1
s_mov_b64 exec, -1
s_branch main_kernel_w_dec
.section .rodata,"a"
.p2align 6
.amdhsa_kernel main_kernel
  .amdhsa_next_free_vgpr 512
  .amdhsa_next_free_sgpr 102
  .amdhsa_accum_offset 256
  .amdhsa_group_segment_fixed_size 0
  .amdhsa_kernarg_size 120
  .amdhsa_user_sgpr_count 2
  .amdhsa_user_sgpr_kernarg_segment_ptr 1
  .amdhsa_system_sgpr_workgroup_id_x 1
.end_amdhsa_kernel
```

```asm
; @launch kernel=main_kernel grid=(256,1,1) block=(256,1,1) lds=163840
.amdgcn_target "amdgcn-amd-amdhsa--gfx950"
.text
.text
.globl main_kernel
.p2align 8
.type main_kernel,@function
main_kernel:
s_load_dwordx4 s[20:23], s[0:1], 104
s_load_dwordx8 s[40:47], s[0:1], 16
s_load_dwordx8 s[64:71], s[0:1], 64
s_load_dwordx2 s[72:73], s[0:1], 0
s_load_dwordx2 s[74:75], s[0:1], 96
s_load_dwordx2 s[76:77], s[0:1], 8
s_cmp_ge_u32 s2, 256
s_cbranch_scc1 main_kernel_end
v_lshrrev_b32 v126, 6, v0
v_and_b32 v94, 63, v0
v_and_b32 v250, 63, v0
v_readfirstlane_b32 s14, v126
s_mov_b32 s29, 0x80000
s_waitcnt lgkmcnt(0)
s_mov_b32 s60, s20
s_and_b32 s61, s21, 0xffff
s_mov_b32 s62, 0x100
s_mov_b32 s63, 0x20000
s_mov_b32 s4, s22
s_and_b32 s5, s23, 0xffff
s_mov_b32 s6, 0x10000000
s_mov_b32 s7, 0x20000
s_cmp_lg_u32 s14, 0
s_cbranch_scc1 main_kernel_slot_wait
s_getreg_b32 s12, hwreg(HW_REG_XCC_ID, 0, 4)
s_and_b32 s12, s12, 7
s_lshl_b32 s32, s12, 5
v_mov_b32 v126, 0
v_mov_b32 v127, 1
s_mov_b64 exec, 1
buffer_atomic_add v127, v126, s[60:63], s32 offen sc0 sc1
s_waitcnt vmcnt(0)
s_mov_b64 exec, -1
v_readfirstlane_b32 s13, v127
s_nop 3
s_cmp_lt_u32 s13, 32
s_cbranch_scc1 main_kernel_slot_pub
v_and_b32 v126, 7, v94
v_lshlrev_b32 v126, 5, v126
main_kernel_ovf_cnt:
buffer_load_dword v127, v126, s[60:63], 0 offen sc1
s_waitcnt vmcnt(0)
v_readlane_b32 s48, v127, 0
v_readlane_b32 s49, v127, 1
v_readlane_b32 s50, v127, 2
v_readlane_b32 s51, v127, 3
v_readlane_b32 s52, v127, 4
v_readlane_b32 s53, v127, 5
v_readlane_b32 s54, v127, 6
v_readlane_b32 s55, v127, 7
s_nop 3
s_add_u32 s33, s48, s49
s_add_u32 s33, s33, s50
s_add_u32 s33, s33, s51
s_add_u32 s33, s33, s52
s_add_u32 s33, s33, s53
s_add_u32 s33, s33, s54
s_add_u32 s33, s33, s55
s_cmp_ge_u32 s33, 256
s_cbranch_scc1 main_kernel_ovf_cnt_ok
s_sub_u32 s29, s29, 1
s_cbranch_scc1 main_kernel_end
s_sleep 4
s_branch main_kernel_ovf_cnt
main_kernel_ovf_cnt_ok:
v_mov_b32 v126, 0
v_mov_b32 v127, 1
s_mov_b64 exec, 1
buffer_atomic_add v127, v126, s[60:63], 0 offen offset:8 sc0 sc1
s_waitcnt vmcnt(0)
s_mov_b64 exec, -1
v_readfirstlane_b32 s33, v127
s_nop 3
s_min_u32 s34, s48, 32
s_sub_u32 s35, 32, s34
s_mov_b32 s12, 0
s_add_u32 s13, s34, s33
s_cmp_lt_u32 s33, s35
s_cbranch_scc1 main_kernel_slot_pub
s_sub_u32 s33, s33, s35
s_min_u32 s34, s49, 32
s_sub_u32 s35, 32, s34
s_mov_b32 s12, 1
s_add_u32 s13, s34, s33
s_cmp_lt_u32 s33, s35
s_cbranch_scc1 main_kernel_slot_pub
s_sub_u32 s33, s33, s35
s_min_u32 s34, s50, 32
s_sub_u32 s35, 32, s34
s_mov_b32 s12, 2
s_add_u32 s13, s34, s33
s_cmp_lt_u32 s33, s35
s_cbranch_scc1 main_kernel_slot_pub
s_sub_u32 s33, s33, s35
s_min_u32 s34, s51, 32
s_sub_u32 s35, 32, s34
s_mov_b32 s12, 3
s_add_u32 s13, s34, s33
s_cmp_lt_u32 s33, s35
s_cbranch_scc1 main_kernel_slot_pub
s_sub_u32 s33, s33, s35
s_min_u32 s34, s52, 32
s_sub_u32 s35, 32, s34
s_mov_b32 s12, 4
s_add_u32 s13, s34, s33
s_cmp_lt_u32 s33, s35
s_cbranch_scc1 main_kernel_slot_pub
s_sub_u32 s33, s33, s35
s_min_u32 s34, s53, 32
s_sub_u32 s35, 32, s34
s_mov_b32 s12, 5
s_add_u32 s13, s34, s33
s_cmp_lt_u32 s33, s35
s_cbranch_scc1 main_kernel_slot_pub
s_sub_u32 s33, s33, s35
s_min_u32 s34, s54, 32
s_sub_u32 s35, 32, s34
s_mov_b32 s12, 6
s_add_u32 s13, s34, s33
s_cmp_lt_u32 s33, s35
s_cbranch_scc1 main_kernel_slot_pub
s_sub_u32 s33, s33, s35
s_min_u32 s34, s55, 32
s_sub_u32 s35, 32, s34
s_mov_b32 s12, 7
s_add_u32 s13, s34, s33
s_cmp_lt_u32 s33, s35
s_cbranch_scc1 main_kernel_slot_pub
s_sub_u32 s33, s33, s35
s_mov_b32 s12, 8
s_mov_b32 s13, 0
main_kernel_slot_pub:
v_mov_b32 v126, 0
v_mov_b32 v127, s12
v_mov_b32 v95, s13
ds_write_b32 v126, v127
ds_write_b32 v126, v95 offset:4
s_waitcnt lgkmcnt(0)
main_kernel_slot_wait:
s_barrier
v_mov_b32 v126, 0
ds_read_b32 v127, v126
ds_read_b32 v95, v126 offset:4
s_waitcnt lgkmcnt(0)
v_readfirstlane_b32 s12, v127
v_readfirstlane_b32 s13, v95
s_nop 3
s_barrier
s_cmp_ge_u32 s12, 8
s_cbranch_scc1 main_kernel_end
s_cmp_lt_u32 s12, 2
s_cbranch_scc1 main_kernel_chain
s_mov_b32 s96, s72
s_and_b32 s97, s73, 0xffff
s_mov_b32 s98, 0x400000
s_mov_b32 s99, 0x20000
s_mov_b32 s92, s74
s_and_b32 s93, s75, 0xffff
s_mov_b32 s94, 0x400000
s_mov_b32 s95, 0x20000
v_lshlrev_b32 v1, 4, v0
v_lshlrev_b32 v251, 4, v250
v_mov_b32 v4, 0
v_mov_b32 v8, -1
v_mov_b32 v5, 0
v_mov_b32 v9, -1
v_mov_b32 v6, 0
v_mov_b32 v10, -1
v_mov_b32 v7, 0
v_mov_b32 v11, -1
v_mul_u32_u24 v12, 128, v0
s_lshl_b32 s15, s12, 4
s_and_b32 s32, s12, 1
s_lshl_b32 s32, s32, 5
s_cmp_lt_u32 s12, 4
s_cselect_b32 s15, s32, s15
s_cselect_b32 s32, 32, 16
s_add_u32 s15, s15, s13
s_sub_u32 s16, s15, 80
s_sub_u32 s27, s12, 2
s_mov_b32 s52, 0
s_cmp_lt_u32 s13, s32
s_cbranch_scc1 main_kernel_s_ln
s_cmp_lg_u32 s13, 16
s_cbranch_scc1 main_kernel_s_fill
s_lshl_b32 s32, s16, 11
s_add_u32 s32, s32, 0x8400000
buffer_store_dwordx4 v[4:7], v1, s[4:7], s32 offen sc1
s_add_u32 s32, s32, 4096
buffer_store_dwordx4 v[4:7], v1, s[4:7], s32 offen sc1
s_add_u32 s32, s32, 4096
buffer_store_dwordx4 v[4:7], v1, s[4:7], s32 offen sc1
s_add_u32 s32, s32, 4096
buffer_store_dwordx4 v[4:7], v1, s[4:7], s32 offen sc1
s_add_u32 s32, s32, 4096
buffer_store_dwordx4 v[4:7], v1, s[4:7], s32 offen sc1
s_add_u32 s32, s32, 4096
buffer_store_dwordx4 v[4:7], v1, s[4:7], s32 offen sc1
s_add_u32 s32, s32, 4096
buffer_store_dwordx4 v[4:7], v1, s[4:7], s32 offen sc1
s_add_u32 s32, s32, 4096
buffer_store_dwordx4 v[4:7], v1, s[4:7], s32 offen sc1
s_add_u32 s32, s32, 4096
v_bfe_u32 v2, v0, 2, 1
s_lshr_b32 s32, s14, 1
v_and_b32 v2, s32, v2
s_bitcmp1_b32 s14, 0
s_cselect_b32 s32, 15, 0
s_cselect_b32 s33, 4161536, 0
v_xor_b32 v2, s32, v2
v_lshlrev_b32 v2, 4, v2
v_and_b32 v3, 3, v0
v_lshl_add_u32 v2, v3, 8, v2
v_lshrrev_b32 v3, 3, v0
v_lshl_add_u32 v2, v3, 10, v2
s_add_u32 s33, s33, 0x4808000
buffer_store_dwordx4 v[4:7], v2, s[4:7], s33 offen sc1
s_waitcnt vmcnt(0)
s_barrier
s_cmp_lg_u32 s14, 0
s_cbranch_scc1 main_kernel_s_fill
v_mov_b32 v2, 1
s_mov_b64 exec, 1
buffer_atomic_add v2, v4, s[60:63], 0 offen offset:12 sc1
s_mov_b64 exec, -1
s_branch main_kernel_s_fill
main_kernel_s_ln:
v_and_b32 v3, 15, v250
v_and_b32 v2, 48, v250
v_lshl_add_u32 v3, v3, 11, v2
s_lshl_b32 s34, s15, 15
s_lshl_b32 s32, s14, 9
s_add_u32 s32, s34, s32
buffer_load_dwordx4 v[32:35], v3, s[96:99], s32 offen offset:0
buffer_load_dwordx4 v[36:39], v3, s[96:99], s32 offen offset:64
buffer_load_dwordx4 v[40:43], v3, s[96:99], s32 offen offset:128
buffer_load_dwordx4 v[44:47], v3, s[96:99], s32 offen offset:192
buffer_load_dwordx4 v[48:51], v3, s[96:99], s32 offen offset:256
buffer_load_dwordx4 v[52:55], v3, s[96:99], s32 offen offset:320
buffer_load_dwordx4 v[56:59], v3, s[96:99], s32 offen offset:384
buffer_load_dwordx4 v[60:63], v3, s[96:99], s32 offen offset:448
v_and_b32 v255, 15, v250
v_lshlrev_b32 v254, 6, v255
v_add_u32 v254, 132096, v254
v_lshrrev_b32 v255, 4, v250
v_lshl_add_u32 v253, v255, 2, v254
v_lshl_add_u32 v253, s14, 4, v253
s_lshl_b32 s32, s14, 13
s_add_u32 s34, s34, s32
s_waitcnt vmcnt(0)
v_permlane16_swap_b32 v32, v34
v_permlane16_swap_b32 v33, v35
v_permlane16_swap_b32 v36, v38
v_permlane16_swap_b32 v37, v39
v_permlane16_swap_b32 v40, v42
v_permlane16_swap_b32 v41, v43
v_permlane16_swap_b32 v44, v46
v_permlane16_swap_b32 v45, v47
v_permlane16_swap_b32 v48, v50
v_permlane16_swap_b32 v49, v51
v_permlane16_swap_b32 v52, v54
v_permlane16_swap_b32 v53, v55
v_permlane16_swap_b32 v56, v58
v_permlane16_swap_b32 v57, v59
v_permlane16_swap_b32 v60, v62
v_permlane16_swap_b32 v61, v63
v_permlane32_swap_b32 v32, v34
v_permlane32_swap_b32 v33, v35
v_permlane32_swap_b32 v36, v38
v_permlane32_swap_b32 v37, v39
v_permlane32_swap_b32 v40, v42
v_permlane32_swap_b32 v41, v43
v_permlane32_swap_b32 v44, v46
v_permlane32_swap_b32 v45, v47
v_permlane32_swap_b32 v48, v50
v_permlane32_swap_b32 v49, v51
v_permlane32_swap_b32 v52, v54
v_permlane32_swap_b32 v53, v55
v_permlane32_swap_b32 v56, v58
v_permlane32_swap_b32 v57, v59
v_permlane32_swap_b32 v60, v62
v_permlane32_swap_b32 v61, v63
s_lshr_b32 s32, s15, 3
s_lshl_b32 s32, s32, 9
s_and_b32 s33, s15, 7
s_lshl_b32 s33, s33, 4
s_add_u32 s32, s32, s33
s_add_u32 s16, s32, 0x8416000
v_lshlrev_b32 v64, 16, v32
v_and_b32 v65, 0xffff0000, v32
v_lshlrev_b32 v66, 16, v33
v_and_b32 v67, 0xffff0000, v33
v_lshlrev_b32 v68, 16, v34
v_and_b32 v69, 0xffff0000, v34
v_lshlrev_b32 v70, 16, v35
v_and_b32 v71, 0xffff0000, v35
v_lshlrev_b32 v72, 16, v36
v_and_b32 v73, 0xffff0000, v36
v_lshlrev_b32 v74, 16, v37
v_and_b32 v75, 0xffff0000, v37
v_lshlrev_b32 v76, 16, v38
v_and_b32 v77, 0xffff0000, v38
v_lshlrev_b32 v78, 16, v39
v_and_b32 v79, 0xffff0000, v39
v_lshlrev_b32 v80, 16, v40
v_and_b32 v81, 0xffff0000, v40
v_lshlrev_b32 v82, 16, v41
v_and_b32 v83, 0xffff0000, v41
v_lshlrev_b32 v84, 16, v42
v_and_b32 v85, 0xffff0000, v42
v_lshlrev_b32 v86, 16, v43
v_and_b32 v87, 0xffff0000, v43
v_lshlrev_b32 v88, 16, v44
v_and_b32 v89, 0xffff0000, v44
v_lshlrev_b32 v90, 16, v45
v_and_b32 v91, 0xffff0000, v45
v_lshlrev_b32 v92, 16, v46
v_and_b32 v93, 0xffff0000, v46
v_lshlrev_b32 v94, 16, v47
v_and_b32 v95, 0xffff0000, v47
v_lshlrev_b32 v96, 16, v48
v_and_b32 v97, 0xffff0000, v48
v_lshlrev_b32 v98, 16, v49
v_and_b32 v99, 0xffff0000, v49
v_lshlrev_b32 v100, 16, v50
v_and_b32 v101, 0xffff0000, v50
v_lshlrev_b32 v102, 16, v51
v_and_b32 v103, 0xffff0000, v51
v_lshlrev_b32 v104, 16, v52
v_and_b32 v105, 0xffff0000, v52
v_lshlrev_b32 v106, 16, v53
v_and_b32 v107, 0xffff0000, v53
v_lshlrev_b32 v108, 16, v54
v_and_b32 v109, 0xffff0000, v54
v_lshlrev_b32 v110, 16, v55
v_and_b32 v111, 0xffff0000, v55
v_lshlrev_b32 v112, 16, v56
v_and_b32 v113, 0xffff0000, v56
v_lshlrev_b32 v114, 16, v57
v_and_b32 v115, 0xffff0000, v57
v_lshlrev_b32 v116, 16, v58
v_and_b32 v117, 0xffff0000, v58
v_lshlrev_b32 v118, 16, v59
v_and_b32 v119, 0xffff0000, v59
v_lshlrev_b32 v120, 16, v60
v_and_b32 v121, 0xffff0000, v60
v_lshlrev_b32 v122, 16, v61
v_and_b32 v123, 0xffff0000, v61
v_lshlrev_b32 v124, 16, v62
v_and_b32 v125, 0xffff0000, v62
v_lshlrev_b32 v126, 16, v63
v_and_b32 v127, 0xffff0000, v63
v_pk_add_f32 v[16:17], v[64:65], v[72:73]
v_pk_add_f32 v[18:19], v[66:67], v[74:75]
v_pk_add_f32 v[20:21], v[68:69], v[76:77]
v_pk_add_f32 v[22:23], v[70:71], v[78:79]
v_pk_add_f32 v[16:17], v[16:17], v[80:81]
v_pk_add_f32 v[18:19], v[18:19], v[82:83]
v_pk_add_f32 v[20:21], v[20:21], v[84:85]
v_pk_add_f32 v[22:23], v[22:23], v[86:87]
v_pk_add_f32 v[16:17], v[16:17], v[88:89]
v_pk_add_f32 v[18:19], v[18:19], v[90:91]
v_pk_add_f32 v[20:21], v[20:21], v[92:93]
v_pk_add_f32 v[22:23], v[22:23], v[94:95]
v_pk_add_f32 v[16:17], v[16:17], v[96:97]
v_pk_add_f32 v[18:19], v[18:19], v[98:99]
v_pk_add_f32 v[20:21], v[20:21], v[100:101]
v_pk_add_f32 v[22:23], v[22:23], v[102:103]
v_pk_add_f32 v[16:17], v[16:17], v[104:105]
v_pk_add_f32 v[18:19], v[18:19], v[106:107]
v_pk_add_f32 v[20:21], v[20:21], v[108:109]
v_pk_add_f32 v[22:23], v[22:23], v[110:111]
v_pk_add_f32 v[16:17], v[16:17], v[112:113]
v_pk_add_f32 v[18:19], v[18:19], v[114:115]
v_pk_add_f32 v[20:21], v[20:21], v[116:117]
v_pk_add_f32 v[22:23], v[22:23], v[118:119]
v_pk_add_f32 v[16:17], v[16:17], v[120:121]
v_pk_add_f32 v[18:19], v[18:19], v[122:123]
v_pk_add_f32 v[20:21], v[20:21], v[124:125]
v_pk_add_f32 v[22:23], v[22:23], v[126:127]
v_pk_add_f32 v[16:17], v[16:17], v[18:19]
v_pk_add_f32 v[20:21], v[20:21], v[22:23]
v_pk_add_f32 v[16:17], v[16:17], v[20:21]
v_add_f32 v16, v16, v17
ds_write_b32 v253, v16 offset:0
s_waitcnt lgkmcnt(0)
s_barrier
ds_read_b128 v[16:19], v254 offset:0
ds_read_b128 v[20:23], v254 offset:16
ds_read_b128 v[24:27], v254 offset:32
ds_read_b128 v[28:31], v254 offset:48
s_waitcnt lgkmcnt(2)
v_pk_add_f32 v[16:17], v[16:17], v[18:19]
v_pk_add_f32 v[20:21], v[20:21], v[22:23]
s_waitcnt lgkmcnt(0)
v_pk_add_f32 v[24:25], v[24:25], v[26:27]
v_pk_add_f32 v[28:29], v[28:29], v[30:31]
v_pk_add_f32 v[16:17], v[16:17], v[20:21]
v_pk_add_f32 v[24:25], v[24:25], v[28:29]
v_pk_add_f32 v[16:17], v[16:17], v[24:25]
v_add_f32 v16, v16, v17
v_mul_f32 v16, 0xba800000, v16
v_mov_b32 v17, v16
v_pk_add_f32 v[64:65], v[64:65], v[16:17]
v_pk_add_f32 v[66:67], v[66:67], v[16:17]
v_pk_add_f32 v[68:69], v[68:69], v[16:17]
v_pk_add_f32 v[70:71], v[70:71], v[16:17]
v_pk_add_f32 v[72:73], v[72:73], v[16:17]
v_pk_add_f32 v[74:75], v[74:75], v[16:17]
v_pk_add_f32 v[76:77], v[76:77], v[16:17]
v_pk_add_f32 v[78:79], v[78:79], v[16:17]
v_pk_add_f32 v[80:81], v[80:81], v[16:17]
v_pk_add_f32 v[82:83], v[82:83], v[16:17]
v_pk_add_f32 v[84:85], v[84:85], v[16:17]
v_pk_add_f32 v[86:87], v[86:87], v[16:17]
v_pk_add_f32 v[88:89], v[88:89], v[16:17]
v_pk_add_f32 v[90:91], v[90:91], v[16:17]
v_pk_add_f32 v[92:93], v[92:93], v[16:17]
v_pk_add_f32 v[94:95], v[94:95], v[16:17]
v_pk_add_f32 v[96:97], v[96:97], v[16:17]
v_pk_add_f32 v[98:99], v[98:99], v[16:17]
v_pk_add_f32 v[100:101], v[100:101], v[16:17]
v_pk_add_f32 v[102:103], v[102:103], v[16:17]
v_pk_add_f32 v[104:105], v[104:105], v[16:17]
v_pk_add_f32 v[106:107], v[106:107], v[16:17]
v_pk_add_f32 v[108:109], v[108:109], v[16:17]
v_pk_add_f32 v[110:111], v[110:111], v[16:17]
v_pk_add_f32 v[112:113], v[112:113], v[16:17]
v_pk_add_f32 v[114:115], v[114:115], v[16:17]
v_pk_add_f32 v[116:117], v[116:117], v[16:17]
v_pk_add_f32 v[118:119], v[118:119], v[16:17]
v_pk_add_f32 v[120:121], v[120:121], v[16:17]
v_pk_add_f32 v[122:123], v[122:123], v[16:17]
v_pk_add_f32 v[124:125], v[124:125], v[16:17]
v_pk_add_f32 v[126:127], v[126:127], v[16:17]
v_pk_mul_f32 v[16:17], v[64:65], v[64:65]
v_pk_mul_f32 v[18:19], v[66:67], v[66:67]
v_pk_mul_f32 v[20:21], v[68:69], v[68:69]
v_pk_mul_f32 v[22:23], v[70:71], v[70:71]
v_pk_fma_f32 v[16:17], v[72:73], v[72:73], v[16:17]
v_pk_fma_f32 v[18:19], v[74:75], v[74:75], v[18:19]
v_pk_fma_f32 v[20:21], v[76:77], v[76:77], v[20:21]
v_pk_fma_f32 v[22:23], v[78:79], v[78:79], v[22:23]
v_pk_fma_f32 v[16:17], v[80:81], v[80:81], v[16:17]
v_pk_fma_f32 v[18:19], v[82:83], v[82:83], v[18:19]
v_pk_fma_f32 v[20:21], v[84:85], v[84:85], v[20:21]
v_pk_fma_f32 v[22:23], v[86:87], v[86:87], v[22:23]
v_pk_fma_f32 v[16:17], v[88:89], v[88:89], v[16:17]
v_pk_fma_f32 v[18:19], v[90:91], v[90:91], v[18:19]
v_pk_fma_f32 v[20:21], v[92:93], v[92:93], v[20:21]
v_pk_fma_f32 v[22:23], v[94:95], v[94:95], v[22:23]
v_pk_fma_f32 v[16:17], v[96:97], v[96:97], v[16:17]
v_pk_fma_f32 v[18:19], v[98:99], v[98:99], v[18:19]
v_pk_fma_f32 v[20:21], v[100:101], v[100:101], v[20:21]
v_pk_fma_f32 v[22:23], v[102:103], v[102:103], v[22:23]
v_pk_fma_f32 v[16:17], v[104:105], v[104:105], v[16:17]
v_pk_fma_f32 v[18:19], v[106:107], v[106:107], v[18:19]
v_pk_fma_f32 v[20:21], v[108:109], v[108:109], v[20:21]
v_pk_fma_f32 v[22:23], v[110:111], v[110:111], v[22:23]
v_pk_fma_f32 v[16:17], v[112:113], v[112:113], v[16:17]
v_pk_fma_f32 v[18:19], v[114:115], v[114:115], v[18:19]
v_pk_fma_f32 v[20:21], v[116:117], v[116:117], v[20:21]
v_pk_fma_f32 v[22:23], v[118:119], v[118:119], v[22:23]
v_pk_fma_f32 v[16:17], v[120:121], v[120:121], v[16:17]
v_pk_fma_f32 v[18:19], v[122:123], v[122:123], v[18:19]
v_pk_fma_f32 v[20:21], v[124:125], v[124:125], v[20:21]
v_pk_fma_f32 v[22:23], v[126:127], v[126:127], v[22:23]
v_pk_add_f32 v[16:17], v[16:17], v[18:19]
v_pk_add_f32 v[20:21], v[20:21], v[22:23]
v_pk_add_f32 v[16:17], v[16:17], v[20:21]
v_add_f32 v16, v16, v17
ds_write_b32 v253, v16 offset:1024
s_waitcnt lgkmcnt(0)
s_barrier
ds_read_b128 v[16:19], v254 offset:1024
ds_read_b128 v[20:23], v254 offset:1040
ds_read_b128 v[24:27], v254 offset:1056
ds_read_b128 v[28:31], v254 offset:1072
s_waitcnt lgkmcnt(2)
v_pk_add_f32 v[16:17], v[16:17], v[18:19]
v_pk_add_f32 v[20:21], v[20:21], v[22:23]
s_waitcnt lgkmcnt(0)
v_pk_add_f32 v[24:25], v[24:25], v[26:27]
v_pk_add_f32 v[28:29], v[28:29], v[30:31]
v_pk_add_f32 v[16:17], v[16:17], v[20:21]
v_pk_add_f32 v[24:25], v[24:25], v[28:29]
v_pk_add_f32 v[16:17], v[16:17], v[24:25]
v_add_f32 v16, v16, v17
v_mov_b32 v17, 0x3727c5ac
v_fmac_f32 v17, 0x3a800000, v16
v_rsq_f32 v16, v17
s_nop 0
v_mov_b32 v17, v16
v_pk_mul_f32 v[64:65], v[64:65], v[16:17]
v_pk_mul_f32 v[66:67], v[66:67], v[16:17]
v_pk_mul_f32 v[68:69], v[68:69], v[16:17]
v_pk_mul_f32 v[70:71], v[70:71], v[16:17]
v_pk_mul_f32 v[72:73], v[72:73], v[16:17]
v_pk_mul_f32 v[74:75], v[74:75], v[16:17]
v_pk_mul_f32 v[76:77], v[76:77], v[16:17]
v_pk_mul_f32 v[78:79], v[78:79], v[16:17]
v_pk_mul_f32 v[80:81], v[80:81], v[16:17]
v_pk_mul_f32 v[82:83], v[82:83], v[16:17]
v_pk_mul_f32 v[84:85], v[84:85], v[16:17]
v_pk_mul_f32 v[86:87], v[86:87], v[16:17]
v_pk_mul_f32 v[88:89], v[88:89], v[16:17]
v_pk_mul_f32 v[90:91], v[90:91], v[16:17]
v_pk_mul_f32 v[92:93], v[92:93], v[16:17]
v_pk_mul_f32 v[94:95], v[94:95], v[16:17]
v_pk_mul_f32 v[96:97], v[96:97], v[16:17]
v_pk_mul_f32 v[98:99], v[98:99], v[16:17]
v_pk_mul_f32 v[100:101], v[100:101], v[16:17]
v_pk_mul_f32 v[102:103], v[102:103], v[16:17]
v_pk_mul_f32 v[104:105], v[104:105], v[16:17]
v_pk_mul_f32 v[106:107], v[106:107], v[16:17]
v_pk_mul_f32 v[108:109], v[108:109], v[16:17]
v_pk_mul_f32 v[110:111], v[110:111], v[16:17]
v_pk_mul_f32 v[112:113], v[112:113], v[16:17]
v_pk_mul_f32 v[114:115], v[114:115], v[16:17]
v_pk_mul_f32 v[116:117], v[116:117], v[16:17]
v_pk_mul_f32 v[118:119], v[118:119], v[16:17]
v_pk_mul_f32 v[120:121], v[120:121], v[16:17]
v_pk_mul_f32 v[122:123], v[122:123], v[16:17]
v_pk_mul_f32 v[124:125], v[124:125], v[16:17]
v_pk_mul_f32 v[126:127], v[126:127], v[16:17]
v_cvt_pk_bf16_f32 v128, v64, v65
v_cvt_pk_bf16_f32 v129, v66, v67
v_cvt_pk_bf16_f32 v130, v68, v69
v_cvt_pk_bf16_f32 v131, v70, v71
v_cvt_pk_bf16_f32 v132, v72, v73
v_cvt_pk_bf16_f32 v133, v74, v75
v_cvt_pk_bf16_f32 v134, v76, v77
v_cvt_pk_bf16_f32 v135, v78, v79
v_cvt_pk_bf16_f32 v136, v80, v81
v_cvt_pk_bf16_f32 v137, v82, v83
v_cvt_pk_bf16_f32 v138, v84, v85
v_cvt_pk_bf16_f32 v139, v86, v87
v_cvt_pk_bf16_f32 v140, v88, v89
v_cvt_pk_bf16_f32 v141, v90, v91
v_cvt_pk_bf16_f32 v142, v92, v93
v_cvt_pk_bf16_f32 v143, v94, v95
v_cvt_pk_bf16_f32 v144, v96, v97
v_cvt_pk_bf16_f32 v145, v98, v99
v_cvt_pk_bf16_f32 v146, v100, v101
v_cvt_pk_bf16_f32 v147, v102, v103
v_cvt_pk_bf16_f32 v148, v104, v105
v_cvt_pk_bf16_f32 v149, v106, v107
v_cvt_pk_bf16_f32 v150, v108, v109
v_cvt_pk_bf16_f32 v151, v110, v111
v_cvt_pk_bf16_f32 v152, v112, v113
v_cvt_pk_bf16_f32 v153, v114, v115
v_cvt_pk_bf16_f32 v154, v116, v117
v_cvt_pk_bf16_f32 v155, v118, v119
v_cvt_pk_bf16_f32 v156, v120, v121
v_cvt_pk_bf16_f32 v157, v122, v123
v_cvt_pk_bf16_f32 v158, v124, v125
v_cvt_pk_bf16_f32 v159, v126, v127
s_add_u32 s32, s34, 0x0
s_add_u32 s33, s32, 4096
buffer_store_dwordx4 v[128:131], v251, s[4:7], s32 offen offset:0 sc1
buffer_store_dwordx4 v[132:135], v251, s[4:7], s32 offen offset:1024 sc1
buffer_store_dwordx4 v[136:139], v251, s[4:7], s32 offen offset:2048 sc1
buffer_store_dwordx4 v[140:143], v251, s[4:7], s32 offen offset:3072 sc1
buffer_store_dwordx4 v[144:147], v251, s[4:7], s33 offen offset:0 sc1
buffer_store_dwordx4 v[148:151], v251, s[4:7], s33 offen offset:1024 sc1
buffer_store_dwordx4 v[152:155], v251, s[4:7], s33 offen offset:2048 sc1
buffer_store_dwordx4 v[156:159], v251, s[4:7], s33 offen offset:3072 sc1
buffer_load_dword v2, v4, s[60:63], 0 offen offset:12 sc1
v_lshlrev_b32 v64, 16, v128
v_and_b32 v65, 0xffff0000, v128
v_lshlrev_b32 v66, 16, v129
v_and_b32 v67, 0xffff0000, v129
v_lshlrev_b32 v68, 16, v130
v_and_b32 v69, 0xffff0000, v130
v_lshlrev_b32 v70, 16, v131
v_and_b32 v71, 0xffff0000, v131
v_lshlrev_b32 v72, 16, v132
v_and_b32 v73, 0xffff0000, v132
v_lshlrev_b32 v74, 16, v133
v_and_b32 v75, 0xffff0000, v133
v_lshlrev_b32 v76, 16, v134
v_and_b32 v77, 0xffff0000, v134
v_lshlrev_b32 v78, 16, v135
v_and_b32 v79, 0xffff0000, v135
v_lshlrev_b32 v80, 16, v136
v_and_b32 v81, 0xffff0000, v136
v_lshlrev_b32 v82, 16, v137
v_and_b32 v83, 0xffff0000, v137
v_lshlrev_b32 v84, 16, v138
v_and_b32 v85, 0xffff0000, v138
v_lshlrev_b32 v86, 16, v139
v_and_b32 v87, 0xffff0000, v139
v_lshlrev_b32 v88, 16, v140
v_and_b32 v89, 0xffff0000, v140
v_lshlrev_b32 v90, 16, v141
v_and_b32 v91, 0xffff0000, v141
v_lshlrev_b32 v92, 16, v142
v_and_b32 v93, 0xffff0000, v142
v_lshlrev_b32 v94, 16, v143
v_and_b32 v95, 0xffff0000, v143
v_lshlrev_b32 v96, 16, v144
v_and_b32 v97, 0xffff0000, v144
v_lshlrev_b32 v98, 16, v145
v_and_b32 v99, 0xffff0000, v145
v_lshlrev_b32 v100, 16, v146
v_and_b32 v101, 0xffff0000, v146
v_lshlrev_b32 v102, 16, v147
v_and_b32 v103, 0xffff0000, v147
v_lshlrev_b32 v104, 16, v148
v_and_b32 v105, 0xffff0000, v148
v_lshlrev_b32 v106, 16, v149
v_and_b32 v107, 0xffff0000, v149
v_lshlrev_b32 v108, 16, v150
v_and_b32 v109, 0xffff0000, v150
v_lshlrev_b32 v110, 16, v151
v_and_b32 v111, 0xffff0000, v151
v_lshlrev_b32 v112, 16, v152
v_and_b32 v113, 0xffff0000, v152
v_lshlrev_b32 v114, 16, v153
v_and_b32 v115, 0xffff0000, v153
v_lshlrev_b32 v116, 16, v154
v_and_b32 v117, 0xffff0000, v154
v_lshlrev_b32 v118, 16, v155
v_and_b32 v119, 0xffff0000, v155
v_lshlrev_b32 v120, 16, v156
v_and_b32 v121, 0xffff0000, v156
v_lshlrev_b32 v122, 16, v157
v_and_b32 v123, 0xffff0000, v157
v_lshlrev_b32 v124, 16, v158
v_and_b32 v125, 0xffff0000, v158
v_lshlrev_b32 v126, 16, v159
v_and_b32 v127, 0xffff0000, v159
v_pk_add_f32 v[16:17], v[64:65], v[72:73]
v_pk_add_f32 v[18:19], v[66:67], v[74:75]
v_pk_add_f32 v[20:21], v[68:69], v[76:77]
v_pk_add_f32 v[22:23], v[70:71], v[78:79]
v_pk_add_f32 v[16:17], v[16:17], v[80:81]
v_pk_add_f32 v[18:19], v[18:19], v[82:83]
v_pk_add_f32 v[20:21], v[20:21], v[84:85]
v_pk_add_f32 v[22:23], v[22:23], v[86:87]
v_pk_add_f32 v[16:17], v[16:17], v[88:89]
v_pk_add_f32 v[18:19], v[18:19], v[90:91]
v_pk_add_f32 v[20:21], v[20:21], v[92:93]
v_pk_add_f32 v[22:23], v[22:23], v[94:95]
v_pk_add_f32 v[16:17], v[16:17], v[96:97]
v_pk_add_f32 v[18:19], v[18:19], v[98:99]
v_pk_add_f32 v[20:21], v[20:21], v[100:101]
v_pk_add_f32 v[22:23], v[22:23], v[102:103]
v_pk_add_f32 v[16:17], v[16:17], v[104:105]
v_pk_add_f32 v[18:19], v[18:19], v[106:107]
v_pk_add_f32 v[20:21], v[20:21], v[108:109]
v_pk_add_f32 v[22:23], v[22:23], v[110:111]
v_pk_add_f32 v[16:17], v[16:17], v[112:113]
v_pk_add_f32 v[18:19], v[18:19], v[114:115]
v_pk_add_f32 v[20:21], v[20:21], v[116:117]
v_pk_add_f32 v[22:23], v[22:23], v[118:119]
v_pk_add_f32 v[16:17], v[16:17], v[120:121]
v_pk_add_f32 v[18:19], v[18:19], v[122:123]
v_pk_add_f32 v[20:21], v[20:21], v[124:125]
v_pk_add_f32 v[22:23], v[22:23], v[126:127]
v_pk_add_f32 v[16:17], v[16:17], v[18:19]
v_pk_add_f32 v[20:21], v[20:21], v[22:23]
v_pk_add_f32 v[16:17], v[16:17], v[20:21]
v_add_f32 v16, v16, v17
ds_write_b32 v253, v16 offset:0
s_waitcnt lgkmcnt(0)
s_barrier
ds_read_b128 v[16:19], v254 offset:0
ds_read_b128 v[20:23], v254 offset:16
ds_read_b128 v[24:27], v254 offset:32
ds_read_b128 v[28:31], v254 offset:48
s_waitcnt lgkmcnt(2)
v_pk_add_f32 v[16:17], v[16:17], v[18:19]
v_pk_add_f32 v[20:21], v[20:21], v[22:23]
s_waitcnt lgkmcnt(0)
v_pk_add_f32 v[24:25], v[24:25], v[26:27]
v_pk_add_f32 v[28:29], v[28:29], v[30:31]
v_pk_add_f32 v[16:17], v[16:17], v[20:21]
v_pk_add_f32 v[24:25], v[24:25], v[28:29]
v_pk_add_f32 v[16:17], v[16:17], v[24:25]
v_add_f32 v16, v16, v17
v_mul_f32 v16, 0xba800000, v16
v_mov_b32 v17, v16
v_pk_add_f32 v[64:65], v[64:65], v[16:17]
v_pk_add_f32 v[66:67], v[66:67], v[16:17]
v_pk_add_f32 v[68:69], v[68:69], v[16:17]
v_pk_add_f32 v[70:71], v[70:71], v[16:17]
v_pk_add_f32 v[72:73], v[72:73], v[16:17]
v_pk_add_f32 v[74:75], v[74:75], v[16:17]
v_pk_add_f32 v[76:77], v[76:77], v[16:17]
v_pk_add_f32 v[78:79], v[78:79], v[16:17]
v_pk_add_f32 v[80:81], v[80:81], v[16:17]
v_pk_add_f32 v[82:83], v[82:83], v[16:17]
v_pk_add_f32 v[84:85], v[84:85], v[16:17]
v_pk_add_f32 v[86:87], v[86:87], v[16:17]
v_pk_add_f32 v[88:89], v[88:89], v[16:17]
v_pk_add_f32 v[90:91], v[90:91], v[16:17]
v_pk_add_f32 v[92:93], v[92:93], v[16:17]
v_pk_add_f32 v[94:95], v[94:95], v[16:17]
v_pk_add_f32 v[96:97], v[96:97], v[16:17]
v_pk_add_f32 v[98:99], v[98:99], v[16:17]
v_pk_add_f32 v[100:101], v[100:101], v[16:17]
v_pk_add_f32 v[102:103], v[102:103], v[16:17]
v_pk_add_f32 v[104:105], v[104:105], v[16:17]
v_pk_add_f32 v[106:107], v[106:107], v[16:17]
v_pk_add_f32 v[108:109], v[108:109], v[16:17]
v_pk_add_f32 v[110:111], v[110:111], v[16:17]
v_pk_add_f32 v[112:113], v[112:113], v[16:17]
v_pk_add_f32 v[114:115], v[114:115], v[16:17]
v_pk_add_f32 v[116:117], v[116:117], v[16:17]
v_pk_add_f32 v[118:119], v[118:119], v[16:17]
v_pk_add_f32 v[120:121], v[120:121], v[16:17]
v_pk_add_f32 v[122:123], v[122:123], v[16:17]
v_pk_add_f32 v[124:125], v[124:125], v[16:17]
v_pk_add_f32 v[126:127], v[126:127], v[16:17]
v_pk_mul_f32 v[16:17], v[64:65], v[64:65]
v_pk_mul_f32 v[18:19], v[66:67], v[66:67]
v_pk_mul_f32 v[20:21], v[68:69], v[68:69]
v_pk_mul_f32 v[22:23], v[70:71], v[70:71]
v_pk_fma_f32 v[16:17], v[72:73], v[72:73], v[16:17]
v_pk_fma_f32 v[18:19], v[74:75], v[74:75], v[18:19]
v_pk_fma_f32 v[20:21], v[76:77], v[76:77], v[20:21]
v_pk_fma_f32 v[22:23], v[78:79], v[78:79], v[22:23]
v_pk_fma_f32 v[16:17], v[80:81], v[80:81], v[16:17]
v_pk_fma_f32 v[18:19], v[82:83], v[82:83], v[18:19]
v_pk_fma_f32 v[20:21], v[84:85], v[84:85], v[20:21]
v_pk_fma_f32 v[22:23], v[86:87], v[86:87], v[22:23]
v_pk_fma_f32 v[16:17], v[88:89], v[88:89], v[16:17]
v_pk_fma_f32 v[18:19], v[90:91], v[90:91], v[18:19]
v_pk_fma_f32 v[20:21], v[92:93], v[92:93], v[20:21]
v_pk_fma_f32 v[22:23], v[94:95], v[94:95], v[22:23]
v_pk_fma_f32 v[16:17], v[96:97], v[96:97], v[16:17]
v_pk_fma_f32 v[18:19], v[98:99], v[98:99], v[18:19]
v_pk_fma_f32 v[20:21], v[100:101], v[100:101], v[20:21]
v_pk_fma_f32 v[22:23], v[102:103], v[102:103], v[22:23]
v_pk_fma_f32 v[16:17], v[104:105], v[104:105], v[16:17]
v_pk_fma_f32 v[18:19], v[106:107], v[106:107], v[18:19]
v_pk_fma_f32 v[20:21], v[108:109], v[108:109], v[20:21]
v_pk_fma_f32 v[22:23], v[110:111], v[110:111], v[22:23]
v_pk_fma_f32 v[16:17], v[112:113], v[112:113], v[16:17]
v_pk_fma_f32 v[18:19], v[114:115], v[114:115], v[18:19]
v_pk_fma_f32 v[20:21], v[116:117], v[116:117], v[20:21]
v_pk_fma_f32 v[22:23], v[118:119], v[118:119], v[22:23]
v_pk_fma_f32 v[16:17], v[120:121], v[120:121], v[16:17]
v_pk_fma_f32 v[18:19], v[122:123], v[122:123], v[18:19]
v_pk_fma_f32 v[20:21], v[124:125], v[124:125], v[20:21]
v_pk_fma_f32 v[22:23], v[126:127], v[126:127], v[22:23]
v_pk_add_f32 v[16:17], v[16:17], v[18:19]
v_pk_add_f32 v[20:21], v[20:21], v[22:23]
v_pk_add_f32 v[16:17], v[16:17], v[20:21]
v_add_f32 v16, v16, v17
ds_write_b32 v253, v16 offset:1024
s_waitcnt lgkmcnt(0)
s_waitcnt vmcnt(0)
s_barrier
s_cmp_lg_u32 s14, 0
s_cbranch_scc1 main_kernel_s_nf
v_cmp_gt_u32 vcc, 4, v2
s_cbranch_vccz main_kernel_s_wa1_ok
v_mov_b32 v2, 0
main_kernel_s_wa1:
buffer_load_dword v3, v2, s[60:63], 0 offen offset:12 sc1
s_waitcnt vmcnt(0)
v_cmp_gt_u32 vcc, 4, v3
s_cbranch_vccz main_kernel_s_wa1_ok
s_sleep 4
s_sub_u32 s29, s29, 1
s_cbranch_scc0 main_kernel_s_wa1
s_branch main_kernel_end
main_kernel_s_wa1_ok:
s_mov_b64 exec, 1
buffer_store_dword v8, v4, s[4:7], s16 offen sc1
s_mov_b64 exec, -1
main_kernel_s_nf:
ds_read_b128 v[16:19], v254 offset:1024
ds_read_b128 v[20:23], v254 offset:1040
ds_read_b128 v[24:27], v254 offset:1056
ds_read_b128 v[28:31], v254 offset:1072
s_waitcnt lgkmcnt(2)
v_pk_add_f32 v[16:17], v[16:17], v[18:19]
v_pk_add_f32 v[20:21], v[20:21], v[22:23]
s_waitcnt lgkmcnt(0)
v_pk_add_f32 v[24:25], v[24:25], v[26:27]
v_pk_add_f32 v[28:29], v[28:29], v[30:31]
v_pk_add_f32 v[16:17], v[16:17], v[20:21]
v_pk_add_f32 v[24:25], v[24:25], v[28:29]
v_pk_add_f32 v[16:17], v[16:17], v[24:25]
v_add_f32 v16, v16, v17
v_mov_b32 v17, 0x3727c5ac
v_fmac_f32 v17, 0x3a800000, v16
v_rsq_f32 v16, v17
s_nop 0
v_mov_b32 v17, v16
v_pk_mul_f32 v[64:65], v[64:65], v[16:17]
v_pk_mul_f32 v[66:67], v[66:67], v[16:17]
v_pk_mul_f32 v[68:69], v[68:69], v[16:17]
v_pk_mul_f32 v[70:71], v[70:71], v[16:17]
v_pk_mul_f32 v[72:73], v[72:73], v[16:17]
v_pk_mul_f32 v[74:75], v[74:75], v[16:17]
v_pk_mul_f32 v[76:77], v[76:77], v[16:17]
v_pk_mul_f32 v[78:79], v[78:79], v[16:17]
v_pk_mul_f32 v[80:81], v[80:81], v[16:17]
v_pk_mul_f32 v[82:83], v[82:83], v[16:17]
v_pk_mul_f32 v[84:85], v[84:85], v[16:17]
v_pk_mul_f32 v[86:87], v[86:87], v[16:17]
v_pk_mul_f32 v[88:89], v[88:89], v[16:17]
v_pk_mul_f32 v[90:91], v[90:91], v[16:17]
v_pk_mul_f32 v[92:93], v[92:93], v[16:17]
v_pk_mul_f32 v[94:95], v[94:95], v[16:17]
v_pk_mul_f32 v[96:97], v[96:97], v[16:17]
v_pk_mul_f32 v[98:99], v[98:99], v[16:17]
v_pk_mul_f32 v[100:101], v[100:101], v[16:17]
v_pk_mul_f32 v[102:103], v[102:103], v[16:17]
v_pk_mul_f32 v[104:105], v[104:105], v[16:17]
v_pk_mul_f32 v[106:107], v[106:107], v[16:17]
v_pk_mul_f32 v[108:109], v[108:109], v[16:17]
v_pk_mul_f32 v[110:111], v[110:111], v[16:17]
v_pk_mul_f32 v[112:113], v[112:113], v[16:17]
v_pk_mul_f32 v[114:115], v[114:115], v[16:17]
v_pk_mul_f32 v[116:117], v[116:117], v[16:17]
v_pk_mul_f32 v[118:119], v[118:119], v[16:17]
v_pk_mul_f32 v[120:121], v[120:121], v[16:17]
v_pk_mul_f32 v[122:123], v[122:123], v[16:17]
v_pk_mul_f32 v[124:125], v[124:125], v[16:17]
v_pk_mul_f32 v[126:127], v[126:127], v[16:17]
v_cvt_pk_bf16_f32 v32, v64, v65
v_cvt_pk_bf16_f32 v33, v66, v67
v_cvt_pk_bf16_f32 v34, v68, v69
v_cvt_pk_bf16_f32 v35, v70, v71
v_cvt_pk_bf16_f32 v36, v72, v73
v_cvt_pk_bf16_f32 v37, v74, v75
v_cvt_pk_bf16_f32 v38, v76, v77
v_cvt_pk_bf16_f32 v39, v78, v79
v_cvt_pk_bf16_f32 v40, v80, v81
v_cvt_pk_bf16_f32 v41, v82, v83
v_cvt_pk_bf16_f32 v42, v84, v85
v_cvt_pk_bf16_f32 v43, v86, v87
v_cvt_pk_bf16_f32 v44, v88, v89
v_cvt_pk_bf16_f32 v45, v90, v91
v_cvt_pk_bf16_f32 v46, v92, v93
v_cvt_pk_bf16_f32 v47, v94, v95
v_cvt_pk_bf16_f32 v48, v96, v97
v_cvt_pk_bf16_f32 v49, v98, v99
v_cvt_pk_bf16_f32 v50, v100, v101
v_cvt_pk_bf16_f32 v51, v102, v103
v_cvt_pk_bf16_f32 v52, v104, v105
v_cvt_pk_bf16_f32 v53, v106, v107
v_cvt_pk_bf16_f32 v54, v108, v109
v_cvt_pk_bf16_f32 v55, v110, v111
v_cvt_pk_bf16_f32 v56, v112, v113
v_cvt_pk_bf16_f32 v57, v114, v115
v_cvt_pk_bf16_f32 v58, v116, v117
v_cvt_pk_bf16_f32 v59, v118, v119
v_cvt_pk_bf16_f32 v60, v120, v121
v_cvt_pk_bf16_f32 v61, v122, v123
v_cvt_pk_bf16_f32 v62, v124, v125
v_cvt_pk_bf16_f32 v63, v126, v127
s_add_u32 s32, s34, 0x400000
s_add_u32 s33, s32, 4096
buffer_store_dwordx4 v[32:35], v251, s[4:7], s32 offen offset:0 sc1
buffer_store_dwordx4 v[36:39], v251, s[4:7], s32 offen offset:1024 sc1
buffer_store_dwordx4 v[40:43], v251, s[4:7], s32 offen offset:2048 sc1
buffer_store_dwordx4 v[44:47], v251, s[4:7], s32 offen offset:3072 sc1
buffer_store_dwordx4 v[48:51], v251, s[4:7], s33 offen offset:0 sc1
buffer_store_dwordx4 v[52:55], v251, s[4:7], s33 offen offset:1024 sc1
buffer_store_dwordx4 v[56:59], v251, s[4:7], s33 offen offset:2048 sc1
buffer_store_dwordx4 v[60:63], v251, s[4:7], s33 offen offset:3072 sc1
s_add_u32 s16, s16, 4
s_branch main_kernel_s_wa2_ok
main_kernel_s_fill:
v_cmp_gt_u32 vcc, 128, v0
v_mov_b32 v20, 0x1f80
v_mov_b32 v21, 0x380
v_cndmask_b32 v20, v20, v21, vcc
v_mov_b32 v21, 0x1fff
v_mov_b32 v22, 0x1ff
v_cndmask_b32 v21, v21, v22, vcc
v_subrev_u32 v22, 128, v0
v_lshlrev_b32 v22, 13, v22
v_lshlrev_b32 v23, 10, v0
v_cndmask_b32 v22, v22, v23, vcc
v_cmp_gt_u32 vcc, 144, v0
v_mov_b32 v23, 0x40000000
s_nop 0
v_cndmask_b32 v22, v23, v22, vcc
s_mov_b32 s8, s42
s_and_b32 s9, s43, 0xffff
s_mov_b32 s10, 0x800000
s_mov_b32 s11, 0x20000
s_lshl_b32 s35, s16, 17
v_subrev_u32 v23, s42, v21
v_and_b32 v23, v23, v20
v_add_u32 v26, v23, v22
buffer_load_dwordx2 v[14:15], v26, s[8:11], s35 offen offset:60
s_add_u32 s35, s35, 8388608
s_mov_b32 s8, s44
s_and_b32 s9, s45, 0xffff
s_mov_b32 s10, 0x800000
s_mov_b32 s11, 0x20000
s_lshl_b32 s35, s16, 17
v_subrev_u32 v23, s44, v21
v_and_b32 v23, v23, v20
v_add_u32 v28, v23, v22
buffer_load_dwordx2 v[14:15], v28, s[8:11], s35 offen offset:60
s_add_u32 s35, s35, 8388608
s_lshl_b32 s32, s16, 2
s_sub_u32 s33, s32, 48
s_lshl_b32 s34, s32, 12
s_add_u32 s34, s34, 0x6c00000
s_cmp_lt_u32 s33, 16
s_cselect_b32 s34, 0x7f000000, s34
buffer_store_dwordx4 v[8:11], v1, s[4:7], s34 offen sc1
s_sub_u32 s33, s32, 47
s_lshl_b32 s34, s32, 12
s_add_u32 s34, s34, 0x6c01000
s_cmp_lt_u32 s33, 16
s_cselect_b32 s34, 0x7f000000, s34
buffer_store_dwordx4 v[8:11], v1, s[4:7], s34 offen sc1
s_sub_u32 s33, s32, 46
s_lshl_b32 s34, s32, 12
s_add_u32 s34, s34, 0x6c02000
s_cmp_lt_u32 s33, 16
s_cselect_b32 s34, 0x7f000000, s34
buffer_store_dwordx4 v[8:11], v1, s[4:7], s34 offen sc1
s_sub_u32 s33, s32, 45
s_lshl_b32 s34, s32, 12
s_add_u32 s34, s34, 0x6c03000
s_cmp_lt_u32 s33, 16
s_cselect_b32 s34, 0x7f000000, s34
buffer_store_dwordx4 v[8:11], v1, s[4:7], s34 offen sc1
s_lshl_b32 s32, s16, 12
s_add_u32 s33, s32, 0x8c00000
s_add_u32 s34, s32, 0x6e00000
buffer_store_dwordx4 v[8:11], v1, s[4:7], s34 offen sc1
s_add_u32 s32, s32, 0x8000000
buffer_store_dwordx4 v[8:11], v1, s[4:7], s32 offen sc1
buffer_store_dwordx4 v[8:11], v1, s[4:7], s33 offen sc1
s_lshl_b32 s16, s16, 2
s_add_u32 s16, s16, 0x841f000
s_cmp_lg_u32 s16, 0x841f034
s_cbranch_scc1 main_kernel_s_fd
s_mov_b32 s8, s76
s_and_b32 s9, s77, 0xffff
s_mov_b32 s10, 0x4000
s_mov_b32 s11, 0x20000
v_and_b32 v2, 7, v0
v_lshlrev_b32 v2, 11, v2
v_lshrrev_b32 v3, 6, v0
v_lshl_add_u32 v2, v3, 7, v2
v_bfe_u32 v3, v0, 4, 2
v_lshl_add_u32 v2, v3, 5, v2
v_bfe_u32 v3, v0, 3, 1
v_lshl_add_u32 v2, v3, 4, v2
buffer_load_dwordx4 v[16:19], v2, s[8:11], 0 offen offset:0
buffer_load_dwordx4 v[20:23], v2, s[8:11], 0 offen offset:512
buffer_load_dwordx4 v[24:27], v2, s[8:11], 0 offen offset:1024
buffer_load_dwordx4 v[28:31], v2, s[8:11], 0 offen offset:1536
s_mov_b32 s32, 0x6c30000
s_waitcnt vmcnt(0)
s_cmp_lt_u32 s14, 0
s_cbranch_scc1 main_kernel_s_m0b
v_lshlrev_b32 v2, 16, v16
v_and_b32 v3, 0xffff0000, v16
v_cvt_pk_f16_f32 v16, v2, v3
v_lshlrev_b32 v2, 16, v17
v_and_b32 v3, 0xffff0000, v17
v_cvt_pk_f16_f32 v17, v2, v3
v_lshlrev_b32 v2, 16, v18
v_and_b32 v3, 0xffff0000, v18
v_cvt_pk_f16_f32 v18, v2, v3
v_lshlrev_b32 v2, 16, v19
v_and_b32 v3, 0xffff0000, v19
v_cvt_pk_f16_f32 v19, v2, v3
v_lshlrev_b32 v2, 16, v20
v_and_b32 v3, 0xffff0000, v20
v_cvt_pk_f16_f32 v20, v2, v3
v_lshlrev_b32 v2, 16, v21
v_and_b32 v3, 0xffff0000, v21
v_cvt_pk_f16_f32 v21, v2, v3
v_lshlrev_b32 v2, 16, v22
v_and_b32 v3, 0xffff0000, v22
v_cvt_pk_f16_f32 v22, v2, v3
v_lshlrev_b32 v2, 16, v23
v_and_b32 v3, 0xffff0000, v23
v_cvt_pk_f16_f32 v23, v2, v3
v_lshlrev_b32 v2, 16, v24
v_and_b32 v3, 0xffff0000, v24
v_cvt_pk_f16_f32 v24, v2, v3
v_lshlrev_b32 v2, 16, v25
v_and_b32 v3, 0xffff0000, v25
v_cvt_pk_f16_f32 v25, v2, v3
v_lshlrev_b32 v2, 16, v26
v_and_b32 v3, 0xffff0000, v26
v_cvt_pk_f16_f32 v26, v2, v3
v_lshlrev_b32 v2, 16, v27
v_and_b32 v3, 0xffff0000, v27
v_cvt_pk_f16_f32 v27, v2, v3
v_lshlrev_b32 v2, 16, v28
v_and_b32 v3, 0xffff0000, v28
v_cvt_pk_f16_f32 v28, v2, v3
v_lshlrev_b32 v2, 16, v29
v_and_b32 v3, 0xffff0000, v29
v_cvt_pk_f16_f32 v29, v2, v3
v_lshlrev_b32 v2, 16, v30
v_and_b32 v3, 0xffff0000, v30
v_cvt_pk_f16_f32 v30, v2, v3
v_lshlrev_b32 v2, 16, v31
v_and_b32 v3, 0xffff0000, v31
v_cvt_pk_f16_f32 v31, v2, v3
main_kernel_s_m0b:
v_xor_b32 v2, 0, v1
buffer_store_dwordx4 v[16:19], v1, s[4:7], s32 offen sc1
s_add_u32 s32, s32, 4096
buffer_store_dwordx4 v[20:23], v2, s[4:7], s32 offen sc1
s_add_u32 s32, s32, 4096
buffer_store_dwordx4 v[24:27], v1, s[4:7], s32 offen sc1
s_add_u32 s32, s32, 4096
buffer_store_dwordx4 v[28:31], v2, s[4:7], s32 offen sc1
s_add_u32 s32, s32, 4096
buffer_store_dwordx4 v[4:7], v1, s[4:7], s32 offen sc1
s_add_u32 s32, s32, 4096
buffer_store_dwordx4 v[4:7], v2, s[4:7], s32 offen sc1
s_add_u32 s32, s32, 4096
buffer_store_dwordx4 v[4:7], v1, s[4:7], s32 offen sc1
s_add_u32 s32, s32, 4096
buffer_store_dwordx4 v[4:7], v2, s[4:7], s32 offen sc1
s_add_u32 s32, s32, 4096
buffer_store_dwordx4 v[16:19], v1, s[4:7], s32 offen sc1
s_add_u32 s32, s32, 4096
buffer_store_dwordx4 v[20:23], v2, s[4:7], s32 offen sc1
s_add_u32 s32, s32, 4096
buffer_store_dwordx4 v[24:27], v1, s[4:7], s32 offen sc1
s_add_u32 s32, s32, 4096
buffer_store_dwordx4 v[28:31], v2, s[4:7], s32 offen sc1
s_add_u32 s32, s32, 4096
buffer_store_dwordx4 v[4:7], v1, s[4:7], s32 offen sc1
s_add_u32 s32, s32, 4096
buffer_store_dwordx4 v[4:7], v2, s[4:7], s32 offen sc1
s_add_u32 s32, s32, 4096
buffer_store_dwordx4 v[4:7], v1, s[4:7], s32 offen sc1
s_add_u32 s32, s32, 4096
buffer_store_dwordx4 v[4:7], v2, s[4:7], s32 offen sc1
s_add_u32 s32, s32, 4096
v_mov_b32 v2, 0
main_kernel_s_wa3:
buffer_load_dword v3, v2, s[60:63], 0 offen offset:12 sc1
s_waitcnt vmcnt(0)
v_cmp_gt_u32 vcc, 4, v3
s_cbranch_vccz main_kernel_s_wa3_ok
s_sleep 4
s_sub_u32 s29, s29, 1
s_cbranch_scc0 main_kernel_s_wa3
s_branch main_kernel_end
main_kernel_s_wa3_ok:
v_lshlrev_b32 v2, 7, v250
s_mov_b32 s32, 0x841a000
s_mov_b64 exec, 15
buffer_store_dwordx4 v[8:11], v2, s[4:7], s32 offen sc1
s_mov_b64 exec, -1
main_kernel_s_fd:
s_cmp_lg_u32 s14, 0
s_cbranch_scc1 main_kernel_s_wa2_ok
v_mov_b32 v2, 0
main_kernel_s_wa2:
buffer_load_dword v3, v2, s[60:63], 0 offen offset:12 sc1
s_waitcnt vmcnt(0)
v_cmp_gt_u32 vcc, 4, v3
s_cbranch_vccz main_kernel_s_wa2_ok
s_sleep 4
s_sub_u32 s29, s29, 1
s_cbranch_scc0 main_kernel_s_wa2
s_branch main_kernel_end
main_kernel_s_wa2_ok:
s_waitcnt vmcnt(0)
s_barrier
s_cmp_lg_u32 s14, 0
s_cbranch_scc1 main_kernel_s_end
s_mov_b64 exec, 1
buffer_store_dword v8, v4, s[4:7], s16 offen sc1
s_mov_b64 exec, -1
main_kernel_s_end:
s_lshl_b32 s32, s12, 5
s_add_u32 s32, s32, s13
s_sub_u32 s32, s32, 96
s_cmp_lt_u32 s32, 16
s_cbranch_scc1 main_kernel_att
s_branch main_kernel_worker
main_kernel_end:
s_endpgm
main_kernel_chain:
s_lshr_b32 s15, s13, 1
s_lshl_b32 s32, s12, 4
s_add_u32 s15, s15, s32
s_and_b32 s16, s13, 1
s_lshl_b32 s36, s14, 15
s_add_u32 s36, s36, 32768
v_lshrrev_b32 v126, 3, v94
v_and_b32 v127, 7, v94
v_lshlrev_b32 v126, 13, v126
v_lshl_add_u32 v64, v127, 4, v126
v_lshrrev_b32 v126, 2, v94
v_and_b32 v70, 3, v94
v_lshlrev_b32 v126, 11, v126
v_lshl_add_u32 v65, v70, 4, v126
v_lshrrev_b32 v126, 5, v94
v_lshlrev_b32 v69, 4, v126
v_bfe_u32 v126, v94, 4, 1
v_lshl_add_u32 v69, v126, 2, v69
v_bfe_u32 v126, v94, 2, 1
v_add_u32 v69, v69, v126
v_bfe_u32 v126, v94, 3, 1
v_lshl_add_u32 v69, v126, 3, v69
v_lshl_add_u32 v126, v69, 7, s36
v_lshl_add_u32 v67, v70, 3, v126
v_lshl_add_u32 v126, v69, 6, s36
v_lshl_add_u32 v68, v70, 3, v126
v_lshlrev_b32 v116, 4, v94
v_add_u32 v113, s36, v116
v_lshlrev_b32 v126, 7, v69
v_lshl_add_u32 v41, v70, 3, v126
v_lshl_add_u32 v41, s14, 5, v41
v_and_b32 v127, 1, v70
v_lshl_add_u32 v40, v127, 3, v126
v_lshrrev_b32 v127, 1, v70
v_lshl_add_u32 v40, v127, 5, v40
s_lshr_b32 s32, s14, 1
s_and_b32 s33, s14, 1
v_lshl_add_u32 v40, s32, 6, v40
v_lshl_add_u32 v40, s33, 4, v40
s_xor_b32 s32, s14, 0
s_lshl_b32 s32, s32, 15
s_add_u32 s32, s32, 32768
v_add_u32 v32, s32, v40
v_add_u32 v36, s32, v41
s_xor_b32 s32, s14, 1
s_lshl_b32 s32, s32, 15
s_add_u32 s32, s32, 32768
v_add_u32 v33, s32, v40
v_add_u32 v37, s32, v41
s_xor_b32 s32, s14, 2
s_lshl_b32 s32, s32, 15
s_add_u32 s32, s32, 32768
v_add_u32 v34, s32, v40
v_add_u32 v38, s32, v41
s_xor_b32 s32, s14, 3
s_lshl_b32 s32, s32, 15
s_add_u32 s32, s32, 32768
v_add_u32 v35, s32, v40
v_add_u32 v39, s32, v41
s_lshl_b32 s34, s14, 21
s_lshl_b32 s32, s15, 8
s_add_u32 s34, s34, s32
s_lshl_b32 s32, s16, 7
s_add_u32 s34, s34, s32
s_lshl_b32 s35, s12, 22
s_lshl_b32 s32, s14, 20
s_add_u32 s35, s35, s32
s_lshl_b32 s32, s13, 6
s_add_u32 s35, s35, s32
s_xor_b32 s32, s14, s13
s_and_b32 s32, s32, 3
s_lshl_b32 s32, s32, 19
s_add_u32 s34, s34, s32
s_xor_b32 s32, s14, s13
s_and_b32 s32, s32, 7
s_lshl_b32 s32, s32, 17
s_add_u32 s35, s35, s32
v_min_u32 v73, 8, v94
v_lshlrev_b32 v73, 5, v73
v_mov_b32 v126, 12
v_cmp_gt_u32 vcc, 8, v94
v_lshlrev_b32 v74, 2, v94
v_add_u32 v74, 0x841f000, v74
v_cndmask_b32 v73, v126, v73, vcc
v_and_b32 v75, 1, v94
s_lshl_b32 s32, s15, 2
s_add_u32 s32, s32, 0x8406000
v_lshl_add_u32 v75, v75, 13, s32
s_mov_b32 s8, s42
s_and_b32 s9, s43, 0xffff
s_mov_b32 s10, 0x800000
s_mov_b32 s11, 0x20000
s_xor_b32 s32, s34, 0x0
s_add_u32 m0, s36, 0
s_nop 0
buffer_load_dwordx4 v64, s[8:11], s32 offen lds
s_xor_b32 s32, s34, 0x10000
s_add_u32 m0, s36, 1024
s_nop 0
buffer_load_dwordx4 v64, s[8:11], s32 offen lds
s_xor_b32 s32, s34, 0x20000
s_add_u32 m0, s36, 2048
s_nop 0
buffer_load_dwordx4 v64, s[8:11], s32 offen lds
s_xor_b32 s32, s34, 0x30000
s_add_u32 m0, s36, 3072
s_nop 0
buffer_load_dwordx4 v64, s[8:11], s32 offen lds
s_xor_b32 s32, s34, 0x40000
s_add_u32 m0, s36, 4096
s_nop 0
buffer_load_dwordx4 v64, s[8:11], s32 offen lds
s_xor_b32 s32, s34, 0x50000
s_add_u32 m0, s36, 5120
s_nop 0
buffer_load_dwordx4 v64, s[8:11], s32 offen lds
s_xor_b32 s32, s34, 0x60000
s_add_u32 m0, s36, 6144
s_nop 0
buffer_load_dwordx4 v64, s[8:11], s32 offen lds
s_xor_b32 s32, s34, 0x70000
s_add_u32 m0, s36, 7168
s_nop 0
buffer_load_dwordx4 v64, s[8:11], s32 offen lds
s_xor_b32 s32, s34, 0x80000
s_add_u32 m0, s36, 8192
s_nop 0
buffer_load_dwordx4 v64, s[8:11], s32 offen lds
s_xor_b32 s32, s34, 0x90000
s_add_u32 m0, s36, 9216
s_nop 0
buffer_load_dwordx4 v64, s[8:11], s32 offen lds
s_xor_b32 s32, s34, 0xa0000
s_add_u32 m0, s36, 10240
s_nop 0
buffer_load_dwordx4 v64, s[8:11], s32 offen lds
s_xor_b32 s32, s34, 0xb0000
s_add_u32 m0, s36, 11264
s_nop 0
buffer_load_dwordx4 v64, s[8:11], s32 offen lds
s_xor_b32 s32, s34, 0xc0000
s_add_u32 m0, s36, 12288
s_nop 0
buffer_load_dwordx4 v64, s[8:11], s32 offen lds
s_xor_b32 s32, s34, 0xd0000
s_add_u32 m0, s36, 13312
s_nop 0
buffer_load_dwordx4 v64, s[8:11], s32 offen lds
s_xor_b32 s32, s34, 0xe0000
s_add_u32 m0, s36, 14336
s_nop 0
buffer_load_dwordx4 v64, s[8:11], s32 offen lds
s_xor_b32 s32, s34, 0xf0000
s_add_u32 m0, s36, 15360
s_nop 0
buffer_load_dwordx4 v64, s[8:11], s32 offen lds
s_xor_b32 s32, s34, 0x100000
s_add_u32 m0, s36, 16384
s_nop 0
buffer_load_dwordx4 v64, s[8:11], s32 offen lds
s_xor_b32 s32, s34, 0x110000
s_add_u32 m0, s36, 17408
s_nop 0
buffer_load_dwordx4 v64, s[8:11], s32 offen lds
s_xor_b32 s32, s34, 0x120000
s_add_u32 m0, s36, 18432
s_nop 0
buffer_load_dwordx4 v64, s[8:11], s32 offen lds
s_xor_b32 s32, s34, 0x130000
s_add_u32 m0, s36, 19456
s_nop 0
buffer_load_dwordx4 v64, s[8:11], s32 offen lds
s_xor_b32 s32, s34, 0x140000
s_add_u32 m0, s36, 20480
s_nop 0
buffer_load_dwordx4 v64, s[8:11], s32 offen lds
s_xor_b32 s32, s34, 0x150000
s_add_u32 m0, s36, 21504
s_nop 0
buffer_load_dwordx4 v64, s[8:11], s32 offen lds
s_xor_b32 s32, s34, 0x160000
s_add_u32 m0, s36, 22528
s_nop 0
buffer_load_dwordx4 v64, s[8:11], s32 offen lds
s_xor_b32 s32, s34, 0x170000
s_add_u32 m0, s36, 23552
s_nop 0
buffer_load_dwordx4 v64, s[8:11], s32 offen lds
s_xor_b32 s32, s34, 0x180000
s_add_u32 m0, s36, 24576
s_nop 0
buffer_load_dwordx4 v64, s[8:11], s32 offen lds
s_xor_b32 s32, s34, 0x190000
s_add_u32 m0, s36, 25600
s_nop 0
buffer_load_dwordx4 v64, s[8:11], s32 offen lds
s_xor_b32 s32, s34, 0x1a0000
s_add_u32 m0, s36, 26624
s_nop 0
buffer_load_dwordx4 v64, s[8:11], s32 offen lds
s_xor_b32 s32, s34, 0x1b0000
s_add_u32 m0, s36, 27648
s_nop 0
buffer_load_dwordx4 v64, s[8:11], s32 offen lds
s_xor_b32 s32, s34, 0x1c0000
s_add_u32 m0, s36, 28672
s_nop 0
buffer_load_dwordx4 v64, s[8:11], s32 offen lds
s_xor_b32 s32, s34, 0x1d0000
s_add_u32 m0, s36, 29696
s_nop 0
buffer_load_dwordx4 v64, s[8:11], s32 offen lds
s_xor_b32 s32, s34, 0x1e0000
s_add_u32 m0, s36, 30720
s_nop 0
buffer_load_dwordx4 v64, s[8:11], s32 offen lds
s_xor_b32 s32, s34, 0x1f0000
s_add_u32 m0, s36, 31744
s_nop 0
buffer_load_dwordx4 v64, s[8:11], s32 offen lds
s_waitcnt vmcnt(24)
s_barrier
ds_read_b64_tr_b16 v[0:1], v32 offset:0
ds_read_b64_tr_b16 v[2:3], v32 offset:256
ds_read_b64_tr_b16 v[4:5], v32 offset:4096
ds_read_b64_tr_b16 v[6:7], v32 offset:4352
ds_read_b64_tr_b16 v[8:9], v33 offset:0
ds_read_b64_tr_b16 v[10:11], v33 offset:256
ds_read_b64_tr_b16 v[12:13], v33 offset:4096
ds_read_b64_tr_b16 v[14:15], v33 offset:4352
ds_read_b64_tr_b16 v[16:17], v34 offset:0
ds_read_b64_tr_b16 v[18:19], v34 offset:256
ds_read_b64_tr_b16 v[20:21], v34 offset:4096
ds_read_b64_tr_b16 v[22:23], v34 offset:4352
ds_read_b64_tr_b16 v[24:25], v35 offset:0
ds_read_b64_tr_b16 v[26:27], v35 offset:256
ds_read_b64_tr_b16 v[28:29], v35 offset:4096
ds_read_b64_tr_b16 v[30:31], v35 offset:4352
s_waitcnt lgkmcnt(0)
s_barrier
s_mov_b32 s8, s44
s_and_b32 s9, s45, 0xffff
s_mov_b32 s10, 0x800000
s_mov_b32 s11, 0x20000
s_xor_b32 s32, s34, 0x0
s_add_u32 m0, s36, 0
s_nop 0
buffer_load_dwordx4 v64, s[8:11], s32 offen lds
s_xor_b32 s32, s34, 0x10000
s_add_u32 m0, s36, 1024
s_nop 0
buffer_load_dwordx4 v64, s[8:11], s32 offen lds
s_xor_b32 s32, s34, 0x20000
s_add_u32 m0, s36, 2048
s_nop 0
buffer_load_dwordx4 v64, s[8:11], s32 offen lds
s_xor_b32 s32, s34, 0x30000
s_add_u32 m0, s36, 3072
s_nop 0
buffer_load_dwordx4 v64, s[8:11], s32 offen lds
s_xor_b32 s32, s34, 0x40000
s_add_u32 m0, s36, 4096
s_nop 0
buffer_load_dwordx4 v64, s[8:11], s32 offen lds
s_xor_b32 s32, s34, 0x50000
s_add_u32 m0, s36, 5120
s_nop 0
buffer_load_dwordx4 v64, s[8:11], s32 offen lds
s_xor_b32 s32, s34, 0x60000
s_add_u32 m0, s36, 6144
s_nop 0
buffer_load_dwordx4 v64, s[8:11], s32 offen lds
s_xor_b32 s32, s34, 0x70000
s_add_u32 m0, s36, 7168
s_nop 0
buffer_load_dwordx4 v64, s[8:11], s32 offen lds
v_lshlrev_b32 v42, 16, v0
v_and_b32 v43, 0xffff0000, v0
v_cvt_pk_f16_f32 v0, v42, v43
v_lshlrev_b32 v44, 16, v1
v_and_b32 v45, 0xffff0000, v1
v_cvt_pk_f16_f32 v1, v44, v45
v_lshlrev_b32 v42, 16, v2
v_and_b32 v43, 0xffff0000, v2
v_cvt_pk_f16_f32 v2, v42, v43
v_lshlrev_b32 v44, 16, v3
v_and_b32 v45, 0xffff0000, v3
v_cvt_pk_f16_f32 v3, v44, v45
v_lshlrev_b32 v42, 16, v4
v_and_b32 v43, 0xffff0000, v4
v_cvt_pk_f16_f32 v4, v42, v43
v_lshlrev_b32 v44, 16, v5
v_and_b32 v45, 0xffff0000, v5
v_cvt_pk_f16_f32 v5, v44, v45
v_lshlrev_b32 v42, 16, v6
v_and_b32 v43, 0xffff0000, v6
v_cvt_pk_f16_f32 v6, v42, v43
v_lshlrev_b32 v44, 16, v7
v_and_b32 v45, 0xffff0000, v7
v_cvt_pk_f16_f32 v7, v44, v45
v_accvgpr_write_b32 a128, v0
v_accvgpr_write_b32 a129, v1
v_accvgpr_write_b32 a130, v2
v_accvgpr_write_b32 a131, v3
v_accvgpr_write_b32 a132, v4
v_accvgpr_write_b32 a133, v5
v_accvgpr_write_b32 a134, v6
v_accvgpr_write_b32 a135, v7
v_lshlrev_b32 v42, 16, v8
v_and_b32 v43, 0xffff0000, v8
v_cvt_pk_f16_f32 v8, v42, v43
v_lshlrev_b32 v44, 16, v9
v_and_b32 v45, 0xffff0000, v9
v_cvt_pk_f16_f32 v9, v44, v45
v_lshlrev_b32 v42, 16, v10
v_and_b32 v43, 0xffff0000, v10
v_cvt_pk_f16_f32 v10, v42, v43
v_lshlrev_b32 v44, 16, v11
v_and_b32 v45, 0xffff0000, v11
v_cvt_pk_f16_f32 v11, v44, v45
v_lshlrev_b32 v42, 16, v12
v_and_b32 v43, 0xffff0000, v12
v_cvt_pk_f16_f32 v12, v42, v43
v_lshlrev_b32 v44, 16, v13
v_and_b32 v45, 0xffff0000, v13
v_cvt_pk_f16_f32 v13, v44, v45
v_lshlrev_b32 v42, 16, v14
v_and_b32 v43, 0xffff0000, v14
v_cvt_pk_f16_f32 v14, v42, v43
v_lshlrev_b32 v44, 16, v15
v_and_b32 v45, 0xffff0000, v15
v_cvt_pk_f16_f32 v15, v44, v45
v_accvgpr_write_b32 a160, v8
v_accvgpr_write_b32 a161, v9
v_accvgpr_write_b32 a162, v10
v_accvgpr_write_b32 a163, v11
v_accvgpr_write_b32 a164, v12
v_accvgpr_write_b32 a165, v13
v_accvgpr_write_b32 a166, v14
v_accvgpr_write_b32 a167, v15
v_lshlrev_b32 v42, 16, v16
v_and_b32 v43, 0xffff0000, v16
v_cvt_pk_f16_f32 v16, v42, v43
v_lshlrev_b32 v44, 16, v17
v_and_b32 v45, 0xffff0000, v17
v_cvt_pk_f16_f32 v17, v44, v45
v_lshlrev_b32 v42, 16, v18
v_and_b32 v43, 0xffff0000, v18
v_cvt_pk_f16_f32 v18, v42, v43
v_lshlrev_b32 v44, 16, v19
v_and_b32 v45, 0xffff0000, v19
v_cvt_pk_f16_f32 v19, v44, v45
v_lshlrev_b32 v42, 16, v20
v_and_b32 v43, 0xffff0000, v20
v_cvt_pk_f16_f32 v20, v42, v43
v_lshlrev_b32 v44, 16, v21
v_and_b32 v45, 0xffff0000, v21
v_cvt_pk_f16_f32 v21, v44, v45
v_lshlrev_b32 v42, 16, v22
v_and_b32 v43, 0xffff0000, v22
v_cvt_pk_f16_f32 v22, v42, v43
v_lshlrev_b32 v44, 16, v23
v_and_b32 v45, 0xffff0000, v23
v_cvt_pk_f16_f32 v23, v44, v45
v_accvgpr_write_b32 a192, v16
v_accvgpr_write_b32 a193, v17
v_accvgpr_write_b32 a194, v18
v_accvgpr_write_b32 a195, v19
v_accvgpr_write_b32 a196, v20
v_accvgpr_write_b32 a197, v21
v_accvgpr_write_b32 a198, v22
v_accvgpr_write_b32 a199, v23
v_lshlrev_b32 v42, 16, v24
v_and_b32 v43, 0xffff0000, v24
v_cvt_pk_f16_f32 v24, v42, v43
v_lshlrev_b32 v44, 16, v25
v_and_b32 v45, 0xffff0000, v25
v_cvt_pk_f16_f32 v25, v44, v45
v_lshlrev_b32 v42, 16, v26
v_and_b32 v43, 0xffff0000, v26
v_cvt_pk_f16_f32 v26, v42, v43
v_lshlrev_b32 v44, 16, v27
v_and_b32 v45, 0xffff0000, v27
v_cvt_pk_f16_f32 v27, v44, v45
v_lshlrev_b32 v42, 16, v28
v_and_b32 v43, 0xffff0000, v28
v_cvt_pk_f16_f32 v28, v42, v43
v_lshlrev_b32 v44, 16, v29
v_and_b32 v45, 0xffff0000, v29
v_cvt_pk_f16_f32 v29, v44, v45
v_lshlrev_b32 v42, 16, v30
v_and_b32 v43, 0xffff0000, v30
v_cvt_pk_f16_f32 v30, v42, v43
v_lshlrev_b32 v44, 16, v31
v_and_b32 v45, 0xffff0000, v31
v_cvt_pk_f16_f32 v31, v44, v45
v_accvgpr_write_b32 a224, v24
v_accvgpr_write_b32 a225, v25
v_accvgpr_write_b32 a226, v26
v_accvgpr_write_b32 a227, v27
v_accvgpr_write_b32 a228, v28
v_accvgpr_write_b32 a229, v29
v_accvgpr_write_b32 a230, v30
v_accvgpr_write_b32 a231, v31
s_waitcnt vmcnt(24)
s_barrier
ds_read_b64_tr_b16 v[0:1], v32 offset:8192
ds_read_b64_tr_b16 v[2:3], v32 offset:8448
ds_read_b64_tr_b16 v[4:5], v32 offset:12288
ds_read_b64_tr_b16 v[6:7], v32 offset:12544
ds_read_b64_tr_b16 v[8:9], v33 offset:8192
ds_read_b64_tr_b16 v[10:11], v33 offset:8448
ds_read_b64_tr_b16 v[12:13], v33 offset:12288
ds_read_b64_tr_b16 v[14:15], v33 offset:12544
ds_read_b64_tr_b16 v[16:17], v34 offset:8192
ds_read_b64_tr_b16 v[18:19], v34 offset:8448
ds_read_b64_tr_b16 v[20:21], v34 offset:12288
ds_read_b64_tr_b16 v[22:23], v34 offset:12544
ds_read_b64_tr_b16 v[24:25], v35 offset:8192
ds_read_b64_tr_b16 v[26:27], v35 offset:8448
ds_read_b64_tr_b16 v[28:29], v35 offset:12288
ds_read_b64_tr_b16 v[30:31], v35 offset:12544
s_waitcnt lgkmcnt(0)
s_barrier
s_xor_b32 s32, s34, 0x80000
s_add_u32 m0, s36, 8192
s_nop 0
buffer_load_dwordx4 v64, s[8:11], s32 offen lds
s_xor_b32 s32, s34, 0x90000
s_add_u32 m0, s36, 9216
s_nop 0
buffer_load_dwordx4 v64, s[8:11], s32 offen lds
s_xor_b32 s32, s34, 0xa0000
s_add_u32 m0, s36, 10240
s_nop 0
buffer_load_dwordx4 v64, s[8:11], s32 offen lds
s_xor_b32 s32, s34, 0xb0000
s_add_u32 m0, s36, 11264
s_nop 0
buffer_load_dwordx4 v64, s[8:11], s32 offen lds
s_xor_b32 s32, s34, 0xc0000
s_add_u32 m0, s36, 12288
s_nop 0
buffer_load_dwordx4 v64, s[8:11], s32 offen lds
s_xor_b32 s32, s34, 0xd0000
s_add_u32 m0, s36, 13312
s_nop 0
buffer_load_dwordx4 v64, s[8:11], s32 offen lds
s_xor_b32 s32, s34, 0xe0000
s_add_u32 m0, s36, 14336
s_nop 0
buffer_load_dwordx4 v64, s[8:11], s32 offen lds
s_xor_b32 s32, s34, 0xf0000
s_add_u32 m0, s36, 15360
s_nop 0
buffer_load_dwordx4 v64, s[8:11], s32 offen lds
v_lshlrev_b32 v42, 16, v0
v_and_b32 v43, 0xffff0000, v0
v_cvt_pk_f16_f32 v0, v42, v43
v_lshlrev_b32 v44, 16, v1
v_and_b32 v45, 0xffff0000, v1
v_cvt_pk_f16_f32 v1, v44, v45
v_lshlrev_b32 v42, 16, v2
v_and_b32 v43, 0xffff0000, v2
v_cvt_pk_f16_f32 v2, v42, v43
v_lshlrev_b32 v44, 16, v3
v_and_b32 v45, 0xffff0000, v3
v_cvt_pk_f16_f32 v3, v44, v45
v_lshlrev_b32 v42, 16, v4
v_and_b32 v43, 0xffff0000, v4
v_cvt_pk_f16_f32 v4, v42, v43
v_lshlrev_b32 v44, 16, v5
v_and_b32 v45, 0xffff0000, v5
v_cvt_pk_f16_f32 v5, v44, v45
v_lshlrev_b32 v42, 16, v6
v_and_b32 v43, 0xffff0000, v6
v_cvt_pk_f16_f32 v6, v42, v43
v_lshlrev_b32 v44, 16, v7
v_and_b32 v45, 0xffff0000, v7
v_cvt_pk_f16_f32 v7, v44, v45
v_accvgpr_write_b32 a136, v0
v_accvgpr_write_b32 a137, v1
v_accvgpr_write_b32 a138, v2
v_accvgpr_write_b32 a139, v3
v_accvgpr_write_b32 a140, v4
v_accvgpr_write_b32 a141, v5
v_accvgpr_write_b32 a142, v6
v_accvgpr_write_b32 a143, v7
v_lshlrev_b32 v42, 16, v8
v_and_b32 v43, 0xffff0000, v8
v_cvt_pk_f16_f32 v8, v42, v43
v_lshlrev_b32 v44, 16, v9
v_and_b32 v45, 0xffff0000, v9
v_cvt_pk_f16_f32 v9, v44, v45
v_lshlrev_b32 v42, 16, v10
v_and_b32 v43, 0xffff0000, v10
v_cvt_pk_f16_f32 v10, v42, v43
v_lshlrev_b32 v44, 16, v11
v_and_b32 v45, 0xffff0000, v11
v_cvt_pk_f16_f32 v11, v44, v45
v_lshlrev_b32 v42, 16, v12
v_and_b32 v43, 0xffff0000, v12
v_cvt_pk_f16_f32 v12, v42, v43
v_lshlrev_b32 v44, 16, v13
v_and_b32 v45, 0xffff0000, v13
v_cvt_pk_f16_f32 v13, v44, v45
v_lshlrev_b32 v42, 16, v14
v_and_b32 v43, 0xffff0000, v14
v_cvt_pk_f16_f32 v14, v42, v43
v_lshlrev_b32 v44, 16, v15
v_and_b32 v45, 0xffff0000, v15
v_cvt_pk_f16_f32 v15, v44, v45
v_accvgpr_write_b32 a168, v8
v_accvgpr_write_b32 a169, v9
v_accvgpr_write_b32 a170, v10
v_accvgpr_write_b32 a171, v11
v_accvgpr_write_b32 a172, v12
v_accvgpr_write_b32 a173, v13
v_accvgpr_write_b32 a174, v14
v_accvgpr_write_b32 a175, v15
v_lshlrev_b32 v42, 16, v16
v_and_b32 v43, 0xffff0000, v16
v_cvt_pk_f16_f32 v16, v42, v43
v_lshlrev_b32 v44, 16, v17
v_and_b32 v45, 0xffff0000, v17
v_cvt_pk_f16_f32 v17, v44, v45
v_lshlrev_b32 v42, 16, v18
v_and_b32 v43, 0xffff0000, v18
v_cvt_pk_f16_f32 v18, v42, v43
v_lshlrev_b32 v44, 16, v19
v_and_b32 v45, 0xffff0000, v19
v_cvt_pk_f16_f32 v19, v44, v45
v_lshlrev_b32 v42, 16, v20
v_and_b32 v43, 0xffff0000, v20
v_cvt_pk_f16_f32 v20, v42, v43
v_lshlrev_b32 v44, 16, v21
v_and_b32 v45, 0xffff0000, v21
v_cvt_pk_f16_f32 v21, v44, v45
v_lshlrev_b32 v42, 16, v22
v_and_b32 v43, 0xffff0000, v22
v_cvt_pk_f16_f32 v22, v42, v43
v_lshlrev_b32 v44, 16, v23
v_and_b32 v45, 0xffff0000, v23
v_cvt_pk_f16_f32 v23, v44, v45
v_accvgpr_write_b32 a200, v16
v_accvgpr_write_b32 a201, v17
v_accvgpr_write_b32 a202, v18
v_accvgpr_write_b32 a203, v19
v_accvgpr_write_b32 a204, v20
v_accvgpr_write_b32 a205, v21
v_accvgpr_write_b32 a206, v22
v_accvgpr_write_b32 a207, v23
v_lshlrev_b32 v42, 16, v24
v_and_b32 v43, 0xffff0000, v24
v_cvt_pk_f16_f32 v24, v42, v43
v_lshlrev_b32 v44, 16, v25
v_and_b32 v45, 0xffff0000, v25
v_cvt_pk_f16_f32 v25, v44, v45
v_lshlrev_b32 v42, 16, v26
v_and_b32 v43, 0xffff0000, v26
v_cvt_pk_f16_f32 v26, v42, v43
v_lshlrev_b32 v44, 16, v27
v_and_b32 v45, 0xffff0000, v27
v_cvt_pk_f16_f32 v27, v44, v45
v_lshlrev_b32 v42, 16, v28
v_and_b32 v43, 0xffff0000, v28
v_cvt_pk_f16_f32 v28, v42, v43
v_lshlrev_b32 v44, 16, v29
v_and_b32 v45, 0xffff0000, v29
v_cvt_pk_f16_f32 v29, v44, v45
v_lshlrev_b32 v42, 16, v30
v_and_b32 v43, 0xffff0000, v30
v_cvt_pk_f16_f32 v30, v42, v43
v_lshlrev_b32 v44, 16, v31
v_and_b32 v45, 0xffff0000, v31
v_cvt_pk_f16_f32 v31, v44, v45
v_accvgpr_write_b32 a232, v24
v_accvgpr_write_b32 a233, v25
v_accvgpr_write_b32 a234, v26
v_accvgpr_write_b32 a235, v27
v_accvgpr_write_b32 a236, v28
v_accvgpr_write_b32 a237, v29
v_accvgpr_write_b32 a238, v30
v_accvgpr_write_b32 a239, v31
s_waitcnt vmcnt(24)
s_barrier
ds_read_b64_tr_b16 v[0:1], v32 offset:16384
ds_read_b64_tr_b16 v[2:3], v32 offset:16640
ds_read_b64_tr_b16 v[4:5], v32 offset:20480
ds_read_b64_tr_b16 v[6:7], v32 offset:20736
ds_read_b64_tr_b16 v[8:9], v33 offset:16384
ds_read_b64_tr_b16 v[10:11], v33 offset:16640
ds_read_b64_tr_b16 v[12:13], v33 offset:20480
ds_read_b64_tr_b16 v[14:15], v33 offset:20736
ds_read_b64_tr_b16 v[16:17], v34 offset:16384
ds_read_b64_tr_b16 v[18:19], v34 offset:16640
ds_read_b64_tr_b16 v[20:21], v34 offset:20480
ds_read_b64_tr_b16 v[22:23], v34 offset:20736
ds_read_b64_tr_b16 v[24:25], v35 offset:16384
ds_read_b64_tr_b16 v[26:27], v35 offset:16640
ds_read_b64_tr_b16 v[28:29], v35 offset:20480
ds_read_b64_tr_b16 v[30:31], v35 offset:20736
s_waitcnt lgkmcnt(0)
s_barrier
s_xor_b32 s32, s34, 0x100000
s_add_u32 m0, s36, 16384
s_nop 0
buffer_load_dwordx4 v64, s[8:11], s32 offen lds
s_xor_b32 s32, s34, 0x110000
s_add_u32 m0, s36, 17408
s_nop 0
buffer_load_dwordx4 v64, s[8:11], s32 offen lds
s_xor_b32 s32, s34, 0x120000
s_add_u32 m0, s36, 18432
s_nop 0
buffer_load_dwordx4 v64, s[8:11], s32 offen lds
s_xor_b32 s32, s34, 0x130000
s_add_u32 m0, s36, 19456
s_nop 0
buffer_load_dwordx4 v64, s[8:11], s32 offen lds
s_xor_b32 s32, s34, 0x140000
s_add_u32 m0, s36, 20480
s_nop 0
buffer_load_dwordx4 v64, s[8:11], s32 offen lds
s_xor_b32 s32, s34, 0x150000
s_add_u32 m0, s36, 21504
s_nop 0
buffer_load_dwordx4 v64, s[8:11], s32 offen lds
s_xor_b32 s32, s34, 0x160000
s_add_u32 m0, s36, 22528
s_nop 0
buffer_load_dwordx4 v64, s[8:11], s32 offen lds
s_xor_b32 s32, s34, 0x170000
s_add_u32 m0, s36, 23552
s_nop 0
buffer_load_dwordx4 v64, s[8:11], s32 offen lds
v_lshlrev_b32 v42, 16, v0
v_and_b32 v43, 0xffff0000, v0
v_cvt_pk_f16_f32 v0, v42, v43
v_lshlrev_b32 v44, 16, v1
v_and_b32 v45, 0xffff0000, v1
v_cvt_pk_f16_f32 v1, v44, v45
v_lshlrev_b32 v42, 16, v2
v_and_b32 v43, 0xffff0000, v2
v_cvt_pk_f16_f32 v2, v42, v43
v_lshlrev_b32 v44, 16, v3
v_and_b32 v45, 0xffff0000, v3
v_cvt_pk_f16_f32 v3, v44, v45
v_lshlrev_b32 v42, 16, v4
v_and_b32 v43, 0xffff0000, v4
v_cvt_pk_f16_f32 v4, v42, v43
v_lshlrev_b32 v44, 16, v5
v_and_b32 v45, 0xffff0000, v5
v_cvt_pk_f16_f32 v5, v44, v45
v_lshlrev_b32 v42, 16, v6
v_and_b32 v43, 0xffff0000, v6
v_cvt_pk_f16_f32 v6, v42, v43
v_lshlrev_b32 v44, 16, v7
v_and_b32 v45, 0xffff0000, v7
v_cvt_pk_f16_f32 v7, v44, v45
v_accvgpr_write_b32 a144, v0
v_accvgpr_write_b32 a145, v1
v_accvgpr_write_b32 a146, v2
v_accvgpr_write_b32 a147, v3
v_accvgpr_write_b32 a148, v4
v_accvgpr_write_b32 a149, v5
v_accvgpr_write_b32 a150, v6
v_accvgpr_write_b32 a151, v7
v_lshlrev_b32 v42, 16, v8
v_and_b32 v43, 0xffff0000, v8
v_cvt_pk_f16_f32 v8, v42, v43
v_lshlrev_b32 v44, 16, v9
v_and_b32 v45, 0xffff0000, v9
v_cvt_pk_f16_f32 v9, v44, v45
v_lshlrev_b32 v42, 16, v10
v_and_b32 v43, 0xffff0000, v10
v_cvt_pk_f16_f32 v10, v42, v43
v_lshlrev_b32 v44, 16, v11
v_and_b32 v45, 0xffff0000, v11
v_cvt_pk_f16_f32 v11, v44, v45
v_lshlrev_b32 v42, 16, v12
v_and_b32 v43, 0xffff0000, v12
v_cvt_pk_f16_f32 v12, v42, v43
v_lshlrev_b32 v44, 16, v13
v_and_b32 v45, 0xffff0000, v13
v_cvt_pk_f16_f32 v13, v44, v45
v_lshlrev_b32 v42, 16, v14
v_and_b32 v43, 0xffff0000, v14
v_cvt_pk_f16_f32 v14, v42, v43
v_lshlrev_b32 v44, 16, v15
v_and_b32 v45, 0xffff0000, v15
v_cvt_pk_f16_f32 v15, v44, v45
v_accvgpr_write_b32 a176, v8
v_accvgpr_write_b32 a177, v9
v_accvgpr_write_b32 a178, v10
v_accvgpr_write_b32 a179, v11
v_accvgpr_write_b32 a180, v12
v_accvgpr_write_b32 a181, v13
v_accvgpr_write_b32 a182, v14
v_accvgpr_write_b32 a183, v15
v_lshlrev_b32 v42, 16, v16
v_and_b32 v43, 0xffff0000, v16
v_cvt_pk_f16_f32 v16, v42, v43
v_lshlrev_b32 v44, 16, v17
v_and_b32 v45, 0xffff0000, v17
v_cvt_pk_f16_f32 v17, v44, v45
v_lshlrev_b32 v42, 16, v18
v_and_b32 v43, 0xffff0000, v18
v_cvt_pk_f16_f32 v18, v42, v43
v_lshlrev_b32 v44, 16, v19
v_and_b32 v45, 0xffff0000, v19
v_cvt_pk_f16_f32 v19, v44, v45
v_lshlrev_b32 v42, 16, v20
v_and_b32 v43, 0xffff0000, v20
v_cvt_pk_f16_f32 v20, v42, v43
v_lshlrev_b32 v44, 16, v21
v_and_b32 v45, 0xffff0000, v21
v_cvt_pk_f16_f32 v21, v44, v45
v_lshlrev_b32 v42, 16, v22
v_and_b32 v43, 0xffff0000, v22
v_cvt_pk_f16_f32 v22, v42, v43
v_lshlrev_b32 v44, 16, v23
v_and_b32 v45, 0xffff0000, v23
v_cvt_pk_f16_f32 v23, v44, v45
v_accvgpr_write_b32 a208, v16
v_accvgpr_write_b32 a209, v17
v_accvgpr_write_b32 a210, v18
v_accvgpr_write_b32 a211, v19
v_accvgpr_write_b32 a212, v20
v_accvgpr_write_b32 a213, v21
v_accvgpr_write_b32 a214, v22
v_accvgpr_write_b32 a215, v23
v_lshlrev_b32 v42, 16, v24
v_and_b32 v43, 0xffff0000, v24
v_cvt_pk_f16_f32 v24, v42, v43
v_lshlrev_b32 v44, 16, v25
v_and_b32 v45, 0xffff0000, v25
v_cvt_pk_f16_f32 v25, v44, v45
v_lshlrev_b32 v42, 16, v26
v_and_b32 v43, 0xffff0000, v26
v_cvt_pk_f16_f32 v26, v42, v43
v_lshlrev_b32 v44, 16, v27
v_and_b32 v45, 0xffff0000, v27
v_cvt_pk_f16_f32 v27, v44, v45
v_lshlrev_b32 v42, 16, v28
v_and_b32 v43, 0xffff0000, v28
v_cvt_pk_f16_f32 v28, v42, v43
v_lshlrev_b32 v44, 16, v29
v_and_b32 v45, 0xffff0000, v29
v_cvt_pk_f16_f32 v29, v44, v45
v_lshlrev_b32 v42, 16, v30
v_and_b32 v43, 0xffff0000, v30
v_cvt_pk_f16_f32 v30, v42, v43
v_lshlrev_b32 v44, 16, v31
v_and_b32 v45, 0xffff0000, v31
v_cvt_pk_f16_f32 v31, v44, v45
v_accvgpr_write_b32 a240, v24
v_accvgpr_write_b32 a241, v25
v_accvgpr_write_b32 a242, v26
v_accvgpr_write_b32 a243, v27
v_accvgpr_write_b32 a244, v28
v_accvgpr_write_b32 a245, v29
v_accvgpr_write_b32 a246, v30
v_accvgpr_write_b32 a247, v31
s_waitcnt vmcnt(24)
s_barrier
ds_read_b64_tr_b16 v[0:1], v32 offset:24576
ds_read_b64_tr_b16 v[2:3], v32 offset:24832
ds_read_b64_tr_b16 v[4:5], v32 offset:28672
ds_read_b64_tr_b16 v[6:7], v32 offset:28928
ds_read_b64_tr_b16 v[8:9], v33 offset:24576
ds_read_b64_tr_b16 v[10:11], v33 offset:24832
ds_read_b64_tr_b16 v[12:13], v33 offset:28672
ds_read_b64_tr_b16 v[14:15], v33 offset:28928
ds_read_b64_tr_b16 v[16:17], v34 offset:24576
ds_read_b64_tr_b16 v[18:19], v34 offset:24832
ds_read_b64_tr_b16 v[20:21], v34 offset:28672
ds_read_b64_tr_b16 v[22:23], v34 offset:28928
ds_read_b64_tr_b16 v[24:25], v35 offset:24576
ds_read_b64_tr_b16 v[26:27], v35 offset:24832
ds_read_b64_tr_b16 v[28:29], v35 offset:28672
ds_read_b64_tr_b16 v[30:31], v35 offset:28928
s_waitcnt lgkmcnt(0)
s_barrier
s_xor_b32 s32, s34, 0x180000
s_add_u32 m0, s36, 24576
s_nop 0
buffer_load_dwordx4 v64, s[8:11], s32 offen lds
s_xor_b32 s32, s34, 0x190000
s_add_u32 m0, s36, 25600
s_nop 0
buffer_load_dwordx4 v64, s[8:11], s32 offen lds
s_xor_b32 s32, s34, 0x1a0000
s_add_u32 m0, s36, 26624
s_nop 0
buffer_load_dwordx4 v64, s[8:11], s32 offen lds
s_xor_b32 s32, s34, 0x1b0000
s_add_u32 m0, s36, 27648
s_nop 0
buffer_load_dwordx4 v64, s[8:11], s32 offen lds
s_xor_b32 s32, s34, 0x1c0000
s_add_u32 m0, s36, 28672
s_nop 0
buffer_load_dwordx4 v64, s[8:11], s32 offen lds
s_xor_b32 s32, s34, 0x1d0000
s_add_u32 m0, s36, 29696
s_nop 0
buffer_load_dwordx4 v64, s[8:11], s32 offen lds
s_xor_b32 s32, s34, 0x1e0000
s_add_u32 m0, s36, 30720
s_nop 0
buffer_load_dwordx4 v64, s[8:11], s32 offen lds
s_xor_b32 s32, s34, 0x1f0000
s_add_u32 m0, s36, 31744
s_nop 0
buffer_load_dwordx4 v64, s[8:11], s32 offen lds
v_lshlrev_b32 v42, 16, v0
v_and_b32 v43, 0xffff0000, v0
v_cvt_pk_f16_f32 v0, v42, v43
v_lshlrev_b32 v44, 16, v1
v_and_b32 v45, 0xffff0000, v1
v_cvt_pk_f16_f32 v1, v44, v45
v_lshlrev_b32 v42, 16, v2
v_and_b32 v43, 0xffff0000, v2
v_cvt_pk_f16_f32 v2, v42, v43
v_lshlrev_b32 v44, 16, v3
v_and_b32 v45, 0xffff0000, v3
v_cvt_pk_f16_f32 v3, v44, v45
v_lshlrev_b32 v42, 16, v4
v_and_b32 v43, 0xffff0000, v4
v_cvt_pk_f16_f32 v4, v42, v43
v_lshlrev_b32 v44, 16, v5
v_and_b32 v45, 0xffff0000, v5
v_cvt_pk_f16_f32 v5, v44, v45
v_lshlrev_b32 v42, 16, v6
v_and_b32 v43, 0xffff0000, v6
v_cvt_pk_f16_f32 v6, v42, v43
v_lshlrev_b32 v44, 16, v7
v_and_b32 v45, 0xffff0000, v7
v_cvt_pk_f16_f32 v7, v44, v45
v_accvgpr_write_b32 a152, v0
v_accvgpr_write_b32 a153, v1
v_accvgpr_write_b32 a154, v2
v_accvgpr_write_b32 a155, v3
v_accvgpr_write_b32 a156, v4
v_accvgpr_write_b32 a157, v5
v_accvgpr_write_b32 a158, v6
v_accvgpr_write_b32 a159, v7
v_lshlrev_b32 v42, 16, v8
v_and_b32 v43, 0xffff0000, v8
v_cvt_pk_f16_f32 v8, v42, v43
v_lshlrev_b32 v44, 16, v9
v_and_b32 v45, 0xffff0000, v9
v_cvt_pk_f16_f32 v9, v44, v45
v_lshlrev_b32 v42, 16, v10
v_and_b32 v43, 0xffff0000, v10
v_cvt_pk_f16_f32 v10, v42, v43
v_lshlrev_b32 v44, 16, v11
v_and_b32 v45, 0xffff0000, v11
v_cvt_pk_f16_f32 v11, v44, v45
v_lshlrev_b32 v42, 16, v12
v_and_b32 v43, 0xffff0000, v12
v_cvt_pk_f16_f32 v12, v42, v43
v_lshlrev_b32 v44, 16, v13
v_and_b32 v45, 0xffff0000, v13
v_cvt_pk_f16_f32 v13, v44, v45
v_lshlrev_b32 v42, 16, v14
v_and_b32 v43, 0xffff0000, v14
v_cvt_pk_f16_f32 v14, v42, v43
v_lshlrev_b32 v44, 16, v15
v_and_b32 v45, 0xffff0000, v15
v_cvt_pk_f16_f32 v15, v44, v45
v_accvgpr_write_b32 a184, v8
v_accvgpr_write_b32 a185, v9
v_accvgpr_write_b32 a186, v10
v_accvgpr_write_b32 a187, v11
v_accvgpr_write_b32 a188, v12
v_accvgpr_write_b32 a189, v13
v_accvgpr_write_b32 a190, v14
v_accvgpr_write_b32 a191, v15
v_lshlrev_b32 v42, 16, v16
v_and_b32 v43, 0xffff0000, v16
v_cvt_pk_f16_f32 v16, v42, v43
v_lshlrev_b32 v44, 16, v17
v_and_b32 v45, 0xffff0000, v17
v_cvt_pk_f16_f32 v17, v44, v45
v_lshlrev_b32 v42, 16, v18
v_and_b32 v43, 0xffff0000, v18
v_cvt_pk_f16_f32 v18, v42, v43
v_lshlrev_b32 v44, 16, v19
v_and_b32 v45, 0xffff0000, v19
v_cvt_pk_f16_f32 v19, v44, v45
v_lshlrev_b32 v42, 16, v20
v_and_b32 v43, 0xffff0000, v20
v_cvt_pk_f16_f32 v20, v42, v43
v_lshlrev_b32 v44, 16, v21
v_and_b32 v45, 0xffff0000, v21
v_cvt_pk_f16_f32 v21, v44, v45
v_lshlrev_b32 v42, 16, v22
v_and_b32 v43, 0xffff0000, v22
v_cvt_pk_f16_f32 v22, v42, v43
v_lshlrev_b32 v44, 16, v23
v_and_b32 v45, 0xffff0000, v23
v_cvt_pk_f16_f32 v23, v44, v45
v_accvgpr_write_b32 a216, v16
v_accvgpr_write_b32 a217, v17
v_accvgpr_write_b32 a218, v18
v_accvgpr_write_b32 a219, v19
v_accvgpr_write_b32 a220, v20
v_accvgpr_write_b32 a221, v21
v_accvgpr_write_b32 a222, v22
v_accvgpr_write_b32 a223, v23
v_lshlrev_b32 v42, 16, v24
v_and_b32 v43, 0xffff0000, v24
v_cvt_pk_f16_f32 v24, v42, v43
v_lshlrev_b32 v44, 16, v25
v_and_b32 v45, 0xffff0000, v25
v_cvt_pk_f16_f32 v25, v44, v45
v_lshlrev_b32 v42, 16, v26
v_and_b32 v43, 0xffff0000, v26
v_cvt_pk_f16_f32 v26, v42, v43
v_lshlrev_b32 v44, 16, v27
v_and_b32 v45, 0xffff0000, v27
v_cvt_pk_f16_f32 v27, v44, v45
v_lshlrev_b32 v42, 16, v28
v_and_b32 v43, 0xffff0000, v28
v_cvt_pk_f16_f32 v28, v42, v43
v_lshlrev_b32 v44, 16, v29
v_and_b32 v45, 0xffff0000, v29
v_cvt_pk_f16_f32 v29, v44, v45
v_lshlrev_b32 v42, 16, v30
v_and_b32 v43, 0xffff0000, v30
v_cvt_pk_f16_f32 v30, v42, v43
v_lshlrev_b32 v44, 16, v31
v_and_b32 v45, 0xffff0000, v31
v_cvt_pk_f16_f32 v31, v44, v45
v_accvgpr_write_b32 a248, v24
v_accvgpr_write_b32 a249, v25
v_accvgpr_write_b32 a250, v26
v_accvgpr_write_b32 a251, v27
v_accvgpr_write_b32 a252, v28
v_accvgpr_write_b32 a253, v29
v_accvgpr_write_b32 a254, v30
v_accvgpr_write_b32 a255, v31
s_waitcnt vmcnt(24)
s_barrier
ds_read_b64_tr_b16 v[128:129], v36 offset:0
ds_read_b64_tr_b16 v[130:131], v36 offset:256
ds_read_b64_tr_b16 v[132:133], v36 offset:4096
ds_read_b64_tr_b16 v[134:135], v36 offset:4352
ds_read_b64_tr_b16 v[136:137], v37 offset:0
ds_read_b64_tr_b16 v[138:139], v37 offset:256
ds_read_b64_tr_b16 v[140:141], v37 offset:4096
ds_read_b64_tr_b16 v[142:143], v37 offset:4352
ds_read_b64_tr_b16 v[144:145], v38 offset:0
ds_read_b64_tr_b16 v[146:147], v38 offset:256
ds_read_b64_tr_b16 v[148:149], v38 offset:4096
ds_read_b64_tr_b16 v[150:151], v38 offset:4352
ds_read_b64_tr_b16 v[152:153], v39 offset:0
ds_read_b64_tr_b16 v[154:155], v39 offset:256
ds_read_b64_tr_b16 v[156:157], v39 offset:4096
ds_read_b64_tr_b16 v[158:159], v39 offset:4352
s_waitcnt lgkmcnt(0)
s_barrier
s_mov_b32 s8, s40
s_and_b32 s9, s41, 0xffff
s_mov_b32 s10, 0x800000
s_mov_b32 s11, 0x20000
s_xor_b32 s32, s34, 0x0
s_add_u32 m0, s36, 0
s_nop 0
buffer_load_dwordx4 v64, s[8:11], s32 offen lds
s_xor_b32 s32, s34, 0x10000
s_add_u32 m0, s36, 1024
s_nop 0
buffer_load_dwordx4 v64, s[8:11], s32 offen lds
s_xor_b32 s32, s34, 0x20000
s_add_u32 m0, s36, 2048
s_nop 0
buffer_load_dwordx4 v64, s[8:11], s32 offen lds
s_xor_b32 s32, s34, 0x30000
s_add_u32 m0, s36, 3072
s_nop 0
buffer_load_dwordx4 v64, s[8:11], s32 offen lds
s_xor_b32 s32, s34, 0x40000
s_add_u32 m0, s36, 4096
s_nop 0
buffer_load_dwordx4 v64, s[8:11], s32 offen lds
s_xor_b32 s32, s34, 0x50000
s_add_u32 m0, s36, 5120
s_nop 0
buffer_load_dwordx4 v64, s[8:11], s32 offen lds
s_xor_b32 s32, s34, 0x60000
s_add_u32 m0, s36, 6144
s_nop 0
buffer_load_dwordx4 v64, s[8:11], s32 offen lds
s_xor_b32 s32, s34, 0x70000
s_add_u32 m0, s36, 7168
s_nop 0
buffer_load_dwordx4 v64, s[8:11], s32 offen lds
v_lshlrev_b32 v42, 16, v128
v_and_b32 v43, 0xffff0000, v128
v_cvt_pk_f16_f32 v128, v42, v43
v_lshlrev_b32 v44, 16, v129
v_and_b32 v45, 0xffff0000, v129
v_cvt_pk_f16_f32 v129, v44, v45
v_lshlrev_b32 v42, 16, v130
v_and_b32 v43, 0xffff0000, v130
v_cvt_pk_f16_f32 v130, v42, v43
v_lshlrev_b32 v44, 16, v131
v_and_b32 v45, 0xffff0000, v131
v_cvt_pk_f16_f32 v131, v44, v45
v_lshlrev_b32 v42, 16, v132
v_and_b32 v43, 0xffff0000, v132
v_cvt_pk_f16_f32 v132, v42, v43
v_lshlrev_b32 v44, 16, v133
v_and_b32 v45, 0xffff0000, v133
v_cvt_pk_f16_f32 v133, v44, v45
v_lshlrev_b32 v42, 16, v134
v_and_b32 v43, 0xffff0000, v134
v_cvt_pk_f16_f32 v134, v42, v43
v_lshlrev_b32 v44, 16, v135
v_and_b32 v45, 0xffff0000, v135
v_cvt_pk_f16_f32 v135, v44, v45
v_lshlrev_b32 v42, 16, v136
v_and_b32 v43, 0xffff0000, v136
v_cvt_pk_f16_f32 v136, v42, v43
v_lshlrev_b32 v44, 16, v137
v_and_b32 v45, 0xffff0000, v137
v_cvt_pk_f16_f32 v137, v44, v45
v_lshlrev_b32 v42, 16, v138
v_and_b32 v43, 0xffff0000, v138
v_cvt_pk_f16_f32 v138, v42, v43
v_lshlrev_b32 v44, 16, v139
v_and_b32 v45, 0xffff0000, v139
v_cvt_pk_f16_f32 v139, v44, v45
v_lshlrev_b32 v42, 16, v140
v_and_b32 v43, 0xffff0000, v140
v_cvt_pk_f16_f32 v140, v42, v43
v_lshlrev_b32 v44, 16, v141
v_and_b32 v45, 0xffff0000, v141
v_cvt_pk_f16_f32 v141, v44, v45
v_lshlrev_b32 v42, 16, v142
v_and_b32 v43, 0xffff0000, v142
v_cvt_pk_f16_f32 v142, v42, v43
v_lshlrev_b32 v44, 16, v143
v_and_b32 v45, 0xffff0000, v143
v_cvt_pk_f16_f32 v143, v44, v45
v_lshlrev_b32 v42, 16, v144
v_and_b32 v43, 0xffff0000, v144
v_cvt_pk_f16_f32 v144, v42, v43
v_lshlrev_b32 v44, 16, v145
v_and_b32 v45, 0xffff0000, v145
v_cvt_pk_f16_f32 v145, v44, v45
v_lshlrev_b32 v42, 16, v146
v_and_b32 v43, 0xffff0000, v146
v_cvt_pk_f16_f32 v146, v42, v43
v_lshlrev_b32 v44, 16, v147
v_and_b32 v45, 0xffff0000, v147
v_cvt_pk_f16_f32 v147, v44, v45
v_lshlrev_b32 v42, 16, v148
v_and_b32 v43, 0xffff0000, v148
v_cvt_pk_f16_f32 v148, v42, v43
v_lshlrev_b32 v44, 16, v149
v_and_b32 v45, 0xffff0000, v149
v_cvt_pk_f16_f32 v149, v44, v45
v_lshlrev_b32 v42, 16, v150
v_and_b32 v43, 0xffff0000, v150
v_cvt_pk_f16_f32 v150, v42, v43
v_lshlrev_b32 v44, 16, v151
v_and_b32 v45, 0xffff0000, v151
v_cvt_pk_f16_f32 v151, v44, v45
v_lshlrev_b32 v42, 16, v152
v_and_b32 v43, 0xffff0000, v152
v_cvt_pk_f16_f32 v152, v42, v43
v_lshlrev_b32 v44, 16, v153
v_and_b32 v45, 0xffff0000, v153
v_cvt_pk_f16_f32 v153, v44, v45
v_lshlrev_b32 v42, 16, v154
v_and_b32 v43, 0xffff0000, v154
v_cvt_pk_f16_f32 v154, v42, v43
v_lshlrev_b32 v44, 16, v155
v_and_b32 v45, 0xffff0000, v155
v_cvt_pk_f16_f32 v155, v44, v45
v_lshlrev_b32 v42, 16, v156
v_and_b32 v43, 0xffff0000, v156
v_cvt_pk_f16_f32 v156, v42, v43
v_lshlrev_b32 v44, 16, v157
v_and_b32 v45, 0xffff0000, v157
v_cvt_pk_f16_f32 v157, v44, v45
v_lshlrev_b32 v42, 16, v158
v_and_b32 v43, 0xffff0000, v158
v_cvt_pk_f16_f32 v158, v42, v43
v_lshlrev_b32 v44, 16, v159
v_and_b32 v45, 0xffff0000, v159
v_cvt_pk_f16_f32 v159, v44, v45
s_waitcnt vmcnt(24)
s_barrier
ds_read_b64_tr_b16 v[160:161], v36 offset:8192
ds_read_b64_tr_b16 v[162:163], v36 offset:8448
ds_read_b64_tr_b16 v[164:165], v36 offset:12288
ds_read_b64_tr_b16 v[166:167], v36 offset:12544
ds_read_b64_tr_b16 v[168:169], v37 offset:8192
ds_read_b64_tr_b16 v[170:171], v37 offset:8448
ds_read_b64_tr_b16 v[172:173], v37 offset:12288
ds_read_b64_tr_b16 v[174:175], v37 offset:12544
ds_read_b64_tr_b16 v[176:177], v38 offset:8192
ds_read_b64_tr_b16 v[178:179], v38 offset:8448
ds_read_b64_tr_b16 v[180:181], v38 offset:12288
ds_read_b64_tr_b16 v[182:183], v38 offset:12544
ds_read_b64_tr_b16 v[184:185], v39 offset:8192
ds_read_b64_tr_b16 v[186:187], v39 offset:8448
ds_read_b64_tr_b16 v[188:189], v39 offset:12288
ds_read_b64_tr_b16 v[190:191], v39 offset:12544
s_waitcnt lgkmcnt(0)
s_barrier
s_xor_b32 s32, s34, 0x80000
s_add_u32 m0, s36, 8192
s_nop 0
buffer_load_dwordx4 v64, s[8:11], s32 offen lds
s_xor_b32 s32, s34, 0x90000
s_add_u32 m0, s36, 9216
s_nop 0
buffer_load_dwordx4 v64, s[8:11], s32 offen lds
s_xor_b32 s32, s34, 0xa0000
s_add_u32 m0, s36, 10240
s_nop 0
buffer_load_dwordx4 v64, s[8:11], s32 offen lds
s_xor_b32 s32, s34, 0xb0000
s_add_u32 m0, s36, 11264
s_nop 0
buffer_load_dwordx4 v64, s[8:11], s32 offen lds
s_xor_b32 s32, s34, 0xc0000
s_add_u32 m0, s36, 12288
s_nop 0
buffer_load_dwordx4 v64, s[8:11], s32 offen lds
s_xor_b32 s32, s34, 0xd0000
s_add_u32 m0, s36, 13312
s_nop 0
buffer_load_dwordx4 v64, s[8:11], s32 offen lds
s_xor_b32 s32, s34, 0xe0000
s_add_u32 m0, s36, 14336
s_nop 0
buffer_load_dwordx4 v64, s[8:11], s32 offen lds
s_xor_b32 s32, s34, 0xf0000
s_add_u32 m0, s36, 15360
s_nop 0
buffer_load_dwordx4 v64, s[8:11], s32 offen lds
v_lshlrev_b32 v42, 16, v160
v_and_b32 v43, 0xffff0000, v160
v_cvt_pk_f16_f32 v160, v42, v43
v_lshlrev_b32 v44, 16, v161
v_and_b32 v45, 0xffff0000, v161
v_cvt_pk_f16_f32 v161, v44, v45
v_lshlrev_b32 v42, 16, v162
v_and_b32 v43, 0xffff0000, v162
v_cvt_pk_f16_f32 v162, v42, v43
v_lshlrev_b32 v44, 16, v163
v_and_b32 v45, 0xffff0000, v163
v_cvt_pk_f16_f32 v163, v44, v45
v_lshlrev_b32 v42, 16, v164
v_and_b32 v43, 0xffff0000, v164
v_cvt_pk_f16_f32 v164, v42, v43
v_lshlrev_b32 v44, 16, v165
v_and_b32 v45, 0xffff0000, v165
v_cvt_pk_f16_f32 v165, v44, v45
v_lshlrev_b32 v42, 16, v166
v_and_b32 v43, 0xffff0000, v166
v_cvt_pk_f16_f32 v166, v42, v43
v_lshlrev_b32 v44, 16, v167
v_and_b32 v45, 0xffff0000, v167
v_cvt_pk_f16_f32 v167, v44, v45
v_lshlrev_b32 v42, 16, v168
v_and_b32 v43, 0xffff0000, v168
v_cvt_pk_f16_f32 v168, v42, v43
v_lshlrev_b32 v44, 16, v169
v_and_b32 v45, 0xffff0000, v169
v_cvt_pk_f16_f32 v169, v44, v45
v_lshlrev_b32 v42, 16, v170
v_and_b32 v43, 0xffff0000, v170
v_cvt_pk_f16_f32 v170, v42, v43
v_lshlrev_b32 v44, 16, v171
v_and_b32 v45, 0xffff0000, v171
v_cvt_pk_f16_f32 v171, v44, v45
v_lshlrev_b32 v42, 16, v172
v_and_b32 v43, 0xffff0000, v172
v_cvt_pk_f16_f32 v172, v42, v43
v_lshlrev_b32 v44, 16, v173
v_and_b32 v45, 0xffff0000, v173
v_cvt_pk_f16_f32 v173, v44, v45
v_lshlrev_b32 v42, 16, v174
v_and_b32 v43, 0xffff0000, v174
v_cvt_pk_f16_f32 v174, v42, v43
v_lshlrev_b32 v44, 16, v175
v_and_b32 v45, 0xffff0000, v175
v_cvt_pk_f16_f32 v175, v44, v45
v_lshlrev_b32 v42, 16, v176
v_and_b32 v43, 0xffff0000, v176
v_cvt_pk_f16_f32 v176, v42, v43
v_lshlrev_b32 v44, 16, v177
v_and_b32 v45, 0xffff0000, v177
v_cvt_pk_f16_f32 v177, v44, v45
v_lshlrev_b32 v42, 16, v178
v_and_b32 v43, 0xffff0000, v178
v_cvt_pk_f16_f32 v178, v42, v43
v_lshlrev_b32 v44, 16, v179
v_and_b32 v45, 0xffff0000, v179
v_cvt_pk_f16_f32 v179, v44, v45
v_lshlrev_b32 v42, 16, v180
v_and_b32 v43, 0xffff0000, v180
v_cvt_pk_f16_f32 v180, v42, v43
v_lshlrev_b32 v44, 16, v181
v_and_b32 v45, 0xffff0000, v181
v_cvt_pk_f16_f32 v181, v44, v45
v_lshlrev_b32 v42, 16, v182
v_and_b32 v43, 0xffff0000, v182
v_cvt_pk_f16_f32 v182, v42, v43
v_lshlrev_b32 v44, 16, v183
v_and_b32 v45, 0xffff0000, v183
v_cvt_pk_f16_f32 v183, v44, v45
v_lshlrev_b32 v42, 16, v184
v_and_b32 v43, 0xffff0000, v184
v_cvt_pk_f16_f32 v184, v42, v43
v_lshlrev_b32 v44, 16, v185
v_and_b32 v45, 0xffff0000, v185
v_cvt_pk_f16_f32 v185, v44, v45
v_lshlrev_b32 v42, 16, v186
v_and_b32 v43, 0xffff0000, v186
v_cvt_pk_f16_f32 v186, v42, v43
v_lshlrev_b32 v44, 16, v187
v_and_b32 v45, 0xffff0000, v187
v_cvt_pk_f16_f32 v187, v44, v45
v_lshlrev_b32 v42, 16, v188
v_and_b32 v43, 0xffff0000, v188
v_cvt_pk_f16_f32 v188, v42, v43
v_lshlrev_b32 v44, 16, v189
v_and_b32 v45, 0xffff0000, v189
v_cvt_pk_f16_f32 v189, v44, v45
v_lshlrev_b32 v42, 16, v190
v_and_b32 v43, 0xffff0000, v190
v_cvt_pk_f16_f32 v190, v42, v43
v_lshlrev_b32 v44, 16, v191
v_and_b32 v45, 0xffff0000, v191
v_cvt_pk_f16_f32 v191, v44, v45
s_waitcnt vmcnt(24)
s_barrier
ds_read_b64_tr_b16 v[192:193], v36 offset:16384
ds_read_b64_tr_b16 v[194:195], v36 offset:16640
ds_read_b64_tr_b16 v[196:197], v36 offset:20480
ds_read_b64_tr_b16 v[198:199], v36 offset:20736
ds_read_b64_tr_b16 v[200:201], v37 offset:16384
ds_read_b64_tr_b16 v[202:203], v37 offset:16640
ds_read_b64_tr_b16 v[204:205], v37 offset:20480
ds_read_b64_tr_b16 v[206:207], v37 offset:20736
ds_read_b64_tr_b16 v[208:209], v38 offset:16384
ds_read_b64_tr_b16 v[210:211], v38 offset:16640
ds_read_b64_tr_b16 v[212:213], v38 offset:20480
ds_read_b64_tr_b16 v[214:215], v38 offset:20736
ds_read_b64_tr_b16 v[216:217], v39 offset:16384
ds_read_b64_tr_b16 v[218:219], v39 offset:16640
ds_read_b64_tr_b16 v[220:221], v39 offset:20480
ds_read_b64_tr_b16 v[222:223], v39 offset:20736
s_waitcnt lgkmcnt(0)
s_barrier
buffer_load_dword v72, v73, s[60:63], 0 offen sc1
buffer_load_dwordx2 v[84:85], off, s[60:63], 0 offset:16 sc1
s_xor_b32 s32, s34, 0x100000
s_add_u32 m0, s36, 16384
s_nop 0
buffer_load_dwordx4 v64, s[8:11], s32 offen lds
s_xor_b32 s32, s34, 0x110000
s_add_u32 m0, s36, 17408
s_nop 0
buffer_load_dwordx4 v64, s[8:11], s32 offen lds
s_xor_b32 s32, s34, 0x120000
s_add_u32 m0, s36, 18432
s_nop 0
buffer_load_dwordx4 v64, s[8:11], s32 offen lds
s_xor_b32 s32, s34, 0x130000
s_add_u32 m0, s36, 19456
s_nop 0
buffer_load_dwordx4 v64, s[8:11], s32 offen lds
s_xor_b32 s32, s34, 0x140000
s_add_u32 m0, s36, 20480
s_nop 0
buffer_load_dwordx4 v64, s[8:11], s32 offen lds
s_xor_b32 s32, s34, 0x150000
s_add_u32 m0, s36, 21504
s_nop 0
buffer_load_dwordx4 v64, s[8:11], s32 offen lds
s_xor_b32 s32, s34, 0x160000
s_add_u32 m0, s36, 22528
s_nop 0
buffer_load_dwordx4 v64, s[8:11], s32 offen lds
s_xor_b32 s32, s34, 0x170000
s_add_u32 m0, s36, 23552
s_nop 0
buffer_load_dwordx4 v64, s[8:11], s32 offen lds
v_lshlrev_b32 v42, 16, v192
v_and_b32 v43, 0xffff0000, v192
v_cvt_pk_f16_f32 v192, v42, v43
v_lshlrev_b32 v44, 16, v193
v_and_b32 v45, 0xffff0000, v193
v_cvt_pk_f16_f32 v193, v44, v45
v_lshlrev_b32 v42, 16, v194
v_and_b32 v43, 0xffff0000, v194
v_cvt_pk_f16_f32 v194, v42, v43
v_lshlrev_b32 v44, 16, v195
v_and_b32 v45, 0xffff0000, v195
v_cvt_pk_f16_f32 v195, v44, v45
v_lshlrev_b32 v42, 16, v196
v_and_b32 v43, 0xffff0000, v196
v_cvt_pk_f16_f32 v196, v42, v43
v_lshlrev_b32 v44, 16, v197
v_and_b32 v45, 0xffff0000, v197
v_cvt_pk_f16_f32 v197, v44, v45
v_lshlrev_b32 v42, 16, v198
v_and_b32 v43, 0xffff0000, v198
v_cvt_pk_f16_f32 v198, v42, v43
v_lshlrev_b32 v44, 16, v199
v_and_b32 v45, 0xffff0000, v199
v_cvt_pk_f16_f32 v199, v44, v45
v_lshlrev_b32 v42, 16, v200
v_and_b32 v43, 0xffff0000, v200
v_cvt_pk_f16_f32 v200, v42, v43
v_lshlrev_b32 v44, 16, v201
v_and_b32 v45, 0xffff0000, v201
v_cvt_pk_f16_f32 v201, v44, v45
v_lshlrev_b32 v42, 16, v202
v_and_b32 v43, 0xffff0000, v202
v_cvt_pk_f16_f32 v202, v42, v43
v_lshlrev_b32 v44, 16, v203
v_and_b32 v45, 0xffff0000, v203
v_cvt_pk_f16_f32 v203, v44, v45
v_lshlrev_b32 v42, 16, v204
v_and_b32 v43, 0xffff0000, v204
v_cvt_pk_f16_f32 v204, v42, v43
v_lshlrev_b32 v44, 16, v205
v_and_b32 v45, 0xffff0000, v205
v_cvt_pk_f16_f32 v205, v44, v45
v_lshlrev_b32 v42, 16, v206
v_and_b32 v43, 0xffff0000, v206
v_cvt_pk_f16_f32 v206, v42, v43
v_lshlrev_b32 v44, 16, v207
v_and_b32 v45, 0xffff0000, v207
v_cvt_pk_f16_f32 v207, v44, v45
v_lshlrev_b32 v42, 16, v208
v_and_b32 v43, 0xffff0000, v208
v_cvt_pk_f16_f32 v208, v42, v43
v_lshlrev_b32 v44, 16, v209
v_and_b32 v45, 0xffff0000, v209
v_cvt_pk_f16_f32 v209, v44, v45
v_lshlrev_b32 v42, 16, v210
v_and_b32 v43, 0xffff0000, v210
v_cvt_pk_f16_f32 v210, v42, v43
v_lshlrev_b32 v44, 16, v211
v_and_b32 v45, 0xffff0000, v211
v_cvt_pk_f16_f32 v211, v44, v45
v_lshlrev_b32 v42, 16, v212
v_and_b32 v43, 0xffff0000, v212
v_cvt_pk_f16_f32 v212, v42, v43
v_lshlrev_b32 v44, 16, v213
v_and_b32 v45, 0xffff0000, v213
v_cvt_pk_f16_f32 v213, v44, v45
v_lshlrev_b32 v42, 16, v214
v_and_b32 v43, 0xffff0000, v214
v_cvt_pk_f16_f32 v214, v42, v43
v_lshlrev_b32 v44, 16, v215
v_and_b32 v45, 0xffff0000, v215
v_cvt_pk_f16_f32 v215, v44, v45
v_lshlrev_b32 v42, 16, v216
v_and_b32 v43, 0xffff0000, v216
v_cvt_pk_f16_f32 v216, v42, v43
v_lshlrev_b32 v44, 16, v217
v_and_b32 v45, 0xffff0000, v217
v_cvt_pk_f16_f32 v217, v44, v45
v_lshlrev_b32 v42, 16, v218
v_and_b32 v43, 0xffff0000, v218
v_cvt_pk_f16_f32 v218, v42, v43
v_lshlrev_b32 v44, 16, v219
v_and_b32 v45, 0xffff0000, v219
v_cvt_pk_f16_f32 v219, v44, v45
v_lshlrev_b32 v42, 16, v220
v_and_b32 v43, 0xffff0000, v220
v_cvt_pk_f16_f32 v220, v42, v43
v_lshlrev_b32 v44, 16, v221
v_and_b32 v45, 0xffff0000, v221
v_cvt_pk_f16_f32 v221, v44, v45
v_lshlrev_b32 v42, 16, v222
v_and_b32 v43, 0xffff0000, v222
v_cvt_pk_f16_f32 v222, v42, v43
v_lshlrev_b32 v44, 16, v223
v_and_b32 v45, 0xffff0000, v223
v_cvt_pk_f16_f32 v223, v44, v45
s_waitcnt vmcnt(26)
s_barrier
ds_read_b64_tr_b16 v[224:225], v36 offset:24576
ds_read_b64_tr_b16 v[226:227], v36 offset:24832
ds_read_b64_tr_b16 v[228:229], v36 offset:28672
ds_read_b64_tr_b16 v[230:231], v36 offset:28928
ds_read_b64_tr_b16 v[232:233], v37 offset:24576
ds_read_b64_tr_b16 v[234:235], v37 offset:24832
ds_read_b64_tr_b16 v[236:237], v37 offset:28672
ds_read_b64_tr_b16 v[238:239], v37 offset:28928
ds_read_b64_tr_b16 v[240:241], v38 offset:24576
ds_read_b64_tr_b16 v[242:243], v38 offset:24832
ds_read_b64_tr_b16 v[244:245], v38 offset:28672
ds_read_b64_tr_b16 v[246:247], v38 offset:28928
ds_read_b64_tr_b16 v[248:249], v39 offset:24576
ds_read_b64_tr_b16 v[250:251], v39 offset:24832
ds_read_b64_tr_b16 v[252:253], v39 offset:28672
ds_read_b64_tr_b16 v[254:255], v39 offset:28928
s_waitcnt lgkmcnt(0)
s_barrier
s_xor_b32 s32, s34, 0x180000
s_add_u32 m0, s36, 24576
s_nop 0
buffer_load_dwordx4 v64, s[8:11], s32 offen lds
s_xor_b32 s32, s34, 0x190000
s_add_u32 m0, s36, 25600
s_nop 0
buffer_load_dwordx4 v64, s[8:11], s32 offen lds
s_xor_b32 s32, s34, 0x1a0000
s_add_u32 m0, s36, 26624
s_nop 0
buffer_load_dwordx4 v64, s[8:11], s32 offen lds
s_xor_b32 s32, s34, 0x1b0000
s_add_u32 m0, s36, 27648
s_nop 0
buffer_load_dwordx4 v64, s[8:11], s32 offen lds
s_xor_b32 s32, s34, 0x1c0000
s_add_u32 m0, s36, 28672
s_nop 0
buffer_load_dwordx4 v64, s[8:11], s32 offen lds
s_xor_b32 s32, s34, 0x1d0000
s_add_u32 m0, s36, 29696
s_nop 0
buffer_load_dwordx4 v64, s[8:11], s32 offen lds
s_xor_b32 s32, s34, 0x1e0000
s_add_u32 m0, s36, 30720
s_nop 0
buffer_load_dwordx4 v64, s[8:11], s32 offen lds
s_xor_b32 s32, s34, 0x1f0000
s_add_u32 m0, s36, 31744
s_nop 0
buffer_load_dwordx4 v64, s[8:11], s32 offen lds
v_lshlrev_b32 v42, 16, v224
v_and_b32 v43, 0xffff0000, v224
v_cvt_pk_f16_f32 v224, v42, v43
v_lshlrev_b32 v44, 16, v225
v_and_b32 v45, 0xffff0000, v225
v_cvt_pk_f16_f32 v225, v44, v45
v_lshlrev_b32 v42, 16, v226
v_and_b32 v43, 0xffff0000, v226
v_cvt_pk_f16_f32 v226, v42, v43
v_lshlrev_b32 v44, 16, v227
v_and_b32 v45, 0xffff0000, v227
v_cvt_pk_f16_f32 v227, v44, v45
v_lshlrev_b32 v42, 16, v228
v_and_b32 v43, 0xffff0000, v228
v_cvt_pk_f16_f32 v228, v42, v43
v_lshlrev_b32 v44, 16, v229
v_and_b32 v45, 0xffff0000, v229
v_cvt_pk_f16_f32 v229, v44, v45
v_lshlrev_b32 v42, 16, v230
v_and_b32 v43, 0xffff0000, v230
v_cvt_pk_f16_f32 v230, v42, v43
v_lshlrev_b32 v44, 16, v231
v_and_b32 v45, 0xffff0000, v231
v_cvt_pk_f16_f32 v231, v44, v45
v_lshlrev_b32 v42, 16, v232
v_and_b32 v43, 0xffff0000, v232
v_cvt_pk_f16_f32 v232, v42, v43
v_lshlrev_b32 v44, 16, v233
v_and_b32 v45, 0xffff0000, v233
v_cvt_pk_f16_f32 v233, v44, v45
v_lshlrev_b32 v42, 16, v234
v_and_b32 v43, 0xffff0000, v234
v_cvt_pk_f16_f32 v234, v42, v43
v_lshlrev_b32 v44, 16, v235
v_and_b32 v45, 0xffff0000, v235
v_cvt_pk_f16_f32 v235, v44, v45
v_lshlrev_b32 v42, 16, v236
v_and_b32 v43, 0xffff0000, v236
v_cvt_pk_f16_f32 v236, v42, v43
v_lshlrev_b32 v44, 16, v237
v_and_b32 v45, 0xffff0000, v237
v_cvt_pk_f16_f32 v237, v44, v45
v_lshlrev_b32 v42, 16, v238
v_and_b32 v43, 0xffff0000, v238
v_cvt_pk_f16_f32 v238, v42, v43
v_lshlrev_b32 v44, 16, v239
v_and_b32 v45, 0xffff0000, v239
v_cvt_pk_f16_f32 v239, v44, v45
v_lshlrev_b32 v42, 16, v240
v_and_b32 v43, 0xffff0000, v240
v_cvt_pk_f16_f32 v240, v42, v43
v_lshlrev_b32 v44, 16, v241
v_and_b32 v45, 0xffff0000, v241
v_cvt_pk_f16_f32 v241, v44, v45
v_lshlrev_b32 v42, 16, v242
v_and_b32 v43, 0xffff0000, v242
v_cvt_pk_f16_f32 v242, v42, v43
v_lshlrev_b32 v44, 16, v243
v_and_b32 v45, 0xffff0000, v243
v_cvt_pk_f16_f32 v243, v44, v45
v_lshlrev_b32 v42, 16, v244
v_and_b32 v43, 0xffff0000, v244
v_cvt_pk_f16_f32 v244, v42, v43
v_lshlrev_b32 v44, 16, v245
v_and_b32 v45, 0xffff0000, v245
v_cvt_pk_f16_f32 v245, v44, v45
v_lshlrev_b32 v42, 16, v246
v_and_b32 v43, 0xffff0000, v246
v_cvt_pk_f16_f32 v246, v42, v43
v_lshlrev_b32 v44, 16, v247
v_and_b32 v45, 0xffff0000, v247
v_cvt_pk_f16_f32 v247, v44, v45
v_lshlrev_b32 v42, 16, v248
v_and_b32 v43, 0xffff0000, v248
v_cvt_pk_f16_f32 v248, v42, v43
v_lshlrev_b32 v44, 16, v249
v_and_b32 v45, 0xffff0000, v249
v_cvt_pk_f16_f32 v249, v44, v45
v_lshlrev_b32 v42, 16, v250
v_and_b32 v43, 0xffff0000, v250
v_cvt_pk_f16_f32 v250, v42, v43
v_lshlrev_b32 v44, 16, v251
v_and_b32 v45, 0xffff0000, v251
v_cvt_pk_f16_f32 v251, v44, v45
v_lshlrev_b32 v42, 16, v252
v_and_b32 v43, 0xffff0000, v252
v_cvt_pk_f16_f32 v252, v42, v43
v_lshlrev_b32 v44, 16, v253
v_and_b32 v45, 0xffff0000, v253
v_cvt_pk_f16_f32 v253, v44, v45
v_lshlrev_b32 v42, 16, v254
v_and_b32 v43, 0xffff0000, v254
v_cvt_pk_f16_f32 v254, v42, v43
v_lshlrev_b32 v44, 16, v255
v_and_b32 v45, 0xffff0000, v255
v_cvt_pk_f16_f32 v255, v44, v45
s_waitcnt vmcnt(26)
s_barrier
ds_read_b64_tr_b16 v[0:1], v32 offset:0
ds_read_b64_tr_b16 v[2:3], v32 offset:256
ds_read_b64_tr_b16 v[4:5], v32 offset:4096
ds_read_b64_tr_b16 v[6:7], v32 offset:4352
ds_read_b64_tr_b16 v[8:9], v33 offset:0
ds_read_b64_tr_b16 v[10:11], v33 offset:256
ds_read_b64_tr_b16 v[12:13], v33 offset:4096
ds_read_b64_tr_b16 v[14:15], v33 offset:4352
ds_read_b64_tr_b16 v[16:17], v34 offset:0
ds_read_b64_tr_b16 v[18:19], v34 offset:256
ds_read_b64_tr_b16 v[20:21], v34 offset:4096
ds_read_b64_tr_b16 v[22:23], v34 offset:4352
ds_read_b64_tr_b16 v[24:25], v35 offset:0
ds_read_b64_tr_b16 v[26:27], v35 offset:256
ds_read_b64_tr_b16 v[28:29], v35 offset:4096
ds_read_b64_tr_b16 v[30:31], v35 offset:4352
s_waitcnt lgkmcnt(0)
s_barrier
s_mov_b32 s8, s46
s_and_b32 s9, s47, 0xffff
s_mov_b32 s10, 0x800000
s_mov_b32 s11, 0x20000
s_xor_b32 s32, s35, 0x0
s_add_u32 m0, s36, 0
s_nop 0
buffer_load_dwordx4 v65, s[8:11], s32 offen lds
s_xor_b32 s32, s35, 0x8000
s_add_u32 m0, s36, 1024
s_nop 0
buffer_load_dwordx4 v65, s[8:11], s32 offen lds
s_xor_b32 s32, s35, 0x10000
s_add_u32 m0, s36, 2048
s_nop 0
buffer_load_dwordx4 v65, s[8:11], s32 offen lds
s_xor_b32 s32, s35, 0x18000
s_add_u32 m0, s36, 3072
s_nop 0
buffer_load_dwordx4 v65, s[8:11], s32 offen lds
s_xor_b32 s32, s35, 0x20000
s_add_u32 m0, s36, 4096
s_nop 0
buffer_load_dwordx4 v65, s[8:11], s32 offen lds
s_xor_b32 s32, s35, 0x28000
s_add_u32 m0, s36, 5120
s_nop 0
buffer_load_dwordx4 v65, s[8:11], s32 offen lds
s_xor_b32 s32, s35, 0x30000
s_add_u32 m0, s36, 6144
s_nop 0
buffer_load_dwordx4 v65, s[8:11], s32 offen lds
s_xor_b32 s32, s35, 0x38000
s_add_u32 m0, s36, 7168
s_nop 0
buffer_load_dwordx4 v65, s[8:11], s32 offen lds
v_lshlrev_b32 v42, 16, v0
v_and_b32 v43, 0xffff0000, v0
v_cvt_pk_f16_f32 v0, v42, v43
v_lshlrev_b32 v44, 16, v1
v_and_b32 v45, 0xffff0000, v1
v_cvt_pk_f16_f32 v1, v44, v45
v_lshlrev_b32 v42, 16, v2
v_and_b32 v43, 0xffff0000, v2
v_cvt_pk_f16_f32 v2, v42, v43
v_lshlrev_b32 v44, 16, v3
v_and_b32 v45, 0xffff0000, v3
v_cvt_pk_f16_f32 v3, v44, v45
v_lshlrev_b32 v42, 16, v4
v_and_b32 v43, 0xffff0000, v4
v_cvt_pk_f16_f32 v4, v42, v43
v_lshlrev_b32 v44, 16, v5
v_and_b32 v45, 0xffff0000, v5
v_cvt_pk_f16_f32 v5, v44, v45
v_lshlrev_b32 v42, 16, v6
v_and_b32 v43, 0xffff0000, v6
v_cvt_pk_f16_f32 v6, v42, v43
v_lshlrev_b32 v44, 16, v7
v_and_b32 v45, 0xffff0000, v7
v_cvt_pk_f16_f32 v7, v44, v45
v_accvgpr_write_b32 a0, v0
v_accvgpr_write_b32 a1, v1
v_accvgpr_write_b32 a2, v2
v_accvgpr_write_b32 a3, v3
v_accvgpr_write_b32 a4, v4
v_accvgpr_write_b32 a5, v5
v_accvgpr_write_b32 a6, v6
v_accvgpr_write_b32 a7, v7
v_lshlrev_b32 v42, 16, v8
v_and_b32 v43, 0xffff0000, v8
v_cvt_pk_f16_f32 v8, v42, v43
v_lshlrev_b32 v44, 16, v9
v_and_b32 v45, 0xffff0000, v9
v_cvt_pk_f16_f32 v9, v44, v45
v_lshlrev_b32 v42, 16, v10
v_and_b32 v43, 0xffff0000, v10
v_cvt_pk_f16_f32 v10, v42, v43
v_lshlrev_b32 v44, 16, v11
v_and_b32 v45, 0xffff0000, v11
v_cvt_pk_f16_f32 v11, v44, v45
v_lshlrev_b32 v42, 16, v12
v_and_b32 v43, 0xffff0000, v12
v_cvt_pk_f16_f32 v12, v42, v43
v_lshlrev_b32 v44, 16, v13
v_and_b32 v45, 0xffff0000, v13
v_cvt_pk_f16_f32 v13, v44, v45
v_lshlrev_b32 v42, 16, v14
v_and_b32 v43, 0xffff0000, v14
v_cvt_pk_f16_f32 v14, v42, v43
v_lshlrev_b32 v44, 16, v15
v_and_b32 v45, 0xffff0000, v15
v_cvt_pk_f16_f32 v15, v44, v45
v_accvgpr_write_b32 a32, v8
v_accvgpr_write_b32 a33, v9
v_accvgpr_write_b32 a34, v10
v_accvgpr_write_b32 a35, v11
v_accvgpr_write_b32 a36, v12
v_accvgpr_write_b32 a37, v13
v_accvgpr_write_b32 a38, v14
v_accvgpr_write_b32 a39, v15
v_lshlrev_b32 v42, 16, v16
v_and_b32 v43, 0xffff0000, v16
v_cvt_pk_f16_f32 v16, v42, v43
v_lshlrev_b32 v44, 16, v17
v_and_b32 v45, 0xffff0000, v17
v_cvt_pk_f16_f32 v17, v44, v45
v_lshlrev_b32 v42, 16, v18
v_and_b32 v43, 0xffff0000, v18
v_cvt_pk_f16_f32 v18, v42, v43
v_lshlrev_b32 v44, 16, v19
v_and_b32 v45, 0xffff0000, v19
v_cvt_pk_f16_f32 v19, v44, v45
v_lshlrev_b32 v42, 16, v20
v_and_b32 v43, 0xffff0000, v20
v_cvt_pk_f16_f32 v20, v42, v43
v_lshlrev_b32 v44, 16, v21
v_and_b32 v45, 0xffff0000, v21
v_cvt_pk_f16_f32 v21, v44, v45
v_lshlrev_b32 v42, 16, v22
v_and_b32 v43, 0xffff0000, v22
v_cvt_pk_f16_f32 v22, v42, v43
v_lshlrev_b32 v44, 16, v23
v_and_b32 v45, 0xffff0000, v23
v_cvt_pk_f16_f32 v23, v44, v45
v_accvgpr_write_b32 a64, v16
v_accvgpr_write_b32 a65, v17
v_accvgpr_write_b32 a66, v18
v_accvgpr_write_b32 a67, v19
v_accvgpr_write_b32 a68, v20
v_accvgpr_write_b32 a69, v21
v_accvgpr_write_b32 a70, v22
v_accvgpr_write_b32 a71, v23
v_lshlrev_b32 v42, 16, v24
v_and_b32 v43, 0xffff0000, v24
v_cvt_pk_f16_f32 v24, v42, v43
v_lshlrev_b32 v44, 16, v25
v_and_b32 v45, 0xffff0000, v25
v_cvt_pk_f16_f32 v25, v44, v45
v_lshlrev_b32 v42, 16, v26
v_and_b32 v43, 0xffff0000, v26
v_cvt_pk_f16_f32 v26, v42, v43
v_lshlrev_b32 v44, 16, v27
v_and_b32 v45, 0xffff0000, v27
v_cvt_pk_f16_f32 v27, v44, v45
v_lshlrev_b32 v42, 16, v28
v_and_b32 v43, 0xffff0000, v28
v_cvt_pk_f16_f32 v28, v42, v43
v_lshlrev_b32 v44, 16, v29
v_and_b32 v45, 0xffff0000, v29
v_cvt_pk_f16_f32 v29, v44, v45
v_lshlrev_b32 v42, 16, v30
v_and_b32 v43, 0xffff0000, v30
v_cvt_pk_f16_f32 v30, v42, v43
v_lshlrev_b32 v44, 16, v31
v_and_b32 v45, 0xffff0000, v31
v_cvt_pk_f16_f32 v31, v44, v45
v_accvgpr_write_b32 a96, v24
v_accvgpr_write_b32 a97, v25
v_accvgpr_write_b32 a98, v26
v_accvgpr_write_b32 a99, v27
v_accvgpr_write_b32 a100, v28
v_accvgpr_write_b32 a101, v29
v_accvgpr_write_b32 a102, v30
v_accvgpr_write_b32 a103, v31
s_waitcnt vmcnt(26)
s_barrier
ds_read_b64_tr_b16 v[0:1], v32 offset:8192
ds_read_b64_tr_b16 v[2:3], v32 offset:8448
ds_read_b64_tr_b16 v[4:5], v32 offset:12288
ds_read_b64_tr_b16 v[6:7], v32 offset:12544
ds_read_b64_tr_b16 v[8:9], v33 offset:8192
ds_read_b64_tr_b16 v[10:11], v33 offset:8448
ds_read_b64_tr_b16 v[12:13], v33 offset:12288
ds_read_b64_tr_b16 v[14:15], v33 offset:12544
ds_read_b64_tr_b16 v[16:17], v34 offset:8192
ds_read_b64_tr_b16 v[18:19], v34 offset:8448
ds_read_b64_tr_b16 v[20:21], v34 offset:12288
ds_read_b64_tr_b16 v[22:23], v34 offset:12544
ds_read_b64_tr_b16 v[24:25], v35 offset:8192
ds_read_b64_tr_b16 v[26:27], v35 offset:8448
ds_read_b64_tr_b16 v[28:29], v35 offset:12288
ds_read_b64_tr_b16 v[30:31], v35 offset:12544
s_waitcnt lgkmcnt(0)
s_barrier
s_xor_b32 s32, s35, 0x40000
s_add_u32 m0, s36, 8192
s_nop 0
buffer_load_dwordx4 v65, s[8:11], s32 offen lds
s_xor_b32 s32, s35, 0x48000
s_add_u32 m0, s36, 9216
s_nop 0
buffer_load_dwordx4 v65, s[8:11], s32 offen lds
s_xor_b32 s32, s35, 0x50000
s_add_u32 m0, s36, 10240
s_nop 0
buffer_load_dwordx4 v65, s[8:11], s32 offen lds
s_xor_b32 s32, s35, 0x58000
s_add_u32 m0, s36, 11264
s_nop 0
buffer_load_dwordx4 v65, s[8:11], s32 offen lds
s_xor_b32 s32, s35, 0x60000
s_add_u32 m0, s36, 12288
s_nop 0
buffer_load_dwordx4 v65, s[8:11], s32 offen lds
s_xor_b32 s32, s35, 0x68000
s_add_u32 m0, s36, 13312
s_nop 0
buffer_load_dwordx4 v65, s[8:11], s32 offen lds
s_xor_b32 s32, s35, 0x70000
s_add_u32 m0, s36, 14336
s_nop 0
buffer_load_dwordx4 v65, s[8:11], s32 offen lds
s_xor_b32 s32, s35, 0x78000
s_add_u32 m0, s36, 15360
s_nop 0
buffer_load_dwordx4 v65, s[8:11], s32 offen lds
v_lshlrev_b32 v42, 16, v0
v_and_b32 v43, 0xffff0000, v0
v_cvt_pk_f16_f32 v0, v42, v43
v_lshlrev_b32 v44, 16, v1
v_and_b32 v45, 0xffff0000, v1
v_cvt_pk_f16_f32 v1, v44, v45
v_lshlrev_b32 v42, 16, v2
v_and_b32 v43, 0xffff0000, v2
v_cvt_pk_f16_f32 v2, v42, v43
v_lshlrev_b32 v44, 16, v3
v_and_b32 v45, 0xffff0000, v3
v_cvt_pk_f16_f32 v3, v44, v45
v_lshlrev_b32 v42, 16, v4
v_and_b32 v43, 0xffff0000, v4
v_cvt_pk_f16_f32 v4, v42, v43
v_lshlrev_b32 v44, 16, v5
v_and_b32 v45, 0xffff0000, v5
v_cvt_pk_f16_f32 v5, v44, v45
v_lshlrev_b32 v42, 16, v6
v_and_b32 v43, 0xffff0000, v6
v_cvt_pk_f16_f32 v6, v42, v43
v_lshlrev_b32 v44, 16, v7
v_and_b32 v45, 0xffff0000, v7
v_cvt_pk_f16_f32 v7, v44, v45
v_accvgpr_write_b32 a8, v0
v_accvgpr_write_b32 a9, v1
v_accvgpr_write_b32 a10, v2
v_accvgpr_write_b32 a11, v3
v_accvgpr_write_b32 a12, v4
v_accvgpr_write_b32 a13, v5
v_accvgpr_write_b32 a14, v6
v_accvgpr_write_b32 a15, v7
v_lshlrev_b32 v42, 16, v8
v_and_b32 v43, 0xffff0000, v8
v_cvt_pk_f16_f32 v8, v42, v43
v_lshlrev_b32 v44, 16, v9
v_and_b32 v45, 0xffff0000, v9
v_cvt_pk_f16_f32 v9, v44, v45
v_lshlrev_b32 v42, 16, v10
v_and_b32 v43, 0xffff0000, v10
v_cvt_pk_f16_f32 v10, v42, v43
v_lshlrev_b32 v44, 16, v11
v_and_b32 v45, 0xffff0000, v11
v_cvt_pk_f16_f32 v11, v44, v45
v_lshlrev_b32 v42, 16, v12
v_and_b32 v43, 0xffff0000, v12
v_cvt_pk_f16_f32 v12, v42, v43
v_lshlrev_b32 v44, 16, v13
v_and_b32 v45, 0xffff0000, v13
v_cvt_pk_f16_f32 v13, v44, v45
v_lshlrev_b32 v42, 16, v14
v_and_b32 v43, 0xffff0000, v14
v_cvt_pk_f16_f32 v14, v42, v43
v_lshlrev_b32 v44, 16, v15
v_and_b32 v45, 0xffff0000, v15
v_cvt_pk_f16_f32 v15, v44, v45
v_accvgpr_write_b32 a40, v8
v_accvgpr_write_b32 a41, v9
v_accvgpr_write_b32 a42, v10
v_accvgpr_write_b32 a43, v11
v_accvgpr_write_b32 a44, v12
v_accvgpr_write_b32 a45, v13
v_accvgpr_write_b32 a46, v14
v_accvgpr_write_b32 a47, v15
v_lshlrev_b32 v42, 16, v16
v_and_b32 v43, 0xffff0000, v16
v_cvt_pk_f16_f32 v16, v42, v43
v_lshlrev_b32 v44, 16, v17
v_and_b32 v45, 0xffff0000, v17
v_cvt_pk_f16_f32 v17, v44, v45
v_lshlrev_b32 v42, 16, v18
v_and_b32 v43, 0xffff0000, v18
v_cvt_pk_f16_f32 v18, v42, v43
v_lshlrev_b32 v44, 16, v19
v_and_b32 v45, 0xffff0000, v19
v_cvt_pk_f16_f32 v19, v44, v45
v_lshlrev_b32 v42, 16, v20
v_and_b32 v43, 0xffff0000, v20
v_cvt_pk_f16_f32 v20, v42, v43
v_lshlrev_b32 v44, 16, v21
v_and_b32 v45, 0xffff0000, v21
v_cvt_pk_f16_f32 v21, v44, v45
v_lshlrev_b32 v42, 16, v22
v_and_b32 v43, 0xffff0000, v22
v_cvt_pk_f16_f32 v22, v42, v43
v_lshlrev_b32 v44, 16, v23
v_and_b32 v45, 0xffff0000, v23
v_cvt_pk_f16_f32 v23, v44, v45
v_accvgpr_write_b32 a72, v16
v_accvgpr_write_b32 a73, v17
v_accvgpr_write_b32 a74, v18
v_accvgpr_write_b32 a75, v19
v_accvgpr_write_b32 a76, v20
v_accvgpr_write_b32 a77, v21
v_accvgpr_write_b32 a78, v22
v_accvgpr_write_b32 a79, v23
v_lshlrev_b32 v42, 16, v24
v_and_b32 v43, 0xffff0000, v24
v_cvt_pk_f16_f32 v24, v42, v43
v_lshlrev_b32 v44, 16, v25
v_and_b32 v45, 0xffff0000, v25
v_cvt_pk_f16_f32 v25, v44, v45
v_lshlrev_b32 v42, 16, v26
v_and_b32 v43, 0xffff0000, v26
v_cvt_pk_f16_f32 v26, v42, v43
v_lshlrev_b32 v44, 16, v27
v_and_b32 v45, 0xffff0000, v27
v_cvt_pk_f16_f32 v27, v44, v45
v_lshlrev_b32 v42, 16, v28
v_and_b32 v43, 0xffff0000, v28
v_cvt_pk_f16_f32 v28, v42, v43
v_lshlrev_b32 v44, 16, v29
v_and_b32 v45, 0xffff0000, v29
v_cvt_pk_f16_f32 v29, v44, v45
v_lshlrev_b32 v42, 16, v30
v_and_b32 v43, 0xffff0000, v30
v_cvt_pk_f16_f32 v30, v42, v43
v_lshlrev_b32 v44, 16, v31
v_and_b32 v45, 0xffff0000, v31
v_cvt_pk_f16_f32 v31, v44, v45
v_accvgpr_write_b32 a104, v24
v_accvgpr_write_b32 a105, v25
v_accvgpr_write_b32 a106, v26
v_accvgpr_write_b32 a107, v27
v_accvgpr_write_b32 a108, v28
v_accvgpr_write_b32 a109, v29
v_accvgpr_write_b32 a110, v30
v_accvgpr_write_b32 a111, v31
s_waitcnt vmcnt(24)
v_readlane_b32 s48, v72, 0
v_readlane_b32 s49, v72, 1
v_readlane_b32 s50, v72, 2
v_readlane_b32 s51, v72, 3
v_readlane_b32 s52, v72, 4
v_readlane_b32 s53, v72, 5
v_readlane_b32 s54, v72, 6
v_readlane_b32 s55, v72, 7
v_readlane_b32 s38, v72, 8
s_nop 3
s_add_u32 s33, s48, s49
s_add_u32 s33, s33, s50
s_add_u32 s33, s33, s51
s_add_u32 s33, s33, s52
s_add_u32 s33, s33, s53
s_add_u32 s33, s33, s54
s_add_u32 s33, s33, s55
s_cmp_ge_u32 s38, 4
s_cselect_b32 s33, s33, 0
s_cmp_ge_u32 s33, 256
s_cselect_b32 s38, 0, 1
s_barrier
ds_read_b64_tr_b16 v[0:1], v32 offset:16384
ds_read_b64_tr_b16 v[2:3], v32 offset:16640
ds_read_b64_tr_b16 v[4:5], v32 offset:20480
ds_read_b64_tr_b16 v[6:7], v32 offset:20736
ds_read_b64_tr_b16 v[8:9], v33 offset:16384
ds_read_b64_tr_b16 v[10:11], v33 offset:16640
ds_read_b64_tr_b16 v[12:13], v33 offset:20480
ds_read_b64_tr_b16 v[14:15], v33 offset:20736
ds_read_b64_tr_b16 v[16:17], v34 offset:16384
ds_read_b64_tr_b16 v[18:19], v34 offset:16640
ds_read_b64_tr_b16 v[20:21], v34 offset:20480
ds_read_b64_tr_b16 v[22:23], v34 offset:20736
ds_read_b64_tr_b16 v[24:25], v35 offset:16384
ds_read_b64_tr_b16 v[26:27], v35 offset:16640
ds_read_b64_tr_b16 v[28:29], v35 offset:20480
ds_read_b64_tr_b16 v[30:31], v35 offset:20736
s_waitcnt lgkmcnt(0)
s_barrier
s_xor_b32 s32, s35, 0x80000
s_add_u32 m0, s36, 16384
s_nop 0
buffer_load_dwordx4 v65, s[8:11], s32 offen lds
s_xor_b32 s32, s35, 0x88000
s_add_u32 m0, s36, 17408
s_nop 0
buffer_load_dwordx4 v65, s[8:11], s32 offen lds
s_xor_b32 s32, s35, 0x90000
s_add_u32 m0, s36, 18432
s_nop 0
buffer_load_dwordx4 v65, s[8:11], s32 offen lds
s_xor_b32 s32, s35, 0x98000
s_add_u32 m0, s36, 19456
s_nop 0
buffer_load_dwordx4 v65, s[8:11], s32 offen lds
s_xor_b32 s32, s35, 0xa0000
s_add_u32 m0, s36, 20480
s_nop 0
buffer_load_dwordx4 v65, s[8:11], s32 offen lds
s_xor_b32 s32, s35, 0xa8000
s_add_u32 m0, s36, 21504
s_nop 0
buffer_load_dwordx4 v65, s[8:11], s32 offen lds
s_xor_b32 s32, s35, 0xb0000
s_add_u32 m0, s36, 22528
s_nop 0
buffer_load_dwordx4 v65, s[8:11], s32 offen lds
s_xor_b32 s32, s35, 0xb8000
s_add_u32 m0, s36, 23552
s_nop 0
buffer_load_dwordx4 v65, s[8:11], s32 offen lds
v_lshlrev_b32 v42, 16, v0
v_and_b32 v43, 0xffff0000, v0
v_cvt_pk_f16_f32 v0, v42, v43
v_lshlrev_b32 v44, 16, v1
v_and_b32 v45, 0xffff0000, v1
v_cvt_pk_f16_f32 v1, v44, v45
v_lshlrev_b32 v42, 16, v2
v_and_b32 v43, 0xffff0000, v2
v_cvt_pk_f16_f32 v2, v42, v43
v_lshlrev_b32 v44, 16, v3
v_and_b32 v45, 0xffff0000, v3
v_cvt_pk_f16_f32 v3, v44, v45
v_lshlrev_b32 v42, 16, v4
v_and_b32 v43, 0xffff0000, v4
v_cvt_pk_f16_f32 v4, v42, v43
v_lshlrev_b32 v44, 16, v5
v_and_b32 v45, 0xffff0000, v5
v_cvt_pk_f16_f32 v5, v44, v45
v_lshlrev_b32 v42, 16, v6
v_and_b32 v43, 0xffff0000, v6
v_cvt_pk_f16_f32 v6, v42, v43
v_lshlrev_b32 v44, 16, v7
v_and_b32 v45, 0xffff0000, v7
v_cvt_pk_f16_f32 v7, v44, v45
v_accvgpr_write_b32 a16, v0
v_accvgpr_write_b32 a17, v1
v_accvgpr_write_b32 a18, v2
v_accvgpr_write_b32 a19, v3
v_accvgpr_write_b32 a20, v4
v_accvgpr_write_b32 a21, v5
v_accvgpr_write_b32 a22, v6
v_accvgpr_write_b32 a23, v7
v_lshlrev_b32 v42, 16, v8
v_and_b32 v43, 0xffff0000, v8
v_cvt_pk_f16_f32 v8, v42, v43
v_lshlrev_b32 v44, 16, v9
v_and_b32 v45, 0xffff0000, v9
v_cvt_pk_f16_f32 v9, v44, v45
v_lshlrev_b32 v42, 16, v10
v_and_b32 v43, 0xffff0000, v10
v_cvt_pk_f16_f32 v10, v42, v43
v_lshlrev_b32 v44, 16, v11
v_and_b32 v45, 0xffff0000, v11
v_cvt_pk_f16_f32 v11, v44, v45
v_lshlrev_b32 v42, 16, v12
v_and_b32 v43, 0xffff0000, v12
v_cvt_pk_f16_f32 v12, v42, v43
v_lshlrev_b32 v44, 16, v13
v_and_b32 v45, 0xffff0000, v13
v_cvt_pk_f16_f32 v13, v44, v45
v_lshlrev_b32 v42, 16, v14
v_and_b32 v43, 0xffff0000, v14
v_cvt_pk_f16_f32 v14, v42, v43
v_lshlrev_b32 v44, 16, v15
v_and_b32 v45, 0xffff0000, v15
v_cvt_pk_f16_f32 v15, v44, v45
v_accvgpr_write_b32 a48, v8
v_accvgpr_write_b32 a49, v9
v_accvgpr_write_b32 a50, v10
v_accvgpr_write_b32 a51, v11
v_accvgpr_write_b32 a52, v12
v_accvgpr_write_b32 a53, v13
v_accvgpr_write_b32 a54, v14
v_accvgpr_write_b32 a55, v15
v_lshlrev_b32 v42, 16, v16
v_and_b32 v43, 0xffff0000, v16
v_cvt_pk_f16_f32 v16, v42, v43
v_lshlrev_b32 v44, 16, v17
v_and_b32 v45, 0xffff0000, v17
v_cvt_pk_f16_f32 v17, v44, v45
v_lshlrev_b32 v42, 16, v18
v_and_b32 v43, 0xffff0000, v18
v_cvt_pk_f16_f32 v18, v42, v43
v_lshlrev_b32 v44, 16, v19
v_and_b32 v45, 0xffff0000, v19
v_cvt_pk_f16_f32 v19, v44, v45
v_lshlrev_b32 v42, 16, v20
v_and_b32 v43, 0xffff0000, v20
v_cvt_pk_f16_f32 v20, v42, v43
v_lshlrev_b32 v44, 16, v21
v_and_b32 v45, 0xffff0000, v21
v_cvt_pk_f16_f32 v21, v44, v45
v_lshlrev_b32 v42, 16, v22
v_and_b32 v43, 0xffff0000, v22
v_cvt_pk_f16_f32 v22, v42, v43
v_lshlrev_b32 v44, 16, v23
v_and_b32 v45, 0xffff0000, v23
v_cvt_pk_f16_f32 v23, v44, v45
v_accvgpr_write_b32 a80, v16
v_accvgpr_write_b32 a81, v17
v_accvgpr_write_b32 a82, v18
v_accvgpr_write_b32 a83, v19
v_accvgpr_write_b32 a84, v20
v_accvgpr_write_b32 a85, v21
v_accvgpr_write_b32 a86, v22
v_accvgpr_write_b32 a87, v23
v_lshlrev_b32 v42, 16, v24
v_and_b32 v43, 0xffff0000, v24
v_cvt_pk_f16_f32 v24, v42, v43
v_lshlrev_b32 v44, 16, v25
v_and_b32 v45, 0xffff0000, v25
v_cvt_pk_f16_f32 v25, v44, v45
v_lshlrev_b32 v42, 16, v26
v_and_b32 v43, 0xffff0000, v26
v_cvt_pk_f16_f32 v26, v42, v43
v_lshlrev_b32 v44, 16, v27
v_and_b32 v45, 0xffff0000, v27
v_cvt_pk_f16_f32 v27, v44, v45
v_lshlrev_b32 v42, 16, v28
v_and_b32 v43, 0xffff0000, v28
v_cvt_pk_f16_f32 v28, v42, v43
v_lshlrev_b32 v44, 16, v29
v_and_b32 v45, 0xffff0000, v29
v_cvt_pk_f16_f32 v29, v44, v45
v_lshlrev_b32 v42, 16, v30
v_and_b32 v43, 0xffff0000, v30
v_cvt_pk_f16_f32 v30, v42, v43
v_lshlrev_b32 v44, 16, v31
v_and_b32 v45, 0xffff0000, v31
v_cvt_pk_f16_f32 v31, v44, v45
v_accvgpr_write_b32 a112, v24
v_accvgpr_write_b32 a113, v25
v_accvgpr_write_b32 a114, v26
v_accvgpr_write_b32 a115, v27
v_accvgpr_write_b32 a116, v28
v_accvgpr_write_b32 a117, v29
v_accvgpr_write_b32 a118, v30
v_accvgpr_write_b32 a119, v31
s_waitcnt vmcnt(24)
s_barrier
ds_read_b64_tr_b16 v[0:1], v32 offset:24576
ds_read_b64_tr_b16 v[2:3], v32 offset:24832
ds_read_b64_tr_b16 v[4:5], v32 offset:28672
ds_read_b64_tr_b16 v[6:7], v32 offset:28928
ds_read_b64_tr_b16 v[8:9], v33 offset:24576
ds_read_b64_tr_b16 v[10:11], v33 offset:24832
ds_read_b64_tr_b16 v[12:13], v33 offset:28672
ds_read_b64_tr_b16 v[14:15], v33 offset:28928
ds_read_b64_tr_b16 v[16:17], v34 offset:24576
ds_read_b64_tr_b16 v[18:19], v34 offset:24832
ds_read_b64_tr_b16 v[20:21], v34 offset:28672
ds_read_b64_tr_b16 v[22:23], v34 offset:28928
ds_read_b64_tr_b16 v[24:25], v35 offset:24576
ds_read_b64_tr_b16 v[26:27], v35 offset:24832
ds_read_b64_tr_b16 v[28:29], v35 offset:28672
ds_read_b64_tr_b16 v[30:31], v35 offset:28928
s_waitcnt lgkmcnt(0)
s_barrier
s_xor_b32 s32, s35, 0xc0000
s_add_u32 m0, s36, 24576
s_nop 0
buffer_load_dwordx4 v65, s[8:11], s32 offen lds
s_xor_b32 s32, s35, 0xc8000
s_add_u32 m0, s36, 25600
s_nop 0
buffer_load_dwordx4 v65, s[8:11], s32 offen lds
s_xor_b32 s32, s35, 0xd0000
s_add_u32 m0, s36, 26624
s_nop 0
buffer_load_dwordx4 v65, s[8:11], s32 offen lds
s_xor_b32 s32, s35, 0xd8000
s_add_u32 m0, s36, 27648
s_nop 0
buffer_load_dwordx4 v65, s[8:11], s32 offen lds
s_xor_b32 s32, s35, 0xe0000
s_add_u32 m0, s36, 28672
s_nop 0
buffer_load_dwordx4 v65, s[8:11], s32 offen lds
s_xor_b32 s32, s35, 0xe8000
s_add_u32 m0, s36, 29696
s_nop 0
buffer_load_dwordx4 v65, s[8:11], s32 offen lds
s_xor_b32 s32, s35, 0xf0000
s_add_u32 m0, s36, 30720
s_nop 0
buffer_load_dwordx4 v65, s[8:11], s32 offen lds
s_xor_b32 s32, s35, 0xf8000
s_add_u32 m0, s36, 31744
s_nop 0
buffer_load_dwordx4 v65, s[8:11], s32 offen lds
v_lshlrev_b32 v42, 16, v0
v_and_b32 v43, 0xffff0000, v0
v_cvt_pk_f16_f32 v0, v42, v43
v_lshlrev_b32 v44, 16, v1
v_and_b32 v45, 0xffff0000, v1
v_cvt_pk_f16_f32 v1, v44, v45
v_lshlrev_b32 v42, 16, v2
v_and_b32 v43, 0xffff0000, v2
v_cvt_pk_f16_f32 v2, v42, v43
v_lshlrev_b32 v44, 16, v3
v_and_b32 v45, 0xffff0000, v3
v_cvt_pk_f16_f32 v3, v44, v45
v_lshlrev_b32 v42, 16, v4
v_and_b32 v43, 0xffff0000, v4
v_cvt_pk_f16_f32 v4, v42, v43
v_lshlrev_b32 v44, 16, v5
v_and_b32 v45, 0xffff0000, v5
v_cvt_pk_f16_f32 v5, v44, v45
v_lshlrev_b32 v42, 16, v6
v_and_b32 v43, 0xffff0000, v6
v_cvt_pk_f16_f32 v6, v42, v43
v_lshlrev_b32 v44, 16, v7
v_and_b32 v45, 0xffff0000, v7
v_cvt_pk_f16_f32 v7, v44, v45
v_accvgpr_write_b32 a24, v0
v_accvgpr_write_b32 a25, v1
v_accvgpr_write_b32 a26, v2
v_accvgpr_write_b32 a27, v3
v_accvgpr_write_b32 a28, v4
v_accvgpr_write_b32 a29, v5
v_accvgpr_write_b32 a30, v6
v_accvgpr_write_b32 a31, v7
v_lshlrev_b32 v42, 16, v8
v_and_b32 v43, 0xffff0000, v8
v_cvt_pk_f16_f32 v8, v42, v43
v_lshlrev_b32 v44, 16, v9
v_and_b32 v45, 0xffff0000, v9
v_cvt_pk_f16_f32 v9, v44, v45
v_lshlrev_b32 v42, 16, v10
v_and_b32 v43, 0xffff0000, v10
v_cvt_pk_f16_f32 v10, v42, v43
v_lshlrev_b32 v44, 16, v11
v_and_b32 v45, 0xffff0000, v11
v_cvt_pk_f16_f32 v11, v44, v45
v_lshlrev_b32 v42, 16, v12
v_and_b32 v43, 0xffff0000, v12
v_cvt_pk_f16_f32 v12, v42, v43
v_lshlrev_b32 v44, 16, v13
v_and_b32 v45, 0xffff0000, v13
v_cvt_pk_f16_f32 v13, v44, v45
v_lshlrev_b32 v42, 16, v14
v_and_b32 v43, 0xffff0000, v14
v_cvt_pk_f16_f32 v14, v42, v43
v_lshlrev_b32 v44, 16, v15
v_and_b32 v45, 0xffff0000, v15
v_cvt_pk_f16_f32 v15, v44, v45
v_accvgpr_write_b32 a56, v8
v_accvgpr_write_b32 a57, v9
v_accvgpr_write_b32 a58, v10
v_accvgpr_write_b32 a59, v11
v_accvgpr_write_b32 a60, v12
v_accvgpr_write_b32 a61, v13
v_accvgpr_write_b32 a62, v14
v_accvgpr_write_b32 a63, v15
v_lshlrev_b32 v42, 16, v16
v_and_b32 v43, 0xffff0000, v16
v_cvt_pk_f16_f32 v16, v42, v43
v_lshlrev_b32 v44, 16, v17
v_and_b32 v45, 0xffff0000, v17
v_cvt_pk_f16_f32 v17, v44, v45
v_lshlrev_b32 v42, 16, v18
v_and_b32 v43, 0xffff0000, v18
v_cvt_pk_f16_f32 v18, v42, v43
v_lshlrev_b32 v44, 16, v19
v_and_b32 v45, 0xffff0000, v19
v_cvt_pk_f16_f32 v19, v44, v45
v_lshlrev_b32 v42, 16, v20
v_and_b32 v43, 0xffff0000, v20
v_cvt_pk_f16_f32 v20, v42, v43
v_lshlrev_b32 v44, 16, v21
v_and_b32 v45, 0xffff0000, v21
v_cvt_pk_f16_f32 v21, v44, v45
v_lshlrev_b32 v42, 16, v22
v_and_b32 v43, 0xffff0000, v22
v_cvt_pk_f16_f32 v22, v42, v43
v_lshlrev_b32 v44, 16, v23
v_and_b32 v45, 0xffff0000, v23
v_cvt_pk_f16_f32 v23, v44, v45
v_accvgpr_write_b32 a88, v16
v_accvgpr_write_b32 a89, v17
v_accvgpr_write_b32 a90, v18
v_accvgpr_write_b32 a91, v19
v_accvgpr_write_b32 a92, v20
v_accvgpr_write_b32 a93, v21
v_accvgpr_write_b32 a94, v22
v_accvgpr_write_b32 a95, v23
v_lshlrev_b32 v42, 16, v24
v_and_b32 v43, 0xffff0000, v24
v_cvt_pk_f16_f32 v24, v42, v43
v_lshlrev_b32 v44, 16, v25
v_and_b32 v45, 0xffff0000, v25
v_cvt_pk_f16_f32 v25, v44, v45
v_lshlrev_b32 v42, 16, v26
v_and_b32 v43, 0xffff0000, v26
v_cvt_pk_f16_f32 v26, v42, v43
v_lshlrev_b32 v44, 16, v27
v_and_b32 v45, 0xffff0000, v27
v_cvt_pk_f16_f32 v27, v44, v45
v_lshlrev_b32 v42, 16, v28
v_and_b32 v43, 0xffff0000, v28
v_cvt_pk_f16_f32 v28, v42, v43
v_lshlrev_b32 v44, 16, v29
v_and_b32 v45, 0xffff0000, v29
v_cvt_pk_f16_f32 v29, v44, v45
v_lshlrev_b32 v42, 16, v30
v_and_b32 v43, 0xffff0000, v30
v_cvt_pk_f16_f32 v30, v42, v43
v_lshlrev_b32 v44, 16, v31
v_and_b32 v45, 0xffff0000, v31
v_cvt_pk_f16_f32 v31, v44, v45
v_accvgpr_write_b32 a120, v24
v_accvgpr_write_b32 a121, v25
v_accvgpr_write_b32 a122, v26
v_accvgpr_write_b32 a123, v27
v_accvgpr_write_b32 a124, v28
v_accvgpr_write_b32 a125, v29
v_accvgpr_write_b32 a126, v30
v_accvgpr_write_b32 a127, v31
v_and_b32 v64, 15, v94
v_lshrrev_b32 v65, 4, v94
v_bfe_u32 v126, v94, 4, 1
v_lshlrev_b32 v126, 2, v126
v_sub_u32 v126, v64, v126
v_mov_b32 v66, 0x3f80
v_mov_b32 v67, 0x3f800000
s_and_b32 s33, s14, 1
s_lshl_b32 s32, s33, 3
v_subrev_u32 v71, s32, v126
v_lshrrev_b32 v70, 3, v64
v_and_b32 v69, 5, v64
v_lshl_add_u32 v69, v70, 1, v69
v_sub_u32 v126, v126, v64
v_add_u32 v126, v126, v69
v_and_b32 v70, 2, v64
v_lshl_add_u32 v126, v70, 4, v126
v_cmp_eq_u32 vcc, 32, v126
s_nop 1
v_cndmask_b32 v127, 0, v66, vcc
v_cmp_eq_u32 vcc, 33, v126
s_nop 1
v_cndmask_b32 v104, v127, v67, vcc
v_mov_b32 v106, v104
v_cmp_eq_u32 vcc, 34, v126
s_nop 1
v_cndmask_b32 v127, 0, v66, vcc
v_cmp_eq_u32 vcc, 35, v126
s_nop 1
v_cndmask_b32 v105, v127, v67, vcc
v_mov_b32 v107, v105
v_cmp_eq_u32 vcc, 0, v126
s_nop 1
v_cndmask_b32 v127, 0, v66, vcc
v_cmp_eq_u32 vcc, 1, v126
s_nop 1
v_cndmask_b32 v108, v127, v67, vcc
v_mov_b32 v110, v108
v_mov_b32 v106, v108
v_cmp_eq_u32 vcc, 2, v126
s_nop 1
v_cndmask_b32 v127, 0, v66, vcc
v_cmp_eq_u32 vcc, 3, v126
s_nop 1
v_cndmask_b32 v109, v127, v67, vcc
v_mov_b32 v111, v109
v_mov_b32 v107, v109
v_mov_b32 v127, 0x4444
v_mov_b32 v95, 0xeeee
v_cmp_gt_u32 vcc, 8, v64
s_nop 1
v_cndmask_b32 v112, v95, v127, vcc
v_lshrrev_b32 v126, 1, v65
v_lshlrev_b32 v126, 7, v126
v_lshl_add_u32 v126, v64, 4, v126
v_and_b32 v127, 1, v65
v_lshl_add_u32 v126, v127, 3, v126
v_mov_b32 v95, 0x7f000000
v_cndmask_b32 v118, v95, v126, vcc
v_lshlrev_b32 v126, 3, v64
v_lshl_add_u32 v126, v127, 7, v126
v_cmp_le_u32 vcc, 2, v65
s_nop 1
v_cndmask_b32 v120, v95, v126, vcc
v_mov_b32 v126, 0xf149f2ca
v_cndmask_b32 v124, v126, 0, vcc
v_lshrrev_b32 v126, 3, v64
v_cmp_eq_u32 vcc, s33, v126
v_and_b32 v126, 7, v64
v_lshlrev_b32 v126, 4, v126
v_lshl_add_u32 v126, v65, 7, v126
v_cndmask_b32 v117, v95, v116, vcc
v_cndmask_b32 v119, v95, v126, vcc
s_lshl_b32 s32, s14, 11
v_add_u32 v114, s32, v116
s_lshr_b32 s32, s14, 1
s_lshl_b32 s32, s32, 10
s_lshl_b32 s33, s33, 3
s_add_u32 s32, s32, s33
v_add_u32 v115, s32, v116
v_lshrrev_b32 v126, 3, v64
v_lshl_add_u32 v125, v126, 11, v116
v_lshrrev_b32 v71, 1, v65
v_cmp_ne_u32 vcc, 0, v70
v_lshlrev_b32 v126, 4, v64
v_lshl_add_u32 v126, v127, 8, v126
v_lshl_add_u32 v117, v71, 3, v126
v_lshrrev_b32 v120, 1, v117
v_lshlrev_b32 v69, 4, v69
v_lshl_add_u32 v126, v127, 7, v69
v_lshl_add_u32 v126, v71, 3, v126
v_cndmask_b32 v119, v126, v95, vcc
v_lshl_add_u32 v126, v71, 7, v69
v_lshl_add_u32 v126, v127, 3, v126
v_cndmask_b32 v125, v126, v95, vcc
v_cndmask_b32 v118, v95, v126, vcc
s_mov_b32 s17, 0
s_lshl_b32 s32, s12, 14
s_lshl_b32 s33, s14, 12
s_add_u32 s18, s32, s33
s_xor_b32 s33, s14, s13
s_and_b32 s33, s33, 3
s_lshl_b32 s33, s33, 10
s_add_u32 s18, s18, s33
s_xor_b32 s19, s18, 0x4000
s_add_u32 s18, s18, 0x6c30000
s_add_u32 s19, s19, 0x6c38000
s_lshl_b32 s20, s15, 12
s_add_u32 s20, s20, 0x6c00000
s_lshl_b32 s32, s16, 11
s_lshl_b32 s33, s14, 9
s_add_u32 s32, s32, s33
s_add_u32 s21, s20, s32
s_lshl_b32 s32, s16, 11
s_xor_b32 s32, s32, 2048
s_add_u32 s20, s20, s32
s_lshl_b32 s32, s12, 15
s_add_u32 s32, s32, 0x6c20000
s_lshl_b32 s33, s13, 10
s_add_u32 s22, s32, s33
s_lshl_b32 s33, s14, 8
s_add_u32 s22, s22, s33
s_lshl_b32 s33, s14, 13
s_add_u32 s23, s32, s33
s_add_u32 s24, s23, 4096
s_xor_b32 s33, s14, s13
s_and_b32 s33, s33, 7
s_lshl_b32 s33, s33, 10
s_add_u32 s23, s23, s33
s_lshl_b32 s32, s12, 14
s_lshl_b32 s33, s13, 9
s_add_u32 s32, s32, s33
s_bitcmp1_b32 s14, 0
s_cselect_b32 s33, 256, 0
s_add_u32 s32, s32, s33
s_add_u32 s25, s32, 0x6c30000
s_lshl_b32 s32, s16, 6
s_lshl_b32 s33, s14, 4
s_add_u32 s32, s32, s33
s_lshl_b32 s33, s15, 7
s_add_u32 s32, s32, s33
s_lshl_b32 s26, s32, 4
s_add_u32 s26, s26, 0x6e00000
s_lshl_b32 s37, s15, 2
s_lshl_b32 s33, s16, 1
s_add_u32 s37, s37, s33
s_lshr_b32 s33, s14, 1
s_add_u32 s37, s37, s33
s_lshl_b32 s37, s37, 9
s_add_u32 s37, s37, 0x8000000
s_bitcmp1_b32 s14, 0
s_cselect_b32 s33, 256, 0
s_add_u32 s37, s37, s33
s_lshl_b32 s28, s32, 6
s_add_u32 s28, s28, 0x2800000
s_lshl_b32 s27, s15, 12
s_lshl_b32 s36, s14, 11
s_and_b32 s33, s36, 2048
s_lshl_b32 s32, s16, 11
s_xor_b32 s33, s33, s32
s_add_u32 s27, s27, s33
s_lshr_b32 s33, s14, 1
s_lshl_b32 s33, s33, 17
s_add_u32 s27, s27, s33
s_add_u32 s27, s27, 0x1800000
s_add_u32 s36, s36, 24576
s_mov_b32 s30, 0x3e0293ee
s_mov_b32 s31, 0xbe0293ee
v_mov_b32 v100, 0x3f803f80
v_mov_b32 v101, 0x3f803f80
v_mov_b32 v102, 0x3f803f80
v_mov_b32 v103, 0x3f803f80
v_mov_b32 v121, 0x7f000000
v_mov_b32 v122, 0
v_and_b32 v127, 1, v94
v_mov_b32 v77, 0x7f000000
s_lshl_b32 s32, s16, 3
s_lshl_b64 exec, 0xff, s32
s_add_u32 s32, s27, 0x40000
v_lshl_add_u32 v121, v64, 7, s32
v_mov_b32 v122, 0x40000
s_mov_b32 exec_lo, 0xff0000
s_add_u32 s32, s28, 0x40000
v_lshl_add_u32 v121, v64, 7, s32
v_mov_b32 v122, 0x40000
s_mov_b32 exec_lo, 0x000f000f
s_mov_b32 exec_hi, 0x000f000f
s_and_b32 s33, s14, 1
s_lshl_b32 s33, s33, 7
s_add_u32 s32, s21, s33
v_lshl_add_u32 v77, v64, 7, s21
s_mov_b32 exec_lo, 0x00300030
s_mov_b32 exec_hi, 0x00300030
v_lshl_add_u32 v77, v127, 7, s22
s_mov_b32 exec_lo, 0x00400040
s_mov_b32 exec_hi, 0x00400040
s_lshl_b32 s32, s12, 14
s_lshl_b32 s33, s13, 9
s_add_u32 s33, s32, s33
s_add_u32 s33, s33, 0x6c30000
s_andn2_b32 s3, s33, 0x3ff
s_andn2_b32 s34, s22, 0x3ff
s_cmp_eq_u32 s14, 1
s_cselect_b32 s3, s34, s3
s_bitcmp0_b32 s14, 0
s_cselect_b32 s3, s21, s3
s_add_u32 s3, s3, 0x80000
s_lshl_b32 s34, s14, 7
s_add_u32 s33, s33, s34
v_mov_b32 v77, s33
s_mov_b32 exec_lo, 0x00800080
s_mov_b32 exec_hi, 0x00800080
s_add_u32 s32, s32, s34
s_add_u32 s32, s32, 0x6c38000
v_mov_b32 v77, s32
s_mov_b64 exec, -1
v_lshl_add_u32 v77, v65, 18, v77
s_mov_b32 exec_lo, 0
s_mov_b32 exec_hi, 0x300
s_lshl_b32 s32, s15, 2
s_add_u32 s32, s32, 0x8406000
v_lshl_add_u32 v121, v127, 13, s32
s_mov_b32 exec_hi, 0x3c00
s_mov_b32 s32, 0x8418158
v_lshl_add_u32 v121, v64, 2, s32
s_mov_b32 exec_hi, 0x3f00
v_mov_b32 v122, 128
s_mov_b64 exec, -1
s_lshl_b32 s32, s15, 3
s_lshl_b32 s33, s16, 2
s_add_u32 s32, s32, s33
s_add_u32 s32, s32, s14
s_mov_b32 s39, 0x7f000000
s_cmp_eq_u32 s32, 2
s_cselect_b32 s39, 0x841ec00, s39
s_waitcnt vmcnt(24)
ds_read_b64_tr_b16 v[0:1], v68 offset:0
ds_read_b64_tr_b16 v[2:3], v68 offset:128
ds_read_b64_tr_b16 v[4:5], v68 offset:2048
ds_read_b64_tr_b16 v[6:7], v68 offset:2176
ds_read_b64_tr_b16 v[8:9], v68 offset:32
ds_read_b64_tr_b16 v[10:11], v68 offset:160
ds_read_b64_tr_b16 v[12:13], v68 offset:2080
ds_read_b64_tr_b16 v[14:15], v68 offset:2208
ds_read_b64_tr_b16 v[16:17], v68 offset:4096
ds_read_b64_tr_b16 v[18:19], v68 offset:4224
ds_read_b64_tr_b16 v[20:21], v68 offset:6144
ds_read_b64_tr_b16 v[22:23], v68 offset:6272
ds_read_b64_tr_b16 v[24:25], v68 offset:4128
ds_read_b64_tr_b16 v[26:27], v68 offset:4256
ds_read_b64_tr_b16 v[28:29], v68 offset:6176
ds_read_b64_tr_b16 v[30:31], v68 offset:6304
s_waitcnt lgkmcnt(0)
ds_write_b128 v113, v[0:3] offset:0
ds_write_b128 v113, v[4:7] offset:1024
ds_write_b128 v113, v[8:11] offset:2048
ds_write_b128 v113, v[12:15] offset:3072
ds_write_b128 v113, v[16:19] offset:4096
ds_write_b128 v113, v[20:23] offset:5120
ds_write_b128 v113, v[24:27] offset:6144
ds_write_b128 v113, v[28:31] offset:7168
s_waitcnt lgkmcnt(0)
s_waitcnt vmcnt(16)
ds_read_b64_tr_b16 v[0:1], v68 offset:8192
ds_read_b64_tr_b16 v[2:3], v68 offset:8320
ds_read_b64_tr_b16 v[4:5], v68 offset:10240
ds_read_b64_tr_b16 v[6:7], v68 offset:10368
ds_read_b64_tr_b16 v[8:9], v68 offset:8224
ds_read_b64_tr_b16 v[10:11], v68 offset:8352
ds_read_b64_tr_b16 v[12:13], v68 offset:10272
ds_read_b64_tr_b16 v[14:15], v68 offset:10400
ds_read_b64_tr_b16 v[16:17], v68 offset:12288
ds_read_b64_tr_b16 v[18:19], v68 offset:12416
ds_read_b64_tr_b16 v[20:21], v68 offset:14336
ds_read_b64_tr_b16 v[22:23], v68 offset:14464
ds_read_b64_tr_b16 v[24:25], v68 offset:12320
ds_read_b64_tr_b16 v[26:27], v68 offset:12448
ds_read_b64_tr_b16 v[28:29], v68 offset:14368
ds_read_b64_tr_b16 v[30:31], v68 offset:14496
s_waitcnt lgkmcnt(0)
ds_write_b128 v113, v[0:3] offset:8192
ds_write_b128 v113, v[4:7] offset:9216
ds_write_b128 v113, v[8:11] offset:10240
ds_write_b128 v113, v[12:15] offset:11264
ds_write_b128 v113, v[16:19] offset:12288
ds_write_b128 v113, v[20:23] offset:13312
ds_write_b128 v113, v[24:27] offset:14336
ds_write_b128 v113, v[28:31] offset:15360
s_waitcnt lgkmcnt(0)
s_waitcnt vmcnt(8)
buffer_load_dword v76, v74, s[4:7], 0 offen sc1
buffer_load_dword v79, v75, s[4:7], 0 offen sc1
ds_read_b64_tr_b16 v[0:1], v68 offset:16384
ds_read_b64_tr_b16 v[2:3], v68 offset:16512
ds_read_b64_tr_b16 v[4:5], v68 offset:18432
ds_read_b64_tr_b16 v[6:7], v68 offset:18560
ds_read_b64_tr_b16 v[8:9], v68 offset:16416
ds_read_b64_tr_b16 v[10:11], v68 offset:16544
ds_read_b64_tr_b16 v[12:13], v68 offset:18464
ds_read_b64_tr_b16 v[14:15], v68 offset:18592
ds_read_b64_tr_b16 v[16:17], v68 offset:20480
ds_read_b64_tr_b16 v[18:19], v68 offset:20608
ds_read_b64_tr_b16 v[20:21], v68 offset:22528
ds_read_b64_tr_b16 v[22:23], v68 offset:22656
ds_read_b64_tr_b16 v[24:25], v68 offset:20512
ds_read_b64_tr_b16 v[26:27], v68 offset:20640
ds_read_b64_tr_b16 v[28:29], v68 offset:22560
ds_read_b64_tr_b16 v[30:31], v68 offset:22688
s_waitcnt lgkmcnt(0)
ds_write_b128 v113, v[0:3] offset:16384
ds_write_b128 v113, v[4:7] offset:17408
ds_write_b128 v113, v[8:11] offset:18432
ds_write_b128 v113, v[12:15] offset:19456
ds_write_b128 v113, v[16:19] offset:20480
ds_write_b128 v113, v[20:23] offset:21504
ds_write_b128 v113, v[24:27] offset:22528
ds_write_b128 v113, v[28:31] offset:23552
s_waitcnt lgkmcnt(0)
s_waitcnt vmcnt(2)
s_waitcnt vmcnt(0)
v_min_u32 v76, v76, v79
v_cmp_eq_u32 vcc, 0, v76
s_cmp_eq_u32 s38, 0
s_cbranch_scc0 main_kernel_c_sl0
s_cbranch_vccnz main_kernel_c_sl1
s_branch main_kernel_c_kv0_ok
main_kernel_c_sl0:
v_and_b32 v126, 7, v94
v_lshlrev_b32 v126, 5, v126
main_kernel_c_mode_cnt:
buffer_load_dword v127, v126, s[60:63], 0 offen sc1
s_waitcnt vmcnt(0)
v_readlane_b32 s48, v127, 0
v_readlane_b32 s49, v127, 1
v_readlane_b32 s50, v127, 2
v_readlane_b32 s51, v127, 3
v_readlane_b32 s52, v127, 4
v_readlane_b32 s53, v127, 5
v_readlane_b32 s54, v127, 6
v_readlane_b32 s55, v127, 7
s_nop 3
s_add_u32 s33, s48, s49
s_add_u32 s33, s33, s50
s_add_u32 s33, s33, s51
s_add_u32 s33, s33, s52
s_add_u32 s33, s33, s53
s_add_u32 s33, s33, s54
s_add_u32 s33, s33, s55
s_cmp_ge_u32 s33, 256
s_cbranch_scc1 main_kernel_c_mode_cnt_ok
s_sub_u32 s29, s29, 1
s_cbranch_scc1 main_kernel_end
s_sleep 4
s_branch main_kernel_c_mode_cnt
main_kernel_c_mode_cnt_ok:
v_mov_b32 v126, 0
main_kernel_c_wa:
buffer_load_dword v127, v126, s[60:63], 0 offen offset:12 sc1
s_waitcnt vmcnt(0)
v_cmp_gt_u32 vcc, 4, v127
s_cbranch_vccz main_kernel_c_wa_ok
s_sleep 4
s_sub_u32 s29, s29, 1
s_cbranch_scc0 main_kernel_c_wa
s_branch main_kernel_end
main_kernel_c_wa_ok:
main_kernel_c_sl1:
v_lshlrev_b32 v126, 2, v94
s_mov_b32 s32, 0x841f000
main_kernel_c_wf:
buffer_load_dword v0, v126, s[4:7], s32 offen sc1
s_waitcnt vmcnt(0)
v_cmp_eq_u32 vcc, 0, v0
s_cbranch_vccz main_kernel_c_wf_ok
s_sleep 4
s_sub_u32 s29, s29, 1
s_cbranch_scc0 main_kernel_c_wf
s_branch main_kernel_end
main_kernel_c_wf_ok:
s_mov_b32 exec_lo, 0
s_mov_b32 exec_hi, 0x300
v_subrev_u32 v127, 0, v121
main_kernel_c_kv0:
buffer_load_dword v126, v127, s[4:7], 0 offen sc1
s_waitcnt vmcnt(0)
v_cmp_eq_u32 vcc, 0, v126
s_cbranch_vccz main_kernel_c_kv0_ok
s_sleep 2
s_sub_u32 s29, s29, 1
s_cbranch_scc0 main_kernel_c_kv0
s_branch main_kernel_end
main_kernel_c_kv0_ok:
s_mov_b32 exec_lo, 0
s_mov_b32 exec_hi, 0x3f00
v_add_u32 v121, 128, v121
s_mov_b64 exec, -1
s_mov_b32 m0, s36
buffer_load_dwordx4 v[96:99], v116, s[4:7], s28 offen sc1
buffer_load_dwordx4 v116, s[4:7], s27 offen sc1 lds
buffer_load_dwordx4 v116, s[4:7], s27 offen offset:1024 sc1 lds
s_add_u32 s27, s27, 0x40000
buffer_load_dword v123, v77, s[4:7], 0 offen sc1
ds_read_b64_tr_b16 v[0:1], v68 offset:24576
ds_read_b64_tr_b16 v[2:3], v68 offset:24704
ds_read_b64_tr_b16 v[4:5], v68 offset:26624
ds_read_b64_tr_b16 v[6:7], v68 offset:26752
ds_read_b64_tr_b16 v[8:9], v68 offset:24608
ds_read_b64_tr_b16 v[10:11], v68 offset:24736
ds_read_b64_tr_b16 v[12:13], v68 offset:26656
ds_read_b64_tr_b16 v[14:15], v68 offset:26784
ds_read_b64_tr_b16 v[16:17], v68 offset:28672
ds_read_b64_tr_b16 v[18:19], v68 offset:28800
ds_read_b64_tr_b16 v[20:21], v68 offset:30720
ds_read_b64_tr_b16 v[22:23], v68 offset:30848
ds_read_b64_tr_b16 v[24:25], v68 offset:28704
ds_read_b64_tr_b16 v[26:27], v68 offset:28832
ds_read_b64_tr_b16 v[28:29], v68 offset:30752
ds_read_b64_tr_b16 v[30:31], v68 offset:30880
s_waitcnt lgkmcnt(0)
ds_write_b128 v113, v[0:3] offset:24576
ds_write_b128 v113, v[4:7] offset:25600
ds_write_b128 v113, v[8:11] offset:26624
ds_write_b128 v113, v[12:15] offset:27648
ds_write_b128 v113, v[16:19] offset:28672
ds_write_b128 v113, v[20:23] offset:29696
ds_write_b128 v113, v[24:27] offset:30720
ds_write_b128 v113, v[28:31] offset:31744
s_waitcnt lgkmcnt(0)
main_kernel_c_nb:
v_readfirstlane_b32 s33, v84
v_readfirstlane_b32 s32, v85
s_nop 3
s_and_b32 s34, s32, s33
s_cbranch_scc1 main_kernel_c_nb_ok
buffer_load_dwordx2 v[84:85], off, s[60:63], 0 offset:16 sc1
s_sub_u32 s29, s29, 1
s_cbranch_scc1 main_kernel_end
s_waitcnt vmcnt(0)
s_branch main_kernel_c_nb
main_kernel_c_nb_ok:
s_and_b32 s33, s33, 1
s_lshl_b32 s33, s33, 13
s_add_u32 s52, s33, 0x8c10000
s_and_b32 s32, s32, 1
s_lshl_b32 s32, s32, 13
s_sub_u32 s53, s32, s33
s_add_u32 s53, s53, 65536
s_and_b32 s59, s25, 0x7fff
s_and_b32 s33, s59, 0x6000
s_add_u32 s59, s59, s33
s_and_b32 s54, s19, 0x7fff
s_and_b32 s33, s54, 0x6000
s_add_u32 s54, s54, s33
s_xor_b32 s34, s52, 0x2000
s_lshl_b32 s32, s14, 14
s_lshl_b32 s33, s13, 8
s_add_u32 s33, s33, s34
s_add_u32 s55, s32, s33
v_writelane_b32 v121, s55, 39
s_lshl_b32 s32, s12, 15
s_add_u32 s44, s32, s33
s_xor_b32 s32, s32, 0x8000
s_add_u32 s45, s32, s34
s_lshl_b32 s32, s12, 14
s_add_u32 s32, s32, 0x6c78000
s_lshl_b32 s33, s13, 3
s_add_u32 s46, s32, s33
s_andn2_b32 s32, s25, 0x3ff
s_add_u32 s32, s32, 0x80000
s_cmp_eq_u32 s14, 1
s_cselect_b32 s46, s32, s46
s_add_u32 s20, s20, 0xc0000
s_add_u32 s21, s21, 0xc0000
s_add_u32 s22, s22, 0xc0000
s_add_u32 s23, s23, 0xc0000
s_sub_u32 s3, s3, 0x40000
s_sub_u32 s37, s37, 65536
s_sub_u32 s26, s26, 65536
s_cmp_eq_u32 s14, 3
s_cselect_b32 s39, 0, s39
s_mov_b32 s15, 0
s_mov_b32 s16, 0
s_cselect_b32 s27, 0, s27
s_mov_b32 s17, -1
s_memrealtime s[32:33]
s_memtime s[40:41]
s_waitcnt lgkmcnt(0)
s_mul_i32 s32, s32, 22
s_sub_u32 s11, s40, s32
s_sub_u32 s31, s32, 0x20000
s_sub_u32 s43, s31, 0x20000
s_min_u32 s32, s48, s49
s_cmp_ge_u32 s32, 32
s_waitcnt vmcnt(0)
s_cselect_b32 s32, 0, 4
s_add_u32 s32, s32, s14
s_cmp_eq_u32 s32, 1
s_cbranch_scc1 main_kernel_c1_top
s_cmp_eq_u32 s32, 2
s_cbranch_scc1 main_kernel_c2_top
s_cmp_eq_u32 s32, 3
s_cbranch_scc1 main_kernel_c3_top
s_cmp_eq_u32 s32, 4
s_cbranch_scc1 main_kernel_c4_top
s_cmp_eq_u32 s32, 5
s_cbranch_scc1 main_kernel_c5_top
s_cmp_eq_u32 s32, 6
s_cbranch_scc1 main_kernel_c6_top
s_cmp_eq_u32 s32, 7
s_cbranch_scc1 main_kernel_c7_top
s_branch main_kernel_c0_top
.p2align 6
main_kernel_c0_top:
s_barrier
buffer_load_dwordx4 v[0:3], v116, s[4:7], s18 offen sc1
s_add_u32 s20, s20, 0x40000
s_bitset0_b32 s20, 20
s_add_u32 s21, s21, 0x40000
s_bitset0_b32 s21, 20
s_add_u32 s22, s22, 0x40000
s_bitset0_b32 s22, 20
s_add_u32 s23, s23, 0x40000
s_bitset0_b32 s23, 20
s_xor_b32 s32, s18, 1024
buffer_load_dwordx4 v[16:19], v116, s[4:7], s32 offen sc1
s_add_u32 s3, s3, 0x40000
s_bitset0_b32 s3, 20
s_add_u32 s17, s17, 1
s_bitcmp1_b32 0x77777777, s17
s_cselect_b32 s33, 0x800, 0
s_xor_b32 s54, s54, s33
s_xor_b32 s59, s59, s33
s_add_u32 s25, s52, s59
s_nop 0
buffer_load_dwordx4 v[64:67], v116, s[4:7], s19 offen sc1
v_mov_b32 v80, 0
v_mov_b32 v81, 0
s_nop 3
s_xor_b32 s32, s19, 1024
buffer_load_dwordx4 v[68:71], v116, s[4:7], s32 offen sc1
v_mov_b32 v82, 0
v_mov_b32 v83, 0
s_nop 3
s_xor_b32 s32, s18, 2048
buffer_load_dwordx4 v[32:35], v116, s[4:7], s32 offen sc1
v_mov_b32 v84, 0
v_mov_b32 v85, 0
s_nop 3
s_xor_b32 s32, s19, 2048
buffer_load_dwordx4 v[72:75], v116, s[4:7], s32 offen sc1
v_mov_b32 v86, 0
v_mov_b32 v87, 0
s_nop 3
s_xor_b32 s32, s18, 3072
buffer_load_dwordx4 v[48:51], v116, s[4:7], s32 offen sc1
v_mov_b32 v88, 0
v_mov_b32 v89, 0
s_nop 3
s_xor_b32 s32, s19, 3072
buffer_load_dwordx4 v[76:79], v116, s[4:7], s32 offen sc1
v_mov_b32 v90, 0
v_mov_b32 v91, 0
s_waitcnt vmcnt(5)
v_pk_add_f16 v0, v0, v64
v_pk_add_f16 v1, v1, v65
v_pk_add_f16 v2, v2, v66
v_pk_add_f16 v3, v3, v67
v_cmp_u_f16 vcc, v0, v2
s_cbranch_vccnz main_kernel_c0_m0_f
main_kernel_c0_m0:
v_smfmac_f32_16x16x64_f16 v[80:83], v[0:3], a[0:7], v112
ds_write_b128 v116, v[0:3] offset:0
v_smfmac_f32_16x16x64_f16 v[84:87], v[0:3], a[128:135], v112
buffer_load_dword v123, v121, s[4:7], 0 offen sc1
s_waitcnt vmcnt(5)
v_pk_add_f16 v16, v16, v68
v_pk_add_f16 v17, v17, v69
v_pk_add_f16 v18, v18, v70
v_pk_add_f16 v19, v19, v71
v_cmp_u_f16 vcc, v16, v18
s_waitcnt lgkmcnt(0)
s_barrier
ds_read_b128 v[4:7], v116 offset:1024
ds_write_b128 v116, v[16:19] offset:4096
s_cbranch_vccnz main_kernel_c0_m1_f
main_kernel_c0_m1:
v_smfmac_f32_16x16x64_f16 v[80:83], v[16:19], a[8:15], v112
v_smfmac_f32_16x16x64_f16 v[84:87], v[16:19], a[136:143], v112
ds_read_b128 v[8:11], v116 offset:2048
v_smfmac_f32_16x16x64_f16 v[88:91], v[0:3], v[128:135], v112
ds_read_b128 v[12:15], v116 offset:3072
s_waitcnt lgkmcnt(3)
v_smfmac_f32_16x16x64_f16 v[80:83], v[4:7], a[32:39], v112
v_smfmac_f32_16x16x64_f16 v[84:87], v[4:7], a[160:167], v112
v_smfmac_f32_16x16x64_f16 v[88:91], v[4:7], v[136:143], v112
s_waitcnt lgkmcnt(2)
s_barrier
s_waitcnt lgkmcnt(1)
v_smfmac_f32_16x16x64_f16 v[80:83], v[8:11], a[64:71], v112
s_waitcnt vmcnt(3)
ds_read_b128 v[20:23], v116 offset:5120
v_pk_add_f16 v32, v32, v72
v_smfmac_f32_16x16x64_f16 v[84:87], v[8:11], a[192:199], v112
ds_read_b128 v[24:27], v116 offset:6144
s_waitcnt lgkmcnt(2)
v_pk_add_f16 v33, v33, v73
v_smfmac_f32_16x16x64_f16 v[80:83], v[12:15], a[96:103], v112
ds_read_b128 v[28:31], v116 offset:7168
v_pk_add_f16 v34, v34, v74
v_smfmac_f32_16x16x64_f16 v[84:87], v[12:15], a[224:231], v112
s_waitcnt lgkmcnt(2)
v_pk_add_f16 v35, v35, v75
v_smfmac_f32_16x16x64_f16 v[80:83], v[20:23], a[40:47], v112
ds_write_b128 v116, v[32:35] offset:8192
v_cmp_u_f16 vcc, v32, v34
v_smfmac_f32_16x16x64_f16 v[84:87], v[20:23], a[168:175], v112
s_cbranch_vccnz main_kernel_c0_m2_f
main_kernel_c0_m2:
v_smfmac_f32_16x16x64_f16 v[80:83], v[32:35], a[16:23], v112
buffer_load_dwordx4 v[96:99], v116, s[4:7], s28 offen sc1
v_smfmac_f32_16x16x64_f16 v[84:87], v[32:35], a[144:151], v112
s_add_u32 s28, s28, 0x40000
s_waitcnt lgkmcnt(2)
v_smfmac_f32_16x16x64_f16 v[80:83], v[24:27], a[72:79], v112
s_waitcnt vmcnt(2)
v_pk_add_f16 v48, v48, v76
v_smfmac_f32_16x16x64_f16 v[84:87], v[24:27], a[200:207], v112
s_waitcnt lgkmcnt(0)
s_barrier
ds_read_b128 v[36:39], v116 offset:9216
v_pk_add_f16 v49, v49, v77
v_smfmac_f32_16x16x64_f16 v[80:83], v[28:31], a[104:111], v112
ds_read_b128 v[40:43], v116 offset:10240
v_pk_add_f16 v50, v50, v78
v_smfmac_f32_16x16x64_f16 v[84:87], v[28:31], a[232:239], v112
ds_read_b128 v[44:47], v116 offset:11264
v_pk_add_f16 v51, v51, v79
v_smfmac_f32_16x16x64_f16 v[88:91], v[8:11], v[144:151], v112
ds_write_b128 v116, v[48:51] offset:12288
s_waitcnt lgkmcnt(3)
v_cmp_u_f16 vcc, v48, v50
v_smfmac_f32_16x16x64_f16 v[80:83], v[36:39], a[48:55], v112
s_cbranch_vccnz main_kernel_c0_m3_f
main_kernel_c0_m3:
v_smfmac_f32_16x16x64_f16 v[80:83], v[48:51], a[24:31], v112
v_smfmac_f32_16x16x64_f16 v[84:87], v[48:51], a[152:159], v112
v_smfmac_f32_16x16x64_f16 v[84:87], v[36:39], a[176:183], v112
s_waitcnt lgkmcnt(2)
v_smfmac_f32_16x16x64_f16 v[80:83], v[40:43], a[80:87], v112
s_waitcnt lgkmcnt(0)
s_barrier
ds_read_b128 v[52:55], v116 offset:13312
v_smfmac_f32_16x16x64_f16 v[84:87], v[40:43], a[208:215], v112
s_add_u32 s19, s52, s54
ds_read_b128 v[56:59], v116 offset:14336
v_smfmac_f32_16x16x64_f16 v[80:83], v[44:47], a[112:119], v112
s_add_u32 s18, s18, 0x40000
ds_read_b128 v[60:63], v116 offset:15360
v_smfmac_f32_16x16x64_f16 v[84:87], v[44:47], a[240:247], v112
s_bitset0_b32 s18, 20
s_waitcnt lgkmcnt(2)
v_smfmac_f32_16x16x64_f16 v[80:83], v[52:55], a[56:63], v112
s_cmp_eq_u32 s17, 30
s_cselect_b32 s32, s53, 0x10000
s_waitcnt lgkmcnt(1)
v_smfmac_f32_16x16x64_f16 v[80:83], v[56:59], a[88:95], v112
s_add_u32 s52, s52, s32
s_waitcnt lgkmcnt(0)
v_smfmac_f32_16x16x64_f16 v[80:83], v[60:63], a[120:127], v112
s_sub_u32 s24, 0x20000, s32
ds_read_b128 v[64:67], v116 offset:24576
v_smfmac_f32_16x16x64_f16 v[84:87], v[52:55], a[184:191], v112
s_add_u32 s55, s55, s24
ds_read_b128 v[68:71], v116 offset:28672
v_smfmac_f32_16x16x64_f16 v[84:87], v[56:59], a[216:223], v112
ds_read_b128 v[72:75], v116 offset:25600
s_nop 0
v_cvt_pk_bf16_f32 v92, v80, v81
v_smfmac_f32_16x16x64_f16 v[84:87], v[60:63], a[248:255], v112
ds_read_b128 v[76:79], v116 offset:29696
s_nop 0
v_cvt_pk_bf16_f32 v93, v82, v83
v_smfmac_f32_16x16x64_f16 v[88:91], v[12:15], v[152:159], v112
s_nop 3
v_cvt_pk_bf16_f32 v94, v84, v85
v_cvt_pk_bf16_f32 v95, v86, v87
s_mov_b32 vcc_lo, 0xcccccccc
s_mov_b32 vcc_hi, 0xcccccccc
v_mfma_f32_16x16x32_bf16 v[84:87], v[92:95], v[104:107], 0
v_add_u32 v121, v121, v122
v_writelane_b32 v121, s55, 39
s_nop 0
v_smfmac_f32_16x16x64_f16 v[88:91], v[16:19], v[160:167], v112
s_nop 2
s_cmp_eq_u32 s17, 63
v_cvt_pk_bf16_f32 v114, v84, v85
v_cvt_pk_bf16_f32 v115, v86, v87
buffer_store_dwordx2 v[114:115], v117, s[4:7], s21 offen
s_cbranch_scc1 main_kernel_c0_last
ds_write_b64 v117, v[114:115] offset:16384
v_smfmac_f32_16x16x64_f16 v[88:91], v[20:23], v[168:175], v112
v_smfmac_f32_16x16x64_f16 v[88:91], v[24:27], v[176:183], v112
v_smfmac_f32_16x16x64_f16 v[88:91], v[28:31], v[184:191], v112
v_smfmac_f32_16x16x64_f16 v[88:91], v[32:35], v[192:199], v112
s_waitcnt lgkmcnt(0)
s_barrier
ds_read_b128 v[0:3], v116 offset:16384
v_smfmac_f32_16x16x64_f16 v[88:91], v[36:39], v[200:207], v112
ds_read_b128 v[4:7], v116 offset:17408
v_smfmac_f32_16x16x64_f16 v[88:91], v[40:43], v[208:215], v112
ds_read_b128 v[16:19], v116 offset:26624
v_smfmac_f32_16x16x64_f16 v[88:91], v[44:47], v[216:223], v112
ds_read_b128 v[20:23], v116 offset:30720
v_smfmac_f32_16x16x64_f16 v[88:91], v[48:51], v[224:231], v112
ds_read_b128 v[24:27], v116 offset:27648
v_smfmac_f32_16x16x64_f16 v[88:91], v[52:55], v[232:239], v112
ds_read_b128 v[28:31], v116 offset:31744
v_smfmac_f32_16x16x64_f16 v[88:91], v[56:59], v[240:247], v112
v_smfmac_f32_16x16x64_f16 v[88:91], v[60:63], v[248:255], v112
s_waitcnt lgkmcnt(5)
v_mfma_f32_16x16x32_bf16 v[80:83], v[64:67], v[0:3], 0
v_mfma_f32_16x16x32_bf16 v[84:87], v[68:71], v[0:3], 0
buffer_load_dwordx4 v[8:11], v116, s[4:7], s20 offen offset:0 sc1
v_mfma_f32_16x16x32_bf16 v[92:95], v[0:3], v[0:3], 0
buffer_load_dwordx4 v[12:15], v116, s[4:7], s20 offen offset:1024 sc1
v_permlane32_swap_b32 v88, v90
s_waitcnt lgkmcnt(4)
v_mfma_f32_16x16x32_bf16 v[80:83], v[72:75], v[4:7], v[80:83]
v_permlane32_swap_b32 v89, v91
v_mfma_f32_16x16x32_bf16 v[84:87], v[76:79], v[4:7], v[84:87]
v_pk_add_f32 v[88:89], v[88:89], v[90:91]
v_mfma_f32_16x16x32_bf16 v[92:95], v[4:7], v[4:7], v[92:95]
v_cvt_pk_bf16_f32 v124, v88, v89
v_mov_b32 v65, 0
s_waitcnt lgkmcnt(0)
s_waitcnt vmcnt(1)
v_mfma_f32_16x16x32_bf16 v[88:91], v[8:11], v[8:11], v[92:95]
v_mfma_f32_16x16x32_bf16 v[0:3], v[16:19], v[8:11], v[80:83]
v_cmp_u_f32 s[0:1], v8, v10
v_mfma_f32_16x16x32_bf16 v[4:7], v[20:23], v[8:11], v[84:87]
s_waitcnt vmcnt(0)
v_mfma_f32_16x16x32_bf16 v[88:91], v[12:15], v[12:15], v[88:91]
v_mfma_f32_16x16x32_bf16 v[0:3], v[24:27], v[12:15], v[0:3]
v_cmp_u_f32 s[32:33], v12, v14
v_mfma_f32_16x16x32_bf16 v[4:7], v[28:31], v[12:15], v[4:7]
s_or_b64 s[0:1], s[0:1], s[32:33]
s_cbranch_scc1 main_kernel_c0_z_f
main_kernel_c0_z:
v_mul_f32 v88, s30, v88
v_mul_f32 v89, s30, v89
v_exp_f32 v88, v88
v_exp_f32 v89, v89
v_cndmask_b32_dpp v0, v2, v0, vcc quad_perm:[2,3,2,3] row_mask:0xf bank_mask:0xf
v_cvt_pk_bf16_f32 v64, v88, v89
v_cndmask_b32_dpp v1, v3, v1, vcc quad_perm:[2,3,2,3] row_mask:0xf bank_mask:0xf
v_exp_f32 v0, v0
v_mfma_f32_16x16x16_bf16 v[16:19], v[100:101], v[64:65], 0
v_exp_f32 v1, v1
v_cndmask_b32_dpp v4, v6, v4, vcc quad_perm:[2,3,2,3] row_mask:0xf bank_mask:0xf
v_mfma_f32_16x16x16_bf16 v[8:11], v[124:125], v[64:65], 0
v_cndmask_b32_dpp v5, v7, v5, vcc quad_perm:[2,3,2,3] row_mask:0xf bank_mask:0xf
v_exp_f32 v4, v4
v_exp_f32 v5, v5
v_cvt_pk_bf16_f32 v92, v0, v1
v_cvt_pk_bf16_f32 v94, v4, v5
v_mov_b32 v80, 0
v_mov_b32_dpp v93, v92 quad_perm:[0,1,0,1] row_mask:0xf bank_mask:0xf
v_mov_b32_dpp v95, v94 quad_perm:[0,1,0,1] row_mask:0xf bank_mask:0xf
v_mov_b32 v81, 0
v_mov_b32 v82, 0
v_mfma_f32_16x16x32_bf16 v[16:19], v[100:103], v[92:95], v[16:19]
v_mov_b32 v83, 0
v_mov_b32 v84, 0
v_mfma_f32_16x16x32_bf16 v[8:11], v[96:99], v[92:95], v[8:11]
s_nop 1
v_mov_b32 v85, 0
v_mov_b32 v86, 0
v_mov_b32 v87, 0
v_rcp_f32 v126, v16
v_subrev_u32 v127, 0x21800000, v16
v_cmp_lt_u32 vcc, 0x3c000000, v127
v_pk_mul_f32 v[8:9], v[8:9], v[126:127] op_sel_hi:[1,0]
v_pk_mul_f32 v[10:11], v[10:11], v[126:127] op_sel_hi:[1,0]
s_and_b32 s32, vcc_lo, 0xcccc
v_cvt_pk_bf16_f32 v126, v8, v9
v_cvt_pk_bf16_f32 v127, v10, v11
s_cbranch_scc1 main_kernel_c0_sm_f
main_kernel_c0_ost:
buffer_store_dwordx2 v[126:127], v118, s[4:7], s22 offen
v_cmp_eq_u32 s[0:1], 0, v123
v_mov_b32 v24, -1
v_mov_b32 v25, -1
v_mov_b32 v26, -1
v_mov_b32 v27, -1
ds_read_b128 v[32:35], v113 offset:0
ds_read_b128 v[36:39], v113 offset:1024
ds_read_b128 v[40:43], v113 offset:2048
ds_read_b128 v[44:47], v113 offset:3072
ds_read_b128 v[48:51], v113 offset:4096
ds_read_b128 v[52:55], v113 offset:5120
s_and_b32 s10, s1, 0x3f00
buffer_store_dwordx4 v[24:27], v116, s[4:7], s3 offen
s_barrier
buffer_load_dwordx4 v[0:3], v116, s[4:7], s23 offen sc1
ds_read_b128 v[56:59], v113 offset:6144
ds_read_b128 v[60:63], v113 offset:7168
s_add_u32 s37, s37, 65536
s_add_u32 s26, s26, 65536
s_nop 1
s_xor_b32 s32, s23, 1024
buffer_load_dwordx4 v[4:7], v116, s[4:7], s32 offen sc1
ds_read_b128 v[64:67], v113 offset:8192
ds_read_b128 v[68:71], v113 offset:9216
s_nop 3
s_xor_b32 s32, s23, 2048
buffer_load_dwordx4 v[8:11], v116, s[4:7], s32 offen sc1
ds_read_b128 v[72:75], v113 offset:10240
ds_read_b128 v[76:79], v113 offset:11264
s_nop 3
s_xor_b32 s32, s23, 3072
buffer_load_dwordx4 v[12:15], v116, s[4:7], s32 offen sc1
ds_read_b128 v[88:91], v113 offset:12288
ds_read_b128 v[92:95], v113 offset:13312
s_nop 3
s_xor_b32 s32, s23, 4096
buffer_load_dwordx4 v[16:19], v116, s[4:7], s32 offen sc1
s_nop 7
s_xor_b32 s32, s23, 5120
buffer_load_dwordx4 v[20:23], v116, s[4:7], s32 offen sc1
s_nop 7
s_xor_b32 s32, s23, 6144
buffer_load_dwordx4 v[24:27], v116, s[4:7], s32 offen sc1
s_nop 7
s_xor_b32 s32, s23, 7168
buffer_load_dwordx4 v[28:31], v116, s[4:7], s32 offen sc1
s_waitcnt lgkmcnt(12)
s_waitcnt vmcnt(7)
v_cmp_u_f32 vcc, v0, v2
s_cbranch_vccnz main_kernel_c0_o0_f
main_kernel_c0_o0:
v_smfmac_f32_16x16x64_bf16 v[80:83], v[0:3], v[32:39], v112
ds_read_b128 v[32:35], v113 offset:14336
ds_read_b128 v[36:39], v113 offset:15360
s_waitcnt lgkmcnt(12)
s_waitcnt vmcnt(6)
v_cmp_u_f32 vcc, v4, v6
v_smfmac_f32_16x16x64_bf16 v[84:87], v[0:3], v[40:47], v112
ds_read_b128 v[40:43], v113 offset:16384
ds_read_b128 v[44:47], v113 offset:17408
buffer_store_dwordx2 v[114:115], v119, s[4:7], s37 offen sc1
s_cbranch_vccnz main_kernel_c0_o1_f
main_kernel_c0_o1:
s_waitcnt lgkmcnt(12)
v_smfmac_f32_16x16x64_bf16 v[80:83], v[4:7], v[48:55], v112
ds_read_b128 v[48:51], v113 offset:18432
ds_read_b128 v[52:55], v113 offset:19456
s_waitcnt lgkmcnt(12)
s_waitcnt vmcnt(6)
v_cmp_u_f32 vcc, v8, v10
v_smfmac_f32_16x16x64_bf16 v[84:87], v[4:7], v[56:63], v112
ds_read_b128 v[56:59], v113 offset:20480
ds_read_b128 v[60:63], v113 offset:21504
buffer_store_dword v124, v120, s[4:7], s26 offen sc1
s_cbranch_vccnz main_kernel_c0_o2_f
main_kernel_c0_o2:
s_waitcnt lgkmcnt(12)
v_smfmac_f32_16x16x64_bf16 v[80:83], v[8:11], v[64:71], v112
ds_read_b128 v[64:67], v113 offset:22528
ds_read_b128 v[68:71], v113 offset:23552
s_waitcnt lgkmcnt(12)
s_waitcnt vmcnt(6)
v_cmp_u_f32 vcc, v12, v14
v_smfmac_f32_16x16x64_bf16 v[84:87], v[8:11], v[72:79], v112
ds_read_b128 v[72:75], v113 offset:24576
ds_read_b128 v[76:79], v113 offset:25600
s_cbranch_vccnz main_kernel_c0_o3_f
main_kernel_c0_o3:
s_waitcnt lgkmcnt(12)
v_smfmac_f32_16x16x64_bf16 v[80:83], v[12:15], v[88:95], v112
ds_read_b128 v[88:91], v113 offset:26624
ds_read_b128 v[92:95], v113 offset:27648
s_waitcnt lgkmcnt(12)
s_waitcnt vmcnt(5)
v_cmp_u_f32 vcc, v16, v18
v_smfmac_f32_16x16x64_bf16 v[84:87], v[12:15], v[32:39], v112
ds_read_b128 v[32:35], v113 offset:28672
ds_read_b128 v[36:39], v113 offset:29696
s_cbranch_vccnz main_kernel_c0_o4_f
main_kernel_c0_o4:
s_waitcnt lgkmcnt(12)
v_smfmac_f32_16x16x64_bf16 v[80:83], v[16:19], v[40:47], v112
ds_read_b128 v[40:43], v113 offset:30720
ds_read_b128 v[44:47], v113 offset:31744
s_waitcnt lgkmcnt(12)
s_waitcnt vmcnt(4)
v_cmp_u_f32 vcc, v20, v22
v_smfmac_f32_16x16x64_bf16 v[84:87], v[16:19], v[48:55], v112
s_cbranch_vccnz main_kernel_c0_o5_f
main_kernel_c0_o5:
s_waitcnt lgkmcnt(10)
v_smfmac_f32_16x16x64_bf16 v[80:83], v[20:23], v[56:63], v112
s_waitcnt lgkmcnt(8)
s_waitcnt vmcnt(3)
v_cmp_u_f32 vcc, v24, v26
v_smfmac_f32_16x16x64_bf16 v[84:87], v[20:23], v[64:71], v112
s_cbranch_vccnz main_kernel_c0_o6_f
main_kernel_c0_o6:
s_waitcnt lgkmcnt(6)
v_smfmac_f32_16x16x64_bf16 v[80:83], v[24:27], v[72:79], v112
s_waitcnt lgkmcnt(4)
v_smfmac_f32_16x16x64_bf16 v[84:87], v[24:27], v[88:95], v112
s_waitcnt lgkmcnt(2)
s_waitcnt vmcnt(2)
v_cmp_u_f32 vcc, v28, v30
s_cbranch_vccnz main_kernel_c0_o7_f
main_kernel_c0_o7:
v_smfmac_f32_16x16x64_bf16 v[80:83], v[28:31], v[32:39], v112
s_waitcnt lgkmcnt(0)
v_smfmac_f32_16x16x64_bf16 v[84:87], v[28:31], v[40:47], v112
s_nop 4
v_cvt_pk_bf16_f32 v80, v80, v81
v_cvt_pk_bf16_f32 v81, v82, v83
ds_write_b64 v116, v[80:81] offset:20480
v_cvt_pk_bf16_f32 v82, v84, v85
v_cvt_pk_bf16_f32 v83, v86, v87
ds_write_b64 v116, v[82:83] offset:22528
s_waitcnt lgkmcnt(0)
s_barrier
ds_read_b128 v[72:75], v116 offset:20480
ds_read_b128 v[76:79], v116 offset:21504
s_mov_b32 m0, 24576
s_cmp_lg_u32 s10, 0
s_waitcnt lgkmcnt(1)
v_mfma_f32_16x16x32_bf16 v[64:67], v[72:75], v[108:111], 0
s_waitcnt lgkmcnt(0)
v_mfma_f32_16x16x32_bf16 v[64:67], v[76:79], v[108:111], v[64:67]
s_nop 7
v_cvt_pk_f16_f32 v68, v64, v65
v_cvt_pk_f16_f32 v69, v66, v67
buffer_store_dwordx2 v[68:69], v125, s[4:7], s25 offen sc1
s_cbranch_scc1 main_kernel_c0_kvw
main_kernel_c0_kvok:
s_nop 3
buffer_load_dwordx4 v116, s[4:7], s27 offen sc1 lds
buffer_load_dwordx4 v116, s[4:7], s27 offen offset:1024 sc1 lds
s_add_u32 s27, s27, 0x40000
s_branch main_kernel_c0_top
main_kernel_c0_kvw:
s_mov_b32 exec_lo, 0
s_mov_b32 exec_hi, 0x3f00
v_subrev_u32 v127, 128, v121
main_kernel_c0_kvp:
buffer_load_dword v126, v127, s[4:7], 0 offen sc1
s_waitcnt vmcnt(0)
v_cmp_eq_u32 vcc, 0, v126
s_cbranch_vccz main_kernel_c0_kvp_ok
s_sleep 2
s_sub_u32 s29, s29, 1
s_cbranch_scc0 main_kernel_c0_kvp
s_branch main_kernel_end
main_kernel_c0_kvp_ok:
s_mov_b64 exec, -1
s_branch main_kernel_c0_kvok
main_kernel_c0_last:
s_add_u32 s37, s37, 65536
s_add_u32 s26, s26, 65536
buffer_store_dwordx2 v[114:115], v119, s[4:7], s37 offen sc1
v_smfmac_f32_16x16x64_f16 v[88:91], v[20:23], v[168:175], v112
v_smfmac_f32_16x16x64_f16 v[88:91], v[24:27], v[176:183], v112
v_smfmac_f32_16x16x64_f16 v[88:91], v[28:31], v[184:191], v112
v_smfmac_f32_16x16x64_f16 v[88:91], v[32:35], v[192:199], v112
v_smfmac_f32_16x16x64_f16 v[88:91], v[36:39], v[200:207], v112
v_smfmac_f32_16x16x64_f16 v[88:91], v[40:43], v[208:215], v112
v_smfmac_f32_16x16x64_f16 v[88:91], v[44:47], v[216:223], v112
v_smfmac_f32_16x16x64_f16 v[88:91], v[48:51], v[224:231], v112
v_smfmac_f32_16x16x64_f16 v[88:91], v[52:55], v[232:239], v112
v_smfmac_f32_16x16x64_f16 v[88:91], v[56:59], v[240:247], v112
v_smfmac_f32_16x16x64_f16 v[88:91], v[60:63], v[248:255], v112
s_nop 7
v_permlane32_swap_b32 v88, v90
s_nop 1
v_permlane32_swap_b32 v89, v91
s_nop 1
v_pk_add_f32 v[88:89], v[88:89], v[90:91]
s_nop 1
v_cvt_pk_bf16_f32 v124, v88, v89
s_nop 1
buffer_store_dword v124, v120, s[4:7], s26 offen sc1
s_branch main_kernel_end
main_kernel_c0_m0_f:
s_waitcnt lgkmcnt(0)
buffer_load_dwordx4 v[0:3], v116, s[4:7], s18 offen sc1
buffer_load_dwordx4 v[64:67], v116, s[4:7], s19 offen sc1
s_xor_b32 s32, s18, 1024
buffer_load_dwordx4 v[16:19], v116, s[4:7], s32 offen sc1
s_xor_b32 s32, s19, 1024
buffer_load_dwordx4 v[68:71], v116, s[4:7], s32 offen sc1
s_xor_b32 s32, s18, 2048
buffer_load_dwordx4 v[32:35], v116, s[4:7], s32 offen sc1
s_xor_b32 s32, s19, 2048
buffer_load_dwordx4 v[72:75], v116, s[4:7], s32 offen sc1
s_xor_b32 s32, s18, 3072
buffer_load_dwordx4 v[48:51], v116, s[4:7], s32 offen sc1
s_xor_b32 s32, s19, 3072
buffer_load_dwordx4 v[76:79], v116, s[4:7], s32 offen sc1
s_sub_u32 s29, s29, 1
s_cbranch_scc1 main_kernel_end
s_waitcnt vmcnt(0)
v_max_u32 v126, v0, v2
v_max3_u32 v126, v126, v64, v66
v_cmp_eq_u32 vcc, -1, v126
s_cbranch_vccnz main_kernel_c0_m0_f
v_pk_add_f16 v0, v0, v64
v_pk_add_f16 v1, v1, v65
v_pk_add_f16 v2, v2, v66
v_pk_add_f16 v3, v3, v67
s_nop 0
s_branch main_kernel_c0_m0
main_kernel_c0_m1_f:
s_waitcnt lgkmcnt(0)
s_xor_b32 s32, s18, 1024
buffer_load_dwordx4 v[16:19], v116, s[4:7], s32 offen sc1
s_xor_b32 s32, s19, 1024
buffer_load_dwordx4 v[68:71], v116, s[4:7], s32 offen sc1
s_xor_b32 s32, s18, 2048
buffer_load_dwordx4 v[32:35], v116, s[4:7], s32 offen sc1
s_xor_b32 s32, s19, 2048
buffer_load_dwordx4 v[72:75], v116, s[4:7], s32 offen sc1
s_xor_b32 s32, s18, 3072
buffer_load_dwordx4 v[48:51], v116, s[4:7], s32 offen sc1
s_xor_b32 s32, s19, 3072
buffer_load_dwordx4 v[76:79], v116, s[4:7], s32 offen sc1
s_sub_u32 s29, s29, 1
s_cbranch_scc1 main_kernel_end
s_waitcnt vmcnt(0)
v_max_u32 v126, v16, v18
v_max3_u32 v126, v126, v68, v70
v_cmp_eq_u32 vcc, -1, v126
s_cbranch_vccnz main_kernel_c0_m1_f
v_pk_add_f16 v16, v16, v68
v_pk_add_f16 v17, v17, v69
v_pk_add_f16 v18, v18, v70
v_pk_add_f16 v19, v19, v71
ds_write_b128 v116, v[16:19] offset:4096
s_branch main_kernel_c0_m1
main_kernel_c0_m2_f:
s_waitcnt lgkmcnt(0)
s_xor_b32 s32, s18, 2048
buffer_load_dwordx4 v[32:35], v116, s[4:7], s32 offen sc1
s_xor_b32 s32, s19, 2048
buffer_load_dwordx4 v[72:75], v116, s[4:7], s32 offen sc1
s_xor_b32 s32, s18, 3072
buffer_load_dwordx4 v[48:51], v116, s[4:7], s32 offen sc1
s_xor_b32 s32, s19, 3072
buffer_load_dwordx4 v[76:79], v116, s[4:7], s32 offen sc1
s_sub_u32 s29, s29, 1
s_cbranch_scc1 main_kernel_end
s_waitcnt vmcnt(0)
v_max_u32 v126, v32, v34
v_max3_u32 v126, v126, v72, v74
v_cmp_eq_u32 vcc, -1, v126
s_cbranch_vccnz main_kernel_c0_m2_f
v_pk_add_f16 v32, v32, v72
v_pk_add_f16 v33, v33, v73
v_pk_add_f16 v34, v34, v74
v_pk_add_f16 v35, v35, v75
ds_write_b128 v116, v[32:35] offset:8192
s_branch main_kernel_c0_m2
main_kernel_c0_m3_f:
s_waitcnt lgkmcnt(0)
s_xor_b32 s32, s18, 3072
buffer_load_dwordx4 v[48:51], v116, s[4:7], s32 offen sc1
s_xor_b32 s32, s19, 3072
buffer_load_dwordx4 v[76:79], v116, s[4:7], s32 offen sc1
s_sub_u32 s29, s29, 1
s_cbranch_scc1 main_kernel_end
s_waitcnt vmcnt(0)
v_max_u32 v126, v48, v50
v_max3_u32 v126, v126, v76, v78
v_cmp_eq_u32 vcc, -1, v126
s_cbranch_vccnz main_kernel_c0_m3_f
v_pk_add_f16 v48, v48, v76
v_pk_add_f16 v49, v49, v77
v_pk_add_f16 v50, v50, v78
v_pk_add_f16 v51, v51, v79
ds_write_b128 v116, v[48:51] offset:12288
s_branch main_kernel_c0_m3
main_kernel_c0_z_f:
buffer_load_dwordx4 v[8:11], v116, s[4:7], s20 offen offset:0 sc1
buffer_load_dwordx4 v[12:15], v116, s[4:7], s20 offen offset:1024 sc1
s_memtime s[32:33]
ds_read_b32 v126, v116 offset:18432
s_sub_u32 s34, s19, s54
s_xor_b32 s34, s34, 0x2000
s_lshl_b32 s35, s12, 15
s_add_u32 s34, s34, s35
s_lshl_b32 s35, s13, 8
s_add_u32 s35, s35, s34
s_add_u32 s34, s34, 0x4000
s_waitcnt lgkmcnt(0)
s_sub_u32 s32, s32, 450
v_sub_u32 v127, s32, v126
buffer_store_dword v127, off, s[4:7], s34
s_sub_u32 s29, s29, 1
s_cbranch_scc1 main_kernel_end
s_waitcnt vmcnt(1)
main_kernel_c0_z_g:
v_max_u32 v126, v8, v10
v_max3_u32 v126, v126, v12, v14
v_cmp_eq_u32 vcc, -1, v126
s_cbranch_vccnz main_kernel_c0_z_h
v_mfma_f32_16x16x32_bf16 v[88:91], v[8:11], v[8:11], v[92:95]
v_mfma_f32_16x16x32_bf16 v[0:3], v[16:19], v[8:11], v[80:83]
v_mfma_f32_16x16x32_bf16 v[4:7], v[20:23], v[8:11], v[84:87]
v_mfma_f32_16x16x32_bf16 v[88:91], v[12:15], v[12:15], v[88:91]
v_mfma_f32_16x16x32_bf16 v[0:3], v[24:27], v[12:15], v[0:3]
v_mfma_f32_16x16x32_bf16 v[4:7], v[28:31], v[12:15], v[4:7]
buffer_store_dword v127, off, s[4:7], s35 offset:132 sc1
s_mov_b32 vcc_lo, 0xcccccccc
s_mov_b32 vcc_hi, 0xcccccccc
s_branch main_kernel_c0_z
main_kernel_c0_z_h:
buffer_load_dwordx4 v[8:11], v116, s[4:7], s20 offen offset:0 sc1
buffer_load_dwordx4 v[12:15], v116, s[4:7], s20 offen offset:1024 sc1
s_sub_u32 s29, s29, 1
s_cbranch_scc1 main_kernel_end
v_add_u32 v127, 300, v127
s_waitcnt vmcnt(0)
s_branch main_kernel_c0_z_g
main_kernel_c0_sm_f:
s_waitcnt vmcnt(0) lgkmcnt(0)
buffer_load_dwordx4 v[8:11], v116, s[4:7], s20 offen offset:0 sc1
buffer_load_dwordx4 v[12:15], v116, s[4:7], s20 offen offset:1024 sc1
ds_read_b128 v[0:3], v116 offset:16384
ds_read_b128 v[4:7], v116 offset:17408
ds_read_b128 v[64:67], v116 offset:24576
ds_read_b128 v[68:71], v116 offset:28672
ds_read_b128 v[72:75], v116 offset:25600
ds_read_b128 v[76:79], v116 offset:29696
ds_read_b128 v[16:19], v116 offset:26624
ds_read_b128 v[20:23], v116 offset:30720
ds_read_b128 v[24:27], v116 offset:27648
ds_read_b128 v[28:31], v116 offset:31744
s_waitcnt vmcnt(0)
s_waitcnt lgkmcnt(0)
v_mfma_f32_16x16x32_bf16 v[80:83], v[64:67], v[0:3], 0
v_mfma_f32_16x16x32_bf16 v[84:87], v[68:71], v[0:3], 0
v_mfma_f32_16x16x32_bf16 v[92:95], v[0:3], v[0:3], 0
v_mfma_f32_16x16x32_bf16 v[80:83], v[72:75], v[4:7], v[80:83]
v_mfma_f32_16x16x32_bf16 v[84:87], v[76:79], v[4:7], v[84:87]
v_mfma_f32_16x16x32_bf16 v[92:95], v[4:7], v[4:7], v[92:95]
v_mfma_f32_16x16x32_bf16 v[0:3], v[16:19], v[8:11], v[80:83]
v_mfma_f32_16x16x32_bf16 v[4:7], v[20:23], v[8:11], v[84:87]
v_mfma_f32_16x16x32_bf16 v[88:91], v[8:11], v[8:11], v[92:95]
v_mfma_f32_16x16x32_bf16 v[0:3], v[24:27], v[12:15], v[0:3]
v_mfma_f32_16x16x32_bf16 v[4:7], v[28:31], v[12:15], v[4:7]
v_mfma_f32_16x16x32_bf16 v[88:91], v[12:15], v[12:15], v[88:91]
s_nop 7
v_mov_b32 v65, 0
v_max_f32 v126, v88, v89
v_mul_f32 v126, s30, v126
v_max3_f32 v126, v126, v0, v1
v_max3_f32 v126, v126, v2, v3
v_max3_f32 v126, v126, v4, v5
v_max3_f32 v126, v126, v6, v7
v_mov_b32 v127, v126
s_nop 1
v_permlane32_swap_b32 v126, v127
v_max_f32 v126, v126, v127
v_mov_b32 v127, v126
s_nop 1
v_permlane16_swap_b32 v126, v127
v_max_f32 v126, v126, v127
v_mul_f32 v127, 0x40faf233, v126
s_mov_b32 vcc_lo, 0xcccccccc
s_mov_b32 vcc_hi, 0xcccccccc
v_sub_f32 v0, v0, v126
v_sub_f32 v1, v1, v126
v_sub_f32 v2, v2, v126
v_sub_f32 v3, v3, v126
v_sub_f32 v4, v4, v126
v_sub_f32 v5, v5, v126
v_sub_f32 v6, v6, v126
v_sub_f32 v7, v7, v126
v_sub_f32 v88, v88, v127
v_sub_f32 v89, v89, v127
s_waitcnt lgkmcnt(0)
s_nop 0
v_mul_f32 v88, s30, v88
v_mul_f32 v89, s30, v89
v_exp_f32 v88, v88
v_exp_f32 v89, v89
v_cndmask_b32_dpp v0, v2, v0, vcc quad_perm:[2,3,2,3] row_mask:0xf bank_mask:0xf
v_cvt_pk_bf16_f32 v64, v88, v89
v_cndmask_b32_dpp v1, v3, v1, vcc quad_perm:[2,3,2,3] row_mask:0xf bank_mask:0xf
v_exp_f32 v0, v0
v_mfma_f32_16x16x16_bf16 v[16:19], v[100:101], v[64:65], 0
v_exp_f32 v1, v1
v_cndmask_b32_dpp v4, v6, v4, vcc quad_perm:[2,3,2,3] row_mask:0xf bank_mask:0xf
v_mfma_f32_16x16x16_bf16 v[8:11], v[124:125], v[64:65], 0
v_cndmask_b32_dpp v5, v7, v5, vcc quad_perm:[2,3,2,3] row_mask:0xf bank_mask:0xf
v_exp_f32 v4, v4
v_exp_f32 v5, v5
v_cvt_pk_bf16_f32 v92, v0, v1
v_cvt_pk_bf16_f32 v94, v4, v5
v_mov_b32 v80, 0
v_mov_b32_dpp v93, v92 quad_perm:[0,1,0,1] row_mask:0xf bank_mask:0xf
v_mov_b32_dpp v95, v94 quad_perm:[0,1,0,1] row_mask:0xf bank_mask:0xf
v_mov_b32 v81, 0
v_mov_b32 v82, 0
v_mfma_f32_16x16x32_bf16 v[16:19], v[100:103], v[92:95], v[16:19]
v_mov_b32 v83, 0
v_mov_b32 v84, 0
v_mfma_f32_16x16x32_bf16 v[8:11], v[96:99], v[92:95], v[8:11]
s_nop 1
v_mov_b32 v85, 0
v_mov_b32 v86, 0
v_mov_b32 v87, 0
v_rcp_f32 v126, v16
v_subrev_u32 v127, 0x21800000, v16
v_cmp_lt_u32 vcc, 0x3c000000, v127
v_pk_mul_f32 v[8:9], v[8:9], v[126:127] op_sel_hi:[1,0]
v_pk_mul_f32 v[10:11], v[10:11], v[126:127] op_sel_hi:[1,0]
s_and_b32 s32, vcc_lo, 0xcccc
v_cvt_pk_bf16_f32 v126, v8, v9
v_cvt_pk_bf16_f32 v127, v10, v11
s_branch main_kernel_c0_ost
main_kernel_c0_o0_f:
s_nop 0
buffer_load_dwordx4 v[0:3], v116, s[4:7], s23 offen sc1
s_xor_b32 s32, s23, 1024
buffer_load_dwordx4 v[4:7], v116, s[4:7], s32 offen sc1
s_sub_u32 s29, s29, 1
s_cbranch_scc1 main_kernel_end
s_waitcnt vmcnt(0)
v_max_u32 v126, v0, v2
v_cmp_eq_u32 vcc, -1, v126
s_cbranch_vccnz main_kernel_c0_o0_f
s_branch main_kernel_c0_o0
main_kernel_c0_o1_f:
s_nop 0
s_xor_b32 s32, s23, 1024
buffer_load_dwordx4 v[4:7], v116, s[4:7], s32 offen sc1
s_xor_b32 s32, s23, 2048
buffer_load_dwordx4 v[8:11], v116, s[4:7], s32 offen sc1
s_sub_u32 s29, s29, 1
s_cbranch_scc1 main_kernel_end
s_waitcnt vmcnt(0)
v_max_u32 v126, v4, v6
v_cmp_eq_u32 vcc, -1, v126
s_cbranch_vccnz main_kernel_c0_o1_f
s_branch main_kernel_c0_o1
main_kernel_c0_o2_f:
s_nop 0
s_xor_b32 s32, s23, 2048
buffer_load_dwordx4 v[8:11], v116, s[4:7], s32 offen sc1
s_xor_b32 s32, s23, 3072
buffer_load_dwordx4 v[12:15], v116, s[4:7], s32 offen sc1
s_sub_u32 s29, s29, 1
s_cbranch_scc1 main_kernel_end
s_waitcnt vmcnt(0)
v_max_u32 v126, v8, v10
v_cmp_eq_u32 vcc, -1, v126
s_cbranch_vccnz main_kernel_c0_o2_f
s_branch main_kernel_c0_o2
main_kernel_c0_o3_f:
s_nop 0
s_xor_b32 s32, s23, 3072
buffer_load_dwordx4 v[12:15], v116, s[4:7], s32 offen sc1
s_xor_b32 s32, s23, 4096
buffer_load_dwordx4 v[16:19], v116, s[4:7], s32 offen sc1
s_sub_u32 s29, s29, 1
s_cbranch_scc1 main_kernel_end
s_waitcnt vmcnt(0)
v_max_u32 v126, v12, v14
v_cmp_eq_u32 vcc, -1, v126
s_cbranch_vccnz main_kernel_c0_o3_f
s_branch main_kernel_c0_o3
main_kernel_c0_o4_f:
s_nop 0
s_xor_b32 s32, s23, 4096
buffer_load_dwordx4 v[16:19], v116, s[4:7], s32 offen sc1
s_xor_b32 s32, s23, 5120
buffer_load_dwordx4 v[20:23], v116, s[4:7], s32 offen sc1
s_sub_u32 s29, s29, 1
s_cbranch_scc1 main_kernel_end
s_waitcnt vmcnt(0)
v_max_u32 v126, v16, v18
v_cmp_eq_u32 vcc, -1, v126
s_cbranch_vccnz main_kernel_c0_o4_f
s_branch main_kernel_c0_o4
main_kernel_c0_o5_f:
s_nop 0
s_xor_b32 s32, s23, 5120
buffer_load_dwordx4 v[20:23], v116, s[4:7], s32 offen sc1
s_xor_b32 s32, s23, 6144
buffer_load_dwordx4 v[24:27], v116, s[4:7], s32 offen sc1
s_sub_u32 s29, s29, 1
s_cbranch_scc1 main_kernel_end
s_waitcnt vmcnt(0)
v_max_u32 v126, v20, v22
v_cmp_eq_u32 vcc, -1, v126
s_cbranch_vccnz main_kernel_c0_o5_f
s_branch main_kernel_c0_o5
main_kernel_c0_o6_f:
s_nop 0
s_xor_b32 s32, s23, 6144
buffer_load_dwordx4 v[24:27], v116, s[4:7], s32 offen sc1
s_xor_b32 s32, s23, 7168
buffer_load_dwordx4 v[28:31], v116, s[4:7], s32 offen sc1
s_sub_u32 s29, s29, 1
s_cbranch_scc1 main_kernel_end
s_waitcnt vmcnt(0)
v_max_u32 v126, v24, v26
v_cmp_eq_u32 vcc, -1, v126
s_cbranch_vccnz main_kernel_c0_o6_f
s_branch main_kernel_c0_o6
main_kernel_c0_o7_f:
s_nop 0
s_xor_b32 s32, s23, 7168
buffer_load_dwordx4 v[28:31], v116, s[4:7], s32 offen sc1
s_sub_u32 s29, s29, 1
s_cbranch_scc1 main_kernel_end
s_waitcnt vmcnt(0)
v_max_u32 v126, v28, v30
v_cmp_eq_u32 vcc, -1, v126
s_cbranch_vccnz main_kernel_c0_o7_f
s_branch main_kernel_c0_o7
.p2align 6
main_kernel_c1_top:
s_barrier
buffer_load_dwordx4 v[0:3], v116, s[4:7], s18 offen sc1
s_add_u32 s20, s20, 0x40000
s_bitset0_b32 s20, 20
s_add_u32 s21, s21, 0x40000
s_bitset0_b32 s21, 20
s_add_u32 s22, s22, 0x40000
s_bitset0_b32 s22, 20
s_add_u32 s23, s23, 0x40000
s_bitset0_b32 s23, 20
s_xor_b32 s32, s18, 1024
buffer_load_dwordx4 v[16:19], v116, s[4:7], s32 offen sc1
s_add_u32 s3, s3, 0x40000
s_bitset0_b32 s3, 20
s_add_u32 s17, s17, 1
s_bitcmp1_b32 0x77777777, s17
s_cselect_b32 s33, 0x800, 0
s_xor_b32 s54, s54, s33
s_xor_b32 s59, s59, s33
s_add_u32 s25, s52, s59
s_nop 0
buffer_load_dwordx4 v[64:67], v116, s[4:7], s19 offen sc1
v_mov_b32 v80, 0
v_mov_b32 v81, 0
s_nop 3
s_xor_b32 s32, s19, 1024
buffer_load_dwordx4 v[68:71], v116, s[4:7], s32 offen sc1
v_mov_b32 v82, 0
v_mov_b32 v83, 0
s_nop 3
s_xor_b32 s32, s18, 2048
buffer_load_dwordx4 v[32:35], v116, s[4:7], s32 offen sc1
v_mov_b32 v84, 0
v_mov_b32 v85, 0
s_nop 3
s_xor_b32 s32, s19, 2048
buffer_load_dwordx4 v[72:75], v116, s[4:7], s32 offen sc1
v_mov_b32 v86, 0
v_mov_b32 v87, 0
s_nop 3
s_xor_b32 s32, s18, 3072
buffer_load_dwordx4 v[48:51], v116, s[4:7], s32 offen sc1
v_mov_b32 v88, 0
v_mov_b32 v89, 0
s_nop 3
s_xor_b32 s32, s19, 3072
buffer_load_dwordx4 v[76:79], v116, s[4:7], s32 offen sc1
v_mov_b32 v90, 0
v_mov_b32 v91, 0
s_waitcnt vmcnt(5)
v_pk_add_f16 v0, v0, v64
v_pk_add_f16 v1, v1, v65
v_pk_add_f16 v2, v2, v66
v_pk_add_f16 v3, v3, v67
v_cmp_u_f16 vcc, v0, v2
s_cbranch_vccnz main_kernel_c1_m0_f
main_kernel_c1_m0:
v_smfmac_f32_16x16x64_f16 v[80:83], v[0:3], a[0:7], v112
ds_write_b128 v116, v[0:3] offset:1024
v_smfmac_f32_16x16x64_f16 v[84:87], v[0:3], a[128:135], v112
buffer_load_dword v123, v121, s[4:7], 0 offen sc1
s_waitcnt vmcnt(5)
v_pk_add_f16 v16, v16, v68
v_pk_add_f16 v17, v17, v69
v_pk_add_f16 v18, v18, v70
v_pk_add_f16 v19, v19, v71
v_cmp_u_f16 vcc, v16, v18
s_waitcnt lgkmcnt(0)
s_barrier
ds_read_b128 v[4:7], v116 offset:0
ds_write_b128 v116, v[16:19] offset:5120
s_cbranch_vccnz main_kernel_c1_m1_f
main_kernel_c1_m1:
v_smfmac_f32_16x16x64_f16 v[80:83], v[16:19], a[8:15], v112
v_smfmac_f32_16x16x64_f16 v[84:87], v[16:19], a[136:143], v112
ds_read_b128 v[8:11], v116 offset:3072
v_smfmac_f32_16x16x64_f16 v[88:91], v[0:3], v[128:135], v112
ds_read_b128 v[12:15], v116 offset:2048
s_waitcnt lgkmcnt(3)
v_smfmac_f32_16x16x64_f16 v[80:83], v[4:7], a[32:39], v112
v_smfmac_f32_16x16x64_f16 v[84:87], v[4:7], a[160:167], v112
v_smfmac_f32_16x16x64_f16 v[88:91], v[4:7], v[136:143], v112
s_waitcnt lgkmcnt(2)
s_barrier
s_waitcnt lgkmcnt(1)
v_smfmac_f32_16x16x64_f16 v[80:83], v[8:11], a[64:71], v112
s_waitcnt vmcnt(3)
ds_read_b128 v[20:23], v116 offset:4096
v_pk_add_f16 v32, v32, v72
v_smfmac_f32_16x16x64_f16 v[84:87], v[8:11], a[192:199], v112
ds_read_b128 v[24:27], v116 offset:7168
s_waitcnt lgkmcnt(2)
v_pk_add_f16 v33, v33, v73
v_smfmac_f32_16x16x64_f16 v[80:83], v[12:15], a[96:103], v112
ds_read_b128 v[28:31], v116 offset:6144
v_pk_add_f16 v34, v34, v74
v_smfmac_f32_16x16x64_f16 v[84:87], v[12:15], a[224:231], v112
s_waitcnt lgkmcnt(2)
v_pk_add_f16 v35, v35, v75
v_smfmac_f32_16x16x64_f16 v[80:83], v[20:23], a[40:47], v112
ds_write_b128 v116, v[32:35] offset:9216
v_cmp_u_f16 vcc, v32, v34
v_smfmac_f32_16x16x64_f16 v[84:87], v[20:23], a[168:175], v112
s_cbranch_vccnz main_kernel_c1_m2_f
main_kernel_c1_m2:
v_smfmac_f32_16x16x64_f16 v[80:83], v[32:35], a[16:23], v112
buffer_load_dwordx4 v[96:99], v116, s[4:7], s28 offen sc1
v_smfmac_f32_16x16x64_f16 v[84:87], v[32:35], a[144:151], v112
s_add_u32 s28, s28, 0x40000
s_waitcnt lgkmcnt(2)
v_smfmac_f32_16x16x64_f16 v[80:83], v[24:27], a[72:79], v112
s_waitcnt vmcnt(2)
v_pk_add_f16 v48, v48, v76
v_smfmac_f32_16x16x64_f16 v[84:87], v[24:27], a[200:207], v112
s_waitcnt lgkmcnt(0)
s_barrier
ds_read_b128 v[36:39], v116 offset:8192
v_pk_add_f16 v49, v49, v77
v_smfmac_f32_16x16x64_f16 v[80:83], v[28:31], a[104:111], v112
ds_read_b128 v[40:43], v116 offset:11264
v_pk_add_f16 v50, v50, v78
v_smfmac_f32_16x16x64_f16 v[84:87], v[28:31], a[232:239], v112
ds_read_b128 v[44:47], v116 offset:10240
v_pk_add_f16 v51, v51, v79
v_smfmac_f32_16x16x64_f16 v[88:91], v[8:11], v[144:151], v112
ds_write_b128 v116, v[48:51] offset:13312
s_waitcnt lgkmcnt(3)
v_cmp_u_f16 vcc, v48, v50
v_smfmac_f32_16x16x64_f16 v[80:83], v[36:39], a[48:55], v112
s_cbranch_vccnz main_kernel_c1_m3_f
main_kernel_c1_m3:
v_smfmac_f32_16x16x64_f16 v[80:83], v[48:51], a[24:31], v112
v_smfmac_f32_16x16x64_f16 v[84:87], v[48:51], a[152:159], v112
v_smfmac_f32_16x16x64_f16 v[84:87], v[36:39], a[176:183], v112
s_waitcnt lgkmcnt(2)
v_smfmac_f32_16x16x64_f16 v[80:83], v[40:43], a[80:87], v112
s_waitcnt lgkmcnt(0)
s_barrier
ds_read_b128 v[52:55], v116 offset:12288
v_smfmac_f32_16x16x64_f16 v[84:87], v[40:43], a[208:215], v112
s_add_u32 s19, s52, s54
ds_read_b128 v[56:59], v116 offset:15360
v_smfmac_f32_16x16x64_f16 v[80:83], v[44:47], a[112:119], v112
s_add_u32 s18, s18, 0x40000
ds_read_b128 v[60:63], v116 offset:14336
v_smfmac_f32_16x16x64_f16 v[84:87], v[44:47], a[240:247], v112
s_bitset0_b32 s18, 20
s_waitcnt lgkmcnt(2)
v_smfmac_f32_16x16x64_f16 v[80:83], v[52:55], a[56:63], v112
s_cmp_eq_u32 s17, 30
s_cselect_b32 s32, s53, 0x10000
s_waitcnt lgkmcnt(1)
v_smfmac_f32_16x16x64_f16 v[80:83], v[56:59], a[88:95], v112
s_add_u32 s52, s52, s32
s_waitcnt lgkmcnt(0)
v_smfmac_f32_16x16x64_f16 v[80:83], v[60:63], a[120:127], v112
s_sub_u32 s24, 0x20000, s32
ds_read_b128 v[64:67], v116 offset:24576
v_smfmac_f32_16x16x64_f16 v[84:87], v[52:55], a[184:191], v112
s_add_u32 s55, s55, s24
ds_read_b128 v[68:71], v116 offset:28672
v_smfmac_f32_16x16x64_f16 v[84:87], v[56:59], a[216:223], v112
ds_read_b128 v[72:75], v116 offset:25600
s_nop 0
v_cvt_pk_bf16_f32 v92, v80, v81
v_smfmac_f32_16x16x64_f16 v[84:87], v[60:63], a[248:255], v112
ds_read_b128 v[76:79], v116 offset:29696
s_nop 0
v_cvt_pk_bf16_f32 v93, v82, v83
v_smfmac_f32_16x16x64_f16 v[88:91], v[12:15], v[152:159], v112
s_nop 3
v_cvt_pk_bf16_f32 v94, v84, v85
v_cvt_pk_bf16_f32 v95, v86, v87
s_mov_b32 vcc_lo, 0xcccccccc
s_mov_b32 vcc_hi, 0xcccccccc
v_mfma_f32_16x16x32_bf16 v[84:87], v[92:95], v[104:107], 0
v_add_u32 v121, v121, v122
v_writelane_b32 v121, s55, 39
s_nop 0
v_smfmac_f32_16x16x64_f16 v[88:91], v[16:19], v[160:167], v112
s_nop 2
s_cmp_eq_u32 s17, 63
v_cvt_pk_bf16_f32 v114, v84, v85
v_cvt_pk_bf16_f32 v115, v86, v87
buffer_store_dwordx2 v[114:115], v117, s[4:7], s21 offen
s_cbranch_scc1 main_kernel_c1_last
ds_write_b64 v117, v[114:115] offset:16896
v_smfmac_f32_16x16x64_f16 v[88:91], v[20:23], v[168:175], v112
v_smfmac_f32_16x16x64_f16 v[88:91], v[24:27], v[176:183], v112
v_smfmac_f32_16x16x64_f16 v[88:91], v[28:31], v[184:191], v112
v_smfmac_f32_16x16x64_f16 v[88:91], v[32:35], v[192:199], v112
s_waitcnt lgkmcnt(0)
s_barrier
ds_read_b128 v[0:3], v116 offset:16384
v_smfmac_f32_16x16x64_f16 v[88:91], v[36:39], v[200:207], v112
ds_read_b128 v[4:7], v116 offset:17408
v_smfmac_f32_16x16x64_f16 v[88:91], v[40:43], v[208:215], v112
ds_read_b128 v[16:19], v116 offset:26624
v_smfmac_f32_16x16x64_f16 v[88:91], v[44:47], v[216:223], v112
ds_read_b128 v[20:23], v116 offset:30720
v_smfmac_f32_16x16x64_f16 v[88:91], v[48:51], v[224:231], v112
ds_read_b128 v[24:27], v116 offset:27648
v_smfmac_f32_16x16x64_f16 v[88:91], v[52:55], v[232:239], v112
ds_read_b128 v[28:31], v116 offset:31744
v_smfmac_f32_16x16x64_f16 v[88:91], v[56:59], v[240:247], v112
v_smfmac_f32_16x16x64_f16 v[88:91], v[60:63], v[248:255], v112
s_waitcnt lgkmcnt(5)
v_mfma_f32_16x16x32_bf16 v[80:83], v[64:67], v[0:3], 0
v_mfma_f32_16x16x32_bf16 v[84:87], v[68:71], v[0:3], 0
buffer_load_dwordx4 v[8:11], v116, s[4:7], s20 offen offset:0 sc1
v_mfma_f32_16x16x32_bf16 v[92:95], v[0:3], v[0:3], 0
buffer_load_dwordx4 v[12:15], v116, s[4:7], s20 offen offset:1024 sc1
v_permlane32_swap_b32 v88, v90
s_waitcnt lgkmcnt(4)
v_mfma_f32_16x16x32_bf16 v[80:83], v[72:75], v[4:7], v[80:83]
v_permlane32_swap_b32 v89, v91
v_mfma_f32_16x16x32_bf16 v[84:87], v[76:79], v[4:7], v[84:87]
v_pk_add_f32 v[88:89], v[88:89], v[90:91]
v_mfma_f32_16x16x32_bf16 v[92:95], v[4:7], v[4:7], v[92:95]
v_cvt_pk_bf16_f32 v124, v88, v89
v_mov_b32 v65, 0
s_waitcnt lgkmcnt(0)
s_waitcnt vmcnt(1)
v_mfma_f32_16x16x32_bf16 v[88:91], v[8:11], v[8:11], v[92:95]
v_mfma_f32_16x16x32_bf16 v[0:3], v[16:19], v[8:11], v[80:83]
v_cmp_u_f32 s[0:1], v8, v10
v_mfma_f32_16x16x32_bf16 v[4:7], v[20:23], v[8:11], v[84:87]
s_waitcnt vmcnt(0)
v_mfma_f32_16x16x32_bf16 v[88:91], v[12:15], v[12:15], v[88:91]
v_mfma_f32_16x16x32_bf16 v[0:3], v[24:27], v[12:15], v[0:3]
v_cmp_u_f32 s[32:33], v12, v14
v_mfma_f32_16x16x32_bf16 v[4:7], v[28:31], v[12:15], v[4:7]
s_or_b64 s[0:1], s[0:1], s[32:33]
s_cbranch_scc1 main_kernel_c1_z_f
main_kernel_c1_z:
v_mul_f32 v88, s30, v88
v_mul_f32 v89, s30, v89
v_exp_f32 v88, v88
v_exp_f32 v89, v89
v_cndmask_b32_dpp v0, v2, v0, vcc quad_perm:[2,3,2,3] row_mask:0xf bank_mask:0xf
v_cvt_pk_bf16_f32 v64, v88, v89
v_cndmask_b32_dpp v1, v3, v1, vcc quad_perm:[2,3,2,3] row_mask:0xf bank_mask:0xf
v_exp_f32 v0, v0
v_mfma_f32_16x16x16_bf16 v[16:19], v[100:101], v[64:65], 0
v_exp_f32 v1, v1
v_cndmask_b32_dpp v4, v6, v4, vcc quad_perm:[2,3,2,3] row_mask:0xf bank_mask:0xf
v_mfma_f32_16x16x16_bf16 v[8:11], v[124:125], v[64:65], 0
v_cndmask_b32_dpp v5, v7, v5, vcc quad_perm:[2,3,2,3] row_mask:0xf bank_mask:0xf
v_exp_f32 v4, v4
v_exp_f32 v5, v5
v_cvt_pk_bf16_f32 v92, v0, v1
v_cvt_pk_bf16_f32 v94, v4, v5
v_mov_b32 v80, 0
v_mov_b32_dpp v93, v92 quad_perm:[0,1,0,1] row_mask:0xf bank_mask:0xf
v_mov_b32_dpp v95, v94 quad_perm:[0,1,0,1] row_mask:0xf bank_mask:0xf
v_mov_b32 v81, 0
v_mov_b32 v82, 0
v_mfma_f32_16x16x32_bf16 v[16:19], v[100:103], v[92:95], v[16:19]
v_mov_b32 v83, 0
v_mov_b32 v84, 0
v_mfma_f32_16x16x32_bf16 v[8:11], v[96:99], v[92:95], v[8:11]
s_nop 1
v_mov_b32 v85, 0
v_mov_b32 v86, 0
v_mov_b32 v87, 0
v_rcp_f32 v126, v16
v_subrev_u32 v127, 0x21800000, v16
v_cmp_lt_u32 vcc, 0x3c000000, v127
v_pk_mul_f32 v[8:9], v[8:9], v[126:127] op_sel_hi:[1,0]
v_pk_mul_f32 v[10:11], v[10:11], v[126:127] op_sel_hi:[1,0]
s_and_b32 s32, vcc_lo, 0xcccc
v_cvt_pk_bf16_f32 v126, v8, v9
v_cvt_pk_bf16_f32 v127, v10, v11
s_cbranch_scc1 main_kernel_c1_sm_f
main_kernel_c1_ost:
buffer_store_dwordx2 v[126:127], v118, s[4:7], s22 offen
v_cmp_eq_u32 s[0:1], 0, v123
v_mov_b32 v24, -1
v_mov_b32 v25, -1
v_mov_b32 v26, -1
v_mov_b32 v27, -1
ds_read_b128 v[32:35], v113 offset:0
ds_read_b128 v[36:39], v113 offset:1024
ds_read_b128 v[40:43], v113 offset:2048
ds_read_b128 v[44:47], v113 offset:3072
ds_read_b128 v[48:51], v113 offset:4096
ds_read_b128 v[52:55], v113 offset:5120
s_and_b32 s10, s1, 0x3f00
buffer_store_dwordx4 v[24:27], v116, s[4:7], s3 offen
buffer_store_dwordx4 v[24:27], v116, s[4:7], s46 offen
s_barrier
buffer_load_dwordx4 v[0:3], v116, s[4:7], s23 offen sc1
ds_read_b128 v[56:59], v113 offset:6144
ds_read_b128 v[60:63], v113 offset:7168
s_add_u32 s46, s46, 0x40000
s_bitset0_b32 s46, 20
s_add_u32 s37, s37, 65536
s_add_u32 s26, s26, 65536
s_xor_b32 s32, s23, 1024
buffer_load_dwordx4 v[4:7], v116, s[4:7], s32 offen sc1
ds_read_b128 v[64:67], v113 offset:8192
ds_read_b128 v[68:71], v113 offset:9216
s_nop 3
s_xor_b32 s32, s23, 2048
buffer_load_dwordx4 v[8:11], v116, s[4:7], s32 offen sc1
ds_read_b128 v[72:75], v113 offset:10240
ds_read_b128 v[76:79], v113 offset:11264
s_nop 3
s_xor_b32 s32, s23, 3072
buffer_load_dwordx4 v[12:15], v116, s[4:7], s32 offen sc1
ds_read_b128 v[88:91], v113 offset:12288
ds_read_b128 v[92:95], v113 offset:13312
s_nop 3
s_xor_b32 s32, s23, 4096
buffer_load_dwordx4 v[16:19], v116, s[4:7], s32 offen sc1
s_nop 7
s_xor_b32 s32, s23, 5120
buffer_load_dwordx4 v[20:23], v116, s[4:7], s32 offen sc1
s_nop 7
s_xor_b32 s32, s23, 6144
buffer_load_dwordx4 v[24:27], v116, s[4:7], s32 offen sc1
s_nop 7
s_xor_b32 s32, s23, 7168
buffer_load_dwordx4 v[28:31], v116, s[4:7], s32 offen sc1
s_waitcnt lgkmcnt(12)
s_waitcnt vmcnt(7)
v_cmp_u_f32 vcc, v0, v2
s_cbranch_vccnz main_kernel_c1_o0_f
main_kernel_c1_o0:
v_smfmac_f32_16x16x64_bf16 v[80:83], v[0:3], v[32:39], v112
ds_read_b128 v[32:35], v113 offset:14336
ds_read_b128 v[36:39], v113 offset:15360
s_waitcnt lgkmcnt(12)
s_waitcnt vmcnt(6)
v_cmp_u_f32 vcc, v4, v6
v_smfmac_f32_16x16x64_bf16 v[84:87], v[0:3], v[40:47], v112
ds_read_b128 v[40:43], v113 offset:16384
ds_read_b128 v[44:47], v113 offset:17408
buffer_store_dwordx2 v[114:115], v119, s[4:7], s37 offen sc1
s_cbranch_vccnz main_kernel_c1_o1_f
main_kernel_c1_o1:
s_waitcnt lgkmcnt(12)
v_smfmac_f32_16x16x64_bf16 v[80:83], v[4:7], v[48:55], v112
ds_read_b128 v[48:51], v113 offset:18432
ds_read_b128 v[52:55], v113 offset:19456
s_waitcnt lgkmcnt(12)
s_waitcnt vmcnt(6)
v_cmp_u_f32 vcc, v8, v10
v_smfmac_f32_16x16x64_bf16 v[84:87], v[4:7], v[56:63], v112
ds_read_b128 v[56:59], v113 offset:20480
ds_read_b128 v[60:63], v113 offset:21504
buffer_store_dword v124, v120, s[4:7], s26 offen sc1
s_cbranch_vccnz main_kernel_c1_o2_f
main_kernel_c1_o2:
s_waitcnt lgkmcnt(12)
v_smfmac_f32_16x16x64_bf16 v[80:83], v[8:11], v[64:71], v112
ds_read_b128 v[64:67], v113 offset:22528
ds_read_b128 v[68:71], v113 offset:23552
s_waitcnt lgkmcnt(12)
s_waitcnt vmcnt(6)
v_cmp_u_f32 vcc, v12, v14
v_smfmac_f32_16x16x64_bf16 v[84:87], v[8:11], v[72:79], v112
ds_read_b128 v[72:75], v113 offset:24576
ds_read_b128 v[76:79], v113 offset:25600
s_cbranch_vccnz main_kernel_c1_o3_f
main_kernel_c1_o3:
s_waitcnt lgkmcnt(12)
v_smfmac_f32_16x16x64_bf16 v[80:83], v[12:15], v[88:95], v112
ds_read_b128 v[88:91], v113 offset:26624
ds_read_b128 v[92:95], v113 offset:27648
s_waitcnt lgkmcnt(12)
s_waitcnt vmcnt(5)
v_cmp_u_f32 vcc, v16, v18
v_smfmac_f32_16x16x64_bf16 v[84:87], v[12:15], v[32:39], v112
ds_read_b128 v[32:35], v113 offset:28672
ds_read_b128 v[36:39], v113 offset:29696
s_cbranch_vccnz main_kernel_c1_o4_f
main_kernel_c1_o4:
s_waitcnt lgkmcnt(12)
v_smfmac_f32_16x16x64_bf16 v[80:83], v[16:19], v[40:47], v112
ds_read_b128 v[40:43], v113 offset:30720
ds_read_b128 v[44:47], v113 offset:31744
s_waitcnt lgkmcnt(12)
s_waitcnt vmcnt(4)
v_cmp_u_f32 vcc, v20, v22
v_smfmac_f32_16x16x64_bf16 v[84:87], v[16:19], v[48:55], v112
s_cbranch_vccnz main_kernel_c1_o5_f
main_kernel_c1_o5:
s_waitcnt lgkmcnt(10)
v_smfmac_f32_16x16x64_bf16 v[80:83], v[20:23], v[56:63], v112
s_waitcnt lgkmcnt(8)
s_waitcnt vmcnt(3)
v_cmp_u_f32 vcc, v24, v26
v_smfmac_f32_16x16x64_bf16 v[84:87], v[20:23], v[64:71], v112
s_cbranch_vccnz main_kernel_c1_o6_f
main_kernel_c1_o6:
s_waitcnt lgkmcnt(6)
v_smfmac_f32_16x16x64_bf16 v[80:83], v[24:27], v[72:79], v112
s_waitcnt lgkmcnt(4)
v_smfmac_f32_16x16x64_bf16 v[84:87], v[24:27], v[88:95], v112
s_waitcnt lgkmcnt(2)
s_waitcnt vmcnt(2)
v_cmp_u_f32 vcc, v28, v30
s_cbranch_vccnz main_kernel_c1_o7_f
main_kernel_c1_o7:
v_smfmac_f32_16x16x64_bf16 v[80:83], v[28:31], v[32:39], v112
s_waitcnt lgkmcnt(0)
v_smfmac_f32_16x16x64_bf16 v[84:87], v[28:31], v[40:47], v112
s_nop 4
v_cvt_pk_bf16_f32 v80, v80, v81
v_cvt_pk_bf16_f32 v81, v82, v83
ds_write_b64 v116, v[80:81] offset:20488
v_cvt_pk_bf16_f32 v82, v84, v85
v_cvt_pk_bf16_f32 v83, v86, v87
ds_write_b64 v116, v[82:83] offset:22536
s_waitcnt lgkmcnt(0)
s_barrier
ds_read_b128 v[72:75], v116 offset:22528
ds_read_b128 v[76:79], v116 offset:23552
s_mov_b32 m0, 26624
s_cmp_lg_u32 s10, 0
s_waitcnt lgkmcnt(1)
v_mfma_f32_16x16x32_bf16 v[64:67], v[72:75], v[108:111], 0
s_waitcnt lgkmcnt(0)
v_mfma_f32_16x16x32_bf16 v[64:67], v[76:79], v[108:111], v[64:67]
s_nop 7
v_cvt_pk_f16_f32 v68, v64, v65
v_cvt_pk_f16_f32 v69, v66, v67
buffer_store_dwordx2 v[68:69], v125, s[4:7], s25 offen sc1
s_cbranch_scc1 main_kernel_c1_kvw
main_kernel_c1_kvok:
s_nop 3
buffer_load_dwordx4 v116, s[4:7], s27 offen sc1 lds
buffer_load_dwordx4 v116, s[4:7], s27 offen offset:1024 sc1 lds
s_mov_b32 m0, 30720
s_xor_b32 s32, s27, 131072
buffer_load_dwordx4 v116, s[4:7], s32 offen offset:0 sc1 lds
s_add_u32 s27, s27, 0x40000
s_branch main_kernel_c1_top
main_kernel_c1_kvw:
s_mov_b32 exec_lo, 0
s_mov_b32 exec_hi, 0x3f00
v_subrev_u32 v127, 128, v121
main_kernel_c1_kvp:
buffer_load_dword v126, v127, s[4:7], 0 offen sc1
s_waitcnt vmcnt(0)
v_cmp_eq_u32 vcc, 0, v126
s_cbranch_vccz main_kernel_c1_kvp_ok
s_sleep 2
s_sub_u32 s29, s29, 1
s_cbranch_scc0 main_kernel_c1_kvp
s_branch main_kernel_end
main_kernel_c1_kvp_ok:
s_mov_b64 exec, -1
s_branch main_kernel_c1_kvok
main_kernel_c1_last:
s_add_u32 s37, s37, 65536
s_add_u32 s26, s26, 65536
buffer_store_dwordx2 v[114:115], v119, s[4:7], s37 offen sc1
v_smfmac_f32_16x16x64_f16 v[88:91], v[20:23], v[168:175], v112
v_smfmac_f32_16x16x64_f16 v[88:91], v[24:27], v[176:183], v112
v_smfmac_f32_16x16x64_f16 v[88:91], v[28:31], v[184:191], v112
v_smfmac_f32_16x16x64_f16 v[88:91], v[32:35], v[192:199], v112
v_smfmac_f32_16x16x64_f16 v[88:91], v[36:39], v[200:207], v112
v_smfmac_f32_16x16x64_f16 v[88:91], v[40:43], v[208:215], v112
v_smfmac_f32_16x16x64_f16 v[88:91], v[44:47], v[216:223], v112
v_smfmac_f32_16x16x64_f16 v[88:91], v[48:51], v[224:231], v112
v_smfmac_f32_16x16x64_f16 v[88:91], v[52:55], v[232:239], v112
v_smfmac_f32_16x16x64_f16 v[88:91], v[56:59], v[240:247], v112
v_smfmac_f32_16x16x64_f16 v[88:91], v[60:63], v[248:255], v112
s_nop 7
v_permlane32_swap_b32 v88, v90
s_nop 1
v_permlane32_swap_b32 v89, v91
s_nop 1
v_pk_add_f32 v[88:89], v[88:89], v[90:91]
s_nop 1
v_cvt_pk_bf16_f32 v124, v88, v89
s_nop 1
buffer_store_dword v124, v120, s[4:7], s26 offen sc1
s_branch main_kernel_end
main_kernel_c1_m0_f:
s_waitcnt lgkmcnt(0)
buffer_load_dwordx4 v[0:3], v116, s[4:7], s18 offen sc1
buffer_load_dwordx4 v[64:67], v116, s[4:7], s19 offen sc1
s_xor_b32 s32, s18, 1024
buffer_load_dwordx4 v[16:19], v116, s[4:7], s32 offen sc1
s_xor_b32 s32, s19, 1024
buffer_load_dwordx4 v[68:71], v116, s[4:7], s32 offen sc1
s_xor_b32 s32, s18, 2048
buffer_load_dwordx4 v[32:35], v116, s[4:7], s32 offen sc1
s_xor_b32 s32, s19, 2048
buffer_load_dwordx4 v[72:75], v116, s[4:7], s32 offen sc1
s_xor_b32 s32, s18, 3072
buffer_load_dwordx4 v[48:51], v116, s[4:7], s32 offen sc1
s_xor_b32 s32, s19, 3072
buffer_load_dwordx4 v[76:79], v116, s[4:7], s32 offen sc1
s_sub_u32 s29, s29, 1
s_cbranch_scc1 main_kernel_end
s_waitcnt vmcnt(0)
v_max_u32 v126, v0, v2
v_max3_u32 v126, v126, v64, v66
v_cmp_eq_u32 vcc, -1, v126
s_cbranch_vccnz main_kernel_c1_m0_f
v_pk_add_f16 v0, v0, v64
v_pk_add_f16 v1, v1, v65
v_pk_add_f16 v2, v2, v66
v_pk_add_f16 v3, v3, v67
s_nop 0
s_branch main_kernel_c1_m0
main_kernel_c1_m1_f:
s_waitcnt lgkmcnt(0)
s_xor_b32 s32, s18, 1024
buffer_load_dwordx4 v[16:19], v116, s[4:7], s32 offen sc1
s_xor_b32 s32, s19, 1024
buffer_load_dwordx4 v[68:71], v116, s[4:7], s32 offen sc1
s_xor_b32 s32, s18, 2048
buffer_load_dwordx4 v[32:35], v116, s[4:7], s32 offen sc1
s_xor_b32 s32, s19, 2048
buffer_load_dwordx4 v[72:75], v116, s[4:7], s32 offen sc1
s_xor_b32 s32, s18, 3072
buffer_load_dwordx4 v[48:51], v116, s[4:7], s32 offen sc1
s_xor_b32 s32, s19, 3072
buffer_load_dwordx4 v[76:79], v116, s[4:7], s32 offen sc1
s_sub_u32 s29, s29, 1
s_cbranch_scc1 main_kernel_end
s_waitcnt vmcnt(0)
v_max_u32 v126, v16, v18
v_max3_u32 v126, v126, v68, v70
v_cmp_eq_u32 vcc, -1, v126
s_cbranch_vccnz main_kernel_c1_m1_f
v_pk_add_f16 v16, v16, v68
v_pk_add_f16 v17, v17, v69
v_pk_add_f16 v18, v18, v70
v_pk_add_f16 v19, v19, v71
ds_write_b128 v116, v[16:19] offset:5120
s_branch main_kernel_c1_m1
main_kernel_c1_m2_f:
s_waitcnt lgkmcnt(0)
s_xor_b32 s32, s18, 2048
buffer_load_dwordx4 v[32:35], v116, s[4:7], s32 offen sc1
s_xor_b32 s32, s19, 2048
buffer_load_dwordx4 v[72:75], v116, s[4:7], s32 offen sc1
s_xor_b32 s32, s18, 3072
buffer_load_dwordx4 v[48:51], v116, s[4:7], s32 offen sc1
s_xor_b32 s32, s19, 3072
buffer_load_dwordx4 v[76:79], v116, s[4:7], s32 offen sc1
s_sub_u32 s29, s29, 1
s_cbranch_scc1 main_kernel_end
s_waitcnt vmcnt(0)
v_max_u32 v126, v32, v34
v_max3_u32 v126, v126, v72, v74
v_cmp_eq_u32 vcc, -1, v126
s_cbranch_vccnz main_kernel_c1_m2_f
v_pk_add_f16 v32, v32, v72
v_pk_add_f16 v33, v33, v73
v_pk_add_f16 v34, v34, v74
v_pk_add_f16 v35, v35, v75
ds_write_b128 v116, v[32:35] offset:9216
s_branch main_kernel_c1_m2
main_kernel_c1_m3_f:
s_waitcnt lgkmcnt(0)
s_xor_b32 s32, s18, 3072
buffer_load_dwordx4 v[48:51], v116, s[4:7], s32 offen sc1
s_xor_b32 s32, s19, 3072
buffer_load_dwordx4 v[76:79], v116, s[4:7], s32 offen sc1
s_sub_u32 s29, s29, 1
s_cbranch_scc1 main_kernel_end
s_waitcnt vmcnt(0)
v_max_u32 v126, v48, v50
v_max3_u32 v126, v126, v76, v78
v_cmp_eq_u32 vcc, -1, v126
s_cbranch_vccnz main_kernel_c1_m3_f
v_pk_add_f16 v48, v48, v76
v_pk_add_f16 v49, v49, v77
v_pk_add_f16 v50, v50, v78
v_pk_add_f16 v51, v51, v79
ds_write_b128 v116, v[48:51] offset:13312
s_branch main_kernel_c1_m3
main_kernel_c1_z_f:
buffer_load_dwordx4 v[8:11], v116, s[4:7], s20 offen offset:0 sc1
buffer_load_dwordx4 v[12:15], v116, s[4:7], s20 offen offset:1024 sc1
s_memtime s[32:33]
ds_read_b32 v126, v116 offset:18432
s_sub_u32 s34, s19, s54
s_xor_b32 s34, s34, 0x2000
s_lshl_b32 s35, s12, 15
s_add_u32 s34, s34, s35
s_lshl_b32 s35, s13, 8
s_add_u32 s35, s35, s34
s_add_u32 s34, s34, 0x4000
s_waitcnt lgkmcnt(0)
s_sub_u32 s32, s32, 450
v_sub_u32 v127, s32, v126
buffer_store_dword v127, off, s[4:7], s34
s_sub_u32 s29, s29, 1
s_cbranch_scc1 main_kernel_end
s_waitcnt vmcnt(1)
main_kernel_c1_z_g:
v_max_u32 v126, v8, v10
v_max3_u32 v126, v126, v12, v14
v_cmp_eq_u32 vcc, -1, v126
s_cbranch_vccnz main_kernel_c1_z_h
v_mfma_f32_16x16x32_bf16 v[88:91], v[8:11], v[8:11], v[92:95]
v_mfma_f32_16x16x32_bf16 v[0:3], v[16:19], v[8:11], v[80:83]
v_mfma_f32_16x16x32_bf16 v[4:7], v[20:23], v[8:11], v[84:87]
v_mfma_f32_16x16x32_bf16 v[88:91], v[12:15], v[12:15], v[88:91]
v_mfma_f32_16x16x32_bf16 v[0:3], v[24:27], v[12:15], v[0:3]
v_mfma_f32_16x16x32_bf16 v[4:7], v[28:31], v[12:15], v[4:7]
buffer_store_dword v127, off, s[4:7], s35 offset:132 sc1
s_mov_b32 vcc_lo, 0xcccccccc
s_mov_b32 vcc_hi, 0xcccccccc
s_branch main_kernel_c1_z
main_kernel_c1_z_h:
buffer_load_dwordx4 v[8:11], v116, s[4:7], s20 offen offset:0 sc1
buffer_load_dwordx4 v[12:15], v116, s[4:7], s20 offen offset:1024 sc1
s_sub_u32 s29, s29, 1
s_cbranch_scc1 main_kernel_end
v_add_u32 v127, 300, v127
s_waitcnt vmcnt(0)
s_branch main_kernel_c1_z_g
main_kernel_c1_sm_f:
s_waitcnt vmcnt(0) lgkmcnt(0)
buffer_load_dwordx4 v[8:11], v116, s[4:7], s20 offen offset:0 sc1
buffer_load_dwordx4 v[12:15], v116, s[4:7], s20 offen offset:1024 sc1
ds_read_b128 v[0:3], v116 offset:16384
ds_read_b128 v[4:7], v116 offset:17408
ds_read_b128 v[64:67], v116 offset:24576
ds_read_b128 v[68:71], v116 offset:28672
ds_read_b128 v[72:75], v116 offset:25600
ds_read_b128 v[76:79], v116 offset:29696
ds_read_b128 v[16:19], v116 offset:26624
ds_read_b128 v[20:23], v116 offset:30720
ds_read_b128 v[24:27], v116 offset:27648
ds_read_b128 v[28:31], v116 offset:31744
s_waitcnt vmcnt(0)
s_waitcnt lgkmcnt(0)
v_mfma_f32_16x16x32_bf16 v[80:83], v[64:67], v[0:3], 0
v_mfma_f32_16x16x32_bf16 v[84:87], v[68:71], v[0:3], 0
v_mfma_f32_16x16x32_bf16 v[92:95], v[0:3], v[0:3], 0
v_mfma_f32_16x16x32_bf16 v[80:83], v[72:75], v[4:7], v[80:83]
v_mfma_f32_16x16x32_bf16 v[84:87], v[76:79], v[4:7], v[84:87]
v_mfma_f32_16x16x32_bf16 v[92:95], v[4:7], v[4:7], v[92:95]
v_mfma_f32_16x16x32_bf16 v[0:3], v[16:19], v[8:11], v[80:83]
v_mfma_f32_16x16x32_bf16 v[4:7], v[20:23], v[8:11], v[84:87]
v_mfma_f32_16x16x32_bf16 v[88:91], v[8:11], v[8:11], v[92:95]
v_mfma_f32_16x16x32_bf16 v[0:3], v[24:27], v[12:15], v[0:3]
v_mfma_f32_16x16x32_bf16 v[4:7], v[28:31], v[12:15], v[4:7]
v_mfma_f32_16x16x32_bf16 v[88:91], v[12:15], v[12:15], v[88:91]
s_nop 7
v_mov_b32 v65, 0
v_max_f32 v126, v88, v89
v_mul_f32 v126, s30, v126
v_max3_f32 v126, v126, v0, v1
v_max3_f32 v126, v126, v2, v3
v_max3_f32 v126, v126, v4, v5
v_max3_f32 v126, v126, v6, v7
v_mov_b32 v127, v126
s_nop 1
v_permlane32_swap_b32 v126, v127
v_max_f32 v126, v126, v127
v_mov_b32 v127, v126
s_nop 1
v_permlane16_swap_b32 v126, v127
v_max_f32 v126, v126, v127
v_mul_f32 v127, 0x40faf233, v126
s_mov_b32 vcc_lo, 0xcccccccc
s_mov_b32 vcc_hi, 0xcccccccc
v_sub_f32 v0, v0, v126
v_sub_f32 v1, v1, v126
v_sub_f32 v2, v2, v126
v_sub_f32 v3, v3, v126
v_sub_f32 v4, v4, v126
v_sub_f32 v5, v5, v126
v_sub_f32 v6, v6, v126
v_sub_f32 v7, v7, v126
v_sub_f32 v88, v88, v127
v_sub_f32 v89, v89, v127
s_waitcnt lgkmcnt(0)
s_nop 0
v_mul_f32 v88, s30, v88
v_mul_f32 v89, s30, v89
v_exp_f32 v88, v88
v_exp_f32 v89, v89
v_cndmask_b32_dpp v0, v2, v0, vcc quad_perm:[2,3,2,3] row_mask:0xf bank_mask:0xf
v_cvt_pk_bf16_f32 v64, v88, v89
v_cndmask_b32_dpp v1, v3, v1, vcc quad_perm:[2,3,2,3] row_mask:0xf bank_mask:0xf
v_exp_f32 v0, v0
v_mfma_f32_16x16x16_bf16 v[16:19], v[100:101], v[64:65], 0
v_exp_f32 v1, v1
v_cndmask_b32_dpp v4, v6, v4, vcc quad_perm:[2,3,2,3] row_mask:0xf bank_mask:0xf
v_mfma_f32_16x16x16_bf16 v[8:11], v[124:125], v[64:65], 0
v_cndmask_b32_dpp v5, v7, v5, vcc quad_perm:[2,3,2,3] row_mask:0xf bank_mask:0xf
v_exp_f32 v4, v4
v_exp_f32 v5, v5
v_cvt_pk_bf16_f32 v92, v0, v1
v_cvt_pk_bf16_f32 v94, v4, v5
v_mov_b32 v80, 0
v_mov_b32_dpp v93, v92 quad_perm:[0,1,0,1] row_mask:0xf bank_mask:0xf
v_mov_b32_dpp v95, v94 quad_perm:[0,1,0,1] row_mask:0xf bank_mask:0xf
v_mov_b32 v81, 0
v_mov_b32 v82, 0
v_mfma_f32_16x16x32_bf16 v[16:19], v[100:103], v[92:95], v[16:19]
v_mov_b32 v83, 0
v_mov_b32 v84, 0
v_mfma_f32_16x16x32_bf16 v[8:11], v[96:99], v[92:95], v[8:11]
s_nop 1
v_mov_b32 v85, 0
v_mov_b32 v86, 0
v_mov_b32 v87, 0
v_rcp_f32 v126, v16
v_subrev_u32 v127, 0x21800000, v16
v_cmp_lt_u32 vcc, 0x3c000000, v127
v_pk_mul_f32 v[8:9], v[8:9], v[126:127] op_sel_hi:[1,0]
v_pk_mul_f32 v[10:11], v[10:11], v[126:127] op_sel_hi:[1,0]
s_and_b32 s32, vcc_lo, 0xcccc
v_cvt_pk_bf16_f32 v126, v8, v9
v_cvt_pk_bf16_f32 v127, v10, v11
s_branch main_kernel_c1_ost
main_kernel_c1_o0_f:
s_nop 0
buffer_load_dwordx4 v[0:3], v116, s[4:7], s23 offen sc1
s_xor_b32 s32, s23, 1024
buffer_load_dwordx4 v[4:7], v116, s[4:7], s32 offen sc1
s_sub_u32 s29, s29, 1
s_cbranch_scc1 main_kernel_end
s_waitcnt vmcnt(0)
v_max_u32 v126, v0, v2
v_cmp_eq_u32 vcc, -1, v126
s_cbranch_vccnz main_kernel_c1_o0_f
s_branch main_kernel_c1_o0
main_kernel_c1_o1_f:
s_nop 0
s_xor_b32 s32, s23, 1024
buffer_load_dwordx4 v[4:7], v116, s[4:7], s32 offen sc1
s_xor_b32 s32, s23, 2048
buffer_load_dwordx4 v[8:11], v116, s[4:7], s32 offen sc1
s_sub_u32 s29, s29, 1
s_cbranch_scc1 main_kernel_end
s_waitcnt vmcnt(0)
v_max_u32 v126, v4, v6
v_cmp_eq_u32 vcc, -1, v126
s_cbranch_vccnz main_kernel_c1_o1_f
s_branch main_kernel_c1_o1
main_kernel_c1_o2_f:
s_nop 0
s_xor_b32 s32, s23, 2048
buffer_load_dwordx4 v[8:11], v116, s[4:7], s32 offen sc1
s_xor_b32 s32, s23, 3072
buffer_load_dwordx4 v[12:15], v116, s[4:7], s32 offen sc1
s_sub_u32 s29, s29, 1
s_cbranch_scc1 main_kernel_end
s_waitcnt vmcnt(0)
v_max_u32 v126, v8, v10
v_cmp_eq_u32 vcc, -1, v126
s_cbranch_vccnz main_kernel_c1_o2_f
s_branch main_kernel_c1_o2
main_kernel_c1_o3_f:
s_nop 0
s_xor_b32 s32, s23, 3072
buffer_load_dwordx4 v[12:15], v116, s[4:7], s32 offen sc1
s_xor_b32 s32, s23, 4096
buffer_load_dwordx4 v[16:19], v116, s[4:7], s32 offen sc1
s_sub_u32 s29, s29, 1
s_cbranch_scc1 main_kernel_end
s_waitcnt vmcnt(0)
v_max_u32 v126, v12, v14
v_cmp_eq_u32 vcc, -1, v126
s_cbranch_vccnz main_kernel_c1_o3_f
s_branch main_kernel_c1_o3
main_kernel_c1_o4_f:
s_nop 0
s_xor_b32 s32, s23, 4096
buffer_load_dwordx4 v[16:19], v116, s[4:7], s32 offen sc1
s_xor_b32 s32, s23, 5120
buffer_load_dwordx4 v[20:23], v116, s[4:7], s32 offen sc1
s_sub_u32 s29, s29, 1
s_cbranch_scc1 main_kernel_end
s_waitcnt vmcnt(0)
v_max_u32 v126, v16, v18
v_cmp_eq_u32 vcc, -1, v126
s_cbranch_vccnz main_kernel_c1_o4_f
s_branch main_kernel_c1_o4
main_kernel_c1_o5_f:
s_nop 0
s_xor_b32 s32, s23, 5120
buffer_load_dwordx4 v[20:23], v116, s[4:7], s32 offen sc1
s_xor_b32 s32, s23, 6144
buffer_load_dwordx4 v[24:27], v116, s[4:7], s32 offen sc1
s_sub_u32 s29, s29, 1
s_cbranch_scc1 main_kernel_end
s_waitcnt vmcnt(0)
v_max_u32 v126, v20, v22
v_cmp_eq_u32 vcc, -1, v126
s_cbranch_vccnz main_kernel_c1_o5_f
s_branch main_kernel_c1_o5
main_kernel_c1_o6_f:
s_nop 0
s_xor_b32 s32, s23, 6144
buffer_load_dwordx4 v[24:27], v116, s[4:7], s32 offen sc1
s_xor_b32 s32, s23, 7168
buffer_load_dwordx4 v[28:31], v116, s[4:7], s32 offen sc1
s_sub_u32 s29, s29, 1
s_cbranch_scc1 main_kernel_end
s_waitcnt vmcnt(0)
v_max_u32 v126, v24, v26
v_cmp_eq_u32 vcc, -1, v126
s_cbranch_vccnz main_kernel_c1_o6_f
s_branch main_kernel_c1_o6
main_kernel_c1_o7_f:
s_nop 0
s_xor_b32 s32, s23, 7168
buffer_load_dwordx4 v[28:31], v116, s[4:7], s32 offen sc1
s_sub_u32 s29, s29, 1
s_cbranch_scc1 main_kernel_end
s_waitcnt vmcnt(0)
v_max_u32 v126, v28, v30
v_cmp_eq_u32 vcc, -1, v126
s_cbranch_vccnz main_kernel_c1_o7_f
s_branch main_kernel_c1_o7
.p2align 6
main_kernel_c2_top:
s_barrier
buffer_load_dwordx4 v[0:3], v116, s[4:7], s18 offen sc1
s_add_u32 s20, s20, 0x40000
s_bitset0_b32 s20, 20
s_add_u32 s21, s21, 0x40000
s_bitset0_b32 s21, 20
s_add_u32 s22, s22, 0x40000
s_bitset0_b32 s22, 20
s_add_u32 s23, s23, 0x40000
s_bitset0_b32 s23, 20
s_xor_b32 s32, s18, 1024
buffer_load_dwordx4 v[16:19], v116, s[4:7], s32 offen sc1
s_add_u32 s3, s3, 0x40000
s_bitset0_b32 s3, 20
s_add_u32 s17, s17, 1
s_bitcmp1_b32 0x77777777, s17
s_cselect_b32 s33, 0x800, 0
s_xor_b32 s54, s54, s33
s_add_u32 s25, s25, 0x40000
s_bitset0_b32 s25, 20
s_nop 0
buffer_load_dwordx4 v[64:67], v116, s[4:7], s19 offen sc1
v_mov_b32 v80, 0
v_mov_b32 v81, 0
s_nop 3
s_xor_b32 s32, s19, 1024
buffer_load_dwordx4 v[68:71], v116, s[4:7], s32 offen sc1
v_mov_b32 v82, 0
v_mov_b32 v83, 0
s_nop 3
s_xor_b32 s32, s18, 2048
buffer_load_dwordx4 v[32:35], v116, s[4:7], s32 offen sc1
v_mov_b32 v84, 0
v_mov_b32 v85, 0
s_nop 3
s_xor_b32 s32, s19, 2048
buffer_load_dwordx4 v[72:75], v116, s[4:7], s32 offen sc1
v_mov_b32 v86, 0
v_mov_b32 v87, 0
s_nop 3
s_xor_b32 s32, s18, 3072
buffer_load_dwordx4 v[48:51], v116, s[4:7], s32 offen sc1
v_mov_b32 v88, 0
v_mov_b32 v89, 0
s_nop 3
s_xor_b32 s32, s19, 3072
buffer_load_dwordx4 v[76:79], v116, s[4:7], s32 offen sc1
v_mov_b32 v90, 0
v_mov_b32 v91, 0
s_waitcnt vmcnt(5)
v_pk_add_f16 v0, v0, v64
v_pk_add_f16 v1, v1, v65
v_pk_add_f16 v2, v2, v66
v_pk_add_f16 v3, v3, v67
v_cmp_u_f16 vcc, v0, v2
s_cbranch_vccnz main_kernel_c2_m0_f
main_kernel_c2_m0:
v_smfmac_f32_16x16x64_f16 v[80:83], v[0:3], a[0:7], v112
ds_write_b128 v116, v[0:3] offset:2048
v_smfmac_f32_16x16x64_f16 v[84:87], v[0:3], a[128:135], v112
buffer_load_dword v123, v121, s[4:7], 0 offen sc1
s_waitcnt vmcnt(5)
v_pk_add_f16 v16, v16, v68
v_pk_add_f16 v17, v17, v69
v_pk_add_f16 v18, v18, v70
v_pk_add_f16 v19, v19, v71
v_cmp_u_f16 vcc, v16, v18
s_waitcnt lgkmcnt(0)
s_barrier
ds_read_b128 v[4:7], v116 offset:3072
s_cbranch_vccnz main_kernel_c2_m1_f
main_kernel_c2_m1:
v_smfmac_f32_16x16x64_f16 v[80:83], v[16:19], a[8:15], v112
ds_write_b128 v116, v[16:19] offset:6144
v_smfmac_f32_16x16x64_f16 v[84:87], v[16:19], a[136:143], v112
ds_read_b128 v[8:11], v116 offset:0
v_smfmac_f32_16x16x64_f16 v[88:91], v[0:3], v[128:135], v112
ds_read_b128 v[12:15], v116 offset:1024
s_waitcnt lgkmcnt(3)
v_smfmac_f32_16x16x64_f16 v[80:83], v[4:7], a[32:39], v112
v_smfmac_f32_16x16x64_f16 v[84:87], v[4:7], a[160:167], v112
v_smfmac_f32_16x16x64_f16 v[88:91], v[4:7], v[136:143], v112
s_waitcnt lgkmcnt(2)
s_barrier
s_waitcnt lgkmcnt(1)
v_smfmac_f32_16x16x64_f16 v[80:83], v[8:11], a[64:71], v112
s_waitcnt vmcnt(3)
ds_read_b128 v[20:23], v116 offset:7168
v_pk_add_f16 v32, v32, v72
v_smfmac_f32_16x16x64_f16 v[84:87], v[8:11], a[192:199], v112
ds_read_b128 v[24:27], v116 offset:4096
s_waitcnt lgkmcnt(2)
v_pk_add_f16 v33, v33, v73
v_smfmac_f32_16x16x64_f16 v[80:83], v[12:15], a[96:103], v112
ds_read_b128 v[28:31], v116 offset:5120
v_pk_add_f16 v34, v34, v74
v_smfmac_f32_16x16x64_f16 v[84:87], v[12:15], a[224:231], v112
s_waitcnt lgkmcnt(2)
v_pk_add_f16 v35, v35, v75
v_smfmac_f32_16x16x64_f16 v[80:83], v[20:23], a[40:47], v112
v_cmp_u_f16 vcc, v32, v34
v_smfmac_f32_16x16x64_f16 v[84:87], v[20:23], a[168:175], v112
ds_write_b128 v116, v[32:35] offset:10240
s_cbranch_vccnz main_kernel_c2_m2_f
main_kernel_c2_m2:
v_smfmac_f32_16x16x64_f16 v[80:83], v[32:35], a[16:23], v112
buffer_load_dwordx4 v[96:99], v116, s[4:7], s28 offen sc1
v_smfmac_f32_16x16x64_f16 v[84:87], v[32:35], a[144:151], v112
s_add_u32 s28, s28, 0x40000
s_waitcnt lgkmcnt(2)
v_smfmac_f32_16x16x64_f16 v[80:83], v[24:27], a[72:79], v112
s_waitcnt vmcnt(2)
v_pk_add_f16 v48, v48, v76
v_smfmac_f32_16x16x64_f16 v[84:87], v[24:27], a[200:207], v112
s_waitcnt lgkmcnt(0)
s_barrier
ds_read_b128 v[36:39], v116 offset:11264
v_pk_add_f16 v49, v49, v77
v_smfmac_f32_16x16x64_f16 v[80:83], v[28:31], a[104:111], v112
ds_read_b128 v[40:43], v116 offset:8192
v_pk_add_f16 v50, v50, v78
v_smfmac_f32_16x16x64_f16 v[84:87], v[28:31], a[232:239], v112
ds_read_b128 v[44:47], v116 offset:9216
v_pk_add_f16 v51, v51, v79
v_smfmac_f32_16x16x64_f16 v[88:91], v[8:11], v[144:151], v112
s_waitcnt lgkmcnt(2)
v_cmp_u_f16 vcc, v48, v50
v_smfmac_f32_16x16x64_f16 v[80:83], v[36:39], a[48:55], v112
ds_write_b128 v116, v[48:51] offset:14336
s_cbranch_vccnz main_kernel_c2_m3_f
main_kernel_c2_m3:
v_smfmac_f32_16x16x64_f16 v[80:83], v[48:51], a[24:31], v112
v_smfmac_f32_16x16x64_f16 v[84:87], v[48:51], a[152:159], v112
v_smfmac_f32_16x16x64_f16 v[84:87], v[36:39], a[176:183], v112
s_waitcnt lgkmcnt(2)
v_smfmac_f32_16x16x64_f16 v[80:83], v[40:43], a[80:87], v112
s_waitcnt lgkmcnt(0)
s_barrier
ds_read_b128 v[52:55], v116 offset:15360
v_smfmac_f32_16x16x64_f16 v[84:87], v[40:43], a[208:215], v112
s_add_u32 s19, s52, s54
ds_read_b128 v[56:59], v116 offset:12288
v_smfmac_f32_16x16x64_f16 v[80:83], v[44:47], a[112:119], v112
s_add_u32 s18, s18, 0x40000
ds_read_b128 v[60:63], v116 offset:13312
v_smfmac_f32_16x16x64_f16 v[84:87], v[44:47], a[240:247], v112
s_bitset0_b32 s18, 20
s_waitcnt lgkmcnt(2)
v_smfmac_f32_16x16x64_f16 v[80:83], v[52:55], a[56:63], v112
s_cmp_eq_u32 s17, 30
s_cselect_b32 s32, s53, 0x10000
s_waitcnt lgkmcnt(1)
v_smfmac_f32_16x16x64_f16 v[80:83], v[56:59], a[88:95], v112
s_add_u32 s52, s52, s32
s_waitcnt lgkmcnt(0)
v_smfmac_f32_16x16x64_f16 v[80:83], v[60:63], a[120:127], v112
s_sub_u32 s24, 0x20000, s32
ds_read_b128 v[64:67], v116 offset:24576
v_smfmac_f32_16x16x64_f16 v[84:87], v[52:55], a[184:191], v112
s_add_u32 s55, s55, s24
ds_read_b128 v[68:71], v116 offset:28672
v_smfmac_f32_16x16x64_f16 v[84:87], v[56:59], a[216:223], v112
ds_read_b128 v[72:75], v116 offset:25600
s_nop 0
v_cvt_pk_bf16_f32 v92, v80, v81
v_smfmac_f32_16x16x64_f16 v[84:87], v[60:63], a[248:255], v112
ds_read_b128 v[76:79], v116 offset:29696
s_nop 0
v_cvt_pk_bf16_f32 v93, v82, v83
v_smfmac_f32_16x16x64_f16 v[88:91], v[12:15], v[152:159], v112
s_nop 3
v_cvt_pk_bf16_f32 v94, v84, v85
v_cvt_pk_bf16_f32 v95, v86, v87
s_mov_b32 vcc_lo, 0xcccccccc
s_mov_b32 vcc_hi, 0xcccccccc
v_mfma_f32_16x16x32_bf16 v[84:87], v[92:95], v[104:107], 0
v_add_u32 v121, v121, v122
v_writelane_b32 v121, s55, 39
s_nop 0
v_smfmac_f32_16x16x64_f16 v[88:91], v[16:19], v[160:167], v112
s_nop 2
s_cmp_eq_u32 s17, 63
v_cvt_pk_bf16_f32 v114, v84, v85
v_cvt_pk_bf16_f32 v115, v86, v87
buffer_store_dwordx2 v[114:115], v117, s[4:7], s21 offen
s_cbranch_scc1 main_kernel_c2_last
ds_write_b64 v117, v[114:115] offset:17408
v_smfmac_f32_16x16x64_f16 v[88:91], v[20:23], v[168:175], v112
v_smfmac_f32_16x16x64_f16 v[88:91], v[24:27], v[176:183], v112
v_smfmac_f32_16x16x64_f16 v[88:91], v[28:31], v[184:191], v112
v_smfmac_f32_16x16x64_f16 v[88:91], v[32:35], v[192:199], v112
s_waitcnt lgkmcnt(0)
s_barrier
ds_read_b128 v[0:3], v116 offset:16384
v_smfmac_f32_16x16x64_f16 v[88:91], v[36:39], v[200:207], v112
ds_read_b128 v[4:7], v116 offset:17408
v_smfmac_f32_16x16x64_f16 v[88:91], v[40:43], v[208:215], v112
ds_read_b128 v[16:19], v116 offset:26624
v_smfmac_f32_16x16x64_f16 v[88:91], v[44:47], v[216:223], v112
ds_read_b128 v[20:23], v116 offset:30720
v_smfmac_f32_16x16x64_f16 v[88:91], v[48:51], v[224:231], v112
ds_read_b128 v[24:27], v116 offset:27648
v_smfmac_f32_16x16x64_f16 v[88:91], v[52:55], v[232:239], v112
ds_read_b128 v[28:31], v116 offset:31744
v_smfmac_f32_16x16x64_f16 v[88:91], v[56:59], v[240:247], v112
v_smfmac_f32_16x16x64_f16 v[88:91], v[60:63], v[248:255], v112
s_waitcnt lgkmcnt(5)
v_mfma_f32_16x16x32_bf16 v[80:83], v[64:67], v[0:3], 0
v_mfma_f32_16x16x32_bf16 v[84:87], v[68:71], v[0:3], 0
buffer_load_dwordx4 v[8:11], v116, s[4:7], s20 offen offset:0 sc1
v_mfma_f32_16x16x32_bf16 v[92:95], v[0:3], v[0:3], 0
buffer_load_dwordx4 v[12:15], v116, s[4:7], s20 offen offset:1024 sc1
v_permlane32_swap_b32 v88, v90
s_waitcnt lgkmcnt(4)
v_mfma_f32_16x16x32_bf16 v[80:83], v[72:75], v[4:7], v[80:83]
v_permlane32_swap_b32 v89, v91
v_mfma_f32_16x16x32_bf16 v[84:87], v[76:79], v[4:7], v[84:87]
v_pk_add_f32 v[88:89], v[88:89], v[90:91]
v_mfma_f32_16x16x32_bf16 v[92:95], v[4:7], v[4:7], v[92:95]
v_cvt_pk_bf16_f32 v124, v88, v89
v_mov_b32 v65, 0
s_waitcnt lgkmcnt(0)
s_waitcnt vmcnt(1)
v_mfma_f32_16x16x32_bf16 v[88:91], v[8:11], v[8:11], v[92:95]
v_mfma_f32_16x16x32_bf16 v[0:3], v[16:19], v[8:11], v[80:83]
v_cmp_u_f32 s[0:1], v8, v10
v_mfma_f32_16x16x32_bf16 v[4:7], v[20:23], v[8:11], v[84:87]
s_waitcnt vmcnt(0)
v_mfma_f32_16x16x32_bf16 v[88:91], v[12:15], v[12:15], v[88:91]
v_mfma_f32_16x16x32_bf16 v[0:3], v[24:27], v[12:15], v[0:3]
v_cmp_u_f32 s[32:33], v12, v14
v_mfma_f32_16x16x32_bf16 v[4:7], v[28:31], v[12:15], v[4:7]
s_or_b64 s[0:1], s[0:1], s[32:33]
s_cbranch_scc1 main_kernel_c2_z_f
main_kernel_c2_z:
v_mul_f32 v88, s30, v88
v_mul_f32 v89, s30, v89
v_exp_f32 v88, v88
v_exp_f32 v89, v89
v_cndmask_b32_dpp v0, v2, v0, vcc quad_perm:[2,3,2,3] row_mask:0xf bank_mask:0xf
v_cvt_pk_bf16_f32 v64, v88, v89
v_cndmask_b32_dpp v1, v3, v1, vcc quad_perm:[2,3,2,3] row_mask:0xf bank_mask:0xf
v_exp_f32 v0, v0
v_mfma_f32_16x16x16_bf16 v[16:19], v[100:101], v[64:65], 0
v_exp_f32 v1, v1
v_cndmask_b32_dpp v4, v6, v4, vcc quad_perm:[2,3,2,3] row_mask:0xf bank_mask:0xf
v_mfma_f32_16x16x16_bf16 v[8:11], v[124:125], v[64:65], 0
v_cndmask_b32_dpp v5, v7, v5, vcc quad_perm:[2,3,2,3] row_mask:0xf bank_mask:0xf
v_exp_f32 v4, v4
v_exp_f32 v5, v5
v_cvt_pk_bf16_f32 v92, v0, v1
v_cvt_pk_bf16_f32 v94, v4, v5
v_mov_b32 v80, 0
v_mov_b32_dpp v93, v92 quad_perm:[0,1,0,1] row_mask:0xf bank_mask:0xf
v_mov_b32_dpp v95, v94 quad_perm:[0,1,0,1] row_mask:0xf bank_mask:0xf
v_mov_b32 v81, 0
v_mov_b32 v82, 0
v_mfma_f32_16x16x32_bf16 v[16:19], v[100:103], v[92:95], v[16:19]
v_mov_b32 v83, 0
v_mov_b32 v84, 0
v_mfma_f32_16x16x32_bf16 v[8:11], v[96:99], v[92:95], v[8:11]
s_nop 1
v_mov_b32 v85, 0
v_mov_b32 v86, 0
v_mov_b32 v87, 0
v_rcp_f32 v126, v16
v_subrev_u32 v127, 0x21800000, v16
v_cmp_lt_u32 vcc, 0x3c000000, v127
v_pk_mul_f32 v[8:9], v[8:9], v[126:127] op_sel_hi:[1,0]
v_pk_mul_f32 v[10:11], v[10:11], v[126:127] op_sel_hi:[1,0]
s_and_b32 s32, vcc_lo, 0xcccc
v_cvt_pk_bf16_f32 v126, v8, v9
v_cvt_pk_bf16_f32 v127, v10, v11
s_cbranch_scc1 main_kernel_c2_sm_f
main_kernel_c2_ost:
buffer_store_dwordx2 v[126:127], v118, s[4:7], s22 offen
v_cmp_eq_u32 s[0:1], 0, v123
v_mov_b32 v24, -1
v_mov_b32 v25, -1
v_mov_b32 v26, -1
v_mov_b32 v27, -1
ds_read_b128 v[32:35], v113 offset:0
ds_read_b128 v[36:39], v113 offset:1024
ds_read_b128 v[40:43], v113 offset:2048
ds_read_b128 v[44:47], v113 offset:3072
ds_read_b128 v[48:51], v113 offset:4096
ds_read_b128 v[52:55], v113 offset:5120
s_and_b32 s10, s1, 0x3f00
buffer_store_dwordx4 v[24:27], v116, s[4:7], s3 offen
s_barrier
buffer_load_dwordx4 v[0:3], v116, s[4:7], s23 offen sc1
ds_read_b128 v[56:59], v113 offset:6144
ds_read_b128 v[60:63], v113 offset:7168
s_add_u32 s37, s37, 65536
s_add_u32 s26, s26, 65536
s_nop 1
s_xor_b32 s32, s23, 1024
buffer_load_dwordx4 v[4:7], v116, s[4:7], s32 offen sc1
ds_read_b128 v[64:67], v113 offset:8192
ds_read_b128 v[68:71], v113 offset:9216
s_nop 3
s_xor_b32 s32, s23, 2048
buffer_load_dwordx4 v[8:11], v116, s[4:7], s32 offen sc1
ds_read_b128 v[72:75], v113 offset:10240
ds_read_b128 v[76:79], v113 offset:11264
s_nop 3
s_xor_b32 s32, s23, 3072
buffer_load_dwordx4 v[12:15], v116, s[4:7], s32 offen sc1
ds_read_b128 v[88:91], v113 offset:12288
ds_read_b128 v[92:95], v113 offset:13312
s_nop 3
s_xor_b32 s32, s23, 4096
buffer_load_dwordx4 v[16:19], v116, s[4:7], s32 offen sc1
s_nop 7
s_xor_b32 s32, s23, 5120
buffer_load_dwordx4 v[20:23], v116, s[4:7], s32 offen sc1
s_nop 7
s_xor_b32 s32, s23, 6144
buffer_load_dwordx4 v[24:27], v116, s[4:7], s32 offen sc1
s_nop 7
s_xor_b32 s32, s23, 7168
buffer_load_dwordx4 v[28:31], v116, s[4:7], s32 offen sc1
s_waitcnt lgkmcnt(12)
s_waitcnt vmcnt(7)
v_cmp_u_f32 vcc, v0, v2
s_cbranch_vccnz main_kernel_c2_o0_f
main_kernel_c2_o0:
v_smfmac_f32_16x16x64_bf16 v[80:83], v[0:3], v[32:39], v112
ds_read_b128 v[32:35], v113 offset:14336
ds_read_b128 v[36:39], v113 offset:15360
s_waitcnt lgkmcnt(12)
s_waitcnt vmcnt(6)
v_cmp_u_f32 vcc, v4, v6
v_smfmac_f32_16x16x64_bf16 v[84:87], v[0:3], v[40:47], v112
ds_read_b128 v[40:43], v113 offset:16384
ds_read_b128 v[44:47], v113 offset:17408
buffer_store_dwordx2 v[114:115], v119, s[4:7], s37 offen sc1
s_cbranch_vccnz main_kernel_c2_o1_f
main_kernel_c2_o1:
s_waitcnt lgkmcnt(12)
v_smfmac_f32_16x16x64_bf16 v[80:83], v[4:7], v[48:55], v112
ds_read_b128 v[48:51], v113 offset:18432
ds_read_b128 v[52:55], v113 offset:19456
s_waitcnt lgkmcnt(12)
s_waitcnt vmcnt(6)
v_cmp_u_f32 vcc, v8, v10
v_smfmac_f32_16x16x64_bf16 v[84:87], v[4:7], v[56:63], v112
ds_read_b128 v[56:59], v113 offset:20480
ds_read_b128 v[60:63], v113 offset:21504
buffer_store_dword v124, v120, s[4:7], s26 offen sc1
s_cbranch_vccnz main_kernel_c2_o2_f
main_kernel_c2_o2:
s_waitcnt lgkmcnt(12)
v_smfmac_f32_16x16x64_bf16 v[80:83], v[8:11], v[64:71], v112
ds_read_b128 v[64:67], v113 offset:22528
ds_read_b128 v[68:71], v113 offset:23552
s_waitcnt lgkmcnt(12)
s_waitcnt vmcnt(6)
v_cmp_u_f32 vcc, v12, v14
v_smfmac_f32_16x16x64_bf16 v[84:87], v[8:11], v[72:79], v112
ds_read_b128 v[72:75], v113 offset:24576
ds_read_b128 v[76:79], v113 offset:25600
s_cbranch_vccnz main_kernel_c2_o3_f
main_kernel_c2_o3:
s_waitcnt lgkmcnt(12)
v_smfmac_f32_16x16x64_bf16 v[80:83], v[12:15], v[88:95], v112
ds_read_b128 v[88:91], v113 offset:26624
ds_read_b128 v[92:95], v113 offset:27648
s_waitcnt lgkmcnt(12)
s_waitcnt vmcnt(5)
v_cmp_u_f32 vcc, v16, v18
v_smfmac_f32_16x16x64_bf16 v[84:87], v[12:15], v[32:39], v112
ds_read_b128 v[32:35], v113 offset:28672
ds_read_b128 v[36:39], v113 offset:29696
s_cbranch_vccnz main_kernel_c2_o4_f
main_kernel_c2_o4:
s_waitcnt lgkmcnt(12)
v_smfmac_f32_16x16x64_bf16 v[80:83], v[16:19], v[40:47], v112
ds_read_b128 v[40:43], v113 offset:30720
ds_read_b128 v[44:47], v113 offset:31744
s_waitcnt lgkmcnt(12)
s_waitcnt vmcnt(4)
v_cmp_u_f32 vcc, v20, v22
v_smfmac_f32_16x16x64_bf16 v[84:87], v[16:19], v[48:55], v112
s_cbranch_vccnz main_kernel_c2_o5_f
main_kernel_c2_o5:
s_waitcnt lgkmcnt(10)
v_smfmac_f32_16x16x64_bf16 v[80:83], v[20:23], v[56:63], v112
s_waitcnt lgkmcnt(8)
s_waitcnt vmcnt(3)
v_cmp_u_f32 vcc, v24, v26
v_smfmac_f32_16x16x64_bf16 v[84:87], v[20:23], v[64:71], v112
s_cbranch_vccnz main_kernel_c2_o6_f
main_kernel_c2_o6:
s_waitcnt lgkmcnt(6)
v_smfmac_f32_16x16x64_bf16 v[80:83], v[24:27], v[72:79], v112
s_waitcnt lgkmcnt(4)
v_smfmac_f32_16x16x64_bf16 v[84:87], v[24:27], v[88:95], v112
s_waitcnt lgkmcnt(2)
s_waitcnt vmcnt(2)
v_cmp_u_f32 vcc, v28, v30
s_cbranch_vccnz main_kernel_c2_o7_f
main_kernel_c2_o7:
v_smfmac_f32_16x16x64_bf16 v[80:83], v[28:31], v[32:39], v112
s_waitcnt lgkmcnt(0)
v_smfmac_f32_16x16x64_bf16 v[84:87], v[28:31], v[40:47], v112
s_nop 4
v_cvt_pk_bf16_f32 v80, v80, v81
v_cvt_pk_bf16_f32 v81, v82, v83
ds_write_b64 v116, v[80:81] offset:21504
v_cvt_pk_bf16_f32 v82, v84, v85
v_cvt_pk_bf16_f32 v83, v86, v87
ds_write_b64 v116, v[82:83] offset:23552
s_waitcnt lgkmcnt(0)
s_barrier
ds_read_b128 v[72:75], v116 offset:20480
ds_read_b128 v[76:79], v116 offset:21504
s_mov_b32 m0, 28672
s_cmp_lg_u32 s10, 0
s_waitcnt lgkmcnt(1)
v_mfma_f32_16x16x32_bf16 v[64:67], v[72:75], v[108:111], 0
s_waitcnt lgkmcnt(0)
v_mfma_f32_16x16x32_bf16 v[64:67], v[76:79], v[108:111], v[64:67]
s_nop 7
v_cvt_pk_f16_f32 v68, v64, v65
v_cvt_pk_f16_f32 v69, v66, v67
buffer_store_dwordx2 v[68:69], v125, s[4:7], s25 offen
s_cbranch_scc1 main_kernel_c2_kvw
main_kernel_c2_kvok:
s_nop 3
buffer_load_dwordx4 v116, s[4:7], s27 offen sc1 lds
buffer_load_dwordx4 v116, s[4:7], s27 offen offset:1024 sc1 lds
s_mov_b32 m0, 30720
s_xor_b32 s32, s27, 2048
buffer_load_dwordx4 v116, s[4:7], s32 offen offset:1024 sc1 lds
s_add_u32 s27, s27, 0x40000
s_branch main_kernel_c2_top
main_kernel_c2_kvw:
s_mov_b32 exec_lo, 0
s_mov_b32 exec_hi, 0x3f00
v_subrev_u32 v127, 128, v121
main_kernel_c2_kvp:
buffer_load_dword v126, v127, s[4:7], 0 offen sc1
s_waitcnt vmcnt(0)
v_cmp_eq_u32 vcc, 0, v126
s_cbranch_vccz main_kernel_c2_kvp_ok
s_sleep 2
s_sub_u32 s29, s29, 1
s_cbranch_scc0 main_kernel_c2_kvp
s_branch main_kernel_end
main_kernel_c2_kvp_ok:
s_mov_b64 exec, -1
s_branch main_kernel_c2_kvok
main_kernel_c2_last:
s_add_u32 s37, s37, 65536
s_add_u32 s26, s26, 65536
buffer_store_dwordx2 v[114:115], v119, s[4:7], s37 offen sc1
v_smfmac_f32_16x16x64_f16 v[88:91], v[20:23], v[168:175], v112
v_smfmac_f32_16x16x64_f16 v[88:91], v[24:27], v[176:183], v112
v_smfmac_f32_16x16x64_f16 v[88:91], v[28:31], v[184:191], v112
v_smfmac_f32_16x16x64_f16 v[88:91], v[32:35], v[192:199], v112
v_smfmac_f32_16x16x64_f16 v[88:91], v[36:39], v[200:207], v112
v_smfmac_f32_16x16x64_f16 v[88:91], v[40:43], v[208:215], v112
v_smfmac_f32_16x16x64_f16 v[88:91], v[44:47], v[216:223], v112
v_smfmac_f32_16x16x64_f16 v[88:91], v[48:51], v[224:231], v112
v_smfmac_f32_16x16x64_f16 v[88:91], v[52:55], v[232:239], v112
v_smfmac_f32_16x16x64_f16 v[88:91], v[56:59], v[240:247], v112
v_smfmac_f32_16x16x64_f16 v[88:91], v[60:63], v[248:255], v112
s_nop 7
v_permlane32_swap_b32 v88, v90
s_nop 1
v_permlane32_swap_b32 v89, v91
s_nop 1
v_pk_add_f32 v[88:89], v[88:89], v[90:91]
s_nop 1
v_cvt_pk_bf16_f32 v124, v88, v89
s_nop 1
buffer_store_dword v124, v120, s[4:7], s26 offen sc1
s_branch main_kernel_end
main_kernel_c2_m0_f:
s_waitcnt lgkmcnt(0)
buffer_load_dwordx4 v[0:3], v116, s[4:7], s18 offen sc1
buffer_load_dwordx4 v[64:67], v116, s[4:7], s19 offen sc1
s_xor_b32 s32, s18, 1024
buffer_load_dwordx4 v[16:19], v116, s[4:7], s32 offen sc1
s_xor_b32 s32, s19, 1024
buffer_load_dwordx4 v[68:71], v116, s[4:7], s32 offen sc1
s_xor_b32 s32, s18, 2048
buffer_load_dwordx4 v[32:35], v116, s[4:7], s32 offen sc1
s_xor_b32 s32, s19, 2048
buffer_load_dwordx4 v[72:75], v116, s[4:7], s32 offen sc1
s_xor_b32 s32, s18, 3072
buffer_load_dwordx4 v[48:51], v116, s[4:7], s32 offen sc1
s_xor_b32 s32, s19, 3072
buffer_load_dwordx4 v[76:79], v116, s[4:7], s32 offen sc1
s_sub_u32 s29, s29, 1
s_cbranch_scc1 main_kernel_end
s_waitcnt vmcnt(0)
v_max_u32 v126, v0, v2
v_max3_u32 v126, v126, v64, v66
v_cmp_eq_u32 vcc, -1, v126
s_cbranch_vccnz main_kernel_c2_m0_f
v_pk_add_f16 v0, v0, v64
v_pk_add_f16 v1, v1, v65
v_pk_add_f16 v2, v2, v66
v_pk_add_f16 v3, v3, v67
s_nop 0
s_branch main_kernel_c2_m0
main_kernel_c2_m1_f:
s_waitcnt lgkmcnt(0)
s_xor_b32 s32, s18, 1024
buffer_load_dwordx4 v[16:19], v116, s[4:7], s32 offen sc1
s_xor_b32 s32, s19, 1024
buffer_load_dwordx4 v[68:71], v116, s[4:7], s32 offen sc1
s_xor_b32 s32, s18, 2048
buffer_load_dwordx4 v[32:35], v116, s[4:7], s32 offen sc1
s_xor_b32 s32, s19, 2048
buffer_load_dwordx4 v[72:75], v116, s[4:7], s32 offen sc1
s_xor_b32 s32, s18, 3072
buffer_load_dwordx4 v[48:51], v116, s[4:7], s32 offen sc1
s_xor_b32 s32, s19, 3072
buffer_load_dwordx4 v[76:79], v116, s[4:7], s32 offen sc1
s_sub_u32 s29, s29, 1
s_cbranch_scc1 main_kernel_end
s_waitcnt vmcnt(0)
v_max_u32 v126, v16, v18
v_max3_u32 v126, v126, v68, v70
v_cmp_eq_u32 vcc, -1, v126
s_cbranch_vccnz main_kernel_c2_m1_f
v_pk_add_f16 v16, v16, v68
v_pk_add_f16 v17, v17, v69
v_pk_add_f16 v18, v18, v70
v_pk_add_f16 v19, v19, v71
s_nop 0
s_branch main_kernel_c2_m1
main_kernel_c2_m2_f:
s_waitcnt lgkmcnt(0)
s_xor_b32 s32, s18, 2048
buffer_load_dwordx4 v[32:35], v116, s[4:7], s32 offen sc1
s_xor_b32 s32, s19, 2048
buffer_load_dwordx4 v[72:75], v116, s[4:7], s32 offen sc1
s_xor_b32 s32, s18, 3072
buffer_load_dwordx4 v[48:51], v116, s[4:7], s32 offen sc1
s_xor_b32 s32, s19, 3072
buffer_load_dwordx4 v[76:79], v116, s[4:7], s32 offen sc1
s_sub_u32 s29, s29, 1
s_cbranch_scc1 main_kernel_end
s_waitcnt vmcnt(0)
v_max_u32 v126, v32, v34
v_max3_u32 v126, v126, v72, v74
v_cmp_eq_u32 vcc, -1, v126
s_cbranch_vccnz main_kernel_c2_m2_f
v_pk_add_f16 v32, v32, v72
v_pk_add_f16 v33, v33, v73
v_pk_add_f16 v34, v34, v74
v_pk_add_f16 v35, v35, v75
ds_write_b128 v116, v[32:35] offset:10240
s_branch main_kernel_c2_m2
main_kernel_c2_m3_f:
s_waitcnt lgkmcnt(0)
s_xor_b32 s32, s18, 3072
buffer_load_dwordx4 v[48:51], v116, s[4:7], s32 offen sc1
s_xor_b32 s32, s19, 3072
buffer_load_dwordx4 v[76:79], v116, s[4:7], s32 offen sc1
s_sub_u32 s29, s29, 1
s_cbranch_scc1 main_kernel_end
s_waitcnt vmcnt(0)
v_max_u32 v126, v48, v50
v_max3_u32 v126, v126, v76, v78
v_cmp_eq_u32 vcc, -1, v126
s_cbranch_vccnz main_kernel_c2_m3_f
v_pk_add_f16 v48, v48, v76
v_pk_add_f16 v49, v49, v77
v_pk_add_f16 v50, v50, v78
v_pk_add_f16 v51, v51, v79
ds_write_b128 v116, v[48:51] offset:14336
s_branch main_kernel_c2_m3
main_kernel_c2_z_f:
buffer_load_dwordx4 v[8:11], v116, s[4:7], s20 offen offset:0 sc1
buffer_load_dwordx4 v[12:15], v116, s[4:7], s20 offen offset:1024 sc1
s_memtime s[32:33]
ds_read_b32 v126, v116 offset:18432
s_sub_u32 s34, s19, s54
s_xor_b32 s34, s34, 0x2000
s_lshl_b32 s35, s12, 15
s_add_u32 s34, s34, s35
s_lshl_b32 s35, s13, 8
s_add_u32 s35, s35, s34
s_add_u32 s34, s34, 0x4000
s_waitcnt lgkmcnt(0)
s_sub_u32 s32, s32, 450
v_sub_u32 v127, s32, v126
buffer_store_dword v127, off, s[4:7], s34
s_sub_u32 s29, s29, 1
s_cbranch_scc1 main_kernel_end
s_waitcnt vmcnt(1)
main_kernel_c2_z_g:
v_max_u32 v126, v8, v10
v_max3_u32 v126, v126, v12, v14
v_cmp_eq_u32 vcc, -1, v126
s_cbranch_vccnz main_kernel_c2_z_h
v_mfma_f32_16x16x32_bf16 v[88:91], v[8:11], v[8:11], v[92:95]
v_mfma_f32_16x16x32_bf16 v[0:3], v[16:19], v[8:11], v[80:83]
v_mfma_f32_16x16x32_bf16 v[4:7], v[20:23], v[8:11], v[84:87]
v_mfma_f32_16x16x32_bf16 v[88:91], v[12:15], v[12:15], v[88:91]
v_mfma_f32_16x16x32_bf16 v[0:3], v[24:27], v[12:15], v[0:3]
v_mfma_f32_16x16x32_bf16 v[4:7], v[28:31], v[12:15], v[4:7]
buffer_store_dword v127, off, s[4:7], s35 offset:132 sc1
s_mov_b32 vcc_lo, 0xcccccccc
s_mov_b32 vcc_hi, 0xcccccccc
s_branch main_kernel_c2_z
main_kernel_c2_z_h:
buffer_load_dwordx4 v[8:11], v116, s[4:7], s20 offen offset:0 sc1
buffer_load_dwordx4 v[12:15], v116, s[4:7], s20 offen offset:1024 sc1
s_sub_u32 s29, s29, 1
s_cbranch_scc1 main_kernel_end
v_add_u32 v127, 300, v127
s_waitcnt vmcnt(0)
s_branch main_kernel_c2_z_g
main_kernel_c2_sm_f:
s_waitcnt vmcnt(0) lgkmcnt(0)
buffer_load_dwordx4 v[8:11], v116, s[4:7], s20 offen offset:0 sc1
buffer_load_dwordx4 v[12:15], v116, s[4:7], s20 offen offset:1024 sc1
ds_read_b128 v[0:3], v116 offset:16384
ds_read_b128 v[4:7], v116 offset:17408
ds_read_b128 v[64:67], v116 offset:24576
ds_read_b128 v[68:71], v116 offset:28672
ds_read_b128 v[72:75], v116 offset:25600
ds_read_b128 v[76:79], v116 offset:29696
ds_read_b128 v[16:19], v116 offset:26624
ds_read_b128 v[20:23], v116 offset:30720
ds_read_b128 v[24:27], v116 offset:27648
ds_read_b128 v[28:31], v116 offset:31744
s_waitcnt vmcnt(0)
s_waitcnt lgkmcnt(0)
v_mfma_f32_16x16x32_bf16 v[80:83], v[64:67], v[0:3], 0
v_mfma_f32_16x16x32_bf16 v[84:87], v[68:71], v[0:3], 0
v_mfma_f32_16x16x32_bf16 v[92:95], v[0:3], v[0:3], 0
v_mfma_f32_16x16x32_bf16 v[80:83], v[72:75], v[4:7], v[80:83]
v_mfma_f32_16x16x32_bf16 v[84:87], v[76:79], v[4:7], v[84:87]
v_mfma_f32_16x16x32_bf16 v[92:95], v[4:7], v[4:7], v[92:95]
v_mfma_f32_16x16x32_bf16 v[0:3], v[16:19], v[8:11], v[80:83]
v_mfma_f32_16x16x32_bf16 v[4:7], v[20:23], v[8:11], v[84:87]
v_mfma_f32_16x16x32_bf16 v[88:91], v[8:11], v[8:11], v[92:95]
v_mfma_f32_16x16x32_bf16 v[0:3], v[24:27], v[12:15], v[0:3]
v_mfma_f32_16x16x32_bf16 v[4:7], v[28:31], v[12:15], v[4:7]
v_mfma_f32_16x16x32_bf16 v[88:91], v[12:15], v[12:15], v[88:91]
s_nop 7
v_mov_b32 v65, 0
v_max_f32 v126, v88, v89
v_mul_f32 v126, s30, v126
v_max3_f32 v126, v126, v0, v1
v_max3_f32 v126, v126, v2, v3
v_max3_f32 v126, v126, v4, v5
v_max3_f32 v126, v126, v6, v7
v_mov_b32 v127, v126
s_nop 1
v_permlane32_swap_b32 v126, v127
v_max_f32 v126, v126, v127
v_mov_b32 v127, v126
s_nop 1
v_permlane16_swap_b32 v126, v127
v_max_f32 v126, v126, v127
v_mul_f32 v127, 0x40faf233, v126
s_mov_b32 vcc_lo, 0xcccccccc
s_mov_b32 vcc_hi, 0xcccccccc
v_sub_f32 v0, v0, v126
v_sub_f32 v1, v1, v126
v_sub_f32 v2, v2, v126
v_sub_f32 v3, v3, v126
v_sub_f32 v4, v4, v126
v_sub_f32 v5, v5, v126
v_sub_f32 v6, v6, v126
v_sub_f32 v7, v7, v126
v_sub_f32 v88, v88, v127
v_sub_f32 v89, v89, v127
s_waitcnt lgkmcnt(0)
s_nop 0
v_mul_f32 v88, s30, v88
v_mul_f32 v89, s30, v89
v_exp_f32 v88, v88
v_exp_f32 v89, v89
v_cndmask_b32_dpp v0, v2, v0, vcc quad_perm:[2,3,2,3] row_mask:0xf bank_mask:0xf
v_cvt_pk_bf16_f32 v64, v88, v89
v_cndmask_b32_dpp v1, v3, v1, vcc quad_perm:[2,3,2,3] row_mask:0xf bank_mask:0xf
v_exp_f32 v0, v0
v_mfma_f32_16x16x16_bf16 v[16:19], v[100:101], v[64:65], 0
v_exp_f32 v1, v1
v_cndmask_b32_dpp v4, v6, v4, vcc quad_perm:[2,3,2,3] row_mask:0xf bank_mask:0xf
v_mfma_f32_16x16x16_bf16 v[8:11], v[124:125], v[64:65], 0
v_cndmask_b32_dpp v5, v7, v5, vcc quad_perm:[2,3,2,3] row_mask:0xf bank_mask:0xf
v_exp_f32 v4, v4
v_exp_f32 v5, v5
v_cvt_pk_bf16_f32 v92, v0, v1
v_cvt_pk_bf16_f32 v94, v4, v5
v_mov_b32 v80, 0
v_mov_b32_dpp v93, v92 quad_perm:[0,1,0,1] row_mask:0xf bank_mask:0xf
v_mov_b32_dpp v95, v94 quad_perm:[0,1,0,1] row_mask:0xf bank_mask:0xf
v_mov_b32 v81, 0
v_mov_b32 v82, 0
v_mfma_f32_16x16x32_bf16 v[16:19], v[100:103], v[92:95], v[16:19]
v_mov_b32 v83, 0
v_mov_b32 v84, 0
v_mfma_f32_16x16x32_bf16 v[8:11], v[96:99], v[92:95], v[8:11]
s_nop 1
v_mov_b32 v85, 0
v_mov_b32 v86, 0
v_mov_b32 v87, 0
v_rcp_f32 v126, v16
v_subrev_u32 v127, 0x21800000, v16
v_cmp_lt_u32 vcc, 0x3c000000, v127
v_pk_mul_f32 v[8:9], v[8:9], v[126:127] op_sel_hi:[1,0]
v_pk_mul_f32 v[10:11], v[10:11], v[126:127] op_sel_hi:[1,0]
s_and_b32 s32, vcc_lo, 0xcccc
v_cvt_pk_bf16_f32 v126, v8, v9
v_cvt_pk_bf16_f32 v127, v10, v11
s_branch main_kernel_c2_ost
main_kernel_c2_o0_f:
s_nop 0
buffer_load_dwordx4 v[0:3], v116, s[4:7], s23 offen sc1
s_xor_b32 s32, s23, 1024
buffer_load_dwordx4 v[4:7], v116, s[4:7], s32 offen sc1
s_sub_u32 s29, s29, 1
s_cbranch_scc1 main_kernel_end
s_waitcnt vmcnt(0)
v_max_u32 v126, v0, v2
v_cmp_eq_u32 vcc, -1, v126
s_cbranch_vccnz main_kernel_c2_o0_f
s_branch main_kernel_c2_o0
main_kernel_c2_o1_f:
s_nop 0
s_xor_b32 s32, s23, 1024
buffer_load_dwordx4 v[4:7], v116, s[4:7], s32 offen sc1
s_xor_b32 s32, s23, 2048
buffer_load_dwordx4 v[8:11], v116, s[4:7], s32 offen sc1
s_sub_u32 s29, s29, 1
s_cbranch_scc1 main_kernel_end
s_waitcnt vmcnt(0)
v_max_u32 v126, v4, v6
v_cmp_eq_u32 vcc, -1, v126
s_cbranch_vccnz main_kernel_c2_o1_f
s_branch main_kernel_c2_o1
main_kernel_c2_o2_f:
s_nop 0
s_xor_b32 s32, s23, 2048
buffer_load_dwordx4 v[8:11], v116, s[4:7], s32 offen sc1
s_xor_b32 s32, s23, 3072
buffer_load_dwordx4 v[12:15], v116, s[4:7], s32 offen sc1
s_sub_u32 s29, s29, 1
s_cbranch_scc1 main_kernel_end
s_waitcnt vmcnt(0)
v_max_u32 v126, v8, v10
v_cmp_eq_u32 vcc, -1, v126
s_cbranch_vccnz main_kernel_c2_o2_f
s_branch main_kernel_c2_o2
main_kernel_c2_o3_f:
s_nop 0
s_xor_b32 s32, s23, 3072
buffer_load_dwordx4 v[12:15], v116, s[4:7], s32 offen sc1
s_xor_b32 s32, s23, 4096
buffer_load_dwordx4 v[16:19], v116, s[4:7], s32 offen sc1
s_sub_u32 s29, s29, 1
s_cbranch_scc1 main_kernel_end
s_waitcnt vmcnt(0)
v_max_u32 v126, v12, v14
v_cmp_eq_u32 vcc, -1, v126
s_cbranch_vccnz main_kernel_c2_o3_f
s_branch main_kernel_c2_o3
main_kernel_c2_o4_f:
s_nop 0
s_xor_b32 s32, s23, 4096
buffer_load_dwordx4 v[16:19], v116, s[4:7], s32 offen sc1
s_xor_b32 s32, s23, 5120
buffer_load_dwordx4 v[20:23], v116, s[4:7], s32 offen sc1
s_sub_u32 s29, s29, 1
s_cbranch_scc1 main_kernel_end
s_waitcnt vmcnt(0)
v_max_u32 v126, v16, v18
v_cmp_eq_u32 vcc, -1, v126
s_cbranch_vccnz main_kernel_c2_o4_f
s_branch main_kernel_c2_o4
main_kernel_c2_o5_f:
s_nop 0
s_xor_b32 s32, s23, 5120
buffer_load_dwordx4 v[20:23], v116, s[4:7], s32 offen sc1
s_xor_b32 s32, s23, 6144
buffer_load_dwordx4 v[24:27], v116, s[4:7], s32 offen sc1
s_sub_u32 s29, s29, 1
s_cbranch_scc1 main_kernel_end
s_waitcnt vmcnt(0)
v_max_u32 v126, v20, v22
v_cmp_eq_u32 vcc, -1, v126
s_cbranch_vccnz main_kernel_c2_o5_f
s_branch main_kernel_c2_o5
main_kernel_c2_o6_f:
s_nop 0
s_xor_b32 s32, s23, 6144
buffer_load_dwordx4 v[24:27], v116, s[4:7], s32 offen sc1
s_xor_b32 s32, s23, 7168
buffer_load_dwordx4 v[28:31], v116, s[4:7], s32 offen sc1
s_sub_u32 s29, s29, 1
s_cbranch_scc1 main_kernel_end
s_waitcnt vmcnt(0)
v_max_u32 v126, v24, v26
v_cmp_eq_u32 vcc, -1, v126
s_cbranch_vccnz main_kernel_c2_o6_f
s_branch main_kernel_c2_o6
main_kernel_c2_o7_f:
s_nop 0
s_xor_b32 s32, s23, 7168
buffer_load_dwordx4 v[28:31], v116, s[4:7], s32 offen sc1
s_sub_u32 s29, s29, 1
s_cbranch_scc1 main_kernel_end
s_waitcnt vmcnt(0)
v_max_u32 v126, v28, v30
v_cmp_eq_u32 vcc, -1, v126
s_cbranch_vccnz main_kernel_c2_o7_f
s_branch main_kernel_c2_o7
.p2align 6
main_kernel_c3_top:
s_barrier
buffer_load_dwordx4 v[0:3], v116, s[4:7], s18 offen sc1
s_add_u32 s20, s20, 0x40000
s_bitset0_b32 s20, 20
s_add_u32 s21, s21, 0x40000
s_bitset0_b32 s21, 20
s_add_u32 s22, s22, 0x40000
s_bitset0_b32 s22, 20
s_add_u32 s23, s23, 0x40000
s_bitset0_b32 s23, 20
s_xor_b32 s32, s18, 1024
buffer_load_dwordx4 v[16:19], v116, s[4:7], s32 offen sc1
s_add_u32 s3, s3, 0x40000
s_bitset0_b32 s3, 20
s_add_u32 s17, s17, 1
s_bitcmp1_b32 0x77777777, s17
s_cselect_b32 s33, 0x800, 0
s_xor_b32 s54, s54, s33
s_add_u32 s25, s25, 0x40000
s_bitset0_b32 s25, 20
s_nop 0
buffer_load_dwordx4 v[64:67], v116, s[4:7], s19 offen sc1
v_mov_b32 v80, 0
v_mov_b32 v81, 0
s_nop 3
s_xor_b32 s32, s19, 1024
buffer_load_dwordx4 v[68:71], v116, s[4:7], s32 offen sc1
v_mov_b32 v82, 0
v_mov_b32 v83, 0
s_nop 3
s_xor_b32 s32, s18, 2048
buffer_load_dwordx4 v[32:35], v116, s[4:7], s32 offen sc1
v_mov_b32 v84, 0
v_mov_b32 v85, 0
s_nop 3
s_xor_b32 s32, s19, 2048
buffer_load_dwordx4 v[72:75], v116, s[4:7], s32 offen sc1
v_mov_b32 v86, 0
v_mov_b32 v87, 0
s_nop 3
s_xor_b32 s32, s18, 3072
buffer_load_dwordx4 v[48:51], v116, s[4:7], s32 offen sc1
v_mov_b32 v88, 0
v_mov_b32 v89, 0
s_nop 3
s_xor_b32 s32, s19, 3072
buffer_load_dwordx4 v[76:79], v116, s[4:7], s32 offen sc1
s_memtime s[40:41]
s_memrealtime s[80:81]
s_memrealtime s[82:83]
s_memrealtime s[84:85]
s_memrealtime s[86:87]
s_memrealtime s[88:89]
s_memrealtime s[90:91]
s_memrealtime s[92:93]
s_memrealtime s[94:95]
s_memrealtime s[96:97]
s_memrealtime s[98:99]
s_memrealtime s[100:101]
s_sub_u32 s32, s15, s16
s_lshr_b32 s33, s17, 1
s_min_u32 s33, s33, 3
s_ashr_i32 s32, s32, s33
s_add_u32 s11, s11, s32
s_sub_u32 s32, s16, s27
s_sub_u32 s32, s32, s39
s_ashr_i32 s32, s32, 2
s_add_u32 s39, s39, s32
s_mov_b32 s27, s16
s_mov_b32 s2, s31
v_mov_b32 v126, s11
s_add_u32 s32, s43, 1590
v_mov_b32 v127, s32
s_waitcnt lgkmcnt(0)
ds_write_b32 v116, v126 offset:18432
s_add_u32 s80, s80, s82
s_add_u32 s80, s80, s84
s_add_u32 s80, s80, s86
s_add_u32 s80, s80, s88
s_add_u32 s80, s80, s90
s_add_u32 s80, s80, s92
s_add_u32 s80, s80, s94
s_add_u32 s80, s80, s96
s_add_u32 s80, s80, s98
s_add_u32 s80, s80, s100
s_lshl1_add_u32 s80, s80, s11
s_sub_u32 s15, s40, s80
s_add_u32 s32, s15, s39
v_mov_b32 v126, s32
buffer_store_dwordx2 v[126:127], off, s[4:7], s44 offset:128 sc1
v_mov_b32 v90, 0
v_mov_b32 v91, 0
s_waitcnt vmcnt(6)
v_pk_add_f16 v0, v0, v64
v_pk_add_f16 v1, v1, v65
v_pk_add_f16 v2, v2, v66
v_pk_add_f16 v3, v3, v67
v_cmp_u_f16 vcc, v0, v2
s_cbranch_vccnz main_kernel_c3_m0_f
main_kernel_c3_m0:
v_smfmac_f32_16x16x64_f16 v[80:83], v[0:3], a[0:7], v112
ds_write_b128 v116, v[0:3] offset:3072
v_smfmac_f32_16x16x64_f16 v[84:87], v[0:3], a[128:135], v112
buffer_load_dword v123, v121, s[4:7], 0 offen sc1
s_waitcnt vmcnt(6)
v_pk_add_f16 v16, v16, v68
v_pk_add_f16 v17, v17, v69
v_pk_add_f16 v18, v18, v70
v_pk_add_f16 v19, v19, v71
v_cmp_u_f16 vcc, v16, v18
s_waitcnt lgkmcnt(0)
s_barrier
ds_read_b128 v[4:7], v116 offset:2048
s_cbranch_vccnz main_kernel_c3_m1_f
main_kernel_c3_m1:
v_smfmac_f32_16x16x64_f16 v[80:83], v[16:19], a[8:15], v112
ds_write_b128 v116, v[16:19] offset:7168
v_smfmac_f32_16x16x64_f16 v[84:87], v[16:19], a[136:143], v112
ds_read_b128 v[8:11], v116 offset:1024
v_smfmac_f32_16x16x64_f16 v[88:91], v[0:3], v[128:135], v112
ds_read_b128 v[12:15], v116 offset:0
s_waitcnt lgkmcnt(3)
v_smfmac_f32_16x16x64_f16 v[80:83], v[4:7], a[32:39], v112
v_smfmac_f32_16x16x64_f16 v[84:87], v[4:7], a[160:167], v112
v_smfmac_f32_16x16x64_f16 v[88:91], v[4:7], v[136:143], v112
s_waitcnt lgkmcnt(2)
s_barrier
s_waitcnt lgkmcnt(1)
v_smfmac_f32_16x16x64_f16 v[80:83], v[8:11], a[64:71], v112
s_waitcnt vmcnt(4)
ds_read_b128 v[20:23], v116 offset:6144
v_pk_add_f16 v32, v32, v72
v_smfmac_f32_16x16x64_f16 v[84:87], v[8:11], a[192:199], v112
ds_read_b128 v[24:27], v116 offset:5120
s_waitcnt lgkmcnt(2)
v_pk_add_f16 v33, v33, v73
v_smfmac_f32_16x16x64_f16 v[80:83], v[12:15], a[96:103], v112
ds_read_b128 v[28:31], v116 offset:4096
v_pk_add_f16 v34, v34, v74
v_smfmac_f32_16x16x64_f16 v[84:87], v[12:15], a[224:231], v112
s_waitcnt lgkmcnt(2)
v_pk_add_f16 v35, v35, v75
v_smfmac_f32_16x16x64_f16 v[80:83], v[20:23], a[40:47], v112
v_cmp_u_f16 vcc, v32, v34
v_smfmac_f32_16x16x64_f16 v[84:87], v[20:23], a[168:175], v112
ds_write_b128 v116, v[32:35] offset:11264
s_cbranch_vccnz main_kernel_c3_m2_f
main_kernel_c3_m2:
v_smfmac_f32_16x16x64_f16 v[80:83], v[32:35], a[16:23], v112
buffer_load_dwordx4 v[96:99], v116, s[4:7], s28 offen sc1
v_smfmac_f32_16x16x64_f16 v[84:87], v[32:35], a[144:151], v112
s_add_u32 s28, s28, 0x40000
s_waitcnt lgkmcnt(2)
v_smfmac_f32_16x16x64_f16 v[80:83], v[24:27], a[72:79], v112
s_waitcnt vmcnt(3)
v_pk_add_f16 v48, v48, v76
v_smfmac_f32_16x16x64_f16 v[84:87], v[24:27], a[200:207], v112
s_waitcnt lgkmcnt(0)
s_barrier
ds_read_b128 v[36:39], v116 offset:10240
v_pk_add_f16 v49, v49, v77
v_smfmac_f32_16x16x64_f16 v[80:83], v[28:31], a[104:111], v112
ds_read_b128 v[40:43], v116 offset:9216
v_pk_add_f16 v50, v50, v78
v_smfmac_f32_16x16x64_f16 v[84:87], v[28:31], a[232:239], v112
ds_read_b128 v[44:47], v116 offset:8192
v_pk_add_f16 v51, v51, v79
v_smfmac_f32_16x16x64_f16 v[88:91], v[8:11], v[144:151], v112
s_waitcnt lgkmcnt(2)
v_cmp_u_f16 vcc, v48, v50
v_smfmac_f32_16x16x64_f16 v[80:83], v[36:39], a[48:55], v112
ds_write_b128 v116, v[48:51] offset:15360
s_cbranch_vccnz main_kernel_c3_m3_f
main_kernel_c3_m3:
v_smfmac_f32_16x16x64_f16 v[80:83], v[48:51], a[24:31], v112
v_smfmac_f32_16x16x64_f16 v[84:87], v[48:51], a[152:159], v112
v_smfmac_f32_16x16x64_f16 v[84:87], v[36:39], a[176:183], v112
s_waitcnt lgkmcnt(2)
v_smfmac_f32_16x16x64_f16 v[80:83], v[40:43], a[80:87], v112
s_waitcnt lgkmcnt(0)
s_barrier
ds_read_b128 v[52:55], v116 offset:14336
v_smfmac_f32_16x16x64_f16 v[84:87], v[40:43], a[208:215], v112
s_memtime s[40:41]
ds_read_b128 v[56:59], v116 offset:13312
v_smfmac_f32_16x16x64_f16 v[80:83], v[44:47], a[112:119], v112
s_add_u32 s19, s52, s54
ds_read_b128 v[60:63], v116 offset:12288
v_smfmac_f32_16x16x64_f16 v[84:87], v[44:47], a[240:247], v112
s_add_u32 s18, s18, 0x40000
s_waitcnt lgkmcnt(2)
v_smfmac_f32_16x16x64_f16 v[80:83], v[52:55], a[56:63], v112
s_bitset0_b32 s18, 20
s_waitcnt lgkmcnt(1)
v_smfmac_f32_16x16x64_f16 v[80:83], v[56:59], a[88:95], v112
s_cmp_eq_u32 s17, 30
s_cselect_b32 s32, s53, 0x10000
s_waitcnt lgkmcnt(0)
v_smfmac_f32_16x16x64_f16 v[80:83], v[60:63], a[120:127], v112
s_add_u32 s52, s52, s32
ds_read_b128 v[64:67], v116 offset:24576
v_smfmac_f32_16x16x64_f16 v[84:87], v[52:55], a[184:191], v112
s_sub_u32 s24, 0x20000, s32
ds_read_b128 v[68:71], v116 offset:28672
v_smfmac_f32_16x16x64_f16 v[84:87], v[56:59], a[216:223], v112
ds_read_b128 v[72:75], v116 offset:25600
s_add_u32 s55, s55, s24
v_cvt_pk_bf16_f32 v92, v80, v81
v_smfmac_f32_16x16x64_f16 v[84:87], v[60:63], a[248:255], v112
ds_read_b128 v[76:79], v116 offset:29696
s_nop 0
v_cvt_pk_bf16_f32 v93, v82, v83
v_smfmac_f32_16x16x64_f16 v[88:91], v[12:15], v[152:159], v112
s_nop 3
v_cvt_pk_bf16_f32 v94, v84, v85
v_cvt_pk_bf16_f32 v95, v86, v87
s_mov_b32 vcc_lo, 0xcccccccc
s_mov_b32 vcc_hi, 0xcccccccc
v_mfma_f32_16x16x32_bf16 v[84:87], v[92:95], v[104:107], 0
v_add_u32 v121, v121, v122
s_waitcnt lgkmcnt(0)
s_sub_u32 s31, s40, s11
v_smfmac_f32_16x16x64_f16 v[88:91], v[16:19], v[160:167], v112
s_sub_u32 s32, s31, s43
s_sub_u32 s47, 1590, s32
s_max_i32 s47, s47, 0
s_cmp_eq_u32 s17, 63
v_cvt_pk_bf16_f32 v114, v84, v85
v_cvt_pk_bf16_f32 v115, v86, v87
buffer_store_dwordx2 v[114:115], v117, s[4:7], s21 offen
s_cbranch_scc1 main_kernel_c3_last
ds_write_b64 v117, v[114:115] offset:17920
v_smfmac_f32_16x16x64_f16 v[88:91], v[20:23], v[168:175], v112
s_cmp_gt_u32 s32, 1790
s_cselect_b32 s33, 900, s47
v_smfmac_f32_16x16x64_f16 v[88:91], v[24:27], v[176:183], v112
s_add_u32 s10, s33, s31
s_andn2_b32 s42, s44, 0x1f00
v_mov_b32 v126, s15
v_smfmac_f32_16x16x64_f16 v[88:91], v[28:31], v[184:191], v112
s_add_u32 s42, s42, 0x4000
v_mov_b32 v127, s10
v_smfmac_f32_16x16x64_f16 v[88:91], v[32:35], v[192:199], v112
.p2align 3
main_kernel_c3_b21:
s_sub_u32 s47, s47, 28
s_cbranch_scc0 main_kernel_c3_b21
s_waitcnt lgkmcnt(0)
s_barrier
ds_read_b128 v[0:3], v116 offset:16384
v_smfmac_f32_16x16x64_f16 v[88:91], v[36:39], v[200:207], v112
ds_read_b128 v[4:7], v116 offset:17408
buffer_store_dwordx2 v[126:127], off, s[4:7], s46
v_smfmac_f32_16x16x64_f16 v[88:91], v[40:43], v[208:215], v112
ds_read_b128 v[16:19], v116 offset:26624
s_cmp_gt_u32 s32, 1790
s_cselect_b32 s80, s44, 0x7f000000
v_smfmac_f32_16x16x64_f16 v[88:91], v[44:47], v[216:223], v112
ds_read_b128 v[20:23], v116 offset:30720
v_writelane_b32 v121, s55, 39
v_smfmac_f32_16x16x64_f16 v[88:91], v[48:51], v[224:231], v112
ds_read_b128 v[24:27], v116 offset:27648
v_smfmac_f32_16x16x64_f16 v[88:91], v[52:55], v[232:239], v112
ds_read_b128 v[28:31], v116 offset:31744
v_smfmac_f32_16x16x64_f16 v[88:91], v[56:59], v[240:247], v112
v_smfmac_f32_16x16x64_f16 v[88:91], v[60:63], v[248:255], v112
s_waitcnt lgkmcnt(5)
v_mfma_f32_16x16x32_bf16 v[80:83], v[64:67], v[0:3], 0
v_mfma_f32_16x16x32_bf16 v[84:87], v[68:71], v[0:3], 0
buffer_load_dwordx4 v[8:11], v116, s[4:7], s20 offen offset:0 sc1
v_mfma_f32_16x16x32_bf16 v[92:95], v[0:3], v[0:3], 0
buffer_load_dwordx4 v[12:15], v116, s[4:7], s20 offen offset:1024 sc1
v_permlane32_swap_b32 v88, v90
s_waitcnt lgkmcnt(4)
v_mfma_f32_16x16x32_bf16 v[80:83], v[72:75], v[4:7], v[80:83]
v_permlane32_swap_b32 v89, v91
v_mfma_f32_16x16x32_bf16 v[84:87], v[76:79], v[4:7], v[84:87]
v_pk_add_f32 v[88:89], v[88:89], v[90:91]
v_mfma_f32_16x16x32_bf16 v[92:95], v[4:7], v[4:7], v[92:95]
v_cvt_pk_bf16_f32 v124, v88, v89
s_andn2_b32 s35, s46, 0xff
v_bfe_u32 v68, v116, 1, 8
v_mov_b32 v65, 0
buffer_load_dwordx2 v[66:67], v68, s[4:7], s35 offen sc1
buffer_store_dword v127, off, s[4:7], s80 offset:132 sc1
s_waitcnt lgkmcnt(0)
s_waitcnt vmcnt(3)
v_mfma_f32_16x16x32_bf16 v[88:91], v[8:11], v[8:11], v[92:95]
v_mfma_f32_16x16x32_bf16 v[0:3], v[16:19], v[8:11], v[80:83]
v_cmp_u_f32 s[0:1], v8, v10
v_mfma_f32_16x16x32_bf16 v[4:7], v[20:23], v[8:11], v[84:87]
s_waitcnt vmcnt(2)
v_mfma_f32_16x16x32_bf16 v[88:91], v[12:15], v[12:15], v[88:91]
v_mfma_f32_16x16x32_bf16 v[0:3], v[24:27], v[12:15], v[0:3]
v_cmp_u_f32 s[32:33], v12, v14
v_mfma_f32_16x16x32_bf16 v[4:7], v[28:31], v[12:15], v[4:7]
s_or_b64 s[0:1], s[0:1], s[32:33]
s_cbranch_scc1 main_kernel_c3_z_f
main_kernel_c3_z:
v_mul_f32 v88, s30, v88
v_mul_f32 v89, s30, v89
v_exp_f32 v88, v88
v_exp_f32 v89, v89
v_cndmask_b32_dpp v0, v2, v0, vcc quad_perm:[2,3,2,3] row_mask:0xf bank_mask:0xf
v_cvt_pk_bf16_f32 v64, v88, v89
v_cndmask_b32_dpp v1, v3, v1, vcc quad_perm:[2,3,2,3] row_mask:0xf bank_mask:0xf
v_exp_f32 v0, v0
v_mfma_f32_16x16x16_bf16 v[16:19], v[100:101], v[64:65], 0
v_exp_f32 v1, v1
v_cndmask_b32_dpp v4, v6, v4, vcc quad_perm:[2,3,2,3] row_mask:0xf bank_mask:0xf
v_mfma_f32_16x16x16_bf16 v[8:11], v[124:125], v[64:65], 0
v_cndmask_b32_dpp v5, v7, v5, vcc quad_perm:[2,3,2,3] row_mask:0xf bank_mask:0xf
v_exp_f32 v4, v4
v_exp_f32 v5, v5
v_cvt_pk_bf16_f32 v92, v0, v1
v_cvt_pk_bf16_f32 v94, v4, v5
v_mov_b32 v80, 0
v_mov_b32_dpp v93, v92 quad_perm:[0,1,0,1] row_mask:0xf bank_mask:0xf
v_mov_b32_dpp v95, v94 quad_perm:[0,1,0,1] row_mask:0xf bank_mask:0xf
v_mov_b32 v81, 0
v_mov_b32 v82, 0
v_mfma_f32_16x16x32_bf16 v[16:19], v[100:103], v[92:95], v[16:19]
v_mov_b32 v83, 0
v_mov_b32 v84, 0
v_mfma_f32_16x16x32_bf16 v[8:11], v[96:99], v[92:95], v[8:11]
s_buffer_load_dword s42, s[4:7], s42
s_nop 1
v_mov_b32 v85, 0
v_mov_b32 v86, 0
v_mov_b32 v87, 0
v_rcp_f32 v126, v16
v_subrev_u32 v127, 0x21800000, v16
v_cmp_lt_u32 vcc, 0x3c000000, v127
v_pk_mul_f32 v[8:9], v[8:9], v[126:127] op_sel_hi:[1,0]
v_pk_mul_f32 v[10:11], v[10:11], v[126:127] op_sel_hi:[1,0]
s_and_b32 s32, vcc_lo, 0xcccc
v_cvt_pk_bf16_f32 v126, v8, v9
v_cvt_pk_bf16_f32 v127, v10, v11
s_cbranch_scc1 main_kernel_c3_sm_f
main_kernel_c3_ost:
buffer_store_dwordx2 v[126:127], v118, s[4:7], s22 offen
s_waitcnt vmcnt(2)
main_kernel_c3_to0:
s_memtime s[40:41]
v_readlane_b32 s16, v66, 0
v_subrev_u32 v67, s2, v67
s_add_u32 s34, s11, s2
s_nop 0
v_max_u32_dpp v67, v67, v67 row_ror:8 row_mask:0xf bank_mask:0xf
s_nop 1
v_max_u32_dpp v67, v67, v67 row_ror:4 row_mask:0xf bank_mask:0xf
s_nop 1
v_max_u32_dpp v67, v67, v67 row_ror:2 row_mask:0xf bank_mask:0xf
s_nop 1
v_max_u32_dpp v67, v67, v67 row_ror:1 row_mask:0xf bank_mask:0xf
s_waitcnt lgkmcnt(0)
v_readlane_b32 s32, v67, 0
v_readlane_b32 s33, v67, 16
s_sub_u32 s34, s40, s34
s_max_u32 s32, s32, s33
s_add_u32 s35, s34, 1536
s_cmp_gt_u32 s32, s35
s_cbranch_scc1 main_kernel_c3_to2
main_kernel_c3_to3:
s_sub_u32 s33, s42, s2
s_cmp_le_u32 s33, s35
s_cselect_b32 s33, s33, 0
s_max_u32 s32, s32, s33
s_add_u32 s36, s32, 2750
s_add_u32 s32, s32, 1270
s_sub_u32 s47, s32, s34
s_max_i32 s47, s47, 0
.p2align 3
main_kernel_c3_to1:
s_sub_u32 s47, s47, 28
s_cbranch_scc0 main_kernel_c3_to1
s_barrier
buffer_load_dwordx4 v[0:3], v116, s[4:7], s23 offen sc1
ds_read_b128 v[32:35], v113 offset:0
ds_read_b128 v[36:39], v113 offset:1024
s_add_u32 s46, s46, 0x40000
s_bitset0_b32 s46, 20
s_add_u32 s37, s37, 65536
s_add_u32 s26, s26, 65536
s_xor_b32 s32, s23, 1024
buffer_load_dwordx4 v[4:7], v116, s[4:7], s32 offen sc1
ds_read_b128 v[40:43], v113 offset:2048
ds_read_b128 v[44:47], v113 offset:3072
s_add_u32 s44, s44, s24
s_nop 2
s_xor_b32 s32, s23, 2048
buffer_load_dwordx4 v[8:11], v116, s[4:7], s32 offen sc1
ds_read_b128 v[48:51], v113 offset:4096
ds_read_b128 v[52:55], v113 offset:5120
s_nop 3
s_xor_b32 s32, s23, 3072
buffer_load_dwordx4 v[12:15], v116, s[4:7], s32 offen sc1
ds_read_b128 v[56:59], v113 offset:6144
ds_read_b128 v[60:63], v113 offset:7168
s_nop 3
s_xor_b32 s32, s23, 4096
buffer_load_dwordx4 v[16:19], v116, s[4:7], s32 offen sc1
ds_read_b128 v[64:67], v113 offset:8192
ds_read_b128 v[68:71], v113 offset:9216
s_nop 3
s_xor_b32 s32, s23, 5120
buffer_load_dwordx4 v[20:23], v116, s[4:7], s32 offen sc1
ds_read_b128 v[72:75], v113 offset:10240
ds_read_b128 v[76:79], v113 offset:11264
s_nop 3
s_xor_b32 s32, s23, 6144
buffer_load_dwordx4 v[24:27], v116, s[4:7], s32 offen sc1
ds_read_b128 v[88:91], v113 offset:12288
ds_read_b128 v[92:95], v113 offset:13312
s_nop 3
s_xor_b32 s32, s23, 7168
buffer_load_dwordx4 v[28:31], v116, s[4:7], s32 offen sc1
v_and_b32 v127, 0x1f0, v116
v_lshlrev_b32 v127, 4, v127
s_waitcnt lgkmcnt(12)
s_waitcnt vmcnt(7)
v_cmp_u_f32 vcc, v0, v2
s_cbranch_vccnz main_kernel_c3_o0_f
main_kernel_c3_o0:
v_smfmac_f32_16x16x64_bf16 v[80:83], v[0:3], v[32:39], v112
ds_read_b128 v[32:35], v113 offset:14336
ds_read_b128 v[36:39], v113 offset:15360
buffer_load_dwordx2 v[96:97], v127, s[4:7], s45 offen offset:128 sc1
s_waitcnt lgkmcnt(12)
s_waitcnt vmcnt(7)
v_cmp_u_f32 vcc, v4, v6
v_smfmac_f32_16x16x64_bf16 v[84:87], v[0:3], v[40:47], v112
ds_read_b128 v[40:43], v113 offset:16384
ds_read_b128 v[44:47], v113 offset:17408
buffer_store_dwordx2 v[114:115], v119, s[4:7], s37 offen sc1
s_cbranch_vccnz main_kernel_c3_o1_f
main_kernel_c3_o1:
s_waitcnt lgkmcnt(12)
v_smfmac_f32_16x16x64_bf16 v[80:83], v[4:7], v[48:55], v112
ds_read_b128 v[48:51], v113 offset:18432
ds_read_b128 v[52:55], v113 offset:19456
s_waitcnt lgkmcnt(12)
s_waitcnt vmcnt(7)
v_cmp_u_f32 vcc, v8, v10
v_smfmac_f32_16x16x64_bf16 v[84:87], v[4:7], v[56:63], v112
ds_read_b128 v[56:59], v113 offset:20480
ds_read_b128 v[60:63], v113 offset:21504
buffer_store_dword v124, v120, s[4:7], s26 offen sc1
s_cbranch_vccnz main_kernel_c3_o2_f
main_kernel_c3_o2:
s_waitcnt lgkmcnt(12)
v_smfmac_f32_16x16x64_bf16 v[80:83], v[8:11], v[64:71], v112
ds_read_b128 v[64:67], v113 offset:22528
ds_read_b128 v[68:71], v113 offset:23552
s_waitcnt lgkmcnt(12)
s_waitcnt vmcnt(7)
v_cmp_u_f32 vcc, v12, v14
v_smfmac_f32_16x16x64_bf16 v[84:87], v[8:11], v[72:79], v112
ds_read_b128 v[72:75], v113 offset:24576
ds_read_b128 v[76:79], v113 offset:25600
s_cbranch_vccnz main_kernel_c3_o3_f
main_kernel_c3_o3:
s_waitcnt lgkmcnt(12)
v_smfmac_f32_16x16x64_bf16 v[80:83], v[12:15], v[88:95], v112
ds_read_b128 v[88:91], v113 offset:26624
ds_read_b128 v[92:95], v113 offset:27648
s_waitcnt lgkmcnt(12)
s_waitcnt vmcnt(6)
v_cmp_u_f32 vcc, v16, v18
v_smfmac_f32_16x16x64_bf16 v[84:87], v[12:15], v[32:39], v112
ds_read_b128 v[32:35], v113 offset:28672
ds_read_b128 v[36:39], v113 offset:29696
s_cbranch_vccnz main_kernel_c3_o4_f
main_kernel_c3_o4:
s_waitcnt lgkmcnt(12)
v_smfmac_f32_16x16x64_bf16 v[80:83], v[16:19], v[40:47], v112
ds_read_b128 v[40:43], v113 offset:30720
ds_read_b128 v[44:47], v113 offset:31744
s_waitcnt lgkmcnt(12)
s_waitcnt vmcnt(5)
v_cmp_u_f32 vcc, v20, v22
v_smfmac_f32_16x16x64_bf16 v[84:87], v[16:19], v[48:55], v112
s_cbranch_vccnz main_kernel_c3_o5_f
main_kernel_c3_o5:
s_waitcnt lgkmcnt(10)
v_smfmac_f32_16x16x64_bf16 v[80:83], v[20:23], v[56:63], v112
s_waitcnt lgkmcnt(8)
s_waitcnt vmcnt(4)
v_cmp_u_f32 vcc, v24, v26
v_smfmac_f32_16x16x64_bf16 v[84:87], v[20:23], v[64:71], v112
s_cbranch_vccnz main_kernel_c3_o6_f
main_kernel_c3_o6:
s_waitcnt lgkmcnt(6)
v_smfmac_f32_16x16x64_bf16 v[80:83], v[24:27], v[72:79], v112
s_waitcnt lgkmcnt(4)
v_smfmac_f32_16x16x64_bf16 v[84:87], v[24:27], v[88:95], v112
s_waitcnt lgkmcnt(2)
s_waitcnt vmcnt(3)
v_cmp_u_f32 vcc, v28, v30
s_cbranch_vccnz main_kernel_c3_o7_f
main_kernel_c3_o7:
v_smfmac_f32_16x16x64_bf16 v[80:83], v[28:31], v[32:39], v112
s_waitcnt lgkmcnt(0)
v_smfmac_f32_16x16x64_bf16 v[84:87], v[28:31], v[40:47], v112
s_nop 4
v_cvt_pk_bf16_f32 v80, v80, v81
v_cvt_pk_bf16_f32 v81, v82, v83
ds_write_b64 v116, v[80:81] offset:21512
v_cvt_pk_bf16_f32 v82, v84, v85
v_cvt_pk_bf16_f32 v83, v86, v87
ds_write_b64 v116, v[82:83] offset:23560
s_waitcnt lgkmcnt(0)
s_barrier
ds_read_b128 v[72:75], v116 offset:22528
ds_read_b128 v[76:79], v116 offset:23552
s_waitcnt lgkmcnt(1)
v_mfma_f32_16x16x32_bf16 v[64:67], v[72:75], v[108:111], 0
s_waitcnt lgkmcnt(0)
v_mfma_f32_16x16x32_bf16 v[64:67], v[76:79], v[108:111], v[64:67]
s_nop 7
v_cvt_pk_f16_f32 v68, v64, v65
v_cvt_pk_f16_f32 v69, v66, v67
buffer_store_dwordx2 v[68:69], v125, s[4:7], s25 offen
s_sub_u32 s0, s2, s16
s_sub_u32 s0, s0, s39
s_waitcnt vmcnt(3)
main_kernel_c3_tm0:
s_memtime s[40:41]
v_sub_u32 v97, v97, v96
v_subrev_u32 v97, s0, v97
s_add_u32 s34, s11, s2
s_nop 0
v_max_u32_dpp v97, v97, v97 row_ror:8 row_mask:0xf bank_mask:0xf
s_nop 1
v_max_u32_dpp v97, v97, v97 row_ror:4 row_mask:0xf bank_mask:0xf
s_nop 1
v_max_u32_dpp v97, v97, v97 row_ror:2 row_mask:0xf bank_mask:0xf
s_nop 1
v_max_u32_dpp v97, v97, v97 row_ror:1 row_mask:0xf bank_mask:0xf
s_waitcnt lgkmcnt(0)
v_readlane_b32 s32, v97, 0
v_readlane_b32 s33, v97, 16
s_sub_u32 s34, s40, s34
s_max_u32 s32, s32, s33
s_add_u32 s35, s34, 1536
s_cmp_gt_u32 s32, s35
s_cbranch_scc1 main_kernel_c3_tm2
main_kernel_c3_tm3:
s_add_u32 s32, s32, 2750
s_max_u32 s32, s32, s36
s_add_u32 s43, s32, s2
s_sub_u32 s47, s32, s34
s_max_i32 s47, s47, 0
.p2align 3
main_kernel_c3_tm1:
s_sub_u32 s47, s47, 28
s_cbranch_scc0 main_kernel_c3_tm1
s_add_u32 s45, s45, s24
s_branch main_kernel_c3_top
main_kernel_c3_to2:
s_mov_b32 s32, s34
s_mov_b32 s16, s15
s_cmp_gt_u32 s34, 0x40000
s_cbranch_scc1 main_kernel_c3_to3
s_andn2_b32 s35, s46, 0xff
v_bfe_u32 v68, v116, 1, 8
buffer_load_dwordx2 v[66:67], v68, s[4:7], s35 offen sc1
s_sub_u32 s29, s29, 1
s_cbranch_scc1 main_kernel_end
s_cmp_lg_u32 s17, 0
s_cbranch_scc1 main_kernel_c3_to7
s_memtime s[40:41]
s_memrealtime s[80:81]
s_memrealtime s[82:83]
s_memrealtime s[84:85]
s_memrealtime s[86:87]
s_memrealtime s[88:89]
s_memrealtime s[90:91]
s_memrealtime s[92:93]
s_memrealtime s[94:95]
s_memrealtime s[96:97]
s_memrealtime s[98:99]
s_memrealtime s[100:101]
s_waitcnt lgkmcnt(0)
s_add_u32 s80, s80, s82
s_add_u32 s80, s80, s84
s_add_u32 s80, s80, s86
s_add_u32 s80, s80, s88
s_add_u32 s80, s80, s90
s_add_u32 s80, s80, s92
s_add_u32 s80, s80, s94
s_add_u32 s80, s80, s96
s_add_u32 s80, s80, s98
s_add_u32 s80, s80, s100
s_lshl1_add_u32 s80, s80, s15
s_sub_u32 s11, s40, s80
main_kernel_c3_to7:
s_waitcnt vmcnt(0)
s_branch main_kernel_c3_to0
main_kernel_c3_tm2:
s_mov_b32 s32, s34
s_cmp_gt_u32 s34, 0x40000
s_cbranch_scc1 main_kernel_c3_tm3
v_and_b32 v127, 0x1f0, v116
v_lshlrev_b32 v127, 4, v127
buffer_load_dwordx2 v[96:97], v127, s[4:7], s45 offen offset:128 sc1
s_sub_u32 s29, s29, 1
s_cbranch_scc1 main_kernel_end
s_cmp_lg_u32 s17, 0
s_cbranch_scc1 main_kernel_c3_tm7
s_memtime s[40:41]
s_memrealtime s[80:81]
s_memrealtime s[82:83]
s_memrealtime s[84:85]
s_memrealtime s[86:87]
s_memrealtime s[88:89]
s_memrealtime s[90:91]
s_memrealtime s[92:93]
s_memrealtime s[94:95]
s_memrealtime s[96:97]
s_memrealtime s[98:99]
s_memrealtime s[100:101]
s_waitcnt lgkmcnt(0)
s_add_u32 s80, s80, s82
s_add_u32 s80, s80, s84
s_add_u32 s80, s80, s86
s_add_u32 s80, s80, s88
s_add_u32 s80, s80, s90
s_add_u32 s80, s80, s92
s_add_u32 s80, s80, s94
s_add_u32 s80, s80, s96
s_add_u32 s80, s80, s98
s_add_u32 s80, s80, s100
s_lshl1_add_u32 s80, s80, s15
s_sub_u32 s11, s40, s80
main_kernel_c3_tm7:
s_waitcnt vmcnt(0)
s_branch main_kernel_c3_tm0
main_kernel_c3_last:
s_add_u32 s37, s37, 65536
s_add_u32 s26, s26, 65536
buffer_store_dwordx2 v[114:115], v119, s[4:7], s37 offen sc1
v_smfmac_f32_16x16x64_f16 v[88:91], v[20:23], v[168:175], v112
v_smfmac_f32_16x16x64_f16 v[88:91], v[24:27], v[176:183], v112
v_smfmac_f32_16x16x64_f16 v[88:91], v[28:31], v[184:191], v112
v_smfmac_f32_16x16x64_f16 v[88:91], v[32:35], v[192:199], v112
v_smfmac_f32_16x16x64_f16 v[88:91], v[36:39], v[200:207], v112
v_smfmac_f32_16x16x64_f16 v[88:91], v[40:43], v[208:215], v112
v_smfmac_f32_16x16x64_f16 v[88:91], v[44:47], v[216:223], v112
v_smfmac_f32_16x16x64_f16 v[88:91], v[48:51], v[224:231], v112
v_smfmac_f32_16x16x64_f16 v[88:91], v[52:55], v[232:239], v112
v_smfmac_f32_16x16x64_f16 v[88:91], v[56:59], v[240:247], v112
v_smfmac_f32_16x16x64_f16 v[88:91], v[60:63], v[248:255], v112
s_nop 7
v_permlane32_swap_b32 v88, v90
s_nop 1
v_permlane32_swap_b32 v89, v91
s_nop 1
v_pk_add_f32 v[88:89], v[88:89], v[90:91]
s_nop 1
v_cvt_pk_bf16_f32 v124, v88, v89
s_nop 1
buffer_store_dword v124, v120, s[4:7], s26 offen sc1
s_branch main_kernel_end
main_kernel_c3_m0_f:
s_waitcnt lgkmcnt(0)
buffer_load_dwordx4 v[0:3], v116, s[4:7], s18 offen sc1
buffer_load_dwordx4 v[64:67], v116, s[4:7], s19 offen sc1
s_xor_b32 s32, s18, 1024
buffer_load_dwordx4 v[16:19], v116, s[4:7], s32 offen sc1
s_xor_b32 s32, s19, 1024
buffer_load_dwordx4 v[68:71], v116, s[4:7], s32 offen sc1
s_xor_b32 s32, s18, 2048
buffer_load_dwordx4 v[32:35], v116, s[4:7], s32 offen sc1
s_xor_b32 s32, s19, 2048
buffer_load_dwordx4 v[72:75], v116, s[4:7], s32 offen sc1
s_xor_b32 s32, s18, 3072
buffer_load_dwordx4 v[48:51], v116, s[4:7], s32 offen sc1
s_xor_b32 s32, s19, 3072
buffer_load_dwordx4 v[76:79], v116, s[4:7], s32 offen sc1
s_sub_u32 s29, s29, 1
s_cbranch_scc1 main_kernel_end
s_waitcnt vmcnt(0)
v_max_u32 v126, v0, v2
v_max3_u32 v126, v126, v64, v66
v_cmp_eq_u32 vcc, -1, v126
s_cbranch_vccnz main_kernel_c3_m0_f
v_pk_add_f16 v0, v0, v64
v_pk_add_f16 v1, v1, v65
v_pk_add_f16 v2, v2, v66
v_pk_add_f16 v3, v3, v67
s_nop 0
s_branch main_kernel_c3_m0
main_kernel_c3_m1_f:
s_waitcnt lgkmcnt(0)
s_xor_b32 s32, s18, 1024
buffer_load_dwordx4 v[16:19], v116, s[4:7], s32 offen sc1
s_xor_b32 s32, s19, 1024
buffer_load_dwordx4 v[68:71], v116, s[4:7], s32 offen sc1
s_xor_b32 s32, s18, 2048
buffer_load_dwordx4 v[32:35], v116, s[4:7], s32 offen sc1
s_xor_b32 s32, s19, 2048
buffer_load_dwordx4 v[72:75], v116, s[4:7], s32 offen sc1
s_xor_b32 s32, s18, 3072
buffer_load_dwordx4 v[48:51], v116, s[4:7], s32 offen sc1
s_xor_b32 s32, s19, 3072
buffer_load_dwordx4 v[76:79], v116, s[4:7], s32 offen sc1
s_sub_u32 s29, s29, 1
s_cbranch_scc1 main_kernel_end
s_waitcnt vmcnt(0)
v_max_u32 v126, v16, v18
v_max3_u32 v126, v126, v68, v70
v_cmp_eq_u32 vcc, -1, v126
s_cbranch_vccnz main_kernel_c3_m1_f
v_pk_add_f16 v16, v16, v68
v_pk_add_f16 v17, v17, v69
v_pk_add_f16 v18, v18, v70
v_pk_add_f16 v19, v19, v71
s_nop 0
s_branch main_kernel_c3_m1
main_kernel_c3_m2_f:
s_waitcnt lgkmcnt(0)
s_xor_b32 s32, s18, 2048
buffer_load_dwordx4 v[32:35], v116, s[4:7], s32 offen sc1
s_xor_b32 s32, s19, 2048
buffer_load_dwordx4 v[72:75], v116, s[4:7], s32 offen sc1
s_xor_b32 s32, s18, 3072
buffer_load_dwordx4 v[48:51], v116, s[4:7], s32 offen sc1
s_xor_b32 s32, s19, 3072
buffer_load_dwordx4 v[76:79], v116, s[4:7], s32 offen sc1
s_sub_u32 s29, s29, 1
s_cbranch_scc1 main_kernel_end
s_waitcnt vmcnt(0)
v_max_u32 v126, v32, v34
v_max3_u32 v126, v126, v72, v74
v_cmp_eq_u32 vcc, -1, v126
s_cbranch_vccnz main_kernel_c3_m2_f
v_pk_add_f16 v32, v32, v72
v_pk_add_f16 v33, v33, v73
v_pk_add_f16 v34, v34, v74
v_pk_add_f16 v35, v35, v75
ds_write_b128 v116, v[32:35] offset:11264
s_branch main_kernel_c3_m2
main_kernel_c3_m3_f:
s_waitcnt lgkmcnt(0)
s_xor_b32 s32, s18, 3072
buffer_load_dwordx4 v[48:51], v116, s[4:7], s32 offen sc1
s_xor_b32 s32, s19, 3072
buffer_load_dwordx4 v[76:79], v116, s[4:7], s32 offen sc1
s_sub_u32 s29, s29, 1
s_cbranch_scc1 main_kernel_end
s_waitcnt vmcnt(0)
v_max_u32 v126, v48, v50
v_max3_u32 v126, v126, v76, v78
v_cmp_eq_u32 vcc, -1, v126
s_cbranch_vccnz main_kernel_c3_m3_f
v_pk_add_f16 v48, v48, v76
v_pk_add_f16 v49, v49, v77
v_pk_add_f16 v50, v50, v78
v_pk_add_f16 v51, v51, v79
ds_write_b128 v116, v[48:51] offset:15360
s_branch main_kernel_c3_m3
main_kernel_c3_z_f:
buffer_load_dwordx4 v[8:11], v116, s[4:7], s20 offen offset:0 sc1
buffer_load_dwordx4 v[12:15], v116, s[4:7], s20 offen offset:1024 sc1
s_memtime s[32:33]
ds_read_b32 v126, v116 offset:18432
s_sub_u32 s34, s19, s54
s_xor_b32 s34, s34, 0x2000
s_lshl_b32 s35, s12, 15
s_add_u32 s34, s34, s35
s_lshl_b32 s35, s13, 8
s_add_u32 s35, s35, s34
s_add_u32 s34, s34, 0x4000
s_waitcnt lgkmcnt(0)
s_sub_u32 s32, s32, 450
v_sub_u32 v126, s32, v126
v_max_u32 v127, v126, v127
buffer_store_dword v127, off, s[4:7], s34
s_sub_u32 s29, s29, 1
s_cbranch_scc1 main_kernel_end
s_waitcnt vmcnt(1)
main_kernel_c3_z_g:
v_max_u32 v126, v8, v10
v_max3_u32 v126, v126, v12, v14
v_cmp_eq_u32 vcc, -1, v126
s_cbranch_vccnz main_kernel_c3_z_h
v_mfma_f32_16x16x32_bf16 v[88:91], v[8:11], v[8:11], v[92:95]
v_mfma_f32_16x16x32_bf16 v[0:3], v[16:19], v[8:11], v[80:83]
v_mfma_f32_16x16x32_bf16 v[4:7], v[20:23], v[8:11], v[84:87]
v_mfma_f32_16x16x32_bf16 v[88:91], v[12:15], v[12:15], v[88:91]
v_mfma_f32_16x16x32_bf16 v[0:3], v[24:27], v[12:15], v[0:3]
v_mfma_f32_16x16x32_bf16 v[4:7], v[28:31], v[12:15], v[4:7]
buffer_store_dword v127, off, s[4:7], s35 offset:132 sc1
s_mov_b32 vcc_lo, 0xcccccccc
s_mov_b32 vcc_hi, 0xcccccccc
s_branch main_kernel_c3_z
main_kernel_c3_z_h:
buffer_load_dwordx4 v[8:11], v116, s[4:7], s20 offen offset:0 sc1
buffer_load_dwordx4 v[12:15], v116, s[4:7], s20 offen offset:1024 sc1
s_sub_u32 s29, s29, 1
s_cbranch_scc1 main_kernel_end
v_add_u32 v127, 300, v127
s_waitcnt vmcnt(0)
s_branch main_kernel_c3_z_g
main_kernel_c3_sm_f:
s_waitcnt vmcnt(0) lgkmcnt(0)
buffer_load_dwordx4 v[8:11], v116, s[4:7], s20 offen offset:0 sc1
buffer_load_dwordx4 v[12:15], v116, s[4:7], s20 offen offset:1024 sc1
ds_read_b128 v[0:3], v116 offset:16384
ds_read_b128 v[4:7], v116 offset:17408
ds_read_b128 v[64:67], v116 offset:24576
ds_read_b128 v[68:71], v116 offset:28672
ds_read_b128 v[72:75], v116 offset:25600
ds_read_b128 v[76:79], v116 offset:29696
ds_read_b128 v[16:19], v116 offset:26624
ds_read_b128 v[20:23], v116 offset:30720
ds_read_b128 v[24:27], v116 offset:27648
ds_read_b128 v[28:31], v116 offset:31744
s_waitcnt vmcnt(0)
s_waitcnt lgkmcnt(0)
v_mfma_f32_16x16x32_bf16 v[80:83], v[64:67], v[0:3], 0
v_mfma_f32_16x16x32_bf16 v[84:87], v[68:71], v[0:3], 0
v_mfma_f32_16x16x32_bf16 v[92:95], v[0:3], v[0:3], 0
v_mfma_f32_16x16x32_bf16 v[80:83], v[72:75], v[4:7], v[80:83]
v_mfma_f32_16x16x32_bf16 v[84:87], v[76:79], v[4:7], v[84:87]
v_mfma_f32_16x16x32_bf16 v[92:95], v[4:7], v[4:7], v[92:95]
v_mfma_f32_16x16x32_bf16 v[0:3], v[16:19], v[8:11], v[80:83]
v_mfma_f32_16x16x32_bf16 v[4:7], v[20:23], v[8:11], v[84:87]
v_mfma_f32_16x16x32_bf16 v[88:91], v[8:11], v[8:11], v[92:95]
v_mfma_f32_16x16x32_bf16 v[0:3], v[24:27], v[12:15], v[0:3]
v_mfma_f32_16x16x32_bf16 v[4:7], v[28:31], v[12:15], v[4:7]
v_mfma_f32_16x16x32_bf16 v[88:91], v[12:15], v[12:15], v[88:91]
s_nop 7
v_mov_b32 v65, 0
v_max_f32 v126, v88, v89
v_mul_f32 v126, s30, v126
v_max3_f32 v126, v126, v0, v1
v_max3_f32 v126, v126, v2, v3
v_max3_f32 v126, v126, v4, v5
v_max3_f32 v126, v126, v6, v7
v_mov_b32 v127, v126
s_nop 1
v_permlane32_swap_b32 v126, v127
v_max_f32 v126, v126, v127
v_mov_b32 v127, v126
s_nop 1
v_permlane16_swap_b32 v126, v127
v_max_f32 v126, v126, v127
v_mul_f32 v127, 0x40faf233, v126
s_mov_b32 vcc_lo, 0xcccccccc
s_mov_b32 vcc_hi, 0xcccccccc
v_sub_f32 v0, v0, v126
v_sub_f32 v1, v1, v126
v_sub_f32 v2, v2, v126
v_sub_f32 v3, v3, v126
v_sub_f32 v4, v4, v126
v_sub_f32 v5, v5, v126
v_sub_f32 v6, v6, v126
v_sub_f32 v7, v7, v126
v_sub_f32 v88, v88, v127
v_sub_f32 v89, v89, v127
s_waitcnt lgkmcnt(0)
s_nop 0
v_mul_f32 v88, s30, v88
v_mul_f32 v89, s30, v89
v_exp_f32 v88, v88
v_exp_f32 v89, v89
v_cndmask_b32_dpp v0, v2, v0, vcc quad_perm:[2,3,2,3] row_mask:0xf bank_mask:0xf
v_cvt_pk_bf16_f32 v64, v88, v89
v_cndmask_b32_dpp v1, v3, v1, vcc quad_perm:[2,3,2,3] row_mask:0xf bank_mask:0xf
v_exp_f32 v0, v0
v_mfma_f32_16x16x16_bf16 v[16:19], v[100:101], v[64:65], 0
v_exp_f32 v1, v1
v_cndmask_b32_dpp v4, v6, v4, vcc quad_perm:[2,3,2,3] row_mask:0xf bank_mask:0xf
v_mfma_f32_16x16x16_bf16 v[8:11], v[124:125], v[64:65], 0
v_cndmask_b32_dpp v5, v7, v5, vcc quad_perm:[2,3,2,3] row_mask:0xf bank_mask:0xf
v_exp_f32 v4, v4
v_exp_f32 v5, v5
v_cvt_pk_bf16_f32 v92, v0, v1
v_cvt_pk_bf16_f32 v94, v4, v5
v_mov_b32 v80, 0
v_mov_b32_dpp v93, v92 quad_perm:[0,1,0,1] row_mask:0xf bank_mask:0xf
v_mov_b32_dpp v95, v94 quad_perm:[0,1,0,1] row_mask:0xf bank_mask:0xf
v_mov_b32 v81, 0
v_mov_b32 v82, 0
v_mfma_f32_16x16x32_bf16 v[16:19], v[100:103], v[92:95], v[16:19]
v_mov_b32 v83, 0
v_mov_b32 v84, 0
v_mfma_f32_16x16x32_bf16 v[8:11], v[96:99], v[92:95], v[8:11]
s_nop 1
v_mov_b32 v85, 0
v_mov_b32 v86, 0
v_mov_b32 v87, 0
v_rcp_f32 v126, v16
v_subrev_u32 v127, 0x21800000, v16
v_cmp_lt_u32 vcc, 0x3c000000, v127
v_pk_mul_f32 v[8:9], v[8:9], v[126:127] op_sel_hi:[1,0]
v_pk_mul_f32 v[10:11], v[10:11], v[126:127] op_sel_hi:[1,0]
s_and_b32 s32, vcc_lo, 0xcccc
v_cvt_pk_bf16_f32 v126, v8, v9
v_cvt_pk_bf16_f32 v127, v10, v11
s_andn2_b32 s35, s46, 0xff
v_bfe_u32 v68, v116, 1, 8
buffer_load_dwordx2 v[66:67], v68, s[4:7], s35 offen sc1
s_waitcnt vmcnt(0)
s_branch main_kernel_c3_ost
main_kernel_c3_o0_f:
s_nop 0
buffer_load_dwordx4 v[0:3], v116, s[4:7], s23 offen sc1
s_xor_b32 s32, s23, 1024
buffer_load_dwordx4 v[4:7], v116, s[4:7], s32 offen sc1
s_sub_u32 s29, s29, 1
s_cbranch_scc1 main_kernel_end
s_waitcnt vmcnt(0)
v_max_u32 v126, v0, v2
v_cmp_eq_u32 vcc, -1, v126
s_cbranch_vccnz main_kernel_c3_o0_f
s_branch main_kernel_c3_o0
main_kernel_c3_o1_f:
s_nop 0
s_xor_b32 s32, s23, 1024
buffer_load_dwordx4 v[4:7], v116, s[4:7], s32 offen sc1
s_xor_b32 s32, s23, 2048
buffer_load_dwordx4 v[8:11], v116, s[4:7], s32 offen sc1
s_sub_u32 s29, s29, 1
s_cbranch_scc1 main_kernel_end
s_waitcnt vmcnt(0)
v_max_u32 v126, v4, v6
v_cmp_eq_u32 vcc, -1, v126
s_cbranch_vccnz main_kernel_c3_o1_f
s_branch main_kernel_c3_o1
main_kernel_c3_o2_f:
s_nop 0
s_xor_b32 s32, s23, 2048
buffer_load_dwordx4 v[8:11], v116, s[4:7], s32 offen sc1
s_xor_b32 s32, s23, 3072
buffer_load_dwordx4 v[12:15], v116, s[4:7], s32 offen sc1
s_sub_u32 s29, s29, 1
s_cbranch_scc1 main_kernel_end
s_waitcnt vmcnt(0)
v_max_u32 v126, v8, v10
v_cmp_eq_u32 vcc, -1, v126
s_cbranch_vccnz main_kernel_c3_o2_f
s_branch main_kernel_c3_o2
main_kernel_c3_o3_f:
s_nop 0
s_xor_b32 s32, s23, 3072
buffer_load_dwordx4 v[12:15], v116, s[4:7], s32 offen sc1
s_xor_b32 s32, s23, 4096
buffer_load_dwordx4 v[16:19], v116, s[4:7], s32 offen sc1
s_sub_u32 s29, s29, 1
s_cbranch_scc1 main_kernel_end
s_waitcnt vmcnt(0)
v_max_u32 v126, v12, v14
v_cmp_eq_u32 vcc, -1, v126
s_cbranch_vccnz main_kernel_c3_o3_f
s_branch main_kernel_c3_o3
main_kernel_c3_o4_f:
s_nop 0
s_xor_b32 s32, s23, 4096
buffer_load_dwordx4 v[16:19], v116, s[4:7], s32 offen sc1
s_xor_b32 s32, s23, 5120
buffer_load_dwordx4 v[20:23], v116, s[4:7], s32 offen sc1
s_sub_u32 s29, s29, 1
s_cbranch_scc1 main_kernel_end
s_waitcnt vmcnt(0)
v_max_u32 v126, v16, v18
v_cmp_eq_u32 vcc, -1, v126
s_cbranch_vccnz main_kernel_c3_o4_f
s_branch main_kernel_c3_o4
main_kernel_c3_o5_f:
s_nop 0
s_xor_b32 s32, s23, 5120
buffer_load_dwordx4 v[20:23], v116, s[4:7], s32 offen sc1
s_xor_b32 s32, s23, 6144
buffer_load_dwordx4 v[24:27], v116, s[4:7], s32 offen sc1
s_sub_u32 s29, s29, 1
s_cbranch_scc1 main_kernel_end
s_waitcnt vmcnt(0)
v_max_u32 v126, v20, v22
v_cmp_eq_u32 vcc, -1, v126
s_cbranch_vccnz main_kernel_c3_o5_f
s_branch main_kernel_c3_o5
main_kernel_c3_o6_f:
s_nop 0
s_xor_b32 s32, s23, 6144
buffer_load_dwordx4 v[24:27], v116, s[4:7], s32 offen sc1
s_xor_b32 s32, s23, 7168
buffer_load_dwordx4 v[28:31], v116, s[4:7], s32 offen sc1
s_sub_u32 s29, s29, 1
s_cbranch_scc1 main_kernel_end
s_waitcnt vmcnt(0)
v_max_u32 v126, v24, v26
v_cmp_eq_u32 vcc, -1, v126
s_cbranch_vccnz main_kernel_c3_o6_f
s_branch main_kernel_c3_o6
main_kernel_c3_o7_f:
s_nop 0
s_xor_b32 s32, s23, 7168
buffer_load_dwordx4 v[28:31], v116, s[4:7], s32 offen sc1
s_sub_u32 s29, s29, 1
s_cbranch_scc1 main_kernel_end
s_waitcnt vmcnt(0)
v_max_u32 v126, v28, v30
v_cmp_eq_u32 vcc, -1, v126
s_cbranch_vccnz main_kernel_c3_o7_f
s_branch main_kernel_c3_o7
.p2align 6
main_kernel_c4_top:
s_barrier
buffer_load_dwordx4 v[0:3], v116, s[4:7], s18 offen sc1
s_add_u32 s20, s20, 0x40000
s_bitset0_b32 s20, 20
s_add_u32 s21, s21, 0x40000
s_bitset0_b32 s21, 20
s_add_u32 s22, s22, 0x40000
s_bitset0_b32 s22, 20
s_add_u32 s23, s23, 0x40000
s_bitset0_b32 s23, 20
s_xor_b32 s32, s18, 1024
buffer_load_dwordx4 v[16:19], v116, s[4:7], s32 offen sc1
s_add_u32 s3, s3, 0x40000
s_bitset0_b32 s3, 20
s_add_u32 s17, s17, 1
s_bitcmp1_b32 0x77777777, s17
s_cselect_b32 s33, 0x800, 0
s_xor_b32 s54, s54, s33
s_xor_b32 s59, s59, s33
s_add_u32 s25, s52, s59
s_nop 0
buffer_load_dwordx4 v[64:67], v116, s[4:7], s19 offen sc1
v_mov_b32 v80, 0
v_mov_b32 v81, 0
s_nop 3
s_xor_b32 s32, s19, 1024
buffer_load_dwordx4 v[68:71], v116, s[4:7], s32 offen sc1
v_mov_b32 v82, 0
v_mov_b32 v83, 0
s_nop 3
s_xor_b32 s32, s18, 2048
buffer_load_dwordx4 v[32:35], v116, s[4:7], s32 offen sc1
v_mov_b32 v84, 0
v_mov_b32 v85, 0
s_nop 3
s_xor_b32 s32, s19, 2048
buffer_load_dwordx4 v[72:75], v116, s[4:7], s32 offen sc1
v_mov_b32 v86, 0
v_mov_b32 v87, 0
s_nop 3
s_xor_b32 s32, s18, 3072
buffer_load_dwordx4 v[48:51], v116, s[4:7], s32 offen sc1
v_mov_b32 v88, 0
v_mov_b32 v89, 0
s_nop 3
s_xor_b32 s32, s19, 3072
buffer_load_dwordx4 v[76:79], v116, s[4:7], s32 offen sc1
v_mov_b32 v90, 0
v_mov_b32 v91, 0
s_waitcnt vmcnt(5)
v_pk_add_f16 v0, v0, v64
v_pk_add_f16 v1, v1, v65
v_pk_add_f16 v2, v2, v66
v_pk_add_f16 v3, v3, v67
v_cmp_u_f16 vcc, v0, v2
s_cbranch_vccnz main_kernel_c4_m0_f
main_kernel_c4_m0:
v_smfmac_f32_16x16x64_f16 v[80:83], v[0:3], a[0:7], v112
ds_write_b128 v116, v[0:3] offset:0
v_smfmac_f32_16x16x64_f16 v[84:87], v[0:3], a[128:135], v112
buffer_load_dword v123, v121, s[4:7], 0 offen sc1
s_waitcnt vmcnt(5)
v_pk_add_f16 v16, v16, v68
v_pk_add_f16 v17, v17, v69
v_pk_add_f16 v18, v18, v70
v_pk_add_f16 v19, v19, v71
v_cmp_u_f16 vcc, v16, v18
s_waitcnt lgkmcnt(0)
s_barrier
ds_read_b128 v[4:7], v116 offset:1024
ds_write_b128 v116, v[16:19] offset:4096
s_cbranch_vccnz main_kernel_c4_m1_f
main_kernel_c4_m1:
v_smfmac_f32_16x16x64_f16 v[80:83], v[16:19], a[8:15], v112
v_smfmac_f32_16x16x64_f16 v[84:87], v[16:19], a[136:143], v112
ds_read_b128 v[8:11], v116 offset:2048
v_smfmac_f32_16x16x64_f16 v[88:91], v[0:3], v[128:135], v112
ds_read_b128 v[12:15], v116 offset:3072
s_waitcnt lgkmcnt(3)
v_smfmac_f32_16x16x64_f16 v[80:83], v[4:7], a[32:39], v112
v_smfmac_f32_16x16x64_f16 v[84:87], v[4:7], a[160:167], v112
v_smfmac_f32_16x16x64_f16 v[88:91], v[4:7], v[136:143], v112
s_waitcnt lgkmcnt(2)
s_barrier
s_waitcnt lgkmcnt(1)
v_smfmac_f32_16x16x64_f16 v[80:83], v[8:11], a[64:71], v112
s_waitcnt vmcnt(3)
ds_read_b128 v[20:23], v116 offset:5120
v_pk_add_f16 v32, v32, v72
v_smfmac_f32_16x16x64_f16 v[84:87], v[8:11], a[192:199], v112
ds_read_b128 v[24:27], v116 offset:6144
s_waitcnt lgkmcnt(2)
v_pk_add_f16 v33, v33, v73
v_smfmac_f32_16x16x64_f16 v[80:83], v[12:15], a[96:103], v112
ds_read_b128 v[28:31], v116 offset:7168
v_pk_add_f16 v34, v34, v74
v_smfmac_f32_16x16x64_f16 v[84:87], v[12:15], a[224:231], v112
s_waitcnt lgkmcnt(2)
v_pk_add_f16 v35, v35, v75
v_smfmac_f32_16x16x64_f16 v[80:83], v[20:23], a[40:47], v112
ds_write_b128 v116, v[32:35] offset:8192
v_cmp_u_f16 vcc, v32, v34
v_smfmac_f32_16x16x64_f16 v[84:87], v[20:23], a[168:175], v112
s_cbranch_vccnz main_kernel_c4_m2_f
main_kernel_c4_m2:
v_smfmac_f32_16x16x64_f16 v[80:83], v[32:35], a[16:23], v112
buffer_load_dwordx4 v[96:99], v116, s[4:7], s28 offen sc1
v_smfmac_f32_16x16x64_f16 v[84:87], v[32:35], a[144:151], v112
s_add_u32 s28, s28, 0x40000
s_waitcnt lgkmcnt(2)
v_smfmac_f32_16x16x64_f16 v[80:83], v[24:27], a[72:79], v112
s_waitcnt vmcnt(2)
v_pk_add_f16 v48, v48, v76
v_smfmac_f32_16x16x64_f16 v[84:87], v[24:27], a[200:207], v112
s_waitcnt lgkmcnt(0)
s_barrier
ds_read_b128 v[36:39], v116 offset:9216
v_pk_add_f16 v49, v49, v77
v_smfmac_f32_16x16x64_f16 v[80:83], v[28:31], a[104:111], v112
ds_read_b128 v[40:43], v116 offset:10240
v_pk_add_f16 v50, v50, v78
v_smfmac_f32_16x16x64_f16 v[84:87], v[28:31], a[232:239], v112
ds_read_b128 v[44:47], v116 offset:11264
v_pk_add_f16 v51, v51, v79
v_smfmac_f32_16x16x64_f16 v[88:91], v[8:11], v[144:151], v112
ds_write_b128 v116, v[48:51] offset:12288
s_waitcnt lgkmcnt(3)
v_cmp_u_f16 vcc, v48, v50
v_smfmac_f32_16x16x64_f16 v[80:83], v[36:39], a[48:55], v112
s_cbranch_vccnz main_kernel_c4_m3_f
main_kernel_c4_m3:
v_smfmac_f32_16x16x64_f16 v[80:83], v[48:51], a[24:31], v112
v_smfmac_f32_16x16x64_f16 v[84:87], v[48:51], a[152:159], v112
v_smfmac_f32_16x16x64_f16 v[84:87], v[36:39], a[176:183], v112
s_waitcnt lgkmcnt(2)
v_smfmac_f32_16x16x64_f16 v[80:83], v[40:43], a[80:87], v112
s_waitcnt lgkmcnt(0)
s_barrier
ds_read_b128 v[52:55], v116 offset:13312
v_smfmac_f32_16x16x64_f16 v[84:87], v[40:43], a[208:215], v112
s_add_u32 s19, s52, s54
ds_read_b128 v[56:59], v116 offset:14336
v_smfmac_f32_16x16x64_f16 v[80:83], v[44:47], a[112:119], v112
s_add_u32 s18, s18, 0x40000
ds_read_b128 v[60:63], v116 offset:15360
v_smfmac_f32_16x16x64_f16 v[84:87], v[44:47], a[240:247], v112
s_bitset0_b32 s18, 20
s_waitcnt lgkmcnt(2)
v_smfmac_f32_16x16x64_f16 v[80:83], v[52:55], a[56:63], v112
s_cmp_eq_u32 s17, 30
s_cselect_b32 s32, s53, 0x10000
s_waitcnt lgkmcnt(1)
v_smfmac_f32_16x16x64_f16 v[80:83], v[56:59], a[88:95], v112
s_add_u32 s52, s52, s32
s_waitcnt lgkmcnt(0)
v_smfmac_f32_16x16x64_f16 v[80:83], v[60:63], a[120:127], v112
s_sub_u32 s24, 0x20000, s32
ds_read_b128 v[64:67], v116 offset:24576
v_smfmac_f32_16x16x64_f16 v[84:87], v[52:55], a[184:191], v112
s_add_u32 s55, s55, s24
ds_read_b128 v[68:71], v116 offset:28672
v_smfmac_f32_16x16x64_f16 v[84:87], v[56:59], a[216:223], v112
ds_read_b128 v[72:75], v116 offset:25600
s_nop 0
v_cvt_pk_bf16_f32 v92, v80, v81
v_smfmac_f32_16x16x64_f16 v[84:87], v[60:63], a[248:255], v112
ds_read_b128 v[76:79], v116 offset:29696
s_nop 0
v_cvt_pk_bf16_f32 v93, v82, v83
v_smfmac_f32_16x16x64_f16 v[88:91], v[12:15], v[152:159], v112
s_nop 3
v_cvt_pk_bf16_f32 v94, v84, v85
v_cvt_pk_bf16_f32 v95, v86, v87
s_mov_b32 vcc_lo, 0xcccccccc
s_mov_b32 vcc_hi, 0xcccccccc
v_mfma_f32_16x16x32_bf16 v[84:87], v[92:95], v[104:107], 0
v_add_u32 v121, v121, v122
v_writelane_b32 v121, s55, 39
s_nop 0
v_smfmac_f32_16x16x64_f16 v[88:91], v[16:19], v[160:167], v112
s_nop 2
s_cmp_eq_u32 s17, 63
v_cvt_pk_bf16_f32 v114, v84, v85
v_cvt_pk_bf16_f32 v115, v86, v87
buffer_store_dwordx2 v[114:115], v117, s[4:7], s21 offen sc1
s_cbranch_scc1 main_kernel_c4_last
ds_write_b64 v117, v[114:115] offset:16384
v_smfmac_f32_16x16x64_f16 v[88:91], v[20:23], v[168:175], v112
v_smfmac_f32_16x16x64_f16 v[88:91], v[24:27], v[176:183], v112
v_smfmac_f32_16x16x64_f16 v[88:91], v[28:31], v[184:191], v112
v_smfmac_f32_16x16x64_f16 v[88:91], v[32:35], v[192:199], v112
s_waitcnt lgkmcnt(0)
s_barrier
ds_read_b128 v[0:3], v116 offset:16384
v_smfmac_f32_16x16x64_f16 v[88:91], v[36:39], v[200:207], v112
ds_read_b128 v[4:7], v116 offset:17408
v_smfmac_f32_16x16x64_f16 v[88:91], v[40:43], v[208:215], v112
ds_read_b128 v[16:19], v116 offset:26624
v_smfmac_f32_16x16x64_f16 v[88:91], v[44:47], v[216:223], v112
ds_read_b128 v[20:23], v116 offset:30720
v_smfmac_f32_16x16x64_f16 v[88:91], v[48:51], v[224:231], v112
ds_read_b128 v[24:27], v116 offset:27648
v_smfmac_f32_16x16x64_f16 v[88:91], v[52:55], v[232:239], v112
ds_read_b128 v[28:31], v116 offset:31744
v_smfmac_f32_16x16x64_f16 v[88:91], v[56:59], v[240:247], v112
v_smfmac_f32_16x16x64_f16 v[88:91], v[60:63], v[248:255], v112
s_waitcnt lgkmcnt(5)
v_mfma_f32_16x16x32_bf16 v[80:83], v[64:67], v[0:3], 0
v_mfma_f32_16x16x32_bf16 v[84:87], v[68:71], v[0:3], 0
buffer_load_dwordx4 v[8:11], v116, s[4:7], s20 offen offset:0 sc1
v_mfma_f32_16x16x32_bf16 v[92:95], v[0:3], v[0:3], 0
buffer_load_dwordx4 v[12:15], v116, s[4:7], s20 offen offset:1024 sc1
v_permlane32_swap_b32 v88, v90
s_waitcnt lgkmcnt(4)
v_mfma_f32_16x16x32_bf16 v[80:83], v[72:75], v[4:7], v[80:83]
v_permlane32_swap_b32 v89, v91
v_mfma_f32_16x16x32_bf16 v[84:87], v[76:79], v[4:7], v[84:87]
v_pk_add_f32 v[88:89], v[88:89], v[90:91]
v_mfma_f32_16x16x32_bf16 v[92:95], v[4:7], v[4:7], v[92:95]
v_cvt_pk_bf16_f32 v124, v88, v89
v_mov_b32 v65, 0
s_waitcnt lgkmcnt(0)
s_waitcnt vmcnt(1)
v_mfma_f32_16x16x32_bf16 v[88:91], v[8:11], v[8:11], v[92:95]
v_mfma_f32_16x16x32_bf16 v[0:3], v[16:19], v[8:11], v[80:83]
v_cmp_u_f32 s[0:1], v8, v10
v_mfma_f32_16x16x32_bf16 v[4:7], v[20:23], v[8:11], v[84:87]
s_waitcnt vmcnt(0)
v_mfma_f32_16x16x32_bf16 v[88:91], v[12:15], v[12:15], v[88:91]
v_mfma_f32_16x16x32_bf16 v[0:3], v[24:27], v[12:15], v[0:3]
v_cmp_u_f32 s[32:33], v12, v14
v_mfma_f32_16x16x32_bf16 v[4:7], v[28:31], v[12:15], v[4:7]
s_or_b64 s[0:1], s[0:1], s[32:33]
s_cbranch_scc1 main_kernel_c4_z_f
main_kernel_c4_z:
v_mul_f32 v88, s30, v88
v_mul_f32 v89, s30, v89
v_exp_f32 v88, v88
v_exp_f32 v89, v89
v_cndmask_b32_dpp v0, v2, v0, vcc quad_perm:[2,3,2,3] row_mask:0xf bank_mask:0xf
v_cvt_pk_bf16_f32 v64, v88, v89
v_cndmask_b32_dpp v1, v3, v1, vcc quad_perm:[2,3,2,3] row_mask:0xf bank_mask:0xf
v_exp_f32 v0, v0
v_mfma_f32_16x16x16_bf16 v[16:19], v[100:101], v[64:65], 0
v_exp_f32 v1, v1
v_cndmask_b32_dpp v4, v6, v4, vcc quad_perm:[2,3,2,3] row_mask:0xf bank_mask:0xf
v_mfma_f32_16x16x16_bf16 v[8:11], v[124:125], v[64:65], 0
v_cndmask_b32_dpp v5, v7, v5, vcc quad_perm:[2,3,2,3] row_mask:0xf bank_mask:0xf
v_exp_f32 v4, v4
v_exp_f32 v5, v5
v_cvt_pk_bf16_f32 v92, v0, v1
v_cvt_pk_bf16_f32 v94, v4, v5
v_mov_b32 v80, 0
v_mov_b32_dpp v93, v92 quad_perm:[0,1,0,1] row_mask:0xf bank_mask:0xf
v_mov_b32_dpp v95, v94 quad_perm:[0,1,0,1] row_mask:0xf bank_mask:0xf
v_mov_b32 v81, 0
v_mov_b32 v82, 0
v_mfma_f32_16x16x32_bf16 v[16:19], v[100:103], v[92:95], v[16:19]
v_mov_b32 v83, 0
v_mov_b32 v84, 0
v_mfma_f32_16x16x32_bf16 v[8:11], v[96:99], v[92:95], v[8:11]
s_nop 1
v_mov_b32 v85, 0
v_mov_b32 v86, 0
v_mov_b32 v87, 0
v_rcp_f32 v126, v16
v_subrev_u32 v127, 0x21800000, v16
v_cmp_lt_u32 vcc, 0x3c000000, v127
v_pk_mul_f32 v[8:9], v[8:9], v[126:127] op_sel_hi:[1,0]
v_pk_mul_f32 v[10:11], v[10:11], v[126:127] op_sel_hi:[1,0]
s_and_b32 s32, vcc_lo, 0xcccc
v_cvt_pk_bf16_f32 v126, v8, v9
v_cvt_pk_bf16_f32 v127, v10, v11
s_cbranch_scc1 main_kernel_c4_sm_f
main_kernel_c4_ost:
buffer_store_dwordx2 v[126:127], v118, s[4:7], s22 offen sc1
v_cmp_eq_u32 s[0:1], 0, v123
v_mov_b32 v24, -1
v_mov_b32 v25, -1
v_mov_b32 v26, -1
v_mov_b32 v27, -1
ds_read_b128 v[32:35], v113 offset:0
ds_read_b128 v[36:39], v113 offset:1024
ds_read_b128 v[40:43], v113 offset:2048
ds_read_b128 v[44:47], v113 offset:3072
ds_read_b128 v[48:51], v113 offset:4096
ds_read_b128 v[52:55], v113 offset:5120
s_and_b32 s10, s1, 0x3f00
buffer_store_dwordx4 v[24:27], v116, s[4:7], s3 offen sc1
s_barrier
buffer_load_dwordx4 v[0:3], v116, s[4:7], s23 offen sc1
ds_read_b128 v[56:59], v113 offset:6144
ds_read_b128 v[60:63], v113 offset:7168
s_add_u32 s37, s37, 65536
s_add_u32 s26, s26, 65536
s_nop 1
s_xor_b32 s32, s23, 1024
buffer_load_dwordx4 v[4:7], v116, s[4:7], s32 offen sc1
ds_read_b128 v[64:67], v113 offset:8192
ds_read_b128 v[68:71], v113 offset:9216
s_nop 3
s_xor_b32 s32, s23, 2048
buffer_load_dwordx4 v[8:11], v116, s[4:7], s32 offen sc1
ds_read_b128 v[72:75], v113 offset:10240
ds_read_b128 v[76:79], v113 offset:11264
s_nop 3
s_xor_b32 s32, s23, 3072
buffer_load_dwordx4 v[12:15], v116, s[4:7], s32 offen sc1
ds_read_b128 v[88:91], v113 offset:12288
ds_read_b128 v[92:95], v113 offset:13312
s_nop 3
s_xor_b32 s32, s23, 4096
buffer_load_dwordx4 v[16:19], v116, s[4:7], s32 offen sc1
s_nop 7
s_xor_b32 s32, s23, 5120
buffer_load_dwordx4 v[20:23], v116, s[4:7], s32 offen sc1
s_nop 7
s_xor_b32 s32, s23, 6144
buffer_load_dwordx4 v[24:27], v116, s[4:7], s32 offen sc1
s_nop 7
s_xor_b32 s32, s23, 7168
buffer_load_dwordx4 v[28:31], v116, s[4:7], s32 offen sc1
s_waitcnt lgkmcnt(12)
s_waitcnt vmcnt(7)
v_cmp_u_f32 vcc, v0, v2
s_cbranch_vccnz main_kernel_c4_o0_f
main_kernel_c4_o0:
v_smfmac_f32_16x16x64_bf16 v[80:83], v[0:3], v[32:39], v112
ds_read_b128 v[32:35], v113 offset:14336
ds_read_b128 v[36:39], v113 offset:15360
s_waitcnt lgkmcnt(12)
s_waitcnt vmcnt(6)
v_cmp_u_f32 vcc, v4, v6
v_smfmac_f32_16x16x64_bf16 v[84:87], v[0:3], v[40:47], v112
ds_read_b128 v[40:43], v113 offset:16384
ds_read_b128 v[44:47], v113 offset:17408
buffer_store_dwordx2 v[114:115], v119, s[4:7], s37 offen sc1
s_cbranch_vccnz main_kernel_c4_o1_f
main_kernel_c4_o1:
s_waitcnt lgkmcnt(12)
v_smfmac_f32_16x16x64_bf16 v[80:83], v[4:7], v[48:55], v112
ds_read_b128 v[48:51], v113 offset:18432
ds_read_b128 v[52:55], v113 offset:19456
s_waitcnt lgkmcnt(12)
s_waitcnt vmcnt(6)
v_cmp_u_f32 vcc, v8, v10
v_smfmac_f32_16x16x64_bf16 v[84:87], v[4:7], v[56:63], v112
ds_read_b128 v[56:59], v113 offset:20480
ds_read_b128 v[60:63], v113 offset:21504
buffer_store_dword v124, v120, s[4:7], s26 offen sc1
s_cbranch_vccnz main_kernel_c4_o2_f
main_kernel_c4_o2:
s_waitcnt lgkmcnt(12)
v_smfmac_f32_16x16x64_bf16 v[80:83], v[8:11], v[64:71], v112
ds_read_b128 v[64:67], v113 offset:22528
ds_read_b128 v[68:71], v113 offset:23552
s_waitcnt lgkmcnt(12)
s_waitcnt vmcnt(6)
v_cmp_u_f32 vcc, v12, v14
v_smfmac_f32_16x16x64_bf16 v[84:87], v[8:11], v[72:79], v112
ds_read_b128 v[72:75], v113 offset:24576
ds_read_b128 v[76:79], v113 offset:25600
s_cbranch_vccnz main_kernel_c4_o3_f
main_kernel_c4_o3:
s_waitcnt lgkmcnt(12)
v_smfmac_f32_16x16x64_bf16 v[80:83], v[12:15], v[88:95], v112
ds_read_b128 v[88:91], v113 offset:26624
ds_read_b128 v[92:95], v113 offset:27648
s_waitcnt lgkmcnt(12)
s_waitcnt vmcnt(5)
v_cmp_u_f32 vcc, v16, v18
v_smfmac_f32_16x16x64_bf16 v[84:87], v[12:15], v[32:39], v112
ds_read_b128 v[32:35], v113 offset:28672
ds_read_b128 v[36:39], v113 offset:29696
s_cbranch_vccnz main_kernel_c4_o4_f
main_kernel_c4_o4:
s_waitcnt lgkmcnt(12)
v_smfmac_f32_16x16x64_bf16 v[80:83], v[16:19], v[40:47], v112
ds_read_b128 v[40:43], v113 offset:30720
ds_read_b128 v[44:47], v113 offset:31744
s_waitcnt lgkmcnt(12)
s_waitcnt vmcnt(4)
v_cmp_u_f32 vcc, v20, v22
v_smfmac_f32_16x16x64_bf16 v[84:87], v[16:19], v[48:55], v112
s_cbranch_vccnz main_kernel_c4_o5_f
main_kernel_c4_o5:
s_waitcnt lgkmcnt(10)
v_smfmac_f32_16x16x64_bf16 v[80:83], v[20:23], v[56:63], v112
s_waitcnt lgkmcnt(8)
s_waitcnt vmcnt(3)
v_cmp_u_f32 vcc, v24, v26
v_smfmac_f32_16x16x64_bf16 v[84:87], v[20:23], v[64:71], v112
s_cbranch_vccnz main_kernel_c4_o6_f
main_kernel_c4_o6:
s_waitcnt lgkmcnt(6)
v_smfmac_f32_16x16x64_bf16 v[80:83], v[24:27], v[72:79], v112
s_waitcnt lgkmcnt(4)
v_smfmac_f32_16x16x64_bf16 v[84:87], v[24:27], v[88:95], v112
s_waitcnt lgkmcnt(2)
s_waitcnt vmcnt(2)
v_cmp_u_f32 vcc, v28, v30
s_cbranch_vccnz main_kernel_c4_o7_f
main_kernel_c4_o7:
v_smfmac_f32_16x16x64_bf16 v[80:83], v[28:31], v[32:39], v112
s_waitcnt lgkmcnt(0)
v_smfmac_f32_16x16x64_bf16 v[84:87], v[28:31], v[40:47], v112
s_nop 4
v_cvt_pk_bf16_f32 v80, v80, v81
v_cvt_pk_bf16_f32 v81, v82, v83
ds_write_b64 v116, v[80:81] offset:20480
v_cvt_pk_bf16_f32 v82, v84, v85
v_cvt_pk_bf16_f32 v83, v86, v87
ds_write_b64 v116, v[82:83] offset:22528
s_waitcnt lgkmcnt(0)
s_barrier
ds_read_b128 v[72:75], v116 offset:20480
ds_read_b128 v[76:79], v116 offset:21504
s_mov_b32 m0, 24576
s_cmp_lg_u32 s10, 0
s_waitcnt lgkmcnt(1)
v_mfma_f32_16x16x32_bf16 v[64:67], v[72:75], v[108:111], 0
s_waitcnt lgkmcnt(0)
v_mfma_f32_16x16x32_bf16 v[64:67], v[76:79], v[108:111], v[64:67]
s_nop 7
v_cvt_pk_f16_f32 v68, v64, v65
v_cvt_pk_f16_f32 v69, v66, v67
buffer_store_dwordx2 v[68:69], v125, s[4:7], s25 offen sc1
s_cbranch_scc1 main_kernel_c4_kvw
main_kernel_c4_kvok:
s_nop 3
buffer_load_dwordx4 v116, s[4:7], s27 offen sc1 lds
buffer_load_dwordx4 v116, s[4:7], s27 offen offset:1024 sc1 lds
s_add_u32 s27, s27, 0x40000
s_branch main_kernel_c4_top
main_kernel_c4_kvw:
s_mov_b32 exec_lo, 0
s_mov_b32 exec_hi, 0x3f00
v_subrev_u32 v127, 128, v121
main_kernel_c4_kvp:
buffer_load_dword v126, v127, s[4:7], 0 offen sc1
s_waitcnt vmcnt(0)
v_cmp_eq_u32 vcc, 0, v126
s_cbranch_vccz main_kernel_c4_kvp_ok
s_sleep 2
s_sub_u32 s29, s29, 1
s_cbranch_scc0 main_kernel_c4_kvp
s_branch main_kernel_end
main_kernel_c4_kvp_ok:
s_mov_b64 exec, -1
s_branch main_kernel_c4_kvok
main_kernel_c4_last:
s_add_u32 s37, s37, 65536
s_add_u32 s26, s26, 65536
buffer_store_dwordx2 v[114:115], v119, s[4:7], s37 offen sc1
v_smfmac_f32_16x16x64_f16 v[88:91], v[20:23], v[168:175], v112
v_smfmac_f32_16x16x64_f16 v[88:91], v[24:27], v[176:183], v112
v_smfmac_f32_16x16x64_f16 v[88:91], v[28:31], v[184:191], v112
v_smfmac_f32_16x16x64_f16 v[88:91], v[32:35], v[192:199], v112
v_smfmac_f32_16x16x64_f16 v[88:91], v[36:39], v[200:207], v112
v_smfmac_f32_16x16x64_f16 v[88:91], v[40:43], v[208:215], v112
v_smfmac_f32_16x16x64_f16 v[88:91], v[44:47], v[216:223], v112
v_smfmac_f32_16x16x64_f16 v[88:91], v[48:51], v[224:231], v112
v_smfmac_f32_16x16x64_f16 v[88:91], v[52:55], v[232:239], v112
v_smfmac_f32_16x16x64_f16 v[88:91], v[56:59], v[240:247], v112
v_smfmac_f32_16x16x64_f16 v[88:91], v[60:63], v[248:255], v112
s_nop 7
v_permlane32_swap_b32 v88, v90
s_nop 1
v_permlane32_swap_b32 v89, v91
s_nop 1
v_pk_add_f32 v[88:89], v[88:89], v[90:91]
s_nop 1
v_cvt_pk_bf16_f32 v124, v88, v89
s_nop 1
buffer_store_dword v124, v120, s[4:7], s26 offen sc1
s_branch main_kernel_end
main_kernel_c4_m0_f:
s_waitcnt lgkmcnt(0)
buffer_load_dwordx4 v[0:3], v116, s[4:7], s18 offen sc1
buffer_load_dwordx4 v[64:67], v116, s[4:7], s19 offen sc1
s_xor_b32 s32, s18, 1024
buffer_load_dwordx4 v[16:19], v116, s[4:7], s32 offen sc1
s_xor_b32 s32, s19, 1024
buffer_load_dwordx4 v[68:71], v116, s[4:7], s32 offen sc1
s_xor_b32 s32, s18, 2048
buffer_load_dwordx4 v[32:35], v116, s[4:7], s32 offen sc1
s_xor_b32 s32, s19, 2048
buffer_load_dwordx4 v[72:75], v116, s[4:7], s32 offen sc1
s_xor_b32 s32, s18, 3072
buffer_load_dwordx4 v[48:51], v116, s[4:7], s32 offen sc1
s_xor_b32 s32, s19, 3072
buffer_load_dwordx4 v[76:79], v116, s[4:7], s32 offen sc1
s_sub_u32 s29, s29, 1
s_cbranch_scc1 main_kernel_end
s_waitcnt vmcnt(0)
v_max_u32 v126, v0, v2
v_max3_u32 v126, v126, v64, v66
v_cmp_eq_u32 vcc, -1, v126
s_cbranch_vccnz main_kernel_c4_m0_f
v_pk_add_f16 v0, v0, v64
v_pk_add_f16 v1, v1, v65
v_pk_add_f16 v2, v2, v66
v_pk_add_f16 v3, v3, v67
s_nop 0
s_branch main_kernel_c4_m0
main_kernel_c4_m1_f:
s_waitcnt lgkmcnt(0)
s_xor_b32 s32, s18, 1024
buffer_load_dwordx4 v[16:19], v116, s[4:7], s32 offen sc1
s_xor_b32 s32, s19, 1024
buffer_load_dwordx4 v[68:71], v116, s[4:7], s32 offen sc1
s_xor_b32 s32, s18, 2048
buffer_load_dwordx4 v[32:35], v116, s[4:7], s32 offen sc1
s_xor_b32 s32, s19, 2048
buffer_load_dwordx4 v[72:75], v116, s[4:7], s32 offen sc1
s_xor_b32 s32, s18, 3072
buffer_load_dwordx4 v[48:51], v116, s[4:7], s32 offen sc1
s_xor_b32 s32, s19, 3072
buffer_load_dwordx4 v[76:79], v116, s[4:7], s32 offen sc1
s_sub_u32 s29, s29, 1
s_cbranch_scc1 main_kernel_end
s_waitcnt vmcnt(0)
v_max_u32 v126, v16, v18
v_max3_u32 v126, v126, v68, v70
v_cmp_eq_u32 vcc, -1, v126
s_cbranch_vccnz main_kernel_c4_m1_f
v_pk_add_f16 v16, v16, v68
v_pk_add_f16 v17, v17, v69
v_pk_add_f16 v18, v18, v70
v_pk_add_f16 v19, v19, v71
ds_write_b128 v116, v[16:19] offset:4096
s_branch main_kernel_c4_m1
main_kernel_c4_m2_f:
s_waitcnt lgkmcnt(0)
s_xor_b32 s32, s18, 2048
buffer_load_dwordx4 v[32:35], v116, s[4:7], s32 offen sc1
s_xor_b32 s32, s19, 2048
buffer_load_dwordx4 v[72:75], v116, s[4:7], s32 offen sc1
s_xor_b32 s32, s18, 3072
buffer_load_dwordx4 v[48:51], v116, s[4:7], s32 offen sc1
s_xor_b32 s32, s19, 3072
buffer_load_dwordx4 v[76:79], v116, s[4:7], s32 offen sc1
s_sub_u32 s29, s29, 1
s_cbranch_scc1 main_kernel_end
s_waitcnt vmcnt(0)
v_max_u32 v126, v32, v34
v_max3_u32 v126, v126, v72, v74
v_cmp_eq_u32 vcc, -1, v126
s_cbranch_vccnz main_kernel_c4_m2_f
v_pk_add_f16 v32, v32, v72
v_pk_add_f16 v33, v33, v73
v_pk_add_f16 v34, v34, v74
v_pk_add_f16 v35, v35, v75
ds_write_b128 v116, v[32:35] offset:8192
s_branch main_kernel_c4_m2
main_kernel_c4_m3_f:
s_waitcnt lgkmcnt(0)
s_xor_b32 s32, s18, 3072
buffer_load_dwordx4 v[48:51], v116, s[4:7], s32 offen sc1
s_xor_b32 s32, s19, 3072
buffer_load_dwordx4 v[76:79], v116, s[4:7], s32 offen sc1
s_sub_u32 s29, s29, 1
s_cbranch_scc1 main_kernel_end
s_waitcnt vmcnt(0)
v_max_u32 v126, v48, v50
v_max3_u32 v126, v126, v76, v78
v_cmp_eq_u32 vcc, -1, v126
s_cbranch_vccnz main_kernel_c4_m3_f
v_pk_add_f16 v48, v48, v76
v_pk_add_f16 v49, v49, v77
v_pk_add_f16 v50, v50, v78
v_pk_add_f16 v51, v51, v79
ds_write_b128 v116, v[48:51] offset:12288
s_branch main_kernel_c4_m3
main_kernel_c4_z_f:
buffer_load_dwordx4 v[8:11], v116, s[4:7], s20 offen offset:0 sc1
buffer_load_dwordx4 v[12:15], v116, s[4:7], s20 offen offset:1024 sc1
s_memtime s[32:33]
ds_read_b32 v126, v116 offset:18432
s_sub_u32 s34, s19, s54
s_xor_b32 s34, s34, 0x2000
s_lshl_b32 s35, s12, 15
s_add_u32 s34, s34, s35
s_lshl_b32 s35, s13, 8
s_add_u32 s35, s35, s34
s_add_u32 s34, s34, 0x4000
s_waitcnt lgkmcnt(0)
s_sub_u32 s32, s32, 450
v_sub_u32 v127, s32, v126
buffer_store_dword v127, off, s[4:7], s34 sc1
s_sub_u32 s29, s29, 1
s_cbranch_scc1 main_kernel_end
s_waitcnt vmcnt(1)
main_kernel_c4_z_g:
v_max_u32 v126, v8, v10
v_max3_u32 v126, v126, v12, v14
v_cmp_eq_u32 vcc, -1, v126
s_cbranch_vccnz main_kernel_c4_z_h
v_mfma_f32_16x16x32_bf16 v[88:91], v[8:11], v[8:11], v[92:95]
v_mfma_f32_16x16x32_bf16 v[0:3], v[16:19], v[8:11], v[80:83]
v_mfma_f32_16x16x32_bf16 v[4:7], v[20:23], v[8:11], v[84:87]
v_mfma_f32_16x16x32_bf16 v[88:91], v[12:15], v[12:15], v[88:91]
v_mfma_f32_16x16x32_bf16 v[0:3], v[24:27], v[12:15], v[0:3]
v_mfma_f32_16x16x32_bf16 v[4:7], v[28:31], v[12:15], v[4:7]
buffer_store_dword v127, off, s[4:7], s35 offset:132 sc1
s_mov_b32 vcc_lo, 0xcccccccc
s_mov_b32 vcc_hi, 0xcccccccc
s_branch main_kernel_c4_z
main_kernel_c4_z_h:
buffer_load_dwordx4 v[8:11], v116, s[4:7], s20 offen offset:0 sc1
buffer_load_dwordx4 v[12:15], v116, s[4:7], s20 offen offset:1024 sc1
s_sub_u32 s29, s29, 1
s_cbranch_scc1 main_kernel_end
v_add_u32 v127, 300, v127
s_waitcnt vmcnt(0)
s_branch main_kernel_c4_z_g
main_kernel_c4_sm_f:
s_waitcnt vmcnt(0) lgkmcnt(0)
buffer_load_dwordx4 v[8:11], v116, s[4:7], s20 offen offset:0 sc1
buffer_load_dwordx4 v[12:15], v116, s[4:7], s20 offen offset:1024 sc1
ds_read_b128 v[0:3], v116 offset:16384
ds_read_b128 v[4:7], v116 offset:17408
ds_read_b128 v[64:67], v116 offset:24576
ds_read_b128 v[68:71], v116 offset:28672
ds_read_b128 v[72:75], v116 offset:25600
ds_read_b128 v[76:79], v116 offset:29696
ds_read_b128 v[16:19], v116 offset:26624
ds_read_b128 v[20:23], v116 offset:30720
ds_read_b128 v[24:27], v116 offset:27648
ds_read_b128 v[28:31], v116 offset:31744
s_waitcnt vmcnt(0)
s_waitcnt lgkmcnt(0)
v_mfma_f32_16x16x32_bf16 v[80:83], v[64:67], v[0:3], 0
v_mfma_f32_16x16x32_bf16 v[84:87], v[68:71], v[0:3], 0
v_mfma_f32_16x16x32_bf16 v[92:95], v[0:3], v[0:3], 0
v_mfma_f32_16x16x32_bf16 v[80:83], v[72:75], v[4:7], v[80:83]
v_mfma_f32_16x16x32_bf16 v[84:87], v[76:79], v[4:7], v[84:87]
v_mfma_f32_16x16x32_bf16 v[92:95], v[4:7], v[4:7], v[92:95]
v_mfma_f32_16x16x32_bf16 v[0:3], v[16:19], v[8:11], v[80:83]
v_mfma_f32_16x16x32_bf16 v[4:7], v[20:23], v[8:11], v[84:87]
v_mfma_f32_16x16x32_bf16 v[88:91], v[8:11], v[8:11], v[92:95]
v_mfma_f32_16x16x32_bf16 v[0:3], v[24:27], v[12:15], v[0:3]
v_mfma_f32_16x16x32_bf16 v[4:7], v[28:31], v[12:15], v[4:7]
v_mfma_f32_16x16x32_bf16 v[88:91], v[12:15], v[12:15], v[88:91]
s_nop 7
v_mov_b32 v65, 0
v_max_f32 v126, v88, v89
v_mul_f32 v126, s30, v126
v_max3_f32 v126, v126, v0, v1
v_max3_f32 v126, v126, v2, v3
v_max3_f32 v126, v126, v4, v5
v_max3_f32 v126, v126, v6, v7
v_mov_b32 v127, v126
s_nop 1
v_permlane32_swap_b32 v126, v127
v_max_f32 v126, v126, v127
v_mov_b32 v127, v126
s_nop 1
v_permlane16_swap_b32 v126, v127
v_max_f32 v126, v126, v127
v_mul_f32 v127, 0x40faf233, v126
s_mov_b32 vcc_lo, 0xcccccccc
s_mov_b32 vcc_hi, 0xcccccccc
v_sub_f32 v0, v0, v126
v_sub_f32 v1, v1, v126
v_sub_f32 v2, v2, v126
v_sub_f32 v3, v3, v126
v_sub_f32 v4, v4, v126
v_sub_f32 v5, v5, v126
v_sub_f32 v6, v6, v126
v_sub_f32 v7, v7, v126
v_sub_f32 v88, v88, v127
v_sub_f32 v89, v89, v127
s_waitcnt lgkmcnt(0)
s_nop 0
v_mul_f32 v88, s30, v88
v_mul_f32 v89, s30, v89
v_exp_f32 v88, v88
v_exp_f32 v89, v89
v_cndmask_b32_dpp v0, v2, v0, vcc quad_perm:[2,3,2,3] row_mask:0xf bank_mask:0xf
v_cvt_pk_bf16_f32 v64, v88, v89
v_cndmask_b32_dpp v1, v3, v1, vcc quad_perm:[2,3,2,3] row_mask:0xf bank_mask:0xf
v_exp_f32 v0, v0
v_mfma_f32_16x16x16_bf16 v[16:19], v[100:101], v[64:65], 0
v_exp_f32 v1, v1
v_cndmask_b32_dpp v4, v6, v4, vcc quad_perm:[2,3,2,3] row_mask:0xf bank_mask:0xf
v_mfma_f32_16x16x16_bf16 v[8:11], v[124:125], v[64:65], 0
v_cndmask_b32_dpp v5, v7, v5, vcc quad_perm:[2,3,2,3] row_mask:0xf bank_mask:0xf
v_exp_f32 v4, v4
v_exp_f32 v5, v5
v_cvt_pk_bf16_f32 v92, v0, v1
v_cvt_pk_bf16_f32 v94, v4, v5
v_mov_b32 v80, 0
v_mov_b32_dpp v93, v92 quad_perm:[0,1,0,1] row_mask:0xf bank_mask:0xf
v_mov_b32_dpp v95, v94 quad_perm:[0,1,0,1] row_mask:0xf bank_mask:0xf
v_mov_b32 v81, 0
v_mov_b32 v82, 0
v_mfma_f32_16x16x32_bf16 v[16:19], v[100:103], v[92:95], v[16:19]
v_mov_b32 v83, 0
v_mov_b32 v84, 0
v_mfma_f32_16x16x32_bf16 v[8:11], v[96:99], v[92:95], v[8:11]
s_nop 1
v_mov_b32 v85, 0
v_mov_b32 v86, 0
v_mov_b32 v87, 0
v_rcp_f32 v126, v16
v_subrev_u32 v127, 0x21800000, v16
v_cmp_lt_u32 vcc, 0x3c000000, v127
v_pk_mul_f32 v[8:9], v[8:9], v[126:127] op_sel_hi:[1,0]
v_pk_mul_f32 v[10:11], v[10:11], v[126:127] op_sel_hi:[1,0]
s_and_b32 s32, vcc_lo, 0xcccc
v_cvt_pk_bf16_f32 v126, v8, v9
v_cvt_pk_bf16_f32 v127, v10, v11
s_branch main_kernel_c4_ost
main_kernel_c4_o0_f:
s_nop 0
buffer_load_dwordx4 v[0:3], v116, s[4:7], s23 offen sc1
s_xor_b32 s32, s23, 1024
buffer_load_dwordx4 v[4:7], v116, s[4:7], s32 offen sc1
s_sub_u32 s29, s29, 1
s_cbranch_scc1 main_kernel_end
s_waitcnt vmcnt(0)
v_max_u32 v126, v0, v2
v_cmp_eq_u32 vcc, -1, v126
s_cbranch_vccnz main_kernel_c4_o0_f
s_branch main_kernel_c4_o0
main_kernel_c4_o1_f:
s_nop 0
s_xor_b32 s32, s23, 1024
buffer_load_dwordx4 v[4:7], v116, s[4:7], s32 offen sc1
s_xor_b32 s32, s23, 2048
buffer_load_dwordx4 v[8:11], v116, s[4:7], s32 offen sc1
s_sub_u32 s29, s29, 1
s_cbranch_scc1 main_kernel_end
s_waitcnt vmcnt(0)
v_max_u32 v126, v4, v6
v_cmp_eq_u32 vcc, -1, v126
s_cbranch_vccnz main_kernel_c4_o1_f
s_branch main_kernel_c4_o1
main_kernel_c4_o2_f:
s_nop 0
s_xor_b32 s32, s23, 2048
buffer_load_dwordx4 v[8:11], v116, s[4:7], s32 offen sc1
s_xor_b32 s32, s23, 3072
buffer_load_dwordx4 v[12:15], v116, s[4:7], s32 offen sc1
s_sub_u32 s29, s29, 1
s_cbranch_scc1 main_kernel_end
s_waitcnt vmcnt(0)
v_max_u32 v126, v8, v10
v_cmp_eq_u32 vcc, -1, v126
s_cbranch_vccnz main_kernel_c4_o2_f
s_branch main_kernel_c4_o2
main_kernel_c4_o3_f:
s_nop 0
s_xor_b32 s32, s23, 3072
buffer_load_dwordx4 v[12:15], v116, s[4:7], s32 offen sc1
s_xor_b32 s32, s23, 4096
buffer_load_dwordx4 v[16:19], v116, s[4:7], s32 offen sc1
s_sub_u32 s29, s29, 1
s_cbranch_scc1 main_kernel_end
s_waitcnt vmcnt(0)
v_max_u32 v126, v12, v14
v_cmp_eq_u32 vcc, -1, v126
s_cbranch_vccnz main_kernel_c4_o3_f
s_branch main_kernel_c4_o3
main_kernel_c4_o4_f:
s_nop 0
s_xor_b32 s32, s23, 4096
buffer_load_dwordx4 v[16:19], v116, s[4:7], s32 offen sc1
s_xor_b32 s32, s23, 5120
buffer_load_dwordx4 v[20:23], v116, s[4:7], s32 offen sc1
s_sub_u32 s29, s29, 1
s_cbranch_scc1 main_kernel_end
s_waitcnt vmcnt(0)
v_max_u32 v126, v16, v18
v_cmp_eq_u32 vcc, -1, v126
s_cbranch_vccnz main_kernel_c4_o4_f
s_branch main_kernel_c4_o4
main_kernel_c4_o5_f:
s_nop 0
s_xor_b32 s32, s23, 5120
buffer_load_dwordx4 v[20:23], v116, s[4:7], s32 offen sc1
s_xor_b32 s32, s23, 6144
buffer_load_dwordx4 v[24:27], v116, s[4:7], s32 offen sc1
s_sub_u32 s29, s29, 1
s_cbranch_scc1 main_kernel_end
s_waitcnt vmcnt(0)
v_max_u32 v126, v20, v22
v_cmp_eq_u32 vcc, -1, v126
s_cbranch_vccnz main_kernel_c4_o5_f
s_branch main_kernel_c4_o5
main_kernel_c4_o6_f:
s_nop 0
s_xor_b32 s32, s23, 6144
buffer_load_dwordx4 v[24:27], v116, s[4:7], s32 offen sc1
s_xor_b32 s32, s23, 7168
buffer_load_dwordx4 v[28:31], v116, s[4:7], s32 offen sc1
s_sub_u32 s29, s29, 1
s_cbranch_scc1 main_kernel_end
s_waitcnt vmcnt(0)
v_max_u32 v126, v24, v26
v_cmp_eq_u32 vcc, -1, v126
s_cbranch_vccnz main_kernel_c4_o6_f
s_branch main_kernel_c4_o6
main_kernel_c4_o7_f:
s_nop 0
s_xor_b32 s32, s23, 7168
buffer_load_dwordx4 v[28:31], v116, s[4:7], s32 offen sc1
s_sub_u32 s29, s29, 1
s_cbranch_scc1 main_kernel_end
s_waitcnt vmcnt(0)
v_max_u32 v126, v28, v30
v_cmp_eq_u32 vcc, -1, v126
s_cbranch_vccnz main_kernel_c4_o7_f
s_branch main_kernel_c4_o7
.p2align 6
main_kernel_c5_top:
s_barrier
buffer_load_dwordx4 v[0:3], v116, s[4:7], s18 offen sc1
s_add_u32 s20, s20, 0x40000
s_bitset0_b32 s20, 20
s_add_u32 s21, s21, 0x40000
s_bitset0_b32 s21, 20
s_add_u32 s22, s22, 0x40000
s_bitset0_b32 s22, 20
s_add_u32 s23, s23, 0x40000
s_bitset0_b32 s23, 20
s_xor_b32 s32, s18, 1024
buffer_load_dwordx4 v[16:19], v116, s[4:7], s32 offen sc1
s_add_u32 s3, s3, 0x40000
s_bitset0_b32 s3, 20
s_add_u32 s17, s17, 1
s_bitcmp1_b32 0x77777777, s17
s_cselect_b32 s33, 0x800, 0
s_xor_b32 s54, s54, s33
s_xor_b32 s59, s59, s33
s_add_u32 s25, s52, s59
s_nop 0
buffer_load_dwordx4 v[64:67], v116, s[4:7], s19 offen sc1
v_mov_b32 v80, 0
v_mov_b32 v81, 0
s_nop 3
s_xor_b32 s32, s19, 1024
buffer_load_dwordx4 v[68:71], v116, s[4:7], s32 offen sc1
v_mov_b32 v82, 0
v_mov_b32 v83, 0
s_nop 3
s_xor_b32 s32, s18, 2048
buffer_load_dwordx4 v[32:35], v116, s[4:7], s32 offen sc1
v_mov_b32 v84, 0
v_mov_b32 v85, 0
s_nop 3
s_xor_b32 s32, s19, 2048
buffer_load_dwordx4 v[72:75], v116, s[4:7], s32 offen sc1
v_mov_b32 v86, 0
v_mov_b32 v87, 0
s_nop 3
s_xor_b32 s32, s18, 3072
buffer_load_dwordx4 v[48:51], v116, s[4:7], s32 offen sc1
v_mov_b32 v88, 0
v_mov_b32 v89, 0
s_nop 3
s_xor_b32 s32, s19, 3072
buffer_load_dwordx4 v[76:79], v116, s[4:7], s32 offen sc1
v_mov_b32 v90, 0
v_mov_b32 v91, 0
s_waitcnt vmcnt(5)
v_pk_add_f16 v0, v0, v64
v_pk_add_f16 v1, v1, v65
v_pk_add_f16 v2, v2, v66
v_pk_add_f16 v3, v3, v67
v_cmp_u_f16 vcc, v0, v2
s_cbranch_vccnz main_kernel_c5_m0_f
main_kernel_c5_m0:
v_smfmac_f32_16x16x64_f16 v[80:83], v[0:3], a[0:7], v112
ds_write_b128 v116, v[0:3] offset:1024
v_smfmac_f32_16x16x64_f16 v[84:87], v[0:3], a[128:135], v112
buffer_load_dword v123, v121, s[4:7], 0 offen sc1
s_waitcnt vmcnt(5)
v_pk_add_f16 v16, v16, v68
v_pk_add_f16 v17, v17, v69
v_pk_add_f16 v18, v18, v70
v_pk_add_f16 v19, v19, v71
v_cmp_u_f16 vcc, v16, v18
s_waitcnt lgkmcnt(0)
s_barrier
ds_read_b128 v[4:7], v116 offset:0
ds_write_b128 v116, v[16:19] offset:5120
s_cbranch_vccnz main_kernel_c5_m1_f
main_kernel_c5_m1:
v_smfmac_f32_16x16x64_f16 v[80:83], v[16:19], a[8:15], v112
v_smfmac_f32_16x16x64_f16 v[84:87], v[16:19], a[136:143], v112
ds_read_b128 v[8:11], v116 offset:3072
v_smfmac_f32_16x16x64_f16 v[88:91], v[0:3], v[128:135], v112
ds_read_b128 v[12:15], v116 offset:2048
s_waitcnt lgkmcnt(3)
v_smfmac_f32_16x16x64_f16 v[80:83], v[4:7], a[32:39], v112
v_smfmac_f32_16x16x64_f16 v[84:87], v[4:7], a[160:167], v112
v_smfmac_f32_16x16x64_f16 v[88:91], v[4:7], v[136:143], v112
s_waitcnt lgkmcnt(2)
s_barrier
s_waitcnt lgkmcnt(1)
v_smfmac_f32_16x16x64_f16 v[80:83], v[8:11], a[64:71], v112
s_waitcnt vmcnt(3)
ds_read_b128 v[20:23], v116 offset:4096
v_pk_add_f16 v32, v32, v72
v_smfmac_f32_16x16x64_f16 v[84:87], v[8:11], a[192:199], v112
ds_read_b128 v[24:27], v116 offset:7168
s_waitcnt lgkmcnt(2)
v_pk_add_f16 v33, v33, v73
v_smfmac_f32_16x16x64_f16 v[80:83], v[12:15], a[96:103], v112
ds_read_b128 v[28:31], v116 offset:6144
v_pk_add_f16 v34, v34, v74
v_smfmac_f32_16x16x64_f16 v[84:87], v[12:15], a[224:231], v112
s_waitcnt lgkmcnt(2)
v_pk_add_f16 v35, v35, v75
v_smfmac_f32_16x16x64_f16 v[80:83], v[20:23], a[40:47], v112
ds_write_b128 v116, v[32:35] offset:9216
v_cmp_u_f16 vcc, v32, v34
v_smfmac_f32_16x16x64_f16 v[84:87], v[20:23], a[168:175], v112
s_cbranch_vccnz main_kernel_c5_m2_f
main_kernel_c5_m2:
v_smfmac_f32_16x16x64_f16 v[80:83], v[32:35], a[16:23], v112
buffer_load_dwordx4 v[96:99], v116, s[4:7], s28 offen sc1
v_smfmac_f32_16x16x64_f16 v[84:87], v[32:35], a[144:151], v112
s_add_u32 s28, s28, 0x40000
s_waitcnt lgkmcnt(2)
v_smfmac_f32_16x16x64_f16 v[80:83], v[24:27], a[72:79], v112
s_waitcnt vmcnt(2)
v_pk_add_f16 v48, v48, v76
v_smfmac_f32_16x16x64_f16 v[84:87], v[24:27], a[200:207], v112
s_waitcnt lgkmcnt(0)
s_barrier
ds_read_b128 v[36:39], v116 offset:8192
v_pk_add_f16 v49, v49, v77
v_smfmac_f32_16x16x64_f16 v[80:83], v[28:31], a[104:111], v112
ds_read_b128 v[40:43], v116 offset:11264
v_pk_add_f16 v50, v50, v78
v_smfmac_f32_16x16x64_f16 v[84:87], v[28:31], a[232:239], v112
ds_read_b128 v[44:47], v116 offset:10240
v_pk_add_f16 v51, v51, v79
v_smfmac_f32_16x16x64_f16 v[88:91], v[8:11], v[144:151], v112
ds_write_b128 v116, v[48:51] offset:13312
s_waitcnt lgkmcnt(3)
v_cmp_u_f16 vcc, v48, v50
v_smfmac_f32_16x16x64_f16 v[80:83], v[36:39], a[48:55], v112
s_cbranch_vccnz main_kernel_c5_m3_f
main_kernel_c5_m3:
v_smfmac_f32_16x16x64_f16 v[80:83], v[48:51], a[24:31], v112
v_smfmac_f32_16x16x64_f16 v[84:87], v[48:51], a[152:159], v112
v_smfmac_f32_16x16x64_f16 v[84:87], v[36:39], a[176:183], v112
s_waitcnt lgkmcnt(2)
v_smfmac_f32_16x16x64_f16 v[80:83], v[40:43], a[80:87], v112
s_waitcnt lgkmcnt(0)
s_barrier
ds_read_b128 v[52:55], v116 offset:12288
v_smfmac_f32_16x16x64_f16 v[84:87], v[40:43], a[208:215], v112
s_add_u32 s19, s52, s54
ds_read_b128 v[56:59], v116 offset:15360
v_smfmac_f32_16x16x64_f16 v[80:83], v[44:47], a[112:119], v112
s_add_u32 s18, s18, 0x40000
ds_read_b128 v[60:63], v116 offset:14336
v_smfmac_f32_16x16x64_f16 v[84:87], v[44:47], a[240:247], v112
s_bitset0_b32 s18, 20
s_waitcnt lgkmcnt(2)
v_smfmac_f32_16x16x64_f16 v[80:83], v[52:55], a[56:63], v112
s_cmp_eq_u32 s17, 30
s_cselect_b32 s32, s53, 0x10000
s_waitcnt lgkmcnt(1)
v_smfmac_f32_16x16x64_f16 v[80:83], v[56:59], a[88:95], v112
s_add_u32 s52, s52, s32
s_waitcnt lgkmcnt(0)
v_smfmac_f32_16x16x64_f16 v[80:83], v[60:63], a[120:127], v112
s_sub_u32 s24, 0x20000, s32
ds_read_b128 v[64:67], v116 offset:24576
v_smfmac_f32_16x16x64_f16 v[84:87], v[52:55], a[184:191], v112
s_add_u32 s55, s55, s24
ds_read_b128 v[68:71], v116 offset:28672
v_smfmac_f32_16x16x64_f16 v[84:87], v[56:59], a[216:223], v112
ds_read_b128 v[72:75], v116 offset:25600
s_nop 0
v_cvt_pk_bf16_f32 v92, v80, v81
v_smfmac_f32_16x16x64_f16 v[84:87], v[60:63], a[248:255], v112
ds_read_b128 v[76:79], v116 offset:29696
s_nop 0
v_cvt_pk_bf16_f32 v93, v82, v83
v_smfmac_f32_16x16x64_f16 v[88:91], v[12:15], v[152:159], v112
s_nop 3
v_cvt_pk_bf16_f32 v94, v84, v85
v_cvt_pk_bf16_f32 v95, v86, v87
s_mov_b32 vcc_lo, 0xcccccccc
s_mov_b32 vcc_hi, 0xcccccccc
v_mfma_f32_16x16x32_bf16 v[84:87], v[92:95], v[104:107], 0
v_add_u32 v121, v121, v122
v_writelane_b32 v121, s55, 39
s_nop 0
v_smfmac_f32_16x16x64_f16 v[88:91], v[16:19], v[160:167], v112
s_nop 2
s_cmp_eq_u32 s17, 63
v_cvt_pk_bf16_f32 v114, v84, v85
v_cvt_pk_bf16_f32 v115, v86, v87
buffer_store_dwordx2 v[114:115], v117, s[4:7], s21 offen sc1
s_cbranch_scc1 main_kernel_c5_last
ds_write_b64 v117, v[114:115] offset:16896
v_smfmac_f32_16x16x64_f16 v[88:91], v[20:23], v[168:175], v112
v_smfmac_f32_16x16x64_f16 v[88:91], v[24:27], v[176:183], v112
v_smfmac_f32_16x16x64_f16 v[88:91], v[28:31], v[184:191], v112
v_smfmac_f32_16x16x64_f16 v[88:91], v[32:35], v[192:199], v112
s_waitcnt lgkmcnt(0)
s_barrier
ds_read_b128 v[0:3], v116 offset:16384
v_smfmac_f32_16x16x64_f16 v[88:91], v[36:39], v[200:207], v112
ds_read_b128 v[4:7], v116 offset:17408
v_smfmac_f32_16x16x64_f16 v[88:91], v[40:43], v[208:215], v112
ds_read_b128 v[16:19], v116 offset:26624
v_smfmac_f32_16x16x64_f16 v[88:91], v[44:47], v[216:223], v112
ds_read_b128 v[20:23], v116 offset:30720
v_smfmac_f32_16x16x64_f16 v[88:91], v[48:51], v[224:231], v112
ds_read_b128 v[24:27], v116 offset:27648
v_smfmac_f32_16x16x64_f16 v[88:91], v[52:55], v[232:239], v112
ds_read_b128 v[28:31], v116 offset:31744
v_smfmac_f32_16x16x64_f16 v[88:91], v[56:59], v[240:247], v112
v_smfmac_f32_16x16x64_f16 v[88:91], v[60:63], v[248:255], v112
s_waitcnt lgkmcnt(5)
v_mfma_f32_16x16x32_bf16 v[80:83], v[64:67], v[0:3], 0
v_mfma_f32_16x16x32_bf16 v[84:87], v[68:71], v[0:3], 0
buffer_load_dwordx4 v[8:11], v116, s[4:7], s20 offen offset:0 sc1
v_mfma_f32_16x16x32_bf16 v[92:95], v[0:3], v[0:3], 0
buffer_load_dwordx4 v[12:15], v116, s[4:7], s20 offen offset:1024 sc1
v_permlane32_swap_b32 v88, v90
s_waitcnt lgkmcnt(4)
v_mfma_f32_16x16x32_bf16 v[80:83], v[72:75], v[4:7], v[80:83]
v_permlane32_swap_b32 v89, v91
v_mfma_f32_16x16x32_bf16 v[84:87], v[76:79], v[4:7], v[84:87]
v_pk_add_f32 v[88:89], v[88:89], v[90:91]
v_mfma_f32_16x16x32_bf16 v[92:95], v[4:7], v[4:7], v[92:95]
v_cvt_pk_bf16_f32 v124, v88, v89
v_mov_b32 v65, 0
s_waitcnt lgkmcnt(0)
s_waitcnt vmcnt(1)
v_mfma_f32_16x16x32_bf16 v[88:91], v[8:11], v[8:11], v[92:95]
v_mfma_f32_16x16x32_bf16 v[0:3], v[16:19], v[8:11], v[80:83]
v_cmp_u_f32 s[0:1], v8, v10
v_mfma_f32_16x16x32_bf16 v[4:7], v[20:23], v[8:11], v[84:87]
s_waitcnt vmcnt(0)
v_mfma_f32_16x16x32_bf16 v[88:91], v[12:15], v[12:15], v[88:91]
v_mfma_f32_16x16x32_bf16 v[0:3], v[24:27], v[12:15], v[0:3]
v_cmp_u_f32 s[32:33], v12, v14
v_mfma_f32_16x16x32_bf16 v[4:7], v[28:31], v[12:15], v[4:7]
s_or_b64 s[0:1], s[0:1], s[32:33]
s_cbranch_scc1 main_kernel_c5_z_f
main_kernel_c5_z:
v_mul_f32 v88, s30, v88
v_mul_f32 v89, s30, v89
v_exp_f32 v88, v88
v_exp_f32 v89, v89
v_cndmask_b32_dpp v0, v2, v0, vcc quad_perm:[2,3,2,3] row_mask:0xf bank_mask:0xf
v_cvt_pk_bf16_f32 v64, v88, v89
v_cndmask_b32_dpp v1, v3, v1, vcc quad_perm:[2,3,2,3] row_mask:0xf bank_mask:0xf
v_exp_f32 v0, v0
v_mfma_f32_16x16x16_bf16 v[16:19], v[100:101], v[64:65], 0
v_exp_f32 v1, v1
v_cndmask_b32_dpp v4, v6, v4, vcc quad_perm:[2,3,2,3] row_mask:0xf bank_mask:0xf
v_mfma_f32_16x16x16_bf16 v[8:11], v[124:125], v[64:65], 0
v_cndmask_b32_dpp v5, v7, v5, vcc quad_perm:[2,3,2,3] row_mask:0xf bank_mask:0xf
v_exp_f32 v4, v4
v_exp_f32 v5, v5
v_cvt_pk_bf16_f32 v92, v0, v1
v_cvt_pk_bf16_f32 v94, v4, v5
v_mov_b32 v80, 0
v_mov_b32_dpp v93, v92 quad_perm:[0,1,0,1] row_mask:0xf bank_mask:0xf
v_mov_b32_dpp v95, v94 quad_perm:[0,1,0,1] row_mask:0xf bank_mask:0xf
v_mov_b32 v81, 0
v_mov_b32 v82, 0
v_mfma_f32_16x16x32_bf16 v[16:19], v[100:103], v[92:95], v[16:19]
v_mov_b32 v83, 0
v_mov_b32 v84, 0
v_mfma_f32_16x16x32_bf16 v[8:11], v[96:99], v[92:95], v[8:11]
s_nop 1
v_mov_b32 v85, 0
v_mov_b32 v86, 0
v_mov_b32 v87, 0
v_rcp_f32 v126, v16
v_subrev_u32 v127, 0x21800000, v16
v_cmp_lt_u32 vcc, 0x3c000000, v127
v_pk_mul_f32 v[8:9], v[8:9], v[126:127] op_sel_hi:[1,0]
v_pk_mul_f32 v[10:11], v[10:11], v[126:127] op_sel_hi:[1,0]
s_and_b32 s32, vcc_lo, 0xcccc
v_cvt_pk_bf16_f32 v126, v8, v9
v_cvt_pk_bf16_f32 v127, v10, v11
s_cbranch_scc1 main_kernel_c5_sm_f
main_kernel_c5_ost:
buffer_store_dwordx2 v[126:127], v118, s[4:7], s22 offen sc1
v_cmp_eq_u32 s[0:1], 0, v123
v_mov_b32 v24, -1
v_mov_b32 v25, -1
v_mov_b32 v26, -1
v_mov_b32 v27, -1
ds_read_b128 v[32:35], v113 offset:0
ds_read_b128 v[36:39], v113 offset:1024
ds_read_b128 v[40:43], v113 offset:2048
ds_read_b128 v[44:47], v113 offset:3072
ds_read_b128 v[48:51], v113 offset:4096
ds_read_b128 v[52:55], v113 offset:5120
s_and_b32 s10, s1, 0x3f00
buffer_store_dwordx4 v[24:27], v116, s[4:7], s3 offen sc1
buffer_store_dwordx4 v[24:27], v116, s[4:7], s46 offen sc1
s_barrier
buffer_load_dwordx4 v[0:3], v116, s[4:7], s23 offen sc1
ds_read_b128 v[56:59], v113 offset:6144
ds_read_b128 v[60:63], v113 offset:7168
s_add_u32 s46, s46, 0x40000
s_bitset0_b32 s46, 20
s_add_u32 s37, s37, 65536
s_add_u32 s26, s26, 65536
s_xor_b32 s32, s23, 1024
buffer_load_dwordx4 v[4:7], v116, s[4:7], s32 offen sc1
ds_read_b128 v[64:67], v113 offset:8192
ds_read_b128 v[68:71], v113 offset:9216
s_nop 3
s_xor_b32 s32, s23, 2048
buffer_load_dwordx4 v[8:11], v116, s[4:7], s32 offen sc1
ds_read_b128 v[72:75], v113 offset:10240
ds_read_b128 v[76:79], v113 offset:11264
s_nop 3
s_xor_b32 s32, s23, 3072
buffer_load_dwordx4 v[12:15], v116, s[4:7], s32 offen sc1
ds_read_b128 v[88:91], v113 offset:12288
ds_read_b128 v[92:95], v113 offset:13312
s_nop 3
s_xor_b32 s32, s23, 4096
buffer_load_dwordx4 v[16:19], v116, s[4:7], s32 offen sc1
s_nop 7
s_xor_b32 s32, s23, 5120
buffer_load_dwordx4 v[20:23], v116, s[4:7], s32 offen sc1
s_nop 7
s_xor_b32 s32, s23, 6144
buffer_load_dwordx4 v[24:27], v116, s[4:7], s32 offen sc1
s_nop 7
s_xor_b32 s32, s23, 7168
buffer_load_dwordx4 v[28:31], v116, s[4:7], s32 offen sc1
s_waitcnt lgkmcnt(12)
s_waitcnt vmcnt(7)
v_cmp_u_f32 vcc, v0, v2
s_cbranch_vccnz main_kernel_c5_o0_f
main_kernel_c5_o0:
v_smfmac_f32_16x16x64_bf16 v[80:83], v[0:3], v[32:39], v112
ds_read_b128 v[32:35], v113 offset:14336
ds_read_b128 v[36:39], v113 offset:15360
s_waitcnt lgkmcnt(12)
s_waitcnt vmcnt(6)
v_cmp_u_f32 vcc, v4, v6
v_smfmac_f32_16x16x64_bf16 v[84:87], v[0:3], v[40:47], v112
ds_read_b128 v[40:43], v113 offset:16384
ds_read_b128 v[44:47], v113 offset:17408
buffer_store_dwordx2 v[114:115], v119, s[4:7], s37 offen sc1
s_cbranch_vccnz main_kernel_c5_o1_f
main_kernel_c5_o1:
s_waitcnt lgkmcnt(12)
v_smfmac_f32_16x16x64_bf16 v[80:83], v[4:7], v[48:55], v112
ds_read_b128 v[48:51], v113 offset:18432
ds_read_b128 v[52:55], v113 offset:19456
s_waitcnt lgkmcnt(12)
s_waitcnt vmcnt(6)
v_cmp_u_f32 vcc, v8, v10
v_smfmac_f32_16x16x64_bf16 v[84:87], v[4:7], v[56:63], v112
ds_read_b128 v[56:59], v113 offset:20480
ds_read_b128 v[60:63], v113 offset:21504
buffer_store_dword v124, v120, s[4:7], s26 offen sc1
s_cbranch_vccnz main_kernel_c5_o2_f
main_kernel_c5_o2:
s_waitcnt lgkmcnt(12)
v_smfmac_f32_16x16x64_bf16 v[80:83], v[8:11], v[64:71], v112
ds_read_b128 v[64:67], v113 offset:22528
ds_read_b128 v[68:71], v113 offset:23552
s_waitcnt lgkmcnt(12)
s_waitcnt vmcnt(6)
v_cmp_u_f32 vcc, v12, v14
v_smfmac_f32_16x16x64_bf16 v[84:87], v[8:11], v[72:79], v112
ds_read_b128 v[72:75], v113 offset:24576
ds_read_b128 v[76:79], v113 offset:25600
s_cbranch_vccnz main_kernel_c5_o3_f
main_kernel_c5_o3:
s_waitcnt lgkmcnt(12)
v_smfmac_f32_16x16x64_bf16 v[80:83], v[12:15], v[88:95], v112
ds_read_b128 v[88:91], v113 offset:26624
ds_read_b128 v[92:95], v113 offset:27648
s_waitcnt lgkmcnt(12)
s_waitcnt vmcnt(5)
v_cmp_u_f32 vcc, v16, v18
v_smfmac_f32_16x16x64_bf16 v[84:87], v[12:15], v[32:39], v112
ds_read_b128 v[32:35], v113 offset:28672
ds_read_b128 v[36:39], v113 offset:29696
s_cbranch_vccnz main_kernel_c5_o4_f
main_kernel_c5_o4:
s_waitcnt lgkmcnt(12)
v_smfmac_f32_16x16x64_bf16 v[80:83], v[16:19], v[40:47], v112
ds_read_b128 v[40:43], v113 offset:30720
ds_read_b128 v[44:47], v113 offset:31744
s_waitcnt lgkmcnt(12)
s_waitcnt vmcnt(4)
v_cmp_u_f32 vcc, v20, v22
v_smfmac_f32_16x16x64_bf16 v[84:87], v[16:19], v[48:55], v112
s_cbranch_vccnz main_kernel_c5_o5_f
main_kernel_c5_o5:
s_waitcnt lgkmcnt(10)
v_smfmac_f32_16x16x64_bf16 v[80:83], v[20:23], v[56:63], v112
s_waitcnt lgkmcnt(8)
s_waitcnt vmcnt(3)
v_cmp_u_f32 vcc, v24, v26
v_smfmac_f32_16x16x64_bf16 v[84:87], v[20:23], v[64:71], v112
s_cbranch_vccnz main_kernel_c5_o6_f
main_kernel_c5_o6:
s_waitcnt lgkmcnt(6)
v_smfmac_f32_16x16x64_bf16 v[80:83], v[24:27], v[72:79], v112
s_waitcnt lgkmcnt(4)
v_smfmac_f32_16x16x64_bf16 v[84:87], v[24:27], v[88:95], v112
s_waitcnt lgkmcnt(2)
s_waitcnt vmcnt(2)
v_cmp_u_f32 vcc, v28, v30
s_cbranch_vccnz main_kernel_c5_o7_f
main_kernel_c5_o7:
v_smfmac_f32_16x16x64_bf16 v[80:83], v[28:31], v[32:39], v112
s_waitcnt lgkmcnt(0)
v_smfmac_f32_16x16x64_bf16 v[84:87], v[28:31], v[40:47], v112
s_nop 4
v_cvt_pk_bf16_f32 v80, v80, v81
v_cvt_pk_bf16_f32 v81, v82, v83
ds_write_b64 v116, v[80:81] offset:20488
v_cvt_pk_bf16_f32 v82, v84, v85
v_cvt_pk_bf16_f32 v83, v86, v87
ds_write_b64 v116, v[82:83] offset:22536
s_waitcnt lgkmcnt(0)
s_barrier
ds_read_b128 v[72:75], v116 offset:22528
ds_read_b128 v[76:79], v116 offset:23552
s_mov_b32 m0, 26624
s_cmp_lg_u32 s10, 0
s_waitcnt lgkmcnt(1)
v_mfma_f32_16x16x32_bf16 v[64:67], v[72:75], v[108:111], 0
s_waitcnt lgkmcnt(0)
v_mfma_f32_16x16x32_bf16 v[64:67], v[76:79], v[108:111], v[64:67]
s_nop 7
v_cvt_pk_f16_f32 v68, v64, v65
v_cvt_pk_f16_f32 v69, v66, v67
buffer_store_dwordx2 v[68:69], v125, s[4:7], s25 offen sc1
s_cbranch_scc1 main_kernel_c5_kvw
main_kernel_c5_kvok:
s_nop 3
buffer_load_dwordx4 v116, s[4:7], s27 offen sc1 lds
buffer_load_dwordx4 v116, s[4:7], s27 offen offset:1024 sc1 lds
s_mov_b32 m0, 30720
s_xor_b32 s32, s27, 131072
buffer_load_dwordx4 v116, s[4:7], s32 offen offset:0 sc1 lds
s_add_u32 s27, s27, 0x40000
s_branch main_kernel_c5_top
main_kernel_c5_kvw:
s_mov_b32 exec_lo, 0
s_mov_b32 exec_hi, 0x3f00
v_subrev_u32 v127, 128, v121
main_kernel_c5_kvp:
buffer_load_dword v126, v127, s[4:7], 0 offen sc1
s_waitcnt vmcnt(0)
v_cmp_eq_u32 vcc, 0, v126
s_cbranch_vccz main_kernel_c5_kvp_ok
s_sleep 2
s_sub_u32 s29, s29, 1
s_cbranch_scc0 main_kernel_c5_kvp
s_branch main_kernel_end
main_kernel_c5_kvp_ok:
s_mov_b64 exec, -1
s_branch main_kernel_c5_kvok
main_kernel_c5_last:
s_add_u32 s37, s37, 65536
s_add_u32 s26, s26, 65536
buffer_store_dwordx2 v[114:115], v119, s[4:7], s37 offen sc1
v_smfmac_f32_16x16x64_f16 v[88:91], v[20:23], v[168:175], v112
v_smfmac_f32_16x16x64_f16 v[88:91], v[24:27], v[176:183], v112
v_smfmac_f32_16x16x64_f16 v[88:91], v[28:31], v[184:191], v112
v_smfmac_f32_16x16x64_f16 v[88:91], v[32:35], v[192:199], v112
v_smfmac_f32_16x16x64_f16 v[88:91], v[36:39], v[200:207], v112
v_smfmac_f32_16x16x64_f16 v[88:91], v[40:43], v[208:215], v112
v_smfmac_f32_16x16x64_f16 v[88:91], v[44:47], v[216:223], v112
v_smfmac_f32_16x16x64_f16 v[88:91], v[48:51], v[224:231], v112
v_smfmac_f32_16x16x64_f16 v[88:91], v[52:55], v[232:239], v112
v_smfmac_f32_16x16x64_f16 v[88:91], v[56:59], v[240:247], v112
v_smfmac_f32_16x16x64_f16 v[88:91], v[60:63], v[248:255], v112
s_nop 7
v_permlane32_swap_b32 v88, v90
s_nop 1
v_permlane32_swap_b32 v89, v91
s_nop 1
v_pk_add_f32 v[88:89], v[88:89], v[90:91]
s_nop 1
v_cvt_pk_bf16_f32 v124, v88, v89
s_nop 1
buffer_store_dword v124, v120, s[4:7], s26 offen sc1
s_branch main_kernel_end
main_kernel_c5_m0_f:
s_waitcnt lgkmcnt(0)
buffer_load_dwordx4 v[0:3], v116, s[4:7], s18 offen sc1
buffer_load_dwordx4 v[64:67], v116, s[4:7], s19 offen sc1
s_xor_b32 s32, s18, 1024
buffer_load_dwordx4 v[16:19], v116, s[4:7], s32 offen sc1
s_xor_b32 s32, s19, 1024
buffer_load_dwordx4 v[68:71], v116, s[4:7], s32 offen sc1
s_xor_b32 s32, s18, 2048
buffer_load_dwordx4 v[32:35], v116, s[4:7], s32 offen sc1
s_xor_b32 s32, s19, 2048
buffer_load_dwordx4 v[72:75], v116, s[4:7], s32 offen sc1
s_xor_b32 s32, s18, 3072
buffer_load_dwordx4 v[48:51], v116, s[4:7], s32 offen sc1
s_xor_b32 s32, s19, 3072
buffer_load_dwordx4 v[76:79], v116, s[4:7], s32 offen sc1
s_sub_u32 s29, s29, 1
s_cbranch_scc1 main_kernel_end
s_waitcnt vmcnt(0)
v_max_u32 v126, v0, v2
v_max3_u32 v126, v126, v64, v66
v_cmp_eq_u32 vcc, -1, v126
s_cbranch_vccnz main_kernel_c5_m0_f
v_pk_add_f16 v0, v0, v64
v_pk_add_f16 v1, v1, v65
v_pk_add_f16 v2, v2, v66
v_pk_add_f16 v3, v3, v67
s_nop 0
s_branch main_kernel_c5_m0
main_kernel_c5_m1_f:
s_waitcnt lgkmcnt(0)
s_xor_b32 s32, s18, 1024
buffer_load_dwordx4 v[16:19], v116, s[4:7], s32 offen sc1
s_xor_b32 s32, s19, 1024
buffer_load_dwordx4 v[68:71], v116, s[4:7], s32 offen sc1
s_xor_b32 s32, s18, 2048
buffer_load_dwordx4 v[32:35], v116, s[4:7], s32 offen sc1
s_xor_b32 s32, s19, 2048
buffer_load_dwordx4 v[72:75], v116, s[4:7], s32 offen sc1
s_xor_b32 s32, s18, 3072
buffer_load_dwordx4 v[48:51], v116, s[4:7], s32 offen sc1
s_xor_b32 s32, s19, 3072
buffer_load_dwordx4 v[76:79], v116, s[4:7], s32 offen sc1
s_sub_u32 s29, s29, 1
s_cbranch_scc1 main_kernel_end
s_waitcnt vmcnt(0)
v_max_u32 v126, v16, v18
v_max3_u32 v126, v126, v68, v70
v_cmp_eq_u32 vcc, -1, v126
s_cbranch_vccnz main_kernel_c5_m1_f
v_pk_add_f16 v16, v16, v68
v_pk_add_f16 v17, v17, v69
v_pk_add_f16 v18, v18, v70
v_pk_add_f16 v19, v19, v71
ds_write_b128 v116, v[16:19] offset:5120
s_branch main_kernel_c5_m1
main_kernel_c5_m2_f:
s_waitcnt lgkmcnt(0)
s_xor_b32 s32, s18, 2048
buffer_load_dwordx4 v[32:35], v116, s[4:7], s32 offen sc1
s_xor_b32 s32, s19, 2048
buffer_load_dwordx4 v[72:75], v116, s[4:7], s32 offen sc1
s_xor_b32 s32, s18, 3072
buffer_load_dwordx4 v[48:51], v116, s[4:7], s32 offen sc1
s_xor_b32 s32, s19, 3072
buffer_load_dwordx4 v[76:79], v116, s[4:7], s32 offen sc1
s_sub_u32 s29, s29, 1
s_cbranch_scc1 main_kernel_end
s_waitcnt vmcnt(0)
v_max_u32 v126, v32, v34
v_max3_u32 v126, v126, v72, v74
v_cmp_eq_u32 vcc, -1, v126
s_cbranch_vccnz main_kernel_c5_m2_f
v_pk_add_f16 v32, v32, v72
v_pk_add_f16 v33, v33, v73
v_pk_add_f16 v34, v34, v74
v_pk_add_f16 v35, v35, v75
ds_write_b128 v116, v[32:35] offset:9216
s_branch main_kernel_c5_m2
main_kernel_c5_m3_f:
s_waitcnt lgkmcnt(0)
s_xor_b32 s32, s18, 3072
buffer_load_dwordx4 v[48:51], v116, s[4:7], s32 offen sc1
s_xor_b32 s32, s19, 3072
buffer_load_dwordx4 v[76:79], v116, s[4:7], s32 offen sc1
s_sub_u32 s29, s29, 1
s_cbranch_scc1 main_kernel_end
s_waitcnt vmcnt(0)
v_max_u32 v126, v48, v50
v_max3_u32 v126, v126, v76, v78
v_cmp_eq_u32 vcc, -1, v126
s_cbranch_vccnz main_kernel_c5_m3_f
v_pk_add_f16 v48, v48, v76
v_pk_add_f16 v49, v49, v77
v_pk_add_f16 v50, v50, v78
v_pk_add_f16 v51, v51, v79
ds_write_b128 v116, v[48:51] offset:13312
s_branch main_kernel_c5_m3
main_kernel_c5_z_f:
buffer_load_dwordx4 v[8:11], v116, s[4:7], s20 offen offset:0 sc1
buffer_load_dwordx4 v[12:15], v116, s[4:7], s20 offen offset:1024 sc1
s_memtime s[32:33]
ds_read_b32 v126, v116 offset:18432
s_sub_u32 s34, s19, s54
s_xor_b32 s34, s34, 0x2000
s_lshl_b32 s35, s12, 15
s_add_u32 s34, s34, s35
s_lshl_b32 s35, s13, 8
s_add_u32 s35, s35, s34
s_add_u32 s34, s34, 0x4000
s_waitcnt lgkmcnt(0)
s_sub_u32 s32, s32, 450
v_sub_u32 v127, s32, v126
buffer_store_dword v127, off, s[4:7], s34 sc1
s_sub_u32 s29, s29, 1
s_cbranch_scc1 main_kernel_end
s_waitcnt vmcnt(1)
main_kernel_c5_z_g:
v_max_u32 v126, v8, v10
v_max3_u32 v126, v126, v12, v14
v_cmp_eq_u32 vcc, -1, v126
s_cbranch_vccnz main_kernel_c5_z_h
v_mfma_f32_16x16x32_bf16 v[88:91], v[8:11], v[8:11], v[92:95]
v_mfma_f32_16x16x32_bf16 v[0:3], v[16:19], v[8:11], v[80:83]
v_mfma_f32_16x16x32_bf16 v[4:7], v[20:23], v[8:11], v[84:87]
v_mfma_f32_16x16x32_bf16 v[88:91], v[12:15], v[12:15], v[88:91]
v_mfma_f32_16x16x32_bf16 v[0:3], v[24:27], v[12:15], v[0:3]
v_mfma_f32_16x16x32_bf16 v[4:7], v[28:31], v[12:15], v[4:7]
buffer_store_dword v127, off, s[4:7], s35 offset:132 sc1
s_mov_b32 vcc_lo, 0xcccccccc
s_mov_b32 vcc_hi, 0xcccccccc
s_branch main_kernel_c5_z
main_kernel_c5_z_h:
buffer_load_dwordx4 v[8:11], v116, s[4:7], s20 offen offset:0 sc1
buffer_load_dwordx4 v[12:15], v116, s[4:7], s20 offen offset:1024 sc1
s_sub_u32 s29, s29, 1
s_cbranch_scc1 main_kernel_end
v_add_u32 v127, 300, v127
s_waitcnt vmcnt(0)
s_branch main_kernel_c5_z_g
main_kernel_c5_sm_f:
s_waitcnt vmcnt(0) lgkmcnt(0)
buffer_load_dwordx4 v[8:11], v116, s[4:7], s20 offen offset:0 sc1
buffer_load_dwordx4 v[12:15], v116, s[4:7], s20 offen offset:1024 sc1
ds_read_b128 v[0:3], v116 offset:16384
ds_read_b128 v[4:7], v116 offset:17408
ds_read_b128 v[64:67], v116 offset:24576
ds_read_b128 v[68:71], v116 offset:28672
ds_read_b128 v[72:75], v116 offset:25600
ds_read_b128 v[76:79], v116 offset:29696
ds_read_b128 v[16:19], v116 offset:26624
ds_read_b128 v[20:23], v116 offset:30720
ds_read_b128 v[24:27], v116 offset:27648
ds_read_b128 v[28:31], v116 offset:31744
s_waitcnt vmcnt(0)
s_waitcnt lgkmcnt(0)
v_mfma_f32_16x16x32_bf16 v[80:83], v[64:67], v[0:3], 0
v_mfma_f32_16x16x32_bf16 v[84:87], v[68:71], v[0:3], 0
v_mfma_f32_16x16x32_bf16 v[92:95], v[0:3], v[0:3], 0
v_mfma_f32_16x16x32_bf16 v[80:83], v[72:75], v[4:7], v[80:83]
v_mfma_f32_16x16x32_bf16 v[84:87], v[76:79], v[4:7], v[84:87]
v_mfma_f32_16x16x32_bf16 v[92:95], v[4:7], v[4:7], v[92:95]
v_mfma_f32_16x16x32_bf16 v[0:3], v[16:19], v[8:11], v[80:83]
v_mfma_f32_16x16x32_bf16 v[4:7], v[20:23], v[8:11], v[84:87]
v_mfma_f32_16x16x32_bf16 v[88:91], v[8:11], v[8:11], v[92:95]
v_mfma_f32_16x16x32_bf16 v[0:3], v[24:27], v[12:15], v[0:3]
v_mfma_f32_16x16x32_bf16 v[4:7], v[28:31], v[12:15], v[4:7]
v_mfma_f32_16x16x32_bf16 v[88:91], v[12:15], v[12:15], v[88:91]
s_nop 7
v_mov_b32 v65, 0
v_max_f32 v126, v88, v89
v_mul_f32 v126, s30, v126
v_max3_f32 v126, v126, v0, v1
v_max3_f32 v126, v126, v2, v3
v_max3_f32 v126, v126, v4, v5
v_max3_f32 v126, v126, v6, v7
v_mov_b32 v127, v126
s_nop 1
v_permlane32_swap_b32 v126, v127
v_max_f32 v126, v126, v127
v_mov_b32 v127, v126
s_nop 1
v_permlane16_swap_b32 v126, v127
v_max_f32 v126, v126, v127
v_mul_f32 v127, 0x40faf233, v126
s_mov_b32 vcc_lo, 0xcccccccc
s_mov_b32 vcc_hi, 0xcccccccc
v_sub_f32 v0, v0, v126
v_sub_f32 v1, v1, v126
v_sub_f32 v2, v2, v126
v_sub_f32 v3, v3, v126
v_sub_f32 v4, v4, v126
v_sub_f32 v5, v5, v126
v_sub_f32 v6, v6, v126
v_sub_f32 v7, v7, v126
v_sub_f32 v88, v88, v127
v_sub_f32 v89, v89, v127
s_waitcnt lgkmcnt(0)
s_nop 0
v_mul_f32 v88, s30, v88
v_mul_f32 v89, s30, v89
v_exp_f32 v88, v88
v_exp_f32 v89, v89
v_cndmask_b32_dpp v0, v2, v0, vcc quad_perm:[2,3,2,3] row_mask:0xf bank_mask:0xf
v_cvt_pk_bf16_f32 v64, v88, v89
v_cndmask_b32_dpp v1, v3, v1, vcc quad_perm:[2,3,2,3] row_mask:0xf bank_mask:0xf
v_exp_f32 v0, v0
v_mfma_f32_16x16x16_bf16 v[16:19], v[100:101], v[64:65], 0
v_exp_f32 v1, v1
v_cndmask_b32_dpp v4, v6, v4, vcc quad_perm:[2,3,2,3] row_mask:0xf bank_mask:0xf
v_mfma_f32_16x16x16_bf16 v[8:11], v[124:125], v[64:65], 0
v_cndmask_b32_dpp v5, v7, v5, vcc quad_perm:[2,3,2,3] row_mask:0xf bank_mask:0xf
v_exp_f32 v4, v4
v_exp_f32 v5, v5
v_cvt_pk_bf16_f32 v92, v0, v1
v_cvt_pk_bf16_f32 v94, v4, v5
v_mov_b32 v80, 0
v_mov_b32_dpp v93, v92 quad_perm:[0,1,0,1] row_mask:0xf bank_mask:0xf
v_mov_b32_dpp v95, v94 quad_perm:[0,1,0,1] row_mask:0xf bank_mask:0xf
v_mov_b32 v81, 0
v_mov_b32 v82, 0
v_mfma_f32_16x16x32_bf16 v[16:19], v[100:103], v[92:95], v[16:19]
v_mov_b32 v83, 0
v_mov_b32 v84, 0
v_mfma_f32_16x16x32_bf16 v[8:11], v[96:99], v[92:95], v[8:11]
s_nop 1
v_mov_b32 v85, 0
v_mov_b32 v86, 0
v_mov_b32 v87, 0
v_rcp_f32 v126, v16
v_subrev_u32 v127, 0x21800000, v16
v_cmp_lt_u32 vcc, 0x3c000000, v127
v_pk_mul_f32 v[8:9], v[8:9], v[126:127] op_sel_hi:[1,0]
v_pk_mul_f32 v[10:11], v[10:11], v[126:127] op_sel_hi:[1,0]
s_and_b32 s32, vcc_lo, 0xcccc
v_cvt_pk_bf16_f32 v126, v8, v9
v_cvt_pk_bf16_f32 v127, v10, v11
s_branch main_kernel_c5_ost
main_kernel_c5_o0_f:
s_nop 0
buffer_load_dwordx4 v[0:3], v116, s[4:7], s23 offen sc1
s_xor_b32 s32, s23, 1024
buffer_load_dwordx4 v[4:7], v116, s[4:7], s32 offen sc1
s_sub_u32 s29, s29, 1
s_cbranch_scc1 main_kernel_end
s_waitcnt vmcnt(0)
v_max_u32 v126, v0, v2
v_cmp_eq_u32 vcc, -1, v126
s_cbranch_vccnz main_kernel_c5_o0_f
s_branch main_kernel_c5_o0
main_kernel_c5_o1_f:
s_nop 0
s_xor_b32 s32, s23, 1024
buffer_load_dwordx4 v[4:7], v116, s[4:7], s32 offen sc1
s_xor_b32 s32, s23, 2048
buffer_load_dwordx4 v[8:11], v116, s[4:7], s32 offen sc1
s_sub_u32 s29, s29, 1
s_cbranch_scc1 main_kernel_end
s_waitcnt vmcnt(0)
v_max_u32 v126, v4, v6
v_cmp_eq_u32 vcc, -1, v126
s_cbranch_vccnz main_kernel_c5_o1_f
s_branch main_kernel_c5_o1
main_kernel_c5_o2_f:
s_nop 0
s_xor_b32 s32, s23, 2048
buffer_load_dwordx4 v[8:11], v116, s[4:7], s32 offen sc1
s_xor_b32 s32, s23, 3072
buffer_load_dwordx4 v[12:15], v116, s[4:7], s32 offen sc1
s_sub_u32 s29, s29, 1
s_cbranch_scc1 main_kernel_end
s_waitcnt vmcnt(0)
v_max_u32 v126, v8, v10
v_cmp_eq_u32 vcc, -1, v126
s_cbranch_vccnz main_kernel_c5_o2_f
s_branch main_kernel_c5_o2
main_kernel_c5_o3_f:
s_nop 0
s_xor_b32 s32, s23, 3072
buffer_load_dwordx4 v[12:15], v116, s[4:7], s32 offen sc1
s_xor_b32 s32, s23, 4096
buffer_load_dwordx4 v[16:19], v116, s[4:7], s32 offen sc1
s_sub_u32 s29, s29, 1
s_cbranch_scc1 main_kernel_end
s_waitcnt vmcnt(0)
v_max_u32 v126, v12, v14
v_cmp_eq_u32 vcc, -1, v126
s_cbranch_vccnz main_kernel_c5_o3_f
s_branch main_kernel_c5_o3
main_kernel_c5_o4_f:
s_nop 0
s_xor_b32 s32, s23, 4096
buffer_load_dwordx4 v[16:19], v116, s[4:7], s32 offen sc1
s_xor_b32 s32, s23, 5120
buffer_load_dwordx4 v[20:23], v116, s[4:7], s32 offen sc1
s_sub_u32 s29, s29, 1
s_cbranch_scc1 main_kernel_end
s_waitcnt vmcnt(0)
v_max_u32 v126, v16, v18
v_cmp_eq_u32 vcc, -1, v126
s_cbranch_vccnz main_kernel_c5_o4_f
s_branch main_kernel_c5_o4
main_kernel_c5_o5_f:
s_nop 0
s_xor_b32 s32, s23, 5120
buffer_load_dwordx4 v[20:23], v116, s[4:7], s32 offen sc1
s_xor_b32 s32, s23, 6144
buffer_load_dwordx4 v[24:27], v116, s[4:7], s32 offen sc1
s_sub_u32 s29, s29, 1
s_cbranch_scc1 main_kernel_end
s_waitcnt vmcnt(0)
v_max_u32 v126, v20, v22
v_cmp_eq_u32 vcc, -1, v126
s_cbranch_vccnz main_kernel_c5_o5_f
s_branch main_kernel_c5_o5
main_kernel_c5_o6_f:
s_nop 0
s_xor_b32 s32, s23, 6144
buffer_load_dwordx4 v[24:27], v116, s[4:7], s32 offen sc1
s_xor_b32 s32, s23, 7168
buffer_load_dwordx4 v[28:31], v116, s[4:7], s32 offen sc1
s_sub_u32 s29, s29, 1
s_cbranch_scc1 main_kernel_end
s_waitcnt vmcnt(0)
v_max_u32 v126, v24, v26
v_cmp_eq_u32 vcc, -1, v126
s_cbranch_vccnz main_kernel_c5_o6_f
s_branch main_kernel_c5_o6
main_kernel_c5_o7_f:
s_nop 0
s_xor_b32 s32, s23, 7168
buffer_load_dwordx4 v[28:31], v116, s[4:7], s32 offen sc1
s_sub_u32 s29, s29, 1
s_cbranch_scc1 main_kernel_end
s_waitcnt vmcnt(0)
v_max_u32 v126, v28, v30
v_cmp_eq_u32 vcc, -1, v126
s_cbranch_vccnz main_kernel_c5_o7_f
s_branch main_kernel_c5_o7
.p2align 6
main_kernel_c6_top:
s_barrier
buffer_load_dwordx4 v[0:3], v116, s[4:7], s18 offen sc1
s_add_u32 s20, s20, 0x40000
s_bitset0_b32 s20, 20
s_add_u32 s21, s21, 0x40000
s_bitset0_b32 s21, 20
s_add_u32 s22, s22, 0x40000
s_bitset0_b32 s22, 20
s_add_u32 s23, s23, 0x40000
s_bitset0_b32 s23, 20
s_xor_b32 s32, s18, 1024
buffer_load_dwordx4 v[16:19], v116, s[4:7], s32 offen sc1
s_add_u32 s3, s3, 0x40000
s_bitset0_b32 s3, 20
s_add_u32 s17, s17, 1
s_bitcmp1_b32 0x77777777, s17
s_cselect_b32 s33, 0x800, 0
s_xor_b32 s54, s54, s33
s_add_u32 s25, s25, 0x40000
s_bitset0_b32 s25, 20
s_nop 0
buffer_load_dwordx4 v[64:67], v116, s[4:7], s19 offen sc1
v_mov_b32 v80, 0
v_mov_b32 v81, 0
s_nop 3
s_xor_b32 s32, s19, 1024
buffer_load_dwordx4 v[68:71], v116, s[4:7], s32 offen sc1
v_mov_b32 v82, 0
v_mov_b32 v83, 0
s_nop 3
s_xor_b32 s32, s18, 2048
buffer_load_dwordx4 v[32:35], v116, s[4:7], s32 offen sc1
v_mov_b32 v84, 0
v_mov_b32 v85, 0
s_nop 3
s_xor_b32 s32, s19, 2048
buffer_load_dwordx4 v[72:75], v116, s[4:7], s32 offen sc1
v_mov_b32 v86, 0
v_mov_b32 v87, 0
s_nop 3
s_xor_b32 s32, s18, 3072
buffer_load_dwordx4 v[48:51], v116, s[4:7], s32 offen sc1
v_mov_b32 v88, 0
v_mov_b32 v89, 0
s_nop 3
s_xor_b32 s32, s19, 3072
buffer_load_dwordx4 v[76:79], v116, s[4:7], s32 offen sc1
v_mov_b32 v90, 0
v_mov_b32 v91, 0
s_waitcnt vmcnt(5)
v_pk_add_f16 v0, v0, v64
v_pk_add_f16 v1, v1, v65
v_pk_add_f16 v2, v2, v66
v_pk_add_f16 v3, v3, v67
v_cmp_u_f16 vcc, v0, v2
s_cbranch_vccnz main_kernel_c6_m0_f
main_kernel_c6_m0:
v_smfmac_f32_16x16x64_f16 v[80:83], v[0:3], a[0:7], v112
ds_write_b128 v116, v[0:3] offset:2048
v_smfmac_f32_16x16x64_f16 v[84:87], v[0:3], a[128:135], v112
buffer_load_dword v123, v121, s[4:7], 0 offen sc1
s_waitcnt vmcnt(5)
v_pk_add_f16 v16, v16, v68
v_pk_add_f16 v17, v17, v69
v_pk_add_f16 v18, v18, v70
v_pk_add_f16 v19, v19, v71
v_cmp_u_f16 vcc, v16, v18
s_waitcnt lgkmcnt(0)
s_barrier
ds_read_b128 v[4:7], v116 offset:3072
s_cbranch_vccnz main_kernel_c6_m1_f
main_kernel_c6_m1:
v_smfmac_f32_16x16x64_f16 v[80:83], v[16:19], a[8:15], v112
ds_write_b128 v116, v[16:19] offset:6144
v_smfmac_f32_16x16x64_f16 v[84:87], v[16:19], a[136:143], v112
ds_read_b128 v[8:11], v116 offset:0
v_smfmac_f32_16x16x64_f16 v[88:91], v[0:3], v[128:135], v112
ds_read_b128 v[12:15], v116 offset:1024
s_waitcnt lgkmcnt(3)
v_smfmac_f32_16x16x64_f16 v[80:83], v[4:7], a[32:39], v112
v_smfmac_f32_16x16x64_f16 v[84:87], v[4:7], a[160:167], v112
v_smfmac_f32_16x16x64_f16 v[88:91], v[4:7], v[136:143], v112
s_waitcnt lgkmcnt(2)
s_barrier
s_waitcnt lgkmcnt(1)
v_smfmac_f32_16x16x64_f16 v[80:83], v[8:11], a[64:71], v112
s_waitcnt vmcnt(3)
ds_read_b128 v[20:23], v116 offset:7168
v_pk_add_f16 v32, v32, v72
v_smfmac_f32_16x16x64_f16 v[84:87], v[8:11], a[192:199], v112
ds_read_b128 v[24:27], v116 offset:4096
s_waitcnt lgkmcnt(2)
v_pk_add_f16 v33, v33, v73
v_smfmac_f32_16x16x64_f16 v[80:83], v[12:15], a[96:103], v112
ds_read_b128 v[28:31], v116 offset:5120
v_pk_add_f16 v34, v34, v74
v_smfmac_f32_16x16x64_f16 v[84:87], v[12:15], a[224:231], v112
s_waitcnt lgkmcnt(2)
v_pk_add_f16 v35, v35, v75
v_smfmac_f32_16x16x64_f16 v[80:83], v[20:23], a[40:47], v112
v_cmp_u_f16 vcc, v32, v34
v_smfmac_f32_16x16x64_f16 v[84:87], v[20:23], a[168:175], v112
ds_write_b128 v116, v[32:35] offset:10240
s_cbranch_vccnz main_kernel_c6_m2_f
main_kernel_c6_m2:
v_smfmac_f32_16x16x64_f16 v[80:83], v[32:35], a[16:23], v112
buffer_load_dwordx4 v[96:99], v116, s[4:7], s28 offen sc1
v_smfmac_f32_16x16x64_f16 v[84:87], v[32:35], a[144:151], v112
s_add_u32 s28, s28, 0x40000
s_waitcnt lgkmcnt(2)
v_smfmac_f32_16x16x64_f16 v[80:83], v[24:27], a[72:79], v112
s_waitcnt vmcnt(2)
v_pk_add_f16 v48, v48, v76
v_smfmac_f32_16x16x64_f16 v[84:87], v[24:27], a[200:207], v112
s_waitcnt lgkmcnt(0)
s_barrier
ds_read_b128 v[36:39], v116 offset:11264
v_pk_add_f16 v49, v49, v77
v_smfmac_f32_16x16x64_f16 v[80:83], v[28:31], a[104:111], v112
ds_read_b128 v[40:43], v116 offset:8192
v_pk_add_f16 v50, v50, v78
v_smfmac_f32_16x16x64_f16 v[84:87], v[28:31], a[232:239], v112
ds_read_b128 v[44:47], v116 offset:9216
v_pk_add_f16 v51, v51, v79
v_smfmac_f32_16x16x64_f16 v[88:91], v[8:11], v[144:151], v112
s_waitcnt lgkmcnt(2)
v_cmp_u_f16 vcc, v48, v50
v_smfmac_f32_16x16x64_f16 v[80:83], v[36:39], a[48:55], v112
ds_write_b128 v116, v[48:51] offset:14336
s_cbranch_vccnz main_kernel_c6_m3_f
main_kernel_c6_m3:
v_smfmac_f32_16x16x64_f16 v[80:83], v[48:51], a[24:31], v112
v_smfmac_f32_16x16x64_f16 v[84:87], v[48:51], a[152:159], v112
v_smfmac_f32_16x16x64_f16 v[84:87], v[36:39], a[176:183], v112
s_waitcnt lgkmcnt(2)
v_smfmac_f32_16x16x64_f16 v[80:83], v[40:43], a[80:87], v112
s_waitcnt lgkmcnt(0)
s_barrier
ds_read_b128 v[52:55], v116 offset:15360
v_smfmac_f32_16x16x64_f16 v[84:87], v[40:43], a[208:215], v112
s_add_u32 s19, s52, s54
ds_read_b128 v[56:59], v116 offset:12288
v_smfmac_f32_16x16x64_f16 v[80:83], v[44:47], a[112:119], v112
s_add_u32 s18, s18, 0x40000
ds_read_b128 v[60:63], v116 offset:13312
v_smfmac_f32_16x16x64_f16 v[84:87], v[44:47], a[240:247], v112
s_bitset0_b32 s18, 20
s_waitcnt lgkmcnt(2)
v_smfmac_f32_16x16x64_f16 v[80:83], v[52:55], a[56:63], v112
s_cmp_eq_u32 s17, 30
s_cselect_b32 s32, s53, 0x10000
s_waitcnt lgkmcnt(1)
v_smfmac_f32_16x16x64_f16 v[80:83], v[56:59], a[88:95], v112
s_add_u32 s52, s52, s32
s_waitcnt lgkmcnt(0)
v_smfmac_f32_16x16x64_f16 v[80:83], v[60:63], a[120:127], v112
s_sub_u32 s24, 0x20000, s32
ds_read_b128 v[64:67], v116 offset:24576
v_smfmac_f32_16x16x64_f16 v[84:87], v[52:55], a[184:191], v112
s_add_u32 s55, s55, s24
ds_read_b128 v[68:71], v116 offset:28672
v_smfmac_f32_16x16x64_f16 v[84:87], v[56:59], a[216:223], v112
ds_read_b128 v[72:75], v116 offset:25600
s_nop 0
v_cvt_pk_bf16_f32 v92, v80, v81
v_smfmac_f32_16x16x64_f16 v[84:87], v[60:63], a[248:255], v112
ds_read_b128 v[76:79], v116 offset:29696
s_nop 0
v_cvt_pk_bf16_f32 v93, v82, v83
v_smfmac_f32_16x16x64_f16 v[88:91], v[12:15], v[152:159], v112
s_nop 3
v_cvt_pk_bf16_f32 v94, v84, v85
v_cvt_pk_bf16_f32 v95, v86, v87
s_mov_b32 vcc_lo, 0xcccccccc
s_mov_b32 vcc_hi, 0xcccccccc
v_mfma_f32_16x16x32_bf16 v[84:87], v[92:95], v[104:107], 0
v_add_u32 v121, v121, v122
v_writelane_b32 v121, s55, 39
s_nop 0
v_smfmac_f32_16x16x64_f16 v[88:91], v[16:19], v[160:167], v112
s_nop 2
s_cmp_eq_u32 s17, 63
v_cvt_pk_bf16_f32 v114, v84, v85
v_cvt_pk_bf16_f32 v115, v86, v87
buffer_store_dwordx2 v[114:115], v117, s[4:7], s21 offen sc1
s_cbranch_scc1 main_kernel_c6_last
ds_write_b64 v117, v[114:115] offset:17408
v_smfmac_f32_16x16x64_f16 v[88:91], v[20:23], v[168:175], v112
v_smfmac_f32_16x16x64_f16 v[88:91], v[24:27], v[176:183], v112
v_smfmac_f32_16x16x64_f16 v[88:91], v[28:31], v[184:191], v112
v_smfmac_f32_16x16x64_f16 v[88:91], v[32:35], v[192:199], v112
s_waitcnt lgkmcnt(0)
s_barrier
ds_read_b128 v[0:3], v116 offset:16384
v_smfmac_f32_16x16x64_f16 v[88:91], v[36:39], v[200:207], v112
ds_read_b128 v[4:7], v116 offset:17408
v_smfmac_f32_16x16x64_f16 v[88:91], v[40:43], v[208:215], v112
ds_read_b128 v[16:19], v116 offset:26624
v_smfmac_f32_16x16x64_f16 v[88:91], v[44:47], v[216:223], v112
ds_read_b128 v[20:23], v116 offset:30720
v_smfmac_f32_16x16x64_f16 v[88:91], v[48:51], v[224:231], v112
ds_read_b128 v[24:27], v116 offset:27648
v_smfmac_f32_16x16x64_f16 v[88:91], v[52:55], v[232:239], v112
ds_read_b128 v[28:31], v116 offset:31744
v_smfmac_f32_16x16x64_f16 v[88:91], v[56:59], v[240:247], v112
v_smfmac_f32_16x16x64_f16 v[88:91], v[60:63], v[248:255], v112
s_waitcnt lgkmcnt(5)
v_mfma_f32_16x16x32_bf16 v[80:83], v[64:67], v[0:3], 0
v_mfma_f32_16x16x32_bf16 v[84:87], v[68:71], v[0:3], 0
buffer_load_dwordx4 v[8:11], v116, s[4:7], s20 offen offset:0 sc1
v_mfma_f32_16x16x32_bf16 v[92:95], v[0:3], v[0:3], 0
buffer_load_dwordx4 v[12:15], v116, s[4:7], s20 offen offset:1024 sc1
v_permlane32_swap_b32 v88, v90
s_waitcnt lgkmcnt(4)
v_mfma_f32_16x16x32_bf16 v[80:83], v[72:75], v[4:7], v[80:83]
v_permlane32_swap_b32 v89, v91
v_mfma_f32_16x16x32_bf16 v[84:87], v[76:79], v[4:7], v[84:87]
v_pk_add_f32 v[88:89], v[88:89], v[90:91]
v_mfma_f32_16x16x32_bf16 v[92:95], v[4:7], v[4:7], v[92:95]
v_cvt_pk_bf16_f32 v124, v88, v89
v_mov_b32 v65, 0
s_waitcnt lgkmcnt(0)
s_waitcnt vmcnt(1)
v_mfma_f32_16x16x32_bf16 v[88:91], v[8:11], v[8:11], v[92:95]
v_mfma_f32_16x16x32_bf16 v[0:3], v[16:19], v[8:11], v[80:83]
v_cmp_u_f32 s[0:1], v8, v10
v_mfma_f32_16x16x32_bf16 v[4:7], v[20:23], v[8:11], v[84:87]
s_waitcnt vmcnt(0)
v_mfma_f32_16x16x32_bf16 v[88:91], v[12:15], v[12:15], v[88:91]
v_mfma_f32_16x16x32_bf16 v[0:3], v[24:27], v[12:15], v[0:3]
v_cmp_u_f32 s[32:33], v12, v14
v_mfma_f32_16x16x32_bf16 v[4:7], v[28:31], v[12:15], v[4:7]
s_or_b64 s[0:1], s[0:1], s[32:33]
s_cbranch_scc1 main_kernel_c6_z_f
main_kernel_c6_z:
v_mul_f32 v88, s30, v88
v_mul_f32 v89, s30, v89
v_exp_f32 v88, v88
v_exp_f32 v89, v89
v_cndmask_b32_dpp v0, v2, v0, vcc quad_perm:[2,3,2,3] row_mask:0xf bank_mask:0xf
v_cvt_pk_bf16_f32 v64, v88, v89
v_cndmask_b32_dpp v1, v3, v1, vcc quad_perm:[2,3,2,3] row_mask:0xf bank_mask:0xf
v_exp_f32 v0, v0
v_mfma_f32_16x16x16_bf16 v[16:19], v[100:101], v[64:65], 0
v_exp_f32 v1, v1
v_cndmask_b32_dpp v4, v6, v4, vcc quad_perm:[2,3,2,3] row_mask:0xf bank_mask:0xf
v_mfma_f32_16x16x16_bf16 v[8:11], v[124:125], v[64:65], 0
v_cndmask_b32_dpp v5, v7, v5, vcc quad_perm:[2,3,2,3] row_mask:0xf bank_mask:0xf
v_exp_f32 v4, v4
v_exp_f32 v5, v5
v_cvt_pk_bf16_f32 v92, v0, v1
v_cvt_pk_bf16_f32 v94, v4, v5
v_mov_b32 v80, 0
v_mov_b32_dpp v93, v92 quad_perm:[0,1,0,1] row_mask:0xf bank_mask:0xf
v_mov_b32_dpp v95, v94 quad_perm:[0,1,0,1] row_mask:0xf bank_mask:0xf
v_mov_b32 v81, 0
v_mov_b32 v82, 0
v_mfma_f32_16x16x32_bf16 v[16:19], v[100:103], v[92:95], v[16:19]
v_mov_b32 v83, 0
v_mov_b32 v84, 0
v_mfma_f32_16x16x32_bf16 v[8:11], v[96:99], v[92:95], v[8:11]
s_nop 1
v_mov_b32 v85, 0
v_mov_b32 v86, 0
v_mov_b32 v87, 0
v_rcp_f32 v126, v16
v_subrev_u32 v127, 0x21800000, v16
v_cmp_lt_u32 vcc, 0x3c000000, v127
v_pk_mul_f32 v[8:9], v[8:9], v[126:127] op_sel_hi:[1,0]
v_pk_mul_f32 v[10:11], v[10:11], v[126:127] op_sel_hi:[1,0]
s_and_b32 s32, vcc_lo, 0xcccc
v_cvt_pk_bf16_f32 v126, v8, v9
v_cvt_pk_bf16_f32 v127, v10, v11
s_cbranch_scc1 main_kernel_c6_sm_f
main_kernel_c6_ost:
buffer_store_dwordx2 v[126:127], v118, s[4:7], s22 offen sc1
v_cmp_eq_u32 s[0:1], 0, v123
v_mov_b32 v24, -1
v_mov_b32 v25, -1
v_mov_b32 v26, -1
v_mov_b32 v27, -1
ds_read_b128 v[32:35], v113 offset:0
ds_read_b128 v[36:39], v113 offset:1024
ds_read_b128 v[40:43], v113 offset:2048
ds_read_b128 v[44:47], v113 offset:3072
ds_read_b128 v[48:51], v113 offset:4096
ds_read_b128 v[52:55], v113 offset:5120
s_and_b32 s10, s1, 0x3f00
buffer_store_dwordx4 v[24:27], v116, s[4:7], s3 offen sc1
s_barrier
buffer_load_dwordx4 v[0:3], v116, s[4:7], s23 offen sc1
ds_read_b128 v[56:59], v113 offset:6144
ds_read_b128 v[60:63], v113 offset:7168
s_add_u32 s37, s37, 65536
s_add_u32 s26, s26, 65536
s_nop 1
s_xor_b32 s32, s23, 1024
buffer_load_dwordx4 v[4:7], v116, s[4:7], s32 offen sc1
ds_read_b128 v[64:67], v113 offset:8192
ds_read_b128 v[68:71], v113 offset:9216
s_nop 3
s_xor_b32 s32, s23, 2048
buffer_load_dwordx4 v[8:11], v116, s[4:7], s32 offen sc1
ds_read_b128 v[72:75], v113 offset:10240
ds_read_b128 v[76:79], v113 offset:11264
s_nop 3
s_xor_b32 s32, s23, 3072
buffer_load_dwordx4 v[12:15], v116, s[4:7], s32 offen sc1
ds_read_b128 v[88:91], v113 offset:12288
ds_read_b128 v[92:95], v113 offset:13312
s_nop 3
s_xor_b32 s32, s23, 4096
buffer_load_dwordx4 v[16:19], v116, s[4:7], s32 offen sc1
s_nop 7
s_xor_b32 s32, s23, 5120
buffer_load_dwordx4 v[20:23], v116, s[4:7], s32 offen sc1
s_nop 7
s_xor_b32 s32, s23, 6144
buffer_load_dwordx4 v[24:27], v116, s[4:7], s32 offen sc1
s_nop 7
s_xor_b32 s32, s23, 7168
buffer_load_dwordx4 v[28:31], v116, s[4:7], s32 offen sc1
s_waitcnt lgkmcnt(12)
s_waitcnt vmcnt(7)
v_cmp_u_f32 vcc, v0, v2
s_cbranch_vccnz main_kernel_c6_o0_f
main_kernel_c6_o0:
v_smfmac_f32_16x16x64_bf16 v[80:83], v[0:3], v[32:39], v112
ds_read_b128 v[32:35], v113 offset:14336
ds_read_b128 v[36:39], v113 offset:15360
s_waitcnt lgkmcnt(12)
s_waitcnt vmcnt(6)
v_cmp_u_f32 vcc, v4, v6
v_smfmac_f32_16x16x64_bf16 v[84:87], v[0:3], v[40:47], v112
ds_read_b128 v[40:43], v113 offset:16384
ds_read_b128 v[44:47], v113 offset:17408
buffer_store_dwordx2 v[114:115], v119, s[4:7], s37 offen sc1
s_cbranch_vccnz main_kernel_c6_o1_f
main_kernel_c6_o1:
s_waitcnt lgkmcnt(12)
v_smfmac_f32_16x16x64_bf16 v[80:83], v[4:7], v[48:55], v112
ds_read_b128 v[48:51], v113 offset:18432
ds_read_b128 v[52:55], v113 offset:19456
s_waitcnt lgkmcnt(12)
s_waitcnt vmcnt(6)
v_cmp_u_f32 vcc, v8, v10
v_smfmac_f32_16x16x64_bf16 v[84:87], v[4:7], v[56:63], v112
ds_read_b128 v[56:59], v113 offset:20480
ds_read_b128 v[60:63], v113 offset:21504
buffer_store_dword v124, v120, s[4:7], s26 offen sc1
s_cbranch_vccnz main_kernel_c6_o2_f
main_kernel_c6_o2:
s_waitcnt lgkmcnt(12)
v_smfmac_f32_16x16x64_bf16 v[80:83], v[8:11], v[64:71], v112
ds_read_b128 v[64:67], v113 offset:22528
ds_read_b128 v[68:71], v113 offset:23552
s_waitcnt lgkmcnt(12)
s_waitcnt vmcnt(6)
v_cmp_u_f32 vcc, v12, v14
v_smfmac_f32_16x16x64_bf16 v[84:87], v[8:11], v[72:79], v112
ds_read_b128 v[72:75], v113 offset:24576
ds_read_b128 v[76:79], v113 offset:25600
s_cbranch_vccnz main_kernel_c6_o3_f
main_kernel_c6_o3:
s_waitcnt lgkmcnt(12)
v_smfmac_f32_16x16x64_bf16 v[80:83], v[12:15], v[88:95], v112
ds_read_b128 v[88:91], v113 offset:26624
ds_read_b128 v[92:95], v113 offset:27648
s_waitcnt lgkmcnt(12)
s_waitcnt vmcnt(5)
v_cmp_u_f32 vcc, v16, v18
v_smfmac_f32_16x16x64_bf16 v[84:87], v[12:15], v[32:39], v112
ds_read_b128 v[32:35], v113 offset:28672
ds_read_b128 v[36:39], v113 offset:29696
s_cbranch_vccnz main_kernel_c6_o4_f
main_kernel_c6_o4:
s_waitcnt lgkmcnt(12)
v_smfmac_f32_16x16x64_bf16 v[80:83], v[16:19], v[40:47], v112
ds_read_b128 v[40:43], v113 offset:30720
ds_read_b128 v[44:47], v113 offset:31744
s_waitcnt lgkmcnt(12)
s_waitcnt vmcnt(4)
v_cmp_u_f32 vcc, v20, v22
v_smfmac_f32_16x16x64_bf16 v[84:87], v[16:19], v[48:55], v112
s_cbranch_vccnz main_kernel_c6_o5_f
main_kernel_c6_o5:
s_waitcnt lgkmcnt(10)
v_smfmac_f32_16x16x64_bf16 v[80:83], v[20:23], v[56:63], v112
s_waitcnt lgkmcnt(8)
s_waitcnt vmcnt(3)
v_cmp_u_f32 vcc, v24, v26
v_smfmac_f32_16x16x64_bf16 v[84:87], v[20:23], v[64:71], v112
s_cbranch_vccnz main_kernel_c6_o6_f
main_kernel_c6_o6:
s_waitcnt lgkmcnt(6)
v_smfmac_f32_16x16x64_bf16 v[80:83], v[24:27], v[72:79], v112
s_waitcnt lgkmcnt(4)
v_smfmac_f32_16x16x64_bf16 v[84:87], v[24:27], v[88:95], v112
s_waitcnt lgkmcnt(2)
s_waitcnt vmcnt(2)
v_cmp_u_f32 vcc, v28, v30
s_cbranch_vccnz main_kernel_c6_o7_f
main_kernel_c6_o7:
v_smfmac_f32_16x16x64_bf16 v[80:83], v[28:31], v[32:39], v112
s_waitcnt lgkmcnt(0)
v_smfmac_f32_16x16x64_bf16 v[84:87], v[28:31], v[40:47], v112
s_nop 4
v_cvt_pk_bf16_f32 v80, v80, v81
v_cvt_pk_bf16_f32 v81, v82, v83
ds_write_b64 v116, v[80:81] offset:21504
v_cvt_pk_bf16_f32 v82, v84, v85
v_cvt_pk_bf16_f32 v83, v86, v87
ds_write_b64 v116, v[82:83] offset:23552
s_waitcnt lgkmcnt(0)
s_barrier
ds_read_b128 v[72:75], v116 offset:20480
ds_read_b128 v[76:79], v116 offset:21504
s_mov_b32 m0, 28672
s_cmp_lg_u32 s10, 0
s_waitcnt lgkmcnt(1)
v_mfma_f32_16x16x32_bf16 v[64:67], v[72:75], v[108:111], 0
s_waitcnt lgkmcnt(0)
v_mfma_f32_16x16x32_bf16 v[64:67], v[76:79], v[108:111], v[64:67]
s_nop 7
v_cvt_pk_f16_f32 v68, v64, v65
v_cvt_pk_f16_f32 v69, v66, v67
buffer_store_dwordx2 v[68:69], v125, s[4:7], s25 offen sc1
s_cbranch_scc1 main_kernel_c6_kvw
main_kernel_c6_kvok:
s_nop 3
buffer_load_dwordx4 v116, s[4:7], s27 offen sc1 lds
buffer_load_dwordx4 v116, s[4:7], s27 offen offset:1024 sc1 lds
s_mov_b32 m0, 30720
s_xor_b32 s32, s27, 2048
buffer_load_dwordx4 v116, s[4:7], s32 offen offset:1024 sc1 lds
s_add_u32 s27, s27, 0x40000
s_branch main_kernel_c6_top
main_kernel_c6_kvw:
s_mov_b32 exec_lo, 0
s_mov_b32 exec_hi, 0x3f00
v_subrev_u32 v127, 128, v121
main_kernel_c6_kvp:
buffer_load_dword v126, v127, s[4:7], 0 offen sc1
s_waitcnt vmcnt(0)
v_cmp_eq_u32 vcc, 0, v126
s_cbranch_vccz main_kernel_c6_kvp_ok
s_sleep 2
s_sub_u32 s29, s29, 1
s_cbranch_scc0 main_kernel_c6_kvp
s_branch main_kernel_end
main_kernel_c6_kvp_ok:
s_mov_b64 exec, -1
s_branch main_kernel_c6_kvok
main_kernel_c6_last:
s_add_u32 s37, s37, 65536
s_add_u32 s26, s26, 65536
buffer_store_dwordx2 v[114:115], v119, s[4:7], s37 offen sc1
v_smfmac_f32_16x16x64_f16 v[88:91], v[20:23], v[168:175], v112
v_smfmac_f32_16x16x64_f16 v[88:91], v[24:27], v[176:183], v112
v_smfmac_f32_16x16x64_f16 v[88:91], v[28:31], v[184:191], v112
v_smfmac_f32_16x16x64_f16 v[88:91], v[32:35], v[192:199], v112
v_smfmac_f32_16x16x64_f16 v[88:91], v[36:39], v[200:207], v112
v_smfmac_f32_16x16x64_f16 v[88:91], v[40:43], v[208:215], v112
v_smfmac_f32_16x16x64_f16 v[88:91], v[44:47], v[216:223], v112
v_smfmac_f32_16x16x64_f16 v[88:91], v[48:51], v[224:231], v112
v_smfmac_f32_16x16x64_f16 v[88:91], v[52:55], v[232:239], v112
v_smfmac_f32_16x16x64_f16 v[88:91], v[56:59], v[240:247], v112
v_smfmac_f32_16x16x64_f16 v[88:91], v[60:63], v[248:255], v112
s_nop 7
v_permlane32_swap_b32 v88, v90
s_nop 1
v_permlane32_swap_b32 v89, v91
s_nop 1
v_pk_add_f32 v[88:89], v[88:89], v[90:91]
s_nop 1
v_cvt_pk_bf16_f32 v124, v88, v89
s_nop 1
buffer_store_dword v124, v120, s[4:7], s26 offen sc1
s_branch main_kernel_end
main_kernel_c6_m0_f:
s_waitcnt lgkmcnt(0)
buffer_load_dwordx4 v[0:3], v116, s[4:7], s18 offen sc1
buffer_load_dwordx4 v[64:67], v116, s[4:7], s19 offen sc1
s_xor_b32 s32, s18, 1024
buffer_load_dwordx4 v[16:19], v116, s[4:7], s32 offen sc1
s_xor_b32 s32, s19, 1024
buffer_load_dwordx4 v[68:71], v116, s[4:7], s32 offen sc1
s_xor_b32 s32, s18, 2048
buffer_load_dwordx4 v[32:35], v116, s[4:7], s32 offen sc1
s_xor_b32 s32, s19, 2048
buffer_load_dwordx4 v[72:75], v116, s[4:7], s32 offen sc1
s_xor_b32 s32, s18, 3072
buffer_load_dwordx4 v[48:51], v116, s[4:7], s32 offen sc1
s_xor_b32 s32, s19, 3072
buffer_load_dwordx4 v[76:79], v116, s[4:7], s32 offen sc1
s_sub_u32 s29, s29, 1
s_cbranch_scc1 main_kernel_end
s_waitcnt vmcnt(0)
v_max_u32 v126, v0, v2
v_max3_u32 v126, v126, v64, v66
v_cmp_eq_u32 vcc, -1, v126
s_cbranch_vccnz main_kernel_c6_m0_f
v_pk_add_f16 v0, v0, v64
v_pk_add_f16 v1, v1, v65
v_pk_add_f16 v2, v2, v66
v_pk_add_f16 v3, v3, v67
s_nop 0
s_branch main_kernel_c6_m0
main_kernel_c6_m1_f:
s_waitcnt lgkmcnt(0)
s_xor_b32 s32, s18, 1024
buffer_load_dwordx4 v[16:19], v116, s[4:7], s32 offen sc1
s_xor_b32 s32, s19, 1024
buffer_load_dwordx4 v[68:71], v116, s[4:7], s32 offen sc1
s_xor_b32 s32, s18, 2048
buffer_load_dwordx4 v[32:35], v116, s[4:7], s32 offen sc1
s_xor_b32 s32, s19, 2048
buffer_load_dwordx4 v[72:75], v116, s[4:7], s32 offen sc1
s_xor_b32 s32, s18, 3072
buffer_load_dwordx4 v[48:51], v116, s[4:7], s32 offen sc1
s_xor_b32 s32, s19, 3072
buffer_load_dwordx4 v[76:79], v116, s[4:7], s32 offen sc1
s_sub_u32 s29, s29, 1
s_cbranch_scc1 main_kernel_end
s_waitcnt vmcnt(0)
v_max_u32 v126, v16, v18
v_max3_u32 v126, v126, v68, v70
v_cmp_eq_u32 vcc, -1, v126
s_cbranch_vccnz main_kernel_c6_m1_f
v_pk_add_f16 v16, v16, v68
v_pk_add_f16 v17, v17, v69
v_pk_add_f16 v18, v18, v70
v_pk_add_f16 v19, v19, v71
s_nop 0
s_branch main_kernel_c6_m1
main_kernel_c6_m2_f:
s_waitcnt lgkmcnt(0)
s_xor_b32 s32, s18, 2048
buffer_load_dwordx4 v[32:35], v116, s[4:7], s32 offen sc1
s_xor_b32 s32, s19, 2048
buffer_load_dwordx4 v[72:75], v116, s[4:7], s32 offen sc1
s_xor_b32 s32, s18, 3072
buffer_load_dwordx4 v[48:51], v116, s[4:7], s32 offen sc1
s_xor_b32 s32, s19, 3072
buffer_load_dwordx4 v[76:79], v116, s[4:7], s32 offen sc1
s_sub_u32 s29, s29, 1
s_cbranch_scc1 main_kernel_end
s_waitcnt vmcnt(0)
v_max_u32 v126, v32, v34
v_max3_u32 v126, v126, v72, v74
v_cmp_eq_u32 vcc, -1, v126
s_cbranch_vccnz main_kernel_c6_m2_f
v_pk_add_f16 v32, v32, v72
v_pk_add_f16 v33, v33, v73
v_pk_add_f16 v34, v34, v74
v_pk_add_f16 v35, v35, v75
ds_write_b128 v116, v[32:35] offset:10240
s_branch main_kernel_c6_m2
main_kernel_c6_m3_f:
s_waitcnt lgkmcnt(0)
s_xor_b32 s32, s18, 3072
buffer_load_dwordx4 v[48:51], v116, s[4:7], s32 offen sc1
s_xor_b32 s32, s19, 3072
buffer_load_dwordx4 v[76:79], v116, s[4:7], s32 offen sc1
s_sub_u32 s29, s29, 1
s_cbranch_scc1 main_kernel_end
s_waitcnt vmcnt(0)
v_max_u32 v126, v48, v50
v_max3_u32 v126, v126, v76, v78
v_cmp_eq_u32 vcc, -1, v126
s_cbranch_vccnz main_kernel_c6_m3_f
v_pk_add_f16 v48, v48, v76
v_pk_add_f16 v49, v49, v77
v_pk_add_f16 v50, v50, v78
v_pk_add_f16 v51, v51, v79
ds_write_b128 v116, v[48:51] offset:14336
s_branch main_kernel_c6_m3
main_kernel_c6_z_f:
buffer_load_dwordx4 v[8:11], v116, s[4:7], s20 offen offset:0 sc1
buffer_load_dwordx4 v[12:15], v116, s[4:7], s20 offen offset:1024 sc1
s_memtime s[32:33]
ds_read_b32 v126, v116 offset:18432
s_sub_u32 s34, s19, s54
s_xor_b32 s34, s34, 0x2000
s_lshl_b32 s35, s12, 15
s_add_u32 s34, s34, s35
s_lshl_b32 s35, s13, 8
s_add_u32 s35, s35, s34
s_add_u32 s34, s34, 0x4000
s_waitcnt lgkmcnt(0)
s_sub_u32 s32, s32, 450
v_sub_u32 v127, s32, v126
buffer_store_dword v127, off, s[4:7], s34 sc1
s_sub_u32 s29, s29, 1
s_cbranch_scc1 main_kernel_end
s_waitcnt vmcnt(1)
main_kernel_c6_z_g:
v_max_u32 v126, v8, v10
v_max3_u32 v126, v126, v12, v14
v_cmp_eq_u32 vcc, -1, v126
s_cbranch_vccnz main_kernel_c6_z_h
v_mfma_f32_16x16x32_bf16 v[88:91], v[8:11], v[8:11], v[92:95]
v_mfma_f32_16x16x32_bf16 v[0:3], v[16:19], v[8:11], v[80:83]
v_mfma_f32_16x16x32_bf16 v[4:7], v[20:23], v[8:11], v[84:87]
v_mfma_f32_16x16x32_bf16 v[88:91], v[12:15], v[12:15], v[88:91]
v_mfma_f32_16x16x32_bf16 v[0:3], v[24:27], v[12:15], v[0:3]
v_mfma_f32_16x16x32_bf16 v[4:7], v[28:31], v[12:15], v[4:7]
buffer_store_dword v127, off, s[4:7], s35 offset:132 sc1
s_mov_b32 vcc_lo, 0xcccccccc
s_mov_b32 vcc_hi, 0xcccccccc
s_branch main_kernel_c6_z
main_kernel_c6_z_h:
buffer_load_dwordx4 v[8:11], v116, s[4:7], s20 offen offset:0 sc1
buffer_load_dwordx4 v[12:15], v116, s[4:7], s20 offen offset:1024 sc1
s_sub_u32 s29, s29, 1
s_cbranch_scc1 main_kernel_end
v_add_u32 v127, 300, v127
s_waitcnt vmcnt(0)
s_branch main_kernel_c6_z_g
main_kernel_c6_sm_f:
s_waitcnt vmcnt(0) lgkmcnt(0)
buffer_load_dwordx4 v[8:11], v116, s[4:7], s20 offen offset:0 sc1
buffer_load_dwordx4 v[12:15], v116, s[4:7], s20 offen offset:1024 sc1
ds_read_b128 v[0:3], v116 offset:16384
ds_read_b128 v[4:7], v116 offset:17408
ds_read_b128 v[64:67], v116 offset:24576
ds_read_b128 v[68:71], v116 offset:28672
ds_read_b128 v[72:75], v116 offset:25600
ds_read_b128 v[76:79], v116 offset:29696
ds_read_b128 v[16:19], v116 offset:26624
ds_read_b128 v[20:23], v116 offset:30720
ds_read_b128 v[24:27], v116 offset:27648
ds_read_b128 v[28:31], v116 offset:31744
s_waitcnt vmcnt(0)
s_waitcnt lgkmcnt(0)
v_mfma_f32_16x16x32_bf16 v[80:83], v[64:67], v[0:3], 0
v_mfma_f32_16x16x32_bf16 v[84:87], v[68:71], v[0:3], 0
v_mfma_f32_16x16x32_bf16 v[92:95], v[0:3], v[0:3], 0
v_mfma_f32_16x16x32_bf16 v[80:83], v[72:75], v[4:7], v[80:83]
v_mfma_f32_16x16x32_bf16 v[84:87], v[76:79], v[4:7], v[84:87]
v_mfma_f32_16x16x32_bf16 v[92:95], v[4:7], v[4:7], v[92:95]
v_mfma_f32_16x16x32_bf16 v[0:3], v[16:19], v[8:11], v[80:83]
v_mfma_f32_16x16x32_bf16 v[4:7], v[20:23], v[8:11], v[84:87]
v_mfma_f32_16x16x32_bf16 v[88:91], v[8:11], v[8:11], v[92:95]
v_mfma_f32_16x16x32_bf16 v[0:3], v[24:27], v[12:15], v[0:3]
v_mfma_f32_16x16x32_bf16 v[4:7], v[28:31], v[12:15], v[4:7]
v_mfma_f32_16x16x32_bf16 v[88:91], v[12:15], v[12:15], v[88:91]
s_nop 7
v_mov_b32 v65, 0
v_max_f32 v126, v88, v89
v_mul_f32 v126, s30, v126
v_max3_f32 v126, v126, v0, v1
v_max3_f32 v126, v126, v2, v3
v_max3_f32 v126, v126, v4, v5
v_max3_f32 v126, v126, v6, v7
v_mov_b32 v127, v126
s_nop 1
v_permlane32_swap_b32 v126, v127
v_max_f32 v126, v126, v127
v_mov_b32 v127, v126
s_nop 1
v_permlane16_swap_b32 v126, v127
v_max_f32 v126, v126, v127
v_mul_f32 v127, 0x40faf233, v126
s_mov_b32 vcc_lo, 0xcccccccc
s_mov_b32 vcc_hi, 0xcccccccc
v_sub_f32 v0, v0, v126
v_sub_f32 v1, v1, v126
v_sub_f32 v2, v2, v126
v_sub_f32 v3, v3, v126
v_sub_f32 v4, v4, v126
v_sub_f32 v5, v5, v126
v_sub_f32 v6, v6, v126
v_sub_f32 v7, v7, v126
v_sub_f32 v88, v88, v127
v_sub_f32 v89, v89, v127
s_waitcnt lgkmcnt(0)
s_nop 0
v_mul_f32 v88, s30, v88
v_mul_f32 v89, s30, v89
v_exp_f32 v88, v88
v_exp_f32 v89, v89
v_cndmask_b32_dpp v0, v2, v0, vcc quad_perm:[2,3,2,3] row_mask:0xf bank_mask:0xf
v_cvt_pk_bf16_f32 v64, v88, v89
v_cndmask_b32_dpp v1, v3, v1, vcc quad_perm:[2,3,2,3] row_mask:0xf bank_mask:0xf
v_exp_f32 v0, v0
v_mfma_f32_16x16x16_bf16 v[16:19], v[100:101], v[64:65], 0
v_exp_f32 v1, v1
v_cndmask_b32_dpp v4, v6, v4, vcc quad_perm:[2,3,2,3] row_mask:0xf bank_mask:0xf
v_mfma_f32_16x16x16_bf16 v[8:11], v[124:125], v[64:65], 0
v_cndmask_b32_dpp v5, v7, v5, vcc quad_perm:[2,3,2,3] row_mask:0xf bank_mask:0xf
v_exp_f32 v4, v4
v_exp_f32 v5, v5
v_cvt_pk_bf16_f32 v92, v0, v1
v_cvt_pk_bf16_f32 v94, v4, v5
v_mov_b32 v80, 0
v_mov_b32_dpp v93, v92 quad_perm:[0,1,0,1] row_mask:0xf bank_mask:0xf
v_mov_b32_dpp v95, v94 quad_perm:[0,1,0,1] row_mask:0xf bank_mask:0xf
v_mov_b32 v81, 0
v_mov_b32 v82, 0
v_mfma_f32_16x16x32_bf16 v[16:19], v[100:103], v[92:95], v[16:19]
v_mov_b32 v83, 0
v_mov_b32 v84, 0
v_mfma_f32_16x16x32_bf16 v[8:11], v[96:99], v[92:95], v[8:11]
s_nop 1
v_mov_b32 v85, 0
v_mov_b32 v86, 0
v_mov_b32 v87, 0
v_rcp_f32 v126, v16
v_subrev_u32 v127, 0x21800000, v16
v_cmp_lt_u32 vcc, 0x3c000000, v127
v_pk_mul_f32 v[8:9], v[8:9], v[126:127] op_sel_hi:[1,0]
v_pk_mul_f32 v[10:11], v[10:11], v[126:127] op_sel_hi:[1,0]
s_and_b32 s32, vcc_lo, 0xcccc
v_cvt_pk_bf16_f32 v126, v8, v9
v_cvt_pk_bf16_f32 v127, v10, v11
s_branch main_kernel_c6_ost
main_kernel_c6_o0_f:
s_nop 0
buffer_load_dwordx4 v[0:3], v116, s[4:7], s23 offen sc1
s_xor_b32 s32, s23, 1024
buffer_load_dwordx4 v[4:7], v116, s[4:7], s32 offen sc1
s_sub_u32 s29, s29, 1
s_cbranch_scc1 main_kernel_end
s_waitcnt vmcnt(0)
v_max_u32 v126, v0, v2
v_cmp_eq_u32 vcc, -1, v126
s_cbranch_vccnz main_kernel_c6_o0_f
s_branch main_kernel_c6_o0
main_kernel_c6_o1_f:
s_nop 0
s_xor_b32 s32, s23, 1024
buffer_load_dwordx4 v[4:7], v116, s[4:7], s32 offen sc1
s_xor_b32 s32, s23, 2048
buffer_load_dwordx4 v[8:11], v116, s[4:7], s32 offen sc1
s_sub_u32 s29, s29, 1
s_cbranch_scc1 main_kernel_end
s_waitcnt vmcnt(0)
v_max_u32 v126, v4, v6
v_cmp_eq_u32 vcc, -1, v126
s_cbranch_vccnz main_kernel_c6_o1_f
s_branch main_kernel_c6_o1
main_kernel_c6_o2_f:
s_nop 0
s_xor_b32 s32, s23, 2048
buffer_load_dwordx4 v[8:11], v116, s[4:7], s32 offen sc1
s_xor_b32 s32, s23, 3072
buffer_load_dwordx4 v[12:15], v116, s[4:7], s32 offen sc1
s_sub_u32 s29, s29, 1
s_cbranch_scc1 main_kernel_end
s_waitcnt vmcnt(0)
v_max_u32 v126, v8, v10
v_cmp_eq_u32 vcc, -1, v126
s_cbranch_vccnz main_kernel_c6_o2_f
s_branch main_kernel_c6_o2
main_kernel_c6_o3_f:
s_nop 0
s_xor_b32 s32, s23, 3072
buffer_load_dwordx4 v[12:15], v116, s[4:7], s32 offen sc1
s_xor_b32 s32, s23, 4096
buffer_load_dwordx4 v[16:19], v116, s[4:7], s32 offen sc1
s_sub_u32 s29, s29, 1
s_cbranch_scc1 main_kernel_end
s_waitcnt vmcnt(0)
v_max_u32 v126, v12, v14
v_cmp_eq_u32 vcc, -1, v126
s_cbranch_vccnz main_kernel_c6_o3_f
s_branch main_kernel_c6_o3
main_kernel_c6_o4_f:
s_nop 0
s_xor_b32 s32, s23, 4096
buffer_load_dwordx4 v[16:19], v116, s[4:7], s32 offen sc1
s_xor_b32 s32, s23, 5120
buffer_load_dwordx4 v[20:23], v116, s[4:7], s32 offen sc1
s_sub_u32 s29, s29, 1
s_cbranch_scc1 main_kernel_end
s_waitcnt vmcnt(0)
v_max_u32 v126, v16, v18
v_cmp_eq_u32 vcc, -1, v126
s_cbranch_vccnz main_kernel_c6_o4_f
s_branch main_kernel_c6_o4
main_kernel_c6_o5_f:
s_nop 0
s_xor_b32 s32, s23, 5120
buffer_load_dwordx4 v[20:23], v116, s[4:7], s32 offen sc1
s_xor_b32 s32, s23, 6144
buffer_load_dwordx4 v[24:27], v116, s[4:7], s32 offen sc1
s_sub_u32 s29, s29, 1
s_cbranch_scc1 main_kernel_end
s_waitcnt vmcnt(0)
v_max_u32 v126, v20, v22
v_cmp_eq_u32 vcc, -1, v126
s_cbranch_vccnz main_kernel_c6_o5_f
s_branch main_kernel_c6_o5
main_kernel_c6_o6_f:
s_nop 0
s_xor_b32 s32, s23, 6144
buffer_load_dwordx4 v[24:27], v116, s[4:7], s32 offen sc1
s_xor_b32 s32, s23, 7168
buffer_load_dwordx4 v[28:31], v116, s[4:7], s32 offen sc1
s_sub_u32 s29, s29, 1
s_cbranch_scc1 main_kernel_end
s_waitcnt vmcnt(0)
v_max_u32 v126, v24, v26
v_cmp_eq_u32 vcc, -1, v126
s_cbranch_vccnz main_kernel_c6_o6_f
s_branch main_kernel_c6_o6
main_kernel_c6_o7_f:
s_nop 0
s_xor_b32 s32, s23, 7168
buffer_load_dwordx4 v[28:31], v116, s[4:7], s32 offen sc1
s_sub_u32 s29, s29, 1
s_cbranch_scc1 main_kernel_end
s_waitcnt vmcnt(0)
v_max_u32 v126, v28, v30
v_cmp_eq_u32 vcc, -1, v126
s_cbranch_vccnz main_kernel_c6_o7_f
s_branch main_kernel_c6_o7
.p2align 6
main_kernel_c7_top:
s_barrier
buffer_load_dwordx4 v[0:3], v116, s[4:7], s18 offen sc1
s_add_u32 s20, s20, 0x40000
s_bitset0_b32 s20, 20
s_add_u32 s21, s21, 0x40000
s_bitset0_b32 s21, 20
s_add_u32 s22, s22, 0x40000
s_bitset0_b32 s22, 20
s_add_u32 s23, s23, 0x40000
s_bitset0_b32 s23, 20
s_xor_b32 s32, s18, 1024
buffer_load_dwordx4 v[16:19], v116, s[4:7], s32 offen sc1
s_add_u32 s3, s3, 0x40000
s_bitset0_b32 s3, 20
s_add_u32 s17, s17, 1
s_bitcmp1_b32 0x77777777, s17
s_cselect_b32 s33, 0x800, 0
s_xor_b32 s54, s54, s33
s_add_u32 s25, s25, 0x40000
s_bitset0_b32 s25, 20
s_nop 0
buffer_load_dwordx4 v[64:67], v116, s[4:7], s19 offen sc1
v_mov_b32 v80, 0
v_mov_b32 v81, 0
s_nop 3
s_xor_b32 s32, s19, 1024
buffer_load_dwordx4 v[68:71], v116, s[4:7], s32 offen sc1
v_mov_b32 v82, 0
v_mov_b32 v83, 0
s_nop 3
s_xor_b32 s32, s18, 2048
buffer_load_dwordx4 v[32:35], v116, s[4:7], s32 offen sc1
v_mov_b32 v84, 0
v_mov_b32 v85, 0
s_nop 3
s_xor_b32 s32, s19, 2048
buffer_load_dwordx4 v[72:75], v116, s[4:7], s32 offen sc1
v_mov_b32 v86, 0
v_mov_b32 v87, 0
s_nop 3
s_xor_b32 s32, s18, 3072
buffer_load_dwordx4 v[48:51], v116, s[4:7], s32 offen sc1
v_mov_b32 v88, 0
v_mov_b32 v89, 0
s_nop 3
s_xor_b32 s32, s19, 3072
buffer_load_dwordx4 v[76:79], v116, s[4:7], s32 offen sc1
s_memtime s[40:41]
s_memrealtime s[80:81]
s_memrealtime s[82:83]
s_memrealtime s[84:85]
s_memrealtime s[86:87]
s_memrealtime s[88:89]
s_memrealtime s[90:91]
s_memrealtime s[92:93]
s_memrealtime s[94:95]
s_memrealtime s[96:97]
s_memrealtime s[98:99]
s_memrealtime s[100:101]
s_sub_u32 s32, s15, s16
s_lshr_b32 s33, s17, 1
s_min_u32 s33, s33, 3
s_ashr_i32 s32, s32, s33
s_add_u32 s11, s11, s32
s_sub_u32 s32, s16, s27
s_sub_u32 s32, s32, s39
s_ashr_i32 s32, s32, 2
s_add_u32 s39, s39, s32
s_mov_b32 s27, s16
s_mov_b32 s2, s31
v_mov_b32 v126, s11
s_add_u32 s32, s43, 1590
v_mov_b32 v127, s32
s_waitcnt lgkmcnt(0)
ds_write_b32 v116, v126 offset:18432
s_add_u32 s80, s80, s82
s_add_u32 s80, s80, s84
s_add_u32 s80, s80, s86
s_add_u32 s80, s80, s88
s_add_u32 s80, s80, s90
s_add_u32 s80, s80, s92
s_add_u32 s80, s80, s94
s_add_u32 s80, s80, s96
s_add_u32 s80, s80, s98
s_add_u32 s80, s80, s100
s_lshl1_add_u32 s80, s80, s11
s_sub_u32 s15, s40, s80
s_add_u32 s32, s15, s39
v_mov_b32 v126, s32
buffer_store_dwordx2 v[126:127], off, s[4:7], s44 offset:128 sc1
v_mov_b32 v90, 0
v_mov_b32 v91, 0
s_waitcnt vmcnt(6)
v_pk_add_f16 v0, v0, v64
v_pk_add_f16 v1, v1, v65
v_pk_add_f16 v2, v2, v66
v_pk_add_f16 v3, v3, v67
v_cmp_u_f16 vcc, v0, v2
s_cbranch_vccnz main_kernel_c7_m0_f
main_kernel_c7_m0:
v_smfmac_f32_16x16x64_f16 v[80:83], v[0:3], a[0:7], v112
ds_write_b128 v116, v[0:3] offset:3072
v_smfmac_f32_16x16x64_f16 v[84:87], v[0:3], a[128:135], v112
buffer_load_dword v123, v121, s[4:7], 0 offen sc1
s_waitcnt vmcnt(6)
v_pk_add_f16 v16, v16, v68
v_pk_add_f16 v17, v17, v69
v_pk_add_f16 v18, v18, v70
v_pk_add_f16 v19, v19, v71
v_cmp_u_f16 vcc, v16, v18
s_waitcnt lgkmcnt(0)
s_barrier
ds_read_b128 v[4:7], v116 offset:2048
s_cbranch_vccnz main_kernel_c7_m1_f
main_kernel_c7_m1:
v_smfmac_f32_16x16x64_f16 v[80:83], v[16:19], a[8:15], v112
ds_write_b128 v116, v[16:19] offset:7168
v_smfmac_f32_16x16x64_f16 v[84:87], v[16:19], a[136:143], v112
ds_read_b128 v[8:11], v116 offset:1024
v_smfmac_f32_16x16x64_f16 v[88:91], v[0:3], v[128:135], v112
ds_read_b128 v[12:15], v116 offset:0
s_waitcnt lgkmcnt(3)
v_smfmac_f32_16x16x64_f16 v[80:83], v[4:7], a[32:39], v112
v_smfmac_f32_16x16x64_f16 v[84:87], v[4:7], a[160:167], v112
v_smfmac_f32_16x16x64_f16 v[88:91], v[4:7], v[136:143], v112
s_waitcnt lgkmcnt(2)
s_barrier
s_waitcnt lgkmcnt(1)
v_smfmac_f32_16x16x64_f16 v[80:83], v[8:11], a[64:71], v112
s_waitcnt vmcnt(4)
ds_read_b128 v[20:23], v116 offset:6144
v_pk_add_f16 v32, v32, v72
v_smfmac_f32_16x16x64_f16 v[84:87], v[8:11], a[192:199], v112
ds_read_b128 v[24:27], v116 offset:5120
s_waitcnt lgkmcnt(2)
v_pk_add_f16 v33, v33, v73
v_smfmac_f32_16x16x64_f16 v[80:83], v[12:15], a[96:103], v112
ds_read_b128 v[28:31], v116 offset:4096
v_pk_add_f16 v34, v34, v74
v_smfmac_f32_16x16x64_f16 v[84:87], v[12:15], a[224:231], v112
s_waitcnt lgkmcnt(2)
v_pk_add_f16 v35, v35, v75
v_smfmac_f32_16x16x64_f16 v[80:83], v[20:23], a[40:47], v112
v_cmp_u_f16 vcc, v32, v34
v_smfmac_f32_16x16x64_f16 v[84:87], v[20:23], a[168:175], v112
ds_write_b128 v116, v[32:35] offset:11264
s_cbranch_vccnz main_kernel_c7_m2_f
main_kernel_c7_m2:
v_smfmac_f32_16x16x64_f16 v[80:83], v[32:35], a[16:23], v112
buffer_load_dwordx4 v[96:99], v116, s[4:7], s28 offen sc1
v_smfmac_f32_16x16x64_f16 v[84:87], v[32:35], a[144:151], v112
s_add_u32 s28, s28, 0x40000
s_waitcnt lgkmcnt(2)
v_smfmac_f32_16x16x64_f16 v[80:83], v[24:27], a[72:79], v112
s_waitcnt vmcnt(3)
v_pk_add_f16 v48, v48, v76
v_smfmac_f32_16x16x64_f16 v[84:87], v[24:27], a[200:207], v112
s_waitcnt lgkmcnt(0)
s_barrier
ds_read_b128 v[36:39], v116 offset:10240
v_pk_add_f16 v49, v49, v77
v_smfmac_f32_16x16x64_f16 v[80:83], v[28:31], a[104:111], v112
ds_read_b128 v[40:43], v116 offset:9216
v_pk_add_f16 v50, v50, v78
v_smfmac_f32_16x16x64_f16 v[84:87], v[28:31], a[232:239], v112
ds_read_b128 v[44:47], v116 offset:8192
v_pk_add_f16 v51, v51, v79
v_smfmac_f32_16x16x64_f16 v[88:91], v[8:11], v[144:151], v112
s_waitcnt lgkmcnt(2)
v_cmp_u_f16 vcc, v48, v50
v_smfmac_f32_16x16x64_f16 v[80:83], v[36:39], a[48:55], v112
ds_write_b128 v116, v[48:51] offset:15360
s_cbranch_vccnz main_kernel_c7_m3_f
main_kernel_c7_m3:
v_smfmac_f32_16x16x64_f16 v[80:83], v[48:51], a[24:31], v112
v_smfmac_f32_16x16x64_f16 v[84:87], v[48:51], a[152:159], v112
v_smfmac_f32_16x16x64_f16 v[84:87], v[36:39], a[176:183], v112
s_waitcnt lgkmcnt(2)
v_smfmac_f32_16x16x64_f16 v[80:83], v[40:43], a[80:87], v112
s_waitcnt lgkmcnt(0)
s_barrier
ds_read_b128 v[52:55], v116 offset:14336
v_smfmac_f32_16x16x64_f16 v[84:87], v[40:43], a[208:215], v112
s_memtime s[40:41]
ds_read_b128 v[56:59], v116 offset:13312
v_smfmac_f32_16x16x64_f16 v[80:83], v[44:47], a[112:119], v112
s_add_u32 s19, s52, s54
ds_read_b128 v[60:63], v116 offset:12288
v_smfmac_f32_16x16x64_f16 v[84:87], v[44:47], a[240:247], v112
s_add_u32 s18, s18, 0x40000
s_waitcnt lgkmcnt(2)
v_smfmac_f32_16x16x64_f16 v[80:83], v[52:55], a[56:63], v112
s_bitset0_b32 s18, 20
s_waitcnt lgkmcnt(1)
v_smfmac_f32_16x16x64_f16 v[80:83], v[56:59], a[88:95], v112
s_cmp_eq_u32 s17, 30
s_cselect_b32 s32, s53, 0x10000
s_waitcnt lgkmcnt(0)
v_smfmac_f32_16x16x64_f16 v[80:83], v[60:63], a[120:127], v112
s_add_u32 s52, s52, s32
ds_read_b128 v[64:67], v116 offset:24576
v_smfmac_f32_16x16x64_f16 v[84:87], v[52:55], a[184:191], v112
s_sub_u32 s24, 0x20000, s32
ds_read_b128 v[68:71], v116 offset:28672
v_smfmac_f32_16x16x64_f16 v[84:87], v[56:59], a[216:223], v112
ds_read_b128 v[72:75], v116 offset:25600
s_add_u32 s55, s55, s24
v_cvt_pk_bf16_f32 v92, v80, v81
v_smfmac_f32_16x16x64_f16 v[84:87], v[60:63], a[248:255], v112
ds_read_b128 v[76:79], v116 offset:29696
s_nop 0
v_cvt_pk_bf16_f32 v93, v82, v83
v_smfmac_f32_16x16x64_f16 v[88:91], v[12:15], v[152:159], v112
s_nop 3
v_cvt_pk_bf16_f32 v94, v84, v85
v_cvt_pk_bf16_f32 v95, v86, v87
s_mov_b32 vcc_lo, 0xcccccccc
s_mov_b32 vcc_hi, 0xcccccccc
v_mfma_f32_16x16x32_bf16 v[84:87], v[92:95], v[104:107], 0
v_add_u32 v121, v121, v122
s_waitcnt lgkmcnt(0)
s_sub_u32 s31, s40, s11
v_smfmac_f32_16x16x64_f16 v[88:91], v[16:19], v[160:167], v112
s_sub_u32 s32, s31, s43
s_sub_u32 s47, 1590, s32
s_max_i32 s47, s47, 0
s_cmp_eq_u32 s17, 63
v_cvt_pk_bf16_f32 v114, v84, v85
v_cvt_pk_bf16_f32 v115, v86, v87
buffer_store_dwordx2 v[114:115], v117, s[4:7], s21 offen sc1
s_cbranch_scc1 main_kernel_c7_last
ds_write_b64 v117, v[114:115] offset:17920
v_smfmac_f32_16x16x64_f16 v[88:91], v[20:23], v[168:175], v112
s_cmp_gt_u32 s32, 1790
s_cselect_b32 s33, 900, s47
v_smfmac_f32_16x16x64_f16 v[88:91], v[24:27], v[176:183], v112
s_add_u32 s10, s33, s31
s_andn2_b32 s42, s44, 0x1f00
v_mov_b32 v126, s15
v_smfmac_f32_16x16x64_f16 v[88:91], v[28:31], v[184:191], v112
s_add_u32 s42, s42, 0x4000
v_mov_b32 v127, s10
v_smfmac_f32_16x16x64_f16 v[88:91], v[32:35], v[192:199], v112
.p2align 3
main_kernel_c7_b21:
s_sub_u32 s47, s47, 28
s_cbranch_scc0 main_kernel_c7_b21
s_waitcnt lgkmcnt(0)
s_barrier
ds_read_b128 v[0:3], v116 offset:16384
v_smfmac_f32_16x16x64_f16 v[88:91], v[36:39], v[200:207], v112
ds_read_b128 v[4:7], v116 offset:17408
buffer_store_dwordx2 v[126:127], off, s[4:7], s46 sc1
v_smfmac_f32_16x16x64_f16 v[88:91], v[40:43], v[208:215], v112
ds_read_b128 v[16:19], v116 offset:26624
s_cmp_gt_u32 s32, 1790
s_cselect_b32 s80, s44, 0x7f000000
v_smfmac_f32_16x16x64_f16 v[88:91], v[44:47], v[216:223], v112
ds_read_b128 v[20:23], v116 offset:30720
v_writelane_b32 v121, s55, 39
v_smfmac_f32_16x16x64_f16 v[88:91], v[48:51], v[224:231], v112
ds_read_b128 v[24:27], v116 offset:27648
v_smfmac_f32_16x16x64_f16 v[88:91], v[52:55], v[232:239], v112
ds_read_b128 v[28:31], v116 offset:31744
v_smfmac_f32_16x16x64_f16 v[88:91], v[56:59], v[240:247], v112
v_smfmac_f32_16x16x64_f16 v[88:91], v[60:63], v[248:255], v112
s_waitcnt lgkmcnt(5)
v_mfma_f32_16x16x32_bf16 v[80:83], v[64:67], v[0:3], 0
v_mfma_f32_16x16x32_bf16 v[84:87], v[68:71], v[0:3], 0
buffer_load_dwordx4 v[8:11], v116, s[4:7], s20 offen offset:0 sc1
v_mfma_f32_16x16x32_bf16 v[92:95], v[0:3], v[0:3], 0
buffer_load_dwordx4 v[12:15], v116, s[4:7], s20 offen offset:1024 sc1
v_permlane32_swap_b32 v88, v90
s_waitcnt lgkmcnt(4)
v_mfma_f32_16x16x32_bf16 v[80:83], v[72:75], v[4:7], v[80:83]
v_permlane32_swap_b32 v89, v91
v_mfma_f32_16x16x32_bf16 v[84:87], v[76:79], v[4:7], v[84:87]
v_pk_add_f32 v[88:89], v[88:89], v[90:91]
v_mfma_f32_16x16x32_bf16 v[92:95], v[4:7], v[4:7], v[92:95]
v_cvt_pk_bf16_f32 v124, v88, v89
s_andn2_b32 s35, s46, 0xff
v_bfe_u32 v68, v116, 1, 8
v_mov_b32 v65, 0
buffer_load_dwordx2 v[66:67], v68, s[4:7], s35 offen sc1
buffer_store_dword v127, off, s[4:7], s80 offset:132 sc1
s_waitcnt lgkmcnt(0)
s_waitcnt vmcnt(3)
v_mfma_f32_16x16x32_bf16 v[88:91], v[8:11], v[8:11], v[92:95]
v_mfma_f32_16x16x32_bf16 v[0:3], v[16:19], v[8:11], v[80:83]
v_cmp_u_f32 s[0:1], v8, v10
v_mfma_f32_16x16x32_bf16 v[4:7], v[20:23], v[8:11], v[84:87]
s_waitcnt vmcnt(2)
v_mfma_f32_16x16x32_bf16 v[88:91], v[12:15], v[12:15], v[88:91]
v_mfma_f32_16x16x32_bf16 v[0:3], v[24:27], v[12:15], v[0:3]
v_cmp_u_f32 s[32:33], v12, v14
v_mfma_f32_16x16x32_bf16 v[4:7], v[28:31], v[12:15], v[4:7]
s_or_b64 s[0:1], s[0:1], s[32:33]
s_cbranch_scc1 main_kernel_c7_z_f
main_kernel_c7_z:
v_mul_f32 v88, s30, v88
v_mul_f32 v89, s30, v89
v_exp_f32 v88, v88
v_exp_f32 v89, v89
v_cndmask_b32_dpp v0, v2, v0, vcc quad_perm:[2,3,2,3] row_mask:0xf bank_mask:0xf
v_cvt_pk_bf16_f32 v64, v88, v89
v_cndmask_b32_dpp v1, v3, v1, vcc quad_perm:[2,3,2,3] row_mask:0xf bank_mask:0xf
v_exp_f32 v0, v0
v_mfma_f32_16x16x16_bf16 v[16:19], v[100:101], v[64:65], 0
v_exp_f32 v1, v1
v_cndmask_b32_dpp v4, v6, v4, vcc quad_perm:[2,3,2,3] row_mask:0xf bank_mask:0xf
v_mfma_f32_16x16x16_bf16 v[8:11], v[124:125], v[64:65], 0
v_cndmask_b32_dpp v5, v7, v5, vcc quad_perm:[2,3,2,3] row_mask:0xf bank_mask:0xf
v_exp_f32 v4, v4
v_exp_f32 v5, v5
v_cvt_pk_bf16_f32 v92, v0, v1
v_cvt_pk_bf16_f32 v94, v4, v5
v_mov_b32 v80, 0
v_mov_b32_dpp v93, v92 quad_perm:[0,1,0,1] row_mask:0xf bank_mask:0xf
v_mov_b32_dpp v95, v94 quad_perm:[0,1,0,1] row_mask:0xf bank_mask:0xf
v_mov_b32 v81, 0
v_mov_b32 v82, 0
v_mfma_f32_16x16x32_bf16 v[16:19], v[100:103], v[92:95], v[16:19]
v_mov_b32 v83, 0
v_mov_b32 v84, 0
v_mfma_f32_16x16x32_bf16 v[8:11], v[96:99], v[92:95], v[8:11]
s_buffer_load_dword s42, s[4:7], s42
s_nop 1
v_mov_b32 v85, 0
v_mov_b32 v86, 0
v_mov_b32 v87, 0
v_rcp_f32 v126, v16
v_subrev_u32 v127, 0x21800000, v16
v_cmp_lt_u32 vcc, 0x3c000000, v127
v_pk_mul_f32 v[8:9], v[8:9], v[126:127] op_sel_hi:[1,0]
v_pk_mul_f32 v[10:11], v[10:11], v[126:127] op_sel_hi:[1,0]
s_and_b32 s32, vcc_lo, 0xcccc
v_cvt_pk_bf16_f32 v126, v8, v9
v_cvt_pk_bf16_f32 v127, v10, v11
s_cbranch_scc1 main_kernel_c7_sm_f
main_kernel_c7_ost:
buffer_store_dwordx2 v[126:127], v118, s[4:7], s22 offen sc1
s_waitcnt vmcnt(2)
main_kernel_c7_to0:
s_memtime s[40:41]
v_readlane_b32 s16, v66, 0
v_subrev_u32 v67, s2, v67
s_add_u32 s34, s11, s2
s_nop 0
v_max_u32_dpp v67, v67, v67 row_ror:8 row_mask:0xf bank_mask:0xf
s_nop 1
v_max_u32_dpp v67, v67, v67 row_ror:4 row_mask:0xf bank_mask:0xf
s_nop 1
v_max_u32_dpp v67, v67, v67 row_ror:2 row_mask:0xf bank_mask:0xf
s_nop 1
v_max_u32_dpp v67, v67, v67 row_ror:1 row_mask:0xf bank_mask:0xf
s_waitcnt lgkmcnt(0)
v_readlane_b32 s32, v67, 0
v_readlane_b32 s33, v67, 16
s_sub_u32 s34, s40, s34
s_max_u32 s32, s32, s33
s_add_u32 s35, s34, 1536
s_cmp_gt_u32 s32, s35
s_cbranch_scc1 main_kernel_c7_to2
main_kernel_c7_to3:
s_sub_u32 s33, s42, s2
s_cmp_le_u32 s33, s35
s_cselect_b32 s33, s33, 0
s_max_u32 s32, s32, s33
s_add_u32 s36, s32, 2750
s_add_u32 s32, s32, 1270
s_sub_u32 s47, s32, s34
s_max_i32 s47, s47, 0
.p2align 3
main_kernel_c7_to1:
s_sub_u32 s47, s47, 28
s_cbranch_scc0 main_kernel_c7_to1
s_barrier
buffer_load_dwordx4 v[0:3], v116, s[4:7], s23 offen sc1
ds_read_b128 v[32:35], v113 offset:0
ds_read_b128 v[36:39], v113 offset:1024
s_add_u32 s46, s46, 0x40000
s_bitset0_b32 s46, 20
s_add_u32 s37, s37, 65536
s_add_u32 s26, s26, 65536
s_xor_b32 s32, s23, 1024
buffer_load_dwordx4 v[4:7], v116, s[4:7], s32 offen sc1
ds_read_b128 v[40:43], v113 offset:2048
ds_read_b128 v[44:47], v113 offset:3072
s_add_u32 s44, s44, s24
s_nop 2
s_xor_b32 s32, s23, 2048
buffer_load_dwordx4 v[8:11], v116, s[4:7], s32 offen sc1
ds_read_b128 v[48:51], v113 offset:4096
ds_read_b128 v[52:55], v113 offset:5120
s_nop 3
s_xor_b32 s32, s23, 3072
buffer_load_dwordx4 v[12:15], v116, s[4:7], s32 offen sc1
ds_read_b128 v[56:59], v113 offset:6144
ds_read_b128 v[60:63], v113 offset:7168
s_nop 3
s_xor_b32 s32, s23, 4096
buffer_load_dwordx4 v[16:19], v116, s[4:7], s32 offen sc1
ds_read_b128 v[64:67], v113 offset:8192
ds_read_b128 v[68:71], v113 offset:9216
s_nop 3
s_xor_b32 s32, s23, 5120
buffer_load_dwordx4 v[20:23], v116, s[4:7], s32 offen sc1
ds_read_b128 v[72:75], v113 offset:10240
ds_read_b128 v[76:79], v113 offset:11264
s_nop 3
s_xor_b32 s32, s23, 6144
buffer_load_dwordx4 v[24:27], v116, s[4:7], s32 offen sc1
ds_read_b128 v[88:91], v113 offset:12288
ds_read_b128 v[92:95], v113 offset:13312
s_nop 3
s_xor_b32 s32, s23, 7168
buffer_load_dwordx4 v[28:31], v116, s[4:7], s32 offen sc1
v_and_b32 v127, 0x1f0, v116
v_lshlrev_b32 v127, 4, v127
s_waitcnt lgkmcnt(12)
s_waitcnt vmcnt(7)
v_cmp_u_f32 vcc, v0, v2
s_cbranch_vccnz main_kernel_c7_o0_f
main_kernel_c7_o0:
v_smfmac_f32_16x16x64_bf16 v[80:83], v[0:3], v[32:39], v112
ds_read_b128 v[32:35], v113 offset:14336
ds_read_b128 v[36:39], v113 offset:15360
buffer_load_dwordx2 v[96:97], v127, s[4:7], s45 offen offset:128 sc1
s_waitcnt lgkmcnt(12)
s_waitcnt vmcnt(7)
v_cmp_u_f32 vcc, v4, v6
v_smfmac_f32_16x16x64_bf16 v[84:87], v[0:3], v[40:47], v112
ds_read_b128 v[40:43], v113 offset:16384
ds_read_b128 v[44:47], v113 offset:17408
buffer_store_dwordx2 v[114:115], v119, s[4:7], s37 offen sc1
s_cbranch_vccnz main_kernel_c7_o1_f
main_kernel_c7_o1:
s_waitcnt lgkmcnt(12)
v_smfmac_f32_16x16x64_bf16 v[80:83], v[4:7], v[48:55], v112
ds_read_b128 v[48:51], v113 offset:18432
ds_read_b128 v[52:55], v113 offset:19456
s_waitcnt lgkmcnt(12)
s_waitcnt vmcnt(7)
v_cmp_u_f32 vcc, v8, v10
v_smfmac_f32_16x16x64_bf16 v[84:87], v[4:7], v[56:63], v112
ds_read_b128 v[56:59], v113 offset:20480
ds_read_b128 v[60:63], v113 offset:21504
buffer_store_dword v124, v120, s[4:7], s26 offen sc1
s_cbranch_vccnz main_kernel_c7_o2_f
main_kernel_c7_o2:
s_waitcnt lgkmcnt(12)
v_smfmac_f32_16x16x64_bf16 v[80:83], v[8:11], v[64:71], v112
ds_read_b128 v[64:67], v113 offset:22528
ds_read_b128 v[68:71], v113 offset:23552
s_waitcnt lgkmcnt(12)
s_waitcnt vmcnt(7)
v_cmp_u_f32 vcc, v12, v14
v_smfmac_f32_16x16x64_bf16 v[84:87], v[8:11], v[72:79], v112
ds_read_b128 v[72:75], v113 offset:24576
ds_read_b128 v[76:79], v113 offset:25600
s_cbranch_vccnz main_kernel_c7_o3_f
main_kernel_c7_o3:
s_waitcnt lgkmcnt(12)
v_smfmac_f32_16x16x64_bf16 v[80:83], v[12:15], v[88:95], v112
ds_read_b128 v[88:91], v113 offset:26624
ds_read_b128 v[92:95], v113 offset:27648
s_waitcnt lgkmcnt(12)
s_waitcnt vmcnt(6)
v_cmp_u_f32 vcc, v16, v18
v_smfmac_f32_16x16x64_bf16 v[84:87], v[12:15], v[32:39], v112
ds_read_b128 v[32:35], v113 offset:28672
ds_read_b128 v[36:39], v113 offset:29696
s_cbranch_vccnz main_kernel_c7_o4_f
main_kernel_c7_o4:
s_waitcnt lgkmcnt(12)
v_smfmac_f32_16x16x64_bf16 v[80:83], v[16:19], v[40:47], v112
ds_read_b128 v[40:43], v113 offset:30720
ds_read_b128 v[44:47], v113 offset:31744
s_waitcnt lgkmcnt(12)
s_waitcnt vmcnt(5)
v_cmp_u_f32 vcc, v20, v22
v_smfmac_f32_16x16x64_bf16 v[84:87], v[16:19], v[48:55], v112
s_cbranch_vccnz main_kernel_c7_o5_f
main_kernel_c7_o5:
s_waitcnt lgkmcnt(10)
v_smfmac_f32_16x16x64_bf16 v[80:83], v[20:23], v[56:63], v112
s_waitcnt lgkmcnt(8)
s_waitcnt vmcnt(4)
v_cmp_u_f32 vcc, v24, v26
v_smfmac_f32_16x16x64_bf16 v[84:87], v[20:23], v[64:71], v112
s_cbranch_vccnz main_kernel_c7_o6_f
main_kernel_c7_o6:
s_waitcnt lgkmcnt(6)
v_smfmac_f32_16x16x64_bf16 v[80:83], v[24:27], v[72:79], v112
s_waitcnt lgkmcnt(4)
v_smfmac_f32_16x16x64_bf16 v[84:87], v[24:27], v[88:95], v112
s_waitcnt lgkmcnt(2)
s_waitcnt vmcnt(3)
v_cmp_u_f32 vcc, v28, v30
s_cbranch_vccnz main_kernel_c7_o7_f
main_kernel_c7_o7:
v_smfmac_f32_16x16x64_bf16 v[80:83], v[28:31], v[32:39], v112
s_waitcnt lgkmcnt(0)
v_smfmac_f32_16x16x64_bf16 v[84:87], v[28:31], v[40:47], v112
s_nop 4
v_cvt_pk_bf16_f32 v80, v80, v81
v_cvt_pk_bf16_f32 v81, v82, v83
ds_write_b64 v116, v[80:81] offset:21512
v_cvt_pk_bf16_f32 v82, v84, v85
v_cvt_pk_bf16_f32 v83, v86, v87
ds_write_b64 v116, v[82:83] offset:23560
s_waitcnt lgkmcnt(0)
s_barrier
ds_read_b128 v[72:75], v116 offset:22528
ds_read_b128 v[76:79], v116 offset:23552
s_waitcnt lgkmcnt(1)
v_mfma_f32_16x16x32_bf16 v[64:67], v[72:75], v[108:111], 0
s_waitcnt lgkmcnt(0)
v_mfma_f32_16x16x32_bf16 v[64:67], v[76:79], v[108:111], v[64:67]
s_nop 7
v_cvt_pk_f16_f32 v68, v64, v65
v_cvt_pk_f16_f32 v69, v66, v67
buffer_store_dwordx2 v[68:69], v125, s[4:7], s25 offen sc1
s_sub_u32 s0, s2, s16
s_sub_u32 s0, s0, s39
s_waitcnt vmcnt(3)
main_kernel_c7_tm0:
s_memtime s[40:41]
v_sub_u32 v97, v97, v96
v_subrev_u32 v97, s0, v97
s_add_u32 s34, s11, s2
s_nop 0
v_max_u32_dpp v97, v97, v97 row_ror:8 row_mask:0xf bank_mask:0xf
s_nop 1
v_max_u32_dpp v97, v97, v97 row_ror:4 row_mask:0xf bank_mask:0xf
s_nop 1
v_max_u32_dpp v97, v97, v97 row_ror:2 row_mask:0xf bank_mask:0xf
s_nop 1
v_max_u32_dpp v97, v97, v97 row_ror:1 row_mask:0xf bank_mask:0xf
s_waitcnt lgkmcnt(0)
v_readlane_b32 s32, v97, 0
v_readlane_b32 s33, v97, 16
s_sub_u32 s34, s40, s34
s_max_u32 s32, s32, s33
s_add_u32 s35, s34, 1536
s_cmp_gt_u32 s32, s35
s_cbranch_scc1 main_kernel_c7_tm2
main_kernel_c7_tm3:
s_add_u32 s32, s32, 2750
s_max_u32 s32, s32, s36
s_add_u32 s43, s32, s2
s_sub_u32 s47, s32, s34
s_max_i32 s47, s47, 0
.p2align 3
main_kernel_c7_tm1:
s_sub_u32 s47, s47, 28
s_cbranch_scc0 main_kernel_c7_tm1
s_add_u32 s45, s45, s24
s_branch main_kernel_c7_top
main_kernel_c7_to2:
s_mov_b32 s32, s34
s_mov_b32 s16, s15
s_cmp_gt_u32 s34, 0x40000
s_cbranch_scc1 main_kernel_c7_to3
s_andn2_b32 s35, s46, 0xff
v_bfe_u32 v68, v116, 1, 8
buffer_load_dwordx2 v[66:67], v68, s[4:7], s35 offen sc1
s_sub_u32 s29, s29, 1
s_cbranch_scc1 main_kernel_end
s_cmp_lg_u32 s17, 0
s_cbranch_scc1 main_kernel_c7_to7
s_memtime s[40:41]
s_memrealtime s[80:81]
s_memrealtime s[82:83]
s_memrealtime s[84:85]
s_memrealtime s[86:87]
s_memrealtime s[88:89]
s_memrealtime s[90:91]
s_memrealtime s[92:93]
s_memrealtime s[94:95]
s_memrealtime s[96:97]
s_memrealtime s[98:99]
s_memrealtime s[100:101]
s_waitcnt lgkmcnt(0)
s_add_u32 s80, s80, s82
s_add_u32 s80, s80, s84
s_add_u32 s80, s80, s86
s_add_u32 s80, s80, s88
s_add_u32 s80, s80, s90
s_add_u32 s80, s80, s92
s_add_u32 s80, s80, s94
s_add_u32 s80, s80, s96
s_add_u32 s80, s80, s98
s_add_u32 s80, s80, s100
s_lshl1_add_u32 s80, s80, s15
s_sub_u32 s11, s40, s80
main_kernel_c7_to7:
s_waitcnt vmcnt(0)
s_branch main_kernel_c7_to0
main_kernel_c7_tm2:
s_mov_b32 s32, s34
s_cmp_gt_u32 s34, 0x40000
s_cbranch_scc1 main_kernel_c7_tm3
v_and_b32 v127, 0x1f0, v116
v_lshlrev_b32 v127, 4, v127
buffer_load_dwordx2 v[96:97], v127, s[4:7], s45 offen offset:128 sc1
s_sub_u32 s29, s29, 1
s_cbranch_scc1 main_kernel_end
s_cmp_lg_u32 s17, 0
s_cbranch_scc1 main_kernel_c7_tm7
s_memtime s[40:41]
s_memrealtime s[80:81]
s_memrealtime s[82:83]
s_memrealtime s[84:85]
s_memrealtime s[86:87]
s_memrealtime s[88:89]
s_memrealtime s[90:91]
s_memrealtime s[92:93]
s_memrealtime s[94:95]
s_memrealtime s[96:97]
s_memrealtime s[98:99]
s_memrealtime s[100:101]
s_waitcnt lgkmcnt(0)
s_add_u32 s80, s80, s82
s_add_u32 s80, s80, s84
s_add_u32 s80, s80, s86
s_add_u32 s80, s80, s88
s_add_u32 s80, s80, s90
s_add_u32 s80, s80, s92
s_add_u32 s80, s80, s94
s_add_u32 s80, s80, s96
s_add_u32 s80, s80, s98
s_add_u32 s80, s80, s100
s_lshl1_add_u32 s80, s80, s15
s_sub_u32 s11, s40, s80
main_kernel_c7_tm7:
s_waitcnt vmcnt(0)
s_branch main_kernel_c7_tm0
main_kernel_c7_last:
s_add_u32 s37, s37, 65536
s_add_u32 s26, s26, 65536
buffer_store_dwordx2 v[114:115], v119, s[4:7], s37 offen sc1
v_smfmac_f32_16x16x64_f16 v[88:91], v[20:23], v[168:175], v112
v_smfmac_f32_16x16x64_f16 v[88:91], v[24:27], v[176:183], v112
v_smfmac_f32_16x16x64_f16 v[88:91], v[28:31], v[184:191], v112
v_smfmac_f32_16x16x64_f16 v[88:91], v[32:35], v[192:199], v112
v_smfmac_f32_16x16x64_f16 v[88:91], v[36:39], v[200:207], v112
v_smfmac_f32_16x16x64_f16 v[88:91], v[40:43], v[208:215], v112
v_smfmac_f32_16x16x64_f16 v[88:91], v[44:47], v[216:223], v112
v_smfmac_f32_16x16x64_f16 v[88:91], v[48:51], v[224:231], v112
v_smfmac_f32_16x16x64_f16 v[88:91], v[52:55], v[232:239], v112
v_smfmac_f32_16x16x64_f16 v[88:91], v[56:59], v[240:247], v112
v_smfmac_f32_16x16x64_f16 v[88:91], v[60:63], v[248:255], v112
s_nop 7
v_permlane32_swap_b32 v88, v90
s_nop 1
v_permlane32_swap_b32 v89, v91
s_nop 1
v_pk_add_f32 v[88:89], v[88:89], v[90:91]
s_nop 1
v_cvt_pk_bf16_f32 v124, v88, v89
s_nop 1
buffer_store_dword v124, v120, s[4:7], s26 offen sc1
s_branch main_kernel_end
main_kernel_c7_m0_f:
s_waitcnt lgkmcnt(0)
buffer_load_dwordx4 v[0:3], v116, s[4:7], s18 offen sc1
buffer_load_dwordx4 v[64:67], v116, s[4:7], s19 offen sc1
s_xor_b32 s32, s18, 1024
buffer_load_dwordx4 v[16:19], v116, s[4:7], s32 offen sc1
s_xor_b32 s32, s19, 1024
buffer_load_dwordx4 v[68:71], v116, s[4:7], s32 offen sc1
s_xor_b32 s32, s18, 2048
buffer_load_dwordx4 v[32:35], v116, s[4:7], s32 offen sc1
s_xor_b32 s32, s19, 2048
buffer_load_dwordx4 v[72:75], v116, s[4:7], s32 offen sc1
s_xor_b32 s32, s18, 3072
buffer_load_dwordx4 v[48:51], v116, s[4:7], s32 offen sc1
s_xor_b32 s32, s19, 3072
buffer_load_dwordx4 v[76:79], v116, s[4:7], s32 offen sc1
s_sub_u32 s29, s29, 1
s_cbranch_scc1 main_kernel_end
s_waitcnt vmcnt(0)
v_max_u32 v126, v0, v2
v_max3_u32 v126, v126, v64, v66
v_cmp_eq_u32 vcc, -1, v126
s_cbranch_vccnz main_kernel_c7_m0_f
v_pk_add_f16 v0, v0, v64
v_pk_add_f16 v1, v1, v65
v_pk_add_f16 v2, v2, v66
v_pk_add_f16 v3, v3, v67
s_nop 0
s_branch main_kernel_c7_m0
main_kernel_c7_m1_f:
s_waitcnt lgkmcnt(0)
s_xor_b32 s32, s18, 1024
buffer_load_dwordx4 v[16:19], v116, s[4:7], s32 offen sc1
s_xor_b32 s32, s19, 1024
buffer_load_dwordx4 v[68:71], v116, s[4:7], s32 offen sc1
s_xor_b32 s32, s18, 2048
buffer_load_dwordx4 v[32:35], v116, s[4:7], s32 offen sc1
s_xor_b32 s32, s19, 2048
buffer_load_dwordx4 v[72:75], v116, s[4:7], s32 offen sc1
s_xor_b32 s32, s18, 3072
buffer_load_dwordx4 v[48:51], v116, s[4:7], s32 offen sc1
s_xor_b32 s32, s19, 3072
buffer_load_dwordx4 v[76:79], v116, s[4:7], s32 offen sc1
s_sub_u32 s29, s29, 1
s_cbranch_scc1 main_kernel_end
s_waitcnt vmcnt(0)
v_max_u32 v126, v16, v18
v_max3_u32 v126, v126, v68, v70
v_cmp_eq_u32 vcc, -1, v126
s_cbranch_vccnz main_kernel_c7_m1_f
v_pk_add_f16 v16, v16, v68
v_pk_add_f16 v17, v17, v69
v_pk_add_f16 v18, v18, v70
v_pk_add_f16 v19, v19, v71
s_nop 0
s_branch main_kernel_c7_m1
main_kernel_c7_m2_f:
s_waitcnt lgkmcnt(0)
s_xor_b32 s32, s18, 2048
buffer_load_dwordx4 v[32:35], v116, s[4:7], s32 offen sc1
s_xor_b32 s32, s19, 2048
buffer_load_dwordx4 v[72:75], v116, s[4:7], s32 offen sc1
s_xor_b32 s32, s18, 3072
buffer_load_dwordx4 v[48:51], v116, s[4:7], s32 offen sc1
s_xor_b32 s32, s19, 3072
buffer_load_dwordx4 v[76:79], v116, s[4:7], s32 offen sc1
s_sub_u32 s29, s29, 1
s_cbranch_scc1 main_kernel_end
s_waitcnt vmcnt(0)
v_max_u32 v126, v32, v34
v_max3_u32 v126, v126, v72, v74
v_cmp_eq_u32 vcc, -1, v126
s_cbranch_vccnz main_kernel_c7_m2_f
v_pk_add_f16 v32, v32, v72
v_pk_add_f16 v33, v33, v73
v_pk_add_f16 v34, v34, v74
v_pk_add_f16 v35, v35, v75
ds_write_b128 v116, v[32:35] offset:11264
s_branch main_kernel_c7_m2
main_kernel_c7_m3_f:
s_waitcnt lgkmcnt(0)
s_xor_b32 s32, s18, 3072
buffer_load_dwordx4 v[48:51], v116, s[4:7], s32 offen sc1
s_xor_b32 s32, s19, 3072
buffer_load_dwordx4 v[76:79], v116, s[4:7], s32 offen sc1
s_sub_u32 s29, s29, 1
s_cbranch_scc1 main_kernel_end
s_waitcnt vmcnt(0)
v_max_u32 v126, v48, v50
v_max3_u32 v126, v126, v76, v78
v_cmp_eq_u32 vcc, -1, v126
s_cbranch_vccnz main_kernel_c7_m3_f
v_pk_add_f16 v48, v48, v76
v_pk_add_f16 v49, v49, v77
v_pk_add_f16 v50, v50, v78
v_pk_add_f16 v51, v51, v79
ds_write_b128 v116, v[48:51] offset:15360
s_branch main_kernel_c7_m3
main_kernel_c7_z_f:
buffer_load_dwordx4 v[8:11], v116, s[4:7], s20 offen offset:0 sc1
buffer_load_dwordx4 v[12:15], v116, s[4:7], s20 offen offset:1024 sc1
s_memtime s[32:33]
ds_read_b32 v126, v116 offset:18432
s_sub_u32 s34, s19, s54
s_xor_b32 s34, s34, 0x2000
s_lshl_b32 s35, s12, 15
s_add_u32 s34, s34, s35
s_lshl_b32 s35, s13, 8
s_add_u32 s35, s35, s34
s_add_u32 s34, s34, 0x4000
s_waitcnt lgkmcnt(0)
s_sub_u32 s32, s32, 450
v_sub_u32 v126, s32, v126
v_max_u32 v127, v126, v127
buffer_store_dword v127, off, s[4:7], s34 sc1
s_sub_u32 s29, s29, 1
s_cbranch_scc1 main_kernel_end
s_waitcnt vmcnt(1)
main_kernel_c7_z_g:
v_max_u32 v126, v8, v10
v_max3_u32 v126, v126, v12, v14
v_cmp_eq_u32 vcc, -1, v126
s_cbranch_vccnz main_kernel_c7_z_h
v_mfma_f32_16x16x32_bf16 v[88:91], v[8:11], v[8:11], v[92:95]
v_mfma_f32_16x16x32_bf16 v[0:3], v[16:19], v[8:11], v[80:83]
v_mfma_f32_16x16x32_bf16 v[4:7], v[20:23], v[8:11], v[84:87]
v_mfma_f32_16x16x32_bf16 v[88:91], v[12:15], v[12:15], v[88:91]
v_mfma_f32_16x16x32_bf16 v[0:3], v[24:27], v[12:15], v[0:3]
v_mfma_f32_16x16x32_bf16 v[4:7], v[28:31], v[12:15], v[4:7]
buffer_store_dword v127, off, s[4:7], s35 offset:132 sc1
s_mov_b32 vcc_lo, 0xcccccccc
s_mov_b32 vcc_hi, 0xcccccccc
s_branch main_kernel_c7_z
main_kernel_c7_z_h:
buffer_load_dwordx4 v[8:11], v116, s[4:7], s20 offen offset:0 sc1
buffer_load_dwordx4 v[12:15], v116, s[4:7], s20 offen offset:1024 sc1
s_sub_u32 s29, s29, 1
s_cbranch_scc1 main_kernel_end
v_add_u32 v127, 300, v127
s_waitcnt vmcnt(0)
s_branch main_kernel_c7_z_g
main_kernel_c7_sm_f:
s_waitcnt vmcnt(0) lgkmcnt(0)
buffer_load_dwordx4 v[8:11], v116, s[4:7], s20 offen offset:0 sc1
buffer_load_dwordx4 v[12:15], v116, s[4:7], s20 offen offset:1024 sc1
ds_read_b128 v[0:3], v116 offset:16384
ds_read_b128 v[4:7], v116 offset:17408
ds_read_b128 v[64:67], v116 offset:24576
ds_read_b128 v[68:71], v116 offset:28672
ds_read_b128 v[72:75], v116 offset:25600
ds_read_b128 v[76:79], v116 offset:29696
ds_read_b128 v[16:19], v116 offset:26624
ds_read_b128 v[20:23], v116 offset:30720
ds_read_b128 v[24:27], v116 offset:27648
ds_read_b128 v[28:31], v116 offset:31744
s_waitcnt vmcnt(0)
s_waitcnt lgkmcnt(0)
v_mfma_f32_16x16x32_bf16 v[80:83], v[64:67], v[0:3], 0
v_mfma_f32_16x16x32_bf16 v[84:87], v[68:71], v[0:3], 0
v_mfma_f32_16x16x32_bf16 v[92:95], v[0:3], v[0:3], 0
v_mfma_f32_16x16x32_bf16 v[80:83], v[72:75], v[4:7], v[80:83]
v_mfma_f32_16x16x32_bf16 v[84:87], v[76:79], v[4:7], v[84:87]
v_mfma_f32_16x16x32_bf16 v[92:95], v[4:7], v[4:7], v[92:95]
v_mfma_f32_16x16x32_bf16 v[0:3], v[16:19], v[8:11], v[80:83]
v_mfma_f32_16x16x32_bf16 v[4:7], v[20:23], v[8:11], v[84:87]
v_mfma_f32_16x16x32_bf16 v[88:91], v[8:11], v[8:11], v[92:95]
v_mfma_f32_16x16x32_bf16 v[0:3], v[24:27], v[12:15], v[0:3]
v_mfma_f32_16x16x32_bf16 v[4:7], v[28:31], v[12:15], v[4:7]
v_mfma_f32_16x16x32_bf16 v[88:91], v[12:15], v[12:15], v[88:91]
s_nop 7
v_mov_b32 v65, 0
v_max_f32 v126, v88, v89
v_mul_f32 v126, s30, v126
v_max3_f32 v126, v126, v0, v1
v_max3_f32 v126, v126, v2, v3
v_max3_f32 v126, v126, v4, v5
v_max3_f32 v126, v126, v6, v7
v_mov_b32 v127, v126
s_nop 1
v_permlane32_swap_b32 v126, v127
v_max_f32 v126, v126, v127
v_mov_b32 v127, v126
s_nop 1
v_permlane16_swap_b32 v126, v127
v_max_f32 v126, v126, v127
v_mul_f32 v127, 0x40faf233, v126
s_mov_b32 vcc_lo, 0xcccccccc
s_mov_b32 vcc_hi, 0xcccccccc
v_sub_f32 v0, v0, v126
v_sub_f32 v1, v1, v126
v_sub_f32 v2, v2, v126
v_sub_f32 v3, v3, v126
v_sub_f32 v4, v4, v126
v_sub_f32 v5, v5, v126
v_sub_f32 v6, v6, v126
v_sub_f32 v7, v7, v126
v_sub_f32 v88, v88, v127
v_sub_f32 v89, v89, v127
s_waitcnt lgkmcnt(0)
s_nop 0
v_mul_f32 v88, s30, v88
v_mul_f32 v89, s30, v89
v_exp_f32 v88, v88
v_exp_f32 v89, v89
v_cndmask_b32_dpp v0, v2, v0, vcc quad_perm:[2,3,2,3] row_mask:0xf bank_mask:0xf
v_cvt_pk_bf16_f32 v64, v88, v89
v_cndmask_b32_dpp v1, v3, v1, vcc quad_perm:[2,3,2,3] row_mask:0xf bank_mask:0xf
v_exp_f32 v0, v0
v_mfma_f32_16x16x16_bf16 v[16:19], v[100:101], v[64:65], 0
v_exp_f32 v1, v1
v_cndmask_b32_dpp v4, v6, v4, vcc quad_perm:[2,3,2,3] row_mask:0xf bank_mask:0xf
v_mfma_f32_16x16x16_bf16 v[8:11], v[124:125], v[64:65], 0
v_cndmask_b32_dpp v5, v7, v5, vcc quad_perm:[2,3,2,3] row_mask:0xf bank_mask:0xf
v_exp_f32 v4, v4
v_exp_f32 v5, v5
v_cvt_pk_bf16_f32 v92, v0, v1
v_cvt_pk_bf16_f32 v94, v4, v5
v_mov_b32 v80, 0
v_mov_b32_dpp v93, v92 quad_perm:[0,1,0,1] row_mask:0xf bank_mask:0xf
v_mov_b32_dpp v95, v94 quad_perm:[0,1,0,1] row_mask:0xf bank_mask:0xf
v_mov_b32 v81, 0
v_mov_b32 v82, 0
v_mfma_f32_16x16x32_bf16 v[16:19], v[100:103], v[92:95], v[16:19]
v_mov_b32 v83, 0
v_mov_b32 v84, 0
v_mfma_f32_16x16x32_bf16 v[8:11], v[96:99], v[92:95], v[8:11]
s_nop 1
v_mov_b32 v85, 0
v_mov_b32 v86, 0
v_mov_b32 v87, 0
v_rcp_f32 v126, v16
v_subrev_u32 v127, 0x21800000, v16
v_cmp_lt_u32 vcc, 0x3c000000, v127
v_pk_mul_f32 v[8:9], v[8:9], v[126:127] op_sel_hi:[1,0]
v_pk_mul_f32 v[10:11], v[10:11], v[126:127] op_sel_hi:[1,0]
s_and_b32 s32, vcc_lo, 0xcccc
v_cvt_pk_bf16_f32 v126, v8, v9
v_cvt_pk_bf16_f32 v127, v10, v11
s_andn2_b32 s35, s46, 0xff
v_bfe_u32 v68, v116, 1, 8
buffer_load_dwordx2 v[66:67], v68, s[4:7], s35 offen sc1
s_waitcnt vmcnt(0)
s_branch main_kernel_c7_ost
main_kernel_c7_o0_f:
s_nop 0
buffer_load_dwordx4 v[0:3], v116, s[4:7], s23 offen sc1
s_xor_b32 s32, s23, 1024
buffer_load_dwordx4 v[4:7], v116, s[4:7], s32 offen sc1
s_sub_u32 s29, s29, 1
s_cbranch_scc1 main_kernel_end
s_waitcnt vmcnt(0)
v_max_u32 v126, v0, v2
v_cmp_eq_u32 vcc, -1, v126
s_cbranch_vccnz main_kernel_c7_o0_f
s_branch main_kernel_c7_o0
main_kernel_c7_o1_f:
s_nop 0
s_xor_b32 s32, s23, 1024
buffer_load_dwordx4 v[4:7], v116, s[4:7], s32 offen sc1
s_xor_b32 s32, s23, 2048
buffer_load_dwordx4 v[8:11], v116, s[4:7], s32 offen sc1
s_sub_u32 s29, s29, 1
s_cbranch_scc1 main_kernel_end
s_waitcnt vmcnt(0)
v_max_u32 v126, v4, v6
v_cmp_eq_u32 vcc, -1, v126
s_cbranch_vccnz main_kernel_c7_o1_f
s_branch main_kernel_c7_o1
main_kernel_c7_o2_f:
s_nop 0
s_xor_b32 s32, s23, 2048
buffer_load_dwordx4 v[8:11], v116, s[4:7], s32 offen sc1
s_xor_b32 s32, s23, 3072
buffer_load_dwordx4 v[12:15], v116, s[4:7], s32 offen sc1
s_sub_u32 s29, s29, 1
s_cbranch_scc1 main_kernel_end
s_waitcnt vmcnt(0)
v_max_u32 v126, v8, v10
v_cmp_eq_u32 vcc, -1, v126
s_cbranch_vccnz main_kernel_c7_o2_f
s_branch main_kernel_c7_o2
main_kernel_c7_o3_f:
s_nop 0
s_xor_b32 s32, s23, 3072
buffer_load_dwordx4 v[12:15], v116, s[4:7], s32 offen sc1
s_xor_b32 s32, s23, 4096
buffer_load_dwordx4 v[16:19], v116, s[4:7], s32 offen sc1
s_sub_u32 s29, s29, 1
s_cbranch_scc1 main_kernel_end
s_waitcnt vmcnt(0)
v_max_u32 v126, v12, v14
v_cmp_eq_u32 vcc, -1, v126
s_cbranch_vccnz main_kernel_c7_o3_f
s_branch main_kernel_c7_o3
main_kernel_c7_o4_f:
s_nop 0
s_xor_b32 s32, s23, 4096
buffer_load_dwordx4 v[16:19], v116, s[4:7], s32 offen sc1
s_xor_b32 s32, s23, 5120
buffer_load_dwordx4 v[20:23], v116, s[4:7], s32 offen sc1
s_sub_u32 s29, s29, 1
s_cbranch_scc1 main_kernel_end
s_waitcnt vmcnt(0)
v_max_u32 v126, v16, v18
v_cmp_eq_u32 vcc, -1, v126
s_cbranch_vccnz main_kernel_c7_o4_f
s_branch main_kernel_c7_o4
main_kernel_c7_o5_f:
s_nop 0
s_xor_b32 s32, s23, 5120
buffer_load_dwordx4 v[20:23], v116, s[4:7], s32 offen sc1
s_xor_b32 s32, s23, 6144
buffer_load_dwordx4 v[24:27], v116, s[4:7], s32 offen sc1
s_sub_u32 s29, s29, 1
s_cbranch_scc1 main_kernel_end
s_waitcnt vmcnt(0)
v_max_u32 v126, v20, v22
v_cmp_eq_u32 vcc, -1, v126
s_cbranch_vccnz main_kernel_c7_o5_f
s_branch main_kernel_c7_o5
main_kernel_c7_o6_f:
s_nop 0
s_xor_b32 s32, s23, 6144
buffer_load_dwordx4 v[24:27], v116, s[4:7], s32 offen sc1
s_xor_b32 s32, s23, 7168
buffer_load_dwordx4 v[28:31], v116, s[4:7], s32 offen sc1
s_sub_u32 s29, s29, 1
s_cbranch_scc1 main_kernel_end
s_waitcnt vmcnt(0)
v_max_u32 v126, v24, v26
v_cmp_eq_u32 vcc, -1, v126
s_cbranch_vccnz main_kernel_c7_o6_f
s_branch main_kernel_c7_o6
main_kernel_c7_o7_f:
s_nop 0
s_xor_b32 s32, s23, 7168
buffer_load_dwordx4 v[28:31], v116, s[4:7], s32 offen sc1
s_sub_u32 s29, s29, 1
s_cbranch_scc1 main_kernel_end
s_waitcnt vmcnt(0)
v_max_u32 v126, v28, v30
v_cmp_eq_u32 vcc, -1, v126
s_cbranch_vccnz main_kernel_c7_o7_f
s_branch main_kernel_c7_o7
main_kernel_att:
s_cmp_gt_u32 s13, 1
s_cbranch_scc1 main_kernel_p_end
s_cmp_lg_u32 s14, 0
s_cbranch_scc1 main_kernel_p_bar
s_lshl_b32 s32, s13, 21
s_add_u32 s32, s32, 0x8c00000
v_lshlrev_b32 v2, 2, v250
v_mov_b32 v3, -1
s_mov_b64 s[20:21], -1
s_mov_b32 s34, 6
s_mov_b32 exec_hi, 0
s_waitcnt vmcnt(0)
main_kernel_p_lp:
s_memtime s[16:17]
s_waitcnt lgkmcnt(0)
buffer_store_dword v3, v2, s[4:7], s32 offen sc1
s_waitcnt vmcnt(0)
s_memtime s[18:19]
s_xor_b32 s32, s32, 0x2000
s_waitcnt lgkmcnt(0)
s_sub_u32 s33, s18, s16
s_min_u32 s20, s20, s33
s_memtime s[16:17]
s_waitcnt lgkmcnt(0)
buffer_store_dword v3, v2, s[4:7], s32 offen sc1
s_waitcnt vmcnt(0)
s_memtime s[18:19]
s_xor_b32 s32, s32, 0x2000
s_waitcnt lgkmcnt(0)
s_sub_u32 s33, s18, s16
s_min_u32 s21, s21, s33
s_add_u32 s32, s32, 128
s_sub_u32 s34, s34, 1
s_cmp_lg_u32 s34, 0
s_cbranch_scc1 main_kernel_p_lp
s_cmp_lt_u32 s21, s20
s_cselect_b32 s32, 3, 2
s_lshl_b32 s33, s13, 2
v_mov_b32 v3, s32
s_mov_b64 exec, 1
buffer_store_dword v3, off, s[60:63], s33 offset:16 sc1
s_mov_b64 exec, -1
main_kernel_p_bar:
s_barrier
main_kernel_p_end:
v_cmp_gt_u32 vcc, 128, v0
v_mov_b32 v20, 0x1f80
v_mov_b32 v21, 0x380
v_cndmask_b32 v20, v20, v21, vcc
v_mov_b32 v21, 0x1fff
v_mov_b32 v22, 0x1ff
v_cndmask_b32 v21, v21, v22, vcc
v_subrev_u32 v22, 128, v0
v_lshlrev_b32 v22, 13, v22
v_lshlrev_b32 v23, 10, v0
v_cndmask_b32 v22, v22, v23, vcc
v_cmp_gt_u32 vcc, 144, v0
v_mov_b32 v23, 0x40000000
s_nop 0
v_cndmask_b32 v22, v23, v22, vcc
s_mov_b32 s8, s40
s_and_b32 s9, s41, 0xffff
s_mov_b32 s10, 0x800000
s_mov_b32 s11, 0x20000
s_lshl_b32 s35, s13, 17
v_subrev_u32 v23, s40, v21
v_and_b32 v23, v23, v20
v_add_u32 v24, v23, v22
buffer_load_dwordx2 v[14:15], v24, s[8:11], s35 offen offset:60
s_add_u32 s35, s35, 2097152
buffer_load_dwordx2 v[14:15], v24, s[8:11], s35 offen offset:60
s_add_u32 s35, s35, 2097152
buffer_load_dwordx2 v[14:15], v24, s[8:11], s35 offen offset:60
s_add_u32 s35, s35, 2097152
buffer_load_dwordx2 v[14:15], v24, s[8:11], s35 offen offset:60
s_add_u32 s35, s35, 2097152
s_mov_b32 s8, s46
s_and_b32 s9, s47, 0xffff
s_mov_b32 s10, 0x800000
s_mov_b32 s11, 0x20000
s_lshl_b32 s35, s13, 17
v_subrev_u32 v23, s46, v21
v_and_b32 v23, v23, v20
v_add_u32 v30, v23, v22
buffer_load_dwordx2 v[14:15], v30, s[8:11], s35 offen offset:60
s_add_u32 s35, s35, 2097152
buffer_load_dwordx2 v[14:15], v30, s[8:11], s35 offen offset:60
s_add_u32 s35, s35, 2097152
buffer_load_dwordx2 v[14:15], v30, s[8:11], s35 offen offset:60
s_add_u32 s35, s35, 2097152
buffer_load_dwordx2 v[14:15], v30, s[8:11], s35 offen offset:60
s_add_u32 s35, s35, 2097152
s_mov_b32 s8, s64
s_and_b32 s9, s65, 0xffff
s_mov_b32 s10, 0x200000
s_mov_b32 s11, 0x20000
s_mul_i32 s35, s13, 131072
buffer_load_dword v14, v12, s[8:11], s35 offen
s_add_u32 s35, s35, 32768
buffer_load_dword v14, v12, s[8:11], s35 offen
s_add_u32 s35, s35, 32768
buffer_load_dword v14, v12, s[8:11], s35 offen
s_add_u32 s35, s35, 32768
buffer_load_dword v14, v12, s[8:11], s35 offen
s_add_u32 s35, s35, 32768
s_mov_b32 s8, s66
s_and_b32 s9, s67, 0xffff
s_mov_b32 s10, 0x200000
s_mov_b32 s11, 0x20000
s_mul_i32 s35, s13, 131072
buffer_load_dword v14, v12, s[8:11], s35 offen
s_add_u32 s35, s35, 32768
buffer_load_dword v14, v12, s[8:11], s35 offen
s_add_u32 s35, s35, 32768
buffer_load_dword v14, v12, s[8:11], s35 offen
s_add_u32 s35, s35, 32768
buffer_load_dword v14, v12, s[8:11], s35 offen
s_add_u32 s35, s35, 32768
s_lshl_b32 s35, s13, 18
s_add_u32 s35, s35, 0x4808000
buffer_load_dwordx2 v[14:15], v12, s[4:7], s35 offen offset:60
s_add_u32 s35, s35, 32768
buffer_load_dwordx2 v[14:15], v12, s[4:7], s35 offen offset:60
s_add_u32 s35, s35, 32768
buffer_load_dwordx2 v[14:15], v12, s[4:7], s35 offen offset:60
s_add_u32 s35, s35, 32768
buffer_load_dwordx2 v[14:15], v12, s[4:7], s35 offen offset:60
s_add_u32 s35, s35, 32768
buffer_load_dwordx2 v[14:15], v12, s[4:7], s35 offen offset:60
s_add_u32 s35, s35, 32768
buffer_load_dwordx2 v[14:15], v12, s[4:7], s35 offen offset:60
s_add_u32 s35, s35, 32768
buffer_load_dwordx2 v[14:15], v12, s[4:7], s35 offen offset:60
s_add_u32 s35, s35, 32768
buffer_load_dwordx2 v[14:15], v12, s[4:7], s35 offen offset:60
s_add_u32 s35, s35, 32768
v_lshlrev_b32 v0, 2, v250
s_mov_b32 s32, 0x841f000
main_kernel_awf:
buffer_load_dword v2, v0, s[4:7], s32 offen sc1
s_waitcnt vmcnt(0)
v_cmp_eq_u32 vcc, 0, v2
s_cbranch_vccz main_kernel_awf_ok
s_sleep 4
s_sub_u32 s29, s29, 1
s_cbranch_scc0 main_kernel_awf
s_branch main_kernel_end
main_kernel_awf_ok:
s_mov_b32 s27, 6
s_branch main_kernel_worker
main_kernel_att2:
s_lshl_b32 s25, s13, 1
s_lshr_b32 s31, s14, 1
s_add_u32 s25, s25, s31
s_and_b32 s23, s14, 1
v_lshlrev_b32 v196, 4, v250
v_and_b32 v188, 15, v250
v_lshrrev_b32 v190, 4, v250
v_and_b32 v203, 7, v250
v_lshl_add_u32 v194, v190, 3, v203
v_lshlrev_b32 v197, 4, v194
v_lshlrev_b32 v203, 8, v203
v_bfe_u32 v198, v196, 1, 8
v_min_u32 v199, 2, v250
v_lshlrev_b32 v199, 13, v199
s_lshl_b32 s31, s25, 2
s_sub_u32 s31, 82416, s31
s_mov_b64 exec, 0xf0
v_lshl_add_u32 v199, v250, 2, s31
s_mov_b64 exec, -1
v_mov_b32 v200, 1
v_mov_b32 v201, 1
v_mov_b32 v202, 0
v_lshlrev_b32 v194, 2, v190
v_sub_u32 v188, v188, v194
v_mov_b32 v194, 0xf149f2ca
v_cmp_le_i32 vcc, 0, v188
s_nop 1
v_cndmask_b32 v152, v194, 0, vcc
v_cmp_le_i32 vcc, 1, v188
s_nop 1
v_cndmask_b32 v153, v194, 0, vcc
v_cmp_le_i32 vcc, 2, v188
s_nop 1
v_cndmask_b32 v154, v194, 0, vcc
v_cmp_le_i32 vcc, 3, v188
s_nop 1
v_cndmask_b32 v155, v194, 0, vcc
v_cmp_le_u32 vcc, 2, v190
s_nop 1
v_cndmask_b32 v156, v194, 0, vcc
v_mov_b32 v184, 0x3f803f80
v_cndmask_b32 v157, v194, 0, vcc
v_mov_b32 v185, 0x3f803f80
v_cndmask_b32 v158, v194, 0, vcc
v_mov_b32 v186, 0x3f803f80
v_cndmask_b32 v159, v194, 0, vcc
v_mov_b32 v187, 0x3f803f80
v_mov_b32 v162, 0
v_mov_b32 v163, 0
s_mov_b32 s24, 0x3e0293ee
s_lshl_b32 s31, s23, 18
s_lshl_b32 s32, s25, 12
s_add_u32 s31, s31, s32
s_add_u32 s15, s31, 0x800000
s_add_u32 s16, s31, 0x1800000
s_add_u32 s20, s31, 0x3800000
s_lshl_b32 s31, s23, 18
s_lshl_b32 s32, s25, 13
s_add_u32 s31, s31, s32
s_add_u32 s17, s31, 0x2800000
s_lshl_b32 s31, s23, 16
s_lshl_b32 s32, s25, 11
s_add_u32 s31, s31, s32
s_add_u32 s18, s31, 0x8000000
s_add_u32 s19, s31, 0x6e00000
s_lshl_b32 s31, s23, 7
s_lshl_b32 s32, s25, 2
s_add_u32 s31, s31, s32
s_add_u32 s21, s31, 0x8404000
s_lshl_b32 s31, s23, 8
s_lshl_b32 s32, s25, 3
s_add_u32 s31, s31, s32
s_add_u32 s22, s31, 0x8400000
main_kernel_a_fp:
buffer_load_dword v194, v199, s[4:7], s21 offen sc1
s_waitcnt vmcnt(0)
v_cmp_eq_u32 vcc, 0, v194
s_cbranch_vccz main_kernel_a_fok
s_sleep 8
s_sub_u32 s29, s29, 1
s_cbranch_scc0 main_kernel_a_fp
s_branch main_kernel_end
main_kernel_a_fok:
buffer_load_dwordx4 v[32:35], v196, s[4:7], s16 offen offset:0 sc1
buffer_load_dwordx4 v[36:39], v196, s[4:7], s16 offen offset:1024 sc1
buffer_load_dwordx4 v[40:43], v196, s[4:7], s16 offen offset:2048 sc1
buffer_load_dwordx4 v[44:47], v196, s[4:7], s16 offen offset:3072 sc1
s_add_u32 s16, s16, 131072
buffer_load_dwordx4 v[48:51], v196, s[4:7], s16 offen offset:0 sc1
buffer_load_dwordx4 v[52:55], v196, s[4:7], s16 offen offset:1024 sc1
buffer_load_dwordx4 v[56:59], v196, s[4:7], s16 offen offset:2048 sc1
buffer_load_dwordx4 v[60:63], v196, s[4:7], s16 offen offset:3072 sc1
s_add_u32 s16, s16, 393216
buffer_load_dwordx4 v[0:3], v196, s[4:7], s15 offen offset:0 sc1
buffer_load_dwordx4 v[4:7], v196, s[4:7], s15 offen offset:1024 sc1
buffer_load_dwordx4 v[8:11], v196, s[4:7], s15 offen offset:2048 sc1
buffer_load_dwordx4 v[12:15], v196, s[4:7], s15 offen offset:3072 sc1
s_add_u32 s15, s15, 131072
buffer_load_dwordx4 v[16:19], v196, s[4:7], s15 offen offset:0 sc1
buffer_load_dwordx4 v[20:23], v196, s[4:7], s15 offen offset:1024 sc1
buffer_load_dwordx4 v[24:27], v196, s[4:7], s15 offen offset:2048 sc1
buffer_load_dwordx4 v[28:31], v196, s[4:7], s15 offen offset:3072 sc1
s_add_u32 s15, s15, 393216
buffer_load_dwordx4 v[64:67], v196, s[4:7], s17 offen offset:0 sc1
buffer_load_dwordx4 v[68:71], v196, s[4:7], s17 offen offset:1024 sc1
buffer_load_dwordx4 v[72:75], v196, s[4:7], s17 offen offset:2048 sc1
buffer_load_dwordx4 v[76:79], v196, s[4:7], s17 offen offset:3072 sc1
s_add_u32 s17, s17, 4096
buffer_load_dwordx4 v[80:83], v196, s[4:7], s17 offen offset:0 sc1
buffer_load_dwordx4 v[84:87], v196, s[4:7], s17 offen offset:1024 sc1
buffer_load_dwordx4 v[88:91], v196, s[4:7], s17 offen offset:2048 sc1
buffer_load_dwordx4 v[92:95], v196, s[4:7], s17 offen offset:3072 sc1
s_add_u32 s17, s17, 520192
s_mov_b32 s26, 0
main_kernel_a_top:
s_add_u32 s21, s21, 256
s_waitcnt vmcnt(15)
v_mfma_f32_16x16x32_bf16 v[128:131], v[32:35], v[0:3], v[152:155]
s_waitcnt vmcnt(14)
v_mfma_f32_16x16x32_bf16 v[128:131], v[36:39], v[4:7], v[128:131]
s_waitcnt vmcnt(13)
v_mfma_f32_16x16x32_bf16 v[128:131], v[40:43], v[8:11], v[128:131]
s_waitcnt vmcnt(12)
v_mfma_f32_16x16x32_bf16 v[128:131], v[44:47], v[12:15], v[128:131]
s_waitcnt vmcnt(11)
v_mfma_f32_16x16x32_bf16 v[140:143], v[32:35], v[16:19], 0
v_mfma_f32_16x16x32_bf16 v[144:147], v[48:51], v[16:19], v[152:155]
s_waitcnt vmcnt(10)
v_mfma_f32_16x16x32_bf16 v[140:143], v[36:39], v[20:23], v[140:143]
v_mfma_f32_16x16x32_bf16 v[144:147], v[52:55], v[20:23], v[144:147]
s_waitcnt vmcnt(9)
v_mfma_f32_16x16x32_bf16 v[140:143], v[40:43], v[24:27], v[140:143]
v_mfma_f32_16x16x32_bf16 v[144:147], v[56:59], v[24:27], v[144:147]
s_waitcnt vmcnt(8)
v_mfma_f32_16x16x32_bf16 v[140:143], v[44:47], v[28:31], v[140:143]
v_mfma_f32_16x16x32_bf16 v[144:147], v[60:63], v[28:31], v[144:147]
v_max3_f32 v192, v128, v129, v130
v_max_f32 v192, v192, v131
s_cmp_lg_u32 s26, 0
s_nop 2
v_max3_f32 v193, v140, v141, v142
s_nop 1
v_max3_f32 v193, v193, v143, v144
v_max3_f32 v193, v193, v145, v146
v_max_f32 v193, v193, v147
s_cbranch_scc1 main_kernel_a_me
main_kernel_a_pp:
v_mov_b32 v204, 0
s_mov_b64 exec, 0xff
buffer_atomic_add v204, v203, s[4:7], s19 offen sc0 sc1
s_mov_b64 exec, -1
s_sub_u32 s29, s29, 1
s_cbranch_scc1 main_kernel_end
s_waitcnt vmcnt(0)
v_cmp_eq_u32 vcc, -1, v204
s_cbranch_vccnz main_kernel_a_pp
main_kernel_a_mp:
buffer_load_dwordx4 v[96:99], v197, s[4:7], s18 offen offset:0 sc1
buffer_load_dwordx4 v[100:103], v197, s[4:7], s18 offen offset:512 sc1
buffer_load_dwordx4 v[104:107], v197, s[4:7], s18 offen offset:1024 sc1
buffer_load_dwordx4 v[108:111], v197, s[4:7], s18 offen offset:1536 sc1
buffer_load_dwordx2 v[112:113], v198, s[4:7], s19 offen offset:0 sc1
buffer_load_dwordx2 v[114:115], v198, s[4:7], s19 offen offset:256 sc1
buffer_load_dwordx2 v[116:117], v198, s[4:7], s19 offen offset:512 sc1
buffer_load_dwordx2 v[118:119], v198, s[4:7], s19 offen offset:768 sc1
buffer_load_dwordx2 v[120:121], v198, s[4:7], s19 offen offset:1024 sc1
buffer_load_dwordx2 v[122:123], v198, s[4:7], s19 offen offset:1280 sc1
buffer_load_dwordx2 v[124:125], v198, s[4:7], s19 offen offset:1536 sc1
buffer_load_dwordx2 v[126:127], v198, s[4:7], s19 offen offset:1792 sc1
main_kernel_a_me:
buffer_load_dword v205, v199, s[4:7], s21 offen sc1
s_add_u32 s31, s19, 0x20000
s_cmp_ge_u32 s23, 54
s_cselect_b32 s31, 0x7f000000, s31
s_cselect_b32 s26, 0, 1
v_mov_b32 v204, 0
s_mov_b64 exec, 0xff
buffer_atomic_add v204, v203, s[4:7], s31 offen sc0 sc1
s_mov_b64 exec, -1
s_waitcnt vmcnt(13)
v_mfma_f32_16x16x32_bf16 v[132:135], v[96:99], v[0:3], v[156:159]
v_mfma_f32_16x16x32_bf16 v[148:151], v[96:99], v[16:19], v[156:159]
v_max3_u32 v194, v96, v96, v97
v_max3_u32 v194, v194, v98, v99
s_waitcnt vmcnt(12)
v_mfma_f32_16x16x32_bf16 v[132:135], v[100:103], v[4:7], v[132:135]
v_mfma_f32_16x16x32_bf16 v[148:151], v[100:103], v[20:23], v[148:151]
v_max3_u32 v194, v194, v100, v101
v_max3_u32 v194, v194, v102, v103
s_waitcnt vmcnt(11)
v_mfma_f32_16x16x32_bf16 v[132:135], v[104:107], v[8:11], v[132:135]
v_mfma_f32_16x16x32_bf16 v[148:151], v[104:107], v[24:27], v[148:151]
v_max3_u32 v194, v194, v104, v105
v_max3_u32 v194, v194, v106, v107
s_waitcnt vmcnt(10)
v_mfma_f32_16x16x32_bf16 v[132:135], v[108:111], v[12:15], v[132:135]
v_mfma_f32_16x16x32_bf16 v[148:151], v[108:111], v[28:31], v[148:151]
v_max3_u32 v194, v194, v108, v109
v_max3_u32 v194, v194, v110, v111
s_waitcnt vmcnt(8)
v_max3_u32 v194, v194, v112, v113
v_max3_u32 v194, v194, v114, v115
s_waitcnt vmcnt(6)
v_max3_u32 v194, v194, v116, v117
v_max3_u32 v194, v194, v118, v119
s_waitcnt vmcnt(4)
v_max3_u32 v194, v194, v120, v121
v_max3_u32 v194, v194, v122, v123
s_waitcnt vmcnt(2)
v_max3_u32 v194, v194, v124, v125
v_max3_u32 v194, v194, v126, v127
v_cmp_eq_u32 vcc, -1, v194
s_cbranch_vccz main_kernel_a_mok
s_waitcnt vmcnt(0)
s_sub_u32 s29, s29, 1
s_cbranch_scc0 main_kernel_a_mp
s_branch main_kernel_end
main_kernel_a_mok:
v_mul_f32 v148, s24, v148
v_mul_f32 v149, s24, v149
v_mul_f32 v150, s24, v150
v_mul_f32 v151, s24, v151
v_max3_f32 v190, v193, v148, v149
v_max3_f32 v190, v190, v150, v151
v_mov_b32 v191, v190
v_mul_f32 v132, s24, v132
v_mul_f32 v133, s24, v133
v_mul_f32 v134, s24, v134
v_mul_f32 v135, s24, v135
v_max3_f32 v188, v192, v132, v133
v_max3_f32 v188, v188, v134, v135
v_mov_b32 v189, v188
s_add_u32 s18, s18, 0x20000
s_add_u32 s19, s19, 0x20000
v_permlane32_swap_b32 v190, v191
v_max_f32 v190, v190, v191
v_mov_b32 v191, v190
v_permlane32_swap_b32 v188, v189
v_max_f32 v188, v188, v189
v_mov_b32 v189, v188
v_permlane16_swap_b32 v190, v191
v_max_f32 v190, v190, v191
v_permlane16_swap_b32 v188, v189
v_max_f32 v188, v188, v189
v_sub_f32 v140, v140, v190
v_sub_f32 v141, v141, v190
v_sub_f32 v142, v142, v190
v_sub_f32 v143, v143, v190
v_sub_f32 v144, v144, v190
v_sub_f32 v145, v145, v190
v_sub_f32 v146, v146, v190
v_sub_f32 v147, v147, v190
v_sub_f32 v148, v148, v190
v_sub_f32 v149, v149, v190
v_sub_f32 v150, v150, v190
v_sub_f32 v151, v151, v190
v_exp_f32 v140, v140
v_exp_f32 v141, v141
v_exp_f32 v142, v142
v_exp_f32 v143, v143
v_cvt_pk_bf16_f32 v168, v140, v141
v_exp_f32 v144, v144
v_exp_f32 v145, v145
v_cvt_pk_bf16_f32 v169, v142, v143
v_exp_f32 v146, v146
v_exp_f32 v147, v147
v_cvt_pk_bf16_f32 v170, v144, v145
v_exp_f32 v148, v148
v_exp_f32 v149, v149
v_cvt_pk_bf16_f32 v171, v146, v147
v_exp_f32 v150, v150
v_exp_f32 v151, v151
v_cvt_pk_bf16_f32 v172, v148, v149
s_nop 0
v_cvt_pk_bf16_f32 v173, v150, v151
s_add_u32 s31, s20, 131072
s_nop 0
v_mfma_f32_16x16x32_bf16 v[180:183], v[184:187], v[168:171], 0
v_sub_f32 v128, v128, v188
v_sub_f32 v129, v129, v188
v_sub_f32 v130, v130, v188
v_mfma_f32_16x16x32_bf16 v[32:35], v[64:67], v[168:171], 0
v_sub_f32 v131, v131, v188
v_sub_f32 v132, v132, v188
v_sub_f32 v133, v133, v188
v_mfma_f32_16x16x16_bf16 v[180:183], v[184:185], v[172:173], v[180:183]
v_sub_f32 v134, v134, v188
v_sub_f32 v135, v135, v188
v_exp_f32 v128, v128
v_mfma_f32_16x16x32_bf16 v[36:39], v[68:71], v[168:171], 0
v_exp_f32 v129, v129
v_exp_f32 v130, v130
v_exp_f32 v131, v131
v_mfma_f32_16x16x32_bf16 v[40:43], v[72:75], v[168:171], 0
v_cvt_pk_bf16_f32 v160, v128, v129
v_exp_f32 v132, v132
v_exp_f32 v133, v133
v_mfma_f32_16x16x32_bf16 v[44:47], v[76:79], v[168:171], 0
v_cvt_pk_bf16_f32 v161, v130, v131
v_exp_f32 v134, v134
v_exp_f32 v135, v135
v_mfma_f32_16x16x32_bf16 v[48:51], v[80:83], v[168:171], 0
v_cvt_pk_bf16_f32 v164, v132, v133
s_nop 0
v_cvt_pk_bf16_f32 v165, v134, v135
v_mfma_f32_16x16x32_bf16 v[52:55], v[84:87], v[168:171], 0
v_mfma_f32_16x16x32_bf16 v[56:59], v[88:91], v[168:171], 0
v_mfma_f32_16x16x32_bf16 v[60:63], v[92:95], v[168:171], 0
v_mfma_f32_16x16x16_bf16 v[32:35], v[112:113], v[172:173], v[32:35]
v_mfma_f32_16x16x16_bf16 v[36:39], v[114:115], v[172:173], v[36:39]
v_mfma_f32_16x16x16_bf16 v[40:43], v[116:117], v[172:173], v[40:43]
v_mfma_f32_16x16x16_bf16 v[44:47], v[118:119], v[172:173], v[44:47]
v_mfma_f32_16x16x16_bf16 v[48:51], v[120:121], v[172:173], v[48:51]
v_mfma_f32_16x16x16_bf16 v[52:55], v[122:123], v[172:173], v[52:55]
v_mfma_f32_16x16x16_bf16 v[56:59], v[124:125], v[172:173], v[56:59]
v_mfma_f32_16x16x16_bf16 v[60:63], v[126:127], v[172:173], v[60:63]
v_mfma_f32_16x16x32_bf16 v[176:179], v[184:187], v[160:163], 0
v_rcp_f32 v190, v180
s_nop 0
v_mov_b32 v191, v190
v_mfma_f32_16x16x32_bf16 v[0:3], v[64:67], v[160:163], 0
v_pk_mul_f32 v[32:33], v[32:33], v[190:191]
v_pk_mul_f32 v[34:35], v[34:35], v[190:191]
v_pk_mul_f32 v[36:37], v[36:37], v[190:191]
v_mfma_f32_16x16x16_bf16 v[176:179], v[184:185], v[164:165], v[176:179]
v_pk_mul_f32 v[38:39], v[38:39], v[190:191]
v_cvt_pk_bf16_f32 v208, v32, v33
v_cvt_pk_bf16_f32 v209, v34, v35
v_mfma_f32_16x16x32_bf16 v[4:7], v[68:71], v[160:163], 0
v_cvt_pk_bf16_f32 v210, v36, v37
v_cvt_pk_bf16_f32 v211, v38, v39
buffer_store_dwordx4 v[208:211], v196, s[4:7], s31 offen offset:0 sc1
v_mfma_f32_16x16x32_bf16 v[8:11], v[72:75], v[160:163], 0
v_pk_mul_f32 v[40:41], v[40:41], v[190:191]
v_pk_mul_f32 v[42:43], v[42:43], v[190:191]
v_pk_mul_f32 v[44:45], v[44:45], v[190:191]
v_mfma_f32_16x16x32_bf16 v[12:15], v[76:79], v[160:163], 0
v_pk_mul_f32 v[46:47], v[46:47], v[190:191]
v_cvt_pk_bf16_f32 v212, v40, v41
v_cvt_pk_bf16_f32 v213, v42, v43
v_mfma_f32_16x16x32_bf16 v[16:19], v[80:83], v[160:163], 0
v_cvt_pk_bf16_f32 v214, v44, v45
v_cvt_pk_bf16_f32 v215, v46, v47
buffer_store_dwordx4 v[212:215], v196, s[4:7], s31 offen offset:1024 sc1
v_mfma_f32_16x16x32_bf16 v[20:23], v[84:87], v[160:163], 0
v_pk_mul_f32 v[48:49], v[48:49], v[190:191]
v_pk_mul_f32 v[50:51], v[50:51], v[190:191]
v_pk_mul_f32 v[52:53], v[52:53], v[190:191]
v_mfma_f32_16x16x32_bf16 v[24:27], v[88:91], v[160:163], 0
v_pk_mul_f32 v[54:55], v[54:55], v[190:191]
v_cvt_pk_bf16_f32 v216, v48, v49
v_cvt_pk_bf16_f32 v217, v50, v51
v_mfma_f32_16x16x32_bf16 v[28:31], v[92:95], v[160:163], 0
v_cvt_pk_bf16_f32 v218, v52, v53
v_cvt_pk_bf16_f32 v219, v54, v55
buffer_store_dwordx4 v[216:219], v196, s[4:7], s31 offen offset:2048 sc1
v_mfma_f32_16x16x16_bf16 v[0:3], v[112:113], v[164:165], v[0:3]
v_pk_mul_f32 v[56:57], v[56:57], v[190:191]
v_mfma_f32_16x16x16_bf16 v[4:7], v[114:115], v[164:165], v[4:7]
v_pk_mul_f32 v[58:59], v[58:59], v[190:191]
v_mfma_f32_16x16x16_bf16 v[8:11], v[116:117], v[164:165], v[8:11]
v_pk_mul_f32 v[60:61], v[60:61], v[190:191]
v_mfma_f32_16x16x16_bf16 v[12:15], v[118:119], v[164:165], v[12:15]
v_pk_mul_f32 v[62:63], v[62:63], v[190:191]
v_mfma_f32_16x16x16_bf16 v[16:19], v[120:121], v[164:165], v[16:19]
v_cvt_pk_bf16_f32 v220, v56, v57
v_mfma_f32_16x16x16_bf16 v[20:23], v[122:123], v[164:165], v[20:23]
v_cvt_pk_bf16_f32 v221, v58, v59
v_mfma_f32_16x16x16_bf16 v[24:27], v[124:125], v[164:165], v[24:27]
v_cvt_pk_bf16_f32 v222, v60, v61
v_mfma_f32_16x16x16_bf16 v[28:31], v[126:127], v[164:165], v[28:31]
v_cvt_pk_bf16_f32 v223, v62, v63
buffer_store_dwordx4 v[220:223], v196, s[4:7], s31 offen offset:3072 sc1
s_add_u32 s23, s23, 2
v_rcp_f32 v188, v176
s_nop 0
v_mov_b32 v189, v188
v_pk_mul_f32 v[0:1], v[0:1], v[188:189]
v_pk_mul_f32 v[2:3], v[2:3], v[188:189]
v_pk_mul_f32 v[4:5], v[4:5], v[188:189]
v_pk_mul_f32 v[6:7], v[6:7], v[188:189]
v_cvt_pk_bf16_f32 v224, v0, v1
v_cvt_pk_bf16_f32 v225, v2, v3
v_cvt_pk_bf16_f32 v226, v4, v5
v_cvt_pk_bf16_f32 v227, v6, v7
buffer_store_dwordx4 v[224:227], v196, s[4:7], s20 offen offset:0 sc1
v_pk_mul_f32 v[8:9], v[8:9], v[188:189]
v_pk_mul_f32 v[10:11], v[10:11], v[188:189]
v_pk_mul_f32 v[12:13], v[12:13], v[188:189]
v_pk_mul_f32 v[14:15], v[14:15], v[188:189]
v_cvt_pk_bf16_f32 v228, v8, v9
v_cvt_pk_bf16_f32 v229, v10, v11
v_cvt_pk_bf16_f32 v230, v12, v13
v_cvt_pk_bf16_f32 v231, v14, v15
buffer_store_dwordx4 v[228:231], v196, s[4:7], s20 offen offset:1024 sc1
v_pk_mul_f32 v[16:17], v[16:17], v[188:189]
v_pk_mul_f32 v[18:19], v[18:19], v[188:189]
v_pk_mul_f32 v[20:21], v[20:21], v[188:189]
v_pk_mul_f32 v[22:23], v[22:23], v[188:189]
v_cvt_pk_bf16_f32 v232, v16, v17
v_cvt_pk_bf16_f32 v233, v18, v19
v_cvt_pk_bf16_f32 v234, v20, v21
v_cvt_pk_bf16_f32 v235, v22, v23
buffer_store_dwordx4 v[232:235], v196, s[4:7], s20 offen offset:2048 sc1
v_pk_mul_f32 v[24:25], v[24:25], v[188:189]
v_pk_mul_f32 v[26:27], v[26:27], v[188:189]
v_pk_mul_f32 v[28:29], v[28:29], v[188:189]
v_pk_mul_f32 v[30:31], v[30:31], v[188:189]
v_cvt_pk_bf16_f32 v236, v24, v25
v_cvt_pk_bf16_f32 v237, v26, v27
v_cvt_pk_bf16_f32 v238, v28, v29
v_cvt_pk_bf16_f32 v239, v30, v31
buffer_store_dwordx4 v[236:239], v196, s[4:7], s20 offen offset:3072 sc1
s_add_u32 s20, s20, 524288
s_cmp_ge_u32 s23, 60
s_cbranch_scc1 main_kernel_a_slow
s_waitcnt vmcnt(8)
v_cmp_eq_u32 vcc, 0, v205
s_cbranch_vccnz main_kernel_a_slow
v_cmp_eq_u32 vcc, -1, v204
buffer_load_dwordx4 v[32:35], v196, s[4:7], s16 offen offset:0 sc1
buffer_load_dwordx4 v[36:39], v196, s[4:7], s16 offen offset:1024 sc1
buffer_load_dwordx4 v[40:43], v196, s[4:7], s16 offen offset:2048 sc1
buffer_load_dwordx4 v[44:47], v196, s[4:7], s16 offen offset:3072 sc1
s_add_u32 s16, s16, 131072
buffer_load_dwordx4 v[48:51], v196, s[4:7], s16 offen offset:0 sc1
buffer_load_dwordx4 v[52:55], v196, s[4:7], s16 offen offset:1024 sc1
buffer_load_dwordx4 v[56:59], v196, s[4:7], s16 offen offset:2048 sc1
buffer_load_dwordx4 v[60:63], v196, s[4:7], s16 offen offset:3072 sc1
s_add_u32 s16, s16, 393216
buffer_load_dwordx4 v[0:3], v196, s[4:7], s15 offen offset:0 sc1
buffer_load_dwordx4 v[4:7], v196, s[4:7], s15 offen offset:1024 sc1
buffer_load_dwordx4 v[8:11], v196, s[4:7], s15 offen offset:2048 sc1
buffer_load_dwordx4 v[12:15], v196, s[4:7], s15 offen offset:3072 sc1
s_add_u32 s15, s15, 131072
buffer_load_dwordx4 v[16:19], v196, s[4:7], s15 offen offset:0 sc1
buffer_load_dwordx4 v[20:23], v196, s[4:7], s15 offen offset:1024 sc1
buffer_load_dwordx4 v[24:27], v196, s[4:7], s15 offen offset:2048 sc1
buffer_load_dwordx4 v[28:31], v196, s[4:7], s15 offen offset:3072 sc1
s_add_u32 s15, s15, 393216
buffer_load_dwordx4 v[64:67], v196, s[4:7], s17 offen offset:0 sc1
buffer_load_dwordx4 v[68:71], v196, s[4:7], s17 offen offset:1024 sc1
buffer_load_dwordx4 v[72:75], v196, s[4:7], s17 offen offset:2048 sc1
buffer_load_dwordx4 v[76:79], v196, s[4:7], s17 offen offset:3072 sc1
s_add_u32 s17, s17, 4096
buffer_load_dwordx4 v[80:83], v196, s[4:7], s17 offen offset:0 sc1
buffer_load_dwordx4 v[84:87], v196, s[4:7], s17 offen offset:1024 sc1
buffer_load_dwordx4 v[88:91], v196, s[4:7], s17 offen offset:2048 sc1
buffer_load_dwordx4 v[92:95], v196, s[4:7], s17 offen offset:3072 sc1
s_add_u32 s17, s17, 520192
s_cmp_eq_u64 vcc, 0
s_cselect_b32 s26, s26, 0
s_cmp_eq_u32 s26, 0
s_cbranch_scc1 main_kernel_a_nm
buffer_load_dwordx4 v[96:99], v197, s[4:7], s18 offen offset:0 sc1
buffer_load_dwordx4 v[100:103], v197, s[4:7], s18 offen offset:512 sc1
buffer_load_dwordx4 v[104:107], v197, s[4:7], s18 offen offset:1024 sc1
buffer_load_dwordx4 v[108:111], v197, s[4:7], s18 offen offset:1536 sc1
buffer_load_dwordx2 v[112:113], v198, s[4:7], s19 offen offset:0 sc1
buffer_load_dwordx2 v[114:115], v198, s[4:7], s19 offen offset:256 sc1
buffer_load_dwordx2 v[116:117], v198, s[4:7], s19 offen offset:512 sc1
buffer_load_dwordx2 v[118:119], v198, s[4:7], s19 offen offset:768 sc1
buffer_load_dwordx2 v[120:121], v198, s[4:7], s19 offen offset:1024 sc1
buffer_load_dwordx2 v[122:123], v198, s[4:7], s19 offen offset:1280 sc1
buffer_load_dwordx2 v[124:125], v198, s[4:7], s19 offen offset:1536 sc1
buffer_load_dwordx2 v[126:127], v198, s[4:7], s19 offen offset:1792 sc1
s_waitcnt vmcnt(36)
s_mov_b64 exec, 1
buffer_store_dwordx2 v[200:201], v202, s[4:7], s22 offen sc1
s_mov_b64 exec, -1
s_add_u32 s22, s22, 512
s_branch main_kernel_a_top
main_kernel_a_nm:
s_waitcnt vmcnt(24)
s_mov_b64 exec, 1
buffer_store_dwordx2 v[200:201], v202, s[4:7], s22 offen sc1
s_mov_b64 exec, -1
s_add_u32 s22, s22, 512
s_branch main_kernel_a_top
main_kernel_a_slow:
s_waitcnt vmcnt(0)
s_mov_b64 exec, 1
buffer_store_dwordx2 v[200:201], v202, s[4:7], s22 offen sc1
s_mov_b64 exec, -1
s_add_u32 s22, s22, 512
s_cmp_lt_u32 s23, 64
s_cbranch_scc1 main_kernel_a_fp
s_branch main_kernel_end
main_kernel_wo:
s_mov_b32 s8, s46
s_and_b32 s9, s47, 0xffff
s_mov_b32 s10, 0x800000
s_mov_b32 s11, 0x20000
v_lshlrev_b32 v170, 4, v250
s_lshr_b32 s23, s12, 2
s_sub_u32 s21, s12, 5
s_cselect_b32 s23, s23, s21
s_cselect_b32 s18, 40, 63
v_lshrrev_b32 v178, 2, v250
v_and_b32 v179, 3, v250
v_lshlrev_b32 v0, 11, v178
v_lshl_add_u32 v0, v179, 4, v0
s_lshl_b32 s19, s14, 15
v_lshl_add_u32 v1, v178, 6, s19
v_lshl_add_u32 v1, v179, 3, v1
s_lshl_b32 s20, s14, 21
s_lshl_b32 s21, s13, 6
s_add_u32 s20, s20, s21
s_add_u32 s21, s20, 0x0
s_add_u32 m0, s19, 0
s_nop 0
buffer_load_dwordx4 v0, s[8:11], s21 offen lds
s_add_u32 s21, s20, 0x8000
s_add_u32 m0, s19, 1024
s_nop 0
buffer_load_dwordx4 v0, s[8:11], s21 offen lds
s_add_u32 s21, s20, 0x10000
s_add_u32 m0, s19, 2048
s_nop 0
buffer_load_dwordx4 v0, s[8:11], s21 offen lds
s_add_u32 s21, s20, 0x18000
s_add_u32 m0, s19, 3072
s_nop 0
buffer_load_dwordx4 v0, s[8:11], s21 offen lds
s_add_u32 s21, s20, 0x20000
s_add_u32 m0, s19, 4096
s_nop 0
buffer_load_dwordx4 v0, s[8:11], s21 offen lds
s_add_u32 s21, s20, 0x28000
s_add_u32 m0, s19, 5120
s_nop 0
buffer_load_dwordx4 v0, s[8:11], s21 offen lds
s_add_u32 s21, s20, 0x30000
s_add_u32 m0, s19, 6144
s_nop 0
buffer_load_dwordx4 v0, s[8:11], s21 offen lds
s_add_u32 s21, s20, 0x38000
s_add_u32 m0, s19, 7168
s_nop 0
buffer_load_dwordx4 v0, s[8:11], s21 offen lds
s_add_u32 s21, s20, 0x40000
s_add_u32 m0, s19, 8192
s_nop 0
buffer_load_dwordx4 v0, s[8:11], s21 offen lds
s_add_u32 s21, s20, 0x48000
s_add_u32 m0, s19, 9216
s_nop 0
buffer_load_dwordx4 v0, s[8:11], s21 offen lds
s_add_u32 s21, s20, 0x50000
s_add_u32 m0, s19, 10240
s_nop 0
buffer_load_dwordx4 v0, s[8:11], s21 offen lds
s_add_u32 s21, s20, 0x58000
s_add_u32 m0, s19, 11264
s_nop 0
buffer_load_dwordx4 v0, s[8:11], s21 offen lds
s_add_u32 s21, s20, 0x60000
s_add_u32 m0, s19, 12288
s_nop 0
buffer_load_dwordx4 v0, s[8:11], s21 offen lds
s_add_u32 s21, s20, 0x68000
s_add_u32 m0, s19, 13312
s_nop 0
buffer_load_dwordx4 v0, s[8:11], s21 offen lds
s_add_u32 s21, s20, 0x70000
s_add_u32 m0, s19, 14336
s_nop 0
buffer_load_dwordx4 v0, s[8:11], s21 offen lds
s_add_u32 s21, s20, 0x78000
s_add_u32 m0, s19, 15360
s_nop 0
buffer_load_dwordx4 v0, s[8:11], s21 offen lds
s_add_u32 s21, s20, 0x80000
s_add_u32 m0, s19, 16384
s_nop 0
buffer_load_dwordx4 v0, s[8:11], s21 offen lds
s_add_u32 s21, s20, 0x88000
s_add_u32 m0, s19, 17408
s_nop 0
buffer_load_dwordx4 v0, s[8:11], s21 offen lds
s_add_u32 s21, s20, 0x90000
s_add_u32 m0, s19, 18432
s_nop 0
buffer_load_dwordx4 v0, s[8:11], s21 offen lds
s_add_u32 s21, s20, 0x98000
s_add_u32 m0, s19, 19456
s_nop 0
buffer_load_dwordx4 v0, s[8:11], s21 offen lds
s_add_u32 s21, s20, 0xa0000
s_add_u32 m0, s19, 20480
s_nop 0
buffer_load_dwordx4 v0, s[8:11], s21 offen lds
s_add_u32 s21, s20, 0xa8000
s_add_u32 m0, s19, 21504
s_nop 0
buffer_load_dwordx4 v0, s[8:11], s21 offen lds
s_add_u32 s21, s20, 0xb0000
s_add_u32 m0, s19, 22528
s_nop 0
buffer_load_dwordx4 v0, s[8:11], s21 offen lds
s_add_u32 s21, s20, 0xb8000
s_add_u32 m0, s19, 23552
s_nop 0
buffer_load_dwordx4 v0, s[8:11], s21 offen lds
s_add_u32 s21, s20, 0xc0000
s_add_u32 m0, s19, 24576
s_nop 0
buffer_load_dwordx4 v0, s[8:11], s21 offen lds
s_add_u32 s21, s20, 0xc8000
s_add_u32 m0, s19, 25600
s_nop 0
buffer_load_dwordx4 v0, s[8:11], s21 offen lds
s_add_u32 s21, s20, 0xd0000
s_add_u32 m0, s19, 26624
s_nop 0
buffer_load_dwordx4 v0, s[8:11], s21 offen lds
s_add_u32 s21, s20, 0xd8000
s_add_u32 m0, s19, 27648
s_nop 0
buffer_load_dwordx4 v0, s[8:11], s21 offen lds
s_add_u32 s21, s20, 0xe0000
s_add_u32 m0, s19, 28672
s_nop 0
buffer_load_dwordx4 v0, s[8:11], s21 offen lds
s_add_u32 s21, s20, 0xe8000
s_add_u32 m0, s19, 29696
s_nop 0
buffer_load_dwordx4 v0, s[8:11], s21 offen lds
s_add_u32 s21, s20, 0xf0000
s_add_u32 m0, s19, 30720
s_nop 0
buffer_load_dwordx4 v0, s[8:11], s21 offen lds
s_add_u32 s21, s20, 0xf8000
s_add_u32 m0, s19, 31744
s_nop 0
buffer_load_dwordx4 v0, s[8:11], s21 offen lds
v_and_b32 v178, 15, v250
v_lshrrev_b32 v179, 4, v250
v_lshlrev_b32 v175, 11, v178
v_lshl_add_u32 v175, v179, 3, v175
s_lshl_b32 s21, s14, 11
s_add_u32 s21, s21, 131072
v_add_u32 v176, s21, v170
s_lshl_b32 s21, s14, 10
s_add_u32 s21, s21, 131072
v_add_u32 v177, s21, v170
s_lshr_b32 s21, s13, 2
s_lshl_b32 s21, s21, 2
s_add_u32 s21, s21, 0x8412000
s_lshl_b32 s22, s18, 7
s_add_u32 s21, s22, s21
v_mov_b32 v172, s21
v_mov_b32 v173, 128
s_lshl_b32 s21, s14, 4
s_add_u32 s21, s21, s23
s_lshl_b32 s21, s21, 2
s_add_u32 s21, s21, 0x8400000
s_lshl_b32 s22, s18, 8
s_add_u32 s21, s21, s22
s_mov_b64 exec, 0xff
v_lshl_add_u32 v172, v250, 3, s21
v_mov_b32 v173, 0x100
s_mov_b64 exec, -1
s_lshl_b32 s15, s14, 15
s_lshl_b32 s21, s23, 17
s_add_u32 s15, s15, s21
s_add_u32 s15, s15, 0x3800000
s_lshl_b32 s21, s18, 18
s_add_u32 s15, s15, s21
s_lshl_b32 s21, s23, 15
s_lshl_b32 s22, s18, 16
s_add_u32 s21, s21, s22
s_and_b32 s22, s14, 1
s_lshl_b32 s16, s13, 1
s_add_u32 s16, s16, s22
s_lshl_b32 s16, s16, 5
s_add_u32 s16, s16, s21
s_lshl_b32 s17, s13, 7
s_add_u32 s17, s17, s22
s_lshl_b32 s17, s17, 3
s_add_u32 s17, s17, s21
s_add_u32 s17, s17, 0x6400000
s_waitcnt vmcnt(24)
ds_read_b64_tr_b16 a[0:1], v1 offset:0
ds_read_b64_tr_b16 a[2:3], v1 offset:1024
ds_read_b64_tr_b16 a[128:129], v1 offset:32
ds_read_b64_tr_b16 a[130:131], v1 offset:1056
ds_read_b64_tr_b16 a[4:5], v1 offset:2048
ds_read_b64_tr_b16 a[6:7], v1 offset:3072
ds_read_b64_tr_b16 a[132:133], v1 offset:2080
ds_read_b64_tr_b16 a[134:135], v1 offset:3104
ds_read_b64_tr_b16 a[8:9], v1 offset:4096
ds_read_b64_tr_b16 a[10:11], v1 offset:5120
ds_read_b64_tr_b16 a[136:137], v1 offset:4128
ds_read_b64_tr_b16 a[138:139], v1 offset:5152
ds_read_b64_tr_b16 a[12:13], v1 offset:6144
ds_read_b64_tr_b16 a[14:15], v1 offset:7168
ds_read_b64_tr_b16 a[140:141], v1 offset:6176
ds_read_b64_tr_b16 a[142:143], v1 offset:7200
s_waitcnt lgkmcnt(0)
s_add_u32 s21, s20, 0x100000
s_add_u32 m0, s19, 0
s_nop 0
buffer_load_dwordx4 v0, s[8:11], s21 offen lds
s_add_u32 s21, s20, 0x108000
s_add_u32 m0, s19, 1024
s_nop 0
buffer_load_dwordx4 v0, s[8:11], s21 offen lds
s_add_u32 s21, s20, 0x110000
s_add_u32 m0, s19, 2048
s_nop 0
buffer_load_dwordx4 v0, s[8:11], s21 offen lds
s_add_u32 s21, s20, 0x118000
s_add_u32 m0, s19, 3072
s_nop 0
buffer_load_dwordx4 v0, s[8:11], s21 offen lds
s_add_u32 s21, s20, 0x120000
s_add_u32 m0, s19, 4096
s_nop 0
buffer_load_dwordx4 v0, s[8:11], s21 offen lds
s_add_u32 s21, s20, 0x128000
s_add_u32 m0, s19, 5120
s_nop 0
buffer_load_dwordx4 v0, s[8:11], s21 offen lds
s_add_u32 s21, s20, 0x130000
s_add_u32 m0, s19, 6144
s_nop 0
buffer_load_dwordx4 v0, s[8:11], s21 offen lds
s_add_u32 s21, s20, 0x138000
s_add_u32 m0, s19, 7168
s_nop 0
buffer_load_dwordx4 v0, s[8:11], s21 offen lds
s_waitcnt vmcnt(24)
ds_read_b64_tr_b16 a[16:17], v1 offset:8192
ds_read_b64_tr_b16 a[18:19], v1 offset:9216
ds_read_b64_tr_b16 a[144:145], v1 offset:8224
ds_read_b64_tr_b16 a[146:147], v1 offset:9248
ds_read_b64_tr_b16 a[20:21], v1 offset:10240
ds_read_b64_tr_b16 a[22:23], v1 offset:11264
ds_read_b64_tr_b16 a[148:149], v1 offset:10272
ds_read_b64_tr_b16 a[150:151], v1 offset:11296
ds_read_b64_tr_b16 a[24:25], v1 offset:12288
ds_read_b64_tr_b16 a[26:27], v1 offset:13312
ds_read_b64_tr_b16 a[152:153], v1 offset:12320
ds_read_b64_tr_b16 a[154:155], v1 offset:13344
ds_read_b64_tr_b16 a[28:29], v1 offset:14336
ds_read_b64_tr_b16 a[30:31], v1 offset:15360
ds_read_b64_tr_b16 a[156:157], v1 offset:14368
ds_read_b64_tr_b16 a[158:159], v1 offset:15392
s_waitcnt lgkmcnt(0)
s_add_u32 s21, s20, 0x140000
s_add_u32 m0, s19, 8192
s_nop 0
buffer_load_dwordx4 v0, s[8:11], s21 offen lds
s_add_u32 s21, s20, 0x148000
s_add_u32 m0, s19, 9216
s_nop 0
buffer_load_dwordx4 v0, s[8:11], s21 offen lds
s_add_u32 s21, s20, 0x150000
s_add_u32 m0, s19, 10240
s_nop 0
buffer_load_dwordx4 v0, s[8:11], s21 offen lds
s_add_u32 s21, s20, 0x158000
s_add_u32 m0, s19, 11264
s_nop 0
buffer_load_dwordx4 v0, s[8:11], s21 offen lds
s_add_u32 s21, s20, 0x160000
s_add_u32 m0, s19, 12288
s_nop 0
buffer_load_dwordx4 v0, s[8:11], s21 offen lds
s_add_u32 s21, s20, 0x168000
s_add_u32 m0, s19, 13312
s_nop 0
buffer_load_dwordx4 v0, s[8:11], s21 offen lds
s_add_u32 s21, s20, 0x170000
s_add_u32 m0, s19, 14336
s_nop 0
buffer_load_dwordx4 v0, s[8:11], s21 offen lds
s_add_u32 s21, s20, 0x178000
s_add_u32 m0, s19, 15360
s_nop 0
buffer_load_dwordx4 v0, s[8:11], s21 offen lds
s_waitcnt vmcnt(24)
ds_read_b64_tr_b16 a[32:33], v1 offset:16384
ds_read_b64_tr_b16 a[34:35], v1 offset:17408
ds_read_b64_tr_b16 a[160:161], v1 offset:16416
ds_read_b64_tr_b16 a[162:163], v1 offset:17440
ds_read_b64_tr_b16 a[36:37], v1 offset:18432
ds_read_b64_tr_b16 a[38:39], v1 offset:19456
ds_read_b64_tr_b16 a[164:165], v1 offset:18464
ds_read_b64_tr_b16 a[166:167], v1 offset:19488
ds_read_b64_tr_b16 a[40:41], v1 offset:20480
ds_read_b64_tr_b16 a[42:43], v1 offset:21504
ds_read_b64_tr_b16 a[168:169], v1 offset:20512
ds_read_b64_tr_b16 a[170:171], v1 offset:21536
ds_read_b64_tr_b16 a[44:45], v1 offset:22528
ds_read_b64_tr_b16 a[46:47], v1 offset:23552
ds_read_b64_tr_b16 a[172:173], v1 offset:22560
ds_read_b64_tr_b16 a[174:175], v1 offset:23584
s_waitcnt lgkmcnt(0)
s_add_u32 s21, s20, 0x180000
s_add_u32 m0, s19, 16384
s_nop 0
buffer_load_dwordx4 v0, s[8:11], s21 offen lds
s_add_u32 s21, s20, 0x188000
s_add_u32 m0, s19, 17408
s_nop 0
buffer_load_dwordx4 v0, s[8:11], s21 offen lds
s_add_u32 s21, s20, 0x190000
s_add_u32 m0, s19, 18432
s_nop 0
buffer_load_dwordx4 v0, s[8:11], s21 offen lds
s_add_u32 s21, s20, 0x198000
s_add_u32 m0, s19, 19456
s_nop 0
buffer_load_dwordx4 v0, s[8:11], s21 offen lds
s_add_u32 s21, s20, 0x1a0000
s_add_u32 m0, s19, 20480
s_nop 0
buffer_load_dwordx4 v0, s[8:11], s21 offen lds
s_add_u32 s21, s20, 0x1a8000
s_add_u32 m0, s19, 21504
s_nop 0
buffer_load_dwordx4 v0, s[8:11], s21 offen lds
s_add_u32 s21, s20, 0x1b0000
s_add_u32 m0, s19, 22528
s_nop 0
buffer_load_dwordx4 v0, s[8:11], s21 offen lds
s_add_u32 s21, s20, 0x1b8000
s_add_u32 m0, s19, 23552
s_nop 0
buffer_load_dwordx4 v0, s[8:11], s21 offen lds
s_waitcnt vmcnt(24)
ds_read_b64_tr_b16 a[48:49], v1 offset:24576
ds_read_b64_tr_b16 a[50:51], v1 offset:25600
ds_read_b64_tr_b16 a[176:177], v1 offset:24608
ds_read_b64_tr_b16 a[178:179], v1 offset:25632
ds_read_b64_tr_b16 a[52:53], v1 offset:26624
ds_read_b64_tr_b16 a[54:55], v1 offset:27648
ds_read_b64_tr_b16 a[180:181], v1 offset:26656
ds_read_b64_tr_b16 a[182:183], v1 offset:27680
ds_read_b64_tr_b16 a[56:57], v1 offset:28672
ds_read_b64_tr_b16 a[58:59], v1 offset:29696
ds_read_b64_tr_b16 a[184:185], v1 offset:28704
ds_read_b64_tr_b16 a[186:187], v1 offset:29728
ds_read_b64_tr_b16 a[60:61], v1 offset:30720
ds_read_b64_tr_b16 a[62:63], v1 offset:31744
ds_read_b64_tr_b16 a[188:189], v1 offset:30752
ds_read_b64_tr_b16 a[190:191], v1 offset:31776
s_waitcnt lgkmcnt(0)
s_add_u32 s21, s20, 0x1c0000
s_add_u32 m0, s19, 24576
s_nop 0
buffer_load_dwordx4 v0, s[8:11], s21 offen lds
s_add_u32 s21, s20, 0x1c8000
s_add_u32 m0, s19, 25600
s_nop 0
buffer_load_dwordx4 v0, s[8:11], s21 offen lds
s_add_u32 s21, s20, 0x1d0000
s_add_u32 m0, s19, 26624
s_nop 0
buffer_load_dwordx4 v0, s[8:11], s21 offen lds
s_add_u32 s21, s20, 0x1d8000
s_add_u32 m0, s19, 27648
s_nop 0
buffer_load_dwordx4 v0, s[8:11], s21 offen lds
s_add_u32 s21, s20, 0x1e0000
s_add_u32 m0, s19, 28672
s_nop 0
buffer_load_dwordx4 v0, s[8:11], s21 offen lds
s_add_u32 s21, s20, 0x1e8000
s_add_u32 m0, s19, 29696
s_nop 0
buffer_load_dwordx4 v0, s[8:11], s21 offen lds
s_add_u32 s21, s20, 0x1f0000
s_add_u32 m0, s19, 30720
s_nop 0
buffer_load_dwordx4 v0, s[8:11], s21 offen lds
s_add_u32 s21, s20, 0x1f8000
s_add_u32 m0, s19, 31744
s_nop 0
buffer_load_dwordx4 v0, s[8:11], s21 offen lds
s_waitcnt vmcnt(24)
ds_read_b64_tr_b16 a[64:65], v1 offset:0
ds_read_b64_tr_b16 a[66:67], v1 offset:1024
ds_read_b64_tr_b16 a[192:193], v1 offset:32
ds_read_b64_tr_b16 a[194:195], v1 offset:1056
ds_read_b64_tr_b16 a[68:69], v1 offset:2048
ds_read_b64_tr_b16 a[70:71], v1 offset:3072
ds_read_b64_tr_b16 a[196:197], v1 offset:2080
ds_read_b64_tr_b16 a[198:199], v1 offset:3104
ds_read_b64_tr_b16 a[72:73], v1 offset:4096
ds_read_b64_tr_b16 a[74:75], v1 offset:5120
ds_read_b64_tr_b16 a[200:201], v1 offset:4128
ds_read_b64_tr_b16 a[202:203], v1 offset:5152
ds_read_b64_tr_b16 a[76:77], v1 offset:6144
ds_read_b64_tr_b16 a[78:79], v1 offset:7168
ds_read_b64_tr_b16 a[204:205], v1 offset:6176
ds_read_b64_tr_b16 a[206:207], v1 offset:7200
s_waitcnt lgkmcnt(0)
s_waitcnt vmcnt(16)
ds_read_b64_tr_b16 a[80:81], v1 offset:8192
ds_read_b64_tr_b16 a[82:83], v1 offset:9216
ds_read_b64_tr_b16 a[208:209], v1 offset:8224
ds_read_b64_tr_b16 a[210:211], v1 offset:9248
ds_read_b64_tr_b16 a[84:85], v1 offset:10240
ds_read_b64_tr_b16 a[86:87], v1 offset:11264
ds_read_b64_tr_b16 a[212:213], v1 offset:10272
ds_read_b64_tr_b16 a[214:215], v1 offset:11296
ds_read_b64_tr_b16 a[88:89], v1 offset:12288
ds_read_b64_tr_b16 a[90:91], v1 offset:13312
ds_read_b64_tr_b16 a[216:217], v1 offset:12320
ds_read_b64_tr_b16 a[218:219], v1 offset:13344
ds_read_b64_tr_b16 a[92:93], v1 offset:14336
ds_read_b64_tr_b16 a[94:95], v1 offset:15360
ds_read_b64_tr_b16 a[220:221], v1 offset:14368
ds_read_b64_tr_b16 a[222:223], v1 offset:15392
s_waitcnt lgkmcnt(0)
s_waitcnt vmcnt(8)
ds_read_b64_tr_b16 a[96:97], v1 offset:16384
ds_read_b64_tr_b16 a[98:99], v1 offset:17408
ds_read_b64_tr_b16 a[224:225], v1 offset:16416
ds_read_b64_tr_b16 a[226:227], v1 offset:17440
ds_read_b64_tr_b16 a[100:101], v1 offset:18432
ds_read_b64_tr_b16 a[102:103], v1 offset:19456
ds_read_b64_tr_b16 a[228:229], v1 offset:18464
ds_read_b64_tr_b16 a[230:231], v1 offset:19488
ds_read_b64_tr_b16 a[104:105], v1 offset:20480
ds_read_b64_tr_b16 a[106:107], v1 offset:21504
ds_read_b64_tr_b16 a[232:233], v1 offset:20512
ds_read_b64_tr_b16 a[234:235], v1 offset:21536
ds_read_b64_tr_b16 a[108:109], v1 offset:22528
ds_read_b64_tr_b16 a[110:111], v1 offset:23552
ds_read_b64_tr_b16 a[236:237], v1 offset:22560
ds_read_b64_tr_b16 a[238:239], v1 offset:23584
s_waitcnt lgkmcnt(0)
s_waitcnt vmcnt(0)
ds_read_b64_tr_b16 a[112:113], v1 offset:24576
ds_read_b64_tr_b16 a[114:115], v1 offset:25600
ds_read_b64_tr_b16 a[240:241], v1 offset:24608
ds_read_b64_tr_b16 a[242:243], v1 offset:25632
ds_read_b64_tr_b16 a[116:117], v1 offset:26624
ds_read_b64_tr_b16 a[118:119], v1 offset:27648
ds_read_b64_tr_b16 a[244:245], v1 offset:26656
ds_read_b64_tr_b16 a[246:247], v1 offset:27680
ds_read_b64_tr_b16 a[120:121], v1 offset:28672
ds_read_b64_tr_b16 a[122:123], v1 offset:29696
ds_read_b64_tr_b16 a[248:249], v1 offset:28704
ds_read_b64_tr_b16 a[250:251], v1 offset:29728
ds_read_b64_tr_b16 a[124:125], v1 offset:30720
ds_read_b64_tr_b16 a[126:127], v1 offset:31744
ds_read_b64_tr_b16 a[252:253], v1 offset:30752
ds_read_b64_tr_b16 a[254:255], v1 offset:31776
s_waitcnt lgkmcnt(0)
s_cmp_lt_u32 s12, 5
s_cbranch_scc1 main_kernel_o_top
v_mul_u32_u24 v178, 2, v173
v_sub_u32 v171, v172, v178
main_kernel_o_gp:
buffer_load_dword v174, v171, s[4:7], 0 offen sc1
s_waitcnt vmcnt(0)
v_cmp_eq_u32 vcc, 0, v174
s_cbranch_vccz main_kernel_o_top
s_sleep 32
s_sub_u32 s29, s29, 1
s_cbranch_scc0 main_kernel_o_gp
s_branch main_kernel_end
main_kernel_o_top:
buffer_load_dword v174, v172, s[4:7], 0 offen sc1
s_waitcnt vmcnt(0)
v_cmp_eq_u32 vcc, 0, v174
s_cbranch_vccz main_kernel_o_go
s_sleep 1
s_sub_u32 s29, s29, 1
s_cbranch_scc0 main_kernel_o_top
s_branch main_kernel_end
main_kernel_o_go:
v_add_u32 v172, v172, v173
buffer_load_dword v174, v172, s[4:7], 0 offen sc1
buffer_load_dwordx4 v[0:3], v170, s[4:7], s15 offen offset:0 sc1
buffer_load_dwordx4 v[4:7], v170, s[4:7], s15 offen offset:1024 sc1
buffer_load_dwordx4 v[8:11], v170, s[4:7], s15 offen offset:2048 sc1
buffer_load_dwordx4 v[12:15], v170, s[4:7], s15 offen offset:3072 sc1
s_add_u32 s15, s15, 4096
buffer_load_dwordx4 v[16:19], v170, s[4:7], s15 offen offset:0 sc1
buffer_load_dwordx4 v[20:23], v170, s[4:7], s15 offen offset:1024 sc1
buffer_load_dwordx4 v[24:27], v170, s[4:7], s15 offen offset:2048 sc1
buffer_load_dwordx4 v[28:31], v170, s[4:7], s15 offen offset:3072 sc1
s_add_u32 s15, s15, 4096
buffer_load_dwordx4 v[32:35], v170, s[4:7], s15 offen offset:0 sc1
buffer_load_dwordx4 v[36:39], v170, s[4:7], s15 offen offset:1024 sc1
buffer_load_dwordx4 v[40:43], v170, s[4:7], s15 offen offset:2048 sc1
buffer_load_dwordx4 v[44:47], v170, s[4:7], s15 offen offset:3072 sc1
s_add_u32 s15, s15, 4096
buffer_load_dwordx4 v[48:51], v170, s[4:7], s15 offen offset:0 sc1
buffer_load_dwordx4 v[52:55], v170, s[4:7], s15 offen offset:1024 sc1
buffer_load_dwordx4 v[56:59], v170, s[4:7], s15 offen offset:2048 sc1
buffer_load_dwordx4 v[60:63], v170, s[4:7], s15 offen offset:3072 sc1
s_add_u32 s15, s15, 4096
buffer_load_dwordx4 v[64:67], v170, s[4:7], s15 offen offset:0 sc1
buffer_load_dwordx4 v[68:71], v170, s[4:7], s15 offen offset:1024 sc1
buffer_load_dwordx4 v[72:75], v170, s[4:7], s15 offen offset:2048 sc1
buffer_load_dwordx4 v[76:79], v170, s[4:7], s15 offen offset:3072 sc1
s_add_u32 s15, s15, 4096
buffer_load_dwordx4 v[80:83], v170, s[4:7], s15 offen offset:0 sc1
buffer_load_dwordx4 v[84:87], v170, s[4:7], s15 offen offset:1024 sc1
buffer_load_dwordx4 v[88:91], v170, s[4:7], s15 offen offset:2048 sc1
buffer_load_dwordx4 v[92:95], v170, s[4:7], s15 offen offset:3072 sc1
s_add_u32 s15, s15, 4096
buffer_load_dwordx4 v[96:99], v170, s[4:7], s15 offen offset:0 sc1
buffer_load_dwordx4 v[100:103], v170, s[4:7], s15 offen offset:1024 sc1
buffer_load_dwordx4 v[104:107], v170, s[4:7], s15 offen offset:2048 sc1
buffer_load_dwordx4 v[108:111], v170, s[4:7], s15 offen offset:3072 sc1
s_add_u32 s15, s15, 4096
buffer_load_dwordx4 v[112:115], v170, s[4:7], s15 offen offset:0 sc1
buffer_load_dwordx4 v[116:119], v170, s[4:7], s15 offen offset:1024 sc1
buffer_load_dwordx4 v[120:123], v170, s[4:7], s15 offen offset:2048 sc1
buffer_load_dwordx4 v[124:127], v170, s[4:7], s15 offen offset:3072 sc1
s_add_u32 s15, s15, 233472
buffer_load_dwordx2 v[180:181], v175, s[96:99], s16 offen
buffer_load_dwordx2 v[182:183], v170, s[4:7], s17 offen sc1
s_add_u32 s17, s17, 65536
main_kernel_o_body:
s_add_u32 s18, s18, 1
s_waitcnt vmcnt(34)
v_cmp_eq_u32 vcc, 0, v174
s_cmp_gt_u32 s18, 62
s_cbranch_scc1 main_kernel_o_b0
s_cbranch_vccnz main_kernel_o_b0
v_add_u32 v172, v172, v173
buffer_load_dword v174, v172, s[4:7], 0 offen sc1
s_add_u32 s21, s16, 65536
s_waitcnt vmcnt(34)
v_mfma_f32_16x16x32_bf16 v[128:131], a[0:3], v[0:3], 0
v_mfma_f32_16x16x32_bf16 v[132:135], a[128:131], v[0:3], 0
s_waitcnt vmcnt(33)
v_mfma_f32_16x16x32_bf16 v[128:131], a[4:7], v[4:7], v[128:131]
v_mfma_f32_16x16x32_bf16 v[132:135], a[132:135], v[4:7], v[132:135]
buffer_load_dwordx4 v[0:3], v170, s[4:7], s15 offen offset:0 sc1
s_waitcnt vmcnt(33)
v_mfma_f32_16x16x32_bf16 v[128:131], a[8:11], v[8:11], v[128:131]
v_mfma_f32_16x16x32_bf16 v[132:135], a[136:139], v[8:11], v[132:135]
buffer_load_dwordx4 v[4:7], v170, s[4:7], s15 offen offset:1024 sc1
s_waitcnt vmcnt(33)
v_mfma_f32_16x16x32_bf16 v[128:131], a[12:15], v[12:15], v[128:131]
v_mfma_f32_16x16x32_bf16 v[132:135], a[140:143], v[12:15], v[132:135]
buffer_load_dwordx4 v[8:11], v170, s[4:7], s15 offen offset:2048 sc1
s_waitcnt vmcnt(33)
v_mfma_f32_16x16x32_bf16 v[128:131], a[16:19], v[16:19], v[128:131]
v_mfma_f32_16x16x32_bf16 v[132:135], a[144:147], v[16:19], v[132:135]
buffer_load_dwordx4 v[12:15], v170, s[4:7], s15 offen offset:3072 sc1
s_add_u32 s15, s15, 4096
s_waitcnt vmcnt(33)
v_mfma_f32_16x16x32_bf16 v[128:131], a[20:23], v[20:23], v[128:131]
v_mfma_f32_16x16x32_bf16 v[132:135], a[148:151], v[20:23], v[132:135]
buffer_load_dwordx4 v[16:19], v170, s[4:7], s15 offen offset:0 sc1
s_waitcnt vmcnt(33)
v_mfma_f32_16x16x32_bf16 v[128:131], a[24:27], v[24:27], v[128:131]
v_mfma_f32_16x16x32_bf16 v[132:135], a[152:155], v[24:27], v[132:135]
buffer_load_dwordx4 v[20:23], v170, s[4:7], s15 offen offset:1024 sc1
s_waitcnt vmcnt(33)
v_mfma_f32_16x16x32_bf16 v[128:131], a[28:31], v[28:31], v[128:131]
v_mfma_f32_16x16x32_bf16 v[132:135], a[156:159], v[28:31], v[132:135]
buffer_load_dwordx4 v[24:27], v170, s[4:7], s15 offen offset:2048 sc1
s_waitcnt vmcnt(33)
v_mfma_f32_16x16x32_bf16 v[128:131], a[32:35], v[32:35], v[128:131]
v_mfma_f32_16x16x32_bf16 v[132:135], a[160:163], v[32:35], v[132:135]
buffer_load_dwordx4 v[28:31], v170, s[4:7], s15 offen offset:3072 sc1
s_add_u32 s15, s15, 4096
s_waitcnt vmcnt(33)
v_mfma_f32_16x16x32_bf16 v[128:131], a[36:39], v[36:39], v[128:131]
v_mfma_f32_16x16x32_bf16 v[132:135], a[164:167], v[36:39], v[132:135]
buffer_load_dwordx4 v[32:35], v170, s[4:7], s15 offen offset:0 sc1
s_waitcnt vmcnt(33)
v_mfma_f32_16x16x32_bf16 v[128:131], a[40:43], v[40:43], v[128:131]
v_mfma_f32_16x16x32_bf16 v[132:135], a[168:171], v[40:43], v[132:135]
buffer_load_dwordx4 v[36:39], v170, s[4:7], s15 offen offset:1024 sc1
s_waitcnt vmcnt(33)
v_mfma_f32_16x16x32_bf16 v[128:131], a[44:47], v[44:47], v[128:131]
v_mfma_f32_16x16x32_bf16 v[132:135], a[172:175], v[44:47], v[132:135]
buffer_load_dwordx4 v[40:43], v170, s[4:7], s15 offen offset:2048 sc1
s_waitcnt vmcnt(33)
v_mfma_f32_16x16x32_bf16 v[128:131], a[48:51], v[48:51], v[128:131]
v_mfma_f32_16x16x32_bf16 v[132:135], a[176:179], v[48:51], v[132:135]
buffer_load_dwordx4 v[44:47], v170, s[4:7], s15 offen offset:3072 sc1
s_add_u32 s15, s15, 4096
s_waitcnt vmcnt(33)
v_mfma_f32_16x16x32_bf16 v[128:131], a[52:55], v[52:55], v[128:131]
v_mfma_f32_16x16x32_bf16 v[132:135], a[180:183], v[52:55], v[132:135]
buffer_load_dwordx4 v[48:51], v170, s[4:7], s15 offen offset:0 sc1
s_waitcnt vmcnt(33)
v_mfma_f32_16x16x32_bf16 v[128:131], a[56:59], v[56:59], v[128:131]
v_mfma_f32_16x16x32_bf16 v[132:135], a[184:187], v[56:59], v[132:135]
buffer_load_dwordx4 v[52:55], v170, s[4:7], s15 offen offset:1024 sc1
s_waitcnt vmcnt(33)
v_mfma_f32_16x16x32_bf16 v[128:131], a[60:63], v[60:63], v[128:131]
v_mfma_f32_16x16x32_bf16 v[132:135], a[188:191], v[60:63], v[132:135]
buffer_load_dwordx4 v[56:59], v170, s[4:7], s15 offen offset:2048 sc1
s_waitcnt vmcnt(33)
v_mfma_f32_16x16x32_bf16 v[128:131], a[64:67], v[64:67], v[128:131]
v_mfma_f32_16x16x32_bf16 v[132:135], a[192:195], v[64:67], v[132:135]
buffer_load_dwordx4 v[60:63], v170, s[4:7], s15 offen offset:3072 sc1
s_add_u32 s15, s15, 4096
s_waitcnt vmcnt(33)
v_mfma_f32_16x16x32_bf16 v[128:131], a[68:71], v[68:71], v[128:131]
v_mfma_f32_16x16x32_bf16 v[132:135], a[196:199], v[68:71], v[132:135]
buffer_load_dwordx4 v[64:67], v170, s[4:7], s15 offen offset:0 sc1
s_waitcnt vmcnt(33)
v_mfma_f32_16x16x32_bf16 v[128:131], a[72:75], v[72:75], v[128:131]
v_mfma_f32_16x16x32_bf16 v[132:135], a[200:203], v[72:75], v[132:135]
buffer_load_dwordx4 v[68:71], v170, s[4:7], s15 offen offset:1024 sc1
s_waitcnt vmcnt(33)
v_mfma_f32_16x16x32_bf16 v[128:131], a[76:79], v[76:79], v[128:131]
v_mfma_f32_16x16x32_bf16 v[132:135], a[204:207], v[76:79], v[132:135]
buffer_load_dwordx4 v[72:75], v170, s[4:7], s15 offen offset:2048 sc1
s_waitcnt vmcnt(33)
v_mfma_f32_16x16x32_bf16 v[128:131], a[80:83], v[80:83], v[128:131]
v_mfma_f32_16x16x32_bf16 v[132:135], a[208:211], v[80:83], v[132:135]
buffer_load_dwordx4 v[76:79], v170, s[4:7], s15 offen offset:3072 sc1
s_add_u32 s15, s15, 4096
s_waitcnt vmcnt(33)
v_mfma_f32_16x16x32_bf16 v[128:131], a[84:87], v[84:87], v[128:131]
v_mfma_f32_16x16x32_bf16 v[132:135], a[212:215], v[84:87], v[132:135]
buffer_load_dwordx4 v[80:83], v170, s[4:7], s15 offen offset:0 sc1
s_waitcnt vmcnt(33)
v_mfma_f32_16x16x32_bf16 v[128:131], a[88:91], v[88:91], v[128:131]
v_mfma_f32_16x16x32_bf16 v[132:135], a[216:219], v[88:91], v[132:135]
buffer_load_dwordx4 v[84:87], v170, s[4:7], s15 offen offset:1024 sc1
s_waitcnt vmcnt(33)
v_mfma_f32_16x16x32_bf16 v[128:131], a[92:95], v[92:95], v[128:131]
v_mfma_f32_16x16x32_bf16 v[132:135], a[220:223], v[92:95], v[132:135]
buffer_load_dwordx4 v[88:91], v170, s[4:7], s15 offen offset:2048 sc1
s_waitcnt vmcnt(33)
v_mfma_f32_16x16x32_bf16 v[128:131], a[96:99], v[96:99], v[128:131]
v_mfma_f32_16x16x32_bf16 v[132:135], a[224:227], v[96:99], v[132:135]
buffer_load_dwordx4 v[92:95], v170, s[4:7], s15 offen offset:3072 sc1
s_add_u32 s15, s15, 4096
s_waitcnt vmcnt(33)
v_mfma_f32_16x16x32_bf16 v[128:131], a[100:103], v[100:103], v[128:131]
v_mfma_f32_16x16x32_bf16 v[132:135], a[228:231], v[100:103], v[132:135]
buffer_load_dwordx4 v[96:99], v170, s[4:7], s15 offen offset:0 sc1
s_waitcnt vmcnt(33)
v_mfma_f32_16x16x32_bf16 v[128:131], a[104:107], v[104:107], v[128:131]
v_mfma_f32_16x16x32_bf16 v[132:135], a[232:235], v[104:107], v[132:135]
buffer_load_dwordx4 v[100:103], v170, s[4:7], s15 offen offset:1024 sc1
s_waitcnt vmcnt(33)
v_mfma_f32_16x16x32_bf16 v[128:131], a[108:111], v[108:111], v[128:131]
v_mfma_f32_16x16x32_bf16 v[132:135], a[236:239], v[108:111], v[132:135]
buffer_load_dwordx4 v[104:107], v170, s[4:7], s15 offen offset:2048 sc1
s_waitcnt vmcnt(33)
v_mfma_f32_16x16x32_bf16 v[128:131], a[112:115], v[112:115], v[128:131]
v_mfma_f32_16x16x32_bf16 v[132:135], a[240:243], v[112:115], v[132:135]
buffer_load_dwordx4 v[108:111], v170, s[4:7], s15 offen offset:3072 sc1
s_add_u32 s15, s15, 4096
s_waitcnt vmcnt(33)
v_mfma_f32_16x16x32_bf16 v[128:131], a[116:119], v[116:119], v[128:131]
v_mfma_f32_16x16x32_bf16 v[132:135], a[244:247], v[116:119], v[132:135]
buffer_load_dwordx4 v[112:115], v170, s[4:7], s15 offen offset:0 sc1
s_waitcnt vmcnt(33)
v_mfma_f32_16x16x32_bf16 v[128:131], a[120:123], v[120:123], v[128:131]
v_mfma_f32_16x16x32_bf16 v[132:135], a[248:251], v[120:123], v[132:135]
buffer_load_dwordx4 v[116:119], v170, s[4:7], s15 offen offset:1024 sc1
s_waitcnt vmcnt(33)
v_mfma_f32_16x16x32_bf16 v[128:131], a[124:127], v[124:127], v[128:131]
v_mfma_f32_16x16x32_bf16 v[132:135], a[252:255], v[124:127], v[132:135]
buffer_load_dwordx4 v[120:123], v170, s[4:7], s15 offen offset:2048 sc1
s_waitcnt vmcnt(32)
v_lshlrev_b32 v164, 16, v180
v_and_b32 v165, 0xffff0000, v180
v_lshlrev_b32 v166, 16, v181
v_and_b32 v167, 0xffff0000, v181
v_lshlrev_b32 v160, 16, v182
v_and_b32 v161, 0xffff0000, v182
v_lshlrev_b32 v162, 16, v183
v_and_b32 v163, 0xffff0000, v183
buffer_load_dwordx4 v[124:127], v170, s[4:7], s15 offen offset:3072 sc1
s_add_u32 s15, s15, 233472
buffer_load_dwordx2 v[180:181], v175, s[96:99], s21 offen
buffer_load_dwordx2 v[182:183], v170, s[4:7], s17 offen sc1
s_add_u32 s17, s17, 65536
s_cmp_ge_u32 s14, 2
ds_write_b128 v176, v[128:131] offset:0
ds_write_b128 v176, v[132:135] offset:1024
v_xor_b32 v176, 0x4000, v176
s_waitcnt lgkmcnt(0)
s_barrier
s_cbranch_scc1 main_kernel_o_nx1
ds_read_b128 v[144:147], v177 offset:0
ds_read_b128 v[148:151], v177 offset:2048
ds_read_b128 v[152:155], v177 offset:4096
ds_read_b128 v[156:159], v177 offset:6144
v_xor_b32 v177, 0x4000, v177
s_waitcnt lgkmcnt(2)
v_pk_add_f32 v[144:145], v[144:145], v[148:149]
v_pk_add_f32 v[146:147], v[146:147], v[150:151]
s_waitcnt lgkmcnt(0)
v_pk_add_f32 v[152:153], v[152:153], v[156:157]
v_pk_add_f32 v[154:155], v[154:155], v[158:159]
v_pk_add_f32 v[144:145], v[144:145], v[152:153]
v_pk_add_f32 v[146:147], v[146:147], v[154:155]
v_pk_fma_f32 v[144:145], v[144:145], v[160:161], v[164:165]
v_pk_fma_f32 v[146:147], v[146:147], v[162:163], v[166:167]
v_cvt_pk_bf16_f32 v148, v144, v145
v_cvt_pk_bf16_f32 v149, v146, v147
buffer_store_dwordx2 v[148:149], v175, s[92:95], s16 offen
main_kernel_o_nx1:
s_add_u32 s16, s16, 65536
s_branch main_kernel_o_body
main_kernel_o_b0:
s_waitcnt vmcnt(33)
v_mfma_f32_16x16x32_bf16 v[128:131], a[0:3], v[0:3], 0
v_mfma_f32_16x16x32_bf16 v[132:135], a[128:131], v[0:3], 0
s_waitcnt vmcnt(32)
v_mfma_f32_16x16x32_bf16 v[128:131], a[4:7], v[4:7], v[128:131]
v_mfma_f32_16x16x32_bf16 v[132:135], a[132:135], v[4:7], v[132:135]
s_waitcnt vmcnt(31)
v_mfma_f32_16x16x32_bf16 v[128:131], a[8:11], v[8:11], v[128:131]
v_mfma_f32_16x16x32_bf16 v[132:135], a[136:139], v[8:11], v[132:135]
s_waitcnt vmcnt(30)
v_mfma_f32_16x16x32_bf16 v[128:131], a[12:15], v[12:15], v[128:131]
v_mfma_f32_16x16x32_bf16 v[132:135], a[140:143], v[12:15], v[132:135]
s_waitcnt vmcnt(29)
v_mfma_f32_16x16x32_bf16 v[128:131], a[16:19], v[16:19], v[128:131]
v_mfma_f32_16x16x32_bf16 v[132:135], a[144:147], v[16:19], v[132:135]
s_waitcnt vmcnt(28)
v_mfma_f32_16x16x32_bf16 v[128:131], a[20:23], v[20:23], v[128:131]
v_mfma_f32_16x16x32_bf16 v[132:135], a[148:151], v[20:23], v[132:135]
s_waitcnt vmcnt(27)
v_mfma_f32_16x16x32_bf16 v[128:131], a[24:27], v[24:27], v[128:131]
v_mfma_f32_16x16x32_bf16 v[132:135], a[152:155], v[24:27], v[132:135]
s_waitcnt vmcnt(26)
v_mfma_f32_16x16x32_bf16 v[128:131], a[28:31], v[28:31], v[128:131]
v_mfma_f32_16x16x32_bf16 v[132:135], a[156:159], v[28:31], v[132:135]
s_waitcnt vmcnt(25)
v_mfma_f32_16x16x32_bf16 v[128:131], a[32:35], v[32:35], v[128:131]
v_mfma_f32_16x16x32_bf16 v[132:135], a[160:163], v[32:35], v[132:135]
s_waitcnt vmcnt(24)
v_mfma_f32_16x16x32_bf16 v[128:131], a[36:39], v[36:39], v[128:131]
v_mfma_f32_16x16x32_bf16 v[132:135], a[164:167], v[36:39], v[132:135]
s_waitcnt vmcnt(23)
v_mfma_f32_16x16x32_bf16 v[128:131], a[40:43], v[40:43], v[128:131]
v_mfma_f32_16x16x32_bf16 v[132:135], a[168:171], v[40:43], v[132:135]
s_waitcnt vmcnt(22)
v_mfma_f32_16x16x32_bf16 v[128:131], a[44:47], v[44:47], v[128:131]
v_mfma_f32_16x16x32_bf16 v[132:135], a[172:175], v[44:47], v[132:135]
s_waitcnt vmcnt(21)
v_mfma_f32_16x16x32_bf16 v[128:131], a[48:51], v[48:51], v[128:131]
v_mfma_f32_16x16x32_bf16 v[132:135], a[176:179], v[48:51], v[132:135]
s_waitcnt vmcnt(20)
v_mfma_f32_16x16x32_bf16 v[128:131], a[52:55], v[52:55], v[128:131]
v_mfma_f32_16x16x32_bf16 v[132:135], a[180:183], v[52:55], v[132:135]
s_waitcnt vmcnt(19)
v_mfma_f32_16x16x32_bf16 v[128:131], a[56:59], v[56:59], v[128:131]
v_mfma_f32_16x16x32_bf16 v[132:135], a[184:187], v[56:59], v[132:135]
s_waitcnt vmcnt(18)
v_mfma_f32_16x16x32_bf16 v[128:131], a[60:63], v[60:63], v[128:131]
v_mfma_f32_16x16x32_bf16 v[132:135], a[188:191], v[60:63], v[132:135]
s_waitcnt vmcnt(17)
v_mfma_f32_16x16x32_bf16 v[128:131], a[64:67], v[64:67], v[128:131]
v_mfma_f32_16x16x32_bf16 v[132:135], a[192:195], v[64:67], v[132:135]
s_waitcnt vmcnt(16)
v_mfma_f32_16x16x32_bf16 v[128:131], a[68:71], v[68:71], v[128:131]
v_mfma_f32_16x16x32_bf16 v[132:135], a[196:199], v[68:71], v[132:135]
s_waitcnt vmcnt(15)
v_mfma_f32_16x16x32_bf16 v[128:131], a[72:75], v[72:75], v[128:131]
v_mfma_f32_16x16x32_bf16 v[132:135], a[200:203], v[72:75], v[132:135]
s_waitcnt vmcnt(14)
v_mfma_f32_16x16x32_bf16 v[128:131], a[76:79], v[76:79], v[128:131]
v_mfma_f32_16x16x32_bf16 v[132:135], a[204:207], v[76:79], v[132:135]
s_waitcnt vmcnt(13)
v_mfma_f32_16x16x32_bf16 v[128:131], a[80:83], v[80:83], v[128:131]
v_mfma_f32_16x16x32_bf16 v[132:135], a[208:211], v[80:83], v[132:135]
s_waitcnt vmcnt(12)
v_mfma_f32_16x16x32_bf16 v[128:131], a[84:87], v[84:87], v[128:131]
v_mfma_f32_16x16x32_bf16 v[132:135], a[212:215], v[84:87], v[132:135]
s_waitcnt vmcnt(11)
v_mfma_f32_16x16x32_bf16 v[128:131], a[88:91], v[88:91], v[128:131]
v_mfma_f32_16x16x32_bf16 v[132:135], a[216:219], v[88:91], v[132:135]
s_waitcnt vmcnt(10)
v_mfma_f32_16x16x32_bf16 v[128:131], a[92:95], v[92:95], v[128:131]
v_mfma_f32_16x16x32_bf16 v[132:135], a[220:223], v[92:95], v[132:135]
s_waitcnt vmcnt(9)
v_mfma_f32_16x16x32_bf16 v[128:131], a[96:99], v[96:99], v[128:131]
v_mfma_f32_16x16x32_bf16 v[132:135], a[224:227], v[96:99], v[132:135]
s_waitcnt vmcnt(8)
v_mfma_f32_16x16x32_bf16 v[128:131], a[100:103], v[100:103], v[128:131]
v_mfma_f32_16x16x32_bf16 v[132:135], a[228:231], v[100:103], v[132:135]
s_waitcnt vmcnt(7)
v_mfma_f32_16x16x32_bf16 v[128:131], a[104:107], v[104:107], v[128:131]
v_mfma_f32_16x16x32_bf16 v[132:135], a[232:235], v[104:107], v[132:135]
s_waitcnt vmcnt(6)
v_mfma_f32_16x16x32_bf16 v[128:131], a[108:111], v[108:111], v[128:131]
v_mfma_f32_16x16x32_bf16 v[132:135], a[236:239], v[108:111], v[132:135]
s_waitcnt vmcnt(5)
v_mfma_f32_16x16x32_bf16 v[128:131], a[112:115], v[112:115], v[128:131]
v_mfma_f32_16x16x32_bf16 v[132:135], a[240:243], v[112:115], v[132:135]
s_waitcnt vmcnt(4)
v_mfma_f32_16x16x32_bf16 v[128:131], a[116:119], v[116:119], v[128:131]
v_mfma_f32_16x16x32_bf16 v[132:135], a[244:247], v[116:119], v[132:135]
s_waitcnt vmcnt(3)
v_mfma_f32_16x16x32_bf16 v[128:131], a[120:123], v[120:123], v[128:131]
v_mfma_f32_16x16x32_bf16 v[132:135], a[248:251], v[120:123], v[132:135]
s_waitcnt vmcnt(2)
v_mfma_f32_16x16x32_bf16 v[128:131], a[124:127], v[124:127], v[128:131]
v_mfma_f32_16x16x32_bf16 v[132:135], a[252:255], v[124:127], v[132:135]
s_waitcnt vmcnt(0)
v_lshlrev_b32 v164, 16, v180
v_and_b32 v165, 0xffff0000, v180
v_lshlrev_b32 v166, 16, v181
v_and_b32 v167, 0xffff0000, v181
v_lshlrev_b32 v160, 16, v182
v_and_b32 v161, 0xffff0000, v182
v_lshlrev_b32 v162, 16, v183
v_and_b32 v163, 0xffff0000, v183
s_cmp_ge_u32 s14, 2
s_nop 0
ds_write_b128 v176, v[128:131] offset:0
ds_write_b128 v176, v[132:135] offset:1024
v_xor_b32 v176, 0x4000, v176
s_waitcnt lgkmcnt(0)
s_barrier
s_cbranch_scc1 main_kernel_o_nx0
ds_read_b128 v[144:147], v177 offset:0
ds_read_b128 v[148:151], v177 offset:2048
ds_read_b128 v[152:155], v177 offset:4096
ds_read_b128 v[156:159], v177 offset:6144
v_xor_b32 v177, 0x4000, v177
s_waitcnt lgkmcnt(2)
v_pk_add_f32 v[144:145], v[144:145], v[148:149]
v_pk_add_f32 v[146:147], v[146:147], v[150:151]
s_waitcnt lgkmcnt(0)
v_pk_add_f32 v[152:153], v[152:153], v[156:157]
v_pk_add_f32 v[154:155], v[154:155], v[158:159]
v_pk_add_f32 v[144:145], v[144:145], v[152:153]
v_pk_add_f32 v[146:147], v[146:147], v[154:155]
v_pk_fma_f32 v[144:145], v[144:145], v[160:161], v[164:165]
v_pk_fma_f32 v[146:147], v[146:147], v[162:163], v[166:167]
v_cvt_pk_bf16_f32 v148, v144, v145
v_cvt_pk_bf16_f32 v149, v146, v147
buffer_store_dwordx2 v[148:149], v175, s[92:95], s16 offen
main_kernel_o_nx0:
s_add_u32 s16, s16, 65536
s_cmp_le_u32 s18, 62
s_cbranch_scc1 main_kernel_o_top
v_add_u32 v172, v172, v173
s_add_u32 s17, s17, 65536
s_add_u32 s16, s16, 65536
s_add_u32 s15, s15, 262144
s_add_u32 s18, s18, 1
s_cmp_lt_u32 s18, 64
s_cbranch_scc1 main_kernel_o_top
s_branch main_kernel_end
main_kernel_end2:
s_endpgm
main_kernel_worker:
v_lshlrev_b32 v251, 4, v250
v_mov_b32 v240, 0xc0135761
v_mov_b32 v241, 0xc0135761
v_mov_b32 v242, 0xbdd2d3e8
v_mov_b32 v243, 0xbdd2d3e8
v_mov_b32 v244, 0x3f800000
v_mov_b32 v245, 0x3f800000
v_mov_b32 v246, 0xbfb8aa3b
v_mov_b32 v247, 0xbfb8aa3b
s_lshr_b32 s37, s14, 1
s_and_b32 s38, s14, 1
v_mov_b32 v252, 0
v_mov_b32 v224, 0
v_mov_b32 v225, 0
v_mov_b32 v226, 0
v_mov_b32 v227, 0
v_mov_b32 v228, 0
v_mov_b32 v229, 0
v_mov_b32 v230, 0
v_mov_b32 v231, 0
v_mov_b32 v232, 0
v_mov_b32 v233, 0
v_mov_b32 v234, 0
v_mov_b32 v235, 0
v_mov_b32 v249, 0
v_mov_b32 v248, 0
v_mov_b32 v128, 0
v_mov_b32 v129, 0
v_mov_b32 v130, 0
v_mov_b32 v131, 0
v_mov_b32 v132, 0
v_mov_b32 v133, 0
v_mov_b32 v134, 0
v_mov_b32 v135, 0
v_mov_b32 v136, 0
v_mov_b32 v137, 0
v_mov_b32 v138, 0
v_mov_b32 v139, 0
v_mov_b32 v140, 0
v_mov_b32 v141, 0
v_mov_b32 v142, 0
v_mov_b32 v143, 0
v_mov_b32 v144, 0
v_mov_b32 v145, 0
v_mov_b32 v146, 0
v_mov_b32 v147, 0
v_mov_b32 v148, 0
v_mov_b32 v149, 0
v_mov_b32 v150, 0
v_mov_b32 v151, 0
v_mov_b32 v152, 0
v_mov_b32 v153, 0
v_mov_b32 v154, 0
s_cmp_eq_u32 s14, 0
s_cselect_b64 s[100:101], -1, 0
s_mov_b32 s21, 0
s_mov_b32 s22, 0
s_mov_b32 s26, 0
s_mov_b32 s0, 0
s_mov_b32 s1, 0
s_mov_b32 s2, 0
s_mov_b32 s3, 0
s_mov_b32 s59, 0
s_mov_b32 s60, 0
s_mov_b32 s39, 0
s_mov_b32 s8, s40
s_and_b32 s9, s41, 0xffff
s_mov_b32 s10, 0x0
s_mov_b32 s11, 0x20000
s_cmp_lg_u32 s14, 0
s_cbranch_scc1 main_kernel_w_bar
main_kernel_w_selq:
s_lshl_b32 s32, s27, 8
s_add_u32 s32, s32, 0x841e000
s_mov_b64 exec, 1
v_mov_b32 v249, 1
buffer_atomic_add v249, off, s[4:7], s32 sc0 sc1
s_mov_b64 exec, -1
v_mov_b32 v230, 0x7fff
s_cmp_lg_u32 s27, 0
s_cbranch_scc1 main_kernel_w_q1
s_mov_b32 s32, 0x45800
v_writelane_b32 v230, s32, 0
s_mov_b32 s32, 0x6580e
v_writelane_b32 v230, s32, 1
s_mov_b32 s32, 0x4808881c
v_writelane_b32 v230, s32, 2
s_mov_b32 s32, 0x4b08902c
v_writelane_b32 v230, s32, 3
s_mov_b32 s32, 0x4600803c
v_writelane_b32 v230, s32, 4
s_mov_b32 s32, 0x4b08804c
v_writelane_b32 v230, s32, 5
s_mov_b32 s32, 0x4404805c
v_writelane_b32 v230, s32, 6
s_mov_b32 s32, 0x41c206c
v_writelane_b32 v230, s32, 7
s_mov_b32 s32, 0x4908807c
v_writelane_b32 v230, s32, 8
s_mov_b32 s32, 0x4a00b08c
v_writelane_b32 v230, s32, 9
s_mov_b32 s32, 0x4ac0b098
v_writelane_b32 v230, s32, 10
s_mov_b32 s32, 0x4ad0b0a4
v_writelane_b32 v230, s32, 11
s_mov_b32 s32, 0x4a1080b0
v_writelane_b32 v230, s32, 12
s_mov_b32 s32, 0x40838c0
v_writelane_b32 v230, s32, 13
s_mov_b32 s32, 0x40038d0
v_writelane_b32 v230, s32, 14
s_mov_b32 s32, 0x78e0
v_writelane_b32 v230, s32, 15
s_branch main_kernel_w_qe
main_kernel_w_q1:
s_cmp_lg_u32 s27, 1
s_cbranch_scc1 main_kernel_w_q2
s_mov_b32 s32, 0x25000
v_writelane_b32 v230, s32, 0
s_mov_b32 s32, 0x4045004
v_writelane_b32 v230, s32, 1
s_mov_b32 s32, 0x4b08880c
v_writelane_b32 v230, s32, 2
s_mov_b32 s32, 0x4a08901c
v_writelane_b32 v230, s32, 3
s_mov_b32 s32, 0x400202c
v_writelane_b32 v230, s32, 4
s_mov_b32 s32, 0x418203c
v_writelane_b32 v230, s32, 5
s_mov_b32 s32, 0x4818904c
v_writelane_b32 v230, s32, 6
s_mov_b32 s32, 0x4918885c
v_writelane_b32 v230, s32, 7
s_mov_b32 s32, 0x4818b06c
v_writelane_b32 v230, s32, 8
s_mov_b32 s32, 0x4b18907c
v_writelane_b32 v230, s32, 9
s_mov_b32 s32, 0x4818808c
v_writelane_b32 v230, s32, 10
s_mov_b32 s32, 0x10409c
v_writelane_b32 v230, s32, 11
s_mov_b32 s32, 0x78a4
v_writelane_b32 v230, s32, 12
s_branch main_kernel_w_qe
main_kernel_w_q2:
s_cmp_lg_u32 s27, 2
s_cbranch_scc1 main_kernel_w_q3
s_mov_b32 s32, 0x800
v_writelane_b32 v230, s32, 0
s_mov_b32 s32, 0x1008
v_writelane_b32 v230, s32, 1
s_mov_b32 s32, 0x44028810
v_writelane_b32 v230, s32, 2
s_mov_b32 s32, 0x44029018
v_writelane_b32 v230, s32, 3
s_mov_b32 s32, 0x48089820
v_writelane_b32 v230, s32, 4
s_mov_b32 s32, 0x48189830
v_writelane_b32 v230, s32, 5
s_mov_b32 s32, 0x4b109040
v_writelane_b32 v230, s32, 6
s_mov_b32 s32, 0x48108050
v_writelane_b32 v230, s32, 7
s_mov_b32 s32, 0x48108860
v_writelane_b32 v230, s32, 8
s_mov_b32 s32, 0x4142070
v_writelane_b32 v230, s32, 9
s_mov_b32 s32, 0x4b108880
v_writelane_b32 v230, s32, 10
s_mov_b32 s32, 0x4b188890
v_writelane_b32 v230, s32, 11
s_mov_b32 s32, 0x4808b0a0
v_writelane_b32 v230, s32, 12
s_mov_b32 s32, 0x4810b0b0
v_writelane_b32 v230, s32, 13
s_mov_b32 s32, 0x40438c0
v_writelane_b32 v230, s32, 14
s_mov_b32 s32, 0x40c38d0
v_writelane_b32 v230, s32, 15
s_mov_b32 s32, 0x78e0
v_writelane_b32 v230, s32, 16
s_branch main_kernel_w_qe
main_kernel_w_q3:
s_cmp_lg_u32 s27, 3
s_cbranch_scc1 main_kernel_w_q4
s_mov_b32 s32, 0x1000800
v_writelane_b32 v230, s32, 0
s_mov_b32 s32, 0x1001008
v_writelane_b32 v230, s32, 1
s_mov_b32 s32, 0x45028810
v_writelane_b32 v230, s32, 2
s_mov_b32 s32, 0x45029018
v_writelane_b32 v230, s32, 3
s_mov_b32 s32, 0x40069020
v_writelane_b32 v230, s32, 4
s_mov_b32 s32, 0x42069028
v_writelane_b32 v230, s32, 5
s_mov_b32 s32, 0x8085030
v_writelane_b32 v230, s32, 6
s_mov_b32 s32, 0x48089040
v_writelane_b32 v230, s32, 7
s_mov_b32 s32, 0x49089050
v_writelane_b32 v230, s32, 8
s_mov_b32 s32, 0x4042060
v_writelane_b32 v230, s32, 9
s_mov_b32 s32, 0x4a088070
v_writelane_b32 v230, s32, 10
s_mov_b32 s32, 0x46048080
v_writelane_b32 v230, s32, 11
s_mov_b32 s32, 0x8105090
v_writelane_b32 v230, s32, 12
s_mov_b32 s32, 0x81828a0
v_writelane_b32 v230, s32, 13
s_mov_b32 s32, 0x4900b0b0
v_writelane_b32 v230, s32, 14
s_mov_b32 s32, 0x4b1080c0
v_writelane_b32 v230, s32, 15
s_mov_b32 s32, 0x4910b0d0
v_writelane_b32 v230, s32, 16
s_mov_b32 s32, 0x4918b0e0
v_writelane_b32 v230, s32, 17
s_mov_b32 s32, 0x41438f0
v_writelane_b32 v230, s32, 18
s_mov_b32 s32, 0x4103900
v_writelane_b32 v230, s32, 19
s_mov_b32 s32, 0x44110
v_writelane_b32 v230, s32, 20
s_mov_b32 s32, 0x84118
v_writelane_b32 v230, s32, 21
s_mov_b32 s32, 0x64120
v_writelane_b32 v230, s32, 22
s_mov_b32 s32, 0xe4128
v_writelane_b32 v230, s32, 23
s_mov_b32 s32, 0x7930
v_writelane_b32 v230, s32, 24
s_branch main_kernel_w_qe
main_kernel_w_q4:
s_cmp_lg_u32 s27, 4
s_cbranch_scc1 main_kernel_w_q5
s_mov_b32 s32, 0x2000800
v_writelane_b32 v230, s32, 0
s_mov_b32 s32, 0x2001008
v_writelane_b32 v230, s32, 1
s_mov_b32 s32, 0x46028810
v_writelane_b32 v230, s32, 2
s_mov_b32 s32, 0x46029018
v_writelane_b32 v230, s32, 3
s_mov_b32 s32, 0x40068820
v_writelane_b32 v230, s32, 4
s_mov_b32 s32, 0x42068828
v_writelane_b32 v230, s32, 5
s_mov_b32 s32, 0x4a088830
v_writelane_b32 v230, s32, 6
s_mov_b32 s32, 0x48088040
v_writelane_b32 v230, s32, 7
s_mov_b32 s32, 0x44008050
v_writelane_b32 v230, s32, 8
s_mov_b32 s32, 0x49108860
v_writelane_b32 v230, s32, 9
s_mov_b32 s32, 0x8002870
v_writelane_b32 v230, s32, 10
s_mov_b32 s32, 0x4a188880
v_writelane_b32 v230, s32, 11
s_mov_b32 s32, 0x4a108890
v_writelane_b32 v230, s32, 12
s_mov_b32 s32, 0x4a08b0a0
v_writelane_b32 v230, s32, 13
s_mov_b32 s32, 0x4ac8b0ac
v_writelane_b32 v230, s32, 14
s_mov_b32 s32, 0x4a18b0b8
v_writelane_b32 v230, s32, 15
s_mov_b32 s32, 0x4ad8b0c4
v_writelane_b32 v230, s32, 16
s_mov_b32 s32, 0x491080d0
v_writelane_b32 v230, s32, 17
s_mov_b32 s32, 0x491880e0
v_writelane_b32 v230, s32, 18
s_mov_b32 s32, 0x41838f0
v_writelane_b32 v230, s32, 19
s_mov_b32 s32, 0x41c3900
v_writelane_b32 v230, s32, 20
s_mov_b32 s32, 0x124110
v_writelane_b32 v230, s32, 21
s_mov_b32 s32, 0x7918
v_writelane_b32 v230, s32, 22
s_branch main_kernel_w_qe
main_kernel_w_q5:
s_cmp_lg_u32 s27, 5
s_cbranch_scc1 main_kernel_w_q6
s_mov_b32 s32, 0x3000800
v_writelane_b32 v230, s32, 0
s_mov_b32 s32, 0x3001008
v_writelane_b32 v230, s32, 1
s_mov_b32 s32, 0x47028810
v_writelane_b32 v230, s32, 2
s_mov_b32 s32, 0x47029018
v_writelane_b32 v230, s32, 3
s_mov_b32 s32, 0x48009820
v_writelane_b32 v230, s32, 4
s_mov_b32 s32, 0x48109830
v_writelane_b32 v230, s32, 5
s_mov_b32 s32, 0x49109040
v_writelane_b32 v230, s32, 6
s_mov_b32 s32, 0x4a109050
v_writelane_b32 v230, s32, 7
s_mov_b32 s32, 0x4082060
v_writelane_b32 v230, s32, 8
s_mov_b32 s32, 0x48109070
v_writelane_b32 v230, s32, 9
s_mov_b32 s32, 0x8082880
v_writelane_b32 v230, s32, 10
s_mov_b32 s32, 0x4800b090
v_writelane_b32 v230, s32, 11
s_mov_b32 s32, 0x81028a0
v_writelane_b32 v230, s32, 12
s_mov_b32 s32, 0x4908b0b0
v_writelane_b32 v230, s32, 13
s_mov_b32 s32, 0x4a10b0c0
v_writelane_b32 v230, s32, 14
s_mov_b32 s32, 0x491890cc
v_writelane_b32 v230, s32, 15
s_mov_b32 s32, 0x81850dc
v_writelane_b32 v230, s32, 16
s_mov_b32 s32, 0x481888ec
v_writelane_b32 v230, s32, 17
s_mov_b32 s32, 0x4a1890fc
v_writelane_b32 v230, s32, 18
s_mov_b32 s32, 0x4b18810c
v_writelane_b32 v230, s32, 19
s_mov_b32 s32, 0x4a18811c
v_writelane_b32 v230, s32, 20
s_mov_b32 s32, 0xc412c
v_writelane_b32 v230, s32, 21
s_mov_b32 s32, 0x24134
v_writelane_b32 v230, s32, 22
s_mov_b32 s32, 0xa413c
v_writelane_b32 v230, s32, 23
s_mov_b32 s32, 0x4144
v_writelane_b32 v230, s32, 24
s_mov_b32 s32, 0x794c
v_writelane_b32 v230, s32, 25
s_branch main_kernel_w_qe
main_kernel_w_q6:
s_mov_b32 s32, 0x49088800
v_writelane_b32 v230, s32, 0
s_mov_b32 s32, 0x40c2010
v_writelane_b32 v230, s32, 1
s_mov_b32 s32, 0x4102020
v_writelane_b32 v230, s32, 2
s_mov_b32 s32, 0x7830
v_writelane_b32 v230, s32, 3
main_kernel_w_qe:
v_and_b32 v229, 0x7ff, v230
main_kernel_w_dec:
s_waitcnt vmcnt(0)
v_readfirstlane_b32 s28, v249
s_nop 1
v_cmp_ge_u32 vcc, s28, v229
s_nop 1
s_bcnt1_i32_b64 s32, vcc
s_sub_u32 s32, s32, 1
v_readlane_b32 s36, v230, s32
s_nop 1
s_and_b32 s32, s36, 0x7ff
s_sub_u32 s28, s28, s32
s_bfe_u32 s32, s36, 0x3001a
s_lshr_b32 s25, s28, s32
s_lshl_b32 s33, s25, s32
s_sub_u32 s24, s28, s33
s_bfe_u32 s34, s36, 0x1001d
s_lshl_b32 s24, s24, s34
s_bfe_u32 s35, s36, 0x1001e
s_lshl_b32 s25, s25, s35
s_bfe_u32 s32, s36, 0x40011
s_add_u32 s24, s24, s32
s_bfe_u32 s32, s36, 0x50015
s_add_u32 s25, s25, s32
s_bfe_u32 s23, s36, 0x4000b
s_bfe_u32 s36, s36, 0x6000b
s_lshl_b32 s32, s24, 8
s_or_b32 s36, s36, s32
s_lshl_b32 s32, s25, 16
s_or_b32 s36, s36, s32
s_cmp_eq_u32 s23, 4
s_cselect_b32 s32, 1, 0
s_sub_u32 s48, s24, s32
s_max_i32 s48, s48, 0
s_add_u32 s49, s24, s34
s_add_u32 s49, s49, s32
s_min_u32 s49, s49, 15
s_cmp_eq_u32 s23, 6
s_cselect_b32 s51, 3, 7
s_cmp_eq_u32 s23, 7
s_cselect_b32 s51, 27, s51
s_cselect_b32 s50, 5, 4
s_add_u32 s33, s25, s35
s_lshl_b32 s34, s24, 9
s_cmp_eq_u32 s23, 8
s_cselect_b32 s51, 0, s51
s_cselect_b32 s48, s25, s48
s_cselect_b32 s49, s33, s49
s_cmp_eq_u32 s23, 8
s_cselect_b32 s63, 2, 9
s_cselect_b32 s61, 0, 0x7f000000
s_cselect_b32 s34, s34, 0
v_lshrrev_b32 v228, s50, v250
v_lshlrev_b32 v254, s50, v228
v_sub_u32 v254, v250, v254
s_cmp_lt_u32 s23, 4
s_cselect_b32 s39, 10, s23
v_min_u32 v254, s51, v254
s_lshl_b32 s39, s39, 13
s_cmp_eq_u32 s23, 3
s_cselect_b32 s34, 4, s34
v_add_u32 v228, s48, v228
s_add_u32 s39, s39, s34
s_add_u32 s39, s39, 0x8402000
v_min_u32 v228, s49, v228
s_lshl_b32 s60, s24, 10
s_add_u32 s60, s60, 0x8400000
v_lshlrev_b32 v228, s63, v228
v_lshl_add_u32 v228, v254, 4, v228
v_or_b32 v146, s61, v251
main_kernel_w_chk:
s_and_b32 s23, s36, 15
s_cmp_lg_u32 s23, 15
s_cbranch_scc1 main_kernel_w_got
s_mov_b32 s36, -3
s_cmp_eq_u32 s27, 6
s_cbranch_scc1 main_kernel_w_pub
s_add_u32 s27, s27, 1
s_cmp_ge_u32 s27, 6
s_cselect_b32 s27, 0, s27
s_add_u32 s52, s52, 1
s_mov_b32 s36, -1
s_lshl_b32 s32, 1, s12
s_and_b32 s32, s32, 116
s_cselect_b32 s36, -2, -1
s_cbranch_scc1 main_kernel_w_pub
s_cmp_lt_u32 s52, 6
s_cbranch_scc1 main_kernel_w_selq
s_lshl_b32 s32, s12, 5
s_add_u32 s32, s32, s13
s_sub_u32 s32, s32, 160
s_cmp_lt_u32 s32, 0
s_cselect_b32 s36, -3, -1
s_cmp_lt_u32 s32, 64
s_cselect_b32 s36, -2, s36
s_branch main_kernel_w_pub
main_kernel_w_got:
s_cmp_ge_u32 s23, 10
s_cbranch_scc1 main_kernel_w_pub
main_kernel_w_poll:
buffer_load_dword v231, v228, s[4:7], s39 offen sc1
buffer_load_dwordx4 v[232:235], v146, s[4:7], s60 offen sc1
s_waitcnt vmcnt(0)
v_min3_u32 v253, v232, v233, v234
v_min_u32 v253, v253, v235
v_or_b32 v253, s61, v253
v_min_u32 v253, v253, v231
v_cmp_eq_u32 vcc, 0, v253
s_cbranch_vccz main_kernel_w_pub
s_sleep 8
s_sub_u32 s29, s29, 1
s_cbranch_scc0 main_kernel_w_poll
s_mov_b32 s36, -1
main_kernel_w_pub:
v_mov_b32 v253, 131072
v_mov_b32 v254, s36
ds_write_b32 v253, v254
s_waitcnt lgkmcnt(0)
main_kernel_w_bar:
s_barrier
v_mov_b32 v253, 131072
ds_read_b32 v254, v253
s_mov_b32 s56, 0
s_mov_b32 s73, -1
s_mov_b32 s58, -2
s_waitcnt lgkmcnt(0)
v_readfirstlane_b32 s62, v254
s_nop 3
s_cmp_eq_u32 s62, -1
s_cbranch_scc1 main_kernel_end2
s_cmp_eq_u32 s62, -2
s_cbranch_scc1 main_kernel_wo
s_cmp_eq_u32 s62, -3
s_cbranch_scc1 main_kernel_att2
s_and_b32 s23, s62, 15
s_bfe_u32 s54, s62, 0x20004
s_bfe_u32 s24, s62, 0x80008
s_lshr_b32 s25, s62, 16
s_cmp_eq_u32 s23, 5
s_cbranch_scc1 main_kernel_w_ln2
s_cmp_eq_u32 s23, 10
s_cbranch_scc1 main_kernel_w_fill
s_cmp_eq_u32 s23, 11
s_cbranch_scc1 main_kernel_w_pref
main_kernel_w_gemm:
s_cmp_eq_u32 s54, 1
s_cbranch_scc1 main_kernel_w_c1_task
main_kernel_w_c0_task:
s_cmp_eq_u32 s23, 1
s_cbranch_scc1 main_kernel_w_c0_set1
s_cmp_eq_u32 s23, 2
s_cbranch_scc1 main_kernel_w_c0_set2
s_cmp_eq_u32 s23, 4
s_cbranch_scc1 main_kernel_w_c0_set4
s_cmp_eq_u32 s23, 7
s_cbranch_scc1 main_kernel_w_c0_set7
s_cmp_eq_u32 s23, 8
s_cbranch_scc1 main_kernel_w_c0_set8
s_branch main_kernel_end2
main_kernel_w_c0_set1:
s_mov_b32 s57, 1
s_lshl_b32 s32, s25, 8
s_add_u32 s8, s42, s32
s_addc_u32 s9, s43, 0
s_and_b32 s9, s9, 0xffff
s_sub_u32 s10, 0x800000, s32
s_mov_b32 s11, 0x20000
s_mov_b32 s30, 8192
s_mov_b32 s31, 32768
s_mul_i32 s16, s24, 262144
s_add_u32 s16, s16, 0x0
s_mov_b32 s18, 3
s_lshl_b32 s32, s24, 3
s_mul_i32 s33, s38, 4
s_add_u32 s32, s32, s33
s_mul_i32 s32, s32, 131072
s_lshl_b32 s33, s25, 12
s_add_u32 s32, s32, s33
s_mul_i32 s33, s37, 2048
s_add_u32 s32, s32, s33
s_add_u32 s21, s32, 0x1800000
s_mov_b32 s22, 131072
s_mov_b32 s26, 0x7f000000
s_branch main_kernel_w_c0_go
main_kernel_w_c0_set2:
s_mov_b32 s57, 2
s_lshl_b32 s32, s25, 8
s_add_u32 s8, s44, s32
s_addc_u32 s9, s45, 0
s_and_b32 s9, s9, 0xffff
s_sub_u32 s10, 0x800000, s32
s_mov_b32 s11, 0x20000
s_mov_b32 s30, 8192
s_mov_b32 s31, 32768
s_mul_i32 s16, s24, 262144
s_add_u32 s16, s16, 0x0
s_mov_b32 s18, 3
s_lshl_b32 s32, s24, 2
s_mul_i32 s33, s38, 2
s_add_u32 s32, s32, s33
s_lshl_b32 s32, s32, 18
s_lshl_b32 s33, s25, 13
s_add_u32 s32, s32, s33
s_mul_i32 s33, s37, 4096
s_add_u32 s32, s32, s33
s_add_u32 s21, s32, 0x2800000
s_branch main_kernel_w_c0_gov
main_kernel_w_c0_set4:
s_mov_b32 s57, 3
s_lshl_b32 s32, s25, 8
s_add_u32 s8, s66, s32
s_addc_u32 s9, s67, 0
s_and_b32 s9, s9, 0xffff
s_sub_u32 s10, 0x200000, s32
s_mov_b32 s11, 0x20000
s_mov_b32 s30, 2048
s_mov_b32 s31, 32768
s_mul_i32 s16, s24, 262144
s_add_u32 s16, s16, 0x4808000
s_mov_b32 s18, 3
s_lshl_b32 s32, s24, 3
s_mul_i32 s33, s38, 4
s_add_u32 s32, s32, s33
s_mul_i32 s32, s32, 32768
s_lshl_b32 s33, s25, 12
s_add_u32 s32, s32, s33
s_mul_i32 s33, s37, 2048
s_add_u32 s32, s32, s33
s_add_u32 s21, s32, 0x5000000
s_mov_b32 s22, 32768
s_add_u32 s26, s32, 0x0
s_branch main_kernel_w_c0_go
main_kernel_w_c0_set7:
s_mov_b32 s57, 4
s_lshl_b32 s32, s25, 8
s_add_u32 s8, s70, s32
s_addc_u32 s9, s71, 0
s_and_b32 s9, s9, 0xffff
s_sub_u32 s10, 0x700000, s32
s_mov_b32 s11, 0x20000
s_mov_b32 s30, 2048
s_mov_b32 s31, 114688
s_mul_i32 s16, s24, 917504
s_add_u32 s16, s16, 0x5400000
s_mov_b32 s18, 13
s_lshl_b32 s32, s24, 3
s_mul_i32 s33, s38, 4
s_add_u32 s32, s32, s33
s_mul_i32 s32, s32, 32768
s_lshl_b32 s33, s25, 12
s_add_u32 s32, s32, s33
s_mul_i32 s33, s37, 2048
s_add_u32 s32, s32, s33
s_add_u32 s21, s32, 0x6400000
s_mov_b32 s22, 32768
s_add_u32 s26, s32, 0x5000000
s_branch main_kernel_w_c0_go
main_kernel_w_c0_set8:
s_mov_b32 s57, 5
s_lshl_b32 s32, s25, 8
s_add_u32 s8, s46, s32
s_addc_u32 s9, s47, 0
s_and_b32 s9, s9, 0xffff
s_sub_u32 s10, 0x800000, s32
s_mov_b32 s11, 0x20000
s_mov_b32 s30, 2048
s_mov_b32 s31, 131072
s_mul_i32 s16, s24, 1048576
s_add_u32 s16, s16, 0x3800000
s_mov_b32 s18, 15
s_lshl_b32 s32, s24, 3
s_mul_i32 s33, s38, 4
s_add_u32 s32, s32, s33
s_mul_i32 s32, s32, 32768
s_lshl_b32 s33, s25, 8
s_add_u32 s34, s32, s33
s_mul_i32 s33, s37, 128
s_add_u32 s34, s34, s33
s_lshl_b32 s33, s25, 12
s_add_u32 s32, s32, s33
s_mul_i32 s33, s37, 2048
s_add_u32 s32, s32, s33
s_add_u32 s21, s32, 0x0
s_mov_b32 s22, 32768
s_add_u32 s26, s32, 0x6400000
s_mov_b32 s21, s34
v_and_b32 v253, 15, v250
v_and_b32 v254, 48, v250
v_lshl_add_u32 v252, v253, 11, v254
s_branch main_kernel_w_c0_go
main_kernel_w_c0_str:
s_mul_i32 s32, s14, 2
s_mul_i32 s32, s32, s31
v_mad_u32_u24 v137, v147, s30, v151
v_mad_u32_u24 v138, v148, s30, v152
v_mad_u32_u24 v139, v149, s30, v153
v_mad_u32_u24 v140, v150, s30, v154
v_add_u32 v141, s32, v251
s_add_u32 s32, s32, s31
s_sub_u32 s32, s32, 2048
v_add_u32 v142, s32, v251
s_mul_i32 s17, s30, 64
s_mov_b32 s15, 0
s_mov_b32 s18, 1
s_cmp_eq_u32 s73, 0
s_cbranch_scc1 main_kernel_w_c0_n_mid
s_branch main_kernel_w_c0_v_mid
main_kernel_w_c0_go:
s_mov_b32 s58, 0
s_mov_b32 s72, s18
s_cmp_lg_u32 s73, -1
s_cbranch_scc1 main_kernel_w_c0_str
s_waitcnt lgkmcnt(0)
v_lshrrev_b32 v0, 4, v250
v_bfe_u32 v1, v250, 2, 2
v_lshl_add_u32 v4, v0, 2, v1
v_and_b32 v5, 7, v4
v_mul_u32_u24 v4, 256, v4
v_and_b32 v6, 3, v250
v_lshl_add_u32 v4, v6, 3, v4
s_mul_i32 s32, s37, 4
v_xor_b32 v5, s32, v5
v_lshl_add_u32 v128, v5, 5, v4
v_xor_b32 v129, 32, v128
v_xor_b32 v130, 64, v128
v_xor_b32 v131, 96, v128
s_mul_i32 s32, s38, 8192
s_add_u32 s32, s32, 65536
v_add_u32 v136, s32, v251
v_lshrrev_b32 v2, 4, v250
v_and_b32 v3, 15, v250
s_mul_i32 s32, s14, 16
v_add_u32 v147, s32, v2
v_and_b32 v6, 7, v147
v_lshlrev_b32 v6, 1, v6
v_xor_b32 v6, v6, v3
v_lshlrev_b32 v151, 4, v6
v_add_u32 v148, 4, v147
v_and_b32 v6, 7, v148
v_lshlrev_b32 v6, 1, v6
v_xor_b32 v6, v6, v3
v_lshlrev_b32 v152, 4, v6
v_subrev_u32 v152, 1024, v152
v_add_u32 v149, 8, v147
v_and_b32 v6, 7, v149
v_lshlrev_b32 v6, 1, v6
v_xor_b32 v6, v6, v3
v_lshlrev_b32 v153, 4, v6
v_subrev_u32 v153, 2048, v153
v_add_u32 v150, 12, v147
v_and_b32 v6, 7, v150
v_lshlrev_b32 v6, 1, v6
v_xor_b32 v6, v6, v3
v_lshlrev_b32 v154, 4, v6
v_subrev_u32 v154, 3072, v154
s_mul_i32 s19, s14, 4096
s_mul_i32 s20, s14, 4096
s_add_u32 s20, s20, 65536
s_mul_i32 s32, s14, 2
s_mul_i32 s32, s32, s31
v_mad_u32_u24 v137, v147, s30, v151
v_mad_u32_u24 v138, v148, s30, v152
v_mad_u32_u24 v139, v149, s30, v153
v_mad_u32_u24 v140, v150, s30, v154
v_add_u32 v141, s32, v251
s_add_u32 s32, s32, s31
s_sub_u32 s32, s32, 2048
v_add_u32 v142, s32, v251
s_mul_i32 s17, s30, 64
s_mov_b32 s15, 0
s_waitcnt vmcnt(0)
s_add_u32 m0, s20, 0
s_nop 0
buffer_load_dwordx4 v141, s[4:7], s16 offen offset:0 sc1 lds
buffer_load_dwordx4 v141, s[4:7], s16 offen offset:1024 sc1 lds
buffer_load_dwordx4 v142, s[4:7], s16 offen offset:2048 sc1 lds
buffer_load_dwordx4 v142, s[4:7], s16 offen offset:3072 sc1 lds
s_add_u32 s16, s16, 2048
s_add_u32 m0, s19, 0
s_nop 0
buffer_load_dwordx4 v137, s[8:11], s15 offen offset:0 lds
buffer_load_dwordx4 v138, s[8:11], s15 offen offset:1024 lds
buffer_load_dwordx4 v139, s[8:11], s15 offen offset:2048 lds
buffer_load_dwordx4 v140, s[8:11], s15 offen offset:3072 lds
s_add_u32 s15, s15, s17
s_add_u32 m0, s20, 16384
s_nop 0
buffer_load_dwordx4 v141, s[4:7], s16 offen offset:0 sc1 lds
buffer_load_dwordx4 v141, s[4:7], s16 offen offset:1024 sc1 lds
buffer_load_dwordx4 v142, s[4:7], s16 offen offset:2048 sc1 lds
buffer_load_dwordx4 v142, s[4:7], s16 offen offset:3072 sc1 lds
s_add_u32 s16, s16, 2048
s_add_u32 m0, s19, 16384
s_nop 0
buffer_load_dwordx4 v137, s[8:11], s15 offen offset:0 lds
buffer_load_dwordx4 v138, s[8:11], s15 offen offset:1024 lds
buffer_load_dwordx4 v139, s[8:11], s15 offen offset:2048 lds
buffer_load_dwordx4 v140, s[8:11], s15 offen offset:3072 lds
s_add_u32 s15, s15, s17
s_add_u32 m0, s20, 32768
s_nop 0
buffer_load_dwordx4 v141, s[4:7], s16 offen offset:0 sc1 lds
buffer_load_dwordx4 v141, s[4:7], s16 offen offset:1024 sc1 lds
buffer_load_dwordx4 v142, s[4:7], s16 offen offset:2048 sc1 lds
buffer_load_dwordx4 v142, s[4:7], s16 offen offset:3072 sc1 lds
s_add_u32 s16, s16, 2048
s_add_u32 m0, s19, 32768
s_nop 0
buffer_load_dwordx4 v137, s[8:11], s15 offen offset:0 lds
buffer_load_dwordx4 v138, s[8:11], s15 offen offset:1024 lds
buffer_load_dwordx4 v139, s[8:11], s15 offen offset:2048 lds
buffer_load_dwordx4 v140, s[8:11], s15 offen offset:3072 lds
s_add_u32 s15, s15, s17
s_add_u32 m0, s20, 49152
s_nop 0
buffer_load_dwordx4 v141, s[4:7], s16 offen offset:0 sc1 lds
buffer_load_dwordx4 v141, s[4:7], s16 offen offset:1024 sc1 lds
buffer_load_dwordx4 v142, s[4:7], s16 offen offset:2048 sc1 lds
buffer_load_dwordx4 v142, s[4:7], s16 offen offset:3072 sc1 lds
s_add_u32 s16, s16, 2048
s_cmp_lg_u32 s56, 0
s_cbranch_scc1 main_kernel_w_epi
main_kernel_w_c0_n_ent:
v_mfma_f32_32x32x16_bf16 v[64:79], v[224:227], v[224:227], 0
s_waitcnt vmcnt(20)
s_barrier
ds_read_b128 v[16:19], v136 offset:0
ds_read_b64_tr_b16 v[0:1], v128 offset:0
ds_read_b64_tr_b16 v[2:3], v128 offset:4096
v_mfma_f32_32x32x16_bf16 v[80:95], v[224:227], v[224:227], 0
ds_read_b64_tr_b16 v[4:5], v129 offset:0
ds_read_b64_tr_b16 v[6:7], v129 offset:4096
ds_read_b64_tr_b16 v[8:9], v130 offset:0
v_mfma_f32_32x32x16_bf16 v[96:111], v[224:227], v[224:227], 0
ds_read_b64_tr_b16 v[10:11], v130 offset:4096
ds_read_b64_tr_b16 v[12:13], v131 offset:0
ds_read_b64_tr_b16 v[14:15], v131 offset:4096
v_mfma_f32_32x32x16_bf16 v[112:127], v[224:227], v[224:227], 0
ds_read_b128 v[20:23], v136 offset:2048
ds_read_b128 v[24:27], v136 offset:4096
ds_read_b128 v[28:31], v136 offset:6144
s_sub_u32 s18, s72, 1
s_sub_u32 s55, s72, 2
s_orn2_b32 s55, s55, s100
s_mov_b32 s73, -1
s_nop 0
main_kernel_w_c0_n_loop:
s_waitcnt lgkmcnt(0)
ds_read_b128 v[48:51], v136 offset:1024
s_add_u32 m0, s19, 49152
s_nop 0
v_mfma_f32_16x16x32_bf16 v[64:67], v[0:3], v[16:19], v[64:67]
ds_read_b64_tr_b16 v[32:33], v128 offset:8192
v_mfma_f32_16x16x32_bf16 v[68:71], v[4:7], v[16:19], v[68:71]
ds_read_b64_tr_b16 v[34:35], v128 offset:12288
buffer_load_dwordx4 v137, s[8:11], s15 offen offset:0 lds
v_mfma_f32_16x16x32_bf16 v[72:75], v[8:11], v[16:19], v[72:75]
ds_read_b64_tr_b16 v[36:37], v129 offset:8192
v_mfma_f32_16x16x32_bf16 v[76:79], v[12:15], v[16:19], v[76:79]
ds_read_b64_tr_b16 v[38:39], v129 offset:12288
v_mfma_f32_16x16x32_bf16 v[80:83], v[0:3], v[20:23], v[80:83]
ds_read_b64_tr_b16 v[40:41], v130 offset:8192
buffer_load_dwordx4 v138, s[8:11], s15 offen offset:1024 lds
v_mfma_f32_16x16x32_bf16 v[84:87], v[4:7], v[20:23], v[84:87]
ds_read_b64_tr_b16 v[42:43], v130 offset:12288
v_mfma_f32_16x16x32_bf16 v[88:91], v[8:11], v[20:23], v[88:91]
ds_read_b64_tr_b16 v[44:45], v131 offset:8192
v_mfma_f32_16x16x32_bf16 v[92:95], v[12:15], v[20:23], v[92:95]
ds_read_b64_tr_b16 v[46:47], v131 offset:12288
buffer_load_dwordx4 v139, s[8:11], s15 offen offset:2048 lds
v_mfma_f32_16x16x32_bf16 v[96:99], v[0:3], v[24:27], v[96:99]
ds_read_b128 v[52:55], v136 offset:3072
v_mfma_f32_16x16x32_bf16 v[100:103], v[4:7], v[24:27], v[100:103]
ds_read_b128 v[56:59], v136 offset:5120
buffer_load_dwordx4 v140, s[8:11], s15 offen offset:3072 lds
v_mfma_f32_16x16x32_bf16 v[104:107], v[8:11], v[24:27], v[104:107]
ds_read_b128 v[60:63], v136 offset:7168
v_mfma_f32_16x16x32_bf16 v[108:111], v[12:15], v[24:27], v[108:111]
v_mfma_f32_16x16x32_bf16 v[112:115], v[0:3], v[28:31], v[112:115]
s_add_u32 s15, s15, s17
v_mfma_f32_16x16x32_bf16 v[116:119], v[4:7], v[28:31], v[116:119]
v_mfma_f32_16x16x32_bf16 v[120:123], v[8:11], v[28:31], v[120:123]
v_mfma_f32_16x16x32_bf16 v[124:127], v[12:15], v[28:31], v[124:127]
main_kernel_w_c0_n_mid:
s_waitcnt lgkmcnt(0)
v_mfma_f32_16x16x32_bf16 v[64:67], v[32:35], v[48:51], v[64:67]
s_waitcnt vmcnt(16)
s_barrier
ds_read_b128 v[16:19], v136 offset:16384
s_add_u32 m0, s20, 0
s_nop 0
v_mfma_f32_16x16x32_bf16 v[68:71], v[36:39], v[48:51], v[68:71]
ds_read_b64_tr_b16 v[0:1], v128 offset:16384
v_mfma_f32_16x16x32_bf16 v[72:75], v[40:43], v[48:51], v[72:75]
ds_read_b64_tr_b16 v[2:3], v128 offset:20480
buffer_load_dwordx4 v141, s[4:7], s16 offen offset:0 sc1 lds
v_mfma_f32_16x16x32_bf16 v[76:79], v[44:47], v[48:51], v[76:79]
ds_read_b64_tr_b16 v[4:5], v129 offset:16384
v_mfma_f32_16x16x32_bf16 v[80:83], v[32:35], v[52:55], v[80:83]
ds_read_b64_tr_b16 v[6:7], v129 offset:20480
v_mfma_f32_16x16x32_bf16 v[84:87], v[36:39], v[52:55], v[84:87]
ds_read_b64_tr_b16 v[8:9], v130 offset:16384
buffer_load_dwordx4 v141, s[4:7], s16 offen offset:1024 sc1 lds
v_mfma_f32_16x16x32_bf16 v[88:91], v[40:43], v[52:55], v[88:91]
ds_read_b64_tr_b16 v[10:11], v130 offset:20480
v_mfma_f32_16x16x32_bf16 v[92:95], v[44:47], v[52:55], v[92:95]
ds_read_b64_tr_b16 v[12:13], v131 offset:16384
buffer_load_dwordx4 v142, s[4:7], s16 offen offset:2048 sc1 lds
v_mfma_f32_16x16x32_bf16 v[96:99], v[32:35], v[56:59], v[96:99]
ds_read_b64_tr_b16 v[14:15], v131 offset:20480
v_mfma_f32_16x16x32_bf16 v[100:103], v[36:39], v[56:59], v[100:103]
ds_read_b128 v[20:23], v136 offset:18432
v_mfma_f32_16x16x32_bf16 v[104:107], v[40:43], v[56:59], v[104:107]
ds_read_b128 v[24:27], v136 offset:20480
buffer_load_dwordx4 v142, s[4:7], s16 offen offset:3072 sc1 lds
v_mfma_f32_16x16x32_bf16 v[108:111], v[44:47], v[56:59], v[108:111]
ds_read_b128 v[28:31], v136 offset:22528
v_mfma_f32_16x16x32_bf16 v[112:115], v[32:35], v[60:63], v[112:115]
s_add_u32 s16, s16, 2048
v_mfma_f32_16x16x32_bf16 v[116:119], v[36:39], v[60:63], v[116:119]
v_mfma_f32_16x16x32_bf16 v[120:123], v[40:43], v[60:63], v[120:123]
v_mfma_f32_16x16x32_bf16 v[124:127], v[44:47], v[60:63], v[124:127]
s_waitcnt lgkmcnt(0)
ds_read_b128 v[48:51], v136 offset:17408
s_add_u32 m0, s19, 0
s_nop 0
v_mfma_f32_16x16x32_bf16 v[64:67], v[0:3], v[16:19], v[64:67]
ds_read_b64_tr_b16 v[32:33], v128 offset:24576
v_mfma_f32_16x16x32_bf16 v[68:71], v[4:7], v[16:19], v[68:71]
ds_read_b64_tr_b16 v[34:35], v128 offset:28672
buffer_load_dwordx4 v137, s[8:11], s15 offen offset:0 lds
v_mfma_f32_16x16x32_bf16 v[72:75], v[8:11], v[16:19], v[72:75]
ds_read_b64_tr_b16 v[36:37], v129 offset:24576
v_mfma_f32_16x16x32_bf16 v[76:79], v[12:15], v[16:19], v[76:79]
ds_read_b64_tr_b16 v[38:39], v129 offset:28672
v_mfma_f32_16x16x32_bf16 v[80:83], v[0:3], v[20:23], v[80:83]
ds_read_b64_tr_b16 v[40:41], v130 offset:24576
buffer_load_dwordx4 v138, s[8:11], s15 offen offset:1024 lds
v_mfma_f32_16x16x32_bf16 v[84:87], v[4:7], v[20:23], v[84:87]
ds_read_b64_tr_b16 v[42:43], v130 offset:28672
v_mfma_f32_16x16x32_bf16 v[88:91], v[8:11], v[20:23], v[88:91]
ds_read_b64_tr_b16 v[44:45], v131 offset:24576
v_mfma_f32_16x16x32_bf16 v[92:95], v[12:15], v[20:23], v[92:95]
ds_read_b64_tr_b16 v[46:47], v131 offset:28672
buffer_load_dwordx4 v139, s[8:11], s15 offen offset:2048 lds
v_mfma_f32_16x16x32_bf16 v[96:99], v[0:3], v[24:27], v[96:99]
ds_read_b128 v[52:55], v136 offset:19456
v_mfma_f32_16x16x32_bf16 v[100:103], v[4:7], v[24:27], v[100:103]
ds_read_b128 v[56:59], v136 offset:21504
buffer_load_dwordx4 v140, s[8:11], s15 offen offset:3072 lds
v_mfma_f32_16x16x32_bf16 v[104:107], v[8:11], v[24:27], v[104:107]
ds_read_b128 v[60:63], v136 offset:23552
v_mfma_f32_16x16x32_bf16 v[108:111], v[12:15], v[24:27], v[108:111]
v_mfma_f32_16x16x32_bf16 v[112:115], v[0:3], v[28:31], v[112:115]
s_add_u32 s15, s15, s17
v_mfma_f32_16x16x32_bf16 v[116:119], v[4:7], v[28:31], v[116:119]
v_mfma_f32_16x16x32_bf16 v[120:123], v[8:11], v[28:31], v[120:123]
v_mfma_f32_16x16x32_bf16 v[124:127], v[12:15], v[28:31], v[124:127]
s_waitcnt lgkmcnt(0)
v_mfma_f32_16x16x32_bf16 v[64:67], v[32:35], v[48:51], v[64:67]
s_waitcnt vmcnt(16)
s_barrier
ds_read_b128 v[16:19], v136 offset:32768
s_add_u32 m0, s20, 16384
s_nop 0
v_mfma_f32_16x16x32_bf16 v[68:71], v[36:39], v[48:51], v[68:71]
ds_read_b64_tr_b16 v[0:1], v128 offset:32768
v_mfma_f32_16x16x32_bf16 v[72:75], v[40:43], v[48:51], v[72:75]
ds_read_b64_tr_b16 v[2:3], v128 offset:36864
buffer_load_dwordx4 v141, s[4:7], s16 offen offset:0 sc1 lds
v_mfma_f32_16x16x32_bf16 v[76:79], v[44:47], v[48:51], v[76:79]
ds_read_b64_tr_b16 v[4:5], v129 offset:32768
v_mfma_f32_16x16x32_bf16 v[80:83], v[32:35], v[52:55], v[80:83]
ds_read_b64_tr_b16 v[6:7], v129 offset:36864
v_mfma_f32_16x16x32_bf16 v[84:87], v[36:39], v[52:55], v[84:87]
ds_read_b64_tr_b16 v[8:9], v130 offset:32768
buffer_load_dwordx4 v141, s[4:7], s16 offen offset:1024 sc1 lds
v_mfma_f32_16x16x32_bf16 v[88:91], v[40:43], v[52:55], v[88:91]
ds_read_b64_tr_b16 v[10:11], v130 offset:36864
v_mfma_f32_16x16x32_bf16 v[92:95], v[44:47], v[52:55], v[92:95]
ds_read_b64_tr_b16 v[12:13], v131 offset:32768
buffer_load_dwordx4 v142, s[4:7], s16 offen offset:2048 sc1 lds
v_mfma_f32_16x16x32_bf16 v[96:99], v[32:35], v[56:59], v[96:99]
ds_read_b64_tr_b16 v[14:15], v131 offset:36864
v_mfma_f32_16x16x32_bf16 v[100:103], v[36:39], v[56:59], v[100:103]
ds_read_b128 v[20:23], v136 offset:34816
v_mfma_f32_16x16x32_bf16 v[104:107], v[40:43], v[56:59], v[104:107]
ds_read_b128 v[24:27], v136 offset:36864
buffer_load_dwordx4 v142, s[4:7], s16 offen offset:3072 sc1 lds
v_mfma_f32_16x16x32_bf16 v[108:111], v[44:47], v[56:59], v[108:111]
ds_read_b128 v[28:31], v136 offset:38912
v_mfma_f32_16x16x32_bf16 v[112:115], v[32:35], v[60:63], v[112:115]
s_add_u32 s16, s16, 2048
v_mfma_f32_16x16x32_bf16 v[116:119], v[36:39], v[60:63], v[116:119]
v_mfma_f32_16x16x32_bf16 v[120:123], v[40:43], v[60:63], v[120:123]
v_mfma_f32_16x16x32_bf16 v[124:127], v[44:47], v[60:63], v[124:127]
s_waitcnt lgkmcnt(0)
ds_read_b128 v[48:51], v136 offset:33792
s_add_u32 m0, s19, 16384
s_nop 0
v_mfma_f32_16x16x32_bf16 v[64:67], v[0:3], v[16:19], v[64:67]
ds_read_b64_tr_b16 v[32:33], v128 offset:40960
v_mfma_f32_16x16x32_bf16 v[68:71], v[4:7], v[16:19], v[68:71]
ds_read_b64_tr_b16 v[34:35], v128 offset:45056
buffer_load_dwordx4 v137, s[8:11], s15 offen offset:0 lds
v_mfma_f32_16x16x32_bf16 v[72:75], v[8:11], v[16:19], v[72:75]
ds_read_b64_tr_b16 v[36:37], v129 offset:40960
v_mfma_f32_16x16x32_bf16 v[76:79], v[12:15], v[16:19], v[76:79]
ds_read_b64_tr_b16 v[38:39], v129 offset:45056
v_mfma_f32_16x16x32_bf16 v[80:83], v[0:3], v[20:23], v[80:83]
ds_read_b64_tr_b16 v[40:41], v130 offset:40960
buffer_load_dwordx4 v138, s[8:11], s15 offen offset:1024 lds
v_mfma_f32_16x16x32_bf16 v[84:87], v[4:7], v[20:23], v[84:87]
ds_read_b64_tr_b16 v[42:43], v130 offset:45056
v_mfma_f32_16x16x32_bf16 v[88:91], v[8:11], v[20:23], v[88:91]
ds_read_b64_tr_b16 v[44:45], v131 offset:40960
v_mfma_f32_16x16x32_bf16 v[92:95], v[12:15], v[20:23], v[92:95]
ds_read_b64_tr_b16 v[46:47], v131 offset:45056
buffer_load_dwordx4 v139, s[8:11], s15 offen offset:2048 lds
v_mfma_f32_16x16x32_bf16 v[96:99], v[0:3], v[24:27], v[96:99]
ds_read_b128 v[52:55], v136 offset:35840
v_mfma_f32_16x16x32_bf16 v[100:103], v[4:7], v[24:27], v[100:103]
ds_read_b128 v[56:59], v136 offset:37888
buffer_load_dwordx4 v140, s[8:11], s15 offen offset:3072 lds
v_mfma_f32_16x16x32_bf16 v[104:107], v[8:11], v[24:27], v[104:107]
ds_read_b128 v[60:63], v136 offset:39936
v_mfma_f32_16x16x32_bf16 v[108:111], v[12:15], v[24:27], v[108:111]
v_mfma_f32_16x16x32_bf16 v[112:115], v[0:3], v[28:31], v[112:115]
s_add_u32 s15, s15, s17
v_mfma_f32_16x16x32_bf16 v[116:119], v[4:7], v[28:31], v[116:119]
v_mfma_f32_16x16x32_bf16 v[120:123], v[8:11], v[28:31], v[120:123]
v_mfma_f32_16x16x32_bf16 v[124:127], v[12:15], v[28:31], v[124:127]
s_waitcnt lgkmcnt(0)
v_mfma_f32_16x16x32_bf16 v[64:67], v[32:35], v[48:51], v[64:67]
s_waitcnt vmcnt(16)
s_barrier
ds_read_b128 v[16:19], v136 offset:49152
s_add_u32 m0, s20, 32768
s_nop 0
v_mfma_f32_16x16x32_bf16 v[68:71], v[36:39], v[48:51], v[68:71]
ds_read_b64_tr_b16 v[0:1], v128 offset:49152
v_mfma_f32_16x16x32_bf16 v[72:75], v[40:43], v[48:51], v[72:75]
ds_read_b64_tr_b16 v[2:3], v128 offset:53248
buffer_load_dwordx4 v141, s[4:7], s16 offen offset:0 sc1 lds
v_mfma_f32_16x16x32_bf16 v[76:79], v[44:47], v[48:51], v[76:79]
ds_read_b64_tr_b16 v[4:5], v129 offset:49152
v_mfma_f32_16x16x32_bf16 v[80:83], v[32:35], v[52:55], v[80:83]
ds_read_b64_tr_b16 v[6:7], v129 offset:53248
v_mfma_f32_16x16x32_bf16 v[84:87], v[36:39], v[52:55], v[84:87]
ds_read_b64_tr_b16 v[8:9], v130 offset:49152
buffer_load_dwordx4 v141, s[4:7], s16 offen offset:1024 sc1 lds
v_mfma_f32_16x16x32_bf16 v[88:91], v[40:43], v[52:55], v[88:91]
ds_read_b64_tr_b16 v[10:11], v130 offset:53248
v_mfma_f32_16x16x32_bf16 v[92:95], v[44:47], v[52:55], v[92:95]
ds_read_b64_tr_b16 v[12:13], v131 offset:49152
buffer_load_dwordx4 v142, s[4:7], s16 offen offset:2048 sc1 lds
v_mfma_f32_16x16x32_bf16 v[96:99], v[32:35], v[56:59], v[96:99]
ds_read_b64_tr_b16 v[14:15], v131 offset:53248
v_mfma_f32_16x16x32_bf16 v[100:103], v[36:39], v[56:59], v[100:103]
ds_read_b128 v[20:23], v136 offset:51200
v_mfma_f32_16x16x32_bf16 v[104:107], v[40:43], v[56:59], v[104:107]
ds_read_b128 v[24:27], v136 offset:53248
buffer_load_dwordx4 v142, s[4:7], s16 offen offset:3072 sc1 lds
v_mfma_f32_16x16x32_bf16 v[108:111], v[44:47], v[56:59], v[108:111]
ds_read_b128 v[28:31], v136 offset:55296
v_mfma_f32_16x16x32_bf16 v[112:115], v[32:35], v[60:63], v[112:115]
s_add_u32 s16, s16, 2048
v_mfma_f32_16x16x32_bf16 v[116:119], v[36:39], v[60:63], v[116:119]
v_mfma_f32_16x16x32_bf16 v[120:123], v[40:43], v[60:63], v[120:123]
v_mfma_f32_16x16x32_bf16 v[124:127], v[44:47], v[60:63], v[124:127]
s_waitcnt lgkmcnt(0)
ds_read_b128 v[48:51], v136 offset:50176
s_add_u32 m0, s19, 32768
s_nop 0
v_mfma_f32_16x16x32_bf16 v[64:67], v[0:3], v[16:19], v[64:67]
ds_read_b64_tr_b16 v[32:33], v128 offset:57344
v_mfma_f32_16x16x32_bf16 v[68:71], v[4:7], v[16:19], v[68:71]
ds_read_b64_tr_b16 v[34:35], v128 offset:61440
buffer_load_dwordx4 v137, s[8:11], s15 offen offset:0 lds
v_mfma_f32_16x16x32_bf16 v[72:75], v[8:11], v[16:19], v[72:75]
ds_read_b64_tr_b16 v[36:37], v129 offset:57344
v_mfma_f32_16x16x32_bf16 v[76:79], v[12:15], v[16:19], v[76:79]
ds_read_b64_tr_b16 v[38:39], v129 offset:61440
v_mfma_f32_16x16x32_bf16 v[80:83], v[0:3], v[20:23], v[80:83]
ds_read_b64_tr_b16 v[40:41], v130 offset:57344
buffer_load_dwordx4 v138, s[8:11], s15 offen offset:1024 lds
v_mfma_f32_16x16x32_bf16 v[84:87], v[4:7], v[20:23], v[84:87]
ds_read_b64_tr_b16 v[42:43], v130 offset:61440
v_mfma_f32_16x16x32_bf16 v[88:91], v[8:11], v[20:23], v[88:91]
ds_read_b64_tr_b16 v[44:45], v131 offset:57344
v_mfma_f32_16x16x32_bf16 v[92:95], v[12:15], v[20:23], v[92:95]
ds_read_b64_tr_b16 v[46:47], v131 offset:61440
buffer_load_dwordx4 v139, s[8:11], s15 offen offset:2048 lds
v_mfma_f32_16x16x32_bf16 v[96:99], v[0:3], v[24:27], v[96:99]
ds_read_b128 v[52:55], v136 offset:52224
v_mfma_f32_16x16x32_bf16 v[100:103], v[4:7], v[24:27], v[100:103]
ds_read_b128 v[56:59], v136 offset:54272
buffer_load_dwordx4 v140, s[8:11], s15 offen offset:3072 lds
v_mfma_f32_16x16x32_bf16 v[104:107], v[8:11], v[24:27], v[104:107]
ds_read_b128 v[60:63], v136 offset:56320
v_mfma_f32_16x16x32_bf16 v[108:111], v[12:15], v[24:27], v[108:111]
v_mfma_f32_16x16x32_bf16 v[112:115], v[0:3], v[28:31], v[112:115]
s_add_u32 s15, s15, s17
v_mfma_f32_16x16x32_bf16 v[116:119], v[4:7], v[28:31], v[116:119]
v_mfma_f32_16x16x32_bf16 v[120:123], v[8:11], v[28:31], v[120:123]
v_mfma_f32_16x16x32_bf16 v[124:127], v[12:15], v[28:31], v[124:127]
s_waitcnt lgkmcnt(0)
v_mfma_f32_16x16x32_bf16 v[64:67], v[32:35], v[48:51], v[64:67]
s_waitcnt vmcnt(16)
s_barrier
ds_read_b128 v[16:19], v136 offset:0
s_add_u32 m0, s20, 49152
s_nop 0
v_mfma_f32_16x16x32_bf16 v[68:71], v[36:39], v[48:51], v[68:71]
ds_read_b64_tr_b16 v[0:1], v128 offset:0
v_mfma_f32_16x16x32_bf16 v[72:75], v[40:43], v[48:51], v[72:75]
ds_read_b64_tr_b16 v[2:3], v128 offset:4096
buffer_load_dwordx4 v141, s[4:7], s16 offen offset:0 sc1 lds
v_mfma_f32_16x16x32_bf16 v[76:79], v[44:47], v[48:51], v[76:79]
ds_read_b64_tr_b16 v[4:5], v129 offset:0
v_mfma_f32_16x16x32_bf16 v[80:83], v[32:35], v[52:55], v[80:83]
ds_read_b64_tr_b16 v[6:7], v129 offset:4096
v_mfma_f32_16x16x32_bf16 v[84:87], v[36:39], v[52:55], v[84:87]
ds_read_b64_tr_b16 v[8:9], v130 offset:0
buffer_load_dwordx4 v141, s[4:7], s16 offen offset:1024 sc1 lds
v_mfma_f32_16x16x32_bf16 v[88:91], v[40:43], v[52:55], v[88:91]
ds_read_b64_tr_b16 v[10:11], v130 offset:4096
v_mfma_f32_16x16x32_bf16 v[92:95], v[44:47], v[52:55], v[92:95]
ds_read_b64_tr_b16 v[12:13], v131 offset:0
buffer_load_dwordx4 v142, s[4:7], s16 offen offset:2048 sc1 lds
v_mfma_f32_16x16x32_bf16 v[96:99], v[32:35], v[56:59], v[96:99]
ds_read_b64_tr_b16 v[14:15], v131 offset:4096
v_mfma_f32_16x16x32_bf16 v[100:103], v[36:39], v[56:59], v[100:103]
ds_read_b128 v[20:23], v136 offset:2048
v_mfma_f32_16x16x32_bf16 v[104:107], v[40:43], v[56:59], v[104:107]
ds_read_b128 v[24:27], v136 offset:4096
buffer_load_dwordx4 v142, s[4:7], s16 offen offset:3072 sc1 lds
v_mfma_f32_16x16x32_bf16 v[108:111], v[44:47], v[56:59], v[108:111]
ds_read_b128 v[28:31], v136 offset:6144
v_mfma_f32_16x16x32_bf16 v[112:115], v[32:35], v[60:63], v[112:115]
s_add_u32 s16, s16, 2048
v_mfma_f32_16x16x32_bf16 v[116:119], v[36:39], v[60:63], v[116:119]
v_mfma_f32_16x16x32_bf16 v[120:123], v[40:43], v[60:63], v[120:123]
v_mfma_f32_16x16x32_bf16 v[124:127], v[44:47], v[60:63], v[124:127]
s_sub_u32 s18, s18, 1
s_cmp_eq_u32 s18, s55
s_cbranch_scc1 main_kernel_w_c0_n_ev
s_cmp_lg_u32 s18, 0
s_cbranch_scc1 main_kernel_w_c0_n_loop
s_cmp_lg_u32 s73, -1
s_cbranch_scc1 main_kernel_w_epn
s_waitcnt lgkmcnt(0)
ds_read_b128 v[48:51], v136 offset:1024
s_add_u32 m0, s19, 49152
s_nop 0
v_mfma_f32_16x16x32_bf16 v[64:67], v[0:3], v[16:19], v[64:67]
ds_read_b64_tr_b16 v[32:33], v128 offset:8192
s_add_u32 s32, s23, 1
s_bitcmp0_b32 s32, 2
s_cselect_b32 s34, 7, 2
s_cselect_b32 s35, 2, 4
s_lshl_b32 s59, s23, 13
s_add_u32 s59, s59, 0x8404000
v_mfma_f32_16x16x32_bf16 v[68:71], v[4:7], v[16:19], v[68:71]
ds_read_b64_tr_b16 v[34:35], v128 offset:12288
buffer_load_dwordx4 v137, s[8:11], s15 offen offset:0 lds
v_lshrrev_b32 v253, 3, v250
v_add_lshl_u32 v253, s24, v253, 9
v_mfma_f32_16x16x32_bf16 v[72:75], v[8:11], v[16:19], v[72:75]
ds_read_b64_tr_b16 v[36:37], v129 offset:8192
v_and_b32 v254, 3, v250
v_lshl_add_u32 v253, v254, s34, v253
v_mfma_f32_16x16x32_bf16 v[76:79], v[12:15], v[16:19], v[76:79]
ds_read_b64_tr_b16 v[38:39], v129 offset:12288
v_bfe_u32 v254, v250, 2, 1
v_add_u32 v254, s25, v254
v_lshl_add_u32 v248, v254, s35, v253
v_mfma_f32_16x16x32_bf16 v[80:83], v[0:3], v[20:23], v[80:83]
ds_read_b64_tr_b16 v[40:41], v130 offset:8192
buffer_load_dwordx4 v138, s[8:11], s15 offen offset:1024 lds
s_lshl_b32 s0, 4, s54
v_readfirstlane_b32 s28, v249
v_mfma_f32_16x16x32_bf16 v[84:87], v[4:7], v[20:23], v[84:87]
ds_read_b64_tr_b16 v[42:43], v130 offset:12288
s_nop 1
v_cmp_ge_u32 vcc, s28, v229
v_mfma_f32_16x16x32_bf16 v[88:91], v[8:11], v[20:23], v[88:91]
ds_read_b64_tr_b16 v[44:45], v131 offset:8192
s_nop 1
s_bcnt1_i32_b64 s32, vcc
v_mfma_f32_16x16x32_bf16 v[92:95], v[12:15], v[20:23], v[92:95]
ds_read_b64_tr_b16 v[46:47], v131 offset:12288
buffer_load_dwordx4 v139, s[8:11], s15 offen offset:2048 lds
s_sub_u32 s32, s32, 1
v_readlane_b32 s36, v230, s32
s_nop 1
v_mfma_f32_16x16x32_bf16 v[96:99], v[0:3], v[24:27], v[96:99]
ds_read_b128 v[52:55], v136 offset:3072
s_and_b32 s32, s36, 0x7ff
s_sub_u32 s28, s28, s32
v_mfma_f32_16x16x32_bf16 v[100:103], v[4:7], v[24:27], v[100:103]
ds_read_b128 v[56:59], v136 offset:5120
buffer_load_dwordx4 v140, s[8:11], s15 offen offset:3072 lds
s_bfe_u32 s32, s36, 0x3001a
s_lshr_b32 s25, s28, s32
v_mfma_f32_16x16x32_bf16 v[104:107], v[8:11], v[24:27], v[104:107]
ds_read_b128 v[60:63], v136 offset:7168
s_lshl_b32 s33, s25, s32
s_sub_u32 s24, s28, s33
v_mfma_f32_16x16x32_bf16 v[108:111], v[12:15], v[24:27], v[108:111]
s_bfe_u32 s34, s36, 0x1001d
s_lshl_b32 s24, s24, s34
s_bfe_u32 s35, s36, 0x1001e
v_mfma_f32_16x16x32_bf16 v[112:115], v[0:3], v[28:31], v[112:115]
s_add_u32 s15, s15, s17
s_lshl_b32 s25, s25, s35
s_bfe_u32 s32, s36, 0x40011
v_mfma_f32_16x16x32_bf16 v[116:119], v[4:7], v[28:31], v[116:119]
s_add_u32 s24, s24, s32
s_bfe_u32 s32, s36, 0x50015
v_mfma_f32_16x16x32_bf16 v[120:123], v[8:11], v[28:31], v[120:123]
s_add_u32 s25, s25, s32
s_bfe_u32 s23, s36, 0x4000b
v_mfma_f32_16x16x32_bf16 v[124:127], v[12:15], v[28:31], v[124:127]
s_waitcnt lgkmcnt(0)
v_mfma_f32_16x16x32_bf16 v[64:67], v[32:35], v[48:51], v[64:67]
s_waitcnt vmcnt(16)
s_barrier
ds_read_b128 v[16:19], v136 offset:16384
s_add_u32 m0, s20, 0
s_nop 0
s_bfe_u32 s36, s36, 0x6000b
s_lshl_b32 s32, s24, 8
s_or_b32 s36, s36, s32
v_mfma_f32_16x16x32_bf16 v[68:71], v[36:39], v[48:51], v[68:71]
ds_read_b64_tr_b16 v[0:1], v128 offset:16384
s_lshl_b32 s32, s25, 16
s_or_b32 s36, s36, s32
v_mfma_f32_16x16x32_bf16 v[72:75], v[40:43], v[48:51], v[72:75]
ds_read_b64_tr_b16 v[2:3], v128 offset:20480
buffer_load_dwordx4 v141, s[4:7], s16 offen offset:0 sc1 lds
s_cmp_eq_u32 s23, 4
s_cselect_b32 s32, 1, 0
s_sub_u32 s48, s24, s32
v_mfma_f32_16x16x32_bf16 v[76:79], v[44:47], v[48:51], v[76:79]
ds_read_b64_tr_b16 v[4:5], v129 offset:16384
s_max_i32 s48, s48, 0
s_add_u32 s49, s24, s34
s_add_u32 s49, s49, s32
v_mfma_f32_16x16x32_bf16 v[80:83], v[32:35], v[52:55], v[80:83]
ds_read_b64_tr_b16 v[6:7], v129 offset:20480
s_min_u32 s49, s49, 15
s_cmp_eq_u32 s23, 6
s_cselect_b32 s51, 3, 7
v_mfma_f32_16x16x32_bf16 v[84:87], v[36:39], v[52:55], v[84:87]
ds_read_b64_tr_b16 v[8:9], v130 offset:16384
buffer_load_dwordx4 v141, s[4:7], s16 offen offset:1024 sc1 lds
s_cmp_eq_u32 s23, 7
s_cselect_b32 s51, 27, s51
s_cselect_b32 s50, 5, 4
s_add_u32 s33, s25, s35
v_mfma_f32_16x16x32_bf16 v[88:91], v[40:43], v[52:55], v[88:91]
ds_read_b64_tr_b16 v[10:11], v130 offset:20480
s_lshl_b32 s34, s24, 9
s_cmp_eq_u32 s23, 8
s_cselect_b32 s51, 0, s51
s_cselect_b32 s48, s25, s48
s_cselect_b32 s49, s33, s49
v_mfma_f32_16x16x32_bf16 v[92:95], v[44:47], v[52:55], v[92:95]
ds_read_b64_tr_b16 v[12:13], v131 offset:16384
buffer_load_dwordx4 v142, s[4:7], s16 offen offset:2048 sc1 lds
s_cmp_eq_u32 s23, 8
s_cselect_b32 s63, 2, 9
s_cselect_b32 s61, 0, 0x7f000000
s_cselect_b32 s34, s34, 0
v_lshrrev_b32 v228, s50, v250
v_lshlrev_b32 v254, s50, v228
v_mfma_f32_16x16x32_bf16 v[96:99], v[32:35], v[56:59], v[96:99]
ds_read_b64_tr_b16 v[14:15], v131 offset:20480
v_sub_u32 v254, v250, v254
s_cmp_lt_u32 s23, 4
s_cselect_b32 s39, 10, s23
v_mfma_f32_16x16x32_bf16 v[100:103], v[36:39], v[56:59], v[100:103]
ds_read_b128 v[20:23], v136 offset:18432
v_min_u32 v254, s51, v254
s_lshl_b32 s39, s39, 13
v_mfma_f32_16x16x32_bf16 v[104:107], v[40:43], v[56:59], v[104:107]
ds_read_b128 v[24:27], v136 offset:20480
buffer_load_dwordx4 v142, s[4:7], s16 offen offset:3072 sc1 lds
s_cmp_eq_u32 s23, 3
s_cselect_b32 s34, 4, s34
v_add_u32 v228, s48, v228
v_mfma_f32_16x16x32_bf16 v[108:111], v[44:47], v[56:59], v[108:111]
ds_read_b128 v[28:31], v136 offset:22528
s_add_u32 s39, s39, s34
s_add_u32 s39, s39, 0x8402000
v_min_u32 v228, s49, v228
v_mfma_f32_16x16x32_bf16 v[112:115], v[32:35], v[60:63], v[112:115]
s_add_u32 s16, s16, 2048
s_lshl_b32 s60, s24, 10
s_add_u32 s60, s60, 0x8400000
v_mfma_f32_16x16x32_bf16 v[116:119], v[36:39], v[60:63], v[116:119]
v_lshlrev_b32 v228, s63, v228
v_lshl_add_u32 v228, v254, 4, v228
v_mfma_f32_16x16x32_bf16 v[120:123], v[40:43], v[60:63], v[120:123]
v_or_b32 v146, s61, v251
s_mov_b64 exec, s[100:101]
buffer_load_dword v231, v228, s[4:7], s39 offen sc1
buffer_load_dwordx4 v[232:235], v146, s[4:7], s60 offen sc1
s_mov_b64 exec, -1
v_mfma_f32_16x16x32_bf16 v[124:127], v[44:47], v[60:63], v[124:127]
s_waitcnt lgkmcnt(0)
ds_read_b128 v[48:51], v136 offset:17408
s_add_u32 m0, s19, 0
s_nop 0
v_mfma_f32_16x16x32_bf16 v[64:67], v[0:3], v[16:19], v[64:67]
ds_read_b64_tr_b16 v[32:33], v128 offset:24576
s_mov_b32 s1, s21
v_mfma_f32_16x16x32_bf16 v[68:71], v[4:7], v[16:19], v[68:71]
ds_read_b64_tr_b16 v[34:35], v128 offset:28672
buffer_load_dwordx4 v137, s[8:11], s15 offen offset:0 lds
s_mov_b32 s2, s22
v_mfma_f32_16x16x32_bf16 v[72:75], v[8:11], v[16:19], v[72:75]
ds_read_b64_tr_b16 v[36:37], v129 offset:24576
s_mov_b32 s3, s26
v_mfma_f32_16x16x32_bf16 v[76:79], v[12:15], v[16:19], v[76:79]
ds_read_b64_tr_b16 v[38:39], v129 offset:28672
s_mov_b32 s56, s57
v_mfma_f32_16x16x32_bf16 v[80:83], v[0:3], v[20:23], v[80:83]
ds_read_b64_tr_b16 v[40:41], v130 offset:24576
buffer_load_dwordx4 v138, s[8:11], s15 offen offset:1024 lds
v_mfma_f32_16x16x32_bf16 v[84:87], v[4:7], v[20:23], v[84:87]
ds_read_b64_tr_b16 v[42:43], v130 offset:28672
v_mov_b32 v145, v252
v_mfma_f32_16x16x32_bf16 v[88:91], v[8:11], v[20:23], v[88:91]
ds_read_b64_tr_b16 v[44:45], v131 offset:24576
v_mov_b32 v255, 131072
v_mfma_f32_16x16x32_bf16 v[92:95], v[12:15], v[20:23], v[92:95]
ds_read_b64_tr_b16 v[46:47], v131 offset:28672
buffer_load_dwordx4 v139, s[8:11], s15 offen offset:2048 lds
s_add_u32 s32, s3, 0
v_mfma_f32_16x16x32_bf16 v[96:99], v[0:3], v[24:27], v[96:99]
ds_read_b128 v[52:55], v136 offset:19456
buffer_load_dwordx4 v[192:195], v251, s[4:7], s32 offen offset:0 sc1
v_mfma_f32_16x16x32_bf16 v[100:103], v[4:7], v[24:27], v[100:103]
ds_read_b128 v[56:59], v136 offset:21504
buffer_load_dwordx4 v140, s[8:11], s15 offen offset:3072 lds
v_mfma_f32_16x16x32_bf16 v[104:107], v[8:11], v[24:27], v[104:107]
ds_read_b128 v[60:63], v136 offset:23552
buffer_load_dwordx4 v[196:199], v251, s[4:7], s32 offen offset:1024 sc1
v_mfma_f32_16x16x32_bf16 v[108:111], v[12:15], v[24:27], v[108:111]
s_add_u32 s32, s3, 32768
v_mfma_f32_16x16x32_bf16 v[112:115], v[0:3], v[28:31], v[112:115]
s_add_u32 s15, s15, s17
buffer_load_dwordx4 v[200:203], v251, s[4:7], s32 offen offset:0 sc1
v_mfma_f32_16x16x32_bf16 v[116:119], v[4:7], v[28:31], v[116:119]
buffer_load_dwordx4 v[204:207], v251, s[4:7], s32 offen offset:1024 sc1
v_mfma_f32_16x16x32_bf16 v[120:123], v[8:11], v[28:31], v[120:123]
v_mfma_f32_16x16x32_bf16 v[124:127], v[12:15], v[28:31], v[124:127]
s_waitcnt lgkmcnt(0)
v_mfma_f32_16x16x32_bf16 v[64:67], v[32:35], v[48:51], v[64:67]
s_waitcnt vmcnt(20)
s_barrier
ds_read_b128 v[16:19], v136 offset:32768
s_add_u32 m0, s20, 16384
s_nop 0
s_add_u32 s32, s3, 65536
v_mfma_f32_16x16x32_bf16 v[68:71], v[36:39], v[48:51], v[68:71]
ds_read_b64_tr_b16 v[0:1], v128 offset:32768
v_mfma_f32_16x16x32_bf16 v[72:75], v[40:43], v[48:51], v[72:75]
ds_read_b64_tr_b16 v[2:3], v128 offset:36864
buffer_load_dwordx4 v141, s[4:7], s16 offen offset:0 sc1 lds
buffer_load_dwordx4 v[208:211], v251, s[4:7], s32 offen offset:0 sc1
v_mfma_f32_16x16x32_bf16 v[76:79], v[44:47], v[48:51], v[76:79]
ds_read_b64_tr_b16 v[4:5], v129 offset:32768
v_mfma_f32_16x16x32_bf16 v[80:83], v[32:35], v[52:55], v[80:83]
ds_read_b64_tr_b16 v[6:7], v129 offset:36864
v_mfma_f32_16x16x32_bf16 v[84:87], v[36:39], v[52:55], v[84:87]
ds_read_b64_tr_b16 v[8:9], v130 offset:32768
buffer_load_dwordx4 v141, s[4:7], s16 offen offset:1024 sc1 lds
buffer_load_dwordx4 v[212:215], v251, s[4:7], s32 offen offset:1024 sc1
v_mfma_f32_16x16x32_bf16 v[88:91], v[40:43], v[52:55], v[88:91]
ds_read_b64_tr_b16 v[10:11], v130 offset:36864
v_mfma_f32_16x16x32_bf16 v[92:95], v[44:47], v[52:55], v[92:95]
ds_read_b64_tr_b16 v[12:13], v131 offset:32768
buffer_load_dwordx4 v142, s[4:7], s16 offen offset:2048 sc1 lds
s_add_u32 s32, s3, 98304
v_mfma_f32_16x16x32_bf16 v[96:99], v[32:35], v[56:59], v[96:99]
ds_read_b64_tr_b16 v[14:15], v131 offset:36864
v_mfma_f32_16x16x32_bf16 v[100:103], v[36:39], v[56:59], v[100:103]
ds_read_b128 v[20:23], v136 offset:34816
v_mfma_f32_16x16x32_bf16 v[104:107], v[40:43], v[56:59], v[104:107]
ds_read_b128 v[24:27], v136 offset:36864
buffer_load_dwordx4 v142, s[4:7], s16 offen offset:3072 sc1 lds
buffer_load_dwordx4 v[216:219], v251, s[4:7], s32 offen offset:0 sc1
v_mfma_f32_16x16x32_bf16 v[108:111], v[44:47], v[56:59], v[108:111]
ds_read_b128 v[28:31], v136 offset:38912
v_mfma_f32_16x16x32_bf16 v[112:115], v[32:35], v[60:63], v[112:115]
s_add_u32 s16, s16, 2048
buffer_load_dwordx4 v[220:223], v251, s[4:7], s32 offen offset:1024 sc1
v_mfma_f32_16x16x32_bf16 v[116:119], v[36:39], v[60:63], v[116:119]
v_mfma_f32_16x16x32_bf16 v[120:123], v[40:43], v[60:63], v[120:123]
v_mfma_f32_16x16x32_bf16 v[124:127], v[44:47], v[60:63], v[124:127]
s_cmp_lg_u32 s56, 5
s_cbranch_scc1 main_kernel_w_c0_n_nox
s_add_u32 s32, s1, 0
buffer_load_dwordx4 v[160:163], v145, s[96:99], s32 offen offset:0
buffer_load_dwordx4 v[164:167], v145, s[96:99], s32 offen offset:64
s_add_u32 s32, s1, 32768
buffer_load_dwordx4 v[168:171], v145, s[96:99], s32 offen offset:0
buffer_load_dwordx4 v[172:175], v145, s[96:99], s32 offen offset:64
s_add_u32 s32, s1, 65536
buffer_load_dwordx4 v[176:179], v145, s[96:99], s32 offen offset:0
buffer_load_dwordx4 v[180:183], v145, s[96:99], s32 offen offset:64
s_add_u32 s32, s1, 98304
buffer_load_dwordx4 v[184:187], v145, s[96:99], s32 offen offset:0
buffer_load_dwordx4 v[188:191], v145, s[96:99], s32 offen offset:64
main_kernel_w_c0_n_nox:
s_waitcnt lgkmcnt(0)
ds_read_b128 v[48:51], v136 offset:33792
s_add_u32 m0, s19, 16384
s_nop 0
v_mfma_f32_16x16x32_bf16 v[64:67], v[0:3], v[16:19], v[64:67]
ds_read_b64_tr_b16 v[32:33], v128 offset:40960
v_mfma_f32_16x16x32_bf16 v[68:71], v[4:7], v[16:19], v[68:71]
ds_read_b64_tr_b16 v[34:35], v128 offset:45056
buffer_load_dwordx4 v137, s[8:11], s15 offen offset:0 lds
v_mfma_f32_16x16x32_bf16 v[72:75], v[8:11], v[16:19], v[72:75]
ds_read_b64_tr_b16 v[36:37], v129 offset:40960
v_mfma_f32_16x16x32_bf16 v[76:79], v[12:15], v[16:19], v[76:79]
ds_read_b64_tr_b16 v[38:39], v129 offset:45056
v_mfma_f32_16x16x32_bf16 v[80:83], v[0:3], v[20:23], v[80:83]
ds_read_b64_tr_b16 v[40:41], v130 offset:40960
buffer_load_dwordx4 v138, s[8:11], s15 offen offset:1024 lds
v_mfma_f32_16x16x32_bf16 v[84:87], v[4:7], v[20:23], v[84:87]
ds_read_b64_tr_b16 v[42:43], v130 offset:45056
v_mfma_f32_16x16x32_bf16 v[88:91], v[8:11], v[20:23], v[88:91]
ds_read_b64_tr_b16 v[44:45], v131 offset:40960
v_mfma_f32_16x16x32_bf16 v[92:95], v[12:15], v[20:23], v[92:95]
ds_read_b64_tr_b16 v[46:47], v131 offset:45056
buffer_load_dwordx4 v139, s[8:11], s15 offen offset:2048 lds
v_mfma_f32_16x16x32_bf16 v[96:99], v[0:3], v[24:27], v[96:99]
ds_read_b128 v[52:55], v136 offset:35840
v_mfma_f32_16x16x32_bf16 v[100:103], v[4:7], v[24:27], v[100:103]
ds_read_b128 v[56:59], v136 offset:37888
buffer_load_dwordx4 v140, s[8:11], s15 offen offset:3072 lds
v_mfma_f32_16x16x32_bf16 v[104:107], v[8:11], v[24:27], v[104:107]
ds_read_b128 v[60:63], v136 offset:39936
v_mfma_f32_16x16x32_bf16 v[108:111], v[12:15], v[24:27], v[108:111]
v_mfma_f32_16x16x32_bf16 v[112:115], v[0:3], v[28:31], v[112:115]
s_add_u32 s15, s15, s17
v_mfma_f32_16x16x32_bf16 v[116:119], v[4:7], v[28:31], v[116:119]
v_mfma_f32_16x16x32_bf16 v[120:123], v[8:11], v[28:31], v[120:123]
v_mfma_f32_16x16x32_bf16 v[124:127], v[12:15], v[28:31], v[124:127]
s_waitcnt lgkmcnt(0)
v_mfma_f32_16x16x32_bf16 v[64:67], v[32:35], v[48:51], v[64:67]
s_waitcnt vmcnt(24)
s_barrier
ds_read_b128 v[16:19], v136 offset:49152
s_add_u32 m0, s20, 32768
s_nop 0
v_mfma_f32_16x16x32_bf16 v[68:71], v[36:39], v[48:51], v[68:71]
ds_read_b64_tr_b16 v[0:1], v128 offset:49152
v_mfma_f32_16x16x32_bf16 v[72:75], v[40:43], v[48:51], v[72:75]
ds_read_b64_tr_b16 v[2:3], v128 offset:53248
buffer_load_dwordx4 v141, s[4:7], s16 offen offset:0 sc1 lds
v_mfma_f32_16x16x32_bf16 v[76:79], v[44:47], v[48:51], v[76:79]
ds_read_b64_tr_b16 v[4:5], v129 offset:49152
v_mfma_f32_16x16x32_bf16 v[80:83], v[32:35], v[52:55], v[80:83]
ds_read_b64_tr_b16 v[6:7], v129 offset:53248
s_waitcnt vmcnt(21)
v_min3_u32 v253, v232, v233, v234
v_mfma_f32_16x16x32_bf16 v[84:87], v[36:39], v[52:55], v[84:87]
ds_read_b64_tr_b16 v[8:9], v130 offset:49152
buffer_load_dwordx4 v141, s[4:7], s16 offen offset:1024 sc1 lds
v_min_u32 v253, v253, v235
v_mfma_f32_16x16x32_bf16 v[88:91], v[40:43], v[52:55], v[88:91]
ds_read_b64_tr_b16 v[10:11], v130 offset:53248
v_or_b32 v253, s61, v253
v_mfma_f32_16x16x32_bf16 v[92:95], v[44:47], v[52:55], v[92:95]
ds_read_b64_tr_b16 v[12:13], v131 offset:49152
buffer_load_dwordx4 v142, s[4:7], s16 offen offset:2048 sc1 lds
v_min_u32 v253, v253, v231
v_mfma_f32_16x16x32_bf16 v[96:99], v[32:35], v[56:59], v[96:99]
ds_read_b64_tr_b16 v[14:15], v131 offset:53248
v_cmp_eq_u32 vcc, 0, v253
v_mfma_f32_16x16x32_bf16 v[100:103], v[36:39], v[56:59], v[100:103]
ds_read_b128 v[20:23], v136 offset:51200
s_nop 1
v_mfma_f32_16x16x32_bf16 v[104:107], v[40:43], v[56:59], v[104:107]
ds_read_b128 v[24:27], v136 offset:53248
buffer_load_dwordx4 v142, s[4:7], s16 offen offset:3072 sc1 lds
s_cmp_eq_u64 vcc, 0
s_cselect_b32 s32, s36, -4
v_mfma_f32_16x16x32_bf16 v[108:111], v[44:47], v[56:59], v[108:111]
ds_read_b128 v[28:31], v136 offset:55296
s_bitcmp1_b32 0x1df, s23
s_cselect_b32 s32, s32, -4
v_mfma_f32_16x16x32_bf16 v[112:115], v[32:35], v[60:63], v[112:115]
s_add_u32 s16, s16, 2048
s_sub_u32 s33, s59, 0x8406000
s_cmp_lt_u32 s33, 0x4000
s_cselect_b32 s32, -4, s32
v_mfma_f32_16x16x32_bf16 v[116:119], v[36:39], v[60:63], v[116:119]
v_mov_b32 v254, s32
v_mfma_f32_16x16x32_bf16 v[120:123], v[40:43], v[60:63], v[120:123]
s_mov_b64 exec, s[100:101]
ds_write_b32 v255, v254
s_mov_b64 exec, -1
v_mfma_f32_16x16x32_bf16 v[124:127], v[44:47], v[60:63], v[124:127]
s_waitcnt lgkmcnt(0)
ds_read_b128 v[48:51], v136 offset:50176
s_add_u32 m0, s19, 32768
s_nop 0
v_mfma_f32_16x16x32_bf16 v[64:67], v[0:3], v[16:19], v[64:67]
ds_read_b64_tr_b16 v[32:33], v128 offset:57344
v_mfma_f32_16x16x32_bf16 v[68:71], v[4:7], v[16:19], v[68:71]
ds_read_b64_tr_b16 v[34:35], v128 offset:61440
buffer_load_dwordx4 v137, s[8:11], s15 offen offset:0 lds
v_mfma_f32_16x16x32_bf16 v[72:75], v[8:11], v[16:19], v[72:75]
ds_read_b64_tr_b16 v[36:37], v129 offset:57344
v_mfma_f32_16x16x32_bf16 v[76:79], v[12:15], v[16:19], v[76:79]
ds_read_b64_tr_b16 v[38:39], v129 offset:61440
v_mfma_f32_16x16x32_bf16 v[80:83], v[0:3], v[20:23], v[80:83]
ds_read_b64_tr_b16 v[40:41], v130 offset:57344
buffer_load_dwordx4 v138, s[8:11], s15 offen offset:1024 lds
v_mfma_f32_16x16x32_bf16 v[84:87], v[4:7], v[20:23], v[84:87]
ds_read_b64_tr_b16 v[42:43], v130 offset:61440
v_mfma_f32_16x16x32_bf16 v[88:91], v[8:11], v[20:23], v[88:91]
ds_read_b64_tr_b16 v[44:45], v131 offset:57344
v_mfma_f32_16x16x32_bf16 v[92:95], v[12:15], v[20:23], v[92:95]
ds_read_b64_tr_b16 v[46:47], v131 offset:61440
buffer_load_dwordx4 v139, s[8:11], s15 offen offset:2048 lds
v_mfma_f32_16x16x32_bf16 v[96:99], v[0:3], v[24:27], v[96:99]
ds_read_b128 v[52:55], v136 offset:52224
v_mfma_f32_16x16x32_bf16 v[100:103], v[4:7], v[24:27], v[100:103]
ds_read_b128 v[56:59], v136 offset:54272
buffer_load_dwordx4 v140, s[8:11], s15 offen offset:3072 lds
v_mfma_f32_16x16x32_bf16 v[104:107], v[8:11], v[24:27], v[104:107]
ds_read_b128 v[60:63], v136 offset:56320
v_mfma_f32_16x16x32_bf16 v[108:111], v[12:15], v[24:27], v[108:111]
v_mfma_f32_16x16x32_bf16 v[112:115], v[0:3], v[28:31], v[112:115]
s_add_u32 s15, s15, s17
v_mfma_f32_16x16x32_bf16 v[116:119], v[4:7], v[28:31], v[116:119]
v_mfma_f32_16x16x32_bf16 v[120:123], v[8:11], v[28:31], v[120:123]
v_mfma_f32_16x16x32_bf16 v[124:127], v[12:15], v[28:31], v[124:127]
s_waitcnt lgkmcnt(0)
v_mfma_f32_16x16x32_bf16 v[64:67], v[32:35], v[48:51], v[64:67]
s_waitcnt vmcnt(23)
s_barrier
ds_read_b128 v[16:19], v136 offset:0
s_add_u32 m0, s20, 49152
s_nop 0
ds_read_b32 v254, v255
v_mfma_f32_16x16x32_bf16 v[68:71], v[36:39], v[48:51], v[68:71]
ds_read_b64_tr_b16 v[0:1], v128 offset:0
v_mfma_f32_16x16x32_bf16 v[72:75], v[40:43], v[48:51], v[72:75]
ds_read_b64_tr_b16 v[2:3], v128 offset:4096
buffer_load_dwordx4 v141, s[4:7], s16 offen offset:0 sc1 lds
v_mfma_f32_16x16x32_bf16 v[76:79], v[44:47], v[48:51], v[76:79]
ds_read_b64_tr_b16 v[4:5], v129 offset:0
v_mfma_f32_16x16x32_bf16 v[80:83], v[32:35], v[52:55], v[80:83]
ds_read_b64_tr_b16 v[6:7], v129 offset:4096
v_mfma_f32_16x16x32_bf16 v[84:87], v[36:39], v[52:55], v[84:87]
ds_read_b64_tr_b16 v[8:9], v130 offset:0
buffer_load_dwordx4 v141, s[4:7], s16 offen offset:1024 sc1 lds
v_mfma_f32_16x16x32_bf16 v[88:91], v[40:43], v[52:55], v[88:91]
ds_read_b64_tr_b16 v[10:11], v130 offset:4096
v_mfma_f32_16x16x32_bf16 v[92:95], v[44:47], v[52:55], v[92:95]
ds_read_b64_tr_b16 v[12:13], v131 offset:0
buffer_load_dwordx4 v142, s[4:7], s16 offen offset:2048 sc1 lds
v_mfma_f32_16x16x32_bf16 v[96:99], v[32:35], v[56:59], v[96:99]
ds_read_b64_tr_b16 v[14:15], v131 offset:4096
v_mfma_f32_16x16x32_bf16 v[100:103], v[36:39], v[56:59], v[100:103]
ds_read_b128 v[20:23], v136 offset:2048
v_mfma_f32_16x16x32_bf16 v[104:107], v[40:43], v[56:59], v[104:107]
ds_read_b128 v[24:27], v136 offset:4096
buffer_load_dwordx4 v142, s[4:7], s16 offen offset:3072 sc1 lds
v_mfma_f32_16x16x32_bf16 v[108:111], v[44:47], v[56:59], v[108:111]
ds_read_b128 v[28:31], v136 offset:6144
v_mfma_f32_16x16x32_bf16 v[112:115], v[32:35], v[60:63], v[112:115]
s_add_u32 s16, s16, 2048
v_mfma_f32_16x16x32_bf16 v[116:119], v[36:39], v[60:63], v[116:119]
v_mfma_f32_16x16x32_bf16 v[120:123], v[40:43], v[60:63], v[120:123]
v_mfma_f32_16x16x32_bf16 v[124:127], v[44:47], v[60:63], v[124:127]
s_waitcnt lgkmcnt(0)
ds_read_b128 v[48:51], v136 offset:1024
s_add_u32 m0, s19, 49152
s_nop 0
v_mfma_f32_16x16x32_bf16 v[64:67], v[0:3], v[16:19], v[64:67]
ds_read_b64_tr_b16 v[32:33], v128 offset:8192
v_readfirstlane_b32 s62, v254
v_mfma_f32_16x16x32_bf16 v[68:71], v[4:7], v[16:19], v[68:71]
ds_read_b64_tr_b16 v[34:35], v128 offset:12288
buffer_load_dwordx4 v137, s[8:11], s15 offen offset:0 lds
v_mfma_f32_16x16x32_bf16 v[72:75], v[8:11], v[16:19], v[72:75]
ds_read_b64_tr_b16 v[36:37], v129 offset:8192
s_nop 1
v_mfma_f32_16x16x32_bf16 v[76:79], v[12:15], v[16:19], v[76:79]
ds_read_b64_tr_b16 v[38:39], v129 offset:12288
v_mfma_f32_16x16x32_bf16 v[80:83], v[0:3], v[20:23], v[80:83]
ds_read_b64_tr_b16 v[40:41], v130 offset:8192
buffer_load_dwordx4 v138, s[8:11], s15 offen offset:1024 lds
v_mfma_f32_16x16x32_bf16 v[84:87], v[4:7], v[20:23], v[84:87]
ds_read_b64_tr_b16 v[42:43], v130 offset:12288
s_and_b32 s23, s62, 15
v_mfma_f32_16x16x32_bf16 v[88:91], v[8:11], v[20:23], v[88:91]
ds_read_b64_tr_b16 v[44:45], v131 offset:8192
v_mfma_f32_16x16x32_bf16 v[92:95], v[12:15], v[20:23], v[92:95]
ds_read_b64_tr_b16 v[46:47], v131 offset:12288
buffer_load_dwordx4 v139, s[8:11], s15 offen offset:2048 lds
s_bfe_u32 s54, s62, 0x20004
v_mfma_f32_16x16x32_bf16 v[96:99], v[0:3], v[24:27], v[96:99]
ds_read_b128 v[52:55], v136 offset:3072
v_mfma_f32_16x16x32_bf16 v[100:103], v[4:7], v[24:27], v[100:103]
ds_read_b128 v[56:59], v136 offset:5120
buffer_load_dwordx4 v140, s[8:11], s15 offen offset:3072 lds
v_mfma_f32_16x16x32_bf16 v[104:107], v[8:11], v[24:27], v[104:107]
ds_read_b128 v[60:63], v136 offset:7168
s_bfe_u32 s24, s62, 0x80008
v_mfma_f32_16x16x32_bf16 v[108:111], v[12:15], v[24:27], v[108:111]
v_mfma_f32_16x16x32_bf16 v[112:115], v[0:3], v[28:31], v[112:115]
s_add_u32 s15, s15, s17
s_lshr_b32 s25, s62, 16
v_mfma_f32_16x16x32_bf16 v[116:119], v[4:7], v[28:31], v[116:119]
v_mfma_f32_16x16x32_bf16 v[120:123], v[8:11], v[28:31], v[120:123]
v_mfma_f32_16x16x32_bf16 v[124:127], v[12:15], v[28:31], v[124:127]
s_cmp_eq_u32 s54, 0
s_cselect_b32 s73, 0, -1
s_cbranch_scc1 main_kernel_w_c0_task
s_waitcnt lgkmcnt(0)
v_mfma_f32_16x16x32_bf16 v[64:67], v[32:35], v[48:51], v[64:67]
s_waitcnt vmcnt(16)
s_barrier
ds_read_b128 v[16:19], v136 offset:16384
v_mfma_f32_16x16x32_bf16 v[68:71], v[36:39], v[48:51], v[68:71]
ds_read_b64_tr_b16 v[0:1], v128 offset:16384
v_mfma_f32_16x16x32_bf16 v[72:75], v[40:43], v[48:51], v[72:75]
ds_read_b64_tr_b16 v[2:3], v128 offset:20480
v_mfma_f32_16x16x32_bf16 v[76:79], v[44:47], v[48:51], v[76:79]
ds_read_b64_tr_b16 v[4:5], v129 offset:16384
v_mfma_f32_16x16x32_bf16 v[80:83], v[32:35], v[52:55], v[80:83]
ds_read_b64_tr_b16 v[6:7], v129 offset:20480
v_mfma_f32_16x16x32_bf16 v[84:87], v[36:39], v[52:55], v[84:87]
ds_read_b64_tr_b16 v[8:9], v130 offset:16384
v_mfma_f32_16x16x32_bf16 v[88:91], v[40:43], v[52:55], v[88:91]
ds_read_b64_tr_b16 v[10:11], v130 offset:20480
v_mfma_f32_16x16x32_bf16 v[92:95], v[44:47], v[52:55], v[92:95]
ds_read_b64_tr_b16 v[12:13], v131 offset:16384
v_mfma_f32_16x16x32_bf16 v[96:99], v[32:35], v[56:59], v[96:99]
ds_read_b64_tr_b16 v[14:15], v131 offset:20480
v_mfma_f32_16x16x32_bf16 v[100:103], v[36:39], v[56:59], v[100:103]
ds_read_b128 v[20:23], v136 offset:18432
v_mfma_f32_16x16x32_bf16 v[104:107], v[40:43], v[56:59], v[104:107]
ds_read_b128 v[24:27], v136 offset:20480
v_mfma_f32_16x16x32_bf16 v[108:111], v[44:47], v[56:59], v[108:111]
ds_read_b128 v[28:31], v136 offset:22528
v_mfma_f32_16x16x32_bf16 v[112:115], v[32:35], v[60:63], v[112:115]
v_mfma_f32_16x16x32_bf16 v[116:119], v[36:39], v[60:63], v[116:119]
v_mfma_f32_16x16x32_bf16 v[120:123], v[40:43], v[60:63], v[120:123]
v_mfma_f32_16x16x32_bf16 v[124:127], v[44:47], v[60:63], v[124:127]
s_waitcnt lgkmcnt(0)
ds_read_b128 v[48:51], v136 offset:17408
v_mfma_f32_16x16x32_bf16 v[64:67], v[0:3], v[16:19], v[64:67]
ds_read_b64_tr_b16 v[32:33], v128 offset:24576
v_mfma_f32_16x16x32_bf16 v[68:71], v[4:7], v[16:19], v[68:71]
ds_read_b64_tr_b16 v[34:35], v128 offset:28672
v_mfma_f32_16x16x32_bf16 v[72:75], v[8:11], v[16:19], v[72:75]
ds_read_b64_tr_b16 v[36:37], v129 offset:24576
v_mfma_f32_16x16x32_bf16 v[76:79], v[12:15], v[16:19], v[76:79]
ds_read_b64_tr_b16 v[38:39], v129 offset:28672
v_mfma_f32_16x16x32_bf16 v[80:83], v[0:3], v[20:23], v[80:83]
ds_read_b64_tr_b16 v[40:41], v130 offset:24576
v_mfma_f32_16x16x32_bf16 v[84:87], v[4:7], v[20:23], v[84:87]
ds_read_b64_tr_b16 v[42:43], v130 offset:28672
v_mfma_f32_16x16x32_bf16 v[88:91], v[8:11], v[20:23], v[88:91]
ds_read_b64_tr_b16 v[44:45], v131 offset:24576
v_mfma_f32_16x16x32_bf16 v[92:95], v[12:15], v[20:23], v[92:95]
ds_read_b64_tr_b16 v[46:47], v131 offset:28672
v_mfma_f32_16x16x32_bf16 v[96:99], v[0:3], v[24:27], v[96:99]
ds_read_b128 v[52:55], v136 offset:19456
v_mfma_f32_16x16x32_bf16 v[100:103], v[4:7], v[24:27], v[100:103]
ds_read_b128 v[56:59], v136 offset:21504
v_mfma_f32_16x16x32_bf16 v[104:107], v[8:11], v[24:27], v[104:107]
ds_read_b128 v[60:63], v136 offset:23552
v_mfma_f32_16x16x32_bf16 v[108:111], v[12:15], v[24:27], v[108:111]
v_mfma_f32_16x16x32_bf16 v[112:115], v[0:3], v[28:31], v[112:115]
v_mfma_f32_16x16x32_bf16 v[116:119], v[4:7], v[28:31], v[116:119]
v_mfma_f32_16x16x32_bf16 v[120:123], v[8:11], v[28:31], v[120:123]
v_mfma_f32_16x16x32_bf16 v[124:127], v[12:15], v[28:31], v[124:127]
s_waitcnt lgkmcnt(0)
v_mfma_f32_16x16x32_bf16 v[64:67], v[32:35], v[48:51], v[64:67]
s_waitcnt vmcnt(8)
s_barrier
ds_read_b128 v[16:19], v136 offset:32768
v_mfma_f32_16x16x32_bf16 v[68:71], v[36:39], v[48:51], v[68:71]
ds_read_b64_tr_b16 v[0:1], v128 offset:32768
v_mfma_f32_16x16x32_bf16 v[72:75], v[40:43], v[48:51], v[72:75]
ds_read_b64_tr_b16 v[2:3], v128 offset:36864
v_mfma_f32_16x16x32_bf16 v[76:79], v[44:47], v[48:51], v[76:79]
ds_read_b64_tr_b16 v[4:5], v129 offset:32768
v_mfma_f32_16x16x32_bf16 v[80:83], v[32:35], v[52:55], v[80:83]
ds_read_b64_tr_b16 v[6:7], v129 offset:36864
v_mfma_f32_16x16x32_bf16 v[84:87], v[36:39], v[52:55], v[84:87]
ds_read_b64_tr_b16 v[8:9], v130 offset:32768
v_mfma_f32_16x16x32_bf16 v[88:91], v[40:43], v[52:55], v[88:91]
ds_read_b64_tr_b16 v[10:11], v130 offset:36864
v_mfma_f32_16x16x32_bf16 v[92:95], v[44:47], v[52:55], v[92:95]
ds_read_b64_tr_b16 v[12:13], v131 offset:32768
v_mfma_f32_16x16x32_bf16 v[96:99], v[32:35], v[56:59], v[96:99]
ds_read_b64_tr_b16 v[14:15], v131 offset:36864
v_mfma_f32_16x16x32_bf16 v[100:103], v[36:39], v[56:59], v[100:103]
ds_read_b128 v[20:23], v136 offset:34816
v_mfma_f32_16x16x32_bf16 v[104:107], v[40:43], v[56:59], v[104:107]
ds_read_b128 v[24:27], v136 offset:36864
v_mfma_f32_16x16x32_bf16 v[108:111], v[44:47], v[56:59], v[108:111]
ds_read_b128 v[28:31], v136 offset:38912
v_mfma_f32_16x16x32_bf16 v[112:115], v[32:35], v[60:63], v[112:115]
v_mfma_f32_16x16x32_bf16 v[116:119], v[36:39], v[60:63], v[116:119]
v_mfma_f32_16x16x32_bf16 v[120:123], v[40:43], v[60:63], v[120:123]
v_mfma_f32_16x16x32_bf16 v[124:127], v[44:47], v[60:63], v[124:127]
s_waitcnt lgkmcnt(0)
ds_read_b128 v[48:51], v136 offset:33792
v_mfma_f32_16x16x32_bf16 v[64:67], v[0:3], v[16:19], v[64:67]
ds_read_b64_tr_b16 v[32:33], v128 offset:40960
v_mfma_f32_16x16x32_bf16 v[68:71], v[4:7], v[16:19], v[68:71]
ds_read_b64_tr_b16 v[34:35], v128 offset:45056
v_mfma_f32_16x16x32_bf16 v[72:75], v[8:11], v[16:19], v[72:75]
ds_read_b64_tr_b16 v[36:37], v129 offset:40960
v_mfma_f32_16x16x32_bf16 v[76:79], v[12:15], v[16:19], v[76:79]
ds_read_b64_tr_b16 v[38:39], v129 offset:45056
v_mfma_f32_16x16x32_bf16 v[80:83], v[0:3], v[20:23], v[80:83]
ds_read_b64_tr_b16 v[40:41], v130 offset:40960
v_mfma_f32_16x16x32_bf16 v[84:87], v[4:7], v[20:23], v[84:87]
ds_read_b64_tr_b16 v[42:43], v130 offset:45056
v_mfma_f32_16x16x32_bf16 v[88:91], v[8:11], v[20:23], v[88:91]
ds_read_b64_tr_b16 v[44:45], v131 offset:40960
v_mfma_f32_16x16x32_bf16 v[92:95], v[12:15], v[20:23], v[92:95]
ds_read_b64_tr_b16 v[46:47], v131 offset:45056
v_mfma_f32_16x16x32_bf16 v[96:99], v[0:3], v[24:27], v[96:99]
ds_read_b128 v[52:55], v136 offset:35840
v_mfma_f32_16x16x32_bf16 v[100:103], v[4:7], v[24:27], v[100:103]
ds_read_b128 v[56:59], v136 offset:37888
v_mfma_f32_16x16x32_bf16 v[104:107], v[8:11], v[24:27], v[104:107]
ds_read_b128 v[60:63], v136 offset:39936
v_mfma_f32_16x16x32_bf16 v[108:111], v[12:15], v[24:27], v[108:111]
v_mfma_f32_16x16x32_bf16 v[112:115], v[0:3], v[28:31], v[112:115]
v_mfma_f32_16x16x32_bf16 v[116:119], v[4:7], v[28:31], v[116:119]
v_mfma_f32_16x16x32_bf16 v[120:123], v[8:11], v[28:31], v[120:123]
v_mfma_f32_16x16x32_bf16 v[124:127], v[12:15], v[28:31], v[124:127]
s_waitcnt lgkmcnt(0)
v_mfma_f32_16x16x32_bf16 v[64:67], v[32:35], v[48:51], v[64:67]
s_waitcnt vmcnt(0)
s_barrier
ds_read_b128 v[16:19], v136 offset:49152
v_mfma_f32_16x16x32_bf16 v[68:71], v[36:39], v[48:51], v[68:71]
ds_read_b64_tr_b16 v[0:1], v128 offset:49152
v_mfma_f32_16x16x32_bf16 v[72:75], v[40:43], v[48:51], v[72:75]
ds_read_b64_tr_b16 v[2:3], v128 offset:53248
v_mfma_f32_16x16x32_bf16 v[76:79], v[44:47], v[48:51], v[76:79]
ds_read_b64_tr_b16 v[4:5], v129 offset:49152
v_mfma_f32_16x16x32_bf16 v[80:83], v[32:35], v[52:55], v[80:83]
ds_read_b64_tr_b16 v[6:7], v129 offset:53248
v_mfma_f32_16x16x32_bf16 v[84:87], v[36:39], v[52:55], v[84:87]
ds_read_b64_tr_b16 v[8:9], v130 offset:49152
v_mfma_f32_16x16x32_bf16 v[88:91], v[40:43], v[52:55], v[88:91]
ds_read_b64_tr_b16 v[10:11], v130 offset:53248
v_mfma_f32_16x16x32_bf16 v[92:95], v[44:47], v[52:55], v[92:95]
ds_read_b64_tr_b16 v[12:13], v131 offset:49152
v_mfma_f32_16x16x32_bf16 v[96:99], v[32:35], v[56:59], v[96:99]
ds_read_b64_tr_b16 v[14:15], v131 offset:53248
v_mfma_f32_16x16x32_bf16 v[100:103], v[36:39], v[56:59], v[100:103]
ds_read_b128 v[20:23], v136 offset:51200
v_mfma_f32_16x16x32_bf16 v[104:107], v[40:43], v[56:59], v[104:107]
ds_read_b128 v[24:27], v136 offset:53248
v_mfma_f32_16x16x32_bf16 v[108:111], v[44:47], v[56:59], v[108:111]
ds_read_b128 v[28:31], v136 offset:55296
v_mfma_f32_16x16x32_bf16 v[112:115], v[32:35], v[60:63], v[112:115]
v_mfma_f32_16x16x32_bf16 v[116:119], v[36:39], v[60:63], v[116:119]
v_mfma_f32_16x16x32_bf16 v[120:123], v[40:43], v[60:63], v[120:123]
v_mfma_f32_16x16x32_bf16 v[124:127], v[44:47], v[60:63], v[124:127]
s_waitcnt lgkmcnt(0)
ds_read_b128 v[48:51], v136 offset:50176
v_mfma_f32_16x16x32_bf16 v[64:67], v[0:3], v[16:19], v[64:67]
ds_read_b64_tr_b16 v[32:33], v128 offset:57344
v_mfma_f32_16x16x32_bf16 v[68:71], v[4:7], v[16:19], v[68:71]
ds_read_b64_tr_b16 v[34:35], v128 offset:61440
v_mfma_f32_16x16x32_bf16 v[72:75], v[8:11], v[16:19], v[72:75]
ds_read_b64_tr_b16 v[36:37], v129 offset:57344
v_mfma_f32_16x16x32_bf16 v[76:79], v[12:15], v[16:19], v[76:79]
ds_read_b64_tr_b16 v[38:39], v129 offset:61440
v_mfma_f32_16x16x32_bf16 v[80:83], v[0:3], v[20:23], v[80:83]
ds_read_b64_tr_b16 v[40:41], v130 offset:57344
v_mfma_f32_16x16x32_bf16 v[84:87], v[4:7], v[20:23], v[84:87]
ds_read_b64_tr_b16 v[42:43], v130 offset:61440
v_mfma_f32_16x16x32_bf16 v[88:91], v[8:11], v[20:23], v[88:91]
ds_read_b64_tr_b16 v[44:45], v131 offset:57344
v_mfma_f32_16x16x32_bf16 v[92:95], v[12:15], v[20:23], v[92:95]
ds_read_b64_tr_b16 v[46:47], v131 offset:61440
v_mfma_f32_16x16x32_bf16 v[96:99], v[0:3], v[24:27], v[96:99]
ds_read_b128 v[52:55], v136 offset:52224
v_mfma_f32_16x16x32_bf16 v[100:103], v[4:7], v[24:27], v[100:103]
ds_read_b128 v[56:59], v136 offset:54272
v_mfma_f32_16x16x32_bf16 v[104:107], v[8:11], v[24:27], v[104:107]
ds_read_b128 v[60:63], v136 offset:56320
v_mfma_f32_16x16x32_bf16 v[108:111], v[12:15], v[24:27], v[108:111]
v_mfma_f32_16x16x32_bf16 v[112:115], v[0:3], v[28:31], v[112:115]
v_mfma_f32_16x16x32_bf16 v[116:119], v[4:7], v[28:31], v[116:119]
v_mfma_f32_16x16x32_bf16 v[120:123], v[8:11], v[28:31], v[120:123]
v_mfma_f32_16x16x32_bf16 v[124:127], v[12:15], v[28:31], v[124:127]
s_waitcnt lgkmcnt(0)
v_mfma_f32_16x16x32_bf16 v[64:67], v[32:35], v[48:51], v[64:67]
s_barrier
v_mfma_f32_16x16x32_bf16 v[68:71], v[36:39], v[48:51], v[68:71]
v_mfma_f32_16x16x32_bf16 v[72:75], v[40:43], v[48:51], v[72:75]
v_mfma_f32_16x16x32_bf16 v[76:79], v[44:47], v[48:51], v[76:79]
v_mfma_f32_16x16x32_bf16 v[80:83], v[32:35], v[52:55], v[80:83]
v_mfma_f32_16x16x32_bf16 v[84:87], v[36:39], v[52:55], v[84:87]
v_mfma_f32_16x16x32_bf16 v[88:91], v[40:43], v[52:55], v[88:91]
v_mfma_f32_16x16x32_bf16 v[92:95], v[44:47], v[52:55], v[92:95]
v_mfma_f32_16x16x32_bf16 v[96:99], v[32:35], v[56:59], v[96:99]
v_mfma_f32_16x16x32_bf16 v[100:103], v[36:39], v[56:59], v[100:103]
v_mfma_f32_16x16x32_bf16 v[104:107], v[40:43], v[56:59], v[104:107]
v_mfma_f32_16x16x32_bf16 v[108:111], v[44:47], v[56:59], v[108:111]
v_mfma_f32_16x16x32_bf16 v[112:115], v[32:35], v[60:63], v[112:115]
v_mfma_f32_16x16x32_bf16 v[116:119], v[36:39], v[60:63], v[116:119]
v_mfma_f32_16x16x32_bf16 v[120:123], v[40:43], v[60:63], v[120:123]
v_mfma_f32_16x16x32_bf16 v[124:127], v[44:47], v[60:63], v[124:127]
s_cmp_lg_u32 s62, -4
s_cbranch_scc1 main_kernel_w_gemm
s_branch main_kernel_w_slow
main_kernel_w_c0_n_ev:
s_mov_b32 s55, 1
s_cmp_eq_u32 s56, 0
s_cbranch_scc1 main_kernel_w_c0_n_et
s_bfm_b64 exec, s0, 0
buffer_store_dword v244, v248, s[4:7], s59 offen sc1
s_mov_b64 exec, -1
s_mov_b32 s56, 0
main_kernel_w_c0_n_et:
s_cmp_lg_u32 s18, 1
s_cbranch_scc1 main_kernel_w_c0_n_loop
s_lshl_b32 s32, s27, 8
s_add_u32 s32, s32, 0x841e000
s_mov_b64 exec, 1
v_mov_b32 v249, 1
buffer_atomic_add v249, off, s[4:7], s32 sc0 sc1
s_mov_b64 exec, -1
s_branch main_kernel_w_c0_n_loop
main_kernel_w_c0_gov:
s_mov_b32 s58, 1
s_mov_b32 s72, s18
s_cmp_lg_u32 s73, -1
s_cbranch_scc1 main_kernel_w_c0_str
s_waitcnt lgkmcnt(0)
v_lshrrev_b32 v0, 4, v250
v_bfe_u32 v1, v250, 2, 2
v_lshl_add_u32 v4, v0, 2, v1
v_and_b32 v5, 7, v4
v_mul_u32_u24 v4, 256, v4
v_and_b32 v6, 3, v250
v_lshl_add_u32 v4, v6, 3, v4
s_mul_i32 s32, s37, 4
v_xor_b32 v5, s32, v5
v_lshl_add_u32 v128, v5, 5, v4
v_xor_b32 v129, 32, v128
v_xor_b32 v130, 64, v128
v_xor_b32 v131, 96, v128
s_mul_i32 s32, s38, 8192
s_add_u32 s32, s32, 65536
v_add_u32 v136, s32, v251
v_lshrrev_b32 v2, 4, v250
v_and_b32 v3, 15, v250
s_mul_i32 s32, s14, 16
v_add_u32 v147, s32, v2
v_and_b32 v6, 7, v147
v_lshlrev_b32 v6, 1, v6
v_xor_b32 v6, v6, v3
v_lshlrev_b32 v151, 4, v6
v_add_u32 v148, 4, v147
v_and_b32 v6, 7, v148
v_lshlrev_b32 v6, 1, v6
v_xor_b32 v6, v6, v3
v_lshlrev_b32 v152, 4, v6
v_subrev_u32 v152, 1024, v152
v_add_u32 v149, 8, v147
v_and_b32 v6, 7, v149
v_lshlrev_b32 v6, 1, v6
v_xor_b32 v6, v6, v3
v_lshlrev_b32 v153, 4, v6
v_subrev_u32 v153, 2048, v153
v_add_u32 v150, 12, v147
v_and_b32 v6, 7, v150
v_lshlrev_b32 v6, 1, v6
v_xor_b32 v6, v6, v3
v_lshlrev_b32 v154, 4, v6
v_subrev_u32 v154, 3072, v154
s_mul_i32 s19, s14, 4096
s_mul_i32 s20, s14, 4096
s_add_u32 s20, s20, 65536
s_mul_i32 s32, s14, 2
s_mul_i32 s32, s32, s31
v_mad_u32_u24 v137, v147, s30, v151
v_mad_u32_u24 v138, v148, s30, v152
v_mad_u32_u24 v139, v149, s30, v153
v_mad_u32_u24 v140, v150, s30, v154
v_add_u32 v141, s32, v251
s_add_u32 s32, s32, s31
s_sub_u32 s32, s32, 2048
v_add_u32 v142, s32, v251
s_mul_i32 s17, s30, 64
s_mov_b32 s15, 0
s_waitcnt vmcnt(0)
s_add_u32 m0, s20, 0
s_nop 0
buffer_load_dwordx4 v141, s[4:7], s16 offen offset:0 sc1 lds
buffer_load_dwordx4 v141, s[4:7], s16 offen offset:1024 sc1 lds
buffer_load_dwordx4 v142, s[4:7], s16 offen offset:2048 sc1 lds
buffer_load_dwordx4 v142, s[4:7], s16 offen offset:3072 sc1 lds
s_add_u32 s16, s16, 2048
s_add_u32 m0, s19, 0
s_nop 0
buffer_load_dwordx4 v137, s[8:11], s15 offen offset:0 lds
buffer_load_dwordx4 v138, s[8:11], s15 offen offset:1024 lds
buffer_load_dwordx4 v139, s[8:11], s15 offen offset:2048 lds
buffer_load_dwordx4 v140, s[8:11], s15 offen offset:3072 lds
s_add_u32 s15, s15, s17
s_add_u32 m0, s20, 16384
s_nop 0
buffer_load_dwordx4 v141, s[4:7], s16 offen offset:0 sc1 lds
buffer_load_dwordx4 v141, s[4:7], s16 offen offset:1024 sc1 lds
buffer_load_dwordx4 v142, s[4:7], s16 offen offset:2048 sc1 lds
buffer_load_dwordx4 v142, s[4:7], s16 offen offset:3072 sc1 lds
s_add_u32 s16, s16, 2048
s_add_u32 m0, s19, 16384
s_nop 0
buffer_load_dwordx4 v137, s[8:11], s15 offen offset:0 lds
buffer_load_dwordx4 v138, s[8:11], s15 offen offset:1024 lds
buffer_load_dwordx4 v139, s[8:11], s15 offen offset:2048 lds
buffer_load_dwordx4 v140, s[8:11], s15 offen offset:3072 lds
s_add_u32 s15, s15, s17
s_add_u32 m0, s20, 32768
s_nop 0
buffer_load_dwordx4 v141, s[4:7], s16 offen offset:0 sc1 lds
buffer_load_dwordx4 v141, s[4:7], s16 offen offset:1024 sc1 lds
buffer_load_dwordx4 v142, s[4:7], s16 offen offset:2048 sc1 lds
buffer_load_dwordx4 v142, s[4:7], s16 offen offset:3072 sc1 lds
s_add_u32 s16, s16, 2048
s_add_u32 m0, s19, 32768
s_nop 0
buffer_load_dwordx4 v137, s[8:11], s15 offen offset:0 lds
buffer_load_dwordx4 v138, s[8:11], s15 offen offset:1024 lds
buffer_load_dwordx4 v139, s[8:11], s15 offen offset:2048 lds
buffer_load_dwordx4 v140, s[8:11], s15 offen offset:3072 lds
s_add_u32 s15, s15, s17
s_add_u32 m0, s20, 49152
s_nop 0
buffer_load_dwordx4 v141, s[4:7], s16 offen offset:0 sc1 lds
buffer_load_dwordx4 v141, s[4:7], s16 offen offset:1024 sc1 lds
buffer_load_dwordx4 v142, s[4:7], s16 offen offset:2048 sc1 lds
buffer_load_dwordx4 v142, s[4:7], s16 offen offset:3072 sc1 lds
s_add_u32 s16, s16, 2048
s_cmp_lg_u32 s56, 0
s_cbranch_scc1 main_kernel_w_epi
main_kernel_w_c0_v_ent:
v_mfma_f32_32x32x16_bf16 v[64:79], v[224:227], v[224:227], 0
s_waitcnt vmcnt(20)
s_barrier
ds_read_b128 v[16:19], v136 offset:0
ds_read_b64_tr_b16 v[0:1], v128 offset:0
ds_read_b64_tr_b16 v[2:3], v128 offset:4096
v_mfma_f32_32x32x16_bf16 v[80:95], v[224:227], v[224:227], 0
ds_read_b64_tr_b16 v[4:5], v129 offset:0
ds_read_b64_tr_b16 v[6:7], v129 offset:4096
ds_read_b64_tr_b16 v[8:9], v130 offset:0
v_mfma_f32_32x32x16_bf16 v[96:111], v[224:227], v[224:227], 0
ds_read_b64_tr_b16 v[10:11], v130 offset:4096
ds_read_b64_tr_b16 v[12:13], v131 offset:0
ds_read_b64_tr_b16 v[14:15], v131 offset:4096
v_mfma_f32_32x32x16_bf16 v[112:127], v[224:227], v[224:227], 0
ds_read_b128 v[20:23], v136 offset:2048
ds_read_b128 v[24:27], v136 offset:4096
ds_read_b128 v[28:31], v136 offset:6144
s_sub_u32 s18, s72, 1
s_sub_u32 s55, s72, 2
s_orn2_b32 s55, s55, s100
s_mov_b32 s73, -1
s_nop 0
main_kernel_w_c0_v_loop:
s_waitcnt lgkmcnt(0)
ds_read_b128 v[48:51], v136 offset:1024
s_add_u32 m0, s19, 49152
s_nop 0
v_mfma_f32_16x16x32_bf16 v[64:67], v[16:19], v[0:3], v[64:67]
ds_read_b64_tr_b16 v[32:33], v128 offset:8192
v_mfma_f32_16x16x32_bf16 v[68:71], v[16:19], v[4:7], v[68:71]
ds_read_b64_tr_b16 v[34:35], v128 offset:12288
buffer_load_dwordx4 v137, s[8:11], s15 offen offset:0 lds
v_mfma_f32_16x16x32_bf16 v[72:75], v[16:19], v[8:11], v[72:75]
ds_read_b64_tr_b16 v[36:37], v129 offset:8192
v_mfma_f32_16x16x32_bf16 v[76:79], v[16:19], v[12:15], v[76:79]
ds_read_b64_tr_b16 v[38:39], v129 offset:12288
v_mfma_f32_16x16x32_bf16 v[80:83], v[20:23], v[0:3], v[80:83]
ds_read_b64_tr_b16 v[40:41], v130 offset:8192
buffer_load_dwordx4 v138, s[8:11], s15 offen offset:1024 lds
v_mfma_f32_16x16x32_bf16 v[84:87], v[20:23], v[4:7], v[84:87]
ds_read_b64_tr_b16 v[42:43], v130 offset:12288
v_mfma_f32_16x16x32_bf16 v[88:91], v[20:23], v[8:11], v[88:91]
ds_read_b64_tr_b16 v[44:45], v131 offset:8192
v_mfma_f32_16x16x32_bf16 v[92:95], v[20:23], v[12:15], v[92:95]
ds_read_b64_tr_b16 v[46:47], v131 offset:12288
buffer_load_dwordx4 v139, s[8:11], s15 offen offset:2048 lds
v_mfma_f32_16x16x32_bf16 v[96:99], v[24:27], v[0:3], v[96:99]
ds_read_b128 v[52:55], v136 offset:3072
v_mfma_f32_16x16x32_bf16 v[100:103], v[24:27], v[4:7], v[100:103]
ds_read_b128 v[56:59], v136 offset:5120
buffer_load_dwordx4 v140, s[8:11], s15 offen offset:3072 lds
v_mfma_f32_16x16x32_bf16 v[104:107], v[24:27], v[8:11], v[104:107]
ds_read_b128 v[60:63], v136 offset:7168
v_mfma_f32_16x16x32_bf16 v[108:111], v[24:27], v[12:15], v[108:111]
v_mfma_f32_16x16x32_bf16 v[112:115], v[28:31], v[0:3], v[112:115]
s_add_u32 s15, s15, s17
v_mfma_f32_16x16x32_bf16 v[116:119], v[28:31], v[4:7], v[116:119]
v_mfma_f32_16x16x32_bf16 v[120:123], v[28:31], v[8:11], v[120:123]
v_mfma_f32_16x16x32_bf16 v[124:127], v[28:31], v[12:15], v[124:127]
main_kernel_w_c0_v_mid:
s_waitcnt lgkmcnt(0)
v_mfma_f32_16x16x32_bf16 v[64:67], v[48:51], v[32:35], v[64:67]
s_waitcnt vmcnt(16)
s_barrier
ds_read_b128 v[16:19], v136 offset:16384
s_add_u32 m0, s20, 0
s_nop 0
v_mfma_f32_16x16x32_bf16 v[68:71], v[48:51], v[36:39], v[68:71]
ds_read_b64_tr_b16 v[0:1], v128 offset:16384
v_mfma_f32_16x16x32_bf16 v[72:75], v[48:51], v[40:43], v[72:75]
ds_read_b64_tr_b16 v[2:3], v128 offset:20480
buffer_load_dwordx4 v141, s[4:7], s16 offen offset:0 sc1 lds
v_mfma_f32_16x16x32_bf16 v[76:79], v[48:51], v[44:47], v[76:79]
ds_read_b64_tr_b16 v[4:5], v129 offset:16384
v_mfma_f32_16x16x32_bf16 v[80:83], v[52:55], v[32:35], v[80:83]
ds_read_b64_tr_b16 v[6:7], v129 offset:20480
v_mfma_f32_16x16x32_bf16 v[84:87], v[52:55], v[36:39], v[84:87]
ds_read_b64_tr_b16 v[8:9], v130 offset:16384
buffer_load_dwordx4 v141, s[4:7], s16 offen offset:1024 sc1 lds
v_mfma_f32_16x16x32_bf16 v[88:91], v[52:55], v[40:43], v[88:91]
ds_read_b64_tr_b16 v[10:11], v130 offset:20480
v_mfma_f32_16x16x32_bf16 v[92:95], v[52:55], v[44:47], v[92:95]
ds_read_b64_tr_b16 v[12:13], v131 offset:16384
buffer_load_dwordx4 v142, s[4:7], s16 offen offset:2048 sc1 lds
v_mfma_f32_16x16x32_bf16 v[96:99], v[56:59], v[32:35], v[96:99]
ds_read_b64_tr_b16 v[14:15], v131 offset:20480
v_mfma_f32_16x16x32_bf16 v[100:103], v[56:59], v[36:39], v[100:103]
ds_read_b128 v[20:23], v136 offset:18432
v_mfma_f32_16x16x32_bf16 v[104:107], v[56:59], v[40:43], v[104:107]
ds_read_b128 v[24:27], v136 offset:20480
buffer_load_dwordx4 v142, s[4:7], s16 offen offset:3072 sc1 lds
v_mfma_f32_16x16x32_bf16 v[108:111], v[56:59], v[44:47], v[108:111]
ds_read_b128 v[28:31], v136 offset:22528
v_mfma_f32_16x16x32_bf16 v[112:115], v[60:63], v[32:35], v[112:115]
s_add_u32 s16, s16, 2048
v_mfma_f32_16x16x32_bf16 v[116:119], v[60:63], v[36:39], v[116:119]
v_mfma_f32_16x16x32_bf16 v[120:123], v[60:63], v[40:43], v[120:123]
v_mfma_f32_16x16x32_bf16 v[124:127], v[60:63], v[44:47], v[124:127]
s_waitcnt lgkmcnt(0)
ds_read_b128 v[48:51], v136 offset:17408
s_add_u32 m0, s19, 0
s_nop 0
v_mfma_f32_16x16x32_bf16 v[64:67], v[16:19], v[0:3], v[64:67]
ds_read_b64_tr_b16 v[32:33], v128 offset:24576
v_mfma_f32_16x16x32_bf16 v[68:71], v[16:19], v[4:7], v[68:71]
ds_read_b64_tr_b16 v[34:35], v128 offset:28672
buffer_load_dwordx4 v137, s[8:11], s15 offen offset:0 lds
v_mfma_f32_16x16x32_bf16 v[72:75], v[16:19], v[8:11], v[72:75]
ds_read_b64_tr_b16 v[36:37], v129 offset:24576
v_mfma_f32_16x16x32_bf16 v[76:79], v[16:19], v[12:15], v[76:79]
ds_read_b64_tr_b16 v[38:39], v129 offset:28672
v_mfma_f32_16x16x32_bf16 v[80:83], v[20:23], v[0:3], v[80:83]
ds_read_b64_tr_b16 v[40:41], v130 offset:24576
buffer_load_dwordx4 v138, s[8:11], s15 offen offset:1024 lds
v_mfma_f32_16x16x32_bf16 v[84:87], v[20:23], v[4:7], v[84:87]
ds_read_b64_tr_b16 v[42:43], v130 offset:28672
v_mfma_f32_16x16x32_bf16 v[88:91], v[20:23], v[8:11], v[88:91]
ds_read_b64_tr_b16 v[44:45], v131 offset:24576
v_mfma_f32_16x16x32_bf16 v[92:95], v[20:23], v[12:15], v[92:95]
ds_read_b64_tr_b16 v[46:47], v131 offset:28672
buffer_load_dwordx4 v139, s[8:11], s15 offen offset:2048 lds
v_mfma_f32_16x16x32_bf16 v[96:99], v[24:27], v[0:3], v[96:99]
ds_read_b128 v[52:55], v136 offset:19456
v_mfma_f32_16x16x32_bf16 v[100:103], v[24:27], v[4:7], v[100:103]
ds_read_b128 v[56:59], v136 offset:21504
buffer_load_dwordx4 v140, s[8:11], s15 offen offset:3072 lds
v_mfma_f32_16x16x32_bf16 v[104:107], v[24:27], v[8:11], v[104:107]
ds_read_b128 v[60:63], v136 offset:23552
v_mfma_f32_16x16x32_bf16 v[108:111], v[24:27], v[12:15], v[108:111]
v_mfma_f32_16x16x32_bf16 v[112:115], v[28:31], v[0:3], v[112:115]
s_add_u32 s15, s15, s17
v_mfma_f32_16x16x32_bf16 v[116:119], v[28:31], v[4:7], v[116:119]
v_mfma_f32_16x16x32_bf16 v[120:123], v[28:31], v[8:11], v[120:123]
v_mfma_f32_16x16x32_bf16 v[124:127], v[28:31], v[12:15], v[124:127]
s_waitcnt lgkmcnt(0)
v_mfma_f32_16x16x32_bf16 v[64:67], v[48:51], v[32:35], v[64:67]
s_waitcnt vmcnt(16)
s_barrier
ds_read_b128 v[16:19], v136 offset:32768
s_add_u32 m0, s20, 16384
s_nop 0
v_mfma_f32_16x16x32_bf16 v[68:71], v[48:51], v[36:39], v[68:71]
ds_read_b64_tr_b16 v[0:1], v128 offset:32768
v_mfma_f32_16x16x32_bf16 v[72:75], v[48:51], v[40:43], v[72:75]
ds_read_b64_tr_b16 v[2:3], v128 offset:36864
buffer_load_dwordx4 v141, s[4:7], s16 offen offset:0 sc1 lds
v_mfma_f32_16x16x32_bf16 v[76:79], v[48:51], v[44:47], v[76:79]
ds_read_b64_tr_b16 v[4:5], v129 offset:32768
v_mfma_f32_16x16x32_bf16 v[80:83], v[52:55], v[32:35], v[80:83]
ds_read_b64_tr_b16 v[6:7], v129 offset:36864
v_mfma_f32_16x16x32_bf16 v[84:87], v[52:55], v[36:39], v[84:87]
ds_read_b64_tr_b16 v[8:9], v130 offset:32768
buffer_load_dwordx4 v141, s[4:7], s16 offen offset:1024 sc1 lds
v_mfma_f32_16x16x32_bf16 v[88:91], v[52:55], v[40:43], v[88:91]
ds_read_b64_tr_b16 v[10:11], v130 offset:36864
v_mfma_f32_16x16x32_bf16 v[92:95], v[52:55], v[44:47], v[92:95]
ds_read_b64_tr_b16 v[12:13], v131 offset:32768
buffer_load_dwordx4 v142, s[4:7], s16 offen offset:2048 sc1 lds
v_mfma_f32_16x16x32_bf16 v[96:99], v[56:59], v[32:35], v[96:99]
ds_read_b64_tr_b16 v[14:15], v131 offset:36864
v_mfma_f32_16x16x32_bf16 v[100:103], v[56:59], v[36:39], v[100:103]
ds_read_b128 v[20:23], v136 offset:34816
v_mfma_f32_16x16x32_bf16 v[104:107], v[56:59], v[40:43], v[104:107]
ds_read_b128 v[24:27], v136 offset:36864
buffer_load_dwordx4 v142, s[4:7], s16 offen offset:3072 sc1 lds
v_mfma_f32_16x16x32_bf16 v[108:111], v[56:59], v[44:47], v[108:111]
ds_read_b128 v[28:31], v136 offset:38912
v_mfma_f32_16x16x32_bf16 v[112:115], v[60:63], v[32:35], v[112:115]
s_add_u32 s16, s16, 2048
v_mfma_f32_16x16x32_bf16 v[116:119], v[60:63], v[36:39], v[116:119]
v_mfma_f32_16x16x32_bf16 v[120:123], v[60:63], v[40:43], v[120:123]
v_mfma_f32_16x16x32_bf16 v[124:127], v[60:63], v[44:47], v[124:127]
s_waitcnt lgkmcnt(0)
ds_read_b128 v[48:51], v136 offset:33792
s_add_u32 m0, s19, 16384
s_nop 0
v_mfma_f32_16x16x32_bf16 v[64:67], v[16:19], v[0:3], v[64:67]
ds_read_b64_tr_b16 v[32:33], v128 offset:40960
v_mfma_f32_16x16x32_bf16 v[68:71], v[16:19], v[4:7], v[68:71]
ds_read_b64_tr_b16 v[34:35], v128 offset:45056
buffer_load_dwordx4 v137, s[8:11], s15 offen offset:0 lds
v_mfma_f32_16x16x32_bf16 v[72:75], v[16:19], v[8:11], v[72:75]
ds_read_b64_tr_b16 v[36:37], v129 offset:40960
v_mfma_f32_16x16x32_bf16 v[76:79], v[16:19], v[12:15], v[76:79]
ds_read_b64_tr_b16 v[38:39], v129 offset:45056
v_mfma_f32_16x16x32_bf16 v[80:83], v[20:23], v[0:3], v[80:83]
ds_read_b64_tr_b16 v[40:41], v130 offset:40960
buffer_load_dwordx4 v138, s[8:11], s15 offen offset:1024 lds
v_mfma_f32_16x16x32_bf16 v[84:87], v[20:23], v[4:7], v[84:87]
ds_read_b64_tr_b16 v[42:43], v130 offset:45056
v_mfma_f32_16x16x32_bf16 v[88:91], v[20:23], v[8:11], v[88:91]
ds_read_b64_tr_b16 v[44:45], v131 offset:40960
v_mfma_f32_16x16x32_bf16 v[92:95], v[20:23], v[12:15], v[92:95]
ds_read_b64_tr_b16 v[46:47], v131 offset:45056
buffer_load_dwordx4 v139, s[8:11], s15 offen offset:2048 lds
v_mfma_f32_16x16x32_bf16 v[96:99], v[24:27], v[0:3], v[96:99]
ds_read_b128 v[52:55], v136 offset:35840
v_mfma_f32_16x16x32_bf16 v[100:103], v[24:27], v[4:7], v[100:103]
ds_read_b128 v[56:59], v136 offset:37888
buffer_load_dwordx4 v140, s[8:11], s15 offen offset:3072 lds
v_mfma_f32_16x16x32_bf16 v[104:107], v[24:27], v[8:11], v[104:107]
ds_read_b128 v[60:63], v136 offset:39936
v_mfma_f32_16x16x32_bf16 v[108:111], v[24:27], v[12:15], v[108:111]
v_mfma_f32_16x16x32_bf16 v[112:115], v[28:31], v[0:3], v[112:115]
s_add_u32 s15, s15, s17
v_mfma_f32_16x16x32_bf16 v[116:119], v[28:31], v[4:7], v[116:119]
v_mfma_f32_16x16x32_bf16 v[120:123], v[28:31], v[8:11], v[120:123]
v_mfma_f32_16x16x32_bf16 v[124:127], v[28:31], v[12:15], v[124:127]
s_waitcnt lgkmcnt(0)
v_mfma_f32_16x16x32_bf16 v[64:67], v[48:51], v[32:35], v[64:67]
s_waitcnt vmcnt(16)
s_barrier
ds_read_b128 v[16:19], v136 offset:49152
s_add_u32 m0, s20, 32768
s_nop 0
v_mfma_f32_16x16x32_bf16 v[68:71], v[48:51], v[36:39], v[68:71]
ds_read_b64_tr_b16 v[0:1], v128 offset:49152
v_mfma_f32_16x16x32_bf16 v[72:75], v[48:51], v[40:43], v[72:75]
ds_read_b64_tr_b16 v[2:3], v128 offset:53248
buffer_load_dwordx4 v141, s[4:7], s16 offen offset:0 sc1 lds
v_mfma_f32_16x16x32_bf16 v[76:79], v[48:51], v[44:47], v[76:79]
ds_read_b64_tr_b16 v[4:5], v129 offset:49152
v_mfma_f32_16x16x32_bf16 v[80:83], v[52:55], v[32:35], v[80:83]
ds_read_b64_tr_b16 v[6:7], v129 offset:53248
v_mfma_f32_16x16x32_bf16 v[84:87], v[52:55], v[36:39], v[84:87]
ds_read_b64_tr_b16 v[8:9], v130 offset:49152
buffer_load_dwordx4 v141, s[4:7], s16 offen offset:1024 sc1 lds
v_mfma_f32_16x16x32_bf16 v[88:91], v[52:55], v[40:43], v[88:91]
ds_read_b64_tr_b16 v[10:11], v130 offset:53248
v_mfma_f32_16x16x32_bf16 v[92:95], v[52:55], v[44:47], v[92:95]
ds_read_b64_tr_b16 v[12:13], v131 offset:49152
buffer_load_dwordx4 v142, s[4:7], s16 offen offset:2048 sc1 lds
v_mfma_f32_16x16x32_bf16 v[96:99], v[56:59], v[32:35], v[96:99]
ds_read_b64_tr_b16 v[14:15], v131 offset:53248
v_mfma_f32_16x16x32_bf16 v[100:103], v[56:59], v[36:39], v[100:103]
ds_read_b128 v[20:23], v136 offset:51200
v_mfma_f32_16x16x32_bf16 v[104:107], v[56:59], v[40:43], v[104:107]
ds_read_b128 v[24:27], v136 offset:53248
buffer_load_dwordx4 v142, s[4:7], s16 offen offset:3072 sc1 lds
v_mfma_f32_16x16x32_bf16 v[108:111], v[56:59], v[44:47], v[108:111]
ds_read_b128 v[28:31], v136 offset:55296
v_mfma_f32_16x16x32_bf16 v[112:115], v[60:63], v[32:35], v[112:115]
s_add_u32 s16, s16, 2048
v_mfma_f32_16x16x32_bf16 v[116:119], v[60:63], v[36:39], v[116:119]
v_mfma_f32_16x16x32_bf16 v[120:123], v[60:63], v[40:43], v[120:123]
v_mfma_f32_16x16x32_bf16 v[124:127], v[60:63], v[44:47], v[124:127]
s_waitcnt lgkmcnt(0)
ds_read_b128 v[48:51], v136 offset:50176
s_add_u32 m0, s19, 32768
s_nop 0
v_mfma_f32_16x16x32_bf16 v[64:67], v[16:19], v[0:3], v[64:67]
ds_read_b64_tr_b16 v[32:33], v128 offset:57344
v_mfma_f32_16x16x32_bf16 v[68:71], v[16:19], v[4:7], v[68:71]
ds_read_b64_tr_b16 v[34:35], v128 offset:61440
buffer_load_dwordx4 v137, s[8:11], s15 offen offset:0 lds
v_mfma_f32_16x16x32_bf16 v[72:75], v[16:19], v[8:11], v[72:75]
ds_read_b64_tr_b16 v[36:37], v129 offset:57344
v_mfma_f32_16x16x32_bf16 v[76:79], v[16:19], v[12:15], v[76:79]
ds_read_b64_tr_b16 v[38:39], v129 offset:61440
v_mfma_f32_16x16x32_bf16 v[80:83], v[20:23], v[0:3], v[80:83]
ds_read_b64_tr_b16 v[40:41], v130 offset:57344
buffer_load_dwordx4 v138, s[8:11], s15 offen offset:1024 lds
v_mfma_f32_16x16x32_bf16 v[84:87], v[20:23], v[4:7], v[84:87]
ds_read_b64_tr_b16 v[42:43], v130 offset:61440
v_mfma_f32_16x16x32_bf16 v[88:91], v[20:23], v[8:11], v[88:91]
ds_read_b64_tr_b16 v[44:45], v131 offset:57344
v_mfma_f32_16x16x32_bf16 v[92:95], v[20:23], v[12:15], v[92:95]
ds_read_b64_tr_b16 v[46:47], v131 offset:61440
buffer_load_dwordx4 v139, s[8:11], s15 offen offset:2048 lds
v_mfma_f32_16x16x32_bf16 v[96:99], v[24:27], v[0:3], v[96:99]
ds_read_b128 v[52:55], v136 offset:52224
v_mfma_f32_16x16x32_bf16 v[100:103], v[24:27], v[4:7], v[100:103]
ds_read_b128 v[56:59], v136 offset:54272
buffer_load_dwordx4 v140, s[8:11], s15 offen offset:3072 lds
v_mfma_f32_16x16x32_bf16 v[104:107], v[24:27], v[8:11], v[104:107]
ds_read_b128 v[60:63], v136 offset:56320
v_mfma_f32_16x16x32_bf16 v[108:111], v[24:27], v[12:15], v[108:111]
v_mfma_f32_16x16x32_bf16 v[112:115], v[28:31], v[0:3], v[112:115]
s_add_u32 s15, s15, s17
v_mfma_f32_16x16x32_bf16 v[116:119], v[28:31], v[4:7], v[116:119]
v_mfma_f32_16x16x32_bf16 v[120:123], v[28:31], v[8:11], v[120:123]
v_mfma_f32_16x16x32_bf16 v[124:127], v[28:31], v[12:15], v[124:127]
s_waitcnt lgkmcnt(0)
v_mfma_f32_16x16x32_bf16 v[64:67], v[48:51], v[32:35], v[64:67]
s_waitcnt vmcnt(16)
s_barrier
ds_read_b128 v[16:19], v136 offset:0
s_add_u32 m0, s20, 49152
s_nop 0
v_mfma_f32_16x16x32_bf16 v[68:71], v[48:51], v[36:39], v[68:71]
ds_read_b64_tr_b16 v[0:1], v128 offset:0
v_mfma_f32_16x16x32_bf16 v[72:75], v[48:51], v[40:43], v[72:75]
ds_read_b64_tr_b16 v[2:3], v128 offset:4096
buffer_load_dwordx4 v141, s[4:7], s16 offen offset:0 sc1 lds
v_mfma_f32_16x16x32_bf16 v[76:79], v[48:51], v[44:47], v[76:79]
ds_read_b64_tr_b16 v[4:5], v129 offset:0
v_mfma_f32_16x16x32_bf16 v[80:83], v[52:55], v[32:35], v[80:83]
ds_read_b64_tr_b16 v[6:7], v129 offset:4096
v_mfma_f32_16x16x32_bf16 v[84:87], v[52:55], v[36:39], v[84:87]
ds_read_b64_tr_b16 v[8:9], v130 offset:0
buffer_load_dwordx4 v141, s[4:7], s16 offen offset:1024 sc1 lds
v_mfma_f32_16x16x32_bf16 v[88:91], v[52:55], v[40:43], v[88:91]
ds_read_b64_tr_b16 v[10:11], v130 offset:4096
v_mfma_f32_16x16x32_bf16 v[92:95], v[52:55], v[44:47], v[92:95]
ds_read_b64_tr_b16 v[12:13], v131 offset:0
buffer_load_dwordx4 v142, s[4:7], s16 offen offset:2048 sc1 lds
v_mfma_f32_16x16x32_bf16 v[96:99], v[56:59], v[32:35], v[96:99]
ds_read_b64_tr_b16 v[14:15], v131 offset:4096
v_mfma_f32_16x16x32_bf16 v[100:103], v[56:59], v[36:39], v[100:103]
ds_read_b128 v[20:23], v136 offset:2048
v_mfma_f32_16x16x32_bf16 v[104:107], v[56:59], v[40:43], v[104:107]
ds_read_b128 v[24:27], v136 offset:4096
buffer_load_dwordx4 v142, s[4:7], s16 offen offset:3072 sc1 lds
v_mfma_f32_16x16x32_bf16 v[108:111], v[56:59], v[44:47], v[108:111]
ds_read_b128 v[28:31], v136 offset:6144
v_mfma_f32_16x16x32_bf16 v[112:115], v[60:63], v[32:35], v[112:115]
s_add_u32 s16, s16, 2048
v_mfma_f32_16x16x32_bf16 v[116:119], v[60:63], v[36:39], v[116:119]
v_mfma_f32_16x16x32_bf16 v[120:123], v[60:63], v[40:43], v[120:123]
v_mfma_f32_16x16x32_bf16 v[124:127], v[60:63], v[44:47], v[124:127]
s_sub_u32 s18, s18, 1
s_cmp_eq_u32 s18, s55
s_cbranch_scc1 main_kernel_w_c0_v_ev
s_cmp_lg_u32 s18, 0
s_cbranch_scc1 main_kernel_w_c0_v_loop
s_cmp_lg_u32 s73, -1
s_cbranch_scc1 main_kernel_w_epn
s_waitcnt lgkmcnt(0)
ds_read_b128 v[48:51], v136 offset:1024
s_add_u32 m0, s19, 49152
s_nop 0
v_mfma_f32_16x16x32_bf16 v[64:67], v[16:19], v[0:3], v[64:67]
ds_read_b64_tr_b16 v[32:33], v128 offset:8192
s_add_u32 s32, s23, 1
s_bitcmp0_b32 s32, 2
s_cselect_b32 s34, 7, 2
s_cselect_b32 s35, 2, 4
s_lshl_b32 s59, s23, 13
s_add_u32 s59, s59, 0x8404000
v_mfma_f32_16x16x32_bf16 v[68:71], v[16:19], v[4:7], v[68:71]
ds_read_b64_tr_b16 v[34:35], v128 offset:12288
buffer_load_dwordx4 v137, s[8:11], s15 offen offset:0 lds
v_lshrrev_b32 v253, 3, v250
v_add_lshl_u32 v253, s24, v253, 9
v_mfma_f32_16x16x32_bf16 v[72:75], v[16:19], v[8:11], v[72:75]
ds_read_b64_tr_b16 v[36:37], v129 offset:8192
v_and_b32 v254, 3, v250
v_lshl_add_u32 v253, v254, s34, v253
v_mfma_f32_16x16x32_bf16 v[76:79], v[16:19], v[12:15], v[76:79]
ds_read_b64_tr_b16 v[38:39], v129 offset:12288
v_bfe_u32 v254, v250, 2, 1
v_add_u32 v254, s25, v254
v_lshl_add_u32 v248, v254, s35, v253
v_mfma_f32_16x16x32_bf16 v[80:83], v[20:23], v[0:3], v[80:83]
ds_read_b64_tr_b16 v[40:41], v130 offset:8192
buffer_load_dwordx4 v138, s[8:11], s15 offen offset:1024 lds
s_lshl_b32 s0, 4, s54
v_readfirstlane_b32 s28, v249
v_mfma_f32_16x16x32_bf16 v[84:87], v[20:23], v[4:7], v[84:87]
ds_read_b64_tr_b16 v[42:43], v130 offset:12288
s_nop 1
v_cmp_ge_u32 vcc, s28, v229
v_mfma_f32_16x16x32_bf16 v[88:91], v[20:23], v[8:11], v[88:91]
ds_read_b64_tr_b16 v[44:45], v131 offset:8192
s_nop 1
s_bcnt1_i32_b64 s32, vcc
v_mfma_f32_16x16x32_bf16 v[92:95], v[20:23], v[12:15], v[92:95]
ds_read_b64_tr_b16 v[46:47], v131 offset:12288
buffer_load_dwordx4 v139, s[8:11], s15 offen offset:2048 lds
s_sub_u32 s32, s32, 1
v_readlane_b32 s36, v230, s32
s_nop 1
v_mfma_f32_16x16x32_bf16 v[96:99], v[24:27], v[0:3], v[96:99]
ds_read_b128 v[52:55], v136 offset:3072
s_and_b32 s32, s36, 0x7ff
s_sub_u32 s28, s28, s32
v_mfma_f32_16x16x32_bf16 v[100:103], v[24:27], v[4:7], v[100:103]
ds_read_b128 v[56:59], v136 offset:5120
buffer_load_dwordx4 v140, s[8:11], s15 offen offset:3072 lds
s_bfe_u32 s32, s36, 0x3001a
s_lshr_b32 s25, s28, s32
v_mfma_f32_16x16x32_bf16 v[104:107], v[24:27], v[8:11], v[104:107]
ds_read_b128 v[60:63], v136 offset:7168
s_lshl_b32 s33, s25, s32
s_sub_u32 s24, s28, s33
v_mfma_f32_16x16x32_bf16 v[108:111], v[24:27], v[12:15], v[108:111]
s_bfe_u32 s34, s36, 0x1001d
s_lshl_b32 s24, s24, s34
s_bfe_u32 s35, s36, 0x1001e
v_mfma_f32_16x16x32_bf16 v[112:115], v[28:31], v[0:3], v[112:115]
s_add_u32 s15, s15, s17
s_lshl_b32 s25, s25, s35
s_bfe_u32 s32, s36, 0x40011
v_mfma_f32_16x16x32_bf16 v[116:119], v[28:31], v[4:7], v[116:119]
s_add_u32 s24, s24, s32
s_bfe_u32 s32, s36, 0x50015
v_mfma_f32_16x16x32_bf16 v[120:123], v[28:31], v[8:11], v[120:123]
s_add_u32 s25, s25, s32
s_bfe_u32 s23, s36, 0x4000b
v_mfma_f32_16x16x32_bf16 v[124:127], v[28:31], v[12:15], v[124:127]
s_waitcnt lgkmcnt(0)
v_mfma_f32_16x16x32_bf16 v[64:67], v[48:51], v[32:35], v[64:67]
s_waitcnt vmcnt(16)
s_barrier
ds_read_b128 v[16:19], v136 offset:16384
s_add_u32 m0, s20, 0
s_nop 0
s_bfe_u32 s36, s36, 0x6000b
s_lshl_b32 s32, s24, 8
s_or_b32 s36, s36, s32
v_mfma_f32_16x16x32_bf16 v[68:71], v[48:51], v[36:39], v[68:71]
ds_read_b64_tr_b16 v[0:1], v128 offset:16384
s_lshl_b32 s32, s25, 16
s_or_b32 s36, s36, s32
v_mfma_f32_16x16x32_bf16 v[72:75], v[48:51], v[40:43], v[72:75]
ds_read_b64_tr_b16 v[2:3], v128 offset:20480
buffer_load_dwordx4 v141, s[4:7], s16 offen offset:0 sc1 lds
s_cmp_eq_u32 s23, 4
s_cselect_b32 s32, 1, 0
s_sub_u32 s48, s24, s32
v_mfma_f32_16x16x32_bf16 v[76:79], v[48:51], v[44:47], v[76:79]
ds_read_b64_tr_b16 v[4:5], v129 offset:16384
s_max_i32 s48, s48, 0
s_add_u32 s49, s24, s34
s_add_u32 s49, s49, s32
v_mfma_f32_16x16x32_bf16 v[80:83], v[52:55], v[32:35], v[80:83]
ds_read_b64_tr_b16 v[6:7], v129 offset:20480
s_min_u32 s49, s49, 15
s_cmp_eq_u32 s23, 6
s_cselect_b32 s51, 3, 7
v_mfma_f32_16x16x32_bf16 v[84:87], v[52:55], v[36:39], v[84:87]
ds_read_b64_tr_b16 v[8:9], v130 offset:16384
buffer_load_dwordx4 v141, s[4:7], s16 offen offset:1024 sc1 lds
s_cmp_eq_u32 s23, 7
s_cselect_b32 s51, 27, s51
s_cselect_b32 s50, 5, 4
s_add_u32 s33, s25, s35
v_mfma_f32_16x16x32_bf16 v[88:91], v[52:55], v[40:43], v[88:91]
ds_read_b64_tr_b16 v[10:11], v130 offset:20480
s_lshl_b32 s34, s24, 9
s_cmp_eq_u32 s23, 8
s_cselect_b32 s51, 0, s51
s_cselect_b32 s48, s25, s48
s_cselect_b32 s49, s33, s49
v_mfma_f32_16x16x32_bf16 v[92:95], v[52:55], v[44:47], v[92:95]
ds_read_b64_tr_b16 v[12:13], v131 offset:16384
buffer_load_dwordx4 v142, s[4:7], s16 offen offset:2048 sc1 lds
s_cmp_eq_u32 s23, 8
s_cselect_b32 s63, 2, 9
s_cselect_b32 s61, 0, 0x7f000000
s_cselect_b32 s34, s34, 0
v_lshrrev_b32 v228, s50, v250
v_lshlrev_b32 v254, s50, v228
v_mfma_f32_16x16x32_bf16 v[96:99], v[56:59], v[32:35], v[96:99]
ds_read_b64_tr_b16 v[14:15], v131 offset:20480
v_sub_u32 v254, v250, v254
s_cmp_lt_u32 s23, 4
s_cselect_b32 s39, 10, s23
v_mfma_f32_16x16x32_bf16 v[100:103], v[56:59], v[36:39], v[100:103]
ds_read_b128 v[20:23], v136 offset:18432
v_min_u32 v254, s51, v254
s_lshl_b32 s39, s39, 13
v_mfma_f32_16x16x32_bf16 v[104:107], v[56:59], v[40:43], v[104:107]
ds_read_b128 v[24:27], v136 offset:20480
buffer_load_dwordx4 v142, s[4:7], s16 offen offset:3072 sc1 lds
s_cmp_eq_u32 s23, 3
s_cselect_b32 s34, 4, s34
v_add_u32 v228, s48, v228
v_mfma_f32_16x16x32_bf16 v[108:111], v[56:59], v[44:47], v[108:111]
ds_read_b128 v[28:31], v136 offset:22528
s_add_u32 s39, s39, s34
s_add_u32 s39, s39, 0x8402000
v_min_u32 v228, s49, v228
v_mfma_f32_16x16x32_bf16 v[112:115], v[60:63], v[32:35], v[112:115]
s_add_u32 s16, s16, 2048
s_lshl_b32 s60, s24, 10
s_add_u32 s60, s60, 0x8400000
v_mfma_f32_16x16x32_bf16 v[116:119], v[60:63], v[36:39], v[116:119]
v_lshlrev_b32 v228, s63, v228
v_lshl_add_u32 v228, v254, 4, v228
v_mfma_f32_16x16x32_bf16 v[120:123], v[60:63], v[40:43], v[120:123]
v_or_b32 v146, s61, v251
s_mov_b64 exec, s[100:101]
buffer_load_dword v231, v228, s[4:7], s39 offen sc1
buffer_load_dwordx4 v[232:235], v146, s[4:7], s60 offen sc1
s_mov_b64 exec, -1
v_mfma_f32_16x16x32_bf16 v[124:127], v[60:63], v[44:47], v[124:127]
s_waitcnt lgkmcnt(0)
ds_read_b128 v[48:51], v136 offset:17408
s_add_u32 m0, s19, 0
s_nop 0
v_mfma_f32_16x16x32_bf16 v[64:67], v[16:19], v[0:3], v[64:67]
ds_read_b64_tr_b16 v[32:33], v128 offset:24576
s_mov_b32 s1, s21
v_mfma_f32_16x16x32_bf16 v[68:71], v[16:19], v[4:7], v[68:71]
ds_read_b64_tr_b16 v[34:35], v128 offset:28672
buffer_load_dwordx4 v137, s[8:11], s15 offen offset:0 lds
v_mfma_f32_16x16x32_bf16 v[72:75], v[16:19], v[8:11], v[72:75]
ds_read_b64_tr_b16 v[36:37], v129 offset:24576
v_mfma_f32_16x16x32_bf16 v[76:79], v[16:19], v[12:15], v[76:79]
ds_read_b64_tr_b16 v[38:39], v129 offset:28672
s_mov_b32 s2, s22
v_mfma_f32_16x16x32_bf16 v[80:83], v[20:23], v[0:3], v[80:83]
ds_read_b64_tr_b16 v[40:41], v130 offset:24576
buffer_load_dwordx4 v138, s[8:11], s15 offen offset:1024 lds
v_mfma_f32_16x16x32_bf16 v[84:87], v[20:23], v[4:7], v[84:87]
ds_read_b64_tr_b16 v[42:43], v130 offset:28672
v_mfma_f32_16x16x32_bf16 v[88:91], v[20:23], v[8:11], v[88:91]
ds_read_b64_tr_b16 v[44:45], v131 offset:24576
v_mfma_f32_16x16x32_bf16 v[92:95], v[20:23], v[12:15], v[92:95]
ds_read_b64_tr_b16 v[46:47], v131 offset:28672
buffer_load_dwordx4 v139, s[8:11], s15 offen offset:2048 lds
s_mov_b32 s3, s26
v_mfma_f32_16x16x32_bf16 v[96:99], v[24:27], v[0:3], v[96:99]
ds_read_b128 v[52:55], v136 offset:19456
v_mfma_f32_16x16x32_bf16 v[100:103], v[24:27], v[4:7], v[100:103]
ds_read_b128 v[56:59], v136 offset:21504
buffer_load_dwordx4 v140, s[8:11], s15 offen offset:3072 lds
v_mfma_f32_16x16x32_bf16 v[104:107], v[24:27], v[8:11], v[104:107]
ds_read_b128 v[60:63], v136 offset:23552
v_mfma_f32_16x16x32_bf16 v[108:111], v[24:27], v[12:15], v[108:111]
s_mov_b32 s56, s57
v_mfma_f32_16x16x32_bf16 v[112:115], v[28:31], v[0:3], v[112:115]
s_add_u32 s15, s15, s17
v_mfma_f32_16x16x32_bf16 v[116:119], v[28:31], v[4:7], v[116:119]
v_mfma_f32_16x16x32_bf16 v[120:123], v[28:31], v[8:11], v[120:123]
v_mfma_f32_16x16x32_bf16 v[124:127], v[28:31], v[12:15], v[124:127]
s_waitcnt lgkmcnt(0)
v_mfma_f32_16x16x32_bf16 v[64:67], v[48:51], v[32:35], v[64:67]
s_waitcnt vmcnt(16)
s_barrier
ds_read_b128 v[16:19], v136 offset:32768
s_add_u32 m0, s20, 16384
s_nop 0
v_mov_b32 v145, v252
v_mfma_f32_16x16x32_bf16 v[68:71], v[48:51], v[36:39], v[68:71]
ds_read_b64_tr_b16 v[0:1], v128 offset:32768
v_mfma_f32_16x16x32_bf16 v[72:75], v[48:51], v[40:43], v[72:75]
ds_read_b64_tr_b16 v[2:3], v128 offset:36864
buffer_load_dwordx4 v141, s[4:7], s16 offen offset:0 sc1 lds
v_mfma_f32_16x16x32_bf16 v[76:79], v[48:51], v[44:47], v[76:79]
ds_read_b64_tr_b16 v[4:5], v129 offset:32768
v_mfma_f32_16x16x32_bf16 v[80:83], v[52:55], v[32:35], v[80:83]
ds_read_b64_tr_b16 v[6:7], v129 offset:36864
v_mfma_f32_16x16x32_bf16 v[84:87], v[52:55], v[36:39], v[84:87]
ds_read_b64_tr_b16 v[8:9], v130 offset:32768
buffer_load_dwordx4 v141, s[4:7], s16 offen offset:1024 sc1 lds
v_mfma_f32_16x16x32_bf16 v[88:91], v[52:55], v[40:43], v[88:91]
ds_read_b64_tr_b16 v[10:11], v130 offset:36864
v_mfma_f32_16x16x32_bf16 v[92:95], v[52:55], v[44:47], v[92:95]
ds_read_b64_tr_b16 v[12:13], v131 offset:32768
buffer_load_dwordx4 v142, s[4:7], s16 offen offset:2048 sc1 lds
v_mov_b32 v255, 131072
v_mfma_f32_16x16x32_bf16 v[96:99], v[56:59], v[32:35], v[96:99]
ds_read_b64_tr_b16 v[14:15], v131 offset:36864
v_mfma_f32_16x16x32_bf16 v[100:103], v[56:59], v[36:39], v[100:103]
ds_read_b128 v[20:23], v136 offset:34816
v_mfma_f32_16x16x32_bf16 v[104:107], v[56:59], v[40:43], v[104:107]
ds_read_b128 v[24:27], v136 offset:36864
buffer_load_dwordx4 v142, s[4:7], s16 offen offset:3072 sc1 lds
v_mfma_f32_16x16x32_bf16 v[108:111], v[56:59], v[44:47], v[108:111]
ds_read_b128 v[28:31], v136 offset:38912
v_mfma_f32_16x16x32_bf16 v[112:115], v[60:63], v[32:35], v[112:115]
s_add_u32 s16, s16, 2048
v_mfma_f32_16x16x32_bf16 v[116:119], v[60:63], v[36:39], v[116:119]
v_mfma_f32_16x16x32_bf16 v[120:123], v[60:63], v[40:43], v[120:123]
v_mfma_f32_16x16x32_bf16 v[124:127], v[60:63], v[44:47], v[124:127]
s_waitcnt lgkmcnt(0)
ds_read_b128 v[48:51], v136 offset:33792
s_add_u32 m0, s19, 16384
s_nop 0
v_mfma_f32_16x16x32_bf16 v[64:67], v[16:19], v[0:3], v[64:67]
ds_read_b64_tr_b16 v[32:33], v128 offset:40960
v_mfma_f32_16x16x32_bf16 v[68:71], v[16:19], v[4:7], v[68:71]
ds_read_b64_tr_b16 v[34:35], v128 offset:45056
buffer_load_dwordx4 v137, s[8:11], s15 offen offset:0 lds
v_mfma_f32_16x16x32_bf16 v[72:75], v[16:19], v[8:11], v[72:75]
ds_read_b64_tr_b16 v[36:37], v129 offset:40960
v_mfma_f32_16x16x32_bf16 v[76:79], v[16:19], v[12:15], v[76:79]
ds_read_b64_tr_b16 v[38:39], v129 offset:45056
v_mfma_f32_16x16x32_bf16 v[80:83], v[20:23], v[0:3], v[80:83]
ds_read_b64_tr_b16 v[40:41], v130 offset:40960
buffer_load_dwordx4 v138, s[8:11], s15 offen offset:1024 lds
v_mfma_f32_16x16x32_bf16 v[84:87], v[20:23], v[4:7], v[84:87]
ds_read_b64_tr_b16 v[42:43], v130 offset:45056
v_mfma_f32_16x16x32_bf16 v[88:91], v[20:23], v[8:11], v[88:91]
ds_read_b64_tr_b16 v[44:45], v131 offset:40960
v_mfma_f32_16x16x32_bf16 v[92:95], v[20:23], v[12:15], v[92:95]
ds_read_b64_tr_b16 v[46:47], v131 offset:45056
buffer_load_dwordx4 v139, s[8:11], s15 offen offset:2048 lds
v_mfma_f32_16x16x32_bf16 v[96:99], v[24:27], v[0:3], v[96:99]
ds_read_b128 v[52:55], v136 offset:35840
v_mfma_f32_16x16x32_bf16 v[100:103], v[24:27], v[4:7], v[100:103]
ds_read_b128 v[56:59], v136 offset:37888
buffer_load_dwordx4 v140, s[8:11], s15 offen offset:3072 lds
v_mfma_f32_16x16x32_bf16 v[104:107], v[24:27], v[8:11], v[104:107]
ds_read_b128 v[60:63], v136 offset:39936
v_mfma_f32_16x16x32_bf16 v[108:111], v[24:27], v[12:15], v[108:111]
v_mfma_f32_16x16x32_bf16 v[112:115], v[28:31], v[0:3], v[112:115]
s_add_u32 s15, s15, s17
v_mfma_f32_16x16x32_bf16 v[116:119], v[28:31], v[4:7], v[116:119]
v_mfma_f32_16x16x32_bf16 v[120:123], v[28:31], v[8:11], v[120:123]
v_mfma_f32_16x16x32_bf16 v[124:127], v[28:31], v[12:15], v[124:127]
s_waitcnt lgkmcnt(0)
v_mfma_f32_16x16x32_bf16 v[64:67], v[48:51], v[32:35], v[64:67]
s_waitcnt vmcnt(16)
s_barrier
ds_read_b128 v[16:19], v136 offset:49152
s_add_u32 m0, s20, 32768
s_nop 0
v_mfma_f32_16x16x32_bf16 v[68:71], v[48:51], v[36:39], v[68:71]
ds_read_b64_tr_b16 v[0:1], v128 offset:49152
v_mfma_f32_16x16x32_bf16 v[72:75], v[48:51], v[40:43], v[72:75]
ds_read_b64_tr_b16 v[2:3], v128 offset:53248
buffer_load_dwordx4 v141, s[4:7], s16 offen offset:0 sc1 lds
v_mfma_f32_16x16x32_bf16 v[76:79], v[48:51], v[44:47], v[76:79]
ds_read_b64_tr_b16 v[4:5], v129 offset:49152
v_mfma_f32_16x16x32_bf16 v[80:83], v[52:55], v[32:35], v[80:83]
ds_read_b64_tr_b16 v[6:7], v129 offset:53248
s_waitcnt vmcnt(13)
v_min3_u32 v253, v232, v233, v234
v_mfma_f32_16x16x32_bf16 v[84:87], v[52:55], v[36:39], v[84:87]
ds_read_b64_tr_b16 v[8:9], v130 offset:49152
buffer_load_dwordx4 v141, s[4:7], s16 offen offset:1024 sc1 lds
v_min_u32 v253, v253, v235
v_mfma_f32_16x16x32_bf16 v[88:91], v[52:55], v[40:43], v[88:91]
ds_read_b64_tr_b16 v[10:11], v130 offset:53248
v_or_b32 v253, s61, v253
v_mfma_f32_16x16x32_bf16 v[92:95], v[52:55], v[44:47], v[92:95]
ds_read_b64_tr_b16 v[12:13], v131 offset:49152
buffer_load_dwordx4 v142, s[4:7], s16 offen offset:2048 sc1 lds
v_min_u32 v253, v253, v231
v_mfma_f32_16x16x32_bf16 v[96:99], v[56:59], v[32:35], v[96:99]
ds_read_b64_tr_b16 v[14:15], v131 offset:53248
v_cmp_eq_u32 vcc, 0, v253
v_mfma_f32_16x16x32_bf16 v[100:103], v[56:59], v[36:39], v[100:103]
ds_read_b128 v[20:23], v136 offset:51200
s_nop 1
v_mfma_f32_16x16x32_bf16 v[104:107], v[56:59], v[40:43], v[104:107]
ds_read_b128 v[24:27], v136 offset:53248
buffer_load_dwordx4 v142, s[4:7], s16 offen offset:3072 sc1 lds
s_cmp_eq_u64 vcc, 0
s_cselect_b32 s32, s36, -4
v_mfma_f32_16x16x32_bf16 v[108:111], v[56:59], v[44:47], v[108:111]
ds_read_b128 v[28:31], v136 offset:55296
s_bitcmp1_b32 0x1df, s23
s_cselect_b32 s32, s32, -4
v_mfma_f32_16x16x32_bf16 v[112:115], v[60:63], v[32:35], v[112:115]
s_add_u32 s16, s16, 2048
s_sub_u32 s33, s59, 0x8406000
s_cmp_lt_u32 s33, 0x4000
s_cselect_b32 s32, -4, s32
v_mfma_f32_16x16x32_bf16 v[116:119], v[60:63], v[36:39], v[116:119]
v_mov_b32 v254, s32
v_mfma_f32_16x16x32_bf16 v[120:123], v[60:63], v[40:43], v[120:123]
s_mov_b64 exec, s[100:101]
ds_write_b32 v255, v254
s_mov_b64 exec, -1
v_mfma_f32_16x16x32_bf16 v[124:127], v[60:63], v[44:47], v[124:127]
s_waitcnt lgkmcnt(0)
ds_read_b128 v[48:51], v136 offset:50176
s_add_u32 m0, s19, 32768
s_nop 0
v_mfma_f32_16x16x32_bf16 v[64:67], v[16:19], v[0:3], v[64:67]
ds_read_b64_tr_b16 v[32:33], v128 offset:57344
v_mfma_f32_16x16x32_bf16 v[68:71], v[16:19], v[4:7], v[68:71]
ds_read_b64_tr_b16 v[34:35], v128 offset:61440
buffer_load_dwordx4 v137, s[8:11], s15 offen offset:0 lds
v_mfma_f32_16x16x32_bf16 v[72:75], v[16:19], v[8:11], v[72:75]
ds_read_b64_tr_b16 v[36:37], v129 offset:57344
v_mfma_f32_16x16x32_bf16 v[76:79], v[16:19], v[12:15], v[76:79]
ds_read_b64_tr_b16 v[38:39], v129 offset:61440
v_mfma_f32_16x16x32_bf16 v[80:83], v[20:23], v[0:3], v[80:83]
ds_read_b64_tr_b16 v[40:41], v130 offset:57344
buffer_load_dwordx4 v138, s[8:11], s15 offen offset:1024 lds
v_mfma_f32_16x16x32_bf16 v[84:87], v[20:23], v[4:7], v[84:87]
ds_read_b64_tr_b16 v[42:43], v130 offset:61440
v_mfma_f32_16x16x32_bf16 v[88:91], v[20:23], v[8:11], v[88:91]
ds_read_b64_tr_b16 v[44:45], v131 offset:57344
v_mfma_f32_16x16x32_bf16 v[92:95], v[20:23], v[12:15], v[92:95]
ds_read_b64_tr_b16 v[46:47], v131 offset:61440
buffer_load_dwordx4 v139, s[8:11], s15 offen offset:2048 lds
v_mfma_f32_16x16x32_bf16 v[96:99], v[24:27], v[0:3], v[96:99]
ds_read_b128 v[52:55], v136 offset:52224
v_mfma_f32_16x16x32_bf16 v[100:103], v[24:27], v[4:7], v[100:103]
ds_read_b128 v[56:59], v136 offset:54272
buffer_load_dwordx4 v140, s[8:11], s15 offen offset:3072 lds
v_mfma_f32_16x16x32_bf16 v[104:107], v[24:27], v[8:11], v[104:107]
ds_read_b128 v[60:63], v136 offset:56320
v_mfma_f32_16x16x32_bf16 v[108:111], v[24:27], v[12:15], v[108:111]
v_mfma_f32_16x16x32_bf16 v[112:115], v[28:31], v[0:3], v[112:115]
s_add_u32 s15, s15, s17
v_mfma_f32_16x16x32_bf16 v[116:119], v[28:31], v[4:7], v[116:119]
v_mfma_f32_16x16x32_bf16 v[120:123], v[28:31], v[8:11], v[120:123]
v_mfma_f32_16x16x32_bf16 v[124:127], v[28:31], v[12:15], v[124:127]
s_waitcnt lgkmcnt(0)
v_mfma_f32_16x16x32_bf16 v[64:67], v[48:51], v[32:35], v[64:67]
s_waitcnt vmcnt(16)
s_barrier
ds_read_b128 v[16:19], v136 offset:0
s_add_u32 m0, s20, 49152
s_nop 0
ds_read_b32 v254, v255
v_mfma_f32_16x16x32_bf16 v[68:71], v[48:51], v[36:39], v[68:71]
ds_read_b64_tr_b16 v[0:1], v128 offset:0
v_mfma_f32_16x16x32_bf16 v[72:75], v[48:51], v[40:43], v[72:75]
ds_read_b64_tr_b16 v[2:3], v128 offset:4096
buffer_load_dwordx4 v141, s[4:7], s16 offen offset:0 sc1 lds
v_mfma_f32_16x16x32_bf16 v[76:79], v[48:51], v[44:47], v[76:79]
ds_read_b64_tr_b16 v[4:5], v129 offset:0
v_mfma_f32_16x16x32_bf16 v[80:83], v[52:55], v[32:35], v[80:83]
ds_read_b64_tr_b16 v[6:7], v129 offset:4096
v_mfma_f32_16x16x32_bf16 v[84:87], v[52:55], v[36:39], v[84:87]
ds_read_b64_tr_b16 v[8:9], v130 offset:0
buffer_load_dwordx4 v141, s[4:7], s16 offen offset:1024 sc1 lds
v_mfma_f32_16x16x32_bf16 v[88:91], v[52:55], v[40:43], v[88:91]
ds_read_b64_tr_b16 v[10:11], v130 offset:4096
v_mfma_f32_16x16x32_bf16 v[92:95], v[52:55], v[44:47], v[92:95]
ds_read_b64_tr_b16 v[12:13], v131 offset:0
buffer_load_dwordx4 v142, s[4:7], s16 offen offset:2048 sc1 lds
v_mfma_f32_16x16x32_bf16 v[96:99], v[56:59], v[32:35], v[96:99]
ds_read_b64_tr_b16 v[14:15], v131 offset:4096
v_mfma_f32_16x16x32_bf16 v[100:103], v[56:59], v[36:39], v[100:103]
ds_read_b128 v[20:23], v136 offset:2048
v_mfma_f32_16x16x32_bf16 v[104:107], v[56:59], v[40:43], v[104:107]
ds_read_b128 v[24:27], v136 offset:4096
buffer_load_dwordx4 v142, s[4:7], s16 offen offset:3072 sc1 lds
v_mfma_f32_16x16x32_bf16 v[108:111], v[56:59], v[44:47], v[108:111]
ds_read_b128 v[28:31], v136 offset:6144
v_mfma_f32_16x16x32_bf16 v[112:115], v[60:63], v[32:35], v[112:115]
s_add_u32 s16, s16, 2048
v_mfma_f32_16x16x32_bf16 v[116:119], v[60:63], v[36:39], v[116:119]
v_mfma_f32_16x16x32_bf16 v[120:123], v[60:63], v[40:43], v[120:123]
v_mfma_f32_16x16x32_bf16 v[124:127], v[60:63], v[44:47], v[124:127]
s_waitcnt lgkmcnt(0)
ds_read_b128 v[48:51], v136 offset:1024
s_add_u32 m0, s19, 49152
s_nop 0
v_mfma_f32_16x16x32_bf16 v[64:67], v[16:19], v[0:3], v[64:67]
ds_read_b64_tr_b16 v[32:33], v128 offset:8192
v_readfirstlane_b32 s62, v254
v_mfma_f32_16x16x32_bf16 v[68:71], v[16:19], v[4:7], v[68:71]
ds_read_b64_tr_b16 v[34:35], v128 offset:12288
buffer_load_dwordx4 v137, s[8:11], s15 offen offset:0 lds
v_mfma_f32_16x16x32_bf16 v[72:75], v[16:19], v[8:11], v[72:75]
ds_read_b64_tr_b16 v[36:37], v129 offset:8192
s_nop 1
v_mfma_f32_16x16x32_bf16 v[76:79], v[16:19], v[12:15], v[76:79]
ds_read_b64_tr_b16 v[38:39], v129 offset:12288
v_mfma_f32_16x16x32_bf16 v[80:83], v[20:23], v[0:3], v[80:83]
ds_read_b64_tr_b16 v[40:41], v130 offset:8192
buffer_load_dwordx4 v138, s[8:11], s15 offen offset:1024 lds
v_mfma_f32_16x16x32_bf16 v[84:87], v[20:23], v[4:7], v[84:87]
ds_read_b64_tr_b16 v[42:43], v130 offset:12288
s_and_b32 s23, s62, 15
v_mfma_f32_16x16x32_bf16 v[88:91], v[20:23], v[8:11], v[88:91]
ds_read_b64_tr_b16 v[44:45], v131 offset:8192
v_mfma_f32_16x16x32_bf16 v[92:95], v[20:23], v[12:15], v[92:95]
ds_read_b64_tr_b16 v[46:47], v131 offset:12288
buffer_load_dwordx4 v139, s[8:11], s15 offen offset:2048 lds
s_bfe_u32 s54, s62, 0x20004
v_mfma_f32_16x16x32_bf16 v[96:99], v[24:27], v[0:3], v[96:99]
ds_read_b128 v[52:55], v136 offset:3072
v_mfma_f32_16x16x32_bf16 v[100:103], v[24:27], v[4:7], v[100:103]
ds_read_b128 v[56:59], v136 offset:5120
buffer_load_dwordx4 v140, s[8:11], s15 offen offset:3072 lds
v_mfma_f32_16x16x32_bf16 v[104:107], v[24:27], v[8:11], v[104:107]
ds_read_b128 v[60:63], v136 offset:7168
s_bfe_u32 s24, s62, 0x80008
v_mfma_f32_16x16x32_bf16 v[108:111], v[24:27], v[12:15], v[108:111]
v_mfma_f32_16x16x32_bf16 v[112:115], v[28:31], v[0:3], v[112:115]
s_add_u32 s15, s15, s17
s_lshr_b32 s25, s62, 16
v_mfma_f32_16x16x32_bf16 v[116:119], v[28:31], v[4:7], v[116:119]
v_mfma_f32_16x16x32_bf16 v[120:123], v[28:31], v[8:11], v[120:123]
v_mfma_f32_16x16x32_bf16 v[124:127], v[28:31], v[12:15], v[124:127]
s_cmp_eq_u32 s54, 0
s_cselect_b32 s73, 1, -1
s_cbranch_scc1 main_kernel_w_c0_task
s_waitcnt lgkmcnt(0)
v_mfma_f32_16x16x32_bf16 v[64:67], v[48:51], v[32:35], v[64:67]
s_waitcnt vmcnt(16)
s_barrier
ds_read_b128 v[16:19], v136 offset:16384
v_mfma_f32_16x16x32_bf16 v[68:71], v[48:51], v[36:39], v[68:71]
ds_read_b64_tr_b16 v[0:1], v128 offset:16384
v_mfma_f32_16x16x32_bf16 v[72:75], v[48:51], v[40:43], v[72:75]
ds_read_b64_tr_b16 v[2:3], v128 offset:20480
v_mfma_f32_16x16x32_bf16 v[76:79], v[48:51], v[44:47], v[76:79]
ds_read_b64_tr_b16 v[4:5], v129 offset:16384
v_mfma_f32_16x16x32_bf16 v[80:83], v[52:55], v[32:35], v[80:83]
ds_read_b64_tr_b16 v[6:7], v129 offset:20480
v_mfma_f32_16x16x32_bf16 v[84:87], v[52:55], v[36:39], v[84:87]
ds_read_b64_tr_b16 v[8:9], v130 offset:16384
v_mfma_f32_16x16x32_bf16 v[88:91], v[52:55], v[40:43], v[88:91]
ds_read_b64_tr_b16 v[10:11], v130 offset:20480
v_mfma_f32_16x16x32_bf16 v[92:95], v[52:55], v[44:47], v[92:95]
ds_read_b64_tr_b16 v[12:13], v131 offset:16384
v_mfma_f32_16x16x32_bf16 v[96:99], v[56:59], v[32:35], v[96:99]
ds_read_b64_tr_b16 v[14:15], v131 offset:20480
v_mfma_f32_16x16x32_bf16 v[100:103], v[56:59], v[36:39], v[100:103]
ds_read_b128 v[20:23], v136 offset:18432
v_mfma_f32_16x16x32_bf16 v[104:107], v[56:59], v[40:43], v[104:107]
ds_read_b128 v[24:27], v136 offset:20480
v_mfma_f32_16x16x32_bf16 v[108:111], v[56:59], v[44:47], v[108:111]
ds_read_b128 v[28:31], v136 offset:22528
v_mfma_f32_16x16x32_bf16 v[112:115], v[60:63], v[32:35], v[112:115]
v_mfma_f32_16x16x32_bf16 v[116:119], v[60:63], v[36:39], v[116:119]
v_mfma_f32_16x16x32_bf16 v[120:123], v[60:63], v[40:43], v[120:123]
v_mfma_f32_16x16x32_bf16 v[124:127], v[60:63], v[44:47], v[124:127]
s_waitcnt lgkmcnt(0)
ds_read_b128 v[48:51], v136 offset:17408
v_mfma_f32_16x16x32_bf16 v[64:67], v[16:19], v[0:3], v[64:67]
ds_read_b64_tr_b16 v[32:33], v128 offset:24576
v_mfma_f32_16x16x32_bf16 v[68:71], v[16:19], v[4:7], v[68:71]
ds_read_b64_tr_b16 v[34:35], v128 offset:28672
v_mfma_f32_16x16x32_bf16 v[72:75], v[16:19], v[8:11], v[72:75]
ds_read_b64_tr_b16 v[36:37], v129 offset:24576
v_mfma_f32_16x16x32_bf16 v[76:79], v[16:19], v[12:15], v[76:79]
ds_read_b64_tr_b16 v[38:39], v129 offset:28672
v_mfma_f32_16x16x32_bf16 v[80:83], v[20:23], v[0:3], v[80:83]
ds_read_b64_tr_b16 v[40:41], v130 offset:24576
v_mfma_f32_16x16x32_bf16 v[84:87], v[20:23], v[4:7], v[84:87]
ds_read_b64_tr_b16 v[42:43], v130 offset:28672
v_mfma_f32_16x16x32_bf16 v[88:91], v[20:23], v[8:11], v[88:91]
ds_read_b64_tr_b16 v[44:45], v131 offset:24576
v_mfma_f32_16x16x32_bf16 v[92:95], v[20:23], v[12:15], v[92:95]
ds_read_b64_tr_b16 v[46:47], v131 offset:28672
v_mfma_f32_16x16x32_bf16 v[96:99], v[24:27], v[0:3], v[96:99]
ds_read_b128 v[52:55], v136 offset:19456
v_mfma_f32_16x16x32_bf16 v[100:103], v[24:27], v[4:7], v[100:103]
ds_read_b128 v[56:59], v136 offset:21504
v_mfma_f32_16x16x32_bf16 v[104:107], v[24:27], v[8:11], v[104:107]
ds_read_b128 v[60:63], v136 offset:23552
v_mfma_f32_16x16x32_bf16 v[108:111], v[24:27], v[12:15], v[108:111]
v_mfma_f32_16x16x32_bf16 v[112:115], v[28:31], v[0:3], v[112:115]
v_mfma_f32_16x16x32_bf16 v[116:119], v[28:31], v[4:7], v[116:119]
v_mfma_f32_16x16x32_bf16 v[120:123], v[28:31], v[8:11], v[120:123]
v_mfma_f32_16x16x32_bf16 v[124:127], v[28:31], v[12:15], v[124:127]
s_waitcnt lgkmcnt(0)
v_mfma_f32_16x16x32_bf16 v[64:67], v[48:51], v[32:35], v[64:67]
s_waitcnt vmcnt(8)
s_barrier
ds_read_b128 v[16:19], v136 offset:32768
v_mfma_f32_16x16x32_bf16 v[68:71], v[48:51], v[36:39], v[68:71]
ds_read_b64_tr_b16 v[0:1], v128 offset:32768
v_mfma_f32_16x16x32_bf16 v[72:75], v[48:51], v[40:43], v[72:75]
ds_read_b64_tr_b16 v[2:3], v128 offset:36864
v_mfma_f32_16x16x32_bf16 v[76:79], v[48:51], v[44:47], v[76:79]
ds_read_b64_tr_b16 v[4:5], v129 offset:32768
v_mfma_f32_16x16x32_bf16 v[80:83], v[52:55], v[32:35], v[80:83]
ds_read_b64_tr_b16 v[6:7], v129 offset:36864
v_mfma_f32_16x16x32_bf16 v[84:87], v[52:55], v[36:39], v[84:87]
ds_read_b64_tr_b16 v[8:9], v130 offset:32768
v_mfma_f32_16x16x32_bf16 v[88:91], v[52:55], v[40:43], v[88:91]
ds_read_b64_tr_b16 v[10:11], v130 offset:36864
v_mfma_f32_16x16x32_bf16 v[92:95], v[52:55], v[44:47], v[92:95]
ds_read_b64_tr_b16 v[12:13], v131 offset:32768
v_mfma_f32_16x16x32_bf16 v[96:99], v[56:59], v[32:35], v[96:99]
ds_read_b64_tr_b16 v[14:15], v131 offset:36864
v_mfma_f32_16x16x32_bf16 v[100:103], v[56:59], v[36:39], v[100:103]
ds_read_b128 v[20:23], v136 offset:34816
v_mfma_f32_16x16x32_bf16 v[104:107], v[56:59], v[40:43], v[104:107]
ds_read_b128 v[24:27], v136 offset:36864
v_mfma_f32_16x16x32_bf16 v[108:111], v[56:59], v[44:47], v[108:111]
ds_read_b128 v[28:31], v136 offset:38912
v_mfma_f32_16x16x32_bf16 v[112:115], v[60:63], v[32:35], v[112:115]
v_mfma_f32_16x16x32_bf16 v[116:119], v[60:63], v[36:39], v[116:119]
v_mfma_f32_16x16x32_bf16 v[120:123], v[60:63], v[40:43], v[120:123]
v_mfma_f32_16x16x32_bf16 v[124:127], v[60:63], v[44:47], v[124:127]
s_waitcnt lgkmcnt(0)
ds_read_b128 v[48:51], v136 offset:33792
v_mfma_f32_16x16x32_bf16 v[64:67], v[16:19], v[0:3], v[64:67]
ds_read_b64_tr_b16 v[32:33], v128 offset:40960
v_mfma_f32_16x16x32_bf16 v[68:71], v[16:19], v[4:7], v[68:71]
ds_read_b64_tr_b16 v[34:35], v128 offset:45056
v_mfma_f32_16x16x32_bf16 v[72:75], v[16:19], v[8:11], v[72:75]
ds_read_b64_tr_b16 v[36:37], v129 offset:40960
v_mfma_f32_16x16x32_bf16 v[76:79], v[16:19], v[12:15], v[76:79]
ds_read_b64_tr_b16 v[38:39], v129 offset:45056
v_mfma_f32_16x16x32_bf16 v[80:83], v[20:23], v[0:3], v[80:83]
ds_read_b64_tr_b16 v[40:41], v130 offset:40960
v_mfma_f32_16x16x32_bf16 v[84:87], v[20:23], v[4:7], v[84:87]
ds_read_b64_tr_b16 v[42:43], v130 offset:45056
v_mfma_f32_16x16x32_bf16 v[88:91], v[20:23], v[8:11], v[88:91]
ds_read_b64_tr_b16 v[44:45], v131 offset:40960
v_mfma_f32_16x16x32_bf16 v[92:95], v[20:23], v[12:15], v[92:95]
ds_read_b64_tr_b16 v[46:47], v131 offset:45056
v_mfma_f32_16x16x32_bf16 v[96:99], v[24:27], v[0:3], v[96:99]
ds_read_b128 v[52:55], v136 offset:35840
v_mfma_f32_16x16x32_bf16 v[100:103], v[24:27], v[4:7], v[100:103]
ds_read_b128 v[56:59], v136 offset:37888
v_mfma_f32_16x16x32_bf16 v[104:107], v[24:27], v[8:11], v[104:107]
ds_read_b128 v[60:63], v136 offset:39936
v_mfma_f32_16x16x32_bf16 v[108:111], v[24:27], v[12:15], v[108:111]
v_mfma_f32_16x16x32_bf16 v[112:115], v[28:31], v[0:3], v[112:115]
v_mfma_f32_16x16x32_bf16 v[116:119], v[28:31], v[4:7], v[116:119]
v_mfma_f32_16x16x32_bf16 v[120:123], v[28:31], v[8:11], v[120:123]
v_mfma_f32_16x16x32_bf16 v[124:127], v[28:31], v[12:15], v[124:127]
s_waitcnt lgkmcnt(0)
v_mfma_f32_16x16x32_bf16 v[64:67], v[48:51], v[32:35], v[64:67]
s_waitcnt vmcnt(0)
s_barrier
ds_read_b128 v[16:19], v136 offset:49152
v_mfma_f32_16x16x32_bf16 v[68:71], v[48:51], v[36:39], v[68:71]
ds_read_b64_tr_b16 v[0:1], v128 offset:49152
v_mfma_f32_16x16x32_bf16 v[72:75], v[48:51], v[40:43], v[72:75]
ds_read_b64_tr_b16 v[2:3], v128 offset:53248
v_mfma_f32_16x16x32_bf16 v[76:79], v[48:51], v[44:47], v[76:79]
ds_read_b64_tr_b16 v[4:5], v129 offset:49152
v_mfma_f32_16x16x32_bf16 v[80:83], v[52:55], v[32:35], v[80:83]
ds_read_b64_tr_b16 v[6:7], v129 offset:53248
v_mfma_f32_16x16x32_bf16 v[84:87], v[52:55], v[36:39], v[84:87]
ds_read_b64_tr_b16 v[8:9], v130 offset:49152
v_mfma_f32_16x16x32_bf16 v[88:91], v[52:55], v[40:43], v[88:91]
ds_read_b64_tr_b16 v[10:11], v130 offset:53248
v_mfma_f32_16x16x32_bf16 v[92:95], v[52:55], v[44:47], v[92:95]
ds_read_b64_tr_b16 v[12:13], v131 offset:49152
v_mfma_f32_16x16x32_bf16 v[96:99], v[56:59], v[32:35], v[96:99]
ds_read_b64_tr_b16 v[14:15], v131 offset:53248
v_mfma_f32_16x16x32_bf16 v[100:103], v[56:59], v[36:39], v[100:103]
ds_read_b128 v[20:23], v136 offset:51200
v_mfma_f32_16x16x32_bf16 v[104:107], v[56:59], v[40:43], v[104:107]
ds_read_b128 v[24:27], v136 offset:53248
v_mfma_f32_16x16x32_bf16 v[108:111], v[56:59], v[44:47], v[108:111]
ds_read_b128 v[28:31], v136 offset:55296
v_mfma_f32_16x16x32_bf16 v[112:115], v[60:63], v[32:35], v[112:115]
v_mfma_f32_16x16x32_bf16 v[116:119], v[60:63], v[36:39], v[116:119]
v_mfma_f32_16x16x32_bf16 v[120:123], v[60:63], v[40:43], v[120:123]
v_mfma_f32_16x16x32_bf16 v[124:127], v[60:63], v[44:47], v[124:127]
s_waitcnt lgkmcnt(0)
ds_read_b128 v[48:51], v136 offset:50176
v_mfma_f32_16x16x32_bf16 v[64:67], v[16:19], v[0:3], v[64:67]
ds_read_b64_tr_b16 v[32:33], v128 offset:57344
v_mfma_f32_16x16x32_bf16 v[68:71], v[16:19], v[4:7], v[68:71]
ds_read_b64_tr_b16 v[34:35], v128 offset:61440
v_mfma_f32_16x16x32_bf16 v[72:75], v[16:19], v[8:11], v[72:75]
ds_read_b64_tr_b16 v[36:37], v129 offset:57344
v_mfma_f32_16x16x32_bf16 v[76:79], v[16:19], v[12:15], v[76:79]
ds_read_b64_tr_b16 v[38:39], v129 offset:61440
v_mfma_f32_16x16x32_bf16 v[80:83], v[20:23], v[0:3], v[80:83]
ds_read_b64_tr_b16 v[40:41], v130 offset:57344
v_mfma_f32_16x16x32_bf16 v[84:87], v[20:23], v[4:7], v[84:87]
ds_read_b64_tr_b16 v[42:43], v130 offset:61440
v_mfma_f32_16x16x32_bf16 v[88:91], v[20:23], v[8:11], v[88:91]
ds_read_b64_tr_b16 v[44:45], v131 offset:57344
v_mfma_f32_16x16x32_bf16 v[92:95], v[20:23], v[12:15], v[92:95]
ds_read_b64_tr_b16 v[46:47], v131 offset:61440
v_mfma_f32_16x16x32_bf16 v[96:99], v[24:27], v[0:3], v[96:99]
ds_read_b128 v[52:55], v136 offset:52224
v_mfma_f32_16x16x32_bf16 v[100:103], v[24:27], v[4:7], v[100:103]
ds_read_b128 v[56:59], v136 offset:54272
v_mfma_f32_16x16x32_bf16 v[104:107], v[24:27], v[8:11], v[104:107]
ds_read_b128 v[60:63], v136 offset:56320
v_mfma_f32_16x16x32_bf16 v[108:111], v[24:27], v[12:15], v[108:111]
v_mfma_f32_16x16x32_bf16 v[112:115], v[28:31], v[0:3], v[112:115]
v_mfma_f32_16x16x32_bf16 v[116:119], v[28:31], v[4:7], v[116:119]
v_mfma_f32_16x16x32_bf16 v[120:123], v[28:31], v[8:11], v[120:123]
v_mfma_f32_16x16x32_bf16 v[124:127], v[28:31], v[12:15], v[124:127]
s_waitcnt lgkmcnt(0)
v_mfma_f32_16x16x32_bf16 v[64:67], v[48:51], v[32:35], v[64:67]
s_barrier
v_mfma_f32_16x16x32_bf16 v[68:71], v[48:51], v[36:39], v[68:71]
v_mfma_f32_16x16x32_bf16 v[72:75], v[48:51], v[40:43], v[72:75]
v_mfma_f32_16x16x32_bf16 v[76:79], v[48:51], v[44:47], v[76:79]
v_mfma_f32_16x16x32_bf16 v[80:83], v[52:55], v[32:35], v[80:83]
v_mfma_f32_16x16x32_bf16 v[84:87], v[52:55], v[36:39], v[84:87]
v_mfma_f32_16x16x32_bf16 v[88:91], v[52:55], v[40:43], v[88:91]
v_mfma_f32_16x16x32_bf16 v[92:95], v[52:55], v[44:47], v[92:95]
v_mfma_f32_16x16x32_bf16 v[96:99], v[56:59], v[32:35], v[96:99]
v_mfma_f32_16x16x32_bf16 v[100:103], v[56:59], v[36:39], v[100:103]
v_mfma_f32_16x16x32_bf16 v[104:107], v[56:59], v[40:43], v[104:107]
v_mfma_f32_16x16x32_bf16 v[108:111], v[56:59], v[44:47], v[108:111]
v_mfma_f32_16x16x32_bf16 v[112:115], v[60:63], v[32:35], v[112:115]
v_mfma_f32_16x16x32_bf16 v[116:119], v[60:63], v[36:39], v[116:119]
v_mfma_f32_16x16x32_bf16 v[120:123], v[60:63], v[40:43], v[120:123]
v_mfma_f32_16x16x32_bf16 v[124:127], v[60:63], v[44:47], v[124:127]
s_cmp_lg_u32 s62, -4
s_cbranch_scc1 main_kernel_w_gemm
s_branch main_kernel_w_slow
main_kernel_w_c0_v_ev:
s_mov_b32 s55, 1
s_cmp_eq_u32 s56, 0
s_cbranch_scc1 main_kernel_w_c0_v_et
s_bfm_b64 exec, s0, 0
buffer_store_dword v244, v248, s[4:7], s59 offen sc1
s_mov_b64 exec, -1
s_mov_b32 s56, 0
main_kernel_w_c0_v_et:
s_cmp_lg_u32 s18, 1
s_cbranch_scc1 main_kernel_w_c0_v_loop
s_lshl_b32 s32, s27, 8
s_add_u32 s32, s32, 0x841e000
s_mov_b64 exec, 1
v_mov_b32 v249, 1
buffer_atomic_add v249, off, s[4:7], s32 sc0 sc1
s_mov_b64 exec, -1
s_branch main_kernel_w_c0_v_loop
main_kernel_w_c1_task:
s_cmp_eq_u32 s23, 0
s_cbranch_scc1 main_kernel_w_c1_set0
s_cmp_eq_u32 s23, 1
s_cbranch_scc1 main_kernel_w_c1_set1
s_cmp_eq_u32 s23, 2
s_cbranch_scc1 main_kernel_w_c1_set2
s_cmp_eq_u32 s23, 3
s_cbranch_scc1 main_kernel_w_c1_set3
s_cmp_eq_u32 s23, 6
s_cbranch_scc1 main_kernel_w_c1_set6
s_branch main_kernel_end2
main_kernel_w_c1_set0:
s_mov_b32 s57, 6
s_lshl_b32 s32, s25, 8
s_add_u32 s8, s40, s32
s_addc_u32 s9, s41, 0
s_and_b32 s9, s9, 0xffff
s_sub_u32 s10, 0x800000, s32
s_mov_b32 s11, 0x20000
s_mov_b32 s30, 8192
s_mov_b32 s31, 32768
s_mul_i32 s16, s24, 262144
s_add_u32 s16, s16, 0x0
s_mov_b32 s18, 7
s_lshl_b32 s32, s24, 3
s_mul_i32 s33, s38, 4
s_add_u32 s32, s32, s33
s_mul_i32 s32, s32, 131072
s_lshl_b32 s33, s25, 12
s_add_u32 s32, s32, s33
s_mul_i32 s33, s37, 4096
s_add_u32 s32, s32, s33
s_add_u32 s21, s32, 0x800000
s_mov_b32 s22, 131072
s_mov_b32 s26, 0x7f000000
s_branch main_kernel_w_c1_go
main_kernel_w_c1_set1:
s_mov_b32 s57, 7
s_lshl_b32 s32, s25, 8
s_add_u32 s8, s42, s32
s_addc_u32 s9, s43, 0
s_and_b32 s9, s9, 0xffff
s_sub_u32 s10, 0x800000, s32
s_mov_b32 s11, 0x20000
s_mov_b32 s30, 8192
s_mov_b32 s31, 32768
s_mul_i32 s16, s24, 262144
s_add_u32 s16, s16, 0x0
s_mov_b32 s18, 7
s_lshl_b32 s32, s24, 3
s_mul_i32 s33, s38, 4
s_add_u32 s32, s32, s33
s_mul_i32 s32, s32, 131072
s_lshl_b32 s33, s25, 12
s_add_u32 s32, s32, s33
s_mul_i32 s33, s37, 4096
s_add_u32 s32, s32, s33
s_add_u32 s21, s32, 0x1800000
s_mov_b32 s22, 131072
s_mov_b32 s26, 0x7f000000
s_branch main_kernel_w_c1_go
main_kernel_w_c1_set2:
s_mov_b32 s57, 8
s_lshl_b32 s32, s25, 8
s_add_u32 s8, s44, s32
s_addc_u32 s9, s45, 0
s_and_b32 s9, s9, 0xffff
s_sub_u32 s10, 0x800000, s32
s_mov_b32 s11, 0x20000
s_mov_b32 s30, 8192
s_mov_b32 s31, 32768
s_mul_i32 s16, s24, 262144
s_add_u32 s16, s16, 0x0
s_mov_b32 s18, 7
s_lshl_b32 s32, s24, 2
s_mul_i32 s33, s38, 2
s_add_u32 s32, s32, s33
s_lshl_b32 s32, s32, 18
s_lshl_b32 s33, s25, 13
s_add_u32 s32, s32, s33
s_mul_i32 s33, s37, 8192
s_add_u32 s32, s32, s33
s_add_u32 s21, s32, 0x2800000
s_branch main_kernel_w_c1_gov
main_kernel_w_c1_set3:
s_mov_b32 s57, 9
s_lshl_b32 s32, s25, 8
s_add_u32 s8, s64, s32
s_addc_u32 s9, s65, 0
s_and_b32 s9, s9, 0xffff
s_sub_u32 s10, 0x200000, s32
s_mov_b32 s11, 0x20000
s_mov_b32 s30, 2048
s_mov_b32 s31, 32768
s_mul_i32 s16, s24, 262144
s_add_u32 s16, s16, 0x400000
s_mov_b32 s18, 7
s_lshl_b32 s32, s24, 3
s_mul_i32 s33, s38, 4
s_add_u32 s32, s32, s33
s_mul_i32 s32, s32, 32768
s_lshl_b32 s33, s25, 12
s_add_u32 s32, s32, s33
s_mul_i32 s33, s37, 4096
s_add_u32 s32, s32, s33
s_add_u32 s21, s32, 0x4800000
s_mov_b32 s22, 32768
s_mov_b32 s26, 0x7f000000
s_lshr_b32 s32, s25, 2
s_add_u32 s32, s32, 1
s_sub_u32 s33, 0, s32
s_bitcmp1_b32 s25, 1
s_cselect_b32 s32, s33, s32
s_add_u32 s32, s32, 16
v_and_b32 v253, 15, v250
v_add_u32 v253, s32, v253
v_lshrrev_b32 v254, 4, v253
v_lshlrev_b32 v254, 15, v254
v_and_b32 v253, 15, v253
v_lshl_add_u32 v254, v253, 4, v254
v_and_b32 v253, 0x300, v251
v_add_u32 v252, v253, v254
s_branch main_kernel_w_c1_go
main_kernel_w_c1_set6:
s_mov_b32 s57, 10
s_lshl_b32 s32, s25, 8
s_add_u32 s8, s68, s32
s_addc_u32 s9, s69, 0
s_and_b32 s9, s9, 0xffff
s_sub_u32 s10, 0x700000, s32
s_mov_b32 s11, 0x20000
s_mov_b32 s30, 7168
s_mov_b32 s31, 32768
s_mul_i32 s16, s24, 262144
s_add_u32 s16, s16, 0x6800000
s_mov_b32 s18, 7
s_lshl_b32 s32, s24, 3
s_mul_i32 s33, s38, 4
s_add_u32 s32, s32, s33
s_mul_i32 s32, s32, 114688
s_lshl_b32 s33, s25, 12
s_add_u32 s32, s32, s33
s_mul_i32 s33, s37, 4096
s_add_u32 s32, s32, s33
s_add_u32 s21, s32, 0x5400000
s_mov_b32 s22, 114688
s_mov_b32 s26, 0x7f000000
s_branch main_kernel_w_c1_go
main_kernel_w_c1_str:
s_mul_i32 s32, s14, 2
s_mul_i32 s32, s32, s31
v_mad_u32_u24 v137, v147, s30, v151
v_mad_u32_u24 v138, v148, s30, v152
v_mad_u32_u24 v139, v149, s30, v153
v_mad_u32_u24 v140, v150, s30, v154
v_add_u32 v141, s32, v251
s_add_u32 s32, s32, s31
s_sub_u32 s32, s32, 1024
v_add_u32 v142, s32, v251
s_mul_i32 s17, s30, 32
s_mov_b32 s15, 0
s_mov_b32 s18, 1
s_cmp_eq_u32 s73, 2
s_cbranch_scc1 main_kernel_w_c1_n_mid
s_branch main_kernel_w_c1_v_mid
main_kernel_w_c1_go:
s_mov_b32 s58, 2
s_mov_b32 s72, s18
s_cmp_lg_u32 s73, -1
s_cbranch_scc1 main_kernel_w_c1_str
s_waitcnt lgkmcnt(0)
v_lshrrev_b32 v0, 4, v250
v_bfe_u32 v1, v250, 2, 2
v_lshl_add_u32 v4, v0, 2, v1
v_and_b32 v5, 7, v4
v_mul_u32_u24 v4, 512, v4
v_and_b32 v6, 3, v250
v_lshl_add_u32 v4, v6, 3, v4
s_mul_i32 s32, s37, 8
v_xor_b32 v5, s32, v5
v_lshl_add_u32 v128, v5, 5, v4
v_xor_b32 v129, 32, v128
v_xor_b32 v130, 64, v128
v_xor_b32 v131, 96, v128
v_xor_b32 v132, 128, v128
v_xor_b32 v133, 160, v128
v_xor_b32 v134, 192, v128
v_xor_b32 v135, 224, v128
s_mul_i32 s32, s38, 4096
s_add_u32 s32, s32, 65536
v_add_u32 v136, s32, v251
v_lshrrev_b32 v2, 5, v250
v_and_b32 v3, 31, v250
s_mul_i32 s32, s14, 8
v_add_u32 v147, s32, v2
v_and_b32 v6, 7, v147
v_lshlrev_b32 v6, 1, v6
v_xor_b32 v6, v6, v3
v_lshlrev_b32 v151, 4, v6
v_add_u32 v148, 2, v147
v_and_b32 v6, 7, v148
v_lshlrev_b32 v6, 1, v6
v_xor_b32 v6, v6, v3
v_lshlrev_b32 v152, 4, v6
v_subrev_u32 v152, 1024, v152
v_add_u32 v149, 4, v147
v_and_b32 v6, 7, v149
v_lshlrev_b32 v6, 1, v6
v_xor_b32 v6, v6, v3
v_lshlrev_b32 v153, 4, v6
v_subrev_u32 v153, 2048, v153
v_add_u32 v150, 6, v147
v_and_b32 v6, 7, v150
v_lshlrev_b32 v6, 1, v6
v_xor_b32 v6, v6, v3
v_lshlrev_b32 v154, 4, v6
v_subrev_u32 v154, 3072, v154
s_mul_i32 s19, s14, 4096
s_mul_i32 s20, s14, 2048
s_add_u32 s20, s20, 65536
s_mul_i32 s32, s14, 2
s_mul_i32 s32, s32, s31
v_mad_u32_u24 v137, v147, s30, v151
v_mad_u32_u24 v138, v148, s30, v152
v_mad_u32_u24 v139, v149, s30, v153
v_mad_u32_u24 v140, v150, s30, v154
v_add_u32 v141, s32, v251
s_add_u32 s32, s32, s31
s_sub_u32 s32, s32, 1024
v_add_u32 v142, s32, v251
s_mul_i32 s17, s30, 32
s_mov_b32 s15, 0
s_waitcnt vmcnt(0)
s_add_u32 m0, s20, 0
s_nop 0
buffer_load_dwordx4 v141, s[4:7], s16 offen offset:0 sc1 lds
buffer_load_dwordx4 v142, s[4:7], s16 offen offset:1024 sc1 lds
s_add_u32 s16, s16, 1024
s_add_u32 m0, s19, 0
s_nop 0
buffer_load_dwordx4 v137, s[8:11], s15 offen offset:0 lds
buffer_load_dwordx4 v138, s[8:11], s15 offen offset:1024 lds
buffer_load_dwordx4 v139, s[8:11], s15 offen offset:2048 lds
buffer_load_dwordx4 v140, s[8:11], s15 offen offset:3072 lds
s_add_u32 s15, s15, s17
s_add_u32 m0, s20, 8192
s_nop 0
buffer_load_dwordx4 v141, s[4:7], s16 offen offset:0 sc1 lds
buffer_load_dwordx4 v142, s[4:7], s16 offen offset:1024 sc1 lds
s_add_u32 s16, s16, 1024
s_add_u32 m0, s19, 16384
s_nop 0
buffer_load_dwordx4 v137, s[8:11], s15 offen offset:0 lds
buffer_load_dwordx4 v138, s[8:11], s15 offen offset:1024 lds
buffer_load_dwordx4 v139, s[8:11], s15 offen offset:2048 lds
buffer_load_dwordx4 v140, s[8:11], s15 offen offset:3072 lds
s_add_u32 s15, s15, s17
s_add_u32 m0, s20, 16384
s_nop 0
buffer_load_dwordx4 v141, s[4:7], s16 offen offset:0 sc1 lds
buffer_load_dwordx4 v142, s[4:7], s16 offen offset:1024 sc1 lds
s_add_u32 s16, s16, 1024
s_add_u32 m0, s19, 32768
s_nop 0
buffer_load_dwordx4 v137, s[8:11], s15 offen offset:0 lds
buffer_load_dwordx4 v138, s[8:11], s15 offen offset:1024 lds
buffer_load_dwordx4 v139, s[8:11], s15 offen offset:2048 lds
buffer_load_dwordx4 v140, s[8:11], s15 offen offset:3072 lds
s_add_u32 s15, s15, s17
s_add_u32 m0, s20, 24576
s_nop 0
buffer_load_dwordx4 v141, s[4:7], s16 offen offset:0 sc1 lds
buffer_load_dwordx4 v142, s[4:7], s16 offen offset:1024 sc1 lds
s_add_u32 s16, s16, 1024
s_add_u32 m0, s19, 49152
s_nop 0
buffer_load_dwordx4 v137, s[8:11], s15 offen offset:0 lds
buffer_load_dwordx4 v138, s[8:11], s15 offen offset:1024 lds
buffer_load_dwordx4 v139, s[8:11], s15 offen offset:2048 lds
buffer_load_dwordx4 v140, s[8:11], s15 offen offset:3072 lds
s_add_u32 s15, s15, s17
s_cmp_lg_u32 s56, 0
s_cbranch_scc1 main_kernel_w_epi
main_kernel_w_c1_n_ent:
v_mfma_f32_32x32x16_bf16 a[0:15], v[224:227], v[224:227], 0
s_waitcnt vmcnt(18)
s_barrier
ds_read_b128 v[32:35], v136 offset:0
ds_read_b64_tr_b16 v[0:1], v128 offset:0
ds_read_b64_tr_b16 v[2:3], v128 offset:8192
v_mfma_f32_32x32x16_bf16 a[16:31], v[224:227], v[224:227], 0
ds_read_b64_tr_b16 v[4:5], v129 offset:0
ds_read_b64_tr_b16 v[6:7], v129 offset:8192
ds_read_b64_tr_b16 v[8:9], v130 offset:0
v_mfma_f32_32x32x16_bf16 a[32:47], v[224:227], v[224:227], 0
ds_read_b64_tr_b16 v[10:11], v130 offset:8192
ds_read_b64_tr_b16 v[12:13], v131 offset:0
ds_read_b64_tr_b16 v[14:15], v131 offset:8192
v_mfma_f32_32x32x16_bf16 a[48:63], v[224:227], v[224:227], 0
ds_read_b64_tr_b16 v[16:17], v132 offset:0
ds_read_b64_tr_b16 v[18:19], v132 offset:8192
ds_read_b64_tr_b16 v[20:21], v133 offset:0
v_mfma_f32_32x32x16_bf16 a[64:79], v[224:227], v[224:227], 0
ds_read_b64_tr_b16 v[22:23], v133 offset:8192
ds_read_b64_tr_b16 v[24:25], v134 offset:0
ds_read_b64_tr_b16 v[26:27], v134 offset:8192
v_mfma_f32_32x32x16_bf16 a[80:95], v[224:227], v[224:227], 0
ds_read_b64_tr_b16 v[28:29], v135 offset:0
ds_read_b64_tr_b16 v[30:31], v135 offset:8192
ds_read_b128 v[36:39], v136 offset:1024
v_mfma_f32_32x32x16_bf16 a[96:111], v[224:227], v[224:227], 0
ds_read_b128 v[40:43], v136 offset:2048
ds_read_b128 v[44:47], v136 offset:3072
v_mfma_f32_32x32x16_bf16 a[112:127], v[224:227], v[224:227], 0
s_sub_u32 s18, s72, 1
s_sub_u32 s55, s72, 2
s_orn2_b32 s55, s55, s100
s_mov_b32 s73, -1
s_nop 0
main_kernel_w_c1_n_loop:
main_kernel_w_c1_n_mid:
s_waitcnt lgkmcnt(0)
v_mfma_f32_16x16x32_bf16 a[0:3], v[0:3], v[32:35], a[0:3]
s_waitcnt vmcnt(12)
s_barrier
ds_read_b128 v[80:83], v136 offset:8192
s_add_u32 m0, s20, 0
s_nop 0
v_mfma_f32_16x16x32_bf16 a[4:7], v[4:7], v[32:35], a[4:7]
ds_read_b64_tr_b16 v[48:49], v128 offset:16384
v_mfma_f32_16x16x32_bf16 a[8:11], v[8:11], v[32:35], a[8:11]
ds_read_b64_tr_b16 v[50:51], v128 offset:24576
v_mfma_f32_16x16x32_bf16 a[12:15], v[12:15], v[32:35], a[12:15]
ds_read_b64_tr_b16 v[52:53], v129 offset:16384
buffer_load_dwordx4 v141, s[4:7], s16 offen offset:0 sc1 lds
v_mfma_f32_16x16x32_bf16 a[16:19], v[16:19], v[32:35], a[16:19]
ds_read_b64_tr_b16 v[54:55], v129 offset:24576
v_mfma_f32_16x16x32_bf16 a[20:23], v[20:23], v[32:35], a[20:23]
ds_read_b64_tr_b16 v[56:57], v130 offset:16384
v_mfma_f32_16x16x32_bf16 a[24:27], v[24:27], v[32:35], a[24:27]
ds_read_b64_tr_b16 v[58:59], v130 offset:24576
buffer_load_dwordx4 v142, s[4:7], s16 offen offset:1024 sc1 lds
v_mfma_f32_16x16x32_bf16 a[28:31], v[28:31], v[32:35], a[28:31]
ds_read_b64_tr_b16 v[60:61], v131 offset:16384
v_mfma_f32_16x16x32_bf16 a[32:35], v[0:3], v[36:39], a[32:35]
ds_read_b64_tr_b16 v[62:63], v131 offset:24576
v_mfma_f32_16x16x32_bf16 a[36:39], v[4:7], v[36:39], a[36:39]
ds_read_b64_tr_b16 v[64:65], v132 offset:16384
s_add_u32 s16, s16, 1024
v_mfma_f32_16x16x32_bf16 a[40:43], v[8:11], v[36:39], a[40:43]
ds_read_b64_tr_b16 v[66:67], v132 offset:24576
v_mfma_f32_16x16x32_bf16 a[44:47], v[12:15], v[36:39], a[44:47]
ds_read_b64_tr_b16 v[68:69], v133 offset:16384
v_mfma_f32_16x16x32_bf16 a[48:51], v[16:19], v[36:39], a[48:51]
ds_read_b64_tr_b16 v[70:71], v133 offset:24576
s_add_u32 m0, s19, 0
s_nop 0
v_mfma_f32_16x16x32_bf16 a[52:55], v[20:23], v[36:39], a[52:55]
ds_read_b64_tr_b16 v[72:73], v134 offset:16384
v_mfma_f32_16x16x32_bf16 a[56:59], v[24:27], v[36:39], a[56:59]
ds_read_b64_tr_b16 v[74:75], v134 offset:24576
v_mfma_f32_16x16x32_bf16 a[60:63], v[28:31], v[36:39], a[60:63]
ds_read_b64_tr_b16 v[76:77], v135 offset:16384
buffer_load_dwordx4 v137, s[8:11], s15 offen offset:0 lds
v_mfma_f32_16x16x32_bf16 a[64:67], v[0:3], v[40:43], a[64:67]
ds_read_b64_tr_b16 v[78:79], v135 offset:24576
v_mfma_f32_16x16x32_bf16 a[68:71], v[4:7], v[40:43], a[68:71]
ds_read_b128 v[84:87], v136 offset:9216
v_mfma_f32_16x16x32_bf16 a[72:75], v[8:11], v[40:43], a[72:75]
ds_read_b128 v[88:91], v136 offset:10240
buffer_load_dwordx4 v138, s[8:11], s15 offen offset:1024 lds
v_mfma_f32_16x16x32_bf16 a[76:79], v[12:15], v[40:43], a[76:79]
ds_read_b128 v[92:95], v136 offset:11264
v_mfma_f32_16x16x32_bf16 a[80:83], v[16:19], v[40:43], a[80:83]
v_mfma_f32_16x16x32_bf16 a[84:87], v[20:23], v[40:43], a[84:87]
buffer_load_dwordx4 v139, s[8:11], s15 offen offset:2048 lds
v_mfma_f32_16x16x32_bf16 a[88:91], v[24:27], v[40:43], a[88:91]
v_mfma_f32_16x16x32_bf16 a[92:95], v[28:31], v[40:43], a[92:95]
v_mfma_f32_16x16x32_bf16 a[96:99], v[0:3], v[44:47], a[96:99]
buffer_load_dwordx4 v140, s[8:11], s15 offen offset:3072 lds
v_mfma_f32_16x16x32_bf16 a[100:103], v[4:7], v[44:47], a[100:103]
v_mfma_f32_16x16x32_bf16 a[104:107], v[8:11], v[44:47], a[104:107]
v_mfma_f32_16x16x32_bf16 a[108:111], v[12:15], v[44:47], a[108:111]
s_add_u32 s15, s15, s17
v_mfma_f32_16x16x32_bf16 a[112:115], v[16:19], v[44:47], a[112:115]
v_mfma_f32_16x16x32_bf16 a[116:119], v[20:23], v[44:47], a[116:119]
v_mfma_f32_16x16x32_bf16 a[120:123], v[24:27], v[44:47], a[120:123]
v_mfma_f32_16x16x32_bf16 a[124:127], v[28:31], v[44:47], a[124:127]
s_waitcnt lgkmcnt(0)
v_mfma_f32_16x16x32_bf16 a[0:3], v[48:51], v[80:83], a[0:3]
s_waitcnt vmcnt(12)
s_barrier
ds_read_b128 v[32:35], v136 offset:16384
s_add_u32 m0, s20, 8192
s_nop 0
v_mfma_f32_16x16x32_bf16 a[4:7], v[52:55], v[80:83], a[4:7]
ds_read_b64_tr_b16 v[0:1], v128 offset:32768
v_mfma_f32_16x16x32_bf16 a[8:11], v[56:59], v[80:83], a[8:11]
ds_read_b64_tr_b16 v[2:3], v128 offset:40960
v_mfma_f32_16x16x32_bf16 a[12:15], v[60:63], v[80:83], a[12:15]
ds_read_b64_tr_b16 v[4:5], v129 offset:32768
buffer_load_dwordx4 v141, s[4:7], s16 offen offset:0 sc1 lds
v_mfma_f32_16x16x32_bf16 a[16:19], v[64:67], v[80:83], a[16:19]
ds_read_b64_tr_b16 v[6:7], v129 offset:40960
v_mfma_f32_16x16x32_bf16 a[20:23], v[68:71], v[80:83], a[20:23]
ds_read_b64_tr_b16 v[8:9], v130 offset:32768
v_mfma_f32_16x16x32_bf16 a[24:27], v[72:75], v[80:83], a[24:27]
ds_read_b64_tr_b16 v[10:11], v130 offset:40960
buffer_load_dwordx4 v142, s[4:7], s16 offen offset:1024 sc1 lds
v_mfma_f32_16x16x32_bf16 a[28:31], v[76:79], v[80:83], a[28:31]
ds_read_b64_tr_b16 v[12:13], v131 offset:32768
v_mfma_f32_16x16x32_bf16 a[32:35], v[48:51], v[84:87], a[32:35]
ds_read_b64_tr_b16 v[14:15], v131 offset:40960
v_mfma_f32_16x16x32_bf16 a[36:39], v[52:55], v[84:87], a[36:39]
ds_read_b64_tr_b16 v[16:17], v132 offset:32768
s_add_u32 s16, s16, 1024
v_mfma_f32_16x16x32_bf16 a[40:43], v[56:59], v[84:87], a[40:43]
ds_read_b64_tr_b16 v[18:19], v132 offset:40960
v_mfma_f32_16x16x32_bf16 a[44:47], v[60:63], v[84:87], a[44:47]
ds_read_b64_tr_b16 v[20:21], v133 offset:32768
v_mfma_f32_16x16x32_bf16 a[48:51], v[64:67], v[84:87], a[48:51]
ds_read_b64_tr_b16 v[22:23], v133 offset:40960
s_add_u32 m0, s19, 16384
s_nop 0
v_mfma_f32_16x16x32_bf16 a[52:55], v[68:71], v[84:87], a[52:55]
ds_read_b64_tr_b16 v[24:25], v134 offset:32768
v_mfma_f32_16x16x32_bf16 a[56:59], v[72:75], v[84:87], a[56:59]
ds_read_b64_tr_b16 v[26:27], v134 offset:40960
v_mfma_f32_16x16x32_bf16 a[60:63], v[76:79], v[84:87], a[60:63]
ds_read_b64_tr_b16 v[28:29], v135 offset:32768
buffer_load_dwordx4 v137, s[8:11], s15 offen offset:0 lds
v_mfma_f32_16x16x32_bf16 a[64:67], v[48:51], v[88:91], a[64:67]
ds_read_b64_tr_b16 v[30:31], v135 offset:40960
v_mfma_f32_16x16x32_bf16 a[68:71], v[52:55], v[88:91], a[68:71]
ds_read_b128 v[36:39], v136 offset:17408
v_mfma_f32_16x16x32_bf16 a[72:75], v[56:59], v[88:91], a[72:75]
ds_read_b128 v[40:43], v136 offset:18432
buffer_load_dwordx4 v138, s[8:11], s15 offen offset:1024 lds
v_mfma_f32_16x16x32_bf16 a[76:79], v[60:63], v[88:91], a[76:79]
ds_read_b128 v[44:47], v136 offset:19456
v_mfma_f32_16x16x32_bf16 a[80:83], v[64:67], v[88:91], a[80:83]
v_mfma_f32_16x16x32_bf16 a[84:87], v[68:71], v[88:91], a[84:87]
buffer_load_dwordx4 v139, s[8:11], s15 offen offset:2048 lds
v_mfma_f32_16x16x32_bf16 a[88:91], v[72:75], v[88:91], a[88:91]
v_mfma_f32_16x16x32_bf16 a[92:95], v[76:79], v[88:91], a[92:95]
v_mfma_f32_16x16x32_bf16 a[96:99], v[48:51], v[92:95], a[96:99]
buffer_load_dwordx4 v140, s[8:11], s15 offen offset:3072 lds
v_mfma_f32_16x16x32_bf16 a[100:103], v[52:55], v[92:95], a[100:103]
v_mfma_f32_16x16x32_bf16 a[104:107], v[56:59], v[92:95], a[104:107]
v_mfma_f32_16x16x32_bf16 a[108:111], v[60:63], v[92:95], a[108:111]
s_add_u32 s15, s15, s17
v_mfma_f32_16x16x32_bf16 a[112:115], v[64:67], v[92:95], a[112:115]
v_mfma_f32_16x16x32_bf16 a[116:119], v[68:71], v[92:95], a[116:119]
v_mfma_f32_16x16x32_bf16 a[120:123], v[72:75], v[92:95], a[120:123]
v_mfma_f32_16x16x32_bf16 a[124:127], v[76:79], v[92:95], a[124:127]
s_waitcnt lgkmcnt(0)
v_mfma_f32_16x16x32_bf16 a[0:3], v[0:3], v[32:35], a[0:3]
s_waitcnt vmcnt(12)
s_barrier
ds_read_b128 v[80:83], v136 offset:24576
s_add_u32 m0, s20, 16384
s_nop 0
v_mfma_f32_16x16x32_bf16 a[4:7], v[4:7], v[32:35], a[4:7]
ds_read_b64_tr_b16 v[48:49], v128 offset:49152
v_mfma_f32_16x16x32_bf16 a[8:11], v[8:11], v[32:35], a[8:11]
ds_read_b64_tr_b16 v[50:51], v128 offset:57344
v_mfma_f32_16x16x32_bf16 a[12:15], v[12:15], v[32:35], a[12:15]
ds_read_b64_tr_b16 v[52:53], v129 offset:49152
buffer_load_dwordx4 v141, s[4:7], s16 offen offset:0 sc1 lds
v_mfma_f32_16x16x32_bf16 a[16:19], v[16:19], v[32:35], a[16:19]
ds_read_b64_tr_b16 v[54:55], v129 offset:57344
v_mfma_f32_16x16x32_bf16 a[20:23], v[20:23], v[32:35], a[20:23]
ds_read_b64_tr_b16 v[56:57], v130 offset:49152
v_mfma_f32_16x16x32_bf16 a[24:27], v[24:27], v[32:35], a[24:27]
ds_read_b64_tr_b16 v[58:59], v130 offset:57344
buffer_load_dwordx4 v142, s[4:7], s16 offen offset:1024 sc1 lds
v_mfma_f32_16x16x32_bf16 a[28:31], v[28:31], v[32:35], a[28:31]
ds_read_b64_tr_b16 v[60:61], v131 offset:49152
v_mfma_f32_16x16x32_bf16 a[32:35], v[0:3], v[36:39], a[32:35]
ds_read_b64_tr_b16 v[62:63], v131 offset:57344
v_mfma_f32_16x16x32_bf16 a[36:39], v[4:7], v[36:39], a[36:39]
ds_read_b64_tr_b16 v[64:65], v132 offset:49152
s_add_u32 s16, s16, 1024
v_mfma_f32_16x16x32_bf16 a[40:43], v[8:11], v[36:39], a[40:43]
ds_read_b64_tr_b16 v[66:67], v132 offset:57344
v_mfma_f32_16x16x32_bf16 a[44:47], v[12:15], v[36:39], a[44:47]
ds_read_b64_tr_b16 v[68:69], v133 offset:49152
v_mfma_f32_16x16x32_bf16 a[48:51], v[16:19], v[36:39], a[48:51]
ds_read_b64_tr_b16 v[70:71], v133 offset:57344
s_add_u32 m0, s19, 32768
s_nop 0
v_mfma_f32_16x16x32_bf16 a[52:55], v[20:23], v[36:39], a[52:55]
ds_read_b64_tr_b16 v[72:73], v134 offset:49152
v_mfma_f32_16x16x32_bf16 a[56:59], v[24:27], v[36:39], a[56:59]
ds_read_b64_tr_b16 v[74:75], v134 offset:57344
v_mfma_f32_16x16x32_bf16 a[60:63], v[28:31], v[36:39], a[60:63]
ds_read_b64_tr_b16 v[76:77], v135 offset:49152
buffer_load_dwordx4 v137, s[8:11], s15 offen offset:0 lds
v_mfma_f32_16x16x32_bf16 a[64:67], v[0:3], v[40:43], a[64:67]
ds_read_b64_tr_b16 v[78:79], v135 offset:57344
v_mfma_f32_16x16x32_bf16 a[68:71], v[4:7], v[40:43], a[68:71]
ds_read_b128 v[84:87], v136 offset:25600
v_mfma_f32_16x16x32_bf16 a[72:75], v[8:11], v[40:43], a[72:75]
ds_read_b128 v[88:91], v136 offset:26624
buffer_load_dwordx4 v138, s[8:11], s15 offen offset:1024 lds
v_mfma_f32_16x16x32_bf16 a[76:79], v[12:15], v[40:43], a[76:79]
ds_read_b128 v[92:95], v136 offset:27648
v_mfma_f32_16x16x32_bf16 a[80:83], v[16:19], v[40:43], a[80:83]
v_mfma_f32_16x16x32_bf16 a[84:87], v[20:23], v[40:43], a[84:87]
buffer_load_dwordx4 v139, s[8:11], s15 offen offset:2048 lds
v_mfma_f32_16x16x32_bf16 a[88:91], v[24:27], v[40:43], a[88:91]
v_mfma_f32_16x16x32_bf16 a[92:95], v[28:31], v[40:43], a[92:95]
v_mfma_f32_16x16x32_bf16 a[96:99], v[0:3], v[44:47], a[96:99]
buffer_load_dwordx4 v140, s[8:11], s15 offen offset:3072 lds
v_mfma_f32_16x16x32_bf16 a[100:103], v[4:7], v[44:47], a[100:103]
v_mfma_f32_16x16x32_bf16 a[104:107], v[8:11], v[44:47], a[104:107]
v_mfma_f32_16x16x32_bf16 a[108:111], v[12:15], v[44:47], a[108:111]
s_add_u32 s15, s15, s17
v_mfma_f32_16x16x32_bf16 a[112:115], v[16:19], v[44:47], a[112:115]
v_mfma_f32_16x16x32_bf16 a[116:119], v[20:23], v[44:47], a[116:119]
v_mfma_f32_16x16x32_bf16 a[120:123], v[24:27], v[44:47], a[120:123]
v_mfma_f32_16x16x32_bf16 a[124:127], v[28:31], v[44:47], a[124:127]
s_waitcnt lgkmcnt(0)
v_mfma_f32_16x16x32_bf16 a[0:3], v[48:51], v[80:83], a[0:3]
s_waitcnt vmcnt(12)
s_barrier
ds_read_b128 v[32:35], v136 offset:0
s_add_u32 m0, s20, 24576
s_nop 0
v_mfma_f32_16x16x32_bf16 a[4:7], v[52:55], v[80:83], a[4:7]
ds_read_b64_tr_b16 v[0:1], v128 offset:0
v_mfma_f32_16x16x32_bf16 a[8:11], v[56:59], v[80:83], a[8:11]
ds_read_b64_tr_b16 v[2:3], v128 offset:8192
v_mfma_f32_16x16x32_bf16 a[12:15], v[60:63], v[80:83], a[12:15]
ds_read_b64_tr_b16 v[4:5], v129 offset:0
buffer_load_dwordx4 v141, s[4:7], s16 offen offset:0 sc1 lds
v_mfma_f32_16x16x32_bf16 a[16:19], v[64:67], v[80:83], a[16:19]
ds_read_b64_tr_b16 v[6:7], v129 offset:8192
v_mfma_f32_16x16x32_bf16 a[20:23], v[68:71], v[80:83], a[20:23]
ds_read_b64_tr_b16 v[8:9], v130 offset:0
v_mfma_f32_16x16x32_bf16 a[24:27], v[72:75], v[80:83], a[24:27]
ds_read_b64_tr_b16 v[10:11], v130 offset:8192
buffer_load_dwordx4 v142, s[4:7], s16 offen offset:1024 sc1 lds
v_mfma_f32_16x16x32_bf16 a[28:31], v[76:79], v[80:83], a[28:31]
ds_read_b64_tr_b16 v[12:13], v131 offset:0
v_mfma_f32_16x16x32_bf16 a[32:35], v[48:51], v[84:87], a[32:35]
ds_read_b64_tr_b16 v[14:15], v131 offset:8192
v_mfma_f32_16x16x32_bf16 a[36:39], v[52:55], v[84:87], a[36:39]
ds_read_b64_tr_b16 v[16:17], v132 offset:0
s_add_u32 s16, s16, 1024
v_mfma_f32_16x16x32_bf16 a[40:43], v[56:59], v[84:87], a[40:43]
ds_read_b64_tr_b16 v[18:19], v132 offset:8192
v_mfma_f32_16x16x32_bf16 a[44:47], v[60:63], v[84:87], a[44:47]
ds_read_b64_tr_b16 v[20:21], v133 offset:0
v_mfma_f32_16x16x32_bf16 a[48:51], v[64:67], v[84:87], a[48:51]
ds_read_b64_tr_b16 v[22:23], v133 offset:8192
s_add_u32 m0, s19, 49152
s_nop 0
v_mfma_f32_16x16x32_bf16 a[52:55], v[68:71], v[84:87], a[52:55]
ds_read_b64_tr_b16 v[24:25], v134 offset:0
v_mfma_f32_16x16x32_bf16 a[56:59], v[72:75], v[84:87], a[56:59]
ds_read_b64_tr_b16 v[26:27], v134 offset:8192
v_mfma_f32_16x16x32_bf16 a[60:63], v[76:79], v[84:87], a[60:63]
ds_read_b64_tr_b16 v[28:29], v135 offset:0
buffer_load_dwordx4 v137, s[8:11], s15 offen offset:0 lds
v_mfma_f32_16x16x32_bf16 a[64:67], v[48:51], v[88:91], a[64:67]
ds_read_b64_tr_b16 v[30:31], v135 offset:8192
v_mfma_f32_16x16x32_bf16 a[68:71], v[52:55], v[88:91], a[68:71]
ds_read_b128 v[36:39], v136 offset:1024
v_mfma_f32_16x16x32_bf16 a[72:75], v[56:59], v[88:91], a[72:75]
ds_read_b128 v[40:43], v136 offset:2048
buffer_load_dwordx4 v138, s[8:11], s15 offen offset:1024 lds
v_mfma_f32_16x16x32_bf16 a[76:79], v[60:63], v[88:91], a[76:79]
ds_read_b128 v[44:47], v136 offset:3072
v_mfma_f32_16x16x32_bf16 a[80:83], v[64:67], v[88:91], a[80:83]
v_mfma_f32_16x16x32_bf16 a[84:87], v[68:71], v[88:91], a[84:87]
buffer_load_dwordx4 v139, s[8:11], s15 offen offset:2048 lds
v_mfma_f32_16x16x32_bf16 a[88:91], v[72:75], v[88:91], a[88:91]
v_mfma_f32_16x16x32_bf16 a[92:95], v[76:79], v[88:91], a[92:95]
v_mfma_f32_16x16x32_bf16 a[96:99], v[48:51], v[92:95], a[96:99]
buffer_load_dwordx4 v140, s[8:11], s15 offen offset:3072 lds
v_mfma_f32_16x16x32_bf16 a[100:103], v[52:55], v[92:95], a[100:103]
v_mfma_f32_16x16x32_bf16 a[104:107], v[56:59], v[92:95], a[104:107]
v_mfma_f32_16x16x32_bf16 a[108:111], v[60:63], v[92:95], a[108:111]
s_add_u32 s15, s15, s17
v_mfma_f32_16x16x32_bf16 a[112:115], v[64:67], v[92:95], a[112:115]
v_mfma_f32_16x16x32_bf16 a[116:119], v[68:71], v[92:95], a[116:119]
v_mfma_f32_16x16x32_bf16 a[120:123], v[72:75], v[92:95], a[120:123]
v_mfma_f32_16x16x32_bf16 a[124:127], v[76:79], v[92:95], a[124:127]
s_sub_u32 s18, s18, 1
s_cmp_eq_u32 s18, s55
s_cbranch_scc1 main_kernel_w_c1_n_ev
s_cmp_lg_u32 s18, 0
s_cbranch_scc1 main_kernel_w_c1_n_loop
s_cmp_lg_u32 s73, -1
s_cbranch_scc1 main_kernel_w_epn
s_waitcnt lgkmcnt(0)
v_mfma_f32_16x16x32_bf16 a[0:3], v[0:3], v[32:35], a[0:3]
s_waitcnt vmcnt(12)
s_barrier
ds_read_b128 v[80:83], v136 offset:8192
s_add_u32 m0, s20, 0
s_nop 0
s_add_u32 s32, s23, 1
s_bitcmp0_b32 s32, 2
s_cselect_b32 s34, 7, 2
s_cselect_b32 s35, 2, 4
s_lshl_b32 s59, s23, 13
s_add_u32 s59, s59, 0x8404000
v_mfma_f32_16x16x32_bf16 a[4:7], v[4:7], v[32:35], a[4:7]
ds_read_b64_tr_b16 v[48:49], v128 offset:16384
v_lshrrev_b32 v253, 3, v250
v_add_lshl_u32 v253, s24, v253, 9
v_mfma_f32_16x16x32_bf16 a[8:11], v[8:11], v[32:35], a[8:11]
ds_read_b64_tr_b16 v[50:51], v128 offset:24576
v_and_b32 v254, 3, v250
v_lshl_add_u32 v253, v254, s34, v253
v_mfma_f32_16x16x32_bf16 a[12:15], v[12:15], v[32:35], a[12:15]
ds_read_b64_tr_b16 v[52:53], v129 offset:16384
buffer_load_dwordx4 v141, s[4:7], s16 offen offset:0 sc1 lds
v_bfe_u32 v254, v250, 2, 1
v_add_u32 v254, s25, v254
v_mfma_f32_16x16x32_bf16 a[16:19], v[16:19], v[32:35], a[16:19]
ds_read_b64_tr_b16 v[54:55], v129 offset:24576
v_lshl_add_u32 v248, v254, s35, v253
s_lshl_b32 s0, 4, s54
v_mfma_f32_16x16x32_bf16 a[20:23], v[20:23], v[32:35], a[20:23]
ds_read_b64_tr_b16 v[56:57], v130 offset:16384
v_readfirstlane_b32 s28, v249
s_nop 1
v_cmp_ge_u32 vcc, s28, v229
v_mfma_f32_16x16x32_bf16 a[24:27], v[24:27], v[32:35], a[24:27]
ds_read_b64_tr_b16 v[58:59], v130 offset:24576
buffer_load_dwordx4 v142, s[4:7], s16 offen offset:1024 sc1 lds
s_nop 1
s_bcnt1_i32_b64 s32, vcc
v_mfma_f32_16x16x32_bf16 a[28:31], v[28:31], v[32:35], a[28:31]
ds_read_b64_tr_b16 v[60:61], v131 offset:16384
s_sub_u32 s32, s32, 1
v_readlane_b32 s36, v230, s32
v_mfma_f32_16x16x32_bf16 a[32:35], v[0:3], v[36:39], a[32:35]
ds_read_b64_tr_b16 v[62:63], v131 offset:24576
s_nop 1
s_and_b32 s32, s36, 0x7ff
v_mfma_f32_16x16x32_bf16 a[36:39], v[4:7], v[36:39], a[36:39]
ds_read_b64_tr_b16 v[64:65], v132 offset:16384
s_add_u32 s16, s16, 1024
s_sub_u32 s28, s28, s32
s_bfe_u32 s32, s36, 0x3001a
v_mfma_f32_16x16x32_bf16 a[40:43], v[8:11], v[36:39], a[40:43]
ds_read_b64_tr_b16 v[66:67], v132 offset:24576
s_lshr_b32 s25, s28, s32
s_lshl_b32 s33, s25, s32
s_sub_u32 s24, s28, s33
v_mfma_f32_16x16x32_bf16 a[44:47], v[12:15], v[36:39], a[44:47]
ds_read_b64_tr_b16 v[68:69], v133 offset:16384
s_bfe_u32 s34, s36, 0x1001d
s_lshl_b32 s24, s24, s34
v_mfma_f32_16x16x32_bf16 a[48:51], v[16:19], v[36:39], a[48:51]
ds_read_b64_tr_b16 v[70:71], v133 offset:24576
s_add_u32 m0, s19, 0
s_nop 0
s_bfe_u32 s35, s36, 0x1001e
s_lshl_b32 s25, s25, s35
v_mfma_f32_16x16x32_bf16 a[52:55], v[20:23], v[36:39], a[52:55]
ds_read_b64_tr_b16 v[72:73], v134 offset:16384
s_bfe_u32 s32, s36, 0x40011
s_add_u32 s24, s24, s32
v_mfma_f32_16x16x32_bf16 a[56:59], v[24:27], v[36:39], a[56:59]
ds_read_b64_tr_b16 v[74:75], v134 offset:24576
s_bfe_u32 s32, s36, 0x50015
s_add_u32 s25, s25, s32
v_mfma_f32_16x16x32_bf16 a[60:63], v[28:31], v[36:39], a[60:63]
ds_read_b64_tr_b16 v[76:77], v135 offset:16384
buffer_load_dwordx4 v137, s[8:11], s15 offen offset:0 lds
s_bfe_u32 s23, s36, 0x4000b
s_bfe_u32 s36, s36, 0x6000b
s_lshl_b32 s32, s24, 8
v_mfma_f32_16x16x32_bf16 a[64:67], v[0:3], v[40:43], a[64:67]
ds_read_b64_tr_b16 v[78:79], v135 offset:24576
s_or_b32 s36, s36, s32
s_lshl_b32 s32, s25, 16
v_mfma_f32_16x16x32_bf16 a[68:71], v[4:7], v[40:43], a[68:71]
ds_read_b128 v[84:87], v136 offset:9216
s_or_b32 s36, s36, s32
s_cmp_eq_u32 s23, 4
s_cselect_b32 s32, 1, 0
v_mfma_f32_16x16x32_bf16 a[72:75], v[8:11], v[40:43], a[72:75]
ds_read_b128 v[88:91], v136 offset:10240
buffer_load_dwordx4 v138, s[8:11], s15 offen offset:1024 lds
s_sub_u32 s48, s24, s32
s_max_i32 s48, s48, 0
v_mfma_f32_16x16x32_bf16 a[76:79], v[12:15], v[40:43], a[76:79]
ds_read_b128 v[92:95], v136 offset:11264
s_add_u32 s49, s24, s34
s_add_u32 s49, s49, s32
v_mfma_f32_16x16x32_bf16 a[80:83], v[16:19], v[40:43], a[80:83]
s_min_u32 s49, s49, 15
s_cmp_eq_u32 s23, 6
s_cselect_b32 s51, 3, 7
s_cmp_eq_u32 s23, 7
s_cselect_b32 s51, 27, s51
s_cselect_b32 s50, 5, 4
v_mfma_f32_16x16x32_bf16 a[84:87], v[20:23], v[40:43], a[84:87]
buffer_load_dwordx4 v139, s[8:11], s15 offen offset:2048 lds
s_add_u32 s33, s25, s35
s_lshl_b32 s34, s24, 9
v_mfma_f32_16x16x32_bf16 a[88:91], v[24:27], v[40:43], a[88:91]
s_cmp_eq_u32 s23, 8
s_cselect_b32 s51, 0, s51
s_cselect_b32 s48, s25, s48
s_cselect_b32 s49, s33, s49
s_cmp_eq_u32 s23, 8
s_cselect_b32 s63, 2, 9
s_cselect_b32 s61, 0, 0x7f000000
s_cselect_b32 s34, s34, 0
v_mfma_f32_16x16x32_bf16 a[92:95], v[28:31], v[40:43], a[92:95]
v_lshrrev_b32 v228, s50, v250
v_lshlrev_b32 v254, s50, v228
v_mfma_f32_16x16x32_bf16 a[96:99], v[0:3], v[44:47], a[96:99]
buffer_load_dwordx4 v140, s[8:11], s15 offen offset:3072 lds
v_sub_u32 v254, v250, v254
s_cmp_lt_u32 s23, 4
s_cselect_b32 s39, 10, s23
v_mfma_f32_16x16x32_bf16 a[100:103], v[4:7], v[44:47], a[100:103]
v_min_u32 v254, s51, v254
s_lshl_b32 s39, s39, 13
s_cmp_eq_u32 s23, 3
s_cselect_b32 s34, 4, s34
v_mfma_f32_16x16x32_bf16 a[104:107], v[8:11], v[44:47], a[104:107]
v_add_u32 v228, s48, v228
s_add_u32 s39, s39, s34
v_mfma_f32_16x16x32_bf16 a[108:111], v[12:15], v[44:47], a[108:111]
s_add_u32 s15, s15, s17
s_add_u32 s39, s39, 0x8402000
v_min_u32 v228, s49, v228
v_mfma_f32_16x16x32_bf16 a[112:115], v[16:19], v[44:47], a[112:115]
s_lshl_b32 s60, s24, 10
s_add_u32 s60, s60, 0x8400000
v_mfma_f32_16x16x32_bf16 a[116:119], v[20:23], v[44:47], a[116:119]
v_lshlrev_b32 v228, s63, v228
v_lshl_add_u32 v228, v254, 4, v228
v_mfma_f32_16x16x32_bf16 a[120:123], v[24:27], v[44:47], a[120:123]
v_or_b32 v146, s61, v251
s_mov_b64 exec, s[100:101]
buffer_load_dword v231, v228, s[4:7], s39 offen sc1
buffer_load_dwordx4 v[232:235], v146, s[4:7], s60 offen sc1
s_mov_b64 exec, -1
v_mfma_f32_16x16x32_bf16 a[124:127], v[28:31], v[44:47], a[124:127]
s_waitcnt lgkmcnt(0)
v_mfma_f32_16x16x32_bf16 a[0:3], v[48:51], v[80:83], a[0:3]
s_waitcnt vmcnt(12)
s_barrier
ds_read_b128 v[32:35], v136 offset:16384
s_add_u32 m0, s20, 8192
s_nop 0
s_mov_b32 s1, s21
v_mfma_f32_16x16x32_bf16 a[4:7], v[52:55], v[80:83], a[4:7]
ds_read_b64_tr_b16 v[0:1], v128 offset:32768
v_mfma_f32_16x16x32_bf16 a[8:11], v[56:59], v[80:83], a[8:11]
ds_read_b64_tr_b16 v[2:3], v128 offset:40960
v_mfma_f32_16x16x32_bf16 a[12:15], v[60:63], v[80:83], a[12:15]
ds_read_b64_tr_b16 v[4:5], v129 offset:32768
buffer_load_dwordx4 v141, s[4:7], s16 offen offset:0 sc1 lds
v_mfma_f32_16x16x32_bf16 a[16:19], v[64:67], v[80:83], a[16:19]
ds_read_b64_tr_b16 v[6:7], v129 offset:40960
v_mfma_f32_16x16x32_bf16 a[20:23], v[68:71], v[80:83], a[20:23]
ds_read_b64_tr_b16 v[8:9], v130 offset:32768
s_mov_b32 s2, s22
v_mfma_f32_16x16x32_bf16 a[24:27], v[72:75], v[80:83], a[24:27]
ds_read_b64_tr_b16 v[10:11], v130 offset:40960
buffer_load_dwordx4 v142, s[4:7], s16 offen offset:1024 sc1 lds
v_mfma_f32_16x16x32_bf16 a[28:31], v[76:79], v[80:83], a[28:31]
ds_read_b64_tr_b16 v[12:13], v131 offset:32768
v_mfma_f32_16x16x32_bf16 a[32:35], v[48:51], v[84:87], a[32:35]
ds_read_b64_tr_b16 v[14:15], v131 offset:40960
v_mfma_f32_16x16x32_bf16 a[36:39], v[52:55], v[84:87], a[36:39]
ds_read_b64_tr_b16 v[16:17], v132 offset:32768
s_add_u32 s16, s16, 1024
v_mfma_f32_16x16x32_bf16 a[40:43], v[56:59], v[84:87], a[40:43]
ds_read_b64_tr_b16 v[18:19], v132 offset:40960
s_mov_b32 s3, s26
v_mfma_f32_16x16x32_bf16 a[44:47], v[60:63], v[84:87], a[44:47]
ds_read_b64_tr_b16 v[20:21], v133 offset:32768
v_mfma_f32_16x16x32_bf16 a[48:51], v[64:67], v[84:87], a[48:51]
ds_read_b64_tr_b16 v[22:23], v133 offset:40960
s_add_u32 m0, s19, 16384
s_nop 0
v_mfma_f32_16x16x32_bf16 a[52:55], v[68:71], v[84:87], a[52:55]
ds_read_b64_tr_b16 v[24:25], v134 offset:32768
v_mfma_f32_16x16x32_bf16 a[56:59], v[72:75], v[84:87], a[56:59]
ds_read_b64_tr_b16 v[26:27], v134 offset:40960
v_mfma_f32_16x16x32_bf16 a[60:63], v[76:79], v[84:87], a[60:63]
ds_read_b64_tr_b16 v[28:29], v135 offset:32768
buffer_load_dwordx4 v137, s[8:11], s15 offen offset:0 lds
s_mov_b32 s56, s57
v_mfma_f32_16x16x32_bf16 a[64:67], v[48:51], v[88:91], a[64:67]
ds_read_b64_tr_b16 v[30:31], v135 offset:40960
v_mfma_f32_16x16x32_bf16 a[68:71], v[52:55], v[88:91], a[68:71]
ds_read_b128 v[36:39], v136 offset:17408
v_mfma_f32_16x16x32_bf16 a[72:75], v[56:59], v[88:91], a[72:75]
ds_read_b128 v[40:43], v136 offset:18432
buffer_load_dwordx4 v138, s[8:11], s15 offen offset:1024 lds
v_mfma_f32_16x16x32_bf16 a[76:79], v[60:63], v[88:91], a[76:79]
ds_read_b128 v[44:47], v136 offset:19456
v_mfma_f32_16x16x32_bf16 a[80:83], v[64:67], v[88:91], a[80:83]
v_mov_b32 v145, v252
v_mfma_f32_16x16x32_bf16 a[84:87], v[68:71], v[88:91], a[84:87]
buffer_load_dwordx4 v139, s[8:11], s15 offen offset:2048 lds
v_mfma_f32_16x16x32_bf16 a[88:91], v[72:75], v[88:91], a[88:91]
v_mfma_f32_16x16x32_bf16 a[92:95], v[76:79], v[88:91], a[92:95]
v_mfma_f32_16x16x32_bf16 a[96:99], v[48:51], v[92:95], a[96:99]
buffer_load_dwordx4 v140, s[8:11], s15 offen offset:3072 lds
v_mfma_f32_16x16x32_bf16 a[100:103], v[52:55], v[92:95], a[100:103]
v_mov_b32 v255, 131072
v_mfma_f32_16x16x32_bf16 a[104:107], v[56:59], v[92:95], a[104:107]
v_mfma_f32_16x16x32_bf16 a[108:111], v[60:63], v[92:95], a[108:111]
s_add_u32 s15, s15, s17
v_mfma_f32_16x16x32_bf16 a[112:115], v[64:67], v[92:95], a[112:115]
v_mfma_f32_16x16x32_bf16 a[116:119], v[68:71], v[92:95], a[116:119]
v_mfma_f32_16x16x32_bf16 a[120:123], v[72:75], v[92:95], a[120:123]
v_mfma_f32_16x16x32_bf16 a[124:127], v[76:79], v[92:95], a[124:127]
s_waitcnt lgkmcnt(0)
v_mfma_f32_16x16x32_bf16 a[0:3], v[0:3], v[32:35], a[0:3]
s_waitcnt vmcnt(12)
s_barrier
ds_read_b128 v[80:83], v136 offset:24576
s_add_u32 m0, s20, 16384
s_nop 0
v_mfma_f32_16x16x32_bf16 a[4:7], v[4:7], v[32:35], a[4:7]
ds_read_b64_tr_b16 v[48:49], v128 offset:49152
v_mfma_f32_16x16x32_bf16 a[8:11], v[8:11], v[32:35], a[8:11]
ds_read_b64_tr_b16 v[50:51], v128 offset:57344
v_mfma_f32_16x16x32_bf16 a[12:15], v[12:15], v[32:35], a[12:15]
ds_read_b64_tr_b16 v[52:53], v129 offset:49152
buffer_load_dwordx4 v141, s[4:7], s16 offen offset:0 sc1 lds
v_mfma_f32_16x16x32_bf16 a[16:19], v[16:19], v[32:35], a[16:19]
ds_read_b64_tr_b16 v[54:55], v129 offset:57344
v_mfma_f32_16x16x32_bf16 a[20:23], v[20:23], v[32:35], a[20:23]
ds_read_b64_tr_b16 v[56:57], v130 offset:49152
v_mfma_f32_16x16x32_bf16 a[24:27], v[24:27], v[32:35], a[24:27]
ds_read_b64_tr_b16 v[58:59], v130 offset:57344
buffer_load_dwordx4 v142, s[4:7], s16 offen offset:1024 sc1 lds
v_mfma_f32_16x16x32_bf16 a[28:31], v[28:31], v[32:35], a[28:31]
ds_read_b64_tr_b16 v[60:61], v131 offset:49152
v_mfma_f32_16x16x32_bf16 a[32:35], v[0:3], v[36:39], a[32:35]
ds_read_b64_tr_b16 v[62:63], v131 offset:57344
v_mfma_f32_16x16x32_bf16 a[36:39], v[4:7], v[36:39], a[36:39]
ds_read_b64_tr_b16 v[64:65], v132 offset:49152
s_add_u32 s16, s16, 1024
v_mfma_f32_16x16x32_bf16 a[40:43], v[8:11], v[36:39], a[40:43]
ds_read_b64_tr_b16 v[66:67], v132 offset:57344
v_mfma_f32_16x16x32_bf16 a[44:47], v[12:15], v[36:39], a[44:47]
ds_read_b64_tr_b16 v[68:69], v133 offset:49152
v_mfma_f32_16x16x32_bf16 a[48:51], v[16:19], v[36:39], a[48:51]
ds_read_b64_tr_b16 v[70:71], v133 offset:57344
s_add_u32 m0, s19, 32768
s_nop 0
v_mfma_f32_16x16x32_bf16 a[52:55], v[20:23], v[36:39], a[52:55]
ds_read_b64_tr_b16 v[72:73], v134 offset:49152
v_mfma_f32_16x16x32_bf16 a[56:59], v[24:27], v[36:39], a[56:59]
ds_read_b64_tr_b16 v[74:75], v134 offset:57344
v_mfma_f32_16x16x32_bf16 a[60:63], v[28:31], v[36:39], a[60:63]
ds_read_b64_tr_b16 v[76:77], v135 offset:49152
buffer_load_dwordx4 v137, s[8:11], s15 offen offset:0 lds
v_mfma_f32_16x16x32_bf16 a[64:67], v[0:3], v[40:43], a[64:67]
ds_read_b64_tr_b16 v[78:79], v135 offset:57344
v_mfma_f32_16x16x32_bf16 a[68:71], v[4:7], v[40:43], a[68:71]
ds_read_b128 v[84:87], v136 offset:25600
v_mfma_f32_16x16x32_bf16 a[72:75], v[8:11], v[40:43], a[72:75]
ds_read_b128 v[88:91], v136 offset:26624
buffer_load_dwordx4 v138, s[8:11], s15 offen offset:1024 lds
v_mfma_f32_16x16x32_bf16 a[76:79], v[12:15], v[40:43], a[76:79]
ds_read_b128 v[92:95], v136 offset:27648
v_mfma_f32_16x16x32_bf16 a[80:83], v[16:19], v[40:43], a[80:83]
s_waitcnt vmcnt(10)
v_mfma_f32_16x16x32_bf16 a[84:87], v[20:23], v[40:43], a[84:87]
buffer_load_dwordx4 v139, s[8:11], s15 offen offset:2048 lds
v_min3_u32 v253, v232, v233, v234
v_mfma_f32_16x16x32_bf16 a[88:91], v[24:27], v[40:43], a[88:91]
v_min_u32 v253, v253, v235
v_mfma_f32_16x16x32_bf16 a[92:95], v[28:31], v[40:43], a[92:95]
v_or_b32 v253, s61, v253
v_mfma_f32_16x16x32_bf16 a[96:99], v[0:3], v[44:47], a[96:99]
buffer_load_dwordx4 v140, s[8:11], s15 offen offset:3072 lds
v_min_u32 v253, v253, v231
v_mfma_f32_16x16x32_bf16 a[100:103], v[4:7], v[44:47], a[100:103]
v_cmp_eq_u32 vcc, 0, v253
v_mfma_f32_16x16x32_bf16 a[104:107], v[8:11], v[44:47], a[104:107]
s_nop 1
v_mfma_f32_16x16x32_bf16 a[108:111], v[12:15], v[44:47], a[108:111]
s_add_u32 s15, s15, s17
s_cmp_eq_u64 vcc, 0
s_cselect_b32 s32, s36, -4
v_mfma_f32_16x16x32_bf16 a[112:115], v[16:19], v[44:47], a[112:115]
s_bitcmp1_b32 0x1df, s23
s_cselect_b32 s32, s32, -4
v_mfma_f32_16x16x32_bf16 a[116:119], v[20:23], v[44:47], a[116:119]
v_mov_b32 v254, s32
v_mfma_f32_16x16x32_bf16 a[120:123], v[24:27], v[44:47], a[120:123]
s_mov_b64 exec, s[100:101]
ds_write_b32 v255, v254
s_mov_b64 exec, -1
v_mfma_f32_16x16x32_bf16 a[124:127], v[28:31], v[44:47], a[124:127]
s_waitcnt lgkmcnt(0)
v_mfma_f32_16x16x32_bf16 a[0:3], v[48:51], v[80:83], a[0:3]
s_waitcnt vmcnt(12)
s_barrier
ds_read_b128 v[32:35], v136 offset:0
s_add_u32 m0, s20, 24576
s_nop 0
ds_read_b32 v254, v255
v_mfma_f32_16x16x32_bf16 a[4:7], v[52:55], v[80:83], a[4:7]
ds_read_b64_tr_b16 v[0:1], v128 offset:0
v_mfma_f32_16x16x32_bf16 a[8:11], v[56:59], v[80:83], a[8:11]
ds_read_b64_tr_b16 v[2:3], v128 offset:8192
v_mfma_f32_16x16x32_bf16 a[12:15], v[60:63], v[80:83], a[12:15]
ds_read_b64_tr_b16 v[4:5], v129 offset:0
buffer_load_dwordx4 v141, s[4:7], s16 offen offset:0 sc1 lds
v_mfma_f32_16x16x32_bf16 a[16:19], v[64:67], v[80:83], a[16:19]
ds_read_b64_tr_b16 v[6:7], v129 offset:8192
v_mfma_f32_16x16x32_bf16 a[20:23], v[68:71], v[80:83], a[20:23]
ds_read_b64_tr_b16 v[8:9], v130 offset:0
v_mfma_f32_16x16x32_bf16 a[24:27], v[72:75], v[80:83], a[24:27]
ds_read_b64_tr_b16 v[10:11], v130 offset:8192
buffer_load_dwordx4 v142, s[4:7], s16 offen offset:1024 sc1 lds
v_mfma_f32_16x16x32_bf16 a[28:31], v[76:79], v[80:83], a[28:31]
ds_read_b64_tr_b16 v[12:13], v131 offset:0
v_mfma_f32_16x16x32_bf16 a[32:35], v[48:51], v[84:87], a[32:35]
ds_read_b64_tr_b16 v[14:15], v131 offset:8192
v_mfma_f32_16x16x32_bf16 a[36:39], v[52:55], v[84:87], a[36:39]
ds_read_b64_tr_b16 v[16:17], v132 offset:0
s_add_u32 s16, s16, 1024
v_mfma_f32_16x16x32_bf16 a[40:43], v[56:59], v[84:87], a[40:43]
ds_read_b64_tr_b16 v[18:19], v132 offset:8192
v_mfma_f32_16x16x32_bf16 a[44:47], v[60:63], v[84:87], a[44:47]
ds_read_b64_tr_b16 v[20:21], v133 offset:0
v_mfma_f32_16x16x32_bf16 a[48:51], v[64:67], v[84:87], a[48:51]
ds_read_b64_tr_b16 v[22:23], v133 offset:8192
s_add_u32 m0, s19, 49152
s_nop 0
v_mfma_f32_16x16x32_bf16 a[52:55], v[68:71], v[84:87], a[52:55]
ds_read_b64_tr_b16 v[24:25], v134 offset:0
v_mfma_f32_16x16x32_bf16 a[56:59], v[72:75], v[84:87], a[56:59]
ds_read_b64_tr_b16 v[26:27], v134 offset:8192
v_mfma_f32_16x16x32_bf16 a[60:63], v[76:79], v[84:87], a[60:63]
ds_read_b64_tr_b16 v[28:29], v135 offset:0
buffer_load_dwordx4 v137, s[8:11], s15 offen offset:0 lds
v_mfma_f32_16x16x32_bf16 a[64:67], v[48:51], v[88:91], a[64:67]
ds_read_b64_tr_b16 v[30:31], v135 offset:8192
v_mfma_f32_16x16x32_bf16 a[68:71], v[52:55], v[88:91], a[68:71]
ds_read_b128 v[36:39], v136 offset:1024
v_mfma_f32_16x16x32_bf16 a[72:75], v[56:59], v[88:91], a[72:75]
ds_read_b128 v[40:43], v136 offset:2048
buffer_load_dwordx4 v138, s[8:11], s15 offen offset:1024 lds
v_mfma_f32_16x16x32_bf16 a[76:79], v[60:63], v[88:91], a[76:79]
ds_read_b128 v[44:47], v136 offset:3072
v_mfma_f32_16x16x32_bf16 a[80:83], v[64:67], v[88:91], a[80:83]
s_waitcnt lgkmcnt(8)
v_mfma_f32_16x16x32_bf16 a[84:87], v[68:71], v[88:91], a[84:87]
buffer_load_dwordx4 v139, s[8:11], s15 offen offset:2048 lds
v_readfirstlane_b32 s62, v254
v_mfma_f32_16x16x32_bf16 a[88:91], v[72:75], v[88:91], a[88:91]
v_mfma_f32_16x16x32_bf16 a[92:95], v[76:79], v[88:91], a[92:95]
s_nop 1
v_mfma_f32_16x16x32_bf16 a[96:99], v[48:51], v[92:95], a[96:99]
buffer_load_dwordx4 v140, s[8:11], s15 offen offset:3072 lds
s_and_b32 s23, s62, 15
v_mfma_f32_16x16x32_bf16 a[100:103], v[52:55], v[92:95], a[100:103]
v_mfma_f32_16x16x32_bf16 a[104:107], v[56:59], v[92:95], a[104:107]
s_bfe_u32 s54, s62, 0x20004
v_mfma_f32_16x16x32_bf16 a[108:111], v[60:63], v[92:95], a[108:111]
s_add_u32 s15, s15, s17
s_bfe_u32 s24, s62, 0x80008
v_mfma_f32_16x16x32_bf16 a[112:115], v[64:67], v[92:95], a[112:115]
v_mfma_f32_16x16x32_bf16 a[116:119], v[68:71], v[92:95], a[116:119]
s_lshr_b32 s25, s62, 16
v_mfma_f32_16x16x32_bf16 a[120:123], v[72:75], v[92:95], a[120:123]
v_mfma_f32_16x16x32_bf16 a[124:127], v[76:79], v[92:95], a[124:127]
s_cmp_eq_u32 s54, 1
s_cselect_b32 s73, 2, -1
s_cbranch_scc1 main_kernel_w_c1_task
s_waitcnt lgkmcnt(0)
v_mfma_f32_16x16x32_bf16 a[0:3], v[0:3], v[32:35], a[0:3]
s_waitcnt vmcnt(12)
s_barrier
ds_read_b128 v[80:83], v136 offset:8192
v_mfma_f32_16x16x32_bf16 a[4:7], v[4:7], v[32:35], a[4:7]
ds_read_b64_tr_b16 v[48:49], v128 offset:16384
v_mfma_f32_16x16x32_bf16 a[8:11], v[8:11], v[32:35], a[8:11]
ds_read_b64_tr_b16 v[50:51], v128 offset:24576
v_mfma_f32_16x16x32_bf16 a[12:15], v[12:15], v[32:35], a[12:15]
ds_read_b64_tr_b16 v[52:53], v129 offset:16384
v_mfma_f32_16x16x32_bf16 a[16:19], v[16:19], v[32:35], a[16:19]
ds_read_b64_tr_b16 v[54:55], v129 offset:24576
v_mfma_f32_16x16x32_bf16 a[20:23], v[20:23], v[32:35], a[20:23]
ds_read_b64_tr_b16 v[56:57], v130 offset:16384
v_mfma_f32_16x16x32_bf16 a[24:27], v[24:27], v[32:35], a[24:27]
ds_read_b64_tr_b16 v[58:59], v130 offset:24576
v_mfma_f32_16x16x32_bf16 a[28:31], v[28:31], v[32:35], a[28:31]
ds_read_b64_tr_b16 v[60:61], v131 offset:16384
v_mfma_f32_16x16x32_bf16 a[32:35], v[0:3], v[36:39], a[32:35]
ds_read_b64_tr_b16 v[62:63], v131 offset:24576
v_mfma_f32_16x16x32_bf16 a[36:39], v[4:7], v[36:39], a[36:39]
ds_read_b64_tr_b16 v[64:65], v132 offset:16384
v_mfma_f32_16x16x32_bf16 a[40:43], v[8:11], v[36:39], a[40:43]
ds_read_b64_tr_b16 v[66:67], v132 offset:24576
v_mfma_f32_16x16x32_bf16 a[44:47], v[12:15], v[36:39], a[44:47]
ds_read_b64_tr_b16 v[68:69], v133 offset:16384
v_mfma_f32_16x16x32_bf16 a[48:51], v[16:19], v[36:39], a[48:51]
ds_read_b64_tr_b16 v[70:71], v133 offset:24576
v_mfma_f32_16x16x32_bf16 a[52:55], v[20:23], v[36:39], a[52:55]
ds_read_b64_tr_b16 v[72:73], v134 offset:16384
v_mfma_f32_16x16x32_bf16 a[56:59], v[24:27], v[36:39], a[56:59]
ds_read_b64_tr_b16 v[74:75], v134 offset:24576
v_mfma_f32_16x16x32_bf16 a[60:63], v[28:31], v[36:39], a[60:63]
ds_read_b64_tr_b16 v[76:77], v135 offset:16384
v_mfma_f32_16x16x32_bf16 a[64:67], v[0:3], v[40:43], a[64:67]
ds_read_b64_tr_b16 v[78:79], v135 offset:24576
v_mfma_f32_16x16x32_bf16 a[68:71], v[4:7], v[40:43], a[68:71]
ds_read_b128 v[84:87], v136 offset:9216
v_mfma_f32_16x16x32_bf16 a[72:75], v[8:11], v[40:43], a[72:75]
ds_read_b128 v[88:91], v136 offset:10240
v_mfma_f32_16x16x32_bf16 a[76:79], v[12:15], v[40:43], a[76:79]
ds_read_b128 v[92:95], v136 offset:11264
v_mfma_f32_16x16x32_bf16 a[80:83], v[16:19], v[40:43], a[80:83]
v_mfma_f32_16x16x32_bf16 a[84:87], v[20:23], v[40:43], a[84:87]
v_mfma_f32_16x16x32_bf16 a[88:91], v[24:27], v[40:43], a[88:91]
v_mfma_f32_16x16x32_bf16 a[92:95], v[28:31], v[40:43], a[92:95]
v_mfma_f32_16x16x32_bf16 a[96:99], v[0:3], v[44:47], a[96:99]
v_mfma_f32_16x16x32_bf16 a[100:103], v[4:7], v[44:47], a[100:103]
v_mfma_f32_16x16x32_bf16 a[104:107], v[8:11], v[44:47], a[104:107]
v_mfma_f32_16x16x32_bf16 a[108:111], v[12:15], v[44:47], a[108:111]
v_mfma_f32_16x16x32_bf16 a[112:115], v[16:19], v[44:47], a[112:115]
v_mfma_f32_16x16x32_bf16 a[116:119], v[20:23], v[44:47], a[116:119]
v_mfma_f32_16x16x32_bf16 a[120:123], v[24:27], v[44:47], a[120:123]
v_mfma_f32_16x16x32_bf16 a[124:127], v[28:31], v[44:47], a[124:127]
s_waitcnt lgkmcnt(0)
v_mfma_f32_16x16x32_bf16 a[0:3], v[48:51], v[80:83], a[0:3]
s_waitcnt vmcnt(6)
s_barrier
ds_read_b128 v[32:35], v136 offset:16384
v_mfma_f32_16x16x32_bf16 a[4:7], v[52:55], v[80:83], a[4:7]
ds_read_b64_tr_b16 v[0:1], v128 offset:32768
v_mfma_f32_16x16x32_bf16 a[8:11], v[56:59], v[80:83], a[8:11]
ds_read_b64_tr_b16 v[2:3], v128 offset:40960
v_mfma_f32_16x16x32_bf16 a[12:15], v[60:63], v[80:83], a[12:15]
ds_read_b64_tr_b16 v[4:5], v129 offset:32768
v_mfma_f32_16x16x32_bf16 a[16:19], v[64:67], v[80:83], a[16:19]
ds_read_b64_tr_b16 v[6:7], v129 offset:40960
v_mfma_f32_16x16x32_bf16 a[20:23], v[68:71], v[80:83], a[20:23]
ds_read_b64_tr_b16 v[8:9], v130 offset:32768
v_mfma_f32_16x16x32_bf16 a[24:27], v[72:75], v[80:83], a[24:27]
ds_read_b64_tr_b16 v[10:11], v130 offset:40960
v_mfma_f32_16x16x32_bf16 a[28:31], v[76:79], v[80:83], a[28:31]
ds_read_b64_tr_b16 v[12:13], v131 offset:32768
v_mfma_f32_16x16x32_bf16 a[32:35], v[48:51], v[84:87], a[32:35]
ds_read_b64_tr_b16 v[14:15], v131 offset:40960
v_mfma_f32_16x16x32_bf16 a[36:39], v[52:55], v[84:87], a[36:39]
ds_read_b64_tr_b16 v[16:17], v132 offset:32768
v_mfma_f32_16x16x32_bf16 a[40:43], v[56:59], v[84:87], a[40:43]
ds_read_b64_tr_b16 v[18:19], v132 offset:40960
v_mfma_f32_16x16x32_bf16 a[44:47], v[60:63], v[84:87], a[44:47]
ds_read_b64_tr_b16 v[20:21], v133 offset:32768
v_mfma_f32_16x16x32_bf16 a[48:51], v[64:67], v[84:87], a[48:51]
ds_read_b64_tr_b16 v[22:23], v133 offset:40960
v_mfma_f32_16x16x32_bf16 a[52:55], v[68:71], v[84:87], a[52:55]
ds_read_b64_tr_b16 v[24:25], v134 offset:32768
v_mfma_f32_16x16x32_bf16 a[56:59], v[72:75], v[84:87], a[56:59]
ds_read_b64_tr_b16 v[26:27], v134 offset:40960
v_mfma_f32_16x16x32_bf16 a[60:63], v[76:79], v[84:87], a[60:63]
ds_read_b64_tr_b16 v[28:29], v135 offset:32768
v_mfma_f32_16x16x32_bf16 a[64:67], v[48:51], v[88:91], a[64:67]
ds_read_b64_tr_b16 v[30:31], v135 offset:40960
v_mfma_f32_16x16x32_bf16 a[68:71], v[52:55], v[88:91], a[68:71]
ds_read_b128 v[36:39], v136 offset:17408
v_mfma_f32_16x16x32_bf16 a[72:75], v[56:59], v[88:91], a[72:75]
ds_read_b128 v[40:43], v136 offset:18432
v_mfma_f32_16x16x32_bf16 a[76:79], v[60:63], v[88:91], a[76:79]
ds_read_b128 v[44:47], v136 offset:19456
v_mfma_f32_16x16x32_bf16 a[80:83], v[64:67], v[88:91], a[80:83]
v_mfma_f32_16x16x32_bf16 a[84:87], v[68:71], v[88:91], a[84:87]
v_mfma_f32_16x16x32_bf16 a[88:91], v[72:75], v[88:91], a[88:91]
v_mfma_f32_16x16x32_bf16 a[92:95], v[76:79], v[88:91], a[92:95]
v_mfma_f32_16x16x32_bf16 a[96:99], v[48:51], v[92:95], a[96:99]
v_mfma_f32_16x16x32_bf16 a[100:103], v[52:55], v[92:95], a[100:103]
v_mfma_f32_16x16x32_bf16 a[104:107], v[56:59], v[92:95], a[104:107]
v_mfma_f32_16x16x32_bf16 a[108:111], v[60:63], v[92:95], a[108:111]
v_mfma_f32_16x16x32_bf16 a[112:115], v[64:67], v[92:95], a[112:115]
v_mfma_f32_16x16x32_bf16 a[116:119], v[68:71], v[92:95], a[116:119]
v_mfma_f32_16x16x32_bf16 a[120:123], v[72:75], v[92:95], a[120:123]
v_mfma_f32_16x16x32_bf16 a[124:127], v[76:79], v[92:95], a[124:127]
s_waitcnt lgkmcnt(0)
v_mfma_f32_16x16x32_bf16 a[0:3], v[0:3], v[32:35], a[0:3]
s_waitcnt vmcnt(0)
s_barrier
ds_read_b128 v[80:83], v136 offset:24576
v_mfma_f32_16x16x32_bf16 a[4:7], v[4:7], v[32:35], a[4:7]
ds_read_b64_tr_b16 v[48:49], v128 offset:49152
v_mfma_f32_16x16x32_bf16 a[8:11], v[8:11], v[32:35], a[8:11]
ds_read_b64_tr_b16 v[50:51], v128 offset:57344
v_mfma_f32_16x16x32_bf16 a[12:15], v[12:15], v[32:35], a[12:15]
ds_read_b64_tr_b16 v[52:53], v129 offset:49152
v_mfma_f32_16x16x32_bf16 a[16:19], v[16:19], v[32:35], a[16:19]
ds_read_b64_tr_b16 v[54:55], v129 offset:57344
v_mfma_f32_16x16x32_bf16 a[20:23], v[20:23], v[32:35], a[20:23]
ds_read_b64_tr_b16 v[56:57], v130 offset:49152
v_mfma_f32_16x16x32_bf16 a[24:27], v[24:27], v[32:35], a[24:27]
ds_read_b64_tr_b16 v[58:59], v130 offset:57344
v_mfma_f32_16x16x32_bf16 a[28:31], v[28:31], v[32:35], a[28:31]
ds_read_b64_tr_b16 v[60:61], v131 offset:49152
v_mfma_f32_16x16x32_bf16 a[32:35], v[0:3], v[36:39], a[32:35]
ds_read_b64_tr_b16 v[62:63], v131 offset:57344
v_mfma_f32_16x16x32_bf16 a[36:39], v[4:7], v[36:39], a[36:39]
ds_read_b64_tr_b16 v[64:65], v132 offset:49152
v_mfma_f32_16x16x32_bf16 a[40:43], v[8:11], v[36:39], a[40:43]
ds_read_b64_tr_b16 v[66:67], v132 offset:57344
v_mfma_f32_16x16x32_bf16 a[44:47], v[12:15], v[36:39], a[44:47]
ds_read_b64_tr_b16 v[68:69], v133 offset:49152
v_mfma_f32_16x16x32_bf16 a[48:51], v[16:19], v[36:39], a[48:51]
ds_read_b64_tr_b16 v[70:71], v133 offset:57344
v_mfma_f32_16x16x32_bf16 a[52:55], v[20:23], v[36:39], a[52:55]
ds_read_b64_tr_b16 v[72:73], v134 offset:49152
v_mfma_f32_16x16x32_bf16 a[56:59], v[24:27], v[36:39], a[56:59]
ds_read_b64_tr_b16 v[74:75], v134 offset:57344
v_mfma_f32_16x16x32_bf16 a[60:63], v[28:31], v[36:39], a[60:63]
ds_read_b64_tr_b16 v[76:77], v135 offset:49152
v_mfma_f32_16x16x32_bf16 a[64:67], v[0:3], v[40:43], a[64:67]
ds_read_b64_tr_b16 v[78:79], v135 offset:57344
v_mfma_f32_16x16x32_bf16 a[68:71], v[4:7], v[40:43], a[68:71]
ds_read_b128 v[84:87], v136 offset:25600
v_mfma_f32_16x16x32_bf16 a[72:75], v[8:11], v[40:43], a[72:75]
ds_read_b128 v[88:91], v136 offset:26624
v_mfma_f32_16x16x32_bf16 a[76:79], v[12:15], v[40:43], a[76:79]
ds_read_b128 v[92:95], v136 offset:27648
v_mfma_f32_16x16x32_bf16 a[80:83], v[16:19], v[40:43], a[80:83]
v_mfma_f32_16x16x32_bf16 a[84:87], v[20:23], v[40:43], a[84:87]
v_mfma_f32_16x16x32_bf16 a[88:91], v[24:27], v[40:43], a[88:91]
v_mfma_f32_16x16x32_bf16 a[92:95], v[28:31], v[40:43], a[92:95]
v_mfma_f32_16x16x32_bf16 a[96:99], v[0:3], v[44:47], a[96:99]
v_mfma_f32_16x16x32_bf16 a[100:103], v[4:7], v[44:47], a[100:103]
v_mfma_f32_16x16x32_bf16 a[104:107], v[8:11], v[44:47], a[104:107]
v_mfma_f32_16x16x32_bf16 a[108:111], v[12:15], v[44:47], a[108:111]
v_mfma_f32_16x16x32_bf16 a[112:115], v[16:19], v[44:47], a[112:115]
v_mfma_f32_16x16x32_bf16 a[116:119], v[20:23], v[44:47], a[116:119]
v_mfma_f32_16x16x32_bf16 a[120:123], v[24:27], v[44:47], a[120:123]
v_mfma_f32_16x16x32_bf16 a[124:127], v[28:31], v[44:47], a[124:127]
s_waitcnt lgkmcnt(0)
v_mfma_f32_16x16x32_bf16 a[0:3], v[48:51], v[80:83], a[0:3]
s_barrier
v_mfma_f32_16x16x32_bf16 a[4:7], v[52:55], v[80:83], a[4:7]
v_mfma_f32_16x16x32_bf16 a[8:11], v[56:59], v[80:83], a[8:11]
v_mfma_f32_16x16x32_bf16 a[12:15], v[60:63], v[80:83], a[12:15]
v_mfma_f32_16x16x32_bf16 a[16:19], v[64:67], v[80:83], a[16:19]
v_mfma_f32_16x16x32_bf16 a[20:23], v[68:71], v[80:83], a[20:23]
v_mfma_f32_16x16x32_bf16 a[24:27], v[72:75], v[80:83], a[24:27]
v_mfma_f32_16x16x32_bf16 a[28:31], v[76:79], v[80:83], a[28:31]
v_mfma_f32_16x16x32_bf16 a[32:35], v[48:51], v[84:87], a[32:35]
v_mfma_f32_16x16x32_bf16 a[36:39], v[52:55], v[84:87], a[36:39]
v_mfma_f32_16x16x32_bf16 a[40:43], v[56:59], v[84:87], a[40:43]
v_mfma_f32_16x16x32_bf16 a[44:47], v[60:63], v[84:87], a[44:47]
v_mfma_f32_16x16x32_bf16 a[48:51], v[64:67], v[84:87], a[48:51]
v_mfma_f32_16x16x32_bf16 a[52:55], v[68:71], v[84:87], a[52:55]
v_mfma_f32_16x16x32_bf16 a[56:59], v[72:75], v[84:87], a[56:59]
v_mfma_f32_16x16x32_bf16 a[60:63], v[76:79], v[84:87], a[60:63]
v_mfma_f32_16x16x32_bf16 a[64:67], v[48:51], v[88:91], a[64:67]
v_mfma_f32_16x16x32_bf16 a[68:71], v[52:55], v[88:91], a[68:71]
v_mfma_f32_16x16x32_bf16 a[72:75], v[56:59], v[88:91], a[72:75]
v_mfma_f32_16x16x32_bf16 a[76:79], v[60:63], v[88:91], a[76:79]
v_mfma_f32_16x16x32_bf16 a[80:83], v[64:67], v[88:91], a[80:83]
v_mfma_f32_16x16x32_bf16 a[84:87], v[68:71], v[88:91], a[84:87]
v_mfma_f32_16x16x32_bf16 a[88:91], v[72:75], v[88:91], a[88:91]
v_mfma_f32_16x16x32_bf16 a[92:95], v[76:79], v[88:91], a[92:95]
v_mfma_f32_16x16x32_bf16 a[96:99], v[48:51], v[92:95], a[96:99]
v_mfma_f32_16x16x32_bf16 a[100:103], v[52:55], v[92:95], a[100:103]
v_mfma_f32_16x16x32_bf16 a[104:107], v[56:59], v[92:95], a[104:107]
v_mfma_f32_16x16x32_bf16 a[108:111], v[60:63], v[92:95], a[108:111]
v_mfma_f32_16x16x32_bf16 a[112:115], v[64:67], v[92:95], a[112:115]
v_mfma_f32_16x16x32_bf16 a[116:119], v[68:71], v[92:95], a[116:119]
v_mfma_f32_16x16x32_bf16 a[120:123], v[72:75], v[92:95], a[120:123]
v_mfma_f32_16x16x32_bf16 a[124:127], v[76:79], v[92:95], a[124:127]
s_cmp_lg_u32 s62, -4
s_cbranch_scc1 main_kernel_w_gemm
s_branch main_kernel_w_slow
main_kernel_w_c1_n_ev:
s_mov_b32 s55, 1
s_cmp_eq_u32 s56, 0
s_cbranch_scc1 main_kernel_w_c1_n_et
s_bfm_b64 exec, s0, 0
buffer_store_dword v244, v248, s[4:7], s59 offen sc1
s_mov_b64 exec, -1
s_mov_b32 s56, 0
main_kernel_w_c1_n_et:
s_cmp_lg_u32 s18, 1
s_cbranch_scc1 main_kernel_w_c1_n_loop
s_lshl_b32 s32, s27, 8
s_add_u32 s32, s32, 0x841e000
s_mov_b64 exec, 1
v_mov_b32 v249, 1
buffer_atomic_add v249, off, s[4:7], s32 sc0 sc1
s_mov_b64 exec, -1
s_branch main_kernel_w_c1_n_loop
main_kernel_w_c1_gov:
s_mov_b32 s58, 3
s_mov_b32 s72, s18
s_cmp_lg_u32 s73, -1
s_cbranch_scc1 main_kernel_w_c1_str
s_waitcnt lgkmcnt(0)
v_lshrrev_b32 v0, 4, v250
v_bfe_u32 v1, v250, 2, 2
v_lshl_add_u32 v4, v0, 2, v1
v_and_b32 v5, 7, v4
v_mul_u32_u24 v4, 512, v4
v_and_b32 v6, 3, v250
v_lshl_add_u32 v4, v6, 3, v4
s_mul_i32 s32, s37, 8
v_xor_b32 v5, s32, v5
v_lshl_add_u32 v128, v5, 5, v4
v_xor_b32 v129, 32, v128
v_xor_b32 v130, 64, v128
v_xor_b32 v131, 96, v128
v_xor_b32 v132, 128, v128
v_xor_b32 v133, 160, v128
v_xor_b32 v134, 192, v128
v_xor_b32 v135, 224, v128
s_mul_i32 s32, s38, 4096
s_add_u32 s32, s32, 65536
v_add_u32 v136, s32, v251
v_lshrrev_b32 v2, 5, v250
v_and_b32 v3, 31, v250
s_mul_i32 s32, s14, 8
v_add_u32 v147, s32, v2
v_and_b32 v6, 7, v147
v_lshlrev_b32 v6, 1, v6
v_xor_b32 v6, v6, v3
v_lshlrev_b32 v151, 4, v6
v_add_u32 v148, 2, v147
v_and_b32 v6, 7, v148
v_lshlrev_b32 v6, 1, v6
v_xor_b32 v6, v6, v3
v_lshlrev_b32 v152, 4, v6
v_subrev_u32 v152, 1024, v152
v_add_u32 v149, 4, v147
v_and_b32 v6, 7, v149
v_lshlrev_b32 v6, 1, v6
v_xor_b32 v6, v6, v3
v_lshlrev_b32 v153, 4, v6
v_subrev_u32 v153, 2048, v153
v_add_u32 v150, 6, v147
v_and_b32 v6, 7, v150
v_lshlrev_b32 v6, 1, v6
v_xor_b32 v6, v6, v3
v_lshlrev_b32 v154, 4, v6
v_subrev_u32 v154, 3072, v154
s_mul_i32 s19, s14, 4096
s_mul_i32 s20, s14, 2048
s_add_u32 s20, s20, 65536
s_mul_i32 s32, s14, 2
s_mul_i32 s32, s32, s31
v_mad_u32_u24 v137, v147, s30, v151
v_mad_u32_u24 v138, v148, s30, v152
v_mad_u32_u24 v139, v149, s30, v153
v_mad_u32_u24 v140, v150, s30, v154
v_add_u32 v141, s32, v251
s_add_u32 s32, s32, s31
s_sub_u32 s32, s32, 1024
v_add_u32 v142, s32, v251
s_mul_i32 s17, s30, 32
s_mov_b32 s15, 0
s_waitcnt vmcnt(0)
s_add_u32 m0, s20, 0
s_nop 0
buffer_load_dwordx4 v141, s[4:7], s16 offen offset:0 sc1 lds
buffer_load_dwordx4 v142, s[4:7], s16 offen offset:1024 sc1 lds
s_add_u32 s16, s16, 1024
s_add_u32 m0, s19, 0
s_nop 0
buffer_load_dwordx4 v137, s[8:11], s15 offen offset:0 lds
buffer_load_dwordx4 v138, s[8:11], s15 offen offset:1024 lds
buffer_load_dwordx4 v139, s[8:11], s15 offen offset:2048 lds
buffer_load_dwordx4 v140, s[8:11], s15 offen offset:3072 lds
s_add_u32 s15, s15, s17
s_add_u32 m0, s20, 8192
s_nop 0
buffer_load_dwordx4 v141, s[4:7], s16 offen offset:0 sc1 lds
buffer_load_dwordx4 v142, s[4:7], s16 offen offset:1024 sc1 lds
s_add_u32 s16, s16, 1024
s_add_u32 m0, s19, 16384
s_nop 0
buffer_load_dwordx4 v137, s[8:11], s15 offen offset:0 lds
buffer_load_dwordx4 v138, s[8:11], s15 offen offset:1024 lds
buffer_load_dwordx4 v139, s[8:11], s15 offen offset:2048 lds
buffer_load_dwordx4 v140, s[8:11], s15 offen offset:3072 lds
s_add_u32 s15, s15, s17
s_add_u32 m0, s20, 16384
s_nop 0
buffer_load_dwordx4 v141, s[4:7], s16 offen offset:0 sc1 lds
buffer_load_dwordx4 v142, s[4:7], s16 offen offset:1024 sc1 lds
s_add_u32 s16, s16, 1024
s_add_u32 m0, s19, 32768
s_nop 0
buffer_load_dwordx4 v137, s[8:11], s15 offen offset:0 lds
buffer_load_dwordx4 v138, s[8:11], s15 offen offset:1024 lds
buffer_load_dwordx4 v139, s[8:11], s15 offen offset:2048 lds
buffer_load_dwordx4 v140, s[8:11], s15 offen offset:3072 lds
s_add_u32 s15, s15, s17
s_add_u32 m0, s20, 24576
s_nop 0
buffer_load_dwordx4 v141, s[4:7], s16 offen offset:0 sc1 lds
buffer_load_dwordx4 v142, s[4:7], s16 offen offset:1024 sc1 lds
s_add_u32 s16, s16, 1024
s_add_u32 m0, s19, 49152
s_nop 0
buffer_load_dwordx4 v137, s[8:11], s15 offen offset:0 lds
buffer_load_dwordx4 v138, s[8:11], s15 offen offset:1024 lds
buffer_load_dwordx4 v139, s[8:11], s15 offen offset:2048 lds
buffer_load_dwordx4 v140, s[8:11], s15 offen offset:3072 lds
s_add_u32 s15, s15, s17
s_cmp_lg_u32 s56, 0
s_cbranch_scc1 main_kernel_w_epi
main_kernel_w_c1_v_ent:
v_mfma_f32_32x32x16_bf16 a[0:15], v[224:227], v[224:227], 0
s_waitcnt vmcnt(18)
s_barrier
ds_read_b128 v[32:35], v136 offset:0
ds_read_b64_tr_b16 v[0:1], v128 offset:0
ds_read_b64_tr_b16 v[2:3], v128 offset:8192
v_mfma_f32_32x32x16_bf16 a[16:31], v[224:227], v[224:227], 0
ds_read_b64_tr_b16 v[4:5], v129 offset:0
ds_read_b64_tr_b16 v[6:7], v129 offset:8192
ds_read_b64_tr_b16 v[8:9], v130 offset:0
v_mfma_f32_32x32x16_bf16 a[32:47], v[224:227], v[224:227], 0
ds_read_b64_tr_b16 v[10:11], v130 offset:8192
ds_read_b64_tr_b16 v[12:13], v131 offset:0
ds_read_b64_tr_b16 v[14:15], v131 offset:8192
v_mfma_f32_32x32x16_bf16 a[48:63], v[224:227], v[224:227], 0
ds_read_b64_tr_b16 v[16:17], v132 offset:0
ds_read_b64_tr_b16 v[18:19], v132 offset:8192
ds_read_b64_tr_b16 v[20:21], v133 offset:0
v_mfma_f32_32x32x16_bf16 a[64:79], v[224:227], v[224:227], 0
ds_read_b64_tr_b16 v[22:23], v133 offset:8192
ds_read_b64_tr_b16 v[24:25], v134 offset:0
ds_read_b64_tr_b16 v[26:27], v134 offset:8192
v_mfma_f32_32x32x16_bf16 a[80:95], v[224:227], v[224:227], 0
ds_read_b64_tr_b16 v[28:29], v135 offset:0
ds_read_b64_tr_b16 v[30:31], v135 offset:8192
ds_read_b128 v[36:39], v136 offset:1024
v_mfma_f32_32x32x16_bf16 a[96:111], v[224:227], v[224:227], 0
ds_read_b128 v[40:43], v136 offset:2048
ds_read_b128 v[44:47], v136 offset:3072
v_mfma_f32_32x32x16_bf16 a[112:127], v[224:227], v[224:227], 0
s_sub_u32 s18, s72, 1
s_sub_u32 s55, s72, 2
s_orn2_b32 s55, s55, s100
s_mov_b32 s73, -1
s_nop 0
main_kernel_w_c1_v_loop:
main_kernel_w_c1_v_mid:
s_waitcnt lgkmcnt(0)
v_mfma_f32_16x16x32_bf16 a[0:3], v[32:35], v[0:3], a[0:3]
s_waitcnt vmcnt(12)
s_barrier
ds_read_b128 v[80:83], v136 offset:8192
s_add_u32 m0, s20, 0
s_nop 0
v_mfma_f32_16x16x32_bf16 a[4:7], v[32:35], v[4:7], a[4:7]
ds_read_b64_tr_b16 v[48:49], v128 offset:16384
v_mfma_f32_16x16x32_bf16 a[8:11], v[32:35], v[8:11], a[8:11]
ds_read_b64_tr_b16 v[50:51], v128 offset:24576
v_mfma_f32_16x16x32_bf16 a[12:15], v[32:35], v[12:15], a[12:15]
ds_read_b64_tr_b16 v[52:53], v129 offset:16384
buffer_load_dwordx4 v141, s[4:7], s16 offen offset:0 sc1 lds
v_mfma_f32_16x16x32_bf16 a[16:19], v[32:35], v[16:19], a[16:19]
ds_read_b64_tr_b16 v[54:55], v129 offset:24576
v_mfma_f32_16x16x32_bf16 a[20:23], v[32:35], v[20:23], a[20:23]
ds_read_b64_tr_b16 v[56:57], v130 offset:16384
v_mfma_f32_16x16x32_bf16 a[24:27], v[32:35], v[24:27], a[24:27]
ds_read_b64_tr_b16 v[58:59], v130 offset:24576
buffer_load_dwordx4 v142, s[4:7], s16 offen offset:1024 sc1 lds
v_mfma_f32_16x16x32_bf16 a[28:31], v[32:35], v[28:31], a[28:31]
ds_read_b64_tr_b16 v[60:61], v131 offset:16384
v_mfma_f32_16x16x32_bf16 a[32:35], v[36:39], v[0:3], a[32:35]
ds_read_b64_tr_b16 v[62:63], v131 offset:24576
v_mfma_f32_16x16x32_bf16 a[36:39], v[36:39], v[4:7], a[36:39]
ds_read_b64_tr_b16 v[64:65], v132 offset:16384
s_add_u32 s16, s16, 1024
v_mfma_f32_16x16x32_bf16 a[40:43], v[36:39], v[8:11], a[40:43]
ds_read_b64_tr_b16 v[66:67], v132 offset:24576
v_mfma_f32_16x16x32_bf16 a[44:47], v[36:39], v[12:15], a[44:47]
ds_read_b64_tr_b16 v[68:69], v133 offset:16384
v_mfma_f32_16x16x32_bf16 a[48:51], v[36:39], v[16:19], a[48:51]
ds_read_b64_tr_b16 v[70:71], v133 offset:24576
s_add_u32 m0, s19, 0
s_nop 0
v_mfma_f32_16x16x32_bf16 a[52:55], v[36:39], v[20:23], a[52:55]
ds_read_b64_tr_b16 v[72:73], v134 offset:16384
v_mfma_f32_16x16x32_bf16 a[56:59], v[36:39], v[24:27], a[56:59]
ds_read_b64_tr_b16 v[74:75], v134 offset:24576
v_mfma_f32_16x16x32_bf16 a[60:63], v[36:39], v[28:31], a[60:63]
ds_read_b64_tr_b16 v[76:77], v135 offset:16384
buffer_load_dwordx4 v137, s[8:11], s15 offen offset:0 lds
v_mfma_f32_16x16x32_bf16 a[64:67], v[40:43], v[0:3], a[64:67]
ds_read_b64_tr_b16 v[78:79], v135 offset:24576
v_mfma_f32_16x16x32_bf16 a[68:71], v[40:43], v[4:7], a[68:71]
ds_read_b128 v[84:87], v136 offset:9216
v_mfma_f32_16x16x32_bf16 a[72:75], v[40:43], v[8:11], a[72:75]
ds_read_b128 v[88:91], v136 offset:10240
buffer_load_dwordx4 v138, s[8:11], s15 offen offset:1024 lds
v_mfma_f32_16x16x32_bf16 a[76:79], v[40:43], v[12:15], a[76:79]
ds_read_b128 v[92:95], v136 offset:11264
v_mfma_f32_16x16x32_bf16 a[80:83], v[40:43], v[16:19], a[80:83]
v_mfma_f32_16x16x32_bf16 a[84:87], v[40:43], v[20:23], a[84:87]
buffer_load_dwordx4 v139, s[8:11], s15 offen offset:2048 lds
v_mfma_f32_16x16x32_bf16 a[88:91], v[40:43], v[24:27], a[88:91]
v_mfma_f32_16x16x32_bf16 a[92:95], v[40:43], v[28:31], a[92:95]
v_mfma_f32_16x16x32_bf16 a[96:99], v[44:47], v[0:3], a[96:99]
buffer_load_dwordx4 v140, s[8:11], s15 offen offset:3072 lds
v_mfma_f32_16x16x32_bf16 a[100:103], v[44:47], v[4:7], a[100:103]
v_mfma_f32_16x16x32_bf16 a[104:107], v[44:47], v[8:11], a[104:107]
v_mfma_f32_16x16x32_bf16 a[108:111], v[44:47], v[12:15], a[108:111]
s_add_u32 s15, s15, s17
v_mfma_f32_16x16x32_bf16 a[112:115], v[44:47], v[16:19], a[112:115]
v_mfma_f32_16x16x32_bf16 a[116:119], v[44:47], v[20:23], a[116:119]
v_mfma_f32_16x16x32_bf16 a[120:123], v[44:47], v[24:27], a[120:123]
v_mfma_f32_16x16x32_bf16 a[124:127], v[44:47], v[28:31], a[124:127]
s_waitcnt lgkmcnt(0)
v_mfma_f32_16x16x32_bf16 a[0:3], v[80:83], v[48:51], a[0:3]
s_waitcnt vmcnt(12)
s_barrier
ds_read_b128 v[32:35], v136 offset:16384
s_add_u32 m0, s20, 8192
s_nop 0
v_mfma_f32_16x16x32_bf16 a[4:7], v[80:83], v[52:55], a[4:7]
ds_read_b64_tr_b16 v[0:1], v128 offset:32768
v_mfma_f32_16x16x32_bf16 a[8:11], v[80:83], v[56:59], a[8:11]
ds_read_b64_tr_b16 v[2:3], v128 offset:40960
v_mfma_f32_16x16x32_bf16 a[12:15], v[80:83], v[60:63], a[12:15]
ds_read_b64_tr_b16 v[4:5], v129 offset:32768
buffer_load_dwordx4 v141, s[4:7], s16 offen offset:0 sc1 lds
v_mfma_f32_16x16x32_bf16 a[16:19], v[80:83], v[64:67], a[16:19]
ds_read_b64_tr_b16 v[6:7], v129 offset:40960
v_mfma_f32_16x16x32_bf16 a[20:23], v[80:83], v[68:71], a[20:23]
ds_read_b64_tr_b16 v[8:9], v130 offset:32768
v_mfma_f32_16x16x32_bf16 a[24:27], v[80:83], v[72:75], a[24:27]
ds_read_b64_tr_b16 v[10:11], v130 offset:40960
buffer_load_dwordx4 v142, s[4:7], s16 offen offset:1024 sc1 lds
v_mfma_f32_16x16x32_bf16 a[28:31], v[80:83], v[76:79], a[28:31]
ds_read_b64_tr_b16 v[12:13], v131 offset:32768
v_mfma_f32_16x16x32_bf16 a[32:35], v[84:87], v[48:51], a[32:35]
ds_read_b64_tr_b16 v[14:15], v131 offset:40960
v_mfma_f32_16x16x32_bf16 a[36:39], v[84:87], v[52:55], a[36:39]
ds_read_b64_tr_b16 v[16:17], v132 offset:32768
s_add_u32 s16, s16, 1024
v_mfma_f32_16x16x32_bf16 a[40:43], v[84:87], v[56:59], a[40:43]
ds_read_b64_tr_b16 v[18:19], v132 offset:40960
v_mfma_f32_16x16x32_bf16 a[44:47], v[84:87], v[60:63], a[44:47]
ds_read_b64_tr_b16 v[20:21], v133 offset:32768
v_mfma_f32_16x16x32_bf16 a[48:51], v[84:87], v[64:67], a[48:51]
ds_read_b64_tr_b16 v[22:23], v133 offset:40960
s_add_u32 m0, s19, 16384
s_nop 0
v_mfma_f32_16x16x32_bf16 a[52:55], v[84:87], v[68:71], a[52:55]
ds_read_b64_tr_b16 v[24:25], v134 offset:32768
v_mfma_f32_16x16x32_bf16 a[56:59], v[84:87], v[72:75], a[56:59]
ds_read_b64_tr_b16 v[26:27], v134 offset:40960
v_mfma_f32_16x16x32_bf16 a[60:63], v[84:87], v[76:79], a[60:63]
ds_read_b64_tr_b16 v[28:29], v135 offset:32768
buffer_load_dwordx4 v137, s[8:11], s15 offen offset:0 lds
v_mfma_f32_16x16x32_bf16 a[64:67], v[88:91], v[48:51], a[64:67]
ds_read_b64_tr_b16 v[30:31], v135 offset:40960
v_mfma_f32_16x16x32_bf16 a[68:71], v[88:91], v[52:55], a[68:71]
ds_read_b128 v[36:39], v136 offset:17408
v_mfma_f32_16x16x32_bf16 a[72:75], v[88:91], v[56:59], a[72:75]
ds_read_b128 v[40:43], v136 offset:18432
buffer_load_dwordx4 v138, s[8:11], s15 offen offset:1024 lds
v_mfma_f32_16x16x32_bf16 a[76:79], v[88:91], v[60:63], a[76:79]
ds_read_b128 v[44:47], v136 offset:19456
v_mfma_f32_16x16x32_bf16 a[80:83], v[88:91], v[64:67], a[80:83]
v_mfma_f32_16x16x32_bf16 a[84:87], v[88:91], v[68:71], a[84:87]
buffer_load_dwordx4 v139, s[8:11], s15 offen offset:2048 lds
v_mfma_f32_16x16x32_bf16 a[88:91], v[88:91], v[72:75], a[88:91]
v_mfma_f32_16x16x32_bf16 a[92:95], v[88:91], v[76:79], a[92:95]
v_mfma_f32_16x16x32_bf16 a[96:99], v[92:95], v[48:51], a[96:99]
buffer_load_dwordx4 v140, s[8:11], s15 offen offset:3072 lds
v_mfma_f32_16x16x32_bf16 a[100:103], v[92:95], v[52:55], a[100:103]
v_mfma_f32_16x16x32_bf16 a[104:107], v[92:95], v[56:59], a[104:107]
v_mfma_f32_16x16x32_bf16 a[108:111], v[92:95], v[60:63], a[108:111]
s_add_u32 s15, s15, s17
v_mfma_f32_16x16x32_bf16 a[112:115], v[92:95], v[64:67], a[112:115]
v_mfma_f32_16x16x32_bf16 a[116:119], v[92:95], v[68:71], a[116:119]
v_mfma_f32_16x16x32_bf16 a[120:123], v[92:95], v[72:75], a[120:123]
v_mfma_f32_16x16x32_bf16 a[124:127], v[92:95], v[76:79], a[124:127]
s_waitcnt lgkmcnt(0)
v_mfma_f32_16x16x32_bf16 a[0:3], v[32:35], v[0:3], a[0:3]
s_waitcnt vmcnt(12)
s_barrier
ds_read_b128 v[80:83], v136 offset:24576
s_add_u32 m0, s20, 16384
s_nop 0
v_mfma_f32_16x16x32_bf16 a[4:7], v[32:35], v[4:7], a[4:7]
ds_read_b64_tr_b16 v[48:49], v128 offset:49152
v_mfma_f32_16x16x32_bf16 a[8:11], v[32:35], v[8:11], a[8:11]
ds_read_b64_tr_b16 v[50:51], v128 offset:57344
v_mfma_f32_16x16x32_bf16 a[12:15], v[32:35], v[12:15], a[12:15]
ds_read_b64_tr_b16 v[52:53], v129 offset:49152
buffer_load_dwordx4 v141, s[4:7], s16 offen offset:0 sc1 lds
v_mfma_f32_16x16x32_bf16 a[16:19], v[32:35], v[16:19], a[16:19]
ds_read_b64_tr_b16 v[54:55], v129 offset:57344
v_mfma_f32_16x16x32_bf16 a[20:23], v[32:35], v[20:23], a[20:23]
ds_read_b64_tr_b16 v[56:57], v130 offset:49152
v_mfma_f32_16x16x32_bf16 a[24:27], v[32:35], v[24:27], a[24:27]
ds_read_b64_tr_b16 v[58:59], v130 offset:57344
buffer_load_dwordx4 v142, s[4:7], s16 offen offset:1024 sc1 lds
v_mfma_f32_16x16x32_bf16 a[28:31], v[32:35], v[28:31], a[28:31]
ds_read_b64_tr_b16 v[60:61], v131 offset:49152
v_mfma_f32_16x16x32_bf16 a[32:35], v[36:39], v[0:3], a[32:35]
ds_read_b64_tr_b16 v[62:63], v131 offset:57344
v_mfma_f32_16x16x32_bf16 a[36:39], v[36:39], v[4:7], a[36:39]
ds_read_b64_tr_b16 v[64:65], v132 offset:49152
s_add_u32 s16, s16, 1024
v_mfma_f32_16x16x32_bf16 a[40:43], v[36:39], v[8:11], a[40:43]
ds_read_b64_tr_b16 v[66:67], v132 offset:57344
v_mfma_f32_16x16x32_bf16 a[44:47], v[36:39], v[12:15], a[44:47]
ds_read_b64_tr_b16 v[68:69], v133 offset:49152
v_mfma_f32_16x16x32_bf16 a[48:51], v[36:39], v[16:19], a[48:51]
ds_read_b64_tr_b16 v[70:71], v133 offset:57344
s_add_u32 m0, s19, 32768
s_nop 0
v_mfma_f32_16x16x32_bf16 a[52:55], v[36:39], v[20:23], a[52:55]
ds_read_b64_tr_b16 v[72:73], v134 offset:49152
v_mfma_f32_16x16x32_bf16 a[56:59], v[36:39], v[24:27], a[56:59]
ds_read_b64_tr_b16 v[74:75], v134 offset:57344
v_mfma_f32_16x16x32_bf16 a[60:63], v[36:39], v[28:31], a[60:63]
ds_read_b64_tr_b16 v[76:77], v135 offset:49152
buffer_load_dwordx4 v137, s[8:11], s15 offen offset:0 lds
v_mfma_f32_16x16x32_bf16 a[64:67], v[40:43], v[0:3], a[64:67]
ds_read_b64_tr_b16 v[78:79], v135 offset:57344
v_mfma_f32_16x16x32_bf16 a[68:71], v[40:43], v[4:7], a[68:71]
ds_read_b128 v[84:87], v136 offset:25600
v_mfma_f32_16x16x32_bf16 a[72:75], v[40:43], v[8:11], a[72:75]
ds_read_b128 v[88:91], v136 offset:26624
buffer_load_dwordx4 v138, s[8:11], s15 offen offset:1024 lds
v_mfma_f32_16x16x32_bf16 a[76:79], v[40:43], v[12:15], a[76:79]
ds_read_b128 v[92:95], v136 offset:27648
v_mfma_f32_16x16x32_bf16 a[80:83], v[40:43], v[16:19], a[80:83]
v_mfma_f32_16x16x32_bf16 a[84:87], v[40:43], v[20:23], a[84:87]
buffer_load_dwordx4 v139, s[8:11], s15 offen offset:2048 lds
v_mfma_f32_16x16x32_bf16 a[88:91], v[40:43], v[24:27], a[88:91]
v_mfma_f32_16x16x32_bf16 a[92:95], v[40:43], v[28:31], a[92:95]
v_mfma_f32_16x16x32_bf16 a[96:99], v[44:47], v[0:3], a[96:99]
buffer_load_dwordx4 v140, s[8:11], s15 offen offset:3072 lds
v_mfma_f32_16x16x32_bf16 a[100:103], v[44:47], v[4:7], a[100:103]
v_mfma_f32_16x16x32_bf16 a[104:107], v[44:47], v[8:11], a[104:107]
v_mfma_f32_16x16x32_bf16 a[108:111], v[44:47], v[12:15], a[108:111]
s_add_u32 s15, s15, s17
v_mfma_f32_16x16x32_bf16 a[112:115], v[44:47], v[16:19], a[112:115]
v_mfma_f32_16x16x32_bf16 a[116:119], v[44:47], v[20:23], a[116:119]
v_mfma_f32_16x16x32_bf16 a[120:123], v[44:47], v[24:27], a[120:123]
v_mfma_f32_16x16x32_bf16 a[124:127], v[44:47], v[28:31], a[124:127]
s_waitcnt lgkmcnt(0)
v_mfma_f32_16x16x32_bf16 a[0:3], v[80:83], v[48:51], a[0:3]
s_waitcnt vmcnt(12)
s_barrier
ds_read_b128 v[32:35], v136 offset:0
s_add_u32 m0, s20, 24576
s_nop 0
v_mfma_f32_16x16x32_bf16 a[4:7], v[80:83], v[52:55], a[4:7]
ds_read_b64_tr_b16 v[0:1], v128 offset:0
v_mfma_f32_16x16x32_bf16 a[8:11], v[80:83], v[56:59], a[8:11]
ds_read_b64_tr_b16 v[2:3], v128 offset:8192
v_mfma_f32_16x16x32_bf16 a[12:15], v[80:83], v[60:63], a[12:15]
ds_read_b64_tr_b16 v[4:5], v129 offset:0
buffer_load_dwordx4 v141, s[4:7], s16 offen offset:0 sc1 lds
v_mfma_f32_16x16x32_bf16 a[16:19], v[80:83], v[64:67], a[16:19]
ds_read_b64_tr_b16 v[6:7], v129 offset:8192
v_mfma_f32_16x16x32_bf16 a[20:23], v[80:83], v[68:71], a[20:23]
ds_read_b64_tr_b16 v[8:9], v130 offset:0
v_mfma_f32_16x16x32_bf16 a[24:27], v[80:83], v[72:75], a[24:27]
ds_read_b64_tr_b16 v[10:11], v130 offset:8192
buffer_load_dwordx4 v142, s[4:7], s16 offen offset:1024 sc1 lds
v_mfma_f32_16x16x32_bf16 a[28:31], v[80:83], v[76:79], a[28:31]
ds_read_b64_tr_b16 v[12:13], v131 offset:0
v_mfma_f32_16x16x32_bf16 a[32:35], v[84:87], v[48:51], a[32:35]
ds_read_b64_tr_b16 v[14:15], v131 offset:8192
v_mfma_f32_16x16x32_bf16 a[36:39], v[84:87], v[52:55], a[36:39]
ds_read_b64_tr_b16 v[16:17], v132 offset:0
s_add_u32 s16, s16, 1024
v_mfma_f32_16x16x32_bf16 a[40:43], v[84:87], v[56:59], a[40:43]
ds_read_b64_tr_b16 v[18:19], v132 offset:8192
v_mfma_f32_16x16x32_bf16 a[44:47], v[84:87], v[60:63], a[44:47]
ds_read_b64_tr_b16 v[20:21], v133 offset:0
v_mfma_f32_16x16x32_bf16 a[48:51], v[84:87], v[64:67], a[48:51]
ds_read_b64_tr_b16 v[22:23], v133 offset:8192
s_add_u32 m0, s19, 49152
s_nop 0
v_mfma_f32_16x16x32_bf16 a[52:55], v[84:87], v[68:71], a[52:55]
ds_read_b64_tr_b16 v[24:25], v134 offset:0
v_mfma_f32_16x16x32_bf16 a[56:59], v[84:87], v[72:75], a[56:59]
ds_read_b64_tr_b16 v[26:27], v134 offset:8192
v_mfma_f32_16x16x32_bf16 a[60:63], v[84:87], v[76:79], a[60:63]
ds_read_b64_tr_b16 v[28:29], v135 offset:0
buffer_load_dwordx4 v137, s[8:11], s15 offen offset:0 lds
v_mfma_f32_16x16x32_bf16 a[64:67], v[88:91], v[48:51], a[64:67]
ds_read_b64_tr_b16 v[30:31], v135 offset:8192
v_mfma_f32_16x16x32_bf16 a[68:71], v[88:91], v[52:55], a[68:71]
ds_read_b128 v[36:39], v136 offset:1024
v_mfma_f32_16x16x32_bf16 a[72:75], v[88:91], v[56:59], a[72:75]
ds_read_b128 v[40:43], v136 offset:2048
buffer_load_dwordx4 v138, s[8:11], s15 offen offset:1024 lds
v_mfma_f32_16x16x32_bf16 a[76:79], v[88:91], v[60:63], a[76:79]
ds_read_b128 v[44:47], v136 offset:3072
v_mfma_f32_16x16x32_bf16 a[80:83], v[88:91], v[64:67], a[80:83]
v_mfma_f32_16x16x32_bf16 a[84:87], v[88:91], v[68:71], a[84:87]
buffer_load_dwordx4 v139, s[8:11], s15 offen offset:2048 lds
v_mfma_f32_16x16x32_bf16 a[88:91], v[88:91], v[72:75], a[88:91]
v_mfma_f32_16x16x32_bf16 a[92:95], v[88:91], v[76:79], a[92:95]
v_mfma_f32_16x16x32_bf16 a[96:99], v[92:95], v[48:51], a[96:99]
buffer_load_dwordx4 v140, s[8:11], s15 offen offset:3072 lds
v_mfma_f32_16x16x32_bf16 a[100:103], v[92:95], v[52:55], a[100:103]
v_mfma_f32_16x16x32_bf16 a[104:107], v[92:95], v[56:59], a[104:107]
v_mfma_f32_16x16x32_bf16 a[108:111], v[92:95], v[60:63], a[108:111]
s_add_u32 s15, s15, s17
v_mfma_f32_16x16x32_bf16 a[112:115], v[92:95], v[64:67], a[112:115]
v_mfma_f32_16x16x32_bf16 a[116:119], v[92:95], v[68:71], a[116:119]
v_mfma_f32_16x16x32_bf16 a[120:123], v[92:95], v[72:75], a[120:123]
v_mfma_f32_16x16x32_bf16 a[124:127], v[92:95], v[76:79], a[124:127]
s_sub_u32 s18, s18, 1
s_cmp_eq_u32 s18, s55
s_cbranch_scc1 main_kernel_w_c1_v_ev
s_cmp_lg_u32 s18, 0
s_cbranch_scc1 main_kernel_w_c1_v_loop
s_cmp_lg_u32 s73, -1
s_cbranch_scc1 main_kernel_w_epn
s_waitcnt lgkmcnt(0)
v_mfma_f32_16x16x32_bf16 a[0:3], v[32:35], v[0:3], a[0:3]
s_waitcnt vmcnt(12)
s_barrier
ds_read_b128 v[80:83], v136 offset:8192
s_add_u32 m0, s20, 0
s_nop 0
s_add_u32 s32, s23, 1
s_bitcmp0_b32 s32, 2
s_cselect_b32 s34, 7, 2
s_cselect_b32 s35, 2, 4
s_lshl_b32 s59, s23, 13
s_add_u32 s59, s59, 0x8404000
v_mfma_f32_16x16x32_bf16 a[4:7], v[32:35], v[4:7], a[4:7]
ds_read_b64_tr_b16 v[48:49], v128 offset:16384
v_lshrrev_b32 v253, 3, v250
v_add_lshl_u32 v253, s24, v253, 9
v_mfma_f32_16x16x32_bf16 a[8:11], v[32:35], v[8:11], a[8:11]
ds_read_b64_tr_b16 v[50:51], v128 offset:24576
v_and_b32 v254, 3, v250
v_lshl_add_u32 v253, v254, s34, v253
v_mfma_f32_16x16x32_bf16 a[12:15], v[32:35], v[12:15], a[12:15]
ds_read_b64_tr_b16 v[52:53], v129 offset:16384
buffer_load_dwordx4 v141, s[4:7], s16 offen offset:0 sc1 lds
v_bfe_u32 v254, v250, 2, 1
v_add_u32 v254, s25, v254
v_mfma_f32_16x16x32_bf16 a[16:19], v[32:35], v[16:19], a[16:19]
ds_read_b64_tr_b16 v[54:55], v129 offset:24576
v_lshl_add_u32 v248, v254, s35, v253
s_lshl_b32 s0, 4, s54
v_mfma_f32_16x16x32_bf16 a[20:23], v[32:35], v[20:23], a[20:23]
ds_read_b64_tr_b16 v[56:57], v130 offset:16384
v_readfirstlane_b32 s28, v249
s_nop 1
v_cmp_ge_u32 vcc, s28, v229
v_mfma_f32_16x16x32_bf16 a[24:27], v[32:35], v[24:27], a[24:27]
ds_read_b64_tr_b16 v[58:59], v130 offset:24576
buffer_load_dwordx4 v142, s[4:7], s16 offen offset:1024 sc1 lds
s_nop 1
s_bcnt1_i32_b64 s32, vcc
v_mfma_f32_16x16x32_bf16 a[28:31], v[32:35], v[28:31], a[28:31]
ds_read_b64_tr_b16 v[60:61], v131 offset:16384
s_sub_u32 s32, s32, 1
v_readlane_b32 s36, v230, s32
v_mfma_f32_16x16x32_bf16 a[32:35], v[36:39], v[0:3], a[32:35]
ds_read_b64_tr_b16 v[62:63], v131 offset:24576
s_nop 1
s_and_b32 s32, s36, 0x7ff
v_mfma_f32_16x16x32_bf16 a[36:39], v[36:39], v[4:7], a[36:39]
ds_read_b64_tr_b16 v[64:65], v132 offset:16384
s_add_u32 s16, s16, 1024
s_sub_u32 s28, s28, s32
s_bfe_u32 s32, s36, 0x3001a
v_mfma_f32_16x16x32_bf16 a[40:43], v[36:39], v[8:11], a[40:43]
ds_read_b64_tr_b16 v[66:67], v132 offset:24576
s_lshr_b32 s25, s28, s32
s_lshl_b32 s33, s25, s32
s_sub_u32 s24, s28, s33
v_mfma_f32_16x16x32_bf16 a[44:47], v[36:39], v[12:15], a[44:47]
ds_read_b64_tr_b16 v[68:69], v133 offset:16384
s_bfe_u32 s34, s36, 0x1001d
s_lshl_b32 s24, s24, s34
v_mfma_f32_16x16x32_bf16 a[48:51], v[36:39], v[16:19], a[48:51]
ds_read_b64_tr_b16 v[70:71], v133 offset:24576
s_add_u32 m0, s19, 0
s_nop 0
s_bfe_u32 s35, s36, 0x1001e
s_lshl_b32 s25, s25, s35
v_mfma_f32_16x16x32_bf16 a[52:55], v[36:39], v[20:23], a[52:55]
ds_read_b64_tr_b16 v[72:73], v134 offset:16384
s_bfe_u32 s32, s36, 0x40011
s_add_u32 s24, s24, s32
v_mfma_f32_16x16x32_bf16 a[56:59], v[36:39], v[24:27], a[56:59]
ds_read_b64_tr_b16 v[74:75], v134 offset:24576
s_bfe_u32 s32, s36, 0x50015
s_add_u32 s25, s25, s32
v_mfma_f32_16x16x32_bf16 a[60:63], v[36:39], v[28:31], a[60:63]
ds_read_b64_tr_b16 v[76:77], v135 offset:16384
buffer_load_dwordx4 v137, s[8:11], s15 offen offset:0 lds
s_bfe_u32 s23, s36, 0x4000b
s_bfe_u32 s36, s36, 0x6000b
s_lshl_b32 s32, s24, 8
v_mfma_f32_16x16x32_bf16 a[64:67], v[40:43], v[0:3], a[64:67]
ds_read_b64_tr_b16 v[78:79], v135 offset:24576
s_or_b32 s36, s36, s32
s_lshl_b32 s32, s25, 16
v_mfma_f32_16x16x32_bf16 a[68:71], v[40:43], v[4:7], a[68:71]
ds_read_b128 v[84:87], v136 offset:9216
s_or_b32 s36, s36, s32
s_cmp_eq_u32 s23, 4
s_cselect_b32 s32, 1, 0
v_mfma_f32_16x16x32_bf16 a[72:75], v[40:43], v[8:11], a[72:75]
ds_read_b128 v[88:91], v136 offset:10240
buffer_load_dwordx4 v138, s[8:11], s15 offen offset:1024 lds
s_sub_u32 s48, s24, s32
s_max_i32 s48, s48, 0
v_mfma_f32_16x16x32_bf16 a[76:79], v[40:43], v[12:15], a[76:79]
ds_read_b128 v[92:95], v136 offset:11264
s_add_u32 s49, s24, s34
s_add_u32 s49, s49, s32
v_mfma_f32_16x16x32_bf16 a[80:83], v[40:43], v[16:19], a[80:83]
s_min_u32 s49, s49, 15
s_cmp_eq_u32 s23, 6
s_cselect_b32 s51, 3, 7
s_cmp_eq_u32 s23, 7
s_cselect_b32 s51, 27, s51
s_cselect_b32 s50, 5, 4
v_mfma_f32_16x16x32_bf16 a[84:87], v[40:43], v[20:23], a[84:87]
buffer_load_dwordx4 v139, s[8:11], s15 offen offset:2048 lds
s_add_u32 s33, s25, s35
s_lshl_b32 s34, s24, 9
v_mfma_f32_16x16x32_bf16 a[88:91], v[40:43], v[24:27], a[88:91]
s_cmp_eq_u32 s23, 8
s_cselect_b32 s51, 0, s51
s_cselect_b32 s48, s25, s48
s_cselect_b32 s49, s33, s49
s_cmp_eq_u32 s23, 8
s_cselect_b32 s63, 2, 9
s_cselect_b32 s61, 0, 0x7f000000
s_cselect_b32 s34, s34, 0
v_mfma_f32_16x16x32_bf16 a[92:95], v[40:43], v[28:31], a[92:95]
v_lshrrev_b32 v228, s50, v250
v_lshlrev_b32 v254, s50, v228
v_mfma_f32_16x16x32_bf16 a[96:99], v[44:47], v[0:3], a[96:99]
buffer_load_dwordx4 v140, s[8:11], s15 offen offset:3072 lds
v_sub_u32 v254, v250, v254
s_cmp_lt_u32 s23, 4
s_cselect_b32 s39, 10, s23
v_mfma_f32_16x16x32_bf16 a[100:103], v[44:47], v[4:7], a[100:103]
v_min_u32 v254, s51, v254
s_lshl_b32 s39, s39, 13
s_cmp_eq_u32 s23, 3
s_cselect_b32 s34, 4, s34
v_mfma_f32_16x16x32_bf16 a[104:107], v[44:47], v[8:11], a[104:107]
v_add_u32 v228, s48, v228
s_add_u32 s39, s39, s34
v_mfma_f32_16x16x32_bf16 a[108:111], v[44:47], v[12:15], a[108:111]
s_add_u32 s15, s15, s17
s_add_u32 s39, s39, 0x8402000
v_min_u32 v228, s49, v228
v_mfma_f32_16x16x32_bf16 a[112:115], v[44:47], v[16:19], a[112:115]
s_lshl_b32 s60, s24, 10
s_add_u32 s60, s60, 0x8400000
v_mfma_f32_16x16x32_bf16 a[116:119], v[44:47], v[20:23], a[116:119]
v_lshlrev_b32 v228, s63, v228
v_lshl_add_u32 v228, v254, 4, v228
v_mfma_f32_16x16x32_bf16 a[120:123], v[44:47], v[24:27], a[120:123]
v_or_b32 v146, s61, v251
s_mov_b64 exec, s[100:101]
buffer_load_dword v231, v228, s[4:7], s39 offen sc1
buffer_load_dwordx4 v[232:235], v146, s[4:7], s60 offen sc1
s_mov_b64 exec, -1
v_mfma_f32_16x16x32_bf16 a[124:127], v[44:47], v[28:31], a[124:127]
s_waitcnt lgkmcnt(0)
v_mfma_f32_16x16x32_bf16 a[0:3], v[80:83], v[48:51], a[0:3]
s_waitcnt vmcnt(12)
s_barrier
ds_read_b128 v[32:35], v136 offset:16384
s_add_u32 m0, s20, 8192
s_nop 0
s_mov_b32 s1, s21
v_mfma_f32_16x16x32_bf16 a[4:7], v[80:83], v[52:55], a[4:7]
ds_read_b64_tr_b16 v[0:1], v128 offset:32768
v_mfma_f32_16x16x32_bf16 a[8:11], v[80:83], v[56:59], a[8:11]
ds_read_b64_tr_b16 v[2:3], v128 offset:40960
v_mfma_f32_16x16x32_bf16 a[12:15], v[80:83], v[60:63], a[12:15]
ds_read_b64_tr_b16 v[4:5], v129 offset:32768
buffer_load_dwordx4 v141, s[4:7], s16 offen offset:0 sc1 lds
v_mfma_f32_16x16x32_bf16 a[16:19], v[80:83], v[64:67], a[16:19]
ds_read_b64_tr_b16 v[6:7], v129 offset:40960
v_mfma_f32_16x16x32_bf16 a[20:23], v[80:83], v[68:71], a[20:23]
ds_read_b64_tr_b16 v[8:9], v130 offset:32768
s_mov_b32 s2, s22
v_mfma_f32_16x16x32_bf16 a[24:27], v[80:83], v[72:75], a[24:27]
ds_read_b64_tr_b16 v[10:11], v130 offset:40960
buffer_load_dwordx4 v142, s[4:7], s16 offen offset:1024 sc1 lds
v_mfma_f32_16x16x32_bf16 a[28:31], v[80:83], v[76:79], a[28:31]
ds_read_b64_tr_b16 v[12:13], v131 offset:32768
v_mfma_f32_16x16x32_bf16 a[32:35], v[84:87], v[48:51], a[32:35]
ds_read_b64_tr_b16 v[14:15], v131 offset:40960
v_mfma_f32_16x16x32_bf16 a[36:39], v[84:87], v[52:55], a[36:39]
ds_read_b64_tr_b16 v[16:17], v132 offset:32768
s_add_u32 s16, s16, 1024
v_mfma_f32_16x16x32_bf16 a[40:43], v[84:87], v[56:59], a[40:43]
ds_read_b64_tr_b16 v[18:19], v132 offset:40960
s_mov_b32 s3, s26
v_mfma_f32_16x16x32_bf16 a[44:47], v[84:87], v[60:63], a[44:47]
ds_read_b64_tr_b16 v[20:21], v133 offset:32768
v_mfma_f32_16x16x32_bf16 a[48:51], v[84:87], v[64:67], a[48:51]
ds_read_b64_tr_b16 v[22:23], v133 offset:40960
s_add_u32 m0, s19, 16384
s_nop 0
v_mfma_f32_16x16x32_bf16 a[52:55], v[84:87], v[68:71], a[52:55]
ds_read_b64_tr_b16 v[24:25], v134 offset:32768
v_mfma_f32_16x16x32_bf16 a[56:59], v[84:87], v[72:75], a[56:59]
ds_read_b64_tr_b16 v[26:27], v134 offset:40960
v_mfma_f32_16x16x32_bf16 a[60:63], v[84:87], v[76:79], a[60:63]
ds_read_b64_tr_b16 v[28:29], v135 offset:32768
buffer_load_dwordx4 v137, s[8:11], s15 offen offset:0 lds
s_mov_b32 s56, s57
v_mfma_f32_16x16x32_bf16 a[64:67], v[88:91], v[48:51], a[64:67]
ds_read_b64_tr_b16 v[30:31], v135 offset:40960
v_mfma_f32_16x16x32_bf16 a[68:71], v[88:91], v[52:55], a[68:71]
ds_read_b128 v[36:39], v136 offset:17408
v_mfma_f32_16x16x32_bf16 a[72:75], v[88:91], v[56:59], a[72:75]
ds_read_b128 v[40:43], v136 offset:18432
buffer_load_dwordx4 v138, s[8:11], s15 offen offset:1024 lds
v_mfma_f32_16x16x32_bf16 a[76:79], v[88:91], v[60:63], a[76:79]
ds_read_b128 v[44:47], v136 offset:19456
v_mfma_f32_16x16x32_bf16 a[80:83], v[88:91], v[64:67], a[80:83]
v_mov_b32 v145, v252
v_mfma_f32_16x16x32_bf16 a[84:87], v[88:91], v[68:71], a[84:87]
buffer_load_dwordx4 v139, s[8:11], s15 offen offset:2048 lds
v_mfma_f32_16x16x32_bf16 a[88:91], v[88:91], v[72:75], a[88:91]
v_mfma_f32_16x16x32_bf16 a[92:95], v[88:91], v[76:79], a[92:95]
v_mfma_f32_16x16x32_bf16 a[96:99], v[92:95], v[48:51], a[96:99]
buffer_load_dwordx4 v140, s[8:11], s15 offen offset:3072 lds
v_mfma_f32_16x16x32_bf16 a[100:103], v[92:95], v[52:55], a[100:103]
v_mov_b32 v255, 131072
v_mfma_f32_16x16x32_bf16 a[104:107], v[92:95], v[56:59], a[104:107]
v_mfma_f32_16x16x32_bf16 a[108:111], v[92:95], v[60:63], a[108:111]
s_add_u32 s15, s15, s17
v_mfma_f32_16x16x32_bf16 a[112:115], v[92:95], v[64:67], a[112:115]
v_mfma_f32_16x16x32_bf16 a[116:119], v[92:95], v[68:71], a[116:119]
v_mfma_f32_16x16x32_bf16 a[120:123], v[92:95], v[72:75], a[120:123]
v_mfma_f32_16x16x32_bf16 a[124:127], v[92:95], v[76:79], a[124:127]
s_waitcnt lgkmcnt(0)
v_mfma_f32_16x16x32_bf16 a[0:3], v[32:35], v[0:3], a[0:3]
s_waitcnt vmcnt(12)
s_barrier
ds_read_b128 v[80:83], v136 offset:24576
s_add_u32 m0, s20, 16384
s_nop 0
v_mfma_f32_16x16x32_bf16 a[4:7], v[32:35], v[4:7], a[4:7]
ds_read_b64_tr_b16 v[48:49], v128 offset:49152
v_mfma_f32_16x16x32_bf16 a[8:11], v[32:35], v[8:11], a[8:11]
ds_read_b64_tr_b16 v[50:51], v128 offset:57344
v_mfma_f32_16x16x32_bf16 a[12:15], v[32:35], v[12:15], a[12:15]
ds_read_b64_tr_b16 v[52:53], v129 offset:49152
buffer_load_dwordx4 v141, s[4:7], s16 offen offset:0 sc1 lds
v_mfma_f32_16x16x32_bf16 a[16:19], v[32:35], v[16:19], a[16:19]
ds_read_b64_tr_b16 v[54:55], v129 offset:57344
v_mfma_f32_16x16x32_bf16 a[20:23], v[32:35], v[20:23], a[20:23]
ds_read_b64_tr_b16 v[56:57], v130 offset:49152
v_mfma_f32_16x16x32_bf16 a[24:27], v[32:35], v[24:27], a[24:27]
ds_read_b64_tr_b16 v[58:59], v130 offset:57344
buffer_load_dwordx4 v142, s[4:7], s16 offen offset:1024 sc1 lds
v_mfma_f32_16x16x32_bf16 a[28:31], v[32:35], v[28:31], a[28:31]
ds_read_b64_tr_b16 v[60:61], v131 offset:49152
v_mfma_f32_16x16x32_bf16 a[32:35], v[36:39], v[0:3], a[32:35]
ds_read_b64_tr_b16 v[62:63], v131 offset:57344
v_mfma_f32_16x16x32_bf16 a[36:39], v[36:39], v[4:7], a[36:39]
ds_read_b64_tr_b16 v[64:65], v132 offset:49152
s_add_u32 s16, s16, 1024
v_mfma_f32_16x16x32_bf16 a[40:43], v[36:39], v[8:11], a[40:43]
ds_read_b64_tr_b16 v[66:67], v132 offset:57344
v_mfma_f32_16x16x32_bf16 a[44:47], v[36:39], v[12:15], a[44:47]
ds_read_b64_tr_b16 v[68:69], v133 offset:49152
v_mfma_f32_16x16x32_bf16 a[48:51], v[36:39], v[16:19], a[48:51]
ds_read_b64_tr_b16 v[70:71], v133 offset:57344
s_add_u32 m0, s19, 32768
s_nop 0
v_mfma_f32_16x16x32_bf16 a[52:55], v[36:39], v[20:23], a[52:55]
ds_read_b64_tr_b16 v[72:73], v134 offset:49152
v_mfma_f32_16x16x32_bf16 a[56:59], v[36:39], v[24:27], a[56:59]
ds_read_b64_tr_b16 v[74:75], v134 offset:57344
v_mfma_f32_16x16x32_bf16 a[60:63], v[36:39], v[28:31], a[60:63]
ds_read_b64_tr_b16 v[76:77], v135 offset:49152
buffer_load_dwordx4 v137, s[8:11], s15 offen offset:0 lds
v_mfma_f32_16x16x32_bf16 a[64:67], v[40:43], v[0:3], a[64:67]
ds_read_b64_tr_b16 v[78:79], v135 offset:57344
v_mfma_f32_16x16x32_bf16 a[68:71], v[40:43], v[4:7], a[68:71]
ds_read_b128 v[84:87], v136 offset:25600
v_mfma_f32_16x16x32_bf16 a[72:75], v[40:43], v[8:11], a[72:75]
ds_read_b128 v[88:91], v136 offset:26624
buffer_load_dwordx4 v138, s[8:11], s15 offen offset:1024 lds
v_mfma_f32_16x16x32_bf16 a[76:79], v[40:43], v[12:15], a[76:79]
ds_read_b128 v[92:95], v136 offset:27648
v_mfma_f32_16x16x32_bf16 a[80:83], v[40:43], v[16:19], a[80:83]
s_waitcnt vmcnt(10)
v_mfma_f32_16x16x32_bf16 a[84:87], v[40:43], v[20:23], a[84:87]
buffer_load_dwordx4 v139, s[8:11], s15 offen offset:2048 lds
v_min3_u32 v253, v232, v233, v234
v_mfma_f32_16x16x32_bf16 a[88:91], v[40:43], v[24:27], a[88:91]
v_min_u32 v253, v253, v235
v_mfma_f32_16x16x32_bf16 a[92:95], v[40:43], v[28:31], a[92:95]
v_or_b32 v253, s61, v253
v_mfma_f32_16x16x32_bf16 a[96:99], v[44:47], v[0:3], a[96:99]
buffer_load_dwordx4 v140, s[8:11], s15 offen offset:3072 lds
v_min_u32 v253, v253, v231
v_mfma_f32_16x16x32_bf16 a[100:103], v[44:47], v[4:7], a[100:103]
v_cmp_eq_u32 vcc, 0, v253
v_mfma_f32_16x16x32_bf16 a[104:107], v[44:47], v[8:11], a[104:107]
s_nop 1
v_mfma_f32_16x16x32_bf16 a[108:111], v[44:47], v[12:15], a[108:111]
s_add_u32 s15, s15, s17
s_cmp_eq_u64 vcc, 0
s_cselect_b32 s32, s36, -4
v_mfma_f32_16x16x32_bf16 a[112:115], v[44:47], v[16:19], a[112:115]
s_bitcmp1_b32 0x1df, s23
s_cselect_b32 s32, s32, -4
v_mfma_f32_16x16x32_bf16 a[116:119], v[44:47], v[20:23], a[116:119]
v_mov_b32 v254, s32
v_mfma_f32_16x16x32_bf16 a[120:123], v[44:47], v[24:27], a[120:123]
s_mov_b64 exec, s[100:101]
ds_write_b32 v255, v254
s_mov_b64 exec, -1
v_mfma_f32_16x16x32_bf16 a[124:127], v[44:47], v[28:31], a[124:127]
s_waitcnt lgkmcnt(0)
v_mfma_f32_16x16x32_bf16 a[0:3], v[80:83], v[48:51], a[0:3]
s_waitcnt vmcnt(12)
s_barrier
ds_read_b128 v[32:35], v136 offset:0
s_add_u32 m0, s20, 24576
s_nop 0
ds_read_b32 v254, v255
v_mfma_f32_16x16x32_bf16 a[4:7], v[80:83], v[52:55], a[4:7]
ds_read_b64_tr_b16 v[0:1], v128 offset:0
v_mfma_f32_16x16x32_bf16 a[8:11], v[80:83], v[56:59], a[8:11]
ds_read_b64_tr_b16 v[2:3], v128 offset:8192
v_mfma_f32_16x16x32_bf16 a[12:15], v[80:83], v[60:63], a[12:15]
ds_read_b64_tr_b16 v[4:5], v129 offset:0
buffer_load_dwordx4 v141, s[4:7], s16 offen offset:0 sc1 lds
v_mfma_f32_16x16x32_bf16 a[16:19], v[80:83], v[64:67], a[16:19]
ds_read_b64_tr_b16 v[6:7], v129 offset:8192
v_mfma_f32_16x16x32_bf16 a[20:23], v[80:83], v[68:71], a[20:23]
ds_read_b64_tr_b16 v[8:9], v130 offset:0
v_mfma_f32_16x16x32_bf16 a[24:27], v[80:83], v[72:75], a[24:27]
ds_read_b64_tr_b16 v[10:11], v130 offset:8192
buffer_load_dwordx4 v142, s[4:7], s16 offen offset:1024 sc1 lds
v_mfma_f32_16x16x32_bf16 a[28:31], v[80:83], v[76:79], a[28:31]
ds_read_b64_tr_b16 v[12:13], v131 offset:0
v_mfma_f32_16x16x32_bf16 a[32:35], v[84:87], v[48:51], a[32:35]
ds_read_b64_tr_b16 v[14:15], v131 offset:8192
v_mfma_f32_16x16x32_bf16 a[36:39], v[84:87], v[52:55], a[36:39]
ds_read_b64_tr_b16 v[16:17], v132 offset:0
s_add_u32 s16, s16, 1024
v_mfma_f32_16x16x32_bf16 a[40:43], v[84:87], v[56:59], a[40:43]
ds_read_b64_tr_b16 v[18:19], v132 offset:8192
v_mfma_f32_16x16x32_bf16 a[44:47], v[84:87], v[60:63], a[44:47]
ds_read_b64_tr_b16 v[20:21], v133 offset:0
v_mfma_f32_16x16x32_bf16 a[48:51], v[84:87], v[64:67], a[48:51]
ds_read_b64_tr_b16 v[22:23], v133 offset:8192
s_add_u32 m0, s19, 49152
s_nop 0
v_mfma_f32_16x16x32_bf16 a[52:55], v[84:87], v[68:71], a[52:55]
ds_read_b64_tr_b16 v[24:25], v134 offset:0
v_mfma_f32_16x16x32_bf16 a[56:59], v[84:87], v[72:75], a[56:59]
ds_read_b64_tr_b16 v[26:27], v134 offset:8192
v_mfma_f32_16x16x32_bf16 a[60:63], v[84:87], v[76:79], a[60:63]
ds_read_b64_tr_b16 v[28:29], v135 offset:0
buffer_load_dwordx4 v137, s[8:11], s15 offen offset:0 lds
v_mfma_f32_16x16x32_bf16 a[64:67], v[88:91], v[48:51], a[64:67]
ds_read_b64_tr_b16 v[30:31], v135 offset:8192
v_mfma_f32_16x16x32_bf16 a[68:71], v[88:91], v[52:55], a[68:71]
ds_read_b128 v[36:39], v136 offset:1024
v_mfma_f32_16x16x32_bf16 a[72:75], v[88:91], v[56:59], a[72:75]
ds_read_b128 v[40:43], v136 offset:2048
buffer_load_dwordx4 v138, s[8:11], s15 offen offset:1024 lds
v_mfma_f32_16x16x32_bf16 a[76:79], v[88:91], v[60:63], a[76:79]
ds_read_b128 v[44:47], v136 offset:3072
v_mfma_f32_16x16x32_bf16 a[80:83], v[88:91], v[64:67], a[80:83]
s_waitcnt lgkmcnt(8)
v_mfma_f32_16x16x32_bf16 a[84:87], v[88:91], v[68:71], a[84:87]
buffer_load_dwordx4 v139, s[8:11], s15 offen offset:2048 lds
v_readfirstlane_b32 s62, v254
v_mfma_f32_16x16x32_bf16 a[88:91], v[88:91], v[72:75], a[88:91]
v_mfma_f32_16x16x32_bf16 a[92:95], v[88:91], v[76:79], a[92:95]
s_nop 1
v_mfma_f32_16x16x32_bf16 a[96:99], v[92:95], v[48:51], a[96:99]
buffer_load_dwordx4 v140, s[8:11], s15 offen offset:3072 lds
s_and_b32 s23, s62, 15
v_mfma_f32_16x16x32_bf16 a[100:103], v[92:95], v[52:55], a[100:103]
v_mfma_f32_16x16x32_bf16 a[104:107], v[92:95], v[56:59], a[104:107]
s_bfe_u32 s54, s62, 0x20004
v_mfma_f32_16x16x32_bf16 a[108:111], v[92:95], v[60:63], a[108:111]
s_add_u32 s15, s15, s17
s_bfe_u32 s24, s62, 0x80008
v_mfma_f32_16x16x32_bf16 a[112:115], v[92:95], v[64:67], a[112:115]
v_mfma_f32_16x16x32_bf16 a[116:119], v[92:95], v[68:71], a[116:119]
s_lshr_b32 s25, s62, 16
v_mfma_f32_16x16x32_bf16 a[120:123], v[92:95], v[72:75], a[120:123]
v_mfma_f32_16x16x32_bf16 a[124:127], v[92:95], v[76:79], a[124:127]
s_cmp_eq_u32 s54, 1
s_cselect_b32 s73, 3, -1
s_cbranch_scc1 main_kernel_w_c1_task
s_waitcnt lgkmcnt(0)
v_mfma_f32_16x16x32_bf16 a[0:3], v[32:35], v[0:3], a[0:3]
s_waitcnt vmcnt(12)
s_barrier
ds_read_b128 v[80:83], v136 offset:8192
v_mfma_f32_16x16x32_bf16 a[4:7], v[32:35], v[4:7], a[4:7]
ds_read_b64_tr_b16 v[48:49], v128 offset:16384
v_mfma_f32_16x16x32_bf16 a[8:11], v[32:35], v[8:11], a[8:11]
ds_read_b64_tr_b16 v[50:51], v128 offset:24576
v_mfma_f32_16x16x32_bf16 a[12:15], v[32:35], v[12:15], a[12:15]
ds_read_b64_tr_b16 v[52:53], v129 offset:16384
v_mfma_f32_16x16x32_bf16 a[16:19], v[32:35], v[16:19], a[16:19]
ds_read_b64_tr_b16 v[54:55], v129 offset:24576
v_mfma_f32_16x16x32_bf16 a[20:23], v[32:35], v[20:23], a[20:23]
ds_read_b64_tr_b16 v[56:57], v130 offset:16384
v_mfma_f32_16x16x32_bf16 a[24:27], v[32:35], v[24:27], a[24:27]
ds_read_b64_tr_b16 v[58:59], v130 offset:24576
v_mfma_f32_16x16x32_bf16 a[28:31], v[32:35], v[28:31], a[28:31]
ds_read_b64_tr_b16 v[60:61], v131 offset:16384
v_mfma_f32_16x16x32_bf16 a[32:35], v[36:39], v[0:3], a[32:35]
ds_read_b64_tr_b16 v[62:63], v131 offset:24576
v_mfma_f32_16x16x32_bf16 a[36:39], v[36:39], v[4:7], a[36:39]
ds_read_b64_tr_b16 v[64:65], v132 offset:16384
v_mfma_f32_16x16x32_bf16 a[40:43], v[36:39], v[8:11], a[40:43]
ds_read_b64_tr_b16 v[66:67], v132 offset:24576
v_mfma_f32_16x16x32_bf16 a[44:47], v[36:39], v[12:15], a[44:47]
ds_read_b64_tr_b16 v[68:69], v133 offset:16384
v_mfma_f32_16x16x32_bf16 a[48:51], v[36:39], v[16:19], a[48:51]
ds_read_b64_tr_b16 v[70:71], v133 offset:24576
v_mfma_f32_16x16x32_bf16 a[52:55], v[36:39], v[20:23], a[52:55]
ds_read_b64_tr_b16 v[72:73], v134 offset:16384
v_mfma_f32_16x16x32_bf16 a[56:59], v[36:39], v[24:27], a[56:59]
ds_read_b64_tr_b16 v[74:75], v134 offset:24576
v_mfma_f32_16x16x32_bf16 a[60:63], v[36:39], v[28:31], a[60:63]
ds_read_b64_tr_b16 v[76:77], v135 offset:16384
v_mfma_f32_16x16x32_bf16 a[64:67], v[40:43], v[0:3], a[64:67]
ds_read_b64_tr_b16 v[78:79], v135 offset:24576
v_mfma_f32_16x16x32_bf16 a[68:71], v[40:43], v[4:7], a[68:71]
ds_read_b128 v[84:87], v136 offset:9216
v_mfma_f32_16x16x32_bf16 a[72:75], v[40:43], v[8:11], a[72:75]
ds_read_b128 v[88:91], v136 offset:10240
v_mfma_f32_16x16x32_bf16 a[76:79], v[40:43], v[12:15], a[76:79]
ds_read_b128 v[92:95], v136 offset:11264
v_mfma_f32_16x16x32_bf16 a[80:83], v[40:43], v[16:19], a[80:83]
v_mfma_f32_16x16x32_bf16 a[84:87], v[40:43], v[20:23], a[84:87]
v_mfma_f32_16x16x32_bf16 a[88:91], v[40:43], v[24:27], a[88:91]
v_mfma_f32_16x16x32_bf16 a[92:95], v[40:43], v[28:31], a[92:95]
v_mfma_f32_16x16x32_bf16 a[96:99], v[44:47], v[0:3], a[96:99]
v_mfma_f32_16x16x32_bf16 a[100:103], v[44:47], v[4:7], a[100:103]
v_mfma_f32_16x16x32_bf16 a[104:107], v[44:47], v[8:11], a[104:107]
v_mfma_f32_16x16x32_bf16 a[108:111], v[44:47], v[12:15], a[108:111]
v_mfma_f32_16x16x32_bf16 a[112:115], v[44:47], v[16:19], a[112:115]
v_mfma_f32_16x16x32_bf16 a[116:119], v[44:47], v[20:23], a[116:119]
v_mfma_f32_16x16x32_bf16 a[120:123], v[44:47], v[24:27], a[120:123]
v_mfma_f32_16x16x32_bf16 a[124:127], v[44:47], v[28:31], a[124:127]
s_waitcnt lgkmcnt(0)
v_mfma_f32_16x16x32_bf16 a[0:3], v[80:83], v[48:51], a[0:3]
s_waitcnt vmcnt(6)
s_barrier
ds_read_b128 v[32:35], v136 offset:16384
v_mfma_f32_16x16x32_bf16 a[4:7], v[80:83], v[52:55], a[4:7]
ds_read_b64_tr_b16 v[0:1], v128 offset:32768
v_mfma_f32_16x16x32_bf16 a[8:11], v[80:83], v[56:59], a[8:11]
ds_read_b64_tr_b16 v[2:3], v128 offset:40960
v_mfma_f32_16x16x32_bf16 a[12:15], v[80:83], v[60:63], a[12:15]
ds_read_b64_tr_b16 v[4:5], v129 offset:32768
v_mfma_f32_16x16x32_bf16 a[16:19], v[80:83], v[64:67], a[16:19]
ds_read_b64_tr_b16 v[6:7], v129 offset:40960
v_mfma_f32_16x16x32_bf16 a[20:23], v[80:83], v[68:71], a[20:23]
ds_read_b64_tr_b16 v[8:9], v130 offset:32768
v_mfma_f32_16x16x32_bf16 a[24:27], v[80:83], v[72:75], a[24:27]
ds_read_b64_tr_b16 v[10:11], v130 offset:40960
v_mfma_f32_16x16x32_bf16 a[28:31], v[80:83], v[76:79], a[28:31]
ds_read_b64_tr_b16 v[12:13], v131 offset:32768
v_mfma_f32_16x16x32_bf16 a[32:35], v[84:87], v[48:51], a[32:35]
ds_read_b64_tr_b16 v[14:15], v131 offset:40960
v_mfma_f32_16x16x32_bf16 a[36:39], v[84:87], v[52:55], a[36:39]
ds_read_b64_tr_b16 v[16:17], v132 offset:32768
v_mfma_f32_16x16x32_bf16 a[40:43], v[84:87], v[56:59], a[40:43]
ds_read_b64_tr_b16 v[18:19], v132 offset:40960
v_mfma_f32_16x16x32_bf16 a[44:47], v[84:87], v[60:63], a[44:47]
ds_read_b64_tr_b16 v[20:21], v133 offset:32768
v_mfma_f32_16x16x32_bf16 a[48:51], v[84:87], v[64:67], a[48:51]
ds_read_b64_tr_b16 v[22:23], v133 offset:40960
v_mfma_f32_16x16x32_bf16 a[52:55], v[84:87], v[68:71], a[52:55]
ds_read_b64_tr_b16 v[24:25], v134 offset:32768
v_mfma_f32_16x16x32_bf16 a[56:59], v[84:87], v[72:75], a[56:59]
ds_read_b64_tr_b16 v[26:27], v134 offset:40960
v_mfma_f32_16x16x32_bf16 a[60:63], v[84:87], v[76:79], a[60:63]
ds_read_b64_tr_b16 v[28:29], v135 offset:32768
v_mfma_f32_16x16x32_bf16 a[64:67], v[88:91], v[48:51], a[64:67]
ds_read_b64_tr_b16 v[30:31], v135 offset:40960
v_mfma_f32_16x16x32_bf16 a[68:71], v[88:91], v[52:55], a[68:71]
ds_read_b128 v[36:39], v136 offset:17408
v_mfma_f32_16x16x32_bf16 a[72:75], v[88:91], v[56:59], a[72:75]
ds_read_b128 v[40:43], v136 offset:18432
v_mfma_f32_16x16x32_bf16 a[76:79], v[88:91], v[60:63], a[76:79]
ds_read_b128 v[44:47], v136 offset:19456
v_mfma_f32_16x16x32_bf16 a[80:83], v[88:91], v[64:67], a[80:83]
v_mfma_f32_16x16x32_bf16 a[84:87], v[88:91], v[68:71], a[84:87]
v_mfma_f32_16x16x32_bf16 a[88:91], v[88:91], v[72:75], a[88:91]
v_mfma_f32_16x16x32_bf16 a[92:95], v[88:91], v[76:79], a[92:95]
v_mfma_f32_16x16x32_bf16 a[96:99], v[92:95], v[48:51], a[96:99]
v_mfma_f32_16x16x32_bf16 a[100:103], v[92:95], v[52:55], a[100:103]
v_mfma_f32_16x16x32_bf16 a[104:107], v[92:95], v[56:59], a[104:107]
v_mfma_f32_16x16x32_bf16 a[108:111], v[92:95], v[60:63], a[108:111]
v_mfma_f32_16x16x32_bf16 a[112:115], v[92:95], v[64:67], a[112:115]
v_mfma_f32_16x16x32_bf16 a[116:119], v[92:95], v[68:71], a[116:119]
v_mfma_f32_16x16x32_bf16 a[120:123], v[92:95], v[72:75], a[120:123]
v_mfma_f32_16x16x32_bf16 a[124:127], v[92:95], v[76:79], a[124:127]
s_waitcnt lgkmcnt(0)
v_mfma_f32_16x16x32_bf16 a[0:3], v[32:35], v[0:3], a[0:3]
s_waitcnt vmcnt(0)
s_barrier
ds_read_b128 v[80:83], v136 offset:24576
v_mfma_f32_16x16x32_bf16 a[4:7], v[32:35], v[4:7], a[4:7]
ds_read_b64_tr_b16 v[48:49], v128 offset:49152
v_mfma_f32_16x16x32_bf16 a[8:11], v[32:35], v[8:11], a[8:11]
ds_read_b64_tr_b16 v[50:51], v128 offset:57344
v_mfma_f32_16x16x32_bf16 a[12:15], v[32:35], v[12:15], a[12:15]
ds_read_b64_tr_b16 v[52:53], v129 offset:49152
v_mfma_f32_16x16x32_bf16 a[16:19], v[32:35], v[16:19], a[16:19]
ds_read_b64_tr_b16 v[54:55], v129 offset:57344
v_mfma_f32_16x16x32_bf16 a[20:23], v[32:35], v[20:23], a[20:23]
ds_read_b64_tr_b16 v[56:57], v130 offset:49152
v_mfma_f32_16x16x32_bf16 a[24:27], v[32:35], v[24:27], a[24:27]
ds_read_b64_tr_b16 v[58:59], v130 offset:57344
v_mfma_f32_16x16x32_bf16 a[28:31], v[32:35], v[28:31], a[28:31]
ds_read_b64_tr_b16 v[60:61], v131 offset:49152
v_mfma_f32_16x16x32_bf16 a[32:35], v[36:39], v[0:3], a[32:35]
ds_read_b64_tr_b16 v[62:63], v131 offset:57344
v_mfma_f32_16x16x32_bf16 a[36:39], v[36:39], v[4:7], a[36:39]
ds_read_b64_tr_b16 v[64:65], v132 offset:49152
v_mfma_f32_16x16x32_bf16 a[40:43], v[36:39], v[8:11], a[40:43]
ds_read_b64_tr_b16 v[66:67], v132 offset:57344
v_mfma_f32_16x16x32_bf16 a[44:47], v[36:39], v[12:15], a[44:47]
ds_read_b64_tr_b16 v[68:69], v133 offset:49152
v_mfma_f32_16x16x32_bf16 a[48:51], v[36:39], v[16:19], a[48:51]
ds_read_b64_tr_b16 v[70:71], v133 offset:57344
v_mfma_f32_16x16x32_bf16 a[52:55], v[36:39], v[20:23], a[52:55]
ds_read_b64_tr_b16 v[72:73], v134 offset:49152
v_mfma_f32_16x16x32_bf16 a[56:59], v[36:39], v[24:27], a[56:59]
ds_read_b64_tr_b16 v[74:75], v134 offset:57344
v_mfma_f32_16x16x32_bf16 a[60:63], v[36:39], v[28:31], a[60:63]
ds_read_b64_tr_b16 v[76:77], v135 offset:49152
v_mfma_f32_16x16x32_bf16 a[64:67], v[40:43], v[0:3], a[64:67]
ds_read_b64_tr_b16 v[78:79], v135 offset:57344
v_mfma_f32_16x16x32_bf16 a[68:71], v[40:43], v[4:7], a[68:71]
ds_read_b128 v[84:87], v136 offset:25600
v_mfma_f32_16x16x32_bf16 a[72:75], v[40:43], v[8:11], a[72:75]
ds_read_b128 v[88:91], v136 offset:26624
v_mfma_f32_16x16x32_bf16 a[76:79], v[40:43], v[12:15], a[76:79]
ds_read_b128 v[92:95], v136 offset:27648
v_mfma_f32_16x16x32_bf16 a[80:83], v[40:43], v[16:19], a[80:83]
v_mfma_f32_16x16x32_bf16 a[84:87], v[40:43], v[20:23], a[84:87]
v_mfma_f32_16x16x32_bf16 a[88:91], v[40:43], v[24:27], a[88:91]
v_mfma_f32_16x16x32_bf16 a[92:95], v[40:43], v[28:31], a[92:95]
v_mfma_f32_16x16x32_bf16 a[96:99], v[44:47], v[0:3], a[96:99]
v_mfma_f32_16x16x32_bf16 a[100:103], v[44:47], v[4:7], a[100:103]
v_mfma_f32_16x16x32_bf16 a[104:107], v[44:47], v[8:11], a[104:107]
v_mfma_f32_16x16x32_bf16 a[108:111], v[44:47], v[12:15], a[108:111]
v_mfma_f32_16x16x32_bf16 a[112:115], v[44:47], v[16:19], a[112:115]
v_mfma_f32_16x16x32_bf16 a[116:119], v[44:47], v[20:23], a[116:119]
v_mfma_f32_16x16x32_bf16 a[120:123], v[44:47], v[24:27], a[120:123]
v_mfma_f32_16x16x32_bf16 a[124:127], v[44:47], v[28:31], a[124:127]
s_waitcnt lgkmcnt(0)
v_mfma_f32_16x16x32_bf16 a[0:3], v[80:83], v[48:51], a[0:3]
s_barrier
v_mfma_f32_16x16x32_bf16 a[4:7], v[80:83], v[52:55], a[4:7]
v_mfma_f32_16x16x32_bf16 a[8:11], v[80:83], v[56:59], a[8:11]
v_mfma_f32_16x16x32_bf16 a[12:15], v[80:83], v[60:63], a[12:15]
v_mfma_f32_16x16x32_bf16 a[16:19], v[80:83], v[64:67], a[16:19]
v_mfma_f32_16x16x32_bf16 a[20:23], v[80:83], v[68:71], a[20:23]
v_mfma_f32_16x16x32_bf16 a[24:27], v[80:83], v[72:75], a[24:27]
v_mfma_f32_16x16x32_bf16 a[28:31], v[80:83], v[76:79], a[28:31]
v_mfma_f32_16x16x32_bf16 a[32:35], v[84:87], v[48:51], a[32:35]
v_mfma_f32_16x16x32_bf16 a[36:39], v[84:87], v[52:55], a[36:39]
v_mfma_f32_16x16x32_bf16 a[40:43], v[84:87], v[56:59], a[40:43]
v_mfma_f32_16x16x32_bf16 a[44:47], v[84:87], v[60:63], a[44:47]
v_mfma_f32_16x16x32_bf16 a[48:51], v[84:87], v[64:67], a[48:51]
v_mfma_f32_16x16x32_bf16 a[52:55], v[84:87], v[68:71], a[52:55]
v_mfma_f32_16x16x32_bf16 a[56:59], v[84:87], v[72:75], a[56:59]
v_mfma_f32_16x16x32_bf16 a[60:63], v[84:87], v[76:79], a[60:63]
v_mfma_f32_16x16x32_bf16 a[64:67], v[88:91], v[48:51], a[64:67]
v_mfma_f32_16x16x32_bf16 a[68:71], v[88:91], v[52:55], a[68:71]
v_mfma_f32_16x16x32_bf16 a[72:75], v[88:91], v[56:59], a[72:75]
v_mfma_f32_16x16x32_bf16 a[76:79], v[88:91], v[60:63], a[76:79]
v_mfma_f32_16x16x32_bf16 a[80:83], v[88:91], v[64:67], a[80:83]
v_mfma_f32_16x16x32_bf16 a[84:87], v[88:91], v[68:71], a[84:87]
v_mfma_f32_16x16x32_bf16 a[88:91], v[88:91], v[72:75], a[88:91]
v_mfma_f32_16x16x32_bf16 a[92:95], v[88:91], v[76:79], a[92:95]
v_mfma_f32_16x16x32_bf16 a[96:99], v[92:95], v[48:51], a[96:99]
v_mfma_f32_16x16x32_bf16 a[100:103], v[92:95], v[52:55], a[100:103]
v_mfma_f32_16x16x32_bf16 a[104:107], v[92:95], v[56:59], a[104:107]
v_mfma_f32_16x16x32_bf16 a[108:111], v[92:95], v[60:63], a[108:111]
v_mfma_f32_16x16x32_bf16 a[112:115], v[92:95], v[64:67], a[112:115]
v_mfma_f32_16x16x32_bf16 a[116:119], v[92:95], v[68:71], a[116:119]
v_mfma_f32_16x16x32_bf16 a[120:123], v[92:95], v[72:75], a[120:123]
v_mfma_f32_16x16x32_bf16 a[124:127], v[92:95], v[76:79], a[124:127]
s_cmp_lg_u32 s62, -4
s_cbranch_scc1 main_kernel_w_gemm
s_branch main_kernel_w_slow
main_kernel_w_c1_v_ev:
s_mov_b32 s55, 1
s_cmp_eq_u32 s56, 0
s_cbranch_scc1 main_kernel_w_c1_v_et
s_bfm_b64 exec, s0, 0
buffer_store_dword v244, v248, s[4:7], s59 offen sc1
s_mov_b64 exec, -1
s_mov_b32 s56, 0
main_kernel_w_c1_v_et:
s_cmp_lg_u32 s18, 1
s_cbranch_scc1 main_kernel_w_c1_v_loop
s_lshl_b32 s32, s27, 8
s_add_u32 s32, s32, 0x841e000
s_mov_b64 exec, 1
v_mov_b32 v249, 1
buffer_atomic_add v249, off, s[4:7], s32 sc0 sc1
s_mov_b64 exec, -1
s_branch main_kernel_w_c1_v_loop
main_kernel_w_epn:
s_waitcnt lgkmcnt(0)
s_branch main_kernel_w_epw
main_kernel_w_slow:
s_mov_b32 s58, -1
main_kernel_w_epw:
s_nop 5
main_kernel_w_epi:
s_cmp_eq_u32 s56, 2
s_cbranch_scc1 main_kernel_w_e2
s_cmp_eq_u32 s56, 3
s_cbranch_scc1 main_kernel_w_e3
s_cmp_eq_u32 s56, 4
s_cbranch_scc1 main_kernel_w_e4
s_cmp_eq_u32 s56, 5
s_cbranch_scc1 main_kernel_w_e5
s_cmp_eq_u32 s56, 6
s_cbranch_scc1 main_kernel_w_e6
s_cmp_eq_u32 s56, 7
s_cbranch_scc1 main_kernel_w_e7
s_cmp_eq_u32 s56, 8
s_cbranch_scc1 main_kernel_w_e8
s_cmp_eq_u32 s56, 9
s_cbranch_scc1 main_kernel_w_e9
s_cmp_eq_u32 s56, 10
s_cbranch_scc1 main_kernel_w_e10
main_kernel_w_e1:
s_mov_b32 s53, s1
v_mul_f32 v64, 0x3e0293ee, v64
v_mul_f32 v65, 0x3e0293ee, v65
v_mul_f32 v66, 0x3e0293ee, v66
v_mul_f32 v67, 0x3e0293ee, v67
v_mul_f32 v68, 0x3e0293ee, v68
v_mul_f32 v69, 0x3e0293ee, v69
v_mul_f32 v70, 0x3e0293ee, v70
v_mul_f32 v71, 0x3e0293ee, v71
v_cvt_pk_bf16_f32 v16, v64, v65
v_cvt_pk_bf16_f32 v17, v66, v67
v_cvt_pk_bf16_f32 v18, v68, v69
v_cvt_pk_bf16_f32 v19, v70, v71
buffer_store_dwordx4 v[16:19], v251, s[4:7], s53 offen offset:0 sc1
v_mul_f32 v72, 0x3e0293ee, v72
v_mul_f32 v73, 0x3e0293ee, v73
v_mul_f32 v74, 0x3e0293ee, v74
v_mul_f32 v75, 0x3e0293ee, v75
v_mul_f32 v76, 0x3e0293ee, v76
v_mul_f32 v77, 0x3e0293ee, v77
v_mul_f32 v78, 0x3e0293ee, v78
v_mul_f32 v79, 0x3e0293ee, v79
v_cvt_pk_bf16_f32 v36, v72, v73
v_cvt_pk_bf16_f32 v37, v74, v75
v_cvt_pk_bf16_f32 v38, v76, v77
v_cvt_pk_bf16_f32 v39, v78, v79
buffer_store_dwordx4 v[36:39], v251, s[4:7], s53 offen offset:1024 sc1
s_add_u32 s53, s53, s2
v_mul_f32 v80, 0x3e0293ee, v80
v_mul_f32 v81, 0x3e0293ee, v81
v_mul_f32 v82, 0x3e0293ee, v82
v_mul_f32 v83, 0x3e0293ee, v83
v_mul_f32 v84, 0x3e0293ee, v84
v_mul_f32 v85, 0x3e0293ee, v85
v_mul_f32 v86, 0x3e0293ee, v86
v_mul_f32 v87, 0x3e0293ee, v87
v_cvt_pk_bf16_f32 v56, v80, v81
v_cvt_pk_bf16_f32 v57, v82, v83
v_cvt_pk_bf16_f32 v58, v84, v85
v_cvt_pk_bf16_f32 v59, v86, v87
buffer_store_dwordx4 v[56:59], v251, s[4:7], s53 offen offset:0 sc1
v_mul_f32 v88, 0x3e0293ee, v88
v_mul_f32 v89, 0x3e0293ee, v89
v_mul_f32 v90, 0x3e0293ee, v90
v_mul_f32 v91, 0x3e0293ee, v91
v_mul_f32 v92, 0x3e0293ee, v92
v_mul_f32 v93, 0x3e0293ee, v93
v_mul_f32 v94, 0x3e0293ee, v94
v_mul_f32 v95, 0x3e0293ee, v95
v_cvt_pk_bf16_f32 v16, v88, v89
v_cvt_pk_bf16_f32 v17, v90, v91
v_cvt_pk_bf16_f32 v18, v92, v93
v_cvt_pk_bf16_f32 v19, v94, v95
buffer_store_dwordx4 v[16:19], v251, s[4:7], s53 offen offset:1024 sc1
s_add_u32 s53, s53, s2
v_mul_f32 v96, 0x3e0293ee, v96
v_mul_f32 v97, 0x3e0293ee, v97
v_mul_f32 v98, 0x3e0293ee, v98
v_mul_f32 v99, 0x3e0293ee, v99
v_mul_f32 v100, 0x3e0293ee, v100
v_mul_f32 v101, 0x3e0293ee, v101
v_mul_f32 v102, 0x3e0293ee, v102
v_mul_f32 v103, 0x3e0293ee, v103
v_cvt_pk_bf16_f32 v36, v96, v97
v_cvt_pk_bf16_f32 v37, v98, v99
v_cvt_pk_bf16_f32 v38, v100, v101
v_cvt_pk_bf16_f32 v39, v102, v103
buffer_store_dwordx4 v[36:39], v251, s[4:7], s53 offen offset:0 sc1
v_mul_f32 v104, 0x3e0293ee, v104
v_mul_f32 v105, 0x3e0293ee, v105
v_mul_f32 v106, 0x3e0293ee, v106
v_mul_f32 v107, 0x3e0293ee, v107
v_mul_f32 v108, 0x3e0293ee, v108
v_mul_f32 v109, 0x3e0293ee, v109
v_mul_f32 v110, 0x3e0293ee, v110
v_mul_f32 v111, 0x3e0293ee, v111
v_cvt_pk_bf16_f32 v56, v104, v105
v_cvt_pk_bf16_f32 v57, v106, v107
v_cvt_pk_bf16_f32 v58, v108, v109
v_cvt_pk_bf16_f32 v59, v110, v111
buffer_store_dwordx4 v[56:59], v251, s[4:7], s53 offen offset:1024 sc1
s_add_u32 s53, s53, s2
v_mul_f32 v112, 0x3e0293ee, v112
v_mul_f32 v113, 0x3e0293ee, v113
v_mul_f32 v114, 0x3e0293ee, v114
v_mul_f32 v115, 0x3e0293ee, v115
v_mul_f32 v116, 0x3e0293ee, v116
v_mul_f32 v117, 0x3e0293ee, v117
v_mul_f32 v118, 0x3e0293ee, v118
v_mul_f32 v119, 0x3e0293ee, v119
v_cvt_pk_bf16_f32 v16, v112, v113
v_cvt_pk_bf16_f32 v17, v114, v115
v_cvt_pk_bf16_f32 v18, v116, v117
v_cvt_pk_bf16_f32 v19, v118, v119
buffer_store_dwordx4 v[16:19], v251, s[4:7], s53 offen offset:0 sc1
v_mul_f32 v120, 0x3e0293ee, v120
v_mul_f32 v121, 0x3e0293ee, v121
v_mul_f32 v122, 0x3e0293ee, v122
v_mul_f32 v123, 0x3e0293ee, v123
v_mul_f32 v124, 0x3e0293ee, v124
v_mul_f32 v125, 0x3e0293ee, v125
v_mul_f32 v126, 0x3e0293ee, v126
v_mul_f32 v127, 0x3e0293ee, v127
v_cvt_pk_bf16_f32 v36, v120, v121
v_cvt_pk_bf16_f32 v37, v122, v123
v_cvt_pk_bf16_f32 v38, v124, v125
v_cvt_pk_bf16_f32 v39, v126, v127
buffer_store_dwordx4 v[36:39], v251, s[4:7], s53 offen offset:1024 sc1
s_branch main_kernel_w_ee
main_kernel_w_e2:
s_mov_b32 s53, s1
v_cvt_pk_bf16_f32 v8, v64, v65
v_cvt_pk_bf16_f32 v9, v66, v67
v_cvt_pk_bf16_f32 v10, v80, v81
v_cvt_pk_bf16_f32 v11, v82, v83
buffer_store_dwordx4 v[8:11], v251, s[4:7], s53 offen offset:0 sc1
v_cvt_pk_bf16_f32 v24, v68, v69
v_cvt_pk_bf16_f32 v25, v70, v71
v_cvt_pk_bf16_f32 v26, v84, v85
v_cvt_pk_bf16_f32 v27, v86, v87
buffer_store_dwordx4 v[24:27], v251, s[4:7], s53 offen offset:1024 sc1
v_cvt_pk_bf16_f32 v40, v72, v73
v_cvt_pk_bf16_f32 v41, v74, v75
v_cvt_pk_bf16_f32 v42, v88, v89
v_cvt_pk_bf16_f32 v43, v90, v91
buffer_store_dwordx4 v[40:43], v251, s[4:7], s53 offen offset:2048 sc1
v_cvt_pk_bf16_f32 v56, v76, v77
v_cvt_pk_bf16_f32 v57, v78, v79
v_cvt_pk_bf16_f32 v58, v92, v93
v_cvt_pk_bf16_f32 v59, v94, v95
buffer_store_dwordx4 v[56:59], v251, s[4:7], s53 offen offset:3072 sc1
s_add_u32 s53, s53, 262144
v_cvt_pk_bf16_f32 v8, v96, v97
v_cvt_pk_bf16_f32 v9, v98, v99
v_cvt_pk_bf16_f32 v10, v112, v113
v_cvt_pk_bf16_f32 v11, v114, v115
buffer_store_dwordx4 v[8:11], v251, s[4:7], s53 offen offset:0 sc1
v_cvt_pk_bf16_f32 v24, v100, v101
v_cvt_pk_bf16_f32 v25, v102, v103
v_cvt_pk_bf16_f32 v26, v116, v117
v_cvt_pk_bf16_f32 v27, v118, v119
buffer_store_dwordx4 v[24:27], v251, s[4:7], s53 offen offset:1024 sc1
v_cvt_pk_bf16_f32 v40, v104, v105
v_cvt_pk_bf16_f32 v41, v106, v107
v_cvt_pk_bf16_f32 v42, v120, v121
v_cvt_pk_bf16_f32 v43, v122, v123
buffer_store_dwordx4 v[40:43], v251, s[4:7], s53 offen offset:2048 sc1
v_cvt_pk_bf16_f32 v56, v108, v109
v_cvt_pk_bf16_f32 v57, v110, v111
v_cvt_pk_bf16_f32 v58, v124, v125
v_cvt_pk_bf16_f32 v59, v126, v127
buffer_store_dwordx4 v[56:59], v251, s[4:7], s53 offen offset:3072 sc1
s_add_u32 s53, s53, 262144
s_branch main_kernel_w_ee
main_kernel_w_e3:
s_mov_b32 s53, s1
v_lshlrev_b32 v8, 16, v192
v_and_b32 v9, 0xffff0000, v192
v_lshlrev_b32 v10, 16, v193
v_and_b32 v11, 0xffff0000, v193
v_lshlrev_b32 v12, 16, v194
v_and_b32 v13, 0xffff0000, v194
v_lshlrev_b32 v14, 16, v195
v_and_b32 v15, 0xffff0000, v195
v_pk_add_f32 v[64:65], v[64:65], v[8:9]
v_pk_add_f32 v[66:67], v[66:67], v[10:11]
v_pk_add_f32 v[68:69], v[68:69], v[12:13]
v_pk_add_f32 v[70:71], v[70:71], v[14:15]
v_cvt_pk_bf16_f32 v16, v64, v65
v_cvt_pk_bf16_f32 v17, v66, v67
v_cvt_pk_bf16_f32 v18, v68, v69
v_cvt_pk_bf16_f32 v19, v70, v71
buffer_store_dwordx4 v[16:19], v251, s[4:7], s53 offen offset:0 sc1
v_lshlrev_b32 v28, 16, v196
v_and_b32 v29, 0xffff0000, v196
v_lshlrev_b32 v30, 16, v197
v_and_b32 v31, 0xffff0000, v197
v_lshlrev_b32 v32, 16, v198
v_and_b32 v33, 0xffff0000, v198
v_lshlrev_b32 v34, 16, v199
v_and_b32 v35, 0xffff0000, v199
v_pk_add_f32 v[72:73], v[72:73], v[28:29]
v_pk_add_f32 v[74:75], v[74:75], v[30:31]
v_pk_add_f32 v[76:77], v[76:77], v[32:33]
v_pk_add_f32 v[78:79], v[78:79], v[34:35]
v_cvt_pk_bf16_f32 v36, v72, v73
v_cvt_pk_bf16_f32 v37, v74, v75
v_cvt_pk_bf16_f32 v38, v76, v77
v_cvt_pk_bf16_f32 v39, v78, v79
buffer_store_dwordx4 v[36:39], v251, s[4:7], s53 offen offset:1024 sc1
s_add_u32 s53, s53, s2
v_lshlrev_b32 v48, 16, v200
v_and_b32 v49, 0xffff0000, v200
v_lshlrev_b32 v50, 16, v201
v_and_b32 v51, 0xffff0000, v201
v_lshlrev_b32 v52, 16, v202
v_and_b32 v53, 0xffff0000, v202
v_lshlrev_b32 v54, 16, v203
v_and_b32 v55, 0xffff0000, v203
v_pk_add_f32 v[80:81], v[80:81], v[48:49]
v_pk_add_f32 v[82:83], v[82:83], v[50:51]
v_pk_add_f32 v[84:85], v[84:85], v[52:53]
v_pk_add_f32 v[86:87], v[86:87], v[54:55]
v_cvt_pk_bf16_f32 v56, v80, v81
v_cvt_pk_bf16_f32 v57, v82, v83
v_cvt_pk_bf16_f32 v58, v84, v85
v_cvt_pk_bf16_f32 v59, v86, v87
buffer_store_dwordx4 v[56:59], v251, s[4:7], s53 offen offset:0 sc1
v_lshlrev_b32 v8, 16, v204
v_and_b32 v9, 0xffff0000, v204
v_lshlrev_b32 v10, 16, v205
v_and_b32 v11, 0xffff0000, v205
v_lshlrev_b32 v12, 16, v206
v_and_b32 v13, 0xffff0000, v206
v_lshlrev_b32 v14, 16, v207
v_and_b32 v15, 0xffff0000, v207
v_pk_add_f32 v[88:89], v[88:89], v[8:9]
v_pk_add_f32 v[90:91], v[90:91], v[10:11]
v_pk_add_f32 v[92:93], v[92:93], v[12:13]
v_pk_add_f32 v[94:95], v[94:95], v[14:15]
v_cvt_pk_bf16_f32 v16, v88, v89
v_cvt_pk_bf16_f32 v17, v90, v91
v_cvt_pk_bf16_f32 v18, v92, v93
v_cvt_pk_bf16_f32 v19, v94, v95
buffer_store_dwordx4 v[16:19], v251, s[4:7], s53 offen offset:1024 sc1
s_add_u32 s53, s53, s2
v_lshlrev_b32 v28, 16, v208
v_and_b32 v29, 0xffff0000, v208
v_lshlrev_b32 v30, 16, v209
v_and_b32 v31, 0xffff0000, v209
v_lshlrev_b32 v32, 16, v210
v_and_b32 v33, 0xffff0000, v210
v_lshlrev_b32 v34, 16, v211
v_and_b32 v35, 0xffff0000, v211
v_pk_add_f32 v[96:97], v[96:97], v[28:29]
v_pk_add_f32 v[98:99], v[98:99], v[30:31]
v_pk_add_f32 v[100:101], v[100:101], v[32:33]
v_pk_add_f32 v[102:103], v[102:103], v[34:35]
v_cvt_pk_bf16_f32 v36, v96, v97
v_cvt_pk_bf16_f32 v37, v98, v99
v_cvt_pk_bf16_f32 v38, v100, v101
v_cvt_pk_bf16_f32 v39, v102, v103
buffer_store_dwordx4 v[36:39], v251, s[4:7], s53 offen offset:0 sc1
v_lshlrev_b32 v48, 16, v212
v_and_b32 v49, 0xffff0000, v212
v_lshlrev_b32 v50, 16, v213
v_and_b32 v51, 0xffff0000, v213
v_lshlrev_b32 v52, 16, v214
v_and_b32 v53, 0xffff0000, v214
v_lshlrev_b32 v54, 16, v215
v_and_b32 v55, 0xffff0000, v215
v_pk_add_f32 v[104:105], v[104:105], v[48:49]
v_pk_add_f32 v[106:107], v[106:107], v[50:51]
v_pk_add_f32 v[108:109], v[108:109], v[52:53]
v_pk_add_f32 v[110:111], v[110:111], v[54:55]
v_cvt_pk_bf16_f32 v56, v104, v105
v_cvt_pk_bf16_f32 v57, v106, v107
v_cvt_pk_bf16_f32 v58, v108, v109
v_cvt_pk_bf16_f32 v59, v110, v111
buffer_store_dwordx4 v[56:59], v251, s[4:7], s53 offen offset:1024 sc1
s_add_u32 s53, s53, s2
v_lshlrev_b32 v8, 16, v216
v_and_b32 v9, 0xffff0000, v216
v_lshlrev_b32 v10, 16, v217
v_and_b32 v11, 0xffff0000, v217
v_lshlrev_b32 v12, 16, v218
v_and_b32 v13, 0xffff0000, v218
v_lshlrev_b32 v14, 16, v219
v_and_b32 v15, 0xffff0000, v219
v_pk_add_f32 v[112:113], v[112:113], v[8:9]
v_pk_add_f32 v[114:115], v[114:115], v[10:11]
v_pk_add_f32 v[116:117], v[116:117], v[12:13]
v_pk_add_f32 v[118:119], v[118:119], v[14:15]
v_cvt_pk_bf16_f32 v16, v112, v113
v_cvt_pk_bf16_f32 v17, v114, v115
v_cvt_pk_bf16_f32 v18, v116, v117
v_cvt_pk_bf16_f32 v19, v118, v119
buffer_store_dwordx4 v[16:19], v251, s[4:7], s53 offen offset:0 sc1
v_lshlrev_b32 v28, 16, v220
v_and_b32 v29, 0xffff0000, v220
v_lshlrev_b32 v30, 16, v221
v_and_b32 v31, 0xffff0000, v221
v_lshlrev_b32 v32, 16, v222
v_and_b32 v33, 0xffff0000, v222
v_lshlrev_b32 v34, 16, v223
v_and_b32 v35, 0xffff0000, v223
v_pk_add_f32 v[120:121], v[120:121], v[28:29]
v_pk_add_f32 v[122:123], v[122:123], v[30:31]
v_pk_add_f32 v[124:125], v[124:125], v[32:33]
v_pk_add_f32 v[126:127], v[126:127], v[34:35]
v_cvt_pk_bf16_f32 v36, v120, v121
v_cvt_pk_bf16_f32 v37, v122, v123
v_cvt_pk_bf16_f32 v38, v124, v125
v_cvt_pk_bf16_f32 v39, v126, v127
buffer_store_dwordx4 v[36:39], v251, s[4:7], s53 offen offset:1024 sc1
s_branch main_kernel_w_ee
main_kernel_w_e4:
s_mov_b32 s53, s1
v_lshlrev_b32 v8, 16, v192
v_and_b32 v9, 0xffff0000, v192
v_lshlrev_b32 v10, 16, v193
v_and_b32 v11, 0xffff0000, v193
v_lshlrev_b32 v12, 16, v194
v_and_b32 v13, 0xffff0000, v194
v_lshlrev_b32 v14, 16, v195
v_and_b32 v15, 0xffff0000, v195
v_pk_add_f32 v[64:65], v[64:65], v[8:9]
v_pk_add_f32 v[66:67], v[66:67], v[10:11]
v_pk_add_f32 v[68:69], v[68:69], v[12:13]
v_pk_add_f32 v[70:71], v[70:71], v[14:15]
v_pk_mul_f32 v[8:9], v[64:65], v[246:247]
v_pk_mul_f32 v[10:11], v[66:67], v[246:247]
v_pk_mul_f32 v[12:13], v[68:69], v[246:247]
v_pk_mul_f32 v[14:15], v[70:71], v[246:247]
v_exp_f32 v8, v8
v_exp_f32 v9, v9
v_exp_f32 v10, v10
v_exp_f32 v11, v11
v_exp_f32 v12, v12
v_exp_f32 v13, v13
v_exp_f32 v14, v14
v_exp_f32 v15, v15
v_pk_add_f32 v[8:9], v[8:9], v[244:245]
v_pk_add_f32 v[10:11], v[10:11], v[244:245]
v_pk_add_f32 v[12:13], v[12:13], v[244:245]
v_pk_add_f32 v[14:15], v[14:15], v[244:245]
v_rcp_f32 v8, v8
v_rcp_f32 v9, v9
v_rcp_f32 v10, v10
v_rcp_f32 v11, v11
v_rcp_f32 v12, v12
v_rcp_f32 v13, v13
v_rcp_f32 v14, v14
v_rcp_f32 v15, v15
v_pk_mul_f32 v[64:65], v[8:9], v[64:65]
v_pk_mul_f32 v[66:67], v[10:11], v[66:67]
v_pk_mul_f32 v[68:69], v[12:13], v[68:69]
v_pk_mul_f32 v[70:71], v[14:15], v[70:71]
v_cvt_pk_bf16_f32 v16, v64, v65
v_cvt_pk_bf16_f32 v17, v66, v67
v_cvt_pk_bf16_f32 v18, v68, v69
v_cvt_pk_bf16_f32 v19, v70, v71
buffer_store_dwordx4 v[16:19], v251, s[4:7], s53 offen offset:0 sc1
v_lshlrev_b32 v28, 16, v196
v_and_b32 v29, 0xffff0000, v196
v_lshlrev_b32 v30, 16, v197
v_and_b32 v31, 0xffff0000, v197
v_lshlrev_b32 v32, 16, v198
v_and_b32 v33, 0xffff0000, v198
v_lshlrev_b32 v34, 16, v199
v_and_b32 v35, 0xffff0000, v199
v_pk_add_f32 v[72:73], v[72:73], v[28:29]
v_pk_add_f32 v[74:75], v[74:75], v[30:31]
v_pk_add_f32 v[76:77], v[76:77], v[32:33]
v_pk_add_f32 v[78:79], v[78:79], v[34:35]
v_pk_mul_f32 v[28:29], v[72:73], v[246:247]
v_pk_mul_f32 v[30:31], v[74:75], v[246:247]
v_pk_mul_f32 v[32:33], v[76:77], v[246:247]
v_pk_mul_f32 v[34:35], v[78:79], v[246:247]
v_exp_f32 v28, v28
v_exp_f32 v29, v29
v_exp_f32 v30, v30
v_exp_f32 v31, v31
v_exp_f32 v32, v32
v_exp_f32 v33, v33
v_exp_f32 v34, v34
v_exp_f32 v35, v35
v_pk_add_f32 v[28:29], v[28:29], v[244:245]
v_pk_add_f32 v[30:31], v[30:31], v[244:245]
v_pk_add_f32 v[32:33], v[32:33], v[244:245]
v_pk_add_f32 v[34:35], v[34:35], v[244:245]
v_rcp_f32 v28, v28
v_rcp_f32 v29, v29
v_rcp_f32 v30, v30
v_rcp_f32 v31, v31
v_rcp_f32 v32, v32
v_rcp_f32 v33, v33
v_rcp_f32 v34, v34
v_rcp_f32 v35, v35
v_pk_mul_f32 v[72:73], v[28:29], v[72:73]
v_pk_mul_f32 v[74:75], v[30:31], v[74:75]
v_pk_mul_f32 v[76:77], v[32:33], v[76:77]
v_pk_mul_f32 v[78:79], v[34:35], v[78:79]
v_cvt_pk_bf16_f32 v36, v72, v73
v_cvt_pk_bf16_f32 v37, v74, v75
v_cvt_pk_bf16_f32 v38, v76, v77
v_cvt_pk_bf16_f32 v39, v78, v79
buffer_store_dwordx4 v[36:39], v251, s[4:7], s53 offen offset:1024 sc1
s_add_u32 s53, s53, s2
v_lshlrev_b32 v48, 16, v200
v_and_b32 v49, 0xffff0000, v200
v_lshlrev_b32 v50, 16, v201
v_and_b32 v51, 0xffff0000, v201
v_lshlrev_b32 v52, 16, v202
v_and_b32 v53, 0xffff0000, v202
v_lshlrev_b32 v54, 16, v203
v_and_b32 v55, 0xffff0000, v203
v_pk_add_f32 v[80:81], v[80:81], v[48:49]
v_pk_add_f32 v[82:83], v[82:83], v[50:51]
v_pk_add_f32 v[84:85], v[84:85], v[52:53]
v_pk_add_f32 v[86:87], v[86:87], v[54:55]
v_pk_mul_f32 v[48:49], v[80:81], v[246:247]
v_pk_mul_f32 v[50:51], v[82:83], v[246:247]
v_pk_mul_f32 v[52:53], v[84:85], v[246:247]
v_pk_mul_f32 v[54:55], v[86:87], v[246:247]
v_exp_f32 v48, v48
v_exp_f32 v49, v49
v_exp_f32 v50, v50
v_exp_f32 v51, v51
v_exp_f32 v52, v52
v_exp_f32 v53, v53
v_exp_f32 v54, v54
v_exp_f32 v55, v55
v_pk_add_f32 v[48:49], v[48:49], v[244:245]
v_pk_add_f32 v[50:51], v[50:51], v[244:245]
v_pk_add_f32 v[52:53], v[52:53], v[244:245]
v_pk_add_f32 v[54:55], v[54:55], v[244:245]
v_rcp_f32 v48, v48
v_rcp_f32 v49, v49
v_rcp_f32 v50, v50
v_rcp_f32 v51, v51
v_rcp_f32 v52, v52
v_rcp_f32 v53, v53
v_rcp_f32 v54, v54
v_rcp_f32 v55, v55
v_pk_mul_f32 v[80:81], v[48:49], v[80:81]
v_pk_mul_f32 v[82:83], v[50:51], v[82:83]
v_pk_mul_f32 v[84:85], v[52:53], v[84:85]
v_pk_mul_f32 v[86:87], v[54:55], v[86:87]
v_cvt_pk_bf16_f32 v56, v80, v81
v_cvt_pk_bf16_f32 v57, v82, v83
v_cvt_pk_bf16_f32 v58, v84, v85
v_cvt_pk_bf16_f32 v59, v86, v87
buffer_store_dwordx4 v[56:59], v251, s[4:7], s53 offen offset:0 sc1
v_lshlrev_b32 v8, 16, v204
v_and_b32 v9, 0xffff0000, v204
v_lshlrev_b32 v10, 16, v205
v_and_b32 v11, 0xffff0000, v205
v_lshlrev_b32 v12, 16, v206
v_and_b32 v13, 0xffff0000, v206
v_lshlrev_b32 v14, 16, v207
v_and_b32 v15, 0xffff0000, v207
v_pk_add_f32 v[88:89], v[88:89], v[8:9]
v_pk_add_f32 v[90:91], v[90:91], v[10:11]
v_pk_add_f32 v[92:93], v[92:93], v[12:13]
v_pk_add_f32 v[94:95], v[94:95], v[14:15]
v_pk_mul_f32 v[8:9], v[88:89], v[246:247]
v_pk_mul_f32 v[10:11], v[90:91], v[246:247]
v_pk_mul_f32 v[12:13], v[92:93], v[246:247]
v_pk_mul_f32 v[14:15], v[94:95], v[246:247]
v_exp_f32 v8, v8
v_exp_f32 v9, v9
v_exp_f32 v10, v10
v_exp_f32 v11, v11
v_exp_f32 v12, v12
v_exp_f32 v13, v13
v_exp_f32 v14, v14
v_exp_f32 v15, v15
v_pk_add_f32 v[8:9], v[8:9], v[244:245]
v_pk_add_f32 v[10:11], v[10:11], v[244:245]
v_pk_add_f32 v[12:13], v[12:13], v[244:245]
v_pk_add_f32 v[14:15], v[14:15], v[244:245]
v_rcp_f32 v8, v8
v_rcp_f32 v9, v9
v_rcp_f32 v10, v10
v_rcp_f32 v11, v11
v_rcp_f32 v12, v12
v_rcp_f32 v13, v13
v_rcp_f32 v14, v14
v_rcp_f32 v15, v15
v_pk_mul_f32 v[88:89], v[8:9], v[88:89]
v_pk_mul_f32 v[90:91], v[10:11], v[90:91]
v_pk_mul_f32 v[92:93], v[12:13], v[92:93]
v_pk_mul_f32 v[94:95], v[14:15], v[94:95]
v_cvt_pk_bf16_f32 v16, v88, v89
v_cvt_pk_bf16_f32 v17, v90, v91
v_cvt_pk_bf16_f32 v18, v92, v93
v_cvt_pk_bf16_f32 v19, v94, v95
buffer_store_dwordx4 v[16:19], v251, s[4:7], s53 offen offset:1024 sc1
s_add_u32 s53, s53, s2
v_lshlrev_b32 v28, 16, v208
v_and_b32 v29, 0xffff0000, v208
v_lshlrev_b32 v30, 16, v209
v_and_b32 v31, 0xffff0000, v209
v_lshlrev_b32 v32, 16, v210
v_and_b32 v33, 0xffff0000, v210
v_lshlrev_b32 v34, 16, v211
v_and_b32 v35, 0xffff0000, v211
v_pk_add_f32 v[96:97], v[96:97], v[28:29]
v_pk_add_f32 v[98:99], v[98:99], v[30:31]
v_pk_add_f32 v[100:101], v[100:101], v[32:33]
v_pk_add_f32 v[102:103], v[102:103], v[34:35]
v_pk_mul_f32 v[28:29], v[96:97], v[246:247]
v_pk_mul_f32 v[30:31], v[98:99], v[246:247]
v_pk_mul_f32 v[32:33], v[100:101], v[246:247]
v_pk_mul_f32 v[34:35], v[102:103], v[246:247]
v_exp_f32 v28, v28
v_exp_f32 v29, v29
v_exp_f32 v30, v30
v_exp_f32 v31, v31
v_exp_f32 v32, v32
v_exp_f32 v33, v33
v_exp_f32 v34, v34
v_exp_f32 v35, v35
v_pk_add_f32 v[28:29], v[28:29], v[244:245]
v_pk_add_f32 v[30:31], v[30:31], v[244:245]
v_pk_add_f32 v[32:33], v[32:33], v[244:245]
v_pk_add_f32 v[34:35], v[34:35], v[244:245]
v_rcp_f32 v28, v28
v_rcp_f32 v29, v29
v_rcp_f32 v30, v30
v_rcp_f32 v31, v31
v_rcp_f32 v32, v32
v_rcp_f32 v33, v33
v_rcp_f32 v34, v34
v_rcp_f32 v35, v35
v_pk_mul_f32 v[96:97], v[28:29], v[96:97]
v_pk_mul_f32 v[98:99], v[30:31], v[98:99]
v_pk_mul_f32 v[100:101], v[32:33], v[100:101]
v_pk_mul_f32 v[102:103], v[34:35], v[102:103]
v_cvt_pk_bf16_f32 v36, v96, v97
v_cvt_pk_bf16_f32 v37, v98, v99
v_cvt_pk_bf16_f32 v38, v100, v101
v_cvt_pk_bf16_f32 v39, v102, v103
buffer_store_dwordx4 v[36:39], v251, s[4:7], s53 offen offset:0 sc1
v_lshlrev_b32 v48, 16, v212
v_and_b32 v49, 0xffff0000, v212
v_lshlrev_b32 v50, 16, v213
v_and_b32 v51, 0xffff0000, v213
v_lshlrev_b32 v52, 16, v214
v_and_b32 v53, 0xffff0000, v214
v_lshlrev_b32 v54, 16, v215
v_and_b32 v55, 0xffff0000, v215
v_pk_add_f32 v[104:105], v[104:105], v[48:49]
v_pk_add_f32 v[106:107], v[106:107], v[50:51]
v_pk_add_f32 v[108:109], v[108:109], v[52:53]
v_pk_add_f32 v[110:111], v[110:111], v[54:55]
v_pk_mul_f32 v[48:49], v[104:105], v[246:247]
v_pk_mul_f32 v[50:51], v[106:107], v[246:247]
v_pk_mul_f32 v[52:53], v[108:109], v[246:247]
v_pk_mul_f32 v[54:55], v[110:111], v[246:247]
v_exp_f32 v48, v48
v_exp_f32 v49, v49
v_exp_f32 v50, v50
v_exp_f32 v51, v51
v_exp_f32 v52, v52
v_exp_f32 v53, v53
v_exp_f32 v54, v54
v_exp_f32 v55, v55
v_pk_add_f32 v[48:49], v[48:49], v[244:245]
v_pk_add_f32 v[50:51], v[50:51], v[244:245]
v_pk_add_f32 v[52:53], v[52:53], v[244:245]
v_pk_add_f32 v[54:55], v[54:55], v[244:245]
v_rcp_f32 v48, v48
v_rcp_f32 v49, v49
v_rcp_f32 v50, v50
v_rcp_f32 v51, v51
v_rcp_f32 v52, v52
v_rcp_f32 v53, v53
v_rcp_f32 v54, v54
v_rcp_f32 v55, v55
v_pk_mul_f32 v[104:105], v[48:49], v[104:105]
v_pk_mul_f32 v[106:107], v[50:51], v[106:107]
v_pk_mul_f32 v[108:109], v[52:53], v[108:109]
v_pk_mul_f32 v[110:111], v[54:55], v[110:111]
v_cvt_pk_bf16_f32 v56, v104, v105
v_cvt_pk_bf16_f32 v57, v106, v107
v_cvt_pk_bf16_f32 v58, v108, v109
v_cvt_pk_bf16_f32 v59, v110, v111
buffer_store_dwordx4 v[56:59], v251, s[4:7], s53 offen offset:1024 sc1
s_add_u32 s53, s53, s2
v_lshlrev_b32 v8, 16, v216
v_and_b32 v9, 0xffff0000, v216
v_lshlrev_b32 v10, 16, v217
v_and_b32 v11, 0xffff0000, v217
v_lshlrev_b32 v12, 16, v218
v_and_b32 v13, 0xffff0000, v218
v_lshlrev_b32 v14, 16, v219
v_and_b32 v15, 0xffff0000, v219
v_pk_add_f32 v[112:113], v[112:113], v[8:9]
v_pk_add_f32 v[114:115], v[114:115], v[10:11]
v_pk_add_f32 v[116:117], v[116:117], v[12:13]
v_pk_add_f32 v[118:119], v[118:119], v[14:15]
v_pk_mul_f32 v[8:9], v[112:113], v[246:247]
v_pk_mul_f32 v[10:11], v[114:115], v[246:247]
v_pk_mul_f32 v[12:13], v[116:117], v[246:247]
v_pk_mul_f32 v[14:15], v[118:119], v[246:247]
v_exp_f32 v8, v8
v_exp_f32 v9, v9
v_exp_f32 v10, v10
v_exp_f32 v11, v11
v_exp_f32 v12, v12
v_exp_f32 v13, v13
v_exp_f32 v14, v14
v_exp_f32 v15, v15
v_pk_add_f32 v[8:9], v[8:9], v[244:245]
v_pk_add_f32 v[10:11], v[10:11], v[244:245]
v_pk_add_f32 v[12:13], v[12:13], v[244:245]
v_pk_add_f32 v[14:15], v[14:15], v[244:245]
v_rcp_f32 v8, v8
v_rcp_f32 v9, v9
v_rcp_f32 v10, v10
v_rcp_f32 v11, v11
v_rcp_f32 v12, v12
v_rcp_f32 v13, v13
v_rcp_f32 v14, v14
v_rcp_f32 v15, v15
v_pk_mul_f32 v[112:113], v[8:9], v[112:113]
v_pk_mul_f32 v[114:115], v[10:11], v[114:115]
v_pk_mul_f32 v[116:117], v[12:13], v[116:117]
v_pk_mul_f32 v[118:119], v[14:15], v[118:119]
v_cvt_pk_bf16_f32 v16, v112, v113
v_cvt_pk_bf16_f32 v17, v114, v115
v_cvt_pk_bf16_f32 v18, v116, v117
v_cvt_pk_bf16_f32 v19, v118, v119
buffer_store_dwordx4 v[16:19], v251, s[4:7], s53 offen offset:0 sc1
v_lshlrev_b32 v28, 16, v220
v_and_b32 v29, 0xffff0000, v220
v_lshlrev_b32 v30, 16, v221
v_and_b32 v31, 0xffff0000, v221
v_lshlrev_b32 v32, 16, v222
v_and_b32 v33, 0xffff0000, v222
v_lshlrev_b32 v34, 16, v223
v_and_b32 v35, 0xffff0000, v223
v_pk_add_f32 v[120:121], v[120:121], v[28:29]
v_pk_add_f32 v[122:123], v[122:123], v[30:31]
v_pk_add_f32 v[124:125], v[124:125], v[32:33]
v_pk_add_f32 v[126:127], v[126:127], v[34:35]
v_pk_mul_f32 v[28:29], v[120:121], v[246:247]
v_pk_mul_f32 v[30:31], v[122:123], v[246:247]
v_pk_mul_f32 v[32:33], v[124:125], v[246:247]
v_pk_mul_f32 v[34:35], v[126:127], v[246:247]
v_exp_f32 v28, v28
v_exp_f32 v29, v29
v_exp_f32 v30, v30
v_exp_f32 v31, v31
v_exp_f32 v32, v32
v_exp_f32 v33, v33
v_exp_f32 v34, v34
v_exp_f32 v35, v35
v_pk_add_f32 v[28:29], v[28:29], v[244:245]
v_pk_add_f32 v[30:31], v[30:31], v[244:245]
v_pk_add_f32 v[32:33], v[32:33], v[244:245]
v_pk_add_f32 v[34:35], v[34:35], v[244:245]
v_rcp_f32 v28, v28
v_rcp_f32 v29, v29
v_rcp_f32 v30, v30
v_rcp_f32 v31, v31
v_rcp_f32 v32, v32
v_rcp_f32 v33, v33
v_rcp_f32 v34, v34
v_rcp_f32 v35, v35
v_pk_mul_f32 v[120:121], v[28:29], v[120:121]
v_pk_mul_f32 v[122:123], v[30:31], v[122:123]
v_pk_mul_f32 v[124:125], v[32:33], v[124:125]
v_pk_mul_f32 v[126:127], v[34:35], v[126:127]
v_cvt_pk_bf16_f32 v36, v120, v121
v_cvt_pk_bf16_f32 v37, v122, v123
v_cvt_pk_bf16_f32 v38, v124, v125
v_cvt_pk_bf16_f32 v39, v126, v127
buffer_store_dwordx4 v[36:39], v251, s[4:7], s53 offen offset:1024 sc1
s_branch main_kernel_w_ee
main_kernel_w_e5:
s_mov_b32 s53, s1
v_permlane16_swap_b32 v160, v162
v_permlane16_swap_b32 v161, v163
v_lshlrev_b32 v8, 16, v192
v_and_b32 v9, 0xffff0000, v192
v_lshlrev_b32 v10, 16, v193
v_and_b32 v11, 0xffff0000, v193
v_lshlrev_b32 v12, 16, v194
v_and_b32 v13, 0xffff0000, v194
v_lshlrev_b32 v14, 16, v195
v_and_b32 v15, 0xffff0000, v195
v_permlane32_swap_b32 v160, v162
v_permlane32_swap_b32 v161, v163
v_lshlrev_b32 v16, 16, v160
v_and_b32 v17, 0xffff0000, v160
v_lshlrev_b32 v18, 16, v161
v_and_b32 v19, 0xffff0000, v161
v_lshlrev_b32 v20, 16, v162
v_and_b32 v21, 0xffff0000, v162
v_lshlrev_b32 v22, 16, v163
v_and_b32 v23, 0xffff0000, v163
v_pk_fma_f32 v[8:9], v[64:65], v[8:9], v[16:17]
v_pk_fma_f32 v[10:11], v[66:67], v[10:11], v[18:19]
v_pk_fma_f32 v[12:13], v[68:69], v[12:13], v[20:21]
v_pk_fma_f32 v[14:15], v[70:71], v[14:15], v[22:23]
v_cvt_pk_bf16_f32 v24, v8, v9
v_cvt_pk_bf16_f32 v25, v10, v11
v_cvt_pk_bf16_f32 v26, v12, v13
v_cvt_pk_bf16_f32 v27, v14, v15
s_nop 0
v_permlane32_swap_b32 v24, v26
v_permlane32_swap_b32 v25, v27
s_nop 0
v_permlane16_swap_b32 v24, v26
v_permlane16_swap_b32 v25, v27
buffer_store_dwordx4 v[24:27], v145, s[92:95], s53 offen offset:0
v_permlane16_swap_b32 v164, v166
v_permlane16_swap_b32 v165, v167
v_lshlrev_b32 v36, 16, v196
v_and_b32 v37, 0xffff0000, v196
v_lshlrev_b32 v38, 16, v197
v_and_b32 v39, 0xffff0000, v197
v_lshlrev_b32 v40, 16, v198
v_and_b32 v41, 0xffff0000, v198
v_lshlrev_b32 v42, 16, v199
v_and_b32 v43, 0xffff0000, v199
v_permlane32_swap_b32 v164, v166
v_permlane32_swap_b32 v165, v167
v_lshlrev_b32 v44, 16, v164
v_and_b32 v45, 0xffff0000, v164
v_lshlrev_b32 v46, 16, v165
v_and_b32 v47, 0xffff0000, v165
v_lshlrev_b32 v48, 16, v166
v_and_b32 v49, 0xffff0000, v166
v_lshlrev_b32 v50, 16, v167
v_and_b32 v51, 0xffff0000, v167
v_pk_fma_f32 v[36:37], v[72:73], v[36:37], v[44:45]
v_pk_fma_f32 v[38:39], v[74:75], v[38:39], v[46:47]
v_pk_fma_f32 v[40:41], v[76:77], v[40:41], v[48:49]
v_pk_fma_f32 v[42:43], v[78:79], v[42:43], v[50:51]
v_cvt_pk_bf16_f32 v52, v36, v37
v_cvt_pk_bf16_f32 v53, v38, v39
v_cvt_pk_bf16_f32 v54, v40, v41
v_cvt_pk_bf16_f32 v55, v42, v43
s_nop 0
v_permlane32_swap_b32 v52, v54
v_permlane32_swap_b32 v53, v55
s_nop 0
v_permlane16_swap_b32 v52, v54
v_permlane16_swap_b32 v53, v55
buffer_store_dwordx4 v[52:55], v145, s[92:95], s53 offen offset:64
s_add_u32 s53, s53, 32768
v_permlane16_swap_b32 v168, v170
v_permlane16_swap_b32 v169, v171
v_lshlrev_b32 v8, 16, v200
v_and_b32 v9, 0xffff0000, v200
v_lshlrev_b32 v10, 16, v201
v_and_b32 v11, 0xffff0000, v201
v_lshlrev_b32 v12, 16, v202
v_and_b32 v13, 0xffff0000, v202
v_lshlrev_b32 v14, 16, v203
v_and_b32 v15, 0xffff0000, v203
v_permlane32_swap_b32 v168, v170
v_permlane32_swap_b32 v169, v171
v_lshlrev_b32 v16, 16, v168
v_and_b32 v17, 0xffff0000, v168
v_lshlrev_b32 v18, 16, v169
v_and_b32 v19, 0xffff0000, v169
v_lshlrev_b32 v20, 16, v170
v_and_b32 v21, 0xffff0000, v170
v_lshlrev_b32 v22, 16, v171
v_and_b32 v23, 0xffff0000, v171
v_pk_fma_f32 v[8:9], v[80:81], v[8:9], v[16:17]
v_pk_fma_f32 v[10:11], v[82:83], v[10:11], v[18:19]
v_pk_fma_f32 v[12:13], v[84:85], v[12:13], v[20:21]
v_pk_fma_f32 v[14:15], v[86:87], v[14:15], v[22:23]
v_cvt_pk_bf16_f32 v24, v8, v9
v_cvt_pk_bf16_f32 v25, v10, v11
v_cvt_pk_bf16_f32 v26, v12, v13
v_cvt_pk_bf16_f32 v27, v14, v15
s_nop 0
v_permlane32_swap_b32 v24, v26
v_permlane32_swap_b32 v25, v27
s_nop 0
v_permlane16_swap_b32 v24, v26
v_permlane16_swap_b32 v25, v27
buffer_store_dwordx4 v[24:27], v145, s[92:95], s53 offen offset:0
v_permlane16_swap_b32 v172, v174
v_permlane16_swap_b32 v173, v175
v_lshlrev_b32 v36, 16, v204
v_and_b32 v37, 0xffff0000, v204
v_lshlrev_b32 v38, 16, v205
v_and_b32 v39, 0xffff0000, v205
v_lshlrev_b32 v40, 16, v206
v_and_b32 v41, 0xffff0000, v206
v_lshlrev_b32 v42, 16, v207
v_and_b32 v43, 0xffff0000, v207
v_permlane32_swap_b32 v172, v174
v_permlane32_swap_b32 v173, v175
v_lshlrev_b32 v44, 16, v172
v_and_b32 v45, 0xffff0000, v172
v_lshlrev_b32 v46, 16, v173
v_and_b32 v47, 0xffff0000, v173
v_lshlrev_b32 v48, 16, v174
v_and_b32 v49, 0xffff0000, v174
v_lshlrev_b32 v50, 16, v175
v_and_b32 v51, 0xffff0000, v175
v_pk_fma_f32 v[36:37], v[88:89], v[36:37], v[44:45]
v_pk_fma_f32 v[38:39], v[90:91], v[38:39], v[46:47]
v_pk_fma_f32 v[40:41], v[92:93], v[40:41], v[48:49]
v_pk_fma_f32 v[42:43], v[94:95], v[42:43], v[50:51]
v_cvt_pk_bf16_f32 v52, v36, v37
v_cvt_pk_bf16_f32 v53, v38, v39
v_cvt_pk_bf16_f32 v54, v40, v41
v_cvt_pk_bf16_f32 v55, v42, v43
s_nop 0
v_permlane32_swap_b32 v52, v54
v_permlane32_swap_b32 v53, v55
s_nop 0
v_permlane16_swap_b32 v52, v54
v_permlane16_swap_b32 v53, v55
buffer_store_dwordx4 v[52:55], v145, s[92:95], s53 offen offset:64
s_add_u32 s53, s53, 32768
v_permlane16_swap_b32 v176, v178
v_permlane16_swap_b32 v177, v179
v_lshlrev_b32 v8, 16, v208
v_and_b32 v9, 0xffff0000, v208
v_lshlrev_b32 v10, 16, v209
v_and_b32 v11, 0xffff0000, v209
v_lshlrev_b32 v12, 16, v210
v_and_b32 v13, 0xffff0000, v210
v_lshlrev_b32 v14, 16, v211
v_and_b32 v15, 0xffff0000, v211
v_permlane32_swap_b32 v176, v178
v_permlane32_swap_b32 v177, v179
v_lshlrev_b32 v16, 16, v176
v_and_b32 v17, 0xffff0000, v176
v_lshlrev_b32 v18, 16, v177
v_and_b32 v19, 0xffff0000, v177
v_lshlrev_b32 v20, 16, v178
v_and_b32 v21, 0xffff0000, v178
v_lshlrev_b32 v22, 16, v179
v_and_b32 v23, 0xffff0000, v179
v_pk_fma_f32 v[8:9], v[96:97], v[8:9], v[16:17]
v_pk_fma_f32 v[10:11], v[98:99], v[10:11], v[18:19]
v_pk_fma_f32 v[12:13], v[100:101], v[12:13], v[20:21]
v_pk_fma_f32 v[14:15], v[102:103], v[14:15], v[22:23]
v_cvt_pk_bf16_f32 v24, v8, v9
v_cvt_pk_bf16_f32 v25, v10, v11
v_cvt_pk_bf16_f32 v26, v12, v13
v_cvt_pk_bf16_f32 v27, v14, v15
s_nop 0
v_permlane32_swap_b32 v24, v26
v_permlane32_swap_b32 v25, v27
s_nop 0
v_permlane16_swap_b32 v24, v26
v_permlane16_swap_b32 v25, v27
buffer_store_dwordx4 v[24:27], v145, s[92:95], s53 offen offset:0
v_permlane16_swap_b32 v180, v182
v_permlane16_swap_b32 v181, v183
v_lshlrev_b32 v36, 16, v212
v_and_b32 v37, 0xffff0000, v212
v_lshlrev_b32 v38, 16, v213
v_and_b32 v39, 0xffff0000, v213
v_lshlrev_b32 v40, 16, v214
v_and_b32 v41, 0xffff0000, v214
v_lshlrev_b32 v42, 16, v215
v_and_b32 v43, 0xffff0000, v215
v_permlane32_swap_b32 v180, v182
v_permlane32_swap_b32 v181, v183
v_lshlrev_b32 v44, 16, v180
v_and_b32 v45, 0xffff0000, v180
v_lshlrev_b32 v46, 16, v181
v_and_b32 v47, 0xffff0000, v181
v_lshlrev_b32 v48, 16, v182
v_and_b32 v49, 0xffff0000, v182
v_lshlrev_b32 v50, 16, v183
v_and_b32 v51, 0xffff0000, v183
v_pk_fma_f32 v[36:37], v[104:105], v[36:37], v[44:45]
v_pk_fma_f32 v[38:39], v[106:107], v[38:39], v[46:47]
v_pk_fma_f32 v[40:41], v[108:109], v[40:41], v[48:49]
v_pk_fma_f32 v[42:43], v[110:111], v[42:43], v[50:51]
v_cvt_pk_bf16_f32 v52, v36, v37
v_cvt_pk_bf16_f32 v53, v38, v39
v_cvt_pk_bf16_f32 v54, v40, v41
v_cvt_pk_bf16_f32 v55, v42, v43
s_nop 0
v_permlane32_swap_b32 v52, v54
v_permlane32_swap_b32 v53, v55
s_nop 0
v_permlane16_swap_b32 v52, v54
v_permlane16_swap_b32 v53, v55
buffer_store_dwordx4 v[52:55], v145, s[92:95], s53 offen offset:64
s_add_u32 s53, s53, 32768
v_permlane16_swap_b32 v184, v186
v_permlane16_swap_b32 v185, v187
v_lshlrev_b32 v8, 16, v216
v_and_b32 v9, 0xffff0000, v216
v_lshlrev_b32 v10, 16, v217
v_and_b32 v11, 0xffff0000, v217
v_lshlrev_b32 v12, 16, v218
v_and_b32 v13, 0xffff0000, v218
v_lshlrev_b32 v14, 16, v219
v_and_b32 v15, 0xffff0000, v219
v_permlane32_swap_b32 v184, v186
v_permlane32_swap_b32 v185, v187
v_lshlrev_b32 v16, 16, v184
v_and_b32 v17, 0xffff0000, v184
v_lshlrev_b32 v18, 16, v185
v_and_b32 v19, 0xffff0000, v185
v_lshlrev_b32 v20, 16, v186
v_and_b32 v21, 0xffff0000, v186
v_lshlrev_b32 v22, 16, v187
v_and_b32 v23, 0xffff0000, v187
v_pk_fma_f32 v[8:9], v[112:113], v[8:9], v[16:17]
v_pk_fma_f32 v[10:11], v[114:115], v[10:11], v[18:19]
v_pk_fma_f32 v[12:13], v[116:117], v[12:13], v[20:21]
v_pk_fma_f32 v[14:15], v[118:119], v[14:15], v[22:23]
v_cvt_pk_bf16_f32 v24, v8, v9
v_cvt_pk_bf16_f32 v25, v10, v11
v_cvt_pk_bf16_f32 v26, v12, v13
v_cvt_pk_bf16_f32 v27, v14, v15
s_nop 0
v_permlane32_swap_b32 v24, v26
v_permlane32_swap_b32 v25, v27
s_nop 0
v_permlane16_swap_b32 v24, v26
v_permlane16_swap_b32 v25, v27
buffer_store_dwordx4 v[24:27], v145, s[92:95], s53 offen offset:0
v_permlane16_swap_b32 v188, v190
v_permlane16_swap_b32 v189, v191
v_lshlrev_b32 v36, 16, v220
v_and_b32 v37, 0xffff0000, v220
v_lshlrev_b32 v38, 16, v221
v_and_b32 v39, 0xffff0000, v221
v_lshlrev_b32 v40, 16, v222
v_and_b32 v41, 0xffff0000, v222
v_lshlrev_b32 v42, 16, v223
v_and_b32 v43, 0xffff0000, v223
v_permlane32_swap_b32 v188, v190
v_permlane32_swap_b32 v189, v191
v_lshlrev_b32 v44, 16, v188
v_and_b32 v45, 0xffff0000, v188
v_lshlrev_b32 v46, 16, v189
v_and_b32 v47, 0xffff0000, v189
v_lshlrev_b32 v48, 16, v190
v_and_b32 v49, 0xffff0000, v190
v_lshlrev_b32 v50, 16, v191
v_and_b32 v51, 0xffff0000, v191
v_pk_fma_f32 v[36:37], v[120:121], v[36:37], v[44:45]
v_pk_fma_f32 v[38:39], v[122:123], v[38:39], v[46:47]
v_pk_fma_f32 v[40:41], v[124:125], v[40:41], v[48:49]
v_pk_fma_f32 v[42:43], v[126:127], v[42:43], v[50:51]
v_cvt_pk_bf16_f32 v52, v36, v37
v_cvt_pk_bf16_f32 v53, v38, v39
v_cvt_pk_bf16_f32 v54, v40, v41
v_cvt_pk_bf16_f32 v55, v42, v43
s_nop 0
v_permlane32_swap_b32 v52, v54
v_permlane32_swap_b32 v53, v55
s_nop 0
v_permlane16_swap_b32 v52, v54
v_permlane16_swap_b32 v53, v55
buffer_store_dwordx4 v[52:55], v145, s[92:95], s53 offen offset:64
s_branch main_kernel_w_ee
main_kernel_w_e6:
s_mov_b32 s53, s1
v_accvgpr_read_b32 v0, a0
v_accvgpr_read_b32 v1, a1
v_accvgpr_read_b32 v2, a2
v_accvgpr_read_b32 v3, a3
v_accvgpr_read_b32 v4, a4
v_accvgpr_read_b32 v5, a5
v_accvgpr_read_b32 v6, a6
v_accvgpr_read_b32 v7, a7
v_cvt_pk_bf16_f32 v16, v0, v1
v_cvt_pk_bf16_f32 v17, v2, v3
v_cvt_pk_bf16_f32 v18, v4, v5
v_cvt_pk_bf16_f32 v19, v6, v7
buffer_store_dwordx4 v[16:19], v251, s[4:7], s53 offen offset:0 sc1
v_accvgpr_read_b32 v20, a8
v_accvgpr_read_b32 v21, a9
v_accvgpr_read_b32 v22, a10
v_accvgpr_read_b32 v23, a11
v_accvgpr_read_b32 v24, a12
v_accvgpr_read_b32 v25, a13
v_accvgpr_read_b32 v26, a14
v_accvgpr_read_b32 v27, a15
v_cvt_pk_bf16_f32 v36, v20, v21
v_cvt_pk_bf16_f32 v37, v22, v23
v_cvt_pk_bf16_f32 v38, v24, v25
v_cvt_pk_bf16_f32 v39, v26, v27
buffer_store_dwordx4 v[36:39], v251, s[4:7], s53 offen offset:1024 sc1
v_accvgpr_read_b32 v40, a16
v_accvgpr_read_b32 v41, a17
v_accvgpr_read_b32 v42, a18
v_accvgpr_read_b32 v43, a19
v_accvgpr_read_b32 v44, a20
v_accvgpr_read_b32 v45, a21
v_accvgpr_read_b32 v46, a22
v_accvgpr_read_b32 v47, a23
v_cvt_pk_bf16_f32 v56, v40, v41
v_cvt_pk_bf16_f32 v57, v42, v43
v_cvt_pk_bf16_f32 v58, v44, v45
v_cvt_pk_bf16_f32 v59, v46, v47
buffer_store_dwordx4 v[56:59], v251, s[4:7], s53 offen offset:2048 sc1
v_accvgpr_read_b32 v0, a24
v_accvgpr_read_b32 v1, a25
v_accvgpr_read_b32 v2, a26
v_accvgpr_read_b32 v3, a27
v_accvgpr_read_b32 v4, a28
v_accvgpr_read_b32 v5, a29
v_accvgpr_read_b32 v6, a30
v_accvgpr_read_b32 v7, a31
v_cvt_pk_bf16_f32 v16, v0, v1
v_cvt_pk_bf16_f32 v17, v2, v3
v_cvt_pk_bf16_f32 v18, v4, v5
v_cvt_pk_bf16_f32 v19, v6, v7
buffer_store_dwordx4 v[16:19], v251, s[4:7], s53 offen offset:3072 sc1
s_add_u32 s53, s53, s2
v_accvgpr_read_b32 v20, a32
v_accvgpr_read_b32 v21, a33
v_accvgpr_read_b32 v22, a34
v_accvgpr_read_b32 v23, a35
v_accvgpr_read_b32 v24, a36
v_accvgpr_read_b32 v25, a37
v_accvgpr_read_b32 v26, a38
v_accvgpr_read_b32 v27, a39
v_cvt_pk_bf16_f32 v36, v20, v21
v_cvt_pk_bf16_f32 v37, v22, v23
v_cvt_pk_bf16_f32 v38, v24, v25
v_cvt_pk_bf16_f32 v39, v26, v27
buffer_store_dwordx4 v[36:39], v251, s[4:7], s53 offen offset:0 sc1
v_accvgpr_read_b32 v40, a40
v_accvgpr_read_b32 v41, a41
v_accvgpr_read_b32 v42, a42
v_accvgpr_read_b32 v43, a43
v_accvgpr_read_b32 v44, a44
v_accvgpr_read_b32 v45, a45
v_accvgpr_read_b32 v46, a46
v_accvgpr_read_b32 v47, a47
v_cvt_pk_bf16_f32 v56, v40, v41
v_cvt_pk_bf16_f32 v57, v42, v43
v_cvt_pk_bf16_f32 v58, v44, v45
v_cvt_pk_bf16_f32 v59, v46, v47
buffer_store_dwordx4 v[56:59], v251, s[4:7], s53 offen offset:1024 sc1
v_accvgpr_read_b32 v0, a48
v_accvgpr_read_b32 v1, a49
v_accvgpr_read_b32 v2, a50
v_accvgpr_read_b32 v3, a51
v_accvgpr_read_b32 v4, a52
v_accvgpr_read_b32 v5, a53
v_accvgpr_read_b32 v6, a54
v_accvgpr_read_b32 v7, a55
v_cvt_pk_bf16_f32 v16, v0, v1
v_cvt_pk_bf16_f32 v17, v2, v3
v_cvt_pk_bf16_f32 v18, v4, v5
v_cvt_pk_bf16_f32 v19, v6, v7
buffer_store_dwordx4 v[16:19], v251, s[4:7], s53 offen offset:2048 sc1
v_accvgpr_read_b32 v20, a56
v_accvgpr_read_b32 v21, a57
v_accvgpr_read_b32 v22, a58
v_accvgpr_read_b32 v23, a59
v_accvgpr_read_b32 v24, a60
v_accvgpr_read_b32 v25, a61
v_accvgpr_read_b32 v26, a62
v_accvgpr_read_b32 v27, a63
v_cvt_pk_bf16_f32 v36, v20, v21
v_cvt_pk_bf16_f32 v37, v22, v23
v_cvt_pk_bf16_f32 v38, v24, v25
v_cvt_pk_bf16_f32 v39, v26, v27
buffer_store_dwordx4 v[36:39], v251, s[4:7], s53 offen offset:3072 sc1
s_add_u32 s53, s53, s2
v_accvgpr_read_b32 v40, a64
v_accvgpr_read_b32 v41, a65
v_accvgpr_read_b32 v42, a66
v_accvgpr_read_b32 v43, a67
v_accvgpr_read_b32 v44, a68
v_accvgpr_read_b32 v45, a69
v_accvgpr_read_b32 v46, a70
v_accvgpr_read_b32 v47, a71
v_cvt_pk_bf16_f32 v56, v40, v41
v_cvt_pk_bf16_f32 v57, v42, v43
v_cvt_pk_bf16_f32 v58, v44, v45
v_cvt_pk_bf16_f32 v59, v46, v47
buffer_store_dwordx4 v[56:59], v251, s[4:7], s53 offen offset:0 sc1
v_accvgpr_read_b32 v0, a72
v_accvgpr_read_b32 v1, a73
v_accvgpr_read_b32 v2, a74
v_accvgpr_read_b32 v3, a75
v_accvgpr_read_b32 v4, a76
v_accvgpr_read_b32 v5, a77
v_accvgpr_read_b32 v6, a78
v_accvgpr_read_b32 v7, a79
v_cvt_pk_bf16_f32 v16, v0, v1
v_cvt_pk_bf16_f32 v17, v2, v3
v_cvt_pk_bf16_f32 v18, v4, v5
v_cvt_pk_bf16_f32 v19, v6, v7
buffer_store_dwordx4 v[16:19], v251, s[4:7], s53 offen offset:1024 sc1
v_accvgpr_read_b32 v20, a80
v_accvgpr_read_b32 v21, a81
v_accvgpr_read_b32 v22, a82
v_accvgpr_read_b32 v23, a83
v_accvgpr_read_b32 v24, a84
v_accvgpr_read_b32 v25, a85
v_accvgpr_read_b32 v26, a86
v_accvgpr_read_b32 v27, a87
v_cvt_pk_bf16_f32 v36, v20, v21
v_cvt_pk_bf16_f32 v37, v22, v23
v_cvt_pk_bf16_f32 v38, v24, v25
v_cvt_pk_bf16_f32 v39, v26, v27
buffer_store_dwordx4 v[36:39], v251, s[4:7], s53 offen offset:2048 sc1
v_accvgpr_read_b32 v40, a88
v_accvgpr_read_b32 v41, a89
v_accvgpr_read_b32 v42, a90
v_accvgpr_read_b32 v43, a91
v_accvgpr_read_b32 v44, a92
v_accvgpr_read_b32 v45, a93
v_accvgpr_read_b32 v46, a94
v_accvgpr_read_b32 v47, a95
v_cvt_pk_bf16_f32 v56, v40, v41
v_cvt_pk_bf16_f32 v57, v42, v43
v_cvt_pk_bf16_f32 v58, v44, v45
v_cvt_pk_bf16_f32 v59, v46, v47
buffer_store_dwordx4 v[56:59], v251, s[4:7], s53 offen offset:3072 sc1
s_add_u32 s53, s53, s2
v_accvgpr_read_b32 v0, a96
v_accvgpr_read_b32 v1, a97
v_accvgpr_read_b32 v2, a98
v_accvgpr_read_b32 v3, a99
v_accvgpr_read_b32 v4, a100
v_accvgpr_read_b32 v5, a101
v_accvgpr_read_b32 v6, a102
v_accvgpr_read_b32 v7, a103
v_cvt_pk_bf16_f32 v16, v0, v1
v_cvt_pk_bf16_f32 v17, v2, v3
v_cvt_pk_bf16_f32 v18, v4, v5
v_cvt_pk_bf16_f32 v19, v6, v7
buffer_store_dwordx4 v[16:19], v251, s[4:7], s53 offen offset:0 sc1
v_accvgpr_read_b32 v20, a104
v_accvgpr_read_b32 v21, a105
v_accvgpr_read_b32 v22, a106
v_accvgpr_read_b32 v23, a107
v_accvgpr_read_b32 v24, a108
v_accvgpr_read_b32 v25, a109
v_accvgpr_read_b32 v26, a110
v_accvgpr_read_b32 v27, a111
v_cvt_pk_bf16_f32 v36, v20, v21
v_cvt_pk_bf16_f32 v37, v22, v23
v_cvt_pk_bf16_f32 v38, v24, v25
v_cvt_pk_bf16_f32 v39, v26, v27
buffer_store_dwordx4 v[36:39], v251, s[4:7], s53 offen offset:1024 sc1
v_accvgpr_read_b32 v40, a112
v_accvgpr_read_b32 v41, a113
v_accvgpr_read_b32 v42, a114
v_accvgpr_read_b32 v43, a115
v_accvgpr_read_b32 v44, a116
v_accvgpr_read_b32 v45, a117
v_accvgpr_read_b32 v46, a118
v_accvgpr_read_b32 v47, a119
v_cvt_pk_bf16_f32 v56, v40, v41
v_cvt_pk_bf16_f32 v57, v42, v43
v_cvt_pk_bf16_f32 v58, v44, v45
v_cvt_pk_bf16_f32 v59, v46, v47
buffer_store_dwordx4 v[56:59], v251, s[4:7], s53 offen offset:2048 sc1
v_accvgpr_read_b32 v0, a120
v_accvgpr_read_b32 v1, a121
v_accvgpr_read_b32 v2, a122
v_accvgpr_read_b32 v3, a123
v_accvgpr_read_b32 v4, a124
v_accvgpr_read_b32 v5, a125
v_accvgpr_read_b32 v6, a126
v_accvgpr_read_b32 v7, a127
v_cvt_pk_bf16_f32 v16, v0, v1
v_cvt_pk_bf16_f32 v17, v2, v3
v_cvt_pk_bf16_f32 v18, v4, v5
v_cvt_pk_bf16_f32 v19, v6, v7
buffer_store_dwordx4 v[16:19], v251, s[4:7], s53 offen offset:3072 sc1
s_branch main_kernel_w_ee
main_kernel_w_e7:
s_mov_b32 s53, s1
v_accvgpr_read_b32 v0, a0
v_accvgpr_read_b32 v1, a1
v_accvgpr_read_b32 v2, a2
v_accvgpr_read_b32 v3, a3
v_accvgpr_read_b32 v4, a4
v_accvgpr_read_b32 v5, a5
v_accvgpr_read_b32 v6, a6
v_accvgpr_read_b32 v7, a7
v_mul_f32 v0, 0x3e0293ee, v0
v_mul_f32 v1, 0x3e0293ee, v1
v_mul_f32 v2, 0x3e0293ee, v2
v_mul_f32 v3, 0x3e0293ee, v3
v_mul_f32 v4, 0x3e0293ee, v4
v_mul_f32 v5, 0x3e0293ee, v5
v_mul_f32 v6, 0x3e0293ee, v6
v_mul_f32 v7, 0x3e0293ee, v7
v_cvt_pk_bf16_f32 v16, v0, v1
v_cvt_pk_bf16_f32 v17, v2, v3
v_cvt_pk_bf16_f32 v18, v4, v5
v_cvt_pk_bf16_f32 v19, v6, v7
buffer_store_dwordx4 v[16:19], v251, s[4:7], s53 offen offset:0 sc1
v_accvgpr_read_b32 v20, a8
v_accvgpr_read_b32 v21, a9
v_accvgpr_read_b32 v22, a10
v_accvgpr_read_b32 v23, a11
v_accvgpr_read_b32 v24, a12
v_accvgpr_read_b32 v25, a13
v_accvgpr_read_b32 v26, a14
v_accvgpr_read_b32 v27, a15
v_mul_f32 v20, 0x3e0293ee, v20
v_mul_f32 v21, 0x3e0293ee, v21
v_mul_f32 v22, 0x3e0293ee, v22
v_mul_f32 v23, 0x3e0293ee, v23
v_mul_f32 v24, 0x3e0293ee, v24
v_mul_f32 v25, 0x3e0293ee, v25
v_mul_f32 v26, 0x3e0293ee, v26
v_mul_f32 v27, 0x3e0293ee, v27
v_cvt_pk_bf16_f32 v36, v20, v21
v_cvt_pk_bf16_f32 v37, v22, v23
v_cvt_pk_bf16_f32 v38, v24, v25
v_cvt_pk_bf16_f32 v39, v26, v27
buffer_store_dwordx4 v[36:39], v251, s[4:7], s53 offen offset:1024 sc1
v_accvgpr_read_b32 v40, a16
v_accvgpr_read_b32 v41, a17
v_accvgpr_read_b32 v42, a18
v_accvgpr_read_b32 v43, a19
v_accvgpr_read_b32 v44, a20
v_accvgpr_read_b32 v45, a21
v_accvgpr_read_b32 v46, a22
v_accvgpr_read_b32 v47, a23
v_mul_f32 v40, 0x3e0293ee, v40
v_mul_f32 v41, 0x3e0293ee, v41
v_mul_f32 v42, 0x3e0293ee, v42
v_mul_f32 v43, 0x3e0293ee, v43
v_mul_f32 v44, 0x3e0293ee, v44
v_mul_f32 v45, 0x3e0293ee, v45
v_mul_f32 v46, 0x3e0293ee, v46
v_mul_f32 v47, 0x3e0293ee, v47
v_cvt_pk_bf16_f32 v56, v40, v41
v_cvt_pk_bf16_f32 v57, v42, v43
v_cvt_pk_bf16_f32 v58, v44, v45
v_cvt_pk_bf16_f32 v59, v46, v47
buffer_store_dwordx4 v[56:59], v251, s[4:7], s53 offen offset:2048 sc1
v_accvgpr_read_b32 v0, a24
v_accvgpr_read_b32 v1, a25
v_accvgpr_read_b32 v2, a26
v_accvgpr_read_b32 v3, a27
v_accvgpr_read_b32 v4, a28
v_accvgpr_read_b32 v5, a29
v_accvgpr_read_b32 v6, a30
v_accvgpr_read_b32 v7, a31
v_mul_f32 v0, 0x3e0293ee, v0
v_mul_f32 v1, 0x3e0293ee, v1
v_mul_f32 v2, 0x3e0293ee, v2
v_mul_f32 v3, 0x3e0293ee, v3
v_mul_f32 v4, 0x3e0293ee, v4
v_mul_f32 v5, 0x3e0293ee, v5
v_mul_f32 v6, 0x3e0293ee, v6
v_mul_f32 v7, 0x3e0293ee, v7
v_cvt_pk_bf16_f32 v16, v0, v1
v_cvt_pk_bf16_f32 v17, v2, v3
v_cvt_pk_bf16_f32 v18, v4, v5
v_cvt_pk_bf16_f32 v19, v6, v7
buffer_store_dwordx4 v[16:19], v251, s[4:7], s53 offen offset:3072 sc1
s_add_u32 s53, s53, s2
v_accvgpr_read_b32 v20, a32
v_accvgpr_read_b32 v21, a33
v_accvgpr_read_b32 v22, a34
v_accvgpr_read_b32 v23, a35
v_accvgpr_read_b32 v24, a36
v_accvgpr_read_b32 v25, a37
v_accvgpr_read_b32 v26, a38
v_accvgpr_read_b32 v27, a39
v_mul_f32 v20, 0x3e0293ee, v20
v_mul_f32 v21, 0x3e0293ee, v21
v_mul_f32 v22, 0x3e0293ee, v22
v_mul_f32 v23, 0x3e0293ee, v23
v_mul_f32 v24, 0x3e0293ee, v24
v_mul_f32 v25, 0x3e0293ee, v25
v_mul_f32 v26, 0x3e0293ee, v26
v_mul_f32 v27, 0x3e0293ee, v27
v_cvt_pk_bf16_f32 v36, v20, v21
v_cvt_pk_bf16_f32 v37, v22, v23
v_cvt_pk_bf16_f32 v38, v24, v25
v_cvt_pk_bf16_f32 v39, v26, v27
buffer_store_dwordx4 v[36:39], v251, s[4:7], s53 offen offset:0 sc1
v_accvgpr_read_b32 v40, a40
v_accvgpr_read_b32 v41, a41
v_accvgpr_read_b32 v42, a42
v_accvgpr_read_b32 v43, a43
v_accvgpr_read_b32 v44, a44
v_accvgpr_read_b32 v45, a45
v_accvgpr_read_b32 v46, a46
v_accvgpr_read_b32 v47, a47
v_mul_f32 v40, 0x3e0293ee, v40
v_mul_f32 v41, 0x3e0293ee, v41
v_mul_f32 v42, 0x3e0293ee, v42
v_mul_f32 v43, 0x3e0293ee, v43
v_mul_f32 v44, 0x3e0293ee, v44
v_mul_f32 v45, 0x3e0293ee, v45
v_mul_f32 v46, 0x3e0293ee, v46
v_mul_f32 v47, 0x3e0293ee, v47
v_cvt_pk_bf16_f32 v56, v40, v41
v_cvt_pk_bf16_f32 v57, v42, v43
v_cvt_pk_bf16_f32 v58, v44, v45
v_cvt_pk_bf16_f32 v59, v46, v47
buffer_store_dwordx4 v[56:59], v251, s[4:7], s53 offen offset:1024 sc1
v_accvgpr_read_b32 v0, a48
v_accvgpr_read_b32 v1, a49
v_accvgpr_read_b32 v2, a50
v_accvgpr_read_b32 v3, a51
v_accvgpr_read_b32 v4, a52
v_accvgpr_read_b32 v5, a53
v_accvgpr_read_b32 v6, a54
v_accvgpr_read_b32 v7, a55
v_mul_f32 v0, 0x3e0293ee, v0
v_mul_f32 v1, 0x3e0293ee, v1
v_mul_f32 v2, 0x3e0293ee, v2
v_mul_f32 v3, 0x3e0293ee, v3
v_mul_f32 v4, 0x3e0293ee, v4
v_mul_f32 v5, 0x3e0293ee, v5
v_mul_f32 v6, 0x3e0293ee, v6
v_mul_f32 v7, 0x3e0293ee, v7
v_cvt_pk_bf16_f32 v16, v0, v1
v_cvt_pk_bf16_f32 v17, v2, v3
v_cvt_pk_bf16_f32 v18, v4, v5
v_cvt_pk_bf16_f32 v19, v6, v7
buffer_store_dwordx4 v[16:19], v251, s[4:7], s53 offen offset:2048 sc1
v_accvgpr_read_b32 v20, a56
v_accvgpr_read_b32 v21, a57
v_accvgpr_read_b32 v22, a58
v_accvgpr_read_b32 v23, a59
v_accvgpr_read_b32 v24, a60
v_accvgpr_read_b32 v25, a61
v_accvgpr_read_b32 v26, a62
v_accvgpr_read_b32 v27, a63
v_mul_f32 v20, 0x3e0293ee, v20
v_mul_f32 v21, 0x3e0293ee, v21
v_mul_f32 v22, 0x3e0293ee, v22
v_mul_f32 v23, 0x3e0293ee, v23
v_mul_f32 v24, 0x3e0293ee, v24
v_mul_f32 v25, 0x3e0293ee, v25
v_mul_f32 v26, 0x3e0293ee, v26
v_mul_f32 v27, 0x3e0293ee, v27
v_cvt_pk_bf16_f32 v36, v20, v21
v_cvt_pk_bf16_f32 v37, v22, v23
v_cvt_pk_bf16_f32 v38, v24, v25
v_cvt_pk_bf16_f32 v39, v26, v27
buffer_store_dwordx4 v[36:39], v251, s[4:7], s53 offen offset:3072 sc1
s_add_u32 s53, s53, s2
v_accvgpr_read_b32 v40, a64
v_accvgpr_read_b32 v41, a65
v_accvgpr_read_b32 v42, a66
v_accvgpr_read_b32 v43, a67
v_accvgpr_read_b32 v44, a68
v_accvgpr_read_b32 v45, a69
v_accvgpr_read_b32 v46, a70
v_accvgpr_read_b32 v47, a71
v_mul_f32 v40, 0x3e0293ee, v40
v_mul_f32 v41, 0x3e0293ee, v41
v_mul_f32 v42, 0x3e0293ee, v42
v_mul_f32 v43, 0x3e0293ee, v43
v_mul_f32 v44, 0x3e0293ee, v44
v_mul_f32 v45, 0x3e0293ee, v45
v_mul_f32 v46, 0x3e0293ee, v46
v_mul_f32 v47, 0x3e0293ee, v47
v_cvt_pk_bf16_f32 v56, v40, v41
v_cvt_pk_bf16_f32 v57, v42, v43
v_cvt_pk_bf16_f32 v58, v44, v45
v_cvt_pk_bf16_f32 v59, v46, v47
buffer_store_dwordx4 v[56:59], v251, s[4:7], s53 offen offset:0 sc1
v_accvgpr_read_b32 v0, a72
v_accvgpr_read_b32 v1, a73
v_accvgpr_read_b32 v2, a74
v_accvgpr_read_b32 v3, a75
v_accvgpr_read_b32 v4, a76
v_accvgpr_read_b32 v5, a77
v_accvgpr_read_b32 v6, a78
v_accvgpr_read_b32 v7, a79
v_mul_f32 v0, 0x3e0293ee, v0
v_mul_f32 v1, 0x3e0293ee, v1
v_mul_f32 v2, 0x3e0293ee, v2
v_mul_f32 v3, 0x3e0293ee, v3
v_mul_f32 v4, 0x3e0293ee, v4
v_mul_f32 v5, 0x3e0293ee, v5
v_mul_f32 v6, 0x3e0293ee, v6
v_mul_f32 v7, 0x3e0293ee, v7
v_cvt_pk_bf16_f32 v16, v0, v1
v_cvt_pk_bf16_f32 v17, v2, v3
v_cvt_pk_bf16_f32 v18, v4, v5
v_cvt_pk_bf16_f32 v19, v6, v7
buffer_store_dwordx4 v[16:19], v251, s[4:7], s53 offen offset:1024 sc1
v_accvgpr_read_b32 v20, a80
v_accvgpr_read_b32 v21, a81
v_accvgpr_read_b32 v22, a82
v_accvgpr_read_b32 v23, a83
v_accvgpr_read_b32 v24, a84
v_accvgpr_read_b32 v25, a85
v_accvgpr_read_b32 v26, a86
v_accvgpr_read_b32 v27, a87
v_mul_f32 v20, 0x3e0293ee, v20
v_mul_f32 v21, 0x3e0293ee, v21
v_mul_f32 v22, 0x3e0293ee, v22
v_mul_f32 v23, 0x3e0293ee, v23
v_mul_f32 v24, 0x3e0293ee, v24
v_mul_f32 v25, 0x3e0293ee, v25
v_mul_f32 v26, 0x3e0293ee, v26
v_mul_f32 v27, 0x3e0293ee, v27
v_cvt_pk_bf16_f32 v36, v20, v21
v_cvt_pk_bf16_f32 v37, v22, v23
v_cvt_pk_bf16_f32 v38, v24, v25
v_cvt_pk_bf16_f32 v39, v26, v27
buffer_store_dwordx4 v[36:39], v251, s[4:7], s53 offen offset:2048 sc1
v_accvgpr_read_b32 v40, a88
v_accvgpr_read_b32 v41, a89
v_accvgpr_read_b32 v42, a90
v_accvgpr_read_b32 v43, a91
v_accvgpr_read_b32 v44, a92
v_accvgpr_read_b32 v45, a93
v_accvgpr_read_b32 v46, a94
v_accvgpr_read_b32 v47, a95
v_mul_f32 v40, 0x3e0293ee, v40
v_mul_f32 v41, 0x3e0293ee, v41
v_mul_f32 v42, 0x3e0293ee, v42
v_mul_f32 v43, 0x3e0293ee, v43
v_mul_f32 v44, 0x3e0293ee, v44
v_mul_f32 v45, 0x3e0293ee, v45
v_mul_f32 v46, 0x3e0293ee, v46
v_mul_f32 v47, 0x3e0293ee, v47
v_cvt_pk_bf16_f32 v56, v40, v41
v_cvt_pk_bf16_f32 v57, v42, v43
v_cvt_pk_bf16_f32 v58, v44, v45
v_cvt_pk_bf16_f32 v59, v46, v47
buffer_store_dwordx4 v[56:59], v251, s[4:7], s53 offen offset:3072 sc1
s_add_u32 s53, s53, s2
v_accvgpr_read_b32 v0, a96
v_accvgpr_read_b32 v1, a97
v_accvgpr_read_b32 v2, a98
v_accvgpr_read_b32 v3, a99
v_accvgpr_read_b32 v4, a100
v_accvgpr_read_b32 v5, a101
v_accvgpr_read_b32 v6, a102
v_accvgpr_read_b32 v7, a103
v_mul_f32 v0, 0x3e0293ee, v0
v_mul_f32 v1, 0x3e0293ee, v1
v_mul_f32 v2, 0x3e0293ee, v2
v_mul_f32 v3, 0x3e0293ee, v3
v_mul_f32 v4, 0x3e0293ee, v4
v_mul_f32 v5, 0x3e0293ee, v5
v_mul_f32 v6, 0x3e0293ee, v6
v_mul_f32 v7, 0x3e0293ee, v7
v_cvt_pk_bf16_f32 v16, v0, v1
v_cvt_pk_bf16_f32 v17, v2, v3
v_cvt_pk_bf16_f32 v18, v4, v5
v_cvt_pk_bf16_f32 v19, v6, v7
buffer_store_dwordx4 v[16:19], v251, s[4:7], s53 offen offset:0 sc1
v_accvgpr_read_b32 v20, a104
v_accvgpr_read_b32 v21, a105
v_accvgpr_read_b32 v22, a106
v_accvgpr_read_b32 v23, a107
v_accvgpr_read_b32 v24, a108
v_accvgpr_read_b32 v25, a109
v_accvgpr_read_b32 v26, a110
v_accvgpr_read_b32 v27, a111
v_mul_f32 v20, 0x3e0293ee, v20
v_mul_f32 v21, 0x3e0293ee, v21
v_mul_f32 v22, 0x3e0293ee, v22
v_mul_f32 v23, 0x3e0293ee, v23
v_mul_f32 v24, 0x3e0293ee, v24
v_mul_f32 v25, 0x3e0293ee, v25
v_mul_f32 v26, 0x3e0293ee, v26
v_mul_f32 v27, 0x3e0293ee, v27
v_cvt_pk_bf16_f32 v36, v20, v21
v_cvt_pk_bf16_f32 v37, v22, v23
v_cvt_pk_bf16_f32 v38, v24, v25
v_cvt_pk_bf16_f32 v39, v26, v27
buffer_store_dwordx4 v[36:39], v251, s[4:7], s53 offen offset:1024 sc1
v_accvgpr_read_b32 v40, a112
v_accvgpr_read_b32 v41, a113
v_accvgpr_read_b32 v42, a114
v_accvgpr_read_b32 v43, a115
v_accvgpr_read_b32 v44, a116
v_accvgpr_read_b32 v45, a117
v_accvgpr_read_b32 v46, a118
v_accvgpr_read_b32 v47, a119
v_mul_f32 v40, 0x3e0293ee, v40
v_mul_f32 v41, 0x3e0293ee, v41
v_mul_f32 v42, 0x3e0293ee, v42
v_mul_f32 v43, 0x3e0293ee, v43
v_mul_f32 v44, 0x3e0293ee, v44
v_mul_f32 v45, 0x3e0293ee, v45
v_mul_f32 v46, 0x3e0293ee, v46
v_mul_f32 v47, 0x3e0293ee, v47
v_cvt_pk_bf16_f32 v56, v40, v41
v_cvt_pk_bf16_f32 v57, v42, v43
v_cvt_pk_bf16_f32 v58, v44, v45
v_cvt_pk_bf16_f32 v59, v46, v47
buffer_store_dwordx4 v[56:59], v251, s[4:7], s53 offen offset:2048 sc1
v_accvgpr_read_b32 v0, a120
v_accvgpr_read_b32 v1, a121
v_accvgpr_read_b32 v2, a122
v_accvgpr_read_b32 v3, a123
v_accvgpr_read_b32 v4, a124
v_accvgpr_read_b32 v5, a125
v_accvgpr_read_b32 v6, a126
v_accvgpr_read_b32 v7, a127
v_mul_f32 v0, 0x3e0293ee, v0
v_mul_f32 v1, 0x3e0293ee, v1
v_mul_f32 v2, 0x3e0293ee, v2
v_mul_f32 v3, 0x3e0293ee, v3
v_mul_f32 v4, 0x3e0293ee, v4
v_mul_f32 v5, 0x3e0293ee, v5
v_mul_f32 v6, 0x3e0293ee, v6
v_mul_f32 v7, 0x3e0293ee, v7
v_cvt_pk_bf16_f32 v16, v0, v1
v_cvt_pk_bf16_f32 v17, v2, v3
v_cvt_pk_bf16_f32 v18, v4, v5
v_cvt_pk_bf16_f32 v19, v6, v7
buffer_store_dwordx4 v[16:19], v251, s[4:7], s53 offen offset:3072 sc1
s_branch main_kernel_w_ee
main_kernel_w_e8:
s_mov_b32 s53, s1
v_accvgpr_read_b32 v0, a0
v_accvgpr_read_b32 v1, a1
v_accvgpr_read_b32 v2, a2
v_accvgpr_read_b32 v3, a3
v_accvgpr_read_b32 v4, a32
v_accvgpr_read_b32 v5, a33
v_accvgpr_read_b32 v6, a34
v_accvgpr_read_b32 v7, a35
v_cvt_pk_bf16_f32 v8, v0, v1
v_cvt_pk_bf16_f32 v9, v2, v3
v_cvt_pk_bf16_f32 v10, v4, v5
v_cvt_pk_bf16_f32 v11, v6, v7
buffer_store_dwordx4 v[8:11], v251, s[4:7], s53 offen offset:0 sc1
v_accvgpr_read_b32 v16, a4
v_accvgpr_read_b32 v17, a5
v_accvgpr_read_b32 v18, a6
v_accvgpr_read_b32 v19, a7
v_accvgpr_read_b32 v20, a36
v_accvgpr_read_b32 v21, a37
v_accvgpr_read_b32 v22, a38
v_accvgpr_read_b32 v23, a39
v_cvt_pk_bf16_f32 v24, v16, v17
v_cvt_pk_bf16_f32 v25, v18, v19
v_cvt_pk_bf16_f32 v26, v20, v21
v_cvt_pk_bf16_f32 v27, v22, v23
buffer_store_dwordx4 v[24:27], v251, s[4:7], s53 offen offset:1024 sc1
v_accvgpr_read_b32 v32, a8
v_accvgpr_read_b32 v33, a9
v_accvgpr_read_b32 v34, a10
v_accvgpr_read_b32 v35, a11
v_accvgpr_read_b32 v36, a40
v_accvgpr_read_b32 v37, a41
v_accvgpr_read_b32 v38, a42
v_accvgpr_read_b32 v39, a43
v_cvt_pk_bf16_f32 v40, v32, v33
v_cvt_pk_bf16_f32 v41, v34, v35
v_cvt_pk_bf16_f32 v42, v36, v37
v_cvt_pk_bf16_f32 v43, v38, v39
buffer_store_dwordx4 v[40:43], v251, s[4:7], s53 offen offset:2048 sc1
v_accvgpr_read_b32 v48, a12
v_accvgpr_read_b32 v49, a13
v_accvgpr_read_b32 v50, a14
v_accvgpr_read_b32 v51, a15
v_accvgpr_read_b32 v52, a44
v_accvgpr_read_b32 v53, a45
v_accvgpr_read_b32 v54, a46
v_accvgpr_read_b32 v55, a47
v_cvt_pk_bf16_f32 v56, v48, v49
v_cvt_pk_bf16_f32 v57, v50, v51
v_cvt_pk_bf16_f32 v58, v52, v53
v_cvt_pk_bf16_f32 v59, v54, v55
buffer_store_dwordx4 v[56:59], v251, s[4:7], s53 offen offset:3072 sc1
s_add_u32 s53, s53, 4096
v_accvgpr_read_b32 v0, a16
v_accvgpr_read_b32 v1, a17
v_accvgpr_read_b32 v2, a18
v_accvgpr_read_b32 v3, a19
v_accvgpr_read_b32 v4, a48
v_accvgpr_read_b32 v5, a49
v_accvgpr_read_b32 v6, a50
v_accvgpr_read_b32 v7, a51
v_cvt_pk_bf16_f32 v8, v0, v1
v_cvt_pk_bf16_f32 v9, v2, v3
v_cvt_pk_bf16_f32 v10, v4, v5
v_cvt_pk_bf16_f32 v11, v6, v7
buffer_store_dwordx4 v[8:11], v251, s[4:7], s53 offen offset:0 sc1
v_accvgpr_read_b32 v16, a20
v_accvgpr_read_b32 v17, a21
v_accvgpr_read_b32 v18, a22
v_accvgpr_read_b32 v19, a23
v_accvgpr_read_b32 v20, a52
v_accvgpr_read_b32 v21, a53
v_accvgpr_read_b32 v22, a54
v_accvgpr_read_b32 v23, a55
v_cvt_pk_bf16_f32 v24, v16, v17
v_cvt_pk_bf16_f32 v25, v18, v19
v_cvt_pk_bf16_f32 v26, v20, v21
v_cvt_pk_bf16_f32 v27, v22, v23
buffer_store_dwordx4 v[24:27], v251, s[4:7], s53 offen offset:1024 sc1
v_accvgpr_read_b32 v32, a24
v_accvgpr_read_b32 v33, a25
v_accvgpr_read_b32 v34, a26
v_accvgpr_read_b32 v35, a27
v_accvgpr_read_b32 v36, a56
v_accvgpr_read_b32 v37, a57
v_accvgpr_read_b32 v38, a58
v_accvgpr_read_b32 v39, a59
v_cvt_pk_bf16_f32 v40, v32, v33
v_cvt_pk_bf16_f32 v41, v34, v35
v_cvt_pk_bf16_f32 v42, v36, v37
v_cvt_pk_bf16_f32 v43, v38, v39
buffer_store_dwordx4 v[40:43], v251, s[4:7], s53 offen offset:2048 sc1
v_accvgpr_read_b32 v48, a28
v_accvgpr_read_b32 v49, a29
v_accvgpr_read_b32 v50, a30
v_accvgpr_read_b32 v51, a31
v_accvgpr_read_b32 v52, a60
v_accvgpr_read_b32 v53, a61
v_accvgpr_read_b32 v54, a62
v_accvgpr_read_b32 v55, a63
v_cvt_pk_bf16_f32 v56, v48, v49
v_cvt_pk_bf16_f32 v57, v50, v51
v_cvt_pk_bf16_f32 v58, v52, v53
v_cvt_pk_bf16_f32 v59, v54, v55
buffer_store_dwordx4 v[56:59], v251, s[4:7], s53 offen offset:3072 sc1
s_add_u32 s53, s53, 258048
v_accvgpr_read_b32 v0, a64
v_accvgpr_read_b32 v1, a65
v_accvgpr_read_b32 v2, a66
v_accvgpr_read_b32 v3, a67
v_accvgpr_read_b32 v4, a96
v_accvgpr_read_b32 v5, a97
v_accvgpr_read_b32 v6, a98
v_accvgpr_read_b32 v7, a99
v_cvt_pk_bf16_f32 v8, v0, v1
v_cvt_pk_bf16_f32 v9, v2, v3
v_cvt_pk_bf16_f32 v10, v4, v5
v_cvt_pk_bf16_f32 v11, v6, v7
buffer_store_dwordx4 v[8:11], v251, s[4:7], s53 offen offset:0 sc1
v_accvgpr_read_b32 v16, a68
v_accvgpr_read_b32 v17, a69
v_accvgpr_read_b32 v18, a70
v_accvgpr_read_b32 v19, a71
v_accvgpr_read_b32 v20, a100
v_accvgpr_read_b32 v21, a101
v_accvgpr_read_b32 v22, a102
v_accvgpr_read_b32 v23, a103
v_cvt_pk_bf16_f32 v24, v16, v17
v_cvt_pk_bf16_f32 v25, v18, v19
v_cvt_pk_bf16_f32 v26, v20, v21
v_cvt_pk_bf16_f32 v27, v22, v23
buffer_store_dwordx4 v[24:27], v251, s[4:7], s53 offen offset:1024 sc1
v_accvgpr_read_b32 v32, a72
v_accvgpr_read_b32 v33, a73
v_accvgpr_read_b32 v34, a74
v_accvgpr_read_b32 v35, a75
v_accvgpr_read_b32 v36, a104
v_accvgpr_read_b32 v37, a105
v_accvgpr_read_b32 v38, a106
v_accvgpr_read_b32 v39, a107
v_cvt_pk_bf16_f32 v40, v32, v33
v_cvt_pk_bf16_f32 v41, v34, v35
v_cvt_pk_bf16_f32 v42, v36, v37
v_cvt_pk_bf16_f32 v43, v38, v39
buffer_store_dwordx4 v[40:43], v251, s[4:7], s53 offen offset:2048 sc1
v_accvgpr_read_b32 v48, a76
v_accvgpr_read_b32 v49, a77
v_accvgpr_read_b32 v50, a78
v_accvgpr_read_b32 v51, a79
v_accvgpr_read_b32 v52, a108
v_accvgpr_read_b32 v53, a109
v_accvgpr_read_b32 v54, a110
v_accvgpr_read_b32 v55, a111
v_cvt_pk_bf16_f32 v56, v48, v49
v_cvt_pk_bf16_f32 v57, v50, v51
v_cvt_pk_bf16_f32 v58, v52, v53
v_cvt_pk_bf16_f32 v59, v54, v55
buffer_store_dwordx4 v[56:59], v251, s[4:7], s53 offen offset:3072 sc1
s_add_u32 s53, s53, 4096
v_accvgpr_read_b32 v0, a80
v_accvgpr_read_b32 v1, a81
v_accvgpr_read_b32 v2, a82
v_accvgpr_read_b32 v3, a83
v_accvgpr_read_b32 v4, a112
v_accvgpr_read_b32 v5, a113
v_accvgpr_read_b32 v6, a114
v_accvgpr_read_b32 v7, a115
v_cvt_pk_bf16_f32 v8, v0, v1
v_cvt_pk_bf16_f32 v9, v2, v3
v_cvt_pk_bf16_f32 v10, v4, v5
v_cvt_pk_bf16_f32 v11, v6, v7
buffer_store_dwordx4 v[8:11], v251, s[4:7], s53 offen offset:0 sc1
v_accvgpr_read_b32 v16, a84
v_accvgpr_read_b32 v17, a85
v_accvgpr_read_b32 v18, a86
v_accvgpr_read_b32 v19, a87
v_accvgpr_read_b32 v20, a116
v_accvgpr_read_b32 v21, a117
v_accvgpr_read_b32 v22, a118
v_accvgpr_read_b32 v23, a119
v_cvt_pk_bf16_f32 v24, v16, v17
v_cvt_pk_bf16_f32 v25, v18, v19
v_cvt_pk_bf16_f32 v26, v20, v21
v_cvt_pk_bf16_f32 v27, v22, v23
buffer_store_dwordx4 v[24:27], v251, s[4:7], s53 offen offset:1024 sc1
v_accvgpr_read_b32 v32, a88
v_accvgpr_read_b32 v33, a89
v_accvgpr_read_b32 v34, a90
v_accvgpr_read_b32 v35, a91
v_accvgpr_read_b32 v36, a120
v_accvgpr_read_b32 v37, a121
v_accvgpr_read_b32 v38, a122
v_accvgpr_read_b32 v39, a123
v_cvt_pk_bf16_f32 v40, v32, v33
v_cvt_pk_bf16_f32 v41, v34, v35
v_cvt_pk_bf16_f32 v42, v36, v37
v_cvt_pk_bf16_f32 v43, v38, v39
buffer_store_dwordx4 v[40:43], v251, s[4:7], s53 offen offset:2048 sc1
v_accvgpr_read_b32 v48, a92
v_accvgpr_read_b32 v49, a93
v_accvgpr_read_b32 v50, a94
v_accvgpr_read_b32 v51, a95
v_accvgpr_read_b32 v52, a124
v_accvgpr_read_b32 v53, a125
v_accvgpr_read_b32 v54, a126
v_accvgpr_read_b32 v55, a127
v_cvt_pk_bf16_f32 v56, v48, v49
v_cvt_pk_bf16_f32 v57, v50, v51
v_cvt_pk_bf16_f32 v58, v52, v53
v_cvt_pk_bf16_f32 v59, v54, v55
buffer_store_dwordx4 v[56:59], v251, s[4:7], s53 offen offset:3072 sc1
s_add_u32 s53, s53, 258048
s_branch main_kernel_w_ee
main_kernel_w_e9:
s_mov_b32 s53, s1
v_accvgpr_read_b32 v0, a0
v_accvgpr_read_b32 v1, a1
v_accvgpr_read_b32 v2, a2
v_accvgpr_read_b32 v3, a3
v_accvgpr_read_b32 v4, a4
v_accvgpr_read_b32 v5, a5
v_accvgpr_read_b32 v6, a6
v_accvgpr_read_b32 v7, a7
v_pk_mul_f32 v[8:9], v[0:1], v[0:1]
v_pk_mul_f32 v[10:11], v[2:3], v[2:3]
v_pk_mul_f32 v[12:13], v[4:5], v[4:5]
v_pk_mul_f32 v[14:15], v[6:7], v[6:7]
v_pk_fma_f32 v[8:9], v[8:9], v[242:243], v[240:241]
v_pk_fma_f32 v[10:11], v[10:11], v[242:243], v[240:241]
v_pk_fma_f32 v[12:13], v[12:13], v[242:243], v[240:241]
v_pk_fma_f32 v[14:15], v[14:15], v[242:243], v[240:241]
v_pk_mul_f32 v[8:9], v[8:9], v[0:1]
v_pk_mul_f32 v[10:11], v[10:11], v[2:3]
v_pk_mul_f32 v[12:13], v[12:13], v[4:5]
v_pk_mul_f32 v[14:15], v[14:15], v[6:7]
v_exp_f32 v8, v8
v_exp_f32 v9, v9
v_exp_f32 v10, v10
v_exp_f32 v11, v11
v_exp_f32 v12, v12
v_exp_f32 v13, v13
v_exp_f32 v14, v14
v_exp_f32 v15, v15
v_pk_add_f32 v[8:9], v[8:9], v[244:245]
v_pk_add_f32 v[10:11], v[10:11], v[244:245]
v_pk_add_f32 v[12:13], v[12:13], v[244:245]
v_pk_add_f32 v[14:15], v[14:15], v[244:245]
v_rcp_f32 v8, v8
v_rcp_f32 v9, v9
v_rcp_f32 v10, v10
v_rcp_f32 v11, v11
v_rcp_f32 v12, v12
v_rcp_f32 v13, v13
v_rcp_f32 v14, v14
v_rcp_f32 v15, v15
v_pk_mul_f32 v[0:1], v[8:9], v[0:1]
v_pk_mul_f32 v[2:3], v[10:11], v[2:3]
v_pk_mul_f32 v[4:5], v[12:13], v[4:5]
v_pk_mul_f32 v[6:7], v[14:15], v[6:7]
v_cvt_pk_bf16_f32 v16, v0, v1
v_cvt_pk_bf16_f32 v17, v2, v3
v_cvt_pk_bf16_f32 v18, v4, v5
v_cvt_pk_bf16_f32 v19, v6, v7
buffer_store_dwordx4 v[16:19], v145, s[4:7], s53 offen offset:0 sc1
v_accvgpr_read_b32 v20, a8
v_accvgpr_read_b32 v21, a9
v_accvgpr_read_b32 v22, a10
v_accvgpr_read_b32 v23, a11
v_accvgpr_read_b32 v24, a12
v_accvgpr_read_b32 v25, a13
v_accvgpr_read_b32 v26, a14
v_accvgpr_read_b32 v27, a15
v_pk_mul_f32 v[28:29], v[20:21], v[20:21]
v_pk_mul_f32 v[30:31], v[22:23], v[22:23]
v_pk_mul_f32 v[32:33], v[24:25], v[24:25]
v_pk_mul_f32 v[34:35], v[26:27], v[26:27]
v_pk_fma_f32 v[28:29], v[28:29], v[242:243], v[240:241]
v_pk_fma_f32 v[30:31], v[30:31], v[242:243], v[240:241]
v_pk_fma_f32 v[32:33], v[32:33], v[242:243], v[240:241]
v_pk_fma_f32 v[34:35], v[34:35], v[242:243], v[240:241]
v_pk_mul_f32 v[28:29], v[28:29], v[20:21]
v_pk_mul_f32 v[30:31], v[30:31], v[22:23]
v_pk_mul_f32 v[32:33], v[32:33], v[24:25]
v_pk_mul_f32 v[34:35], v[34:35], v[26:27]
v_exp_f32 v28, v28
v_exp_f32 v29, v29
v_exp_f32 v30, v30
v_exp_f32 v31, v31
v_exp_f32 v32, v32
v_exp_f32 v33, v33
v_exp_f32 v34, v34
v_exp_f32 v35, v35
v_pk_add_f32 v[28:29], v[28:29], v[244:245]
v_pk_add_f32 v[30:31], v[30:31], v[244:245]
v_pk_add_f32 v[32:33], v[32:33], v[244:245]
v_pk_add_f32 v[34:35], v[34:35], v[244:245]
v_rcp_f32 v28, v28
v_rcp_f32 v29, v29
v_rcp_f32 v30, v30
v_rcp_f32 v31, v31
v_rcp_f32 v32, v32
v_rcp_f32 v33, v33
v_rcp_f32 v34, v34
v_rcp_f32 v35, v35
v_pk_mul_f32 v[20:21], v[28:29], v[20:21]
v_pk_mul_f32 v[22:23], v[30:31], v[22:23]
v_pk_mul_f32 v[24:25], v[32:33], v[24:25]
v_pk_mul_f32 v[26:27], v[34:35], v[26:27]
v_cvt_pk_bf16_f32 v36, v20, v21
v_cvt_pk_bf16_f32 v37, v22, v23
v_cvt_pk_bf16_f32 v38, v24, v25
v_cvt_pk_bf16_f32 v39, v26, v27
buffer_store_dwordx4 v[36:39], v145, s[4:7], s53 offen offset:1024 sc1
v_accvgpr_read_b32 v40, a16
v_accvgpr_read_b32 v41, a17
v_accvgpr_read_b32 v42, a18
v_accvgpr_read_b32 v43, a19
v_accvgpr_read_b32 v44, a20
v_accvgpr_read_b32 v45, a21
v_accvgpr_read_b32 v46, a22
v_accvgpr_read_b32 v47, a23
v_pk_mul_f32 v[48:49], v[40:41], v[40:41]
v_pk_mul_f32 v[50:51], v[42:43], v[42:43]
v_pk_mul_f32 v[52:53], v[44:45], v[44:45]
v_pk_mul_f32 v[54:55], v[46:47], v[46:47]
v_pk_fma_f32 v[48:49], v[48:49], v[242:243], v[240:241]
v_pk_fma_f32 v[50:51], v[50:51], v[242:243], v[240:241]
v_pk_fma_f32 v[52:53], v[52:53], v[242:243], v[240:241]
v_pk_fma_f32 v[54:55], v[54:55], v[242:243], v[240:241]
v_pk_mul_f32 v[48:49], v[48:49], v[40:41]
v_pk_mul_f32 v[50:51], v[50:51], v[42:43]
v_pk_mul_f32 v[52:53], v[52:53], v[44:45]
v_pk_mul_f32 v[54:55], v[54:55], v[46:47]
v_exp_f32 v48, v48
v_exp_f32 v49, v49
v_exp_f32 v50, v50
v_exp_f32 v51, v51
v_exp_f32 v52, v52
v_exp_f32 v53, v53
v_exp_f32 v54, v54
v_exp_f32 v55, v55
v_pk_add_f32 v[48:49], v[48:49], v[244:245]
v_pk_add_f32 v[50:51], v[50:51], v[244:245]
v_pk_add_f32 v[52:53], v[52:53], v[244:245]
v_pk_add_f32 v[54:55], v[54:55], v[244:245]
v_rcp_f32 v48, v48
v_rcp_f32 v49, v49
v_rcp_f32 v50, v50
v_rcp_f32 v51, v51
v_rcp_f32 v52, v52
v_rcp_f32 v53, v53
v_rcp_f32 v54, v54
v_rcp_f32 v55, v55
v_pk_mul_f32 v[40:41], v[48:49], v[40:41]
v_pk_mul_f32 v[42:43], v[50:51], v[42:43]
v_pk_mul_f32 v[44:45], v[52:53], v[44:45]
v_pk_mul_f32 v[46:47], v[54:55], v[46:47]
v_cvt_pk_bf16_f32 v56, v40, v41
v_cvt_pk_bf16_f32 v57, v42, v43
v_cvt_pk_bf16_f32 v58, v44, v45
v_cvt_pk_bf16_f32 v59, v46, v47
buffer_store_dwordx4 v[56:59], v145, s[4:7], s53 offen offset:2048 sc1
v_accvgpr_read_b32 v0, a24
v_accvgpr_read_b32 v1, a25
v_accvgpr_read_b32 v2, a26
v_accvgpr_read_b32 v3, a27
v_accvgpr_read_b32 v4, a28
v_accvgpr_read_b32 v5, a29
v_accvgpr_read_b32 v6, a30
v_accvgpr_read_b32 v7, a31
v_pk_mul_f32 v[8:9], v[0:1], v[0:1]
v_pk_mul_f32 v[10:11], v[2:3], v[2:3]
v_pk_mul_f32 v[12:13], v[4:5], v[4:5]
v_pk_mul_f32 v[14:15], v[6:7], v[6:7]
v_pk_fma_f32 v[8:9], v[8:9], v[242:243], v[240:241]
v_pk_fma_f32 v[10:11], v[10:11], v[242:243], v[240:241]
v_pk_fma_f32 v[12:13], v[12:13], v[242:243], v[240:241]
v_pk_fma_f32 v[14:15], v[14:15], v[242:243], v[240:241]
v_pk_mul_f32 v[8:9], v[8:9], v[0:1]
v_pk_mul_f32 v[10:11], v[10:11], v[2:3]
v_pk_mul_f32 v[12:13], v[12:13], v[4:5]
v_pk_mul_f32 v[14:15], v[14:15], v[6:7]
v_exp_f32 v8, v8
v_exp_f32 v9, v9
v_exp_f32 v10, v10
v_exp_f32 v11, v11
v_exp_f32 v12, v12
v_exp_f32 v13, v13
v_exp_f32 v14, v14
v_exp_f32 v15, v15
v_pk_add_f32 v[8:9], v[8:9], v[244:245]
v_pk_add_f32 v[10:11], v[10:11], v[244:245]
v_pk_add_f32 v[12:13], v[12:13], v[244:245]
v_pk_add_f32 v[14:15], v[14:15], v[244:245]
v_rcp_f32 v8, v8
v_rcp_f32 v9, v9
v_rcp_f32 v10, v10
v_rcp_f32 v11, v11
v_rcp_f32 v12, v12
v_rcp_f32 v13, v13
v_rcp_f32 v14, v14
v_rcp_f32 v15, v15
v_pk_mul_f32 v[0:1], v[8:9], v[0:1]
v_pk_mul_f32 v[2:3], v[10:11], v[2:3]
v_pk_mul_f32 v[4:5], v[12:13], v[4:5]
v_pk_mul_f32 v[6:7], v[14:15], v[6:7]
v_cvt_pk_bf16_f32 v16, v0, v1
v_cvt_pk_bf16_f32 v17, v2, v3
v_cvt_pk_bf16_f32 v18, v4, v5
v_cvt_pk_bf16_f32 v19, v6, v7
buffer_store_dwordx4 v[16:19], v145, s[4:7], s53 offen offset:3072 sc1
s_add_u32 s53, s53, s2
v_accvgpr_read_b32 v20, a32
v_accvgpr_read_b32 v21, a33
v_accvgpr_read_b32 v22, a34
v_accvgpr_read_b32 v23, a35
v_accvgpr_read_b32 v24, a36
v_accvgpr_read_b32 v25, a37
v_accvgpr_read_b32 v26, a38
v_accvgpr_read_b32 v27, a39
v_pk_mul_f32 v[28:29], v[20:21], v[20:21]
v_pk_mul_f32 v[30:31], v[22:23], v[22:23]
v_pk_mul_f32 v[32:33], v[24:25], v[24:25]
v_pk_mul_f32 v[34:35], v[26:27], v[26:27]
v_pk_fma_f32 v[28:29], v[28:29], v[242:243], v[240:241]
v_pk_fma_f32 v[30:31], v[30:31], v[242:243], v[240:241]
v_pk_fma_f32 v[32:33], v[32:33], v[242:243], v[240:241]
v_pk_fma_f32 v[34:35], v[34:35], v[242:243], v[240:241]
v_pk_mul_f32 v[28:29], v[28:29], v[20:21]
v_pk_mul_f32 v[30:31], v[30:31], v[22:23]
v_pk_mul_f32 v[32:33], v[32:33], v[24:25]
v_pk_mul_f32 v[34:35], v[34:35], v[26:27]
v_exp_f32 v28, v28
v_exp_f32 v29, v29
v_exp_f32 v30, v30
v_exp_f32 v31, v31
v_exp_f32 v32, v32
v_exp_f32 v33, v33
v_exp_f32 v34, v34
v_exp_f32 v35, v35
v_pk_add_f32 v[28:29], v[28:29], v[244:245]
v_pk_add_f32 v[30:31], v[30:31], v[244:245]
v_pk_add_f32 v[32:33], v[32:33], v[244:245]
v_pk_add_f32 v[34:35], v[34:35], v[244:245]
v_rcp_f32 v28, v28
v_rcp_f32 v29, v29
v_rcp_f32 v30, v30
v_rcp_f32 v31, v31
v_rcp_f32 v32, v32
v_rcp_f32 v33, v33
v_rcp_f32 v34, v34
v_rcp_f32 v35, v35
v_pk_mul_f32 v[20:21], v[28:29], v[20:21]
v_pk_mul_f32 v[22:23], v[30:31], v[22:23]
v_pk_mul_f32 v[24:25], v[32:33], v[24:25]
v_pk_mul_f32 v[26:27], v[34:35], v[26:27]
v_cvt_pk_bf16_f32 v36, v20, v21
v_cvt_pk_bf16_f32 v37, v22, v23
v_cvt_pk_bf16_f32 v38, v24, v25
v_cvt_pk_bf16_f32 v39, v26, v27
buffer_store_dwordx4 v[36:39], v145, s[4:7], s53 offen offset:0 sc1
v_accvgpr_read_b32 v40, a40
v_accvgpr_read_b32 v41, a41
v_accvgpr_read_b32 v42, a42
v_accvgpr_read_b32 v43, a43
v_accvgpr_read_b32 v44, a44
v_accvgpr_read_b32 v45, a45
v_accvgpr_read_b32 v46, a46
v_accvgpr_read_b32 v47, a47
v_pk_mul_f32 v[48:49], v[40:41], v[40:41]
v_pk_mul_f32 v[50:51], v[42:43], v[42:43]
v_pk_mul_f32 v[52:53], v[44:45], v[44:45]
v_pk_mul_f32 v[54:55], v[46:47], v[46:47]
v_pk_fma_f32 v[48:49], v[48:49], v[242:243], v[240:241]
v_pk_fma_f32 v[50:51], v[50:51], v[242:243], v[240:241]
v_pk_fma_f32 v[52:53], v[52:53], v[242:243], v[240:241]
v_pk_fma_f32 v[54:55], v[54:55], v[242:243], v[240:241]
v_pk_mul_f32 v[48:49], v[48:49], v[40:41]
v_pk_mul_f32 v[50:51], v[50:51], v[42:43]
v_pk_mul_f32 v[52:53], v[52:53], v[44:45]
v_pk_mul_f32 v[54:55], v[54:55], v[46:47]
v_exp_f32 v48, v48
v_exp_f32 v49, v49
v_exp_f32 v50, v50
v_exp_f32 v51, v51
v_exp_f32 v52, v52
v_exp_f32 v53, v53
v_exp_f32 v54, v54
v_exp_f32 v55, v55
v_pk_add_f32 v[48:49], v[48:49], v[244:245]
v_pk_add_f32 v[50:51], v[50:51], v[244:245]
v_pk_add_f32 v[52:53], v[52:53], v[244:245]
v_pk_add_f32 v[54:55], v[54:55], v[244:245]
v_rcp_f32 v48, v48
v_rcp_f32 v49, v49
v_rcp_f32 v50, v50
v_rcp_f32 v51, v51
v_rcp_f32 v52, v52
v_rcp_f32 v53, v53
v_rcp_f32 v54, v54
v_rcp_f32 v55, v55
v_pk_mul_f32 v[40:41], v[48:49], v[40:41]
v_pk_mul_f32 v[42:43], v[50:51], v[42:43]
v_pk_mul_f32 v[44:45], v[52:53], v[44:45]
v_pk_mul_f32 v[46:47], v[54:55], v[46:47]
v_cvt_pk_bf16_f32 v56, v40, v41
v_cvt_pk_bf16_f32 v57, v42, v43
v_cvt_pk_bf16_f32 v58, v44, v45
v_cvt_pk_bf16_f32 v59, v46, v47
buffer_store_dwordx4 v[56:59], v145, s[4:7], s53 offen offset:1024 sc1
v_accvgpr_read_b32 v0, a48
v_accvgpr_read_b32 v1, a49
v_accvgpr_read_b32 v2, a50
v_accvgpr_read_b32 v3, a51
v_accvgpr_read_b32 v4, a52
v_accvgpr_read_b32 v5, a53
v_accvgpr_read_b32 v6, a54
v_accvgpr_read_b32 v7, a55
v_pk_mul_f32 v[8:9], v[0:1], v[0:1]
v_pk_mul_f32 v[10:11], v[2:3], v[2:3]
v_pk_mul_f32 v[12:13], v[4:5], v[4:5]
v_pk_mul_f32 v[14:15], v[6:7], v[6:7]
v_pk_fma_f32 v[8:9], v[8:9], v[242:243], v[240:241]
v_pk_fma_f32 v[10:11], v[10:11], v[242:243], v[240:241]
v_pk_fma_f32 v[12:13], v[12:13], v[242:243], v[240:241]
v_pk_fma_f32 v[14:15], v[14:15], v[242:243], v[240:241]
v_pk_mul_f32 v[8:9], v[8:9], v[0:1]
v_pk_mul_f32 v[10:11], v[10:11], v[2:3]
v_pk_mul_f32 v[12:13], v[12:13], v[4:5]
v_pk_mul_f32 v[14:15], v[14:15], v[6:7]
v_exp_f32 v8, v8
v_exp_f32 v9, v9
v_exp_f32 v10, v10
v_exp_f32 v11, v11
v_exp_f32 v12, v12
v_exp_f32 v13, v13
v_exp_f32 v14, v14
v_exp_f32 v15, v15
v_pk_add_f32 v[8:9], v[8:9], v[244:245]
v_pk_add_f32 v[10:11], v[10:11], v[244:245]
v_pk_add_f32 v[12:13], v[12:13], v[244:245]
v_pk_add_f32 v[14:15], v[14:15], v[244:245]
v_rcp_f32 v8, v8
v_rcp_f32 v9, v9
v_rcp_f32 v10, v10
v_rcp_f32 v11, v11
v_rcp_f32 v12, v12
v_rcp_f32 v13, v13
v_rcp_f32 v14, v14
v_rcp_f32 v15, v15
v_pk_mul_f32 v[0:1], v[8:9], v[0:1]
v_pk_mul_f32 v[2:3], v[10:11], v[2:3]
v_pk_mul_f32 v[4:5], v[12:13], v[4:5]
v_pk_mul_f32 v[6:7], v[14:15], v[6:7]
v_cvt_pk_bf16_f32 v16, v0, v1
v_cvt_pk_bf16_f32 v17, v2, v3
v_cvt_pk_bf16_f32 v18, v4, v5
v_cvt_pk_bf16_f32 v19, v6, v7
buffer_store_dwordx4 v[16:19], v145, s[4:7], s53 offen offset:2048 sc1
v_accvgpr_read_b32 v20, a56
v_accvgpr_read_b32 v21, a57
v_accvgpr_read_b32 v22, a58
v_accvgpr_read_b32 v23, a59
v_accvgpr_read_b32 v24, a60
v_accvgpr_read_b32 v25, a61
v_accvgpr_read_b32 v26, a62
v_accvgpr_read_b32 v27, a63
v_pk_mul_f32 v[28:29], v[20:21], v[20:21]
v_pk_mul_f32 v[30:31], v[22:23], v[22:23]
v_pk_mul_f32 v[32:33], v[24:25], v[24:25]
v_pk_mul_f32 v[34:35], v[26:27], v[26:27]
v_pk_fma_f32 v[28:29], v[28:29], v[242:243], v[240:241]
v_pk_fma_f32 v[30:31], v[30:31], v[242:243], v[240:241]
v_pk_fma_f32 v[32:33], v[32:33], v[242:243], v[240:241]
v_pk_fma_f32 v[34:35], v[34:35], v[242:243], v[240:241]
v_pk_mul_f32 v[28:29], v[28:29], v[20:21]
v_pk_mul_f32 v[30:31], v[30:31], v[22:23]
v_pk_mul_f32 v[32:33], v[32:33], v[24:25]
v_pk_mul_f32 v[34:35], v[34:35], v[26:27]
v_exp_f32 v28, v28
v_exp_f32 v29, v29
v_exp_f32 v30, v30
v_exp_f32 v31, v31
v_exp_f32 v32, v32
v_exp_f32 v33, v33
v_exp_f32 v34, v34
v_exp_f32 v35, v35
v_pk_add_f32 v[28:29], v[28:29], v[244:245]
v_pk_add_f32 v[30:31], v[30:31], v[244:245]
v_pk_add_f32 v[32:33], v[32:33], v[244:245]
v_pk_add_f32 v[34:35], v[34:35], v[244:245]
v_rcp_f32 v28, v28
v_rcp_f32 v29, v29
v_rcp_f32 v30, v30
v_rcp_f32 v31, v31
v_rcp_f32 v32, v32
v_rcp_f32 v33, v33
v_rcp_f32 v34, v34
v_rcp_f32 v35, v35
v_pk_mul_f32 v[20:21], v[28:29], v[20:21]
v_pk_mul_f32 v[22:23], v[30:31], v[22:23]
v_pk_mul_f32 v[24:25], v[32:33], v[24:25]
v_pk_mul_f32 v[26:27], v[34:35], v[26:27]
v_cvt_pk_bf16_f32 v36, v20, v21
v_cvt_pk_bf16_f32 v37, v22, v23
v_cvt_pk_bf16_f32 v38, v24, v25
v_cvt_pk_bf16_f32 v39, v26, v27
buffer_store_dwordx4 v[36:39], v145, s[4:7], s53 offen offset:3072 sc1
s_add_u32 s53, s53, s2
v_accvgpr_read_b32 v40, a64
v_accvgpr_read_b32 v41, a65
v_accvgpr_read_b32 v42, a66
v_accvgpr_read_b32 v43, a67
v_accvgpr_read_b32 v44, a68
v_accvgpr_read_b32 v45, a69
v_accvgpr_read_b32 v46, a70
v_accvgpr_read_b32 v47, a71
v_pk_mul_f32 v[48:49], v[40:41], v[40:41]
v_pk_mul_f32 v[50:51], v[42:43], v[42:43]
v_pk_mul_f32 v[52:53], v[44:45], v[44:45]
v_pk_mul_f32 v[54:55], v[46:47], v[46:47]
v_pk_fma_f32 v[48:49], v[48:49], v[242:243], v[240:241]
v_pk_fma_f32 v[50:51], v[50:51], v[242:243], v[240:241]
v_pk_fma_f32 v[52:53], v[52:53], v[242:243], v[240:241]
v_pk_fma_f32 v[54:55], v[54:55], v[242:243], v[240:241]
v_pk_mul_f32 v[48:49], v[48:49], v[40:41]
v_pk_mul_f32 v[50:51], v[50:51], v[42:43]
v_pk_mul_f32 v[52:53], v[52:53], v[44:45]
v_pk_mul_f32 v[54:55], v[54:55], v[46:47]
v_exp_f32 v48, v48
v_exp_f32 v49, v49
v_exp_f32 v50, v50
v_exp_f32 v51, v51
v_exp_f32 v52, v52
v_exp_f32 v53, v53
v_exp_f32 v54, v54
v_exp_f32 v55, v55
v_pk_add_f32 v[48:49], v[48:49], v[244:245]
v_pk_add_f32 v[50:51], v[50:51], v[244:245]
v_pk_add_f32 v[52:53], v[52:53], v[244:245]
v_pk_add_f32 v[54:55], v[54:55], v[244:245]
v_rcp_f32 v48, v48
v_rcp_f32 v49, v49
v_rcp_f32 v50, v50
v_rcp_f32 v51, v51
v_rcp_f32 v52, v52
v_rcp_f32 v53, v53
v_rcp_f32 v54, v54
v_rcp_f32 v55, v55
v_pk_mul_f32 v[40:41], v[48:49], v[40:41]
v_pk_mul_f32 v[42:43], v[50:51], v[42:43]
v_pk_mul_f32 v[44:45], v[52:53], v[44:45]
v_pk_mul_f32 v[46:47], v[54:55], v[46:47]
v_cvt_pk_bf16_f32 v56, v40, v41
v_cvt_pk_bf16_f32 v57, v42, v43
v_cvt_pk_bf16_f32 v58, v44, v45
v_cvt_pk_bf16_f32 v59, v46, v47
buffer_store_dwordx4 v[56:59], v145, s[4:7], s53 offen offset:0 sc1
v_accvgpr_read_b32 v0, a72
v_accvgpr_read_b32 v1, a73
v_accvgpr_read_b32 v2, a74
v_accvgpr_read_b32 v3, a75
v_accvgpr_read_b32 v4, a76
v_accvgpr_read_b32 v5, a77
v_accvgpr_read_b32 v6, a78
v_accvgpr_read_b32 v7, a79
v_pk_mul_f32 v[8:9], v[0:1], v[0:1]
v_pk_mul_f32 v[10:11], v[2:3], v[2:3]
v_pk_mul_f32 v[12:13], v[4:5], v[4:5]
v_pk_mul_f32 v[14:15], v[6:7], v[6:7]
v_pk_fma_f32 v[8:9], v[8:9], v[242:243], v[240:241]
v_pk_fma_f32 v[10:11], v[10:11], v[242:243], v[240:241]
v_pk_fma_f32 v[12:13], v[12:13], v[242:243], v[240:241]
v_pk_fma_f32 v[14:15], v[14:15], v[242:243], v[240:241]
v_pk_mul_f32 v[8:9], v[8:9], v[0:1]
v_pk_mul_f32 v[10:11], v[10:11], v[2:3]
v_pk_mul_f32 v[12:13], v[12:13], v[4:5]
v_pk_mul_f32 v[14:15], v[14:15], v[6:7]
v_exp_f32 v8, v8
v_exp_f32 v9, v9
v_exp_f32 v10, v10
v_exp_f32 v11, v11
v_exp_f32 v12, v12
v_exp_f32 v13, v13
v_exp_f32 v14, v14
v_exp_f32 v15, v15
v_pk_add_f32 v[8:9], v[8:9], v[244:245]
v_pk_add_f32 v[10:11], v[10:11], v[244:245]
v_pk_add_f32 v[12:13], v[12:13], v[244:245]
v_pk_add_f32 v[14:15], v[14:15], v[244:245]
v_rcp_f32 v8, v8
v_rcp_f32 v9, v9
v_rcp_f32 v10, v10
v_rcp_f32 v11, v11
v_rcp_f32 v12, v12
v_rcp_f32 v13, v13
v_rcp_f32 v14, v14
v_rcp_f32 v15, v15
v_pk_mul_f32 v[0:1], v[8:9], v[0:1]
v_pk_mul_f32 v[2:3], v[10:11], v[2:3]
v_pk_mul_f32 v[4:5], v[12:13], v[4:5]
v_pk_mul_f32 v[6:7], v[14:15], v[6:7]
v_cvt_pk_bf16_f32 v16, v0, v1
v_cvt_pk_bf16_f32 v17, v2, v3
v_cvt_pk_bf16_f32 v18, v4, v5
v_cvt_pk_bf16_f32 v19, v6, v7
buffer_store_dwordx4 v[16:19], v145, s[4:7], s53 offen offset:1024 sc1
v_accvgpr_read_b32 v20, a80
v_accvgpr_read_b32 v21, a81
v_accvgpr_read_b32 v22, a82
v_accvgpr_read_b32 v23, a83
v_accvgpr_read_b32 v24, a84
v_accvgpr_read_b32 v25, a85
v_accvgpr_read_b32 v26, a86
v_accvgpr_read_b32 v27, a87
v_pk_mul_f32 v[28:29], v[20:21], v[20:21]
v_pk_mul_f32 v[30:31], v[22:23], v[22:23]
v_pk_mul_f32 v[32:33], v[24:25], v[24:25]
v_pk_mul_f32 v[34:35], v[26:27], v[26:27]
v_pk_fma_f32 v[28:29], v[28:29], v[242:243], v[240:241]
v_pk_fma_f32 v[30:31], v[30:31], v[242:243], v[240:241]
v_pk_fma_f32 v[32:33], v[32:33], v[242:243], v[240:241]
v_pk_fma_f32 v[34:35], v[34:35], v[242:243], v[240:241]
v_pk_mul_f32 v[28:29], v[28:29], v[20:21]
v_pk_mul_f32 v[30:31], v[30:31], v[22:23]
v_pk_mul_f32 v[32:33], v[32:33], v[24:25]
v_pk_mul_f32 v[34:35], v[34:35], v[26:27]
v_exp_f32 v28, v28
v_exp_f32 v29, v29
v_exp_f32 v30, v30
v_exp_f32 v31, v31
v_exp_f32 v32, v32
v_exp_f32 v33, v33
v_exp_f32 v34, v34
v_exp_f32 v35, v35
v_pk_add_f32 v[28:29], v[28:29], v[244:245]
v_pk_add_f32 v[30:31], v[30:31], v[244:245]
v_pk_add_f32 v[32:33], v[32:33], v[244:245]
v_pk_add_f32 v[34:35], v[34:35], v[244:245]
v_rcp_f32 v28, v28
v_rcp_f32 v29, v29
v_rcp_f32 v30, v30
v_rcp_f32 v31, v31
v_rcp_f32 v32, v32
v_rcp_f32 v33, v33
v_rcp_f32 v34, v34
v_rcp_f32 v35, v35
v_pk_mul_f32 v[20:21], v[28:29], v[20:21]
v_pk_mul_f32 v[22:23], v[30:31], v[22:23]
v_pk_mul_f32 v[24:25], v[32:33], v[24:25]
v_pk_mul_f32 v[26:27], v[34:35], v[26:27]
v_cvt_pk_bf16_f32 v36, v20, v21
v_cvt_pk_bf16_f32 v37, v22, v23
v_cvt_pk_bf16_f32 v38, v24, v25
v_cvt_pk_bf16_f32 v39, v26, v27
buffer_store_dwordx4 v[36:39], v145, s[4:7], s53 offen offset:2048 sc1
v_accvgpr_read_b32 v40, a88
v_accvgpr_read_b32 v41, a89
v_accvgpr_read_b32 v42, a90
v_accvgpr_read_b32 v43, a91
v_accvgpr_read_b32 v44, a92
v_accvgpr_read_b32 v45, a93
v_accvgpr_read_b32 v46, a94
v_accvgpr_read_b32 v47, a95
v_pk_mul_f32 v[48:49], v[40:41], v[40:41]
v_pk_mul_f32 v[50:51], v[42:43], v[42:43]
v_pk_mul_f32 v[52:53], v[44:45], v[44:45]
v_pk_mul_f32 v[54:55], v[46:47], v[46:47]
v_pk_fma_f32 v[48:49], v[48:49], v[242:243], v[240:241]
v_pk_fma_f32 v[50:51], v[50:51], v[242:243], v[240:241]
v_pk_fma_f32 v[52:53], v[52:53], v[242:243], v[240:241]
v_pk_fma_f32 v[54:55], v[54:55], v[242:243], v[240:241]
v_pk_mul_f32 v[48:49], v[48:49], v[40:41]
v_pk_mul_f32 v[50:51], v[50:51], v[42:43]
v_pk_mul_f32 v[52:53], v[52:53], v[44:45]
v_pk_mul_f32 v[54:55], v[54:55], v[46:47]
v_exp_f32 v48, v48
v_exp_f32 v49, v49
v_exp_f32 v50, v50
v_exp_f32 v51, v51
v_exp_f32 v52, v52
v_exp_f32 v53, v53
v_exp_f32 v54, v54
v_exp_f32 v55, v55
v_pk_add_f32 v[48:49], v[48:49], v[244:245]
v_pk_add_f32 v[50:51], v[50:51], v[244:245]
v_pk_add_f32 v[52:53], v[52:53], v[244:245]
v_pk_add_f32 v[54:55], v[54:55], v[244:245]
v_rcp_f32 v48, v48
v_rcp_f32 v49, v49
v_rcp_f32 v50, v50
v_rcp_f32 v51, v51
v_rcp_f32 v52, v52
v_rcp_f32 v53, v53
v_rcp_f32 v54, v54
v_rcp_f32 v55, v55
v_pk_mul_f32 v[40:41], v[48:49], v[40:41]
v_pk_mul_f32 v[42:43], v[50:51], v[42:43]
v_pk_mul_f32 v[44:45], v[52:53], v[44:45]
v_pk_mul_f32 v[46:47], v[54:55], v[46:47]
v_cvt_pk_bf16_f32 v56, v40, v41
v_cvt_pk_bf16_f32 v57, v42, v43
v_cvt_pk_bf16_f32 v58, v44, v45
v_cvt_pk_bf16_f32 v59, v46, v47
buffer_store_dwordx4 v[56:59], v145, s[4:7], s53 offen offset:3072 sc1
s_add_u32 s53, s53, s2
v_accvgpr_read_b32 v0, a96
v_accvgpr_read_b32 v1, a97
v_accvgpr_read_b32 v2, a98
v_accvgpr_read_b32 v3, a99
v_accvgpr_read_b32 v4, a100
v_accvgpr_read_b32 v5, a101
v_accvgpr_read_b32 v6, a102
v_accvgpr_read_b32 v7, a103
v_pk_mul_f32 v[8:9], v[0:1], v[0:1]
v_pk_mul_f32 v[10:11], v[2:3], v[2:3]
v_pk_mul_f32 v[12:13], v[4:5], v[4:5]
v_pk_mul_f32 v[14:15], v[6:7], v[6:7]
v_pk_fma_f32 v[8:9], v[8:9], v[242:243], v[240:241]
v_pk_fma_f32 v[10:11], v[10:11], v[242:243], v[240:241]
v_pk_fma_f32 v[12:13], v[12:13], v[242:243], v[240:241]
v_pk_fma_f32 v[14:15], v[14:15], v[242:243], v[240:241]
v_pk_mul_f32 v[8:9], v[8:9], v[0:1]
v_pk_mul_f32 v[10:11], v[10:11], v[2:3]
v_pk_mul_f32 v[12:13], v[12:13], v[4:5]
v_pk_mul_f32 v[14:15], v[14:15], v[6:7]
v_exp_f32 v8, v8
v_exp_f32 v9, v9
v_exp_f32 v10, v10
v_exp_f32 v11, v11
v_exp_f32 v12, v12
v_exp_f32 v13, v13
v_exp_f32 v14, v14
v_exp_f32 v15, v15
v_pk_add_f32 v[8:9], v[8:9], v[244:245]
v_pk_add_f32 v[10:11], v[10:11], v[244:245]
v_pk_add_f32 v[12:13], v[12:13], v[244:245]
v_pk_add_f32 v[14:15], v[14:15], v[244:245]
v_rcp_f32 v8, v8
v_rcp_f32 v9, v9
v_rcp_f32 v10, v10
v_rcp_f32 v11, v11
v_rcp_f32 v12, v12
v_rcp_f32 v13, v13
v_rcp_f32 v14, v14
v_rcp_f32 v15, v15
v_pk_mul_f32 v[0:1], v[8:9], v[0:1]
v_pk_mul_f32 v[2:3], v[10:11], v[2:3]
v_pk_mul_f32 v[4:5], v[12:13], v[4:5]
v_pk_mul_f32 v[6:7], v[14:15], v[6:7]
v_cvt_pk_bf16_f32 v16, v0, v1
v_cvt_pk_bf16_f32 v17, v2, v3
v_cvt_pk_bf16_f32 v18, v4, v5
v_cvt_pk_bf16_f32 v19, v6, v7
buffer_store_dwordx4 v[16:19], v145, s[4:7], s53 offen offset:0 sc1
v_accvgpr_read_b32 v20, a104
v_accvgpr_read_b32 v21, a105
v_accvgpr_read_b32 v22, a106
v_accvgpr_read_b32 v23, a107
v_accvgpr_read_b32 v24, a108
v_accvgpr_read_b32 v25, a109
v_accvgpr_read_b32 v26, a110
v_accvgpr_read_b32 v27, a111
v_pk_mul_f32 v[28:29], v[20:21], v[20:21]
v_pk_mul_f32 v[30:31], v[22:23], v[22:23]
v_pk_mul_f32 v[32:33], v[24:25], v[24:25]
v_pk_mul_f32 v[34:35], v[26:27], v[26:27]
v_pk_fma_f32 v[28:29], v[28:29], v[242:243], v[240:241]
v_pk_fma_f32 v[30:31], v[30:31], v[242:243], v[240:241]
v_pk_fma_f32 v[32:33], v[32:33], v[242:243], v[240:241]
v_pk_fma_f32 v[34:35], v[34:35], v[242:243], v[240:241]
v_pk_mul_f32 v[28:29], v[28:29], v[20:21]
v_pk_mul_f32 v[30:31], v[30:31], v[22:23]
v_pk_mul_f32 v[32:33], v[32:33], v[24:25]
v_pk_mul_f32 v[34:35], v[34:35], v[26:27]
v_exp_f32 v28, v28
v_exp_f32 v29, v29
v_exp_f32 v30, v30
v_exp_f32 v31, v31
v_exp_f32 v32, v32
v_exp_f32 v33, v33
v_exp_f32 v34, v34
v_exp_f32 v35, v35
v_pk_add_f32 v[28:29], v[28:29], v[244:245]
v_pk_add_f32 v[30:31], v[30:31], v[244:245]
v_pk_add_f32 v[32:33], v[32:33], v[244:245]
v_pk_add_f32 v[34:35], v[34:35], v[244:245]
v_rcp_f32 v28, v28
v_rcp_f32 v29, v29
v_rcp_f32 v30, v30
v_rcp_f32 v31, v31
v_rcp_f32 v32, v32
v_rcp_f32 v33, v33
v_rcp_f32 v34, v34
v_rcp_f32 v35, v35
v_pk_mul_f32 v[20:21], v[28:29], v[20:21]
v_pk_mul_f32 v[22:23], v[30:31], v[22:23]
v_pk_mul_f32 v[24:25], v[32:33], v[24:25]
v_pk_mul_f32 v[26:27], v[34:35], v[26:27]
v_cvt_pk_bf16_f32 v36, v20, v21
v_cvt_pk_bf16_f32 v37, v22, v23
v_cvt_pk_bf16_f32 v38, v24, v25
v_cvt_pk_bf16_f32 v39, v26, v27
buffer_store_dwordx4 v[36:39], v145, s[4:7], s53 offen offset:1024 sc1
v_accvgpr_read_b32 v40, a112
v_accvgpr_read_b32 v41, a113
v_accvgpr_read_b32 v42, a114
v_accvgpr_read_b32 v43, a115
v_accvgpr_read_b32 v44, a116
v_accvgpr_read_b32 v45, a117
v_accvgpr_read_b32 v46, a118
v_accvgpr_read_b32 v47, a119
v_pk_mul_f32 v[48:49], v[40:41], v[40:41]
v_pk_mul_f32 v[50:51], v[42:43], v[42:43]
v_pk_mul_f32 v[52:53], v[44:45], v[44:45]
v_pk_mul_f32 v[54:55], v[46:47], v[46:47]
v_pk_fma_f32 v[48:49], v[48:49], v[242:243], v[240:241]
v_pk_fma_f32 v[50:51], v[50:51], v[242:243], v[240:241]
v_pk_fma_f32 v[52:53], v[52:53], v[242:243], v[240:241]
v_pk_fma_f32 v[54:55], v[54:55], v[242:243], v[240:241]
v_pk_mul_f32 v[48:49], v[48:49], v[40:41]
v_pk_mul_f32 v[50:51], v[50:51], v[42:43]
v_pk_mul_f32 v[52:53], v[52:53], v[44:45]
v_pk_mul_f32 v[54:55], v[54:55], v[46:47]
v_exp_f32 v48, v48
v_exp_f32 v49, v49
v_exp_f32 v50, v50
v_exp_f32 v51, v51
v_exp_f32 v52, v52
v_exp_f32 v53, v53
v_exp_f32 v54, v54
v_exp_f32 v55, v55
v_pk_add_f32 v[48:49], v[48:49], v[244:245]
v_pk_add_f32 v[50:51], v[50:51], v[244:245]
v_pk_add_f32 v[52:53], v[52:53], v[244:245]
v_pk_add_f32 v[54:55], v[54:55], v[244:245]
v_rcp_f32 v48, v48
v_rcp_f32 v49, v49
v_rcp_f32 v50, v50
v_rcp_f32 v51, v51
v_rcp_f32 v52, v52
v_rcp_f32 v53, v53
v_rcp_f32 v54, v54
v_rcp_f32 v55, v55
v_pk_mul_f32 v[40:41], v[48:49], v[40:41]
v_pk_mul_f32 v[42:43], v[50:51], v[42:43]
v_pk_mul_f32 v[44:45], v[52:53], v[44:45]
v_pk_mul_f32 v[46:47], v[54:55], v[46:47]
v_cvt_pk_bf16_f32 v56, v40, v41
v_cvt_pk_bf16_f32 v57, v42, v43
v_cvt_pk_bf16_f32 v58, v44, v45
v_cvt_pk_bf16_f32 v59, v46, v47
buffer_store_dwordx4 v[56:59], v145, s[4:7], s53 offen offset:2048 sc1
v_accvgpr_read_b32 v0, a120
v_accvgpr_read_b32 v1, a121
v_accvgpr_read_b32 v2, a122
v_accvgpr_read_b32 v3, a123
v_accvgpr_read_b32 v4, a124
v_accvgpr_read_b32 v5, a125
v_accvgpr_read_b32 v6, a126
v_accvgpr_read_b32 v7, a127
v_pk_mul_f32 v[8:9], v[0:1], v[0:1]
v_pk_mul_f32 v[10:11], v[2:3], v[2:3]
v_pk_mul_f32 v[12:13], v[4:5], v[4:5]
v_pk_mul_f32 v[14:15], v[6:7], v[6:7]
v_pk_fma_f32 v[8:9], v[8:9], v[242:243], v[240:241]
v_pk_fma_f32 v[10:11], v[10:11], v[242:243], v[240:241]
v_pk_fma_f32 v[12:13], v[12:13], v[242:243], v[240:241]
v_pk_fma_f32 v[14:15], v[14:15], v[242:243], v[240:241]
v_pk_mul_f32 v[8:9], v[8:9], v[0:1]
v_pk_mul_f32 v[10:11], v[10:11], v[2:3]
v_pk_mul_f32 v[12:13], v[12:13], v[4:5]
v_pk_mul_f32 v[14:15], v[14:15], v[6:7]
v_exp_f32 v8, v8
v_exp_f32 v9, v9
v_exp_f32 v10, v10
v_exp_f32 v11, v11
v_exp_f32 v12, v12
v_exp_f32 v13, v13
v_exp_f32 v14, v14
v_exp_f32 v15, v15
v_pk_add_f32 v[8:9], v[8:9], v[244:245]
v_pk_add_f32 v[10:11], v[10:11], v[244:245]
v_pk_add_f32 v[12:13], v[12:13], v[244:245]
v_pk_add_f32 v[14:15], v[14:15], v[244:245]
v_rcp_f32 v8, v8
v_rcp_f32 v9, v9
v_rcp_f32 v10, v10
v_rcp_f32 v11, v11
v_rcp_f32 v12, v12
v_rcp_f32 v13, v13
v_rcp_f32 v14, v14
v_rcp_f32 v15, v15
v_pk_mul_f32 v[0:1], v[8:9], v[0:1]
v_pk_mul_f32 v[2:3], v[10:11], v[2:3]
v_pk_mul_f32 v[4:5], v[12:13], v[4:5]
v_pk_mul_f32 v[6:7], v[14:15], v[6:7]
v_cvt_pk_bf16_f32 v16, v0, v1
v_cvt_pk_bf16_f32 v17, v2, v3
v_cvt_pk_bf16_f32 v18, v4, v5
v_cvt_pk_bf16_f32 v19, v6, v7
buffer_store_dwordx4 v[16:19], v145, s[4:7], s53 offen offset:3072 sc1
s_branch main_kernel_w_ee
main_kernel_w_e10:
s_mov_b32 s53, s1
v_accvgpr_read_b32 v0, a0
v_accvgpr_read_b32 v1, a1
v_accvgpr_read_b32 v2, a2
v_accvgpr_read_b32 v3, a3
v_accvgpr_read_b32 v4, a4
v_accvgpr_read_b32 v5, a5
v_accvgpr_read_b32 v6, a6
v_accvgpr_read_b32 v7, a7
v_pk_mul_f32 v[8:9], v[0:1], v[0:1]
v_pk_mul_f32 v[10:11], v[2:3], v[2:3]
v_pk_mul_f32 v[12:13], v[4:5], v[4:5]
v_pk_mul_f32 v[14:15], v[6:7], v[6:7]
v_pk_fma_f32 v[8:9], v[8:9], v[242:243], v[240:241]
v_pk_fma_f32 v[10:11], v[10:11], v[242:243], v[240:241]
v_pk_fma_f32 v[12:13], v[12:13], v[242:243], v[240:241]
v_pk_fma_f32 v[14:15], v[14:15], v[242:243], v[240:241]
v_pk_mul_f32 v[8:9], v[8:9], v[0:1]
v_pk_mul_f32 v[10:11], v[10:11], v[2:3]
v_pk_mul_f32 v[12:13], v[12:13], v[4:5]
v_pk_mul_f32 v[14:15], v[14:15], v[6:7]
v_exp_f32 v8, v8
v_exp_f32 v9, v9
v_exp_f32 v10, v10
v_exp_f32 v11, v11
v_exp_f32 v12, v12
v_exp_f32 v13, v13
v_exp_f32 v14, v14
v_exp_f32 v15, v15
v_pk_add_f32 v[8:9], v[8:9], v[244:245]
v_pk_add_f32 v[10:11], v[10:11], v[244:245]
v_pk_add_f32 v[12:13], v[12:13], v[244:245]
v_pk_add_f32 v[14:15], v[14:15], v[244:245]
v_rcp_f32 v8, v8
v_rcp_f32 v9, v9
v_rcp_f32 v10, v10
v_rcp_f32 v11, v11
v_rcp_f32 v12, v12
v_rcp_f32 v13, v13
v_rcp_f32 v14, v14
v_rcp_f32 v15, v15
v_pk_mul_f32 v[0:1], v[8:9], v[0:1]
v_pk_mul_f32 v[2:3], v[10:11], v[2:3]
v_pk_mul_f32 v[4:5], v[12:13], v[4:5]
v_pk_mul_f32 v[6:7], v[14:15], v[6:7]
v_cvt_pk_bf16_f32 v16, v0, v1
v_cvt_pk_bf16_f32 v17, v2, v3
v_cvt_pk_bf16_f32 v18, v4, v5
v_cvt_pk_bf16_f32 v19, v6, v7
buffer_store_dwordx4 v[16:19], v251, s[4:7], s53 offen offset:0 sc1
v_accvgpr_read_b32 v20, a8
v_accvgpr_read_b32 v21, a9
v_accvgpr_read_b32 v22, a10
v_accvgpr_read_b32 v23, a11
v_accvgpr_read_b32 v24, a12
v_accvgpr_read_b32 v25, a13
v_accvgpr_read_b32 v26, a14
v_accvgpr_read_b32 v27, a15
v_pk_mul_f32 v[28:29], v[20:21], v[20:21]
v_pk_mul_f32 v[30:31], v[22:23], v[22:23]
v_pk_mul_f32 v[32:33], v[24:25], v[24:25]
v_pk_mul_f32 v[34:35], v[26:27], v[26:27]
v_pk_fma_f32 v[28:29], v[28:29], v[242:243], v[240:241]
v_pk_fma_f32 v[30:31], v[30:31], v[242:243], v[240:241]
v_pk_fma_f32 v[32:33], v[32:33], v[242:243], v[240:241]
v_pk_fma_f32 v[34:35], v[34:35], v[242:243], v[240:241]
v_pk_mul_f32 v[28:29], v[28:29], v[20:21]
v_pk_mul_f32 v[30:31], v[30:31], v[22:23]
v_pk_mul_f32 v[32:33], v[32:33], v[24:25]
v_pk_mul_f32 v[34:35], v[34:35], v[26:27]
v_exp_f32 v28, v28
v_exp_f32 v29, v29
v_exp_f32 v30, v30
v_exp_f32 v31, v31
v_exp_f32 v32, v32
v_exp_f32 v33, v33
v_exp_f32 v34, v34
v_exp_f32 v35, v35
v_pk_add_f32 v[28:29], v[28:29], v[244:245]
v_pk_add_f32 v[30:31], v[30:31], v[244:245]
v_pk_add_f32 v[32:33], v[32:33], v[244:245]
v_pk_add_f32 v[34:35], v[34:35], v[244:245]
v_rcp_f32 v28, v28
v_rcp_f32 v29, v29
v_rcp_f32 v30, v30
v_rcp_f32 v31, v31
v_rcp_f32 v32, v32
v_rcp_f32 v33, v33
v_rcp_f32 v34, v34
v_rcp_f32 v35, v35
v_pk_mul_f32 v[20:21], v[28:29], v[20:21]
v_pk_mul_f32 v[22:23], v[30:31], v[22:23]
v_pk_mul_f32 v[24:25], v[32:33], v[24:25]
v_pk_mul_f32 v[26:27], v[34:35], v[26:27]
v_cvt_pk_bf16_f32 v36, v20, v21
v_cvt_pk_bf16_f32 v37, v22, v23
v_cvt_pk_bf16_f32 v38, v24, v25
v_cvt_pk_bf16_f32 v39, v26, v27
buffer_store_dwordx4 v[36:39], v251, s[4:7], s53 offen offset:1024 sc1
v_accvgpr_read_b32 v40, a16
v_accvgpr_read_b32 v41, a17
v_accvgpr_read_b32 v42, a18
v_accvgpr_read_b32 v43, a19
v_accvgpr_read_b32 v44, a20
v_accvgpr_read_b32 v45, a21
v_accvgpr_read_b32 v46, a22
v_accvgpr_read_b32 v47, a23
v_pk_mul_f32 v[48:49], v[40:41], v[40:41]
v_pk_mul_f32 v[50:51], v[42:43], v[42:43]
v_pk_mul_f32 v[52:53], v[44:45], v[44:45]
v_pk_mul_f32 v[54:55], v[46:47], v[46:47]
v_pk_fma_f32 v[48:49], v[48:49], v[242:243], v[240:241]
v_pk_fma_f32 v[50:51], v[50:51], v[242:243], v[240:241]
v_pk_fma_f32 v[52:53], v[52:53], v[242:243], v[240:241]
v_pk_fma_f32 v[54:55], v[54:55], v[242:243], v[240:241]
v_pk_mul_f32 v[48:49], v[48:49], v[40:41]
v_pk_mul_f32 v[50:51], v[50:51], v[42:43]
v_pk_mul_f32 v[52:53], v[52:53], v[44:45]
v_pk_mul_f32 v[54:55], v[54:55], v[46:47]
v_exp_f32 v48, v48
v_exp_f32 v49, v49
v_exp_f32 v50, v50
v_exp_f32 v51, v51
v_exp_f32 v52, v52
v_exp_f32 v53, v53
v_exp_f32 v54, v54
v_exp_f32 v55, v55
v_pk_add_f32 v[48:49], v[48:49], v[244:245]
v_pk_add_f32 v[50:51], v[50:51], v[244:245]
v_pk_add_f32 v[52:53], v[52:53], v[244:245]
v_pk_add_f32 v[54:55], v[54:55], v[244:245]
v_rcp_f32 v48, v48
v_rcp_f32 v49, v49
v_rcp_f32 v50, v50
v_rcp_f32 v51, v51
v_rcp_f32 v52, v52
v_rcp_f32 v53, v53
v_rcp_f32 v54, v54
v_rcp_f32 v55, v55
v_pk_mul_f32 v[40:41], v[48:49], v[40:41]
v_pk_mul_f32 v[42:43], v[50:51], v[42:43]
v_pk_mul_f32 v[44:45], v[52:53], v[44:45]
v_pk_mul_f32 v[46:47], v[54:55], v[46:47]
v_cvt_pk_bf16_f32 v56, v40, v41
v_cvt_pk_bf16_f32 v57, v42, v43
v_cvt_pk_bf16_f32 v58, v44, v45
v_cvt_pk_bf16_f32 v59, v46, v47
buffer_store_dwordx4 v[56:59], v251, s[4:7], s53 offen offset:2048 sc1
v_accvgpr_read_b32 v0, a24
v_accvgpr_read_b32 v1, a25
v_accvgpr_read_b32 v2, a26
v_accvgpr_read_b32 v3, a27
v_accvgpr_read_b32 v4, a28
v_accvgpr_read_b32 v5, a29
v_accvgpr_read_b32 v6, a30
v_accvgpr_read_b32 v7, a31
v_pk_mul_f32 v[8:9], v[0:1], v[0:1]
v_pk_mul_f32 v[10:11], v[2:3], v[2:3]
v_pk_mul_f32 v[12:13], v[4:5], v[4:5]
v_pk_mul_f32 v[14:15], v[6:7], v[6:7]
v_pk_fma_f32 v[8:9], v[8:9], v[242:243], v[240:241]
v_pk_fma_f32 v[10:11], v[10:11], v[242:243], v[240:241]
v_pk_fma_f32 v[12:13], v[12:13], v[242:243], v[240:241]
v_pk_fma_f32 v[14:15], v[14:15], v[242:243], v[240:241]
v_pk_mul_f32 v[8:9], v[8:9], v[0:1]
v_pk_mul_f32 v[10:11], v[10:11], v[2:3]
v_pk_mul_f32 v[12:13], v[12:13], v[4:5]
v_pk_mul_f32 v[14:15], v[14:15], v[6:7]
v_exp_f32 v8, v8
v_exp_f32 v9, v9
v_exp_f32 v10, v10
v_exp_f32 v11, v11
v_exp_f32 v12, v12
v_exp_f32 v13, v13
v_exp_f32 v14, v14
v_exp_f32 v15, v15
v_pk_add_f32 v[8:9], v[8:9], v[244:245]
v_pk_add_f32 v[10:11], v[10:11], v[244:245]
v_pk_add_f32 v[12:13], v[12:13], v[244:245]
v_pk_add_f32 v[14:15], v[14:15], v[244:245]
v_rcp_f32 v8, v8
v_rcp_f32 v9, v9
v_rcp_f32 v10, v10
v_rcp_f32 v11, v11
v_rcp_f32 v12, v12
v_rcp_f32 v13, v13
v_rcp_f32 v14, v14
v_rcp_f32 v15, v15
v_pk_mul_f32 v[0:1], v[8:9], v[0:1]
v_pk_mul_f32 v[2:3], v[10:11], v[2:3]
v_pk_mul_f32 v[4:5], v[12:13], v[4:5]
v_pk_mul_f32 v[6:7], v[14:15], v[6:7]
v_cvt_pk_bf16_f32 v16, v0, v1
v_cvt_pk_bf16_f32 v17, v2, v3
v_cvt_pk_bf16_f32 v18, v4, v5
v_cvt_pk_bf16_f32 v19, v6, v7
buffer_store_dwordx4 v[16:19], v251, s[4:7], s53 offen offset:3072 sc1
s_add_u32 s53, s53, s2
v_accvgpr_read_b32 v20, a32
v_accvgpr_read_b32 v21, a33
v_accvgpr_read_b32 v22, a34
v_accvgpr_read_b32 v23, a35
v_accvgpr_read_b32 v24, a36
v_accvgpr_read_b32 v25, a37
v_accvgpr_read_b32 v26, a38
v_accvgpr_read_b32 v27, a39
v_pk_mul_f32 v[28:29], v[20:21], v[20:21]
v_pk_mul_f32 v[30:31], v[22:23], v[22:23]
v_pk_mul_f32 v[32:33], v[24:25], v[24:25]
v_pk_mul_f32 v[34:35], v[26:27], v[26:27]
v_pk_fma_f32 v[28:29], v[28:29], v[242:243], v[240:241]
v_pk_fma_f32 v[30:31], v[30:31], v[242:243], v[240:241]
v_pk_fma_f32 v[32:33], v[32:33], v[242:243], v[240:241]
v_pk_fma_f32 v[34:35], v[34:35], v[242:243], v[240:241]
v_pk_mul_f32 v[28:29], v[28:29], v[20:21]
v_pk_mul_f32 v[30:31], v[30:31], v[22:23]
v_pk_mul_f32 v[32:33], v[32:33], v[24:25]
v_pk_mul_f32 v[34:35], v[34:35], v[26:27]
v_exp_f32 v28, v28
v_exp_f32 v29, v29
v_exp_f32 v30, v30
v_exp_f32 v31, v31
v_exp_f32 v32, v32
v_exp_f32 v33, v33
v_exp_f32 v34, v34
v_exp_f32 v35, v35
v_pk_add_f32 v[28:29], v[28:29], v[244:245]
v_pk_add_f32 v[30:31], v[30:31], v[244:245]
v_pk_add_f32 v[32:33], v[32:33], v[244:245]
v_pk_add_f32 v[34:35], v[34:35], v[244:245]
v_rcp_f32 v28, v28
v_rcp_f32 v29, v29
v_rcp_f32 v30, v30
v_rcp_f32 v31, v31
v_rcp_f32 v32, v32
v_rcp_f32 v33, v33
v_rcp_f32 v34, v34
v_rcp_f32 v35, v35
v_pk_mul_f32 v[20:21], v[28:29], v[20:21]
v_pk_mul_f32 v[22:23], v[30:31], v[22:23]
v_pk_mul_f32 v[24:25], v[32:33], v[24:25]
v_pk_mul_f32 v[26:27], v[34:35], v[26:27]
v_cvt_pk_bf16_f32 v36, v20, v21
v_cvt_pk_bf16_f32 v37, v22, v23
v_cvt_pk_bf16_f32 v38, v24, v25
v_cvt_pk_bf16_f32 v39, v26, v27
buffer_store_dwordx4 v[36:39], v251, s[4:7], s53 offen offset:0 sc1
v_accvgpr_read_b32 v40, a40
v_accvgpr_read_b32 v41, a41
v_accvgpr_read_b32 v42, a42
v_accvgpr_read_b32 v43, a43
v_accvgpr_read_b32 v44, a44
v_accvgpr_read_b32 v45, a45
v_accvgpr_read_b32 v46, a46
v_accvgpr_read_b32 v47, a47
v_pk_mul_f32 v[48:49], v[40:41], v[40:41]
v_pk_mul_f32 v[50:51], v[42:43], v[42:43]
v_pk_mul_f32 v[52:53], v[44:45], v[44:45]
v_pk_mul_f32 v[54:55], v[46:47], v[46:47]
v_pk_fma_f32 v[48:49], v[48:49], v[242:243], v[240:241]
v_pk_fma_f32 v[50:51], v[50:51], v[242:243], v[240:241]
v_pk_fma_f32 v[52:53], v[52:53], v[242:243], v[240:241]
v_pk_fma_f32 v[54:55], v[54:55], v[242:243], v[240:241]
v_pk_mul_f32 v[48:49], v[48:49], v[40:41]
v_pk_mul_f32 v[50:51], v[50:51], v[42:43]
v_pk_mul_f32 v[52:53], v[52:53], v[44:45]
v_pk_mul_f32 v[54:55], v[54:55], v[46:47]
v_exp_f32 v48, v48
v_exp_f32 v49, v49
v_exp_f32 v50, v50
v_exp_f32 v51, v51
v_exp_f32 v52, v52
v_exp_f32 v53, v53
v_exp_f32 v54, v54
v_exp_f32 v55, v55
v_pk_add_f32 v[48:49], v[48:49], v[244:245]
v_pk_add_f32 v[50:51], v[50:51], v[244:245]
v_pk_add_f32 v[52:53], v[52:53], v[244:245]
v_pk_add_f32 v[54:55], v[54:55], v[244:245]
v_rcp_f32 v48, v48
v_rcp_f32 v49, v49
v_rcp_f32 v50, v50
v_rcp_f32 v51, v51
v_rcp_f32 v52, v52
v_rcp_f32 v53, v53
v_rcp_f32 v54, v54
v_rcp_f32 v55, v55
v_pk_mul_f32 v[40:41], v[48:49], v[40:41]
v_pk_mul_f32 v[42:43], v[50:51], v[42:43]
v_pk_mul_f32 v[44:45], v[52:53], v[44:45]
v_pk_mul_f32 v[46:47], v[54:55], v[46:47]
v_cvt_pk_bf16_f32 v56, v40, v41
v_cvt_pk_bf16_f32 v57, v42, v43
v_cvt_pk_bf16_f32 v58, v44, v45
v_cvt_pk_bf16_f32 v59, v46, v47
buffer_store_dwordx4 v[56:59], v251, s[4:7], s53 offen offset:1024 sc1
v_accvgpr_read_b32 v0, a48
v_accvgpr_read_b32 v1, a49
v_accvgpr_read_b32 v2, a50
v_accvgpr_read_b32 v3, a51
v_accvgpr_read_b32 v4, a52
v_accvgpr_read_b32 v5, a53
v_accvgpr_read_b32 v6, a54
v_accvgpr_read_b32 v7, a55
v_pk_mul_f32 v[8:9], v[0:1], v[0:1]
v_pk_mul_f32 v[10:11], v[2:3], v[2:3]
v_pk_mul_f32 v[12:13], v[4:5], v[4:5]
v_pk_mul_f32 v[14:15], v[6:7], v[6:7]
v_pk_fma_f32 v[8:9], v[8:9], v[242:243], v[240:241]
v_pk_fma_f32 v[10:11], v[10:11], v[242:243], v[240:241]
v_pk_fma_f32 v[12:13], v[12:13], v[242:243], v[240:241]
v_pk_fma_f32 v[14:15], v[14:15], v[242:243], v[240:241]
v_pk_mul_f32 v[8:9], v[8:9], v[0:1]
v_pk_mul_f32 v[10:11], v[10:11], v[2:3]
v_pk_mul_f32 v[12:13], v[12:13], v[4:5]
v_pk_mul_f32 v[14:15], v[14:15], v[6:7]
v_exp_f32 v8, v8
v_exp_f32 v9, v9
v_exp_f32 v10, v10
v_exp_f32 v11, v11
v_exp_f32 v12, v12
v_exp_f32 v13, v13
v_exp_f32 v14, v14
v_exp_f32 v15, v15
v_pk_add_f32 v[8:9], v[8:9], v[244:245]
v_pk_add_f32 v[10:11], v[10:11], v[244:245]
v_pk_add_f32 v[12:13], v[12:13], v[244:245]
v_pk_add_f32 v[14:15], v[14:15], v[244:245]
v_rcp_f32 v8, v8
v_rcp_f32 v9, v9
v_rcp_f32 v10, v10
v_rcp_f32 v11, v11
v_rcp_f32 v12, v12
v_rcp_f32 v13, v13
v_rcp_f32 v14, v14
v_rcp_f32 v15, v15
v_pk_mul_f32 v[0:1], v[8:9], v[0:1]
v_pk_mul_f32 v[2:3], v[10:11], v[2:3]
v_pk_mul_f32 v[4:5], v[12:13], v[4:5]
v_pk_mul_f32 v[6:7], v[14:15], v[6:7]
v_cvt_pk_bf16_f32 v16, v0, v1
v_cvt_pk_bf16_f32 v17, v2, v3
v_cvt_pk_bf16_f32 v18, v4, v5
v_cvt_pk_bf16_f32 v19, v6, v7
buffer_store_dwordx4 v[16:19], v251, s[4:7], s53 offen offset:2048 sc1
v_accvgpr_read_b32 v20, a56
v_accvgpr_read_b32 v21, a57
v_accvgpr_read_b32 v22, a58
v_accvgpr_read_b32 v23, a59
v_accvgpr_read_b32 v24, a60
v_accvgpr_read_b32 v25, a61
v_accvgpr_read_b32 v26, a62
v_accvgpr_read_b32 v27, a63
v_pk_mul_f32 v[28:29], v[20:21], v[20:21]
v_pk_mul_f32 v[30:31], v[22:23], v[22:23]
v_pk_mul_f32 v[32:33], v[24:25], v[24:25]
v_pk_mul_f32 v[34:35], v[26:27], v[26:27]
v_pk_fma_f32 v[28:29], v[28:29], v[242:243], v[240:241]
v_pk_fma_f32 v[30:31], v[30:31], v[242:243], v[240:241]
v_pk_fma_f32 v[32:33], v[32:33], v[242:243], v[240:241]
v_pk_fma_f32 v[34:35], v[34:35], v[242:243], v[240:241]
v_pk_mul_f32 v[28:29], v[28:29], v[20:21]
v_pk_mul_f32 v[30:31], v[30:31], v[22:23]
v_pk_mul_f32 v[32:33], v[32:33], v[24:25]
v_pk_mul_f32 v[34:35], v[34:35], v[26:27]
v_exp_f32 v28, v28
v_exp_f32 v29, v29
v_exp_f32 v30, v30
v_exp_f32 v31, v31
v_exp_f32 v32, v32
v_exp_f32 v33, v33
v_exp_f32 v34, v34
v_exp_f32 v35, v35
v_pk_add_f32 v[28:29], v[28:29], v[244:245]
v_pk_add_f32 v[30:31], v[30:31], v[244:245]
v_pk_add_f32 v[32:33], v[32:33], v[244:245]
v_pk_add_f32 v[34:35], v[34:35], v[244:245]
v_rcp_f32 v28, v28
v_rcp_f32 v29, v29
v_rcp_f32 v30, v30
v_rcp_f32 v31, v31
v_rcp_f32 v32, v32
v_rcp_f32 v33, v33
v_rcp_f32 v34, v34
v_rcp_f32 v35, v35
v_pk_mul_f32 v[20:21], v[28:29], v[20:21]
v_pk_mul_f32 v[22:23], v[30:31], v[22:23]
v_pk_mul_f32 v[24:25], v[32:33], v[24:25]
v_pk_mul_f32 v[26:27], v[34:35], v[26:27]
v_cvt_pk_bf16_f32 v36, v20, v21
v_cvt_pk_bf16_f32 v37, v22, v23
v_cvt_pk_bf16_f32 v38, v24, v25
v_cvt_pk_bf16_f32 v39, v26, v27
buffer_store_dwordx4 v[36:39], v251, s[4:7], s53 offen offset:3072 sc1
s_add_u32 s53, s53, s2
v_accvgpr_read_b32 v40, a64
v_accvgpr_read_b32 v41, a65
v_accvgpr_read_b32 v42, a66
v_accvgpr_read_b32 v43, a67
v_accvgpr_read_b32 v44, a68
v_accvgpr_read_b32 v45, a69
v_accvgpr_read_b32 v46, a70
v_accvgpr_read_b32 v47, a71
v_pk_mul_f32 v[48:49], v[40:41], v[40:41]
v_pk_mul_f32 v[50:51], v[42:43], v[42:43]
v_pk_mul_f32 v[52:53], v[44:45], v[44:45]
v_pk_mul_f32 v[54:55], v[46:47], v[46:47]
v_pk_fma_f32 v[48:49], v[48:49], v[242:243], v[240:241]
v_pk_fma_f32 v[50:51], v[50:51], v[242:243], v[240:241]
v_pk_fma_f32 v[52:53], v[52:53], v[242:243], v[240:241]
v_pk_fma_f32 v[54:55], v[54:55], v[242:243], v[240:241]
v_pk_mul_f32 v[48:49], v[48:49], v[40:41]
v_pk_mul_f32 v[50:51], v[50:51], v[42:43]
v_pk_mul_f32 v[52:53], v[52:53], v[44:45]
v_pk_mul_f32 v[54:55], v[54:55], v[46:47]
v_exp_f32 v48, v48
v_exp_f32 v49, v49
v_exp_f32 v50, v50
v_exp_f32 v51, v51
v_exp_f32 v52, v52
v_exp_f32 v53, v53
v_exp_f32 v54, v54
v_exp_f32 v55, v55
v_pk_add_f32 v[48:49], v[48:49], v[244:245]
v_pk_add_f32 v[50:51], v[50:51], v[244:245]
v_pk_add_f32 v[52:53], v[52:53], v[244:245]
v_pk_add_f32 v[54:55], v[54:55], v[244:245]
v_rcp_f32 v48, v48
v_rcp_f32 v49, v49
v_rcp_f32 v50, v50
v_rcp_f32 v51, v51
v_rcp_f32 v52, v52
v_rcp_f32 v53, v53
v_rcp_f32 v54, v54
v_rcp_f32 v55, v55
v_pk_mul_f32 v[40:41], v[48:49], v[40:41]
v_pk_mul_f32 v[42:43], v[50:51], v[42:43]
v_pk_mul_f32 v[44:45], v[52:53], v[44:45]
v_pk_mul_f32 v[46:47], v[54:55], v[46:47]
v_cvt_pk_bf16_f32 v56, v40, v41
v_cvt_pk_bf16_f32 v57, v42, v43
v_cvt_pk_bf16_f32 v58, v44, v45
v_cvt_pk_bf16_f32 v59, v46, v47
buffer_store_dwordx4 v[56:59], v251, s[4:7], s53 offen offset:0 sc1
v_accvgpr_read_b32 v0, a72
v_accvgpr_read_b32 v1, a73
v_accvgpr_read_b32 v2, a74
v_accvgpr_read_b32 v3, a75
v_accvgpr_read_b32 v4, a76
v_accvgpr_read_b32 v5, a77
v_accvgpr_read_b32 v6, a78
v_accvgpr_read_b32 v7, a79
v_pk_mul_f32 v[8:9], v[0:1], v[0:1]
v_pk_mul_f32 v[10:11], v[2:3], v[2:3]
v_pk_mul_f32 v[12:13], v[4:5], v[4:5]
v_pk_mul_f32 v[14:15], v[6:7], v[6:7]
v_pk_fma_f32 v[8:9], v[8:9], v[242:243], v[240:241]
v_pk_fma_f32 v[10:11], v[10:11], v[242:243], v[240:241]
v_pk_fma_f32 v[12:13], v[12:13], v[242:243], v[240:241]
v_pk_fma_f32 v[14:15], v[14:15], v[242:243], v[240:241]
v_pk_mul_f32 v[8:9], v[8:9], v[0:1]
v_pk_mul_f32 v[10:11], v[10:11], v[2:3]
v_pk_mul_f32 v[12:13], v[12:13], v[4:5]
v_pk_mul_f32 v[14:15], v[14:15], v[6:7]
v_exp_f32 v8, v8
v_exp_f32 v9, v9
v_exp_f32 v10, v10
v_exp_f32 v11, v11
v_exp_f32 v12, v12
v_exp_f32 v13, v13
v_exp_f32 v14, v14
v_exp_f32 v15, v15
v_pk_add_f32 v[8:9], v[8:9], v[244:245]
v_pk_add_f32 v[10:11], v[10:11], v[244:245]
v_pk_add_f32 v[12:13], v[12:13], v[244:245]
v_pk_add_f32 v[14:15], v[14:15], v[244:245]
v_rcp_f32 v8, v8
v_rcp_f32 v9, v9
v_rcp_f32 v10, v10
v_rcp_f32 v11, v11
v_rcp_f32 v12, v12
v_rcp_f32 v13, v13
v_rcp_f32 v14, v14
v_rcp_f32 v15, v15
v_pk_mul_f32 v[0:1], v[8:9], v[0:1]
v_pk_mul_f32 v[2:3], v[10:11], v[2:3]
v_pk_mul_f32 v[4:5], v[12:13], v[4:5]
v_pk_mul_f32 v[6:7], v[14:15], v[6:7]
v_cvt_pk_bf16_f32 v16, v0, v1
v_cvt_pk_bf16_f32 v17, v2, v3
v_cvt_pk_bf16_f32 v18, v4, v5
v_cvt_pk_bf16_f32 v19, v6, v7
buffer_store_dwordx4 v[16:19], v251, s[4:7], s53 offen offset:1024 sc1
v_accvgpr_read_b32 v20, a80
v_accvgpr_read_b32 v21, a81
v_accvgpr_read_b32 v22, a82
v_accvgpr_read_b32 v23, a83
v_accvgpr_read_b32 v24, a84
v_accvgpr_read_b32 v25, a85
v_accvgpr_read_b32 v26, a86
v_accvgpr_read_b32 v27, a87
v_pk_mul_f32 v[28:29], v[20:21], v[20:21]
v_pk_mul_f32 v[30:31], v[22:23], v[22:23]
v_pk_mul_f32 v[32:33], v[24:25], v[24:25]
v_pk_mul_f32 v[34:35], v[26:27], v[26:27]
v_pk_fma_f32 v[28:29], v[28:29], v[242:243], v[240:241]
v_pk_fma_f32 v[30:31], v[30:31], v[242:243], v[240:241]
v_pk_fma_f32 v[32:33], v[32:33], v[242:243], v[240:241]
v_pk_fma_f32 v[34:35], v[34:35], v[242:243], v[240:241]
v_pk_mul_f32 v[28:29], v[28:29], v[20:21]
v_pk_mul_f32 v[30:31], v[30:31], v[22:23]
v_pk_mul_f32 v[32:33], v[32:33], v[24:25]
v_pk_mul_f32 v[34:35], v[34:35], v[26:27]
v_exp_f32 v28, v28
v_exp_f32 v29, v29
v_exp_f32 v30, v30
v_exp_f32 v31, v31
v_exp_f32 v32, v32
v_exp_f32 v33, v33
v_exp_f32 v34, v34
v_exp_f32 v35, v35
v_pk_add_f32 v[28:29], v[28:29], v[244:245]
v_pk_add_f32 v[30:31], v[30:31], v[244:245]
v_pk_add_f32 v[32:33], v[32:33], v[244:245]
v_pk_add_f32 v[34:35], v[34:35], v[244:245]
v_rcp_f32 v28, v28
v_rcp_f32 v29, v29
v_rcp_f32 v30, v30
v_rcp_f32 v31, v31
v_rcp_f32 v32, v32
v_rcp_f32 v33, v33
v_rcp_f32 v34, v34
v_rcp_f32 v35, v35
v_pk_mul_f32 v[20:21], v[28:29], v[20:21]
v_pk_mul_f32 v[22:23], v[30:31], v[22:23]
v_pk_mul_f32 v[24:25], v[32:33], v[24:25]
v_pk_mul_f32 v[26:27], v[34:35], v[26:27]
v_cvt_pk_bf16_f32 v36, v20, v21
v_cvt_pk_bf16_f32 v37, v22, v23
v_cvt_pk_bf16_f32 v38, v24, v25
v_cvt_pk_bf16_f32 v39, v26, v27
buffer_store_dwordx4 v[36:39], v251, s[4:7], s53 offen offset:2048 sc1
v_accvgpr_read_b32 v40, a88
v_accvgpr_read_b32 v41, a89
v_accvgpr_read_b32 v42, a90
v_accvgpr_read_b32 v43, a91
v_accvgpr_read_b32 v44, a92
v_accvgpr_read_b32 v45, a93
v_accvgpr_read_b32 v46, a94
v_accvgpr_read_b32 v47, a95
v_pk_mul_f32 v[48:49], v[40:41], v[40:41]
v_pk_mul_f32 v[50:51], v[42:43], v[42:43]
v_pk_mul_f32 v[52:53], v[44:45], v[44:45]
v_pk_mul_f32 v[54:55], v[46:47], v[46:47]
v_pk_fma_f32 v[48:49], v[48:49], v[242:243], v[240:241]
v_pk_fma_f32 v[50:51], v[50:51], v[242:243], v[240:241]
v_pk_fma_f32 v[52:53], v[52:53], v[242:243], v[240:241]
v_pk_fma_f32 v[54:55], v[54:55], v[242:243], v[240:241]
v_pk_mul_f32 v[48:49], v[48:49], v[40:41]
v_pk_mul_f32 v[50:51], v[50:51], v[42:43]
v_pk_mul_f32 v[52:53], v[52:53], v[44:45]
v_pk_mul_f32 v[54:55], v[54:55], v[46:47]
v_exp_f32 v48, v48
v_exp_f32 v49, v49
v_exp_f32 v50, v50
v_exp_f32 v51, v51
v_exp_f32 v52, v52
v_exp_f32 v53, v53
v_exp_f32 v54, v54
v_exp_f32 v55, v55
v_pk_add_f32 v[48:49], v[48:49], v[244:245]
v_pk_add_f32 v[50:51], v[50:51], v[244:245]
v_pk_add_f32 v[52:53], v[52:53], v[244:245]
v_pk_add_f32 v[54:55], v[54:55], v[244:245]
v_rcp_f32 v48, v48
v_rcp_f32 v49, v49
v_rcp_f32 v50, v50
v_rcp_f32 v51, v51
v_rcp_f32 v52, v52
v_rcp_f32 v53, v53
v_rcp_f32 v54, v54
v_rcp_f32 v55, v55
v_pk_mul_f32 v[40:41], v[48:49], v[40:41]
v_pk_mul_f32 v[42:43], v[50:51], v[42:43]
v_pk_mul_f32 v[44:45], v[52:53], v[44:45]
v_pk_mul_f32 v[46:47], v[54:55], v[46:47]
v_cvt_pk_bf16_f32 v56, v40, v41
v_cvt_pk_bf16_f32 v57, v42, v43
v_cvt_pk_bf16_f32 v58, v44, v45
v_cvt_pk_bf16_f32 v59, v46, v47
buffer_store_dwordx4 v[56:59], v251, s[4:7], s53 offen offset:3072 sc1
s_add_u32 s53, s53, s2
v_accvgpr_read_b32 v0, a96
v_accvgpr_read_b32 v1, a97
v_accvgpr_read_b32 v2, a98
v_accvgpr_read_b32 v3, a99
v_accvgpr_read_b32 v4, a100
v_accvgpr_read_b32 v5, a101
v_accvgpr_read_b32 v6, a102
v_accvgpr_read_b32 v7, a103
v_pk_mul_f32 v[8:9], v[0:1], v[0:1]
v_pk_mul_f32 v[10:11], v[2:3], v[2:3]
v_pk_mul_f32 v[12:13], v[4:5], v[4:5]
v_pk_mul_f32 v[14:15], v[6:7], v[6:7]
v_pk_fma_f32 v[8:9], v[8:9], v[242:243], v[240:241]
v_pk_fma_f32 v[10:11], v[10:11], v[242:243], v[240:241]
v_pk_fma_f32 v[12:13], v[12:13], v[242:243], v[240:241]
v_pk_fma_f32 v[14:15], v[14:15], v[242:243], v[240:241]
v_pk_mul_f32 v[8:9], v[8:9], v[0:1]
v_pk_mul_f32 v[10:11], v[10:11], v[2:3]
v_pk_mul_f32 v[12:13], v[12:13], v[4:5]
v_pk_mul_f32 v[14:15], v[14:15], v[6:7]
v_exp_f32 v8, v8
v_exp_f32 v9, v9
v_exp_f32 v10, v10
v_exp_f32 v11, v11
v_exp_f32 v12, v12
v_exp_f32 v13, v13
v_exp_f32 v14, v14
v_exp_f32 v15, v15
v_pk_add_f32 v[8:9], v[8:9], v[244:245]
v_pk_add_f32 v[10:11], v[10:11], v[244:245]
v_pk_add_f32 v[12:13], v[12:13], v[244:245]
v_pk_add_f32 v[14:15], v[14:15], v[244:245]
v_rcp_f32 v8, v8
v_rcp_f32 v9, v9
v_rcp_f32 v10, v10
v_rcp_f32 v11, v11
v_rcp_f32 v12, v12
v_rcp_f32 v13, v13
v_rcp_f32 v14, v14
v_rcp_f32 v15, v15
v_pk_mul_f32 v[0:1], v[8:9], v[0:1]
v_pk_mul_f32 v[2:3], v[10:11], v[2:3]
v_pk_mul_f32 v[4:5], v[12:13], v[4:5]
v_pk_mul_f32 v[6:7], v[14:15], v[6:7]
v_cvt_pk_bf16_f32 v16, v0, v1
v_cvt_pk_bf16_f32 v17, v2, v3
v_cvt_pk_bf16_f32 v18, v4, v5
v_cvt_pk_bf16_f32 v19, v6, v7
buffer_store_dwordx4 v[16:19], v251, s[4:7], s53 offen offset:0 sc1
v_accvgpr_read_b32 v20, a104
v_accvgpr_read_b32 v21, a105
v_accvgpr_read_b32 v22, a106
v_accvgpr_read_b32 v23, a107
v_accvgpr_read_b32 v24, a108
v_accvgpr_read_b32 v25, a109
v_accvgpr_read_b32 v26, a110
v_accvgpr_read_b32 v27, a111
v_pk_mul_f32 v[28:29], v[20:21], v[20:21]
v_pk_mul_f32 v[30:31], v[22:23], v[22:23]
v_pk_mul_f32 v[32:33], v[24:25], v[24:25]
v_pk_mul_f32 v[34:35], v[26:27], v[26:27]
v_pk_fma_f32 v[28:29], v[28:29], v[242:243], v[240:241]
v_pk_fma_f32 v[30:31], v[30:31], v[242:243], v[240:241]
v_pk_fma_f32 v[32:33], v[32:33], v[242:243], v[240:241]
v_pk_fma_f32 v[34:35], v[34:35], v[242:243], v[240:241]
v_pk_mul_f32 v[28:29], v[28:29], v[20:21]
v_pk_mul_f32 v[30:31], v[30:31], v[22:23]
v_pk_mul_f32 v[32:33], v[32:33], v[24:25]
v_pk_mul_f32 v[34:35], v[34:35], v[26:27]
v_exp_f32 v28, v28
v_exp_f32 v29, v29
v_exp_f32 v30, v30
v_exp_f32 v31, v31
v_exp_f32 v32, v32
v_exp_f32 v33, v33
v_exp_f32 v34, v34
v_exp_f32 v35, v35
v_pk_add_f32 v[28:29], v[28:29], v[244:245]
v_pk_add_f32 v[30:31], v[30:31], v[244:245]
v_pk_add_f32 v[32:33], v[32:33], v[244:245]
v_pk_add_f32 v[34:35], v[34:35], v[244:245]
v_rcp_f32 v28, v28
v_rcp_f32 v29, v29
v_rcp_f32 v30, v30
v_rcp_f32 v31, v31
v_rcp_f32 v32, v32
v_rcp_f32 v33, v33
v_rcp_f32 v34, v34
v_rcp_f32 v35, v35
v_pk_mul_f32 v[20:21], v[28:29], v[20:21]
v_pk_mul_f32 v[22:23], v[30:31], v[22:23]
v_pk_mul_f32 v[24:25], v[32:33], v[24:25]
v_pk_mul_f32 v[26:27], v[34:35], v[26:27]
v_cvt_pk_bf16_f32 v36, v20, v21
v_cvt_pk_bf16_f32 v37, v22, v23
v_cvt_pk_bf16_f32 v38, v24, v25
v_cvt_pk_bf16_f32 v39, v26, v27
buffer_store_dwordx4 v[36:39], v251, s[4:7], s53 offen offset:1024 sc1
v_accvgpr_read_b32 v40, a112
v_accvgpr_read_b32 v41, a113
v_accvgpr_read_b32 v42, a114
v_accvgpr_read_b32 v43, a115
v_accvgpr_read_b32 v44, a116
v_accvgpr_read_b32 v45, a117
v_accvgpr_read_b32 v46, a118
v_accvgpr_read_b32 v47, a119
v_pk_mul_f32 v[48:49], v[40:41], v[40:41]
v_pk_mul_f32 v[50:51], v[42:43], v[42:43]
v_pk_mul_f32 v[52:53], v[44:45], v[44:45]
v_pk_mul_f32 v[54:55], v[46:47], v[46:47]
v_pk_fma_f32 v[48:49], v[48:49], v[242:243], v[240:241]
v_pk_fma_f32 v[50:51], v[50:51], v[242:243], v[240:241]
v_pk_fma_f32 v[52:53], v[52:53], v[242:243], v[240:241]
v_pk_fma_f32 v[54:55], v[54:55], v[242:243], v[240:241]
v_pk_mul_f32 v[48:49], v[48:49], v[40:41]
v_pk_mul_f32 v[50:51], v[50:51], v[42:43]
v_pk_mul_f32 v[52:53], v[52:53], v[44:45]
v_pk_mul_f32 v[54:55], v[54:55], v[46:47]
v_exp_f32 v48, v48
v_exp_f32 v49, v49
v_exp_f32 v50, v50
v_exp_f32 v51, v51
v_exp_f32 v52, v52
v_exp_f32 v53, v53
v_exp_f32 v54, v54
v_exp_f32 v55, v55
v_pk_add_f32 v[48:49], v[48:49], v[244:245]
v_pk_add_f32 v[50:51], v[50:51], v[244:245]
v_pk_add_f32 v[52:53], v[52:53], v[244:245]
v_pk_add_f32 v[54:55], v[54:55], v[244:245]
v_rcp_f32 v48, v48
v_rcp_f32 v49, v49
v_rcp_f32 v50, v50
v_rcp_f32 v51, v51
v_rcp_f32 v52, v52
v_rcp_f32 v53, v53
v_rcp_f32 v54, v54
v_rcp_f32 v55, v55
v_pk_mul_f32 v[40:41], v[48:49], v[40:41]
v_pk_mul_f32 v[42:43], v[50:51], v[42:43]
v_pk_mul_f32 v[44:45], v[52:53], v[44:45]
v_pk_mul_f32 v[46:47], v[54:55], v[46:47]
v_cvt_pk_bf16_f32 v56, v40, v41
v_cvt_pk_bf16_f32 v57, v42, v43
v_cvt_pk_bf16_f32 v58, v44, v45
v_cvt_pk_bf16_f32 v59, v46, v47
buffer_store_dwordx4 v[56:59], v251, s[4:7], s53 offen offset:2048 sc1
v_accvgpr_read_b32 v0, a120
v_accvgpr_read_b32 v1, a121
v_accvgpr_read_b32 v2, a122
v_accvgpr_read_b32 v3, a123
v_accvgpr_read_b32 v4, a124
v_accvgpr_read_b32 v5, a125
v_accvgpr_read_b32 v6, a126
v_accvgpr_read_b32 v7, a127
v_pk_mul_f32 v[8:9], v[0:1], v[0:1]
v_pk_mul_f32 v[10:11], v[2:3], v[2:3]
v_pk_mul_f32 v[12:13], v[4:5], v[4:5]
v_pk_mul_f32 v[14:15], v[6:7], v[6:7]
v_pk_fma_f32 v[8:9], v[8:9], v[242:243], v[240:241]
v_pk_fma_f32 v[10:11], v[10:11], v[242:243], v[240:241]
v_pk_fma_f32 v[12:13], v[12:13], v[242:243], v[240:241]
v_pk_fma_f32 v[14:15], v[14:15], v[242:243], v[240:241]
v_pk_mul_f32 v[8:9], v[8:9], v[0:1]
v_pk_mul_f32 v[10:11], v[10:11], v[2:3]
v_pk_mul_f32 v[12:13], v[12:13], v[4:5]
v_pk_mul_f32 v[14:15], v[14:15], v[6:7]
v_exp_f32 v8, v8
v_exp_f32 v9, v9
v_exp_f32 v10, v10
v_exp_f32 v11, v11
v_exp_f32 v12, v12
v_exp_f32 v13, v13
v_exp_f32 v14, v14
v_exp_f32 v15, v15
v_pk_add_f32 v[8:9], v[8:9], v[244:245]
v_pk_add_f32 v[10:11], v[10:11], v[244:245]
v_pk_add_f32 v[12:13], v[12:13], v[244:245]
v_pk_add_f32 v[14:15], v[14:15], v[244:245]
v_rcp_f32 v8, v8
v_rcp_f32 v9, v9
v_rcp_f32 v10, v10
v_rcp_f32 v11, v11
v_rcp_f32 v12, v12
v_rcp_f32 v13, v13
v_rcp_f32 v14, v14
v_rcp_f32 v15, v15
v_pk_mul_f32 v[0:1], v[8:9], v[0:1]
v_pk_mul_f32 v[2:3], v[10:11], v[2:3]
v_pk_mul_f32 v[4:5], v[12:13], v[4:5]
v_pk_mul_f32 v[6:7], v[14:15], v[6:7]
v_cvt_pk_bf16_f32 v16, v0, v1
v_cvt_pk_bf16_f32 v17, v2, v3
v_cvt_pk_bf16_f32 v18, v4, v5
v_cvt_pk_bf16_f32 v19, v6, v7
buffer_store_dwordx4 v[16:19], v251, s[4:7], s53 offen offset:3072 sc1
main_kernel_w_ee:
s_cmp_eq_u32 s58, 0
s_cbranch_scc1 main_kernel_w_c0_n_ent
s_cmp_eq_u32 s58, 1
s_cbranch_scc1 main_kernel_w_c0_v_ent
s_cmp_eq_u32 s58, 2
s_cbranch_scc1 main_kernel_w_c1_n_ent
s_cmp_eq_u32 s58, 3
s_cbranch_scc1 main_kernel_w_c1_v_ent
s_branch main_kernel_w_drain
main_kernel_w_pref:
s_cmp_lg_u32 s24, 0
s_cbranch_scc1 main_kernel_w_pf0
s_mov_b32 s8, s64
s_and_b32 s9, s65, 0xffff
s_mov_b32 s10, 0x200000
s_mov_b32 s11, 0x20000
s_branch main_kernel_w_pfg
main_kernel_w_pf0:
s_cmp_lg_u32 s24, 1
s_cbranch_scc1 main_kernel_w_pf1
s_mov_b32 s8, s66
s_and_b32 s9, s67, 0xffff
s_mov_b32 s10, 0x200000
s_mov_b32 s11, 0x20000
s_branch main_kernel_w_pfg
main_kernel_w_pf1:
s_cmp_lg_u32 s24, 2
s_cbranch_scc1 main_kernel_w_pf2
s_mov_b32 s8, s68
s_and_b32 s9, s69, 0xffff
s_mov_b32 s10, 0x700000
s_mov_b32 s11, 0x20000
s_branch main_kernel_w_pfg
main_kernel_w_pf2:
s_mov_b32 s8, s70
s_and_b32 s9, s71, 0xffff
s_mov_b32 s10, 0x700000
s_mov_b32 s11, 0x20000
main_kernel_w_pfg:
s_lshl_b32 s32, s25, 19
s_lshl_b32 s33, s14, 17
s_add_u32 s32, s32, s33
v_lshlrev_b32 v253, 7, v250
buffer_load_dword v0, v253, s[8:11], s32 offen
s_add_u32 s32, s32, 8192
buffer_load_dword v0, v253, s[8:11], s32 offen
s_add_u32 s32, s32, 8192
buffer_load_dword v0, v253, s[8:11], s32 offen
s_add_u32 s32, s32, 8192
buffer_load_dword v0, v253, s[8:11], s32 offen
s_add_u32 s32, s32, 8192
buffer_load_dword v0, v253, s[8:11], s32 offen
s_add_u32 s32, s32, 8192
buffer_load_dword v0, v253, s[8:11], s32 offen
s_add_u32 s32, s32, 8192
buffer_load_dword v0, v253, s[8:11], s32 offen
s_add_u32 s32, s32, 8192
buffer_load_dword v0, v253, s[8:11], s32 offen
s_add_u32 s32, s32, 8192
buffer_load_dword v0, v253, s[8:11], s32 offen
s_add_u32 s32, s32, 8192
buffer_load_dword v0, v253, s[8:11], s32 offen
s_add_u32 s32, s32, 8192
buffer_load_dword v0, v253, s[8:11], s32 offen
s_add_u32 s32, s32, 8192
buffer_load_dword v0, v253, s[8:11], s32 offen
s_add_u32 s32, s32, 8192
buffer_load_dword v0, v253, s[8:11], s32 offen
s_add_u32 s32, s32, 8192
buffer_load_dword v0, v253, s[8:11], s32 offen
s_add_u32 s32, s32, 8192
buffer_load_dword v0, v253, s[8:11], s32 offen
s_add_u32 s32, s32, 8192
buffer_load_dword v0, v253, s[8:11], s32 offen
s_add_u32 s32, s32, 8192
s_branch main_kernel_w_done
main_kernel_w_fill:
s_lshl_b32 s32, s24, 2
s_add_u32 s32, s32, s25
s_lshl_b32 s33, s32, 16
s_add_u32 s32, s33, 0x6e00000
s_add_u32 s35, s33, 0x8c00000
s_add_u32 s33, s33, 0x8000000
s_lshl_b32 s34, s14, 12
v_add_u32 v253, s34, v251
v_mov_b32 v0, -1
v_mov_b32 v1, -1
v_mov_b32 v2, -1
v_mov_b32 v3, -1
s_mov_b32 s18, 4
main_kernel_w_fl:
buffer_store_dwordx4 v[0:3], v253, s[4:7], s32 offen offset:0 sc1
buffer_store_dwordx4 v[0:3], v253, s[4:7], s32 offen offset:1024 sc1
buffer_store_dwordx4 v[0:3], v253, s[4:7], s32 offen offset:2048 sc1
buffer_store_dwordx4 v[0:3], v253, s[4:7], s32 offen offset:3072 sc1
s_add_u32 s32, s32, 16384
buffer_store_dwordx4 v[0:3], v253, s[4:7], s33 offen offset:0 sc1
buffer_store_dwordx4 v[0:3], v253, s[4:7], s33 offen offset:1024 sc1
buffer_store_dwordx4 v[0:3], v253, s[4:7], s33 offen offset:2048 sc1
buffer_store_dwordx4 v[0:3], v253, s[4:7], s33 offen offset:3072 sc1
s_add_u32 s33, s33, 16384
buffer_store_dwordx4 v[0:3], v253, s[4:7], s35 offen offset:0 sc1
buffer_store_dwordx4 v[0:3], v253, s[4:7], s35 offen offset:1024 sc1
buffer_store_dwordx4 v[0:3], v253, s[4:7], s35 offen offset:2048 sc1
buffer_store_dwordx4 v[0:3], v253, s[4:7], s35 offen offset:3072 sc1
s_add_u32 s35, s35, 16384
s_sub_u32 s18, s18, 1
s_cmp_lg_u32 s18, 0
s_cbranch_scc1 main_kernel_w_fl
s_branch main_kernel_w_done
main_kernel_w_ln2:
s_lshl_b32 s32, s24, 3
s_mul_i32 s33, s25, 2
s_add_u32 s32, s32, s33
s_lshl_b32 s32, s32, 15
s_lshl_b32 s33, s14, 13
s_add_u32 s32, s32, s33
s_add_u32 s21, s32, 0x6800000
s_add_u32 s32, s32, 0x5000000
buffer_load_dwordx4 v[0:3], v251, s[4:7], s32 offen offset:0 sc1
buffer_load_dwordx4 v[4:7], v251, s[4:7], s32 offen offset:1024 sc1
buffer_load_dwordx4 v[8:11], v251, s[4:7], s32 offen offset:2048 sc1
buffer_load_dwordx4 v[12:15], v251, s[4:7], s32 offen offset:3072 sc1
s_add_u32 s32, s32, 4096
buffer_load_dwordx4 v[16:19], v251, s[4:7], s32 offen offset:0 sc1
buffer_load_dwordx4 v[20:23], v251, s[4:7], s32 offen offset:1024 sc1
buffer_load_dwordx4 v[24:27], v251, s[4:7], s32 offen offset:2048 sc1
buffer_load_dwordx4 v[28:31], v251, s[4:7], s32 offen offset:3072 sc1
s_add_u32 s32, s32, 28672
buffer_load_dwordx4 v[32:35], v251, s[4:7], s32 offen offset:0 sc1
buffer_load_dwordx4 v[36:39], v251, s[4:7], s32 offen offset:1024 sc1
buffer_load_dwordx4 v[40:43], v251, s[4:7], s32 offen offset:2048 sc1
buffer_load_dwordx4 v[44:47], v251, s[4:7], s32 offen offset:3072 sc1
s_add_u32 s32, s32, 4096
buffer_load_dwordx4 v[48:51], v251, s[4:7], s32 offen offset:0 sc1
buffer_load_dwordx4 v[52:55], v251, s[4:7], s32 offen offset:1024 sc1
buffer_load_dwordx4 v[56:59], v251, s[4:7], s32 offen offset:2048 sc1
buffer_load_dwordx4 v[60:63], v251, s[4:7], s32 offen offset:3072 sc1
s_add_u32 s32, s32, 28672
v_and_b32 v255, 15, v250
v_lshlrev_b32 v254, 6, v255
v_add_u32 v254, 132096, v254
v_lshrrev_b32 v255, 4, v250
v_lshl_add_u32 v253, v255, 2, v254
v_lshl_add_u32 v253, s14, 4, v253
s_waitcnt vmcnt(8)
v_lshlrev_b32 v128, 16, v0
v_and_b32 v129, 0xffff0000, v0
v_lshlrev_b32 v130, 16, v1
v_and_b32 v131, 0xffff0000, v1
v_lshlrev_b32 v132, 16, v2
v_and_b32 v133, 0xffff0000, v2
v_lshlrev_b32 v134, 16, v3
v_and_b32 v135, 0xffff0000, v3
v_lshlrev_b32 v136, 16, v4
v_and_b32 v137, 0xffff0000, v4
v_lshlrev_b32 v138, 16, v5
v_and_b32 v139, 0xffff0000, v5
v_lshlrev_b32 v140, 16, v6
v_and_b32 v141, 0xffff0000, v6
v_lshlrev_b32 v142, 16, v7
v_and_b32 v143, 0xffff0000, v7
v_lshlrev_b32 v144, 16, v8
v_and_b32 v145, 0xffff0000, v8
v_lshlrev_b32 v146, 16, v9
v_and_b32 v147, 0xffff0000, v9
v_lshlrev_b32 v148, 16, v10
v_and_b32 v149, 0xffff0000, v10
v_lshlrev_b32 v150, 16, v11
v_and_b32 v151, 0xffff0000, v11
v_lshlrev_b32 v152, 16, v12
v_and_b32 v153, 0xffff0000, v12
v_lshlrev_b32 v154, 16, v13
v_and_b32 v155, 0xffff0000, v13
v_lshlrev_b32 v156, 16, v14
v_and_b32 v157, 0xffff0000, v14
v_lshlrev_b32 v158, 16, v15
v_and_b32 v159, 0xffff0000, v15
v_lshlrev_b32 v160, 16, v16
v_and_b32 v161, 0xffff0000, v16
v_lshlrev_b32 v162, 16, v17
v_and_b32 v163, 0xffff0000, v17
v_lshlrev_b32 v164, 16, v18
v_and_b32 v165, 0xffff0000, v18
v_lshlrev_b32 v166, 16, v19
v_and_b32 v167, 0xffff0000, v19
v_lshlrev_b32 v168, 16, v20
v_and_b32 v169, 0xffff0000, v20
v_lshlrev_b32 v170, 16, v21
v_and_b32 v171, 0xffff0000, v21
v_lshlrev_b32 v172, 16, v22
v_and_b32 v173, 0xffff0000, v22
v_lshlrev_b32 v174, 16, v23
v_and_b32 v175, 0xffff0000, v23
v_lshlrev_b32 v176, 16, v24
v_and_b32 v177, 0xffff0000, v24
v_lshlrev_b32 v178, 16, v25
v_and_b32 v179, 0xffff0000, v25
v_lshlrev_b32 v180, 16, v26
v_and_b32 v181, 0xffff0000, v26
v_lshlrev_b32 v182, 16, v27
v_and_b32 v183, 0xffff0000, v27
v_lshlrev_b32 v184, 16, v28
v_and_b32 v185, 0xffff0000, v28
v_lshlrev_b32 v186, 16, v29
v_and_b32 v187, 0xffff0000, v29
v_lshlrev_b32 v188, 16, v30
v_and_b32 v189, 0xffff0000, v30
v_lshlrev_b32 v190, 16, v31
v_and_b32 v191, 0xffff0000, v31
v_pk_add_f32 v[192:193], v[128:129], v[136:137]
v_pk_add_f32 v[194:195], v[130:131], v[138:139]
v_pk_add_f32 v[196:197], v[132:133], v[140:141]
v_pk_add_f32 v[198:199], v[134:135], v[142:143]
v_pk_add_f32 v[192:193], v[192:193], v[144:145]
v_pk_add_f32 v[194:195], v[194:195], v[146:147]
v_pk_add_f32 v[196:197], v[196:197], v[148:149]
v_pk_add_f32 v[198:199], v[198:199], v[150:151]
v_pk_add_f32 v[192:193], v[192:193], v[152:153]
v_pk_add_f32 v[194:195], v[194:195], v[154:155]
v_pk_add_f32 v[196:197], v[196:197], v[156:157]
v_pk_add_f32 v[198:199], v[198:199], v[158:159]
v_pk_add_f32 v[192:193], v[192:193], v[160:161]
v_pk_add_f32 v[194:195], v[194:195], v[162:163]
v_pk_add_f32 v[196:197], v[196:197], v[164:165]
v_pk_add_f32 v[198:199], v[198:199], v[166:167]
v_pk_add_f32 v[192:193], v[192:193], v[168:169]
v_pk_add_f32 v[194:195], v[194:195], v[170:171]
v_pk_add_f32 v[196:197], v[196:197], v[172:173]
v_pk_add_f32 v[198:199], v[198:199], v[174:175]
v_pk_add_f32 v[192:193], v[192:193], v[176:177]
v_pk_add_f32 v[194:195], v[194:195], v[178:179]
v_pk_add_f32 v[196:197], v[196:197], v[180:181]
v_pk_add_f32 v[198:199], v[198:199], v[182:183]
v_pk_add_f32 v[192:193], v[192:193], v[184:185]
v_pk_add_f32 v[194:195], v[194:195], v[186:187]
v_pk_add_f32 v[196:197], v[196:197], v[188:189]
v_pk_add_f32 v[198:199], v[198:199], v[190:191]
v_pk_add_f32 v[192:193], v[192:193], v[194:195]
v_pk_add_f32 v[196:197], v[196:197], v[198:199]
v_pk_add_f32 v[192:193], v[192:193], v[196:197]
v_add_f32 v192, v192, v193
ds_write_b32 v253, v192 offset:0
s_waitcnt lgkmcnt(0)
s_barrier
ds_read_b128 v[192:195], v254 offset:0
ds_read_b128 v[196:199], v254 offset:16
ds_read_b128 v[200:203], v254 offset:32
ds_read_b128 v[204:207], v254 offset:48
s_waitcnt lgkmcnt(2)
v_pk_add_f32 v[192:193], v[192:193], v[194:195]
v_pk_add_f32 v[196:197], v[196:197], v[198:199]
s_waitcnt lgkmcnt(0)
v_pk_add_f32 v[200:201], v[200:201], v[202:203]
v_pk_add_f32 v[204:205], v[204:205], v[206:207]
v_pk_add_f32 v[192:193], v[192:193], v[196:197]
v_pk_add_f32 v[200:201], v[200:201], v[204:205]
v_pk_add_f32 v[192:193], v[192:193], v[200:201]
v_add_f32 v192, v192, v193
v_mul_f32 v192, 0xba800000, v192
v_mov_b32 v193, v192
v_pk_add_f32 v[128:129], v[128:129], v[192:193]
v_pk_add_f32 v[130:131], v[130:131], v[192:193]
v_pk_add_f32 v[132:133], v[132:133], v[192:193]
v_pk_add_f32 v[134:135], v[134:135], v[192:193]
v_pk_add_f32 v[136:137], v[136:137], v[192:193]
v_pk_add_f32 v[138:139], v[138:139], v[192:193]
v_pk_add_f32 v[140:141], v[140:141], v[192:193]
v_pk_add_f32 v[142:143], v[142:143], v[192:193]
v_pk_add_f32 v[144:145], v[144:145], v[192:193]
v_pk_add_f32 v[146:147], v[146:147], v[192:193]
v_pk_add_f32 v[148:149], v[148:149], v[192:193]
v_pk_add_f32 v[150:151], v[150:151], v[192:193]
v_pk_add_f32 v[152:153], v[152:153], v[192:193]
v_pk_add_f32 v[154:155], v[154:155], v[192:193]
v_pk_add_f32 v[156:157], v[156:157], v[192:193]
v_pk_add_f32 v[158:159], v[158:159], v[192:193]
v_pk_add_f32 v[160:161], v[160:161], v[192:193]
v_pk_add_f32 v[162:163], v[162:163], v[192:193]
v_pk_add_f32 v[164:165], v[164:165], v[192:193]
v_pk_add_f32 v[166:167], v[166:167], v[192:193]
v_pk_add_f32 v[168:169], v[168:169], v[192:193]
v_pk_add_f32 v[170:171], v[170:171], v[192:193]
v_pk_add_f32 v[172:173], v[172:173], v[192:193]
v_pk_add_f32 v[174:175], v[174:175], v[192:193]
v_pk_add_f32 v[176:177], v[176:177], v[192:193]
v_pk_add_f32 v[178:179], v[178:179], v[192:193]
v_pk_add_f32 v[180:181], v[180:181], v[192:193]
v_pk_add_f32 v[182:183], v[182:183], v[192:193]
v_pk_add_f32 v[184:185], v[184:185], v[192:193]
v_pk_add_f32 v[186:187], v[186:187], v[192:193]
v_pk_add_f32 v[188:189], v[188:189], v[192:193]
v_pk_add_f32 v[190:191], v[190:191], v[192:193]
v_pk_mul_f32 v[192:193], v[128:129], v[128:129]
v_pk_mul_f32 v[194:195], v[130:131], v[130:131]
v_pk_mul_f32 v[196:197], v[132:133], v[132:133]
v_pk_mul_f32 v[198:199], v[134:135], v[134:135]
v_pk_fma_f32 v[192:193], v[136:137], v[136:137], v[192:193]
v_pk_fma_f32 v[194:195], v[138:139], v[138:139], v[194:195]
v_pk_fma_f32 v[196:197], v[140:141], v[140:141], v[196:197]
v_pk_fma_f32 v[198:199], v[142:143], v[142:143], v[198:199]
v_pk_fma_f32 v[192:193], v[144:145], v[144:145], v[192:193]
v_pk_fma_f32 v[194:195], v[146:147], v[146:147], v[194:195]
v_pk_fma_f32 v[196:197], v[148:149], v[148:149], v[196:197]
v_pk_fma_f32 v[198:199], v[150:151], v[150:151], v[198:199]
v_pk_fma_f32 v[192:193], v[152:153], v[152:153], v[192:193]
v_pk_fma_f32 v[194:195], v[154:155], v[154:155], v[194:195]
v_pk_fma_f32 v[196:197], v[156:157], v[156:157], v[196:197]
v_pk_fma_f32 v[198:199], v[158:159], v[158:159], v[198:199]
v_pk_fma_f32 v[192:193], v[160:161], v[160:161], v[192:193]
v_pk_fma_f32 v[194:195], v[162:163], v[162:163], v[194:195]
v_pk_fma_f32 v[196:197], v[164:165], v[164:165], v[196:197]
v_pk_fma_f32 v[198:199], v[166:167], v[166:167], v[198:199]
v_pk_fma_f32 v[192:193], v[168:169], v[168:169], v[192:193]
v_pk_fma_f32 v[194:195], v[170:171], v[170:171], v[194:195]
v_pk_fma_f32 v[196:197], v[172:173], v[172:173], v[196:197]
v_pk_fma_f32 v[198:199], v[174:175], v[174:175], v[198:199]
v_pk_fma_f32 v[192:193], v[176:177], v[176:177], v[192:193]
v_pk_fma_f32 v[194:195], v[178:179], v[178:179], v[194:195]
v_pk_fma_f32 v[196:197], v[180:181], v[180:181], v[196:197]
v_pk_fma_f32 v[198:199], v[182:183], v[182:183], v[198:199]
v_pk_fma_f32 v[192:193], v[184:185], v[184:185], v[192:193]
v_pk_fma_f32 v[194:195], v[186:187], v[186:187], v[194:195]
v_pk_fma_f32 v[196:197], v[188:189], v[188:189], v[196:197]
v_pk_fma_f32 v[198:199], v[190:191], v[190:191], v[198:199]
v_pk_add_f32 v[192:193], v[192:193], v[194:195]
v_pk_add_f32 v[196:197], v[196:197], v[198:199]
v_pk_add_f32 v[192:193], v[192:193], v[196:197]
v_add_f32 v192, v192, v193
ds_write_b32 v253, v192 offset:1024
s_waitcnt lgkmcnt(0)
s_barrier
ds_read_b128 v[192:195], v254 offset:1024
ds_read_b128 v[196:199], v254 offset:1040
ds_read_b128 v[200:203], v254 offset:1056
ds_read_b128 v[204:207], v254 offset:1072
s_waitcnt lgkmcnt(2)
v_pk_add_f32 v[192:193], v[192:193], v[194:195]
v_pk_add_f32 v[196:197], v[196:197], v[198:199]
s_waitcnt lgkmcnt(0)
v_pk_add_f32 v[200:201], v[200:201], v[202:203]
v_pk_add_f32 v[204:205], v[204:205], v[206:207]
v_pk_add_f32 v[192:193], v[192:193], v[196:197]
v_pk_add_f32 v[200:201], v[200:201], v[204:205]
v_pk_add_f32 v[192:193], v[192:193], v[200:201]
v_add_f32 v192, v192, v193
v_mov_b32 v193, 0x3727c5ac
v_fmac_f32 v193, 0x3a800000, v192
v_rsq_f32 v192, v193
s_nop 0
v_mov_b32 v193, v192
v_pk_mul_f32 v[128:129], v[128:129], v[192:193]
v_pk_mul_f32 v[130:131], v[130:131], v[192:193]
v_pk_mul_f32 v[132:133], v[132:133], v[192:193]
v_pk_mul_f32 v[134:135], v[134:135], v[192:193]
v_pk_mul_f32 v[136:137], v[136:137], v[192:193]
v_pk_mul_f32 v[138:139], v[138:139], v[192:193]
v_pk_mul_f32 v[140:141], v[140:141], v[192:193]
v_pk_mul_f32 v[142:143], v[142:143], v[192:193]
v_pk_mul_f32 v[144:145], v[144:145], v[192:193]
v_pk_mul_f32 v[146:147], v[146:147], v[192:193]
v_pk_mul_f32 v[148:149], v[148:149], v[192:193]
v_pk_mul_f32 v[150:151], v[150:151], v[192:193]
v_pk_mul_f32 v[152:153], v[152:153], v[192:193]
v_pk_mul_f32 v[154:155], v[154:155], v[192:193]
v_pk_mul_f32 v[156:157], v[156:157], v[192:193]
v_pk_mul_f32 v[158:159], v[158:159], v[192:193]
v_pk_mul_f32 v[160:161], v[160:161], v[192:193]
v_pk_mul_f32 v[162:163], v[162:163], v[192:193]
v_pk_mul_f32 v[164:165], v[164:165], v[192:193]
v_pk_mul_f32 v[166:167], v[166:167], v[192:193]
v_pk_mul_f32 v[168:169], v[168:169], v[192:193]
v_pk_mul_f32 v[170:171], v[170:171], v[192:193]
v_pk_mul_f32 v[172:173], v[172:173], v[192:193]
v_pk_mul_f32 v[174:175], v[174:175], v[192:193]
v_pk_mul_f32 v[176:177], v[176:177], v[192:193]
v_pk_mul_f32 v[178:179], v[178:179], v[192:193]
v_pk_mul_f32 v[180:181], v[180:181], v[192:193]
v_pk_mul_f32 v[182:183], v[182:183], v[192:193]
v_pk_mul_f32 v[184:185], v[184:185], v[192:193]
v_pk_mul_f32 v[186:187], v[186:187], v[192:193]
v_pk_mul_f32 v[188:189], v[188:189], v[192:193]
v_pk_mul_f32 v[190:191], v[190:191], v[192:193]
v_cvt_pk_bf16_f32 v0, v128, v129
v_cvt_pk_bf16_f32 v1, v130, v131
v_cvt_pk_bf16_f32 v2, v132, v133
v_cvt_pk_bf16_f32 v3, v134, v135
v_cvt_pk_bf16_f32 v4, v136, v137
v_cvt_pk_bf16_f32 v5, v138, v139
v_cvt_pk_bf16_f32 v6, v140, v141
v_cvt_pk_bf16_f32 v7, v142, v143
v_cvt_pk_bf16_f32 v8, v144, v145
v_cvt_pk_bf16_f32 v9, v146, v147
v_cvt_pk_bf16_f32 v10, v148, v149
v_cvt_pk_bf16_f32 v11, v150, v151
v_cvt_pk_bf16_f32 v12, v152, v153
v_cvt_pk_bf16_f32 v13, v154, v155
v_cvt_pk_bf16_f32 v14, v156, v157
v_cvt_pk_bf16_f32 v15, v158, v159
v_cvt_pk_bf16_f32 v16, v160, v161
v_cvt_pk_bf16_f32 v17, v162, v163
v_cvt_pk_bf16_f32 v18, v164, v165
v_cvt_pk_bf16_f32 v19, v166, v167
v_cvt_pk_bf16_f32 v20, v168, v169
v_cvt_pk_bf16_f32 v21, v170, v171
v_cvt_pk_bf16_f32 v22, v172, v173
v_cvt_pk_bf16_f32 v23, v174, v175
v_cvt_pk_bf16_f32 v24, v176, v177
v_cvt_pk_bf16_f32 v25, v178, v179
v_cvt_pk_bf16_f32 v26, v180, v181
v_cvt_pk_bf16_f32 v27, v182, v183
v_cvt_pk_bf16_f32 v28, v184, v185
v_cvt_pk_bf16_f32 v29, v186, v187
v_cvt_pk_bf16_f32 v30, v188, v189
v_cvt_pk_bf16_f32 v31, v190, v191
buffer_store_dwordx4 v[0:3], v251, s[4:7], s21 offen offset:0 sc1
buffer_store_dwordx4 v[4:7], v251, s[4:7], s21 offen offset:1024 sc1
buffer_store_dwordx4 v[8:11], v251, s[4:7], s21 offen offset:2048 sc1
buffer_store_dwordx4 v[12:15], v251, s[4:7], s21 offen offset:3072 sc1
s_add_u32 s21, s21, 4096
buffer_store_dwordx4 v[16:19], v251, s[4:7], s21 offen offset:0 sc1
buffer_store_dwordx4 v[20:23], v251, s[4:7], s21 offen offset:1024 sc1
buffer_store_dwordx4 v[24:27], v251, s[4:7], s21 offen offset:2048 sc1
buffer_store_dwordx4 v[28:31], v251, s[4:7], s21 offen offset:3072 sc1
s_add_u32 s21, s21, 28672
s_waitcnt vmcnt(8)
v_lshlrev_b32 v128, 16, v32
v_and_b32 v129, 0xffff0000, v32
v_lshlrev_b32 v130, 16, v33
v_and_b32 v131, 0xffff0000, v33
v_lshlrev_b32 v132, 16, v34
v_and_b32 v133, 0xffff0000, v34
v_lshlrev_b32 v134, 16, v35
v_and_b32 v135, 0xffff0000, v35
v_lshlrev_b32 v136, 16, v36
v_and_b32 v137, 0xffff0000, v36
v_lshlrev_b32 v138, 16, v37
v_and_b32 v139, 0xffff0000, v37
v_lshlrev_b32 v140, 16, v38
v_and_b32 v141, 0xffff0000, v38
v_lshlrev_b32 v142, 16, v39
v_and_b32 v143, 0xffff0000, v39
v_lshlrev_b32 v144, 16, v40
v_and_b32 v145, 0xffff0000, v40
v_lshlrev_b32 v146, 16, v41
v_and_b32 v147, 0xffff0000, v41
v_lshlrev_b32 v148, 16, v42
v_and_b32 v149, 0xffff0000, v42
v_lshlrev_b32 v150, 16, v43
v_and_b32 v151, 0xffff0000, v43
v_lshlrev_b32 v152, 16, v44
v_and_b32 v153, 0xffff0000, v44
v_lshlrev_b32 v154, 16, v45
v_and_b32 v155, 0xffff0000, v45
v_lshlrev_b32 v156, 16, v46
v_and_b32 v157, 0xffff0000, v46
v_lshlrev_b32 v158, 16, v47
v_and_b32 v159, 0xffff0000, v47
v_lshlrev_b32 v160, 16, v48
v_and_b32 v161, 0xffff0000, v48
v_lshlrev_b32 v162, 16, v49
v_and_b32 v163, 0xffff0000, v49
v_lshlrev_b32 v164, 16, v50
v_and_b32 v165, 0xffff0000, v50
v_lshlrev_b32 v166, 16, v51
v_and_b32 v167, 0xffff0000, v51
v_lshlrev_b32 v168, 16, v52
v_and_b32 v169, 0xffff0000, v52
v_lshlrev_b32 v170, 16, v53
v_and_b32 v171, 0xffff0000, v53
v_lshlrev_b32 v172, 16, v54
v_and_b32 v173, 0xffff0000, v54
v_lshlrev_b32 v174, 16, v55
v_and_b32 v175, 0xffff0000, v55
v_lshlrev_b32 v176, 16, v56
v_and_b32 v177, 0xffff0000, v56
v_lshlrev_b32 v178, 16, v57
v_and_b32 v179, 0xffff0000, v57
v_lshlrev_b32 v180, 16, v58
v_and_b32 v181, 0xffff0000, v58
v_lshlrev_b32 v182, 16, v59
v_and_b32 v183, 0xffff0000, v59
v_lshlrev_b32 v184, 16, v60
v_and_b32 v185, 0xffff0000, v60
v_lshlrev_b32 v186, 16, v61
v_and_b32 v187, 0xffff0000, v61
v_lshlrev_b32 v188, 16, v62
v_and_b32 v189, 0xffff0000, v62
v_lshlrev_b32 v190, 16, v63
v_and_b32 v191, 0xffff0000, v63
v_pk_add_f32 v[192:193], v[128:129], v[136:137]
v_pk_add_f32 v[194:195], v[130:131], v[138:139]
v_pk_add_f32 v[196:197], v[132:133], v[140:141]
v_pk_add_f32 v[198:199], v[134:135], v[142:143]
v_pk_add_f32 v[192:193], v[192:193], v[144:145]
v_pk_add_f32 v[194:195], v[194:195], v[146:147]
v_pk_add_f32 v[196:197], v[196:197], v[148:149]
v_pk_add_f32 v[198:199], v[198:199], v[150:151]
v_pk_add_f32 v[192:193], v[192:193], v[152:153]
v_pk_add_f32 v[194:195], v[194:195], v[154:155]
v_pk_add_f32 v[196:197], v[196:197], v[156:157]
v_pk_add_f32 v[198:199], v[198:199], v[158:159]
v_pk_add_f32 v[192:193], v[192:193], v[160:161]
v_pk_add_f32 v[194:195], v[194:195], v[162:163]
v_pk_add_f32 v[196:197], v[196:197], v[164:165]
v_pk_add_f32 v[198:199], v[198:199], v[166:167]
v_pk_add_f32 v[192:193], v[192:193], v[168:169]
v_pk_add_f32 v[194:195], v[194:195], v[170:171]
v_pk_add_f32 v[196:197], v[196:197], v[172:173]
v_pk_add_f32 v[198:199], v[198:199], v[174:175]
v_pk_add_f32 v[192:193], v[192:193], v[176:177]
v_pk_add_f32 v[194:195], v[194:195], v[178:179]
v_pk_add_f32 v[196:197], v[196:197], v[180:181]
v_pk_add_f32 v[198:199], v[198:199], v[182:183]
v_pk_add_f32 v[192:193], v[192:193], v[184:185]
v_pk_add_f32 v[194:195], v[194:195], v[186:187]
v_pk_add_f32 v[196:197], v[196:197], v[188:189]
v_pk_add_f32 v[198:199], v[198:199], v[190:191]
v_pk_add_f32 v[192:193], v[192:193], v[194:195]
v_pk_add_f32 v[196:197], v[196:197], v[198:199]
v_pk_add_f32 v[192:193], v[192:193], v[196:197]
v_add_f32 v192, v192, v193
ds_write_b32 v253, v192 offset:0
s_waitcnt lgkmcnt(0)
s_barrier
ds_read_b128 v[192:195], v254 offset:0
ds_read_b128 v[196:199], v254 offset:16
ds_read_b128 v[200:203], v254 offset:32
ds_read_b128 v[204:207], v254 offset:48
s_waitcnt lgkmcnt(2)
v_pk_add_f32 v[192:193], v[192:193], v[194:195]
v_pk_add_f32 v[196:197], v[196:197], v[198:199]
s_waitcnt lgkmcnt(0)
v_pk_add_f32 v[200:201], v[200:201], v[202:203]
v_pk_add_f32 v[204:205], v[204:205], v[206:207]
v_pk_add_f32 v[192:193], v[192:193], v[196:197]
v_pk_add_f32 v[200:201], v[200:201], v[204:205]
v_pk_add_f32 v[192:193], v[192:193], v[200:201]
v_add_f32 v192, v192, v193
v_mul_f32 v192, 0xba800000, v192
v_mov_b32 v193, v192
v_pk_add_f32 v[128:129], v[128:129], v[192:193]
v_pk_add_f32 v[130:131], v[130:131], v[192:193]
v_pk_add_f32 v[132:133], v[132:133], v[192:193]
v_pk_add_f32 v[134:135], v[134:135], v[192:193]
v_pk_add_f32 v[136:137], v[136:137], v[192:193]
v_pk_add_f32 v[138:139], v[138:139], v[192:193]
v_pk_add_f32 v[140:141], v[140:141], v[192:193]
v_pk_add_f32 v[142:143], v[142:143], v[192:193]
v_pk_add_f32 v[144:145], v[144:145], v[192:193]
v_pk_add_f32 v[146:147], v[146:147], v[192:193]
v_pk_add_f32 v[148:149], v[148:149], v[192:193]
v_pk_add_f32 v[150:151], v[150:151], v[192:193]
v_pk_add_f32 v[152:153], v[152:153], v[192:193]
v_pk_add_f32 v[154:155], v[154:155], v[192:193]
v_pk_add_f32 v[156:157], v[156:157], v[192:193]
v_pk_add_f32 v[158:159], v[158:159], v[192:193]
v_pk_add_f32 v[160:161], v[160:161], v[192:193]
v_pk_add_f32 v[162:163], v[162:163], v[192:193]
v_pk_add_f32 v[164:165], v[164:165], v[192:193]
v_pk_add_f32 v[166:167], v[166:167], v[192:193]
v_pk_add_f32 v[168:169], v[168:169], v[192:193]
v_pk_add_f32 v[170:171], v[170:171], v[192:193]
v_pk_add_f32 v[172:173], v[172:173], v[192:193]
v_pk_add_f32 v[174:175], v[174:175], v[192:193]
v_pk_add_f32 v[176:177], v[176:177], v[192:193]
v_pk_add_f32 v[178:179], v[178:179], v[192:193]
v_pk_add_f32 v[180:181], v[180:181], v[192:193]
v_pk_add_f32 v[182:183], v[182:183], v[192:193]
v_pk_add_f32 v[184:185], v[184:185], v[192:193]
v_pk_add_f32 v[186:187], v[186:187], v[192:193]
v_pk_add_f32 v[188:189], v[188:189], v[192:193]
v_pk_add_f32 v[190:191], v[190:191], v[192:193]
v_pk_mul_f32 v[192:193], v[128:129], v[128:129]
v_pk_mul_f32 v[194:195], v[130:131], v[130:131]
v_pk_mul_f32 v[196:197], v[132:133], v[132:133]
v_pk_mul_f32 v[198:199], v[134:135], v[134:135]
v_pk_fma_f32 v[192:193], v[136:137], v[136:137], v[192:193]
v_pk_fma_f32 v[194:195], v[138:139], v[138:139], v[194:195]
v_pk_fma_f32 v[196:197], v[140:141], v[140:141], v[196:197]
v_pk_fma_f32 v[198:199], v[142:143], v[142:143], v[198:199]
v_pk_fma_f32 v[192:193], v[144:145], v[144:145], v[192:193]
v_pk_fma_f32 v[194:195], v[146:147], v[146:147], v[194:195]
v_pk_fma_f32 v[196:197], v[148:149], v[148:149], v[196:197]
v_pk_fma_f32 v[198:199], v[150:151], v[150:151], v[198:199]
v_pk_fma_f32 v[192:193], v[152:153], v[152:153], v[192:193]
v_pk_fma_f32 v[194:195], v[154:155], v[154:155], v[194:195]
v_pk_fma_f32 v[196:197], v[156:157], v[156:157], v[196:197]
v_pk_fma_f32 v[198:199], v[158:159], v[158:159], v[198:199]
v_pk_fma_f32 v[192:193], v[160:161], v[160:161], v[192:193]
v_pk_fma_f32 v[194:195], v[162:163], v[162:163], v[194:195]
v_pk_fma_f32 v[196:197], v[164:165], v[164:165], v[196:197]
v_pk_fma_f32 v[198:199], v[166:167], v[166:167], v[198:199]
v_pk_fma_f32 v[192:193], v[168:169], v[168:169], v[192:193]
v_pk_fma_f32 v[194:195], v[170:171], v[170:171], v[194:195]
v_pk_fma_f32 v[196:197], v[172:173], v[172:173], v[196:197]
v_pk_fma_f32 v[198:199], v[174:175], v[174:175], v[198:199]
v_pk_fma_f32 v[192:193], v[176:177], v[176:177], v[192:193]
v_pk_fma_f32 v[194:195], v[178:179], v[178:179], v[194:195]
v_pk_fma_f32 v[196:197], v[180:181], v[180:181], v[196:197]
v_pk_fma_f32 v[198:199], v[182:183], v[182:183], v[198:199]
v_pk_fma_f32 v[192:193], v[184:185], v[184:185], v[192:193]
v_pk_fma_f32 v[194:195], v[186:187], v[186:187], v[194:195]
v_pk_fma_f32 v[196:197], v[188:189], v[188:189], v[196:197]
v_pk_fma_f32 v[198:199], v[190:191], v[190:191], v[198:199]
v_pk_add_f32 v[192:193], v[192:193], v[194:195]
v_pk_add_f32 v[196:197], v[196:197], v[198:199]
v_pk_add_f32 v[192:193], v[192:193], v[196:197]
v_add_f32 v192, v192, v193
ds_write_b32 v253, v192 offset:1024
s_waitcnt lgkmcnt(0)
s_barrier
ds_read_b128 v[192:195], v254 offset:1024
ds_read_b128 v[196:199], v254 offset:1040
ds_read_b128 v[200:203], v254 offset:1056
ds_read_b128 v[204:207], v254 offset:1072
s_waitcnt lgkmcnt(2)
v_pk_add_f32 v[192:193], v[192:193], v[194:195]
v_pk_add_f32 v[196:197], v[196:197], v[198:199]
s_waitcnt lgkmcnt(0)
v_pk_add_f32 v[200:201], v[200:201], v[202:203]
v_pk_add_f32 v[204:205], v[204:205], v[206:207]
v_pk_add_f32 v[192:193], v[192:193], v[196:197]
v_pk_add_f32 v[200:201], v[200:201], v[204:205]
v_pk_add_f32 v[192:193], v[192:193], v[200:201]
v_add_f32 v192, v192, v193
v_mov_b32 v193, 0x3727c5ac
v_fmac_f32 v193, 0x3a800000, v192
v_rsq_f32 v192, v193
s_nop 0
v_mov_b32 v193, v192
v_pk_mul_f32 v[128:129], v[128:129], v[192:193]
v_pk_mul_f32 v[130:131], v[130:131], v[192:193]
v_pk_mul_f32 v[132:133], v[132:133], v[192:193]
v_pk_mul_f32 v[134:135], v[134:135], v[192:193]
v_pk_mul_f32 v[136:137], v[136:137], v[192:193]
v_pk_mul_f32 v[138:139], v[138:139], v[192:193]
v_pk_mul_f32 v[140:141], v[140:141], v[192:193]
v_pk_mul_f32 v[142:143], v[142:143], v[192:193]
v_pk_mul_f32 v[144:145], v[144:145], v[192:193]
v_pk_mul_f32 v[146:147], v[146:147], v[192:193]
v_pk_mul_f32 v[148:149], v[148:149], v[192:193]
v_pk_mul_f32 v[150:151], v[150:151], v[192:193]
v_pk_mul_f32 v[152:153], v[152:153], v[192:193]
v_pk_mul_f32 v[154:155], v[154:155], v[192:193]
v_pk_mul_f32 v[156:157], v[156:157], v[192:193]
v_pk_mul_f32 v[158:159], v[158:159], v[192:193]
v_pk_mul_f32 v[160:161], v[160:161], v[192:193]
v_pk_mul_f32 v[162:163], v[162:163], v[192:193]
v_pk_mul_f32 v[164:165], v[164:165], v[192:193]
v_pk_mul_f32 v[166:167], v[166:167], v[192:193]
v_pk_mul_f32 v[168:169], v[168:169], v[192:193]
v_pk_mul_f32 v[170:171], v[170:171], v[192:193]
v_pk_mul_f32 v[172:173], v[172:173], v[192:193]
v_pk_mul_f32 v[174:175], v[174:175], v[192:193]
v_pk_mul_f32 v[176:177], v[176:177], v[192:193]
v_pk_mul_f32 v[178:179], v[178:179], v[192:193]
v_pk_mul_f32 v[180:181], v[180:181], v[192:193]
v_pk_mul_f32 v[182:183], v[182:183], v[192:193]
v_pk_mul_f32 v[184:185], v[184:185], v[192:193]
v_pk_mul_f32 v[186:187], v[186:187], v[192:193]
v_pk_mul_f32 v[188:189], v[188:189], v[192:193]
v_pk_mul_f32 v[190:191], v[190:191], v[192:193]
v_cvt_pk_bf16_f32 v32, v128, v129
v_cvt_pk_bf16_f32 v33, v130, v131
v_cvt_pk_bf16_f32 v34, v132, v133
v_cvt_pk_bf16_f32 v35, v134, v135
v_cvt_pk_bf16_f32 v36, v136, v137
v_cvt_pk_bf16_f32 v37, v138, v139
v_cvt_pk_bf16_f32 v38, v140, v141
v_cvt_pk_bf16_f32 v39, v142, v143
v_cvt_pk_bf16_f32 v40, v144, v145
v_cvt_pk_bf16_f32 v41, v146, v147
v_cvt_pk_bf16_f32 v42, v148, v149
v_cvt_pk_bf16_f32 v43, v150, v151
v_cvt_pk_bf16_f32 v44, v152, v153
v_cvt_pk_bf16_f32 v45, v154, v155
v_cvt_pk_bf16_f32 v46, v156, v157
v_cvt_pk_bf16_f32 v47, v158, v159
v_cvt_pk_bf16_f32 v48, v160, v161
v_cvt_pk_bf16_f32 v49, v162, v163
v_cvt_pk_bf16_f32 v50, v164, v165
v_cvt_pk_bf16_f32 v51, v166, v167
v_cvt_pk_bf16_f32 v52, v168, v169
v_cvt_pk_bf16_f32 v53, v170, v171
v_cvt_pk_bf16_f32 v54, v172, v173
v_cvt_pk_bf16_f32 v55, v174, v175
v_cvt_pk_bf16_f32 v56, v176, v177
v_cvt_pk_bf16_f32 v57, v178, v179
v_cvt_pk_bf16_f32 v58, v180, v181
v_cvt_pk_bf16_f32 v59, v182, v183
v_cvt_pk_bf16_f32 v60, v184, v185
v_cvt_pk_bf16_f32 v61, v186, v187
v_cvt_pk_bf16_f32 v62, v188, v189
v_cvt_pk_bf16_f32 v63, v190, v191
buffer_store_dwordx4 v[32:35], v251, s[4:7], s21 offen offset:0 sc1
buffer_store_dwordx4 v[36:39], v251, s[4:7], s21 offen offset:1024 sc1
buffer_store_dwordx4 v[40:43], v251, s[4:7], s21 offen offset:2048 sc1
buffer_store_dwordx4 v[44:47], v251, s[4:7], s21 offen offset:3072 sc1
s_add_u32 s21, s21, 4096
buffer_store_dwordx4 v[48:51], v251, s[4:7], s21 offen offset:0 sc1
buffer_store_dwordx4 v[52:55], v251, s[4:7], s21 offen offset:1024 sc1
buffer_store_dwordx4 v[56:59], v251, s[4:7], s21 offen offset:2048 sc1
buffer_store_dwordx4 v[60:63], v251, s[4:7], s21 offen offset:3072 sc1
s_add_u32 s21, s21, 28672
s_mov_b32 s54, 0
main_kernel_w_done:
s_add_u32 s32, s23, 1
s_bitcmp0_b32 s32, 2
s_cselect_b32 s34, 7, 2
s_cselect_b32 s35, 2, 4
s_lshl_b32 s59, s23, 13
s_add_u32 s59, s59, 0x8404000
v_lshrrev_b32 v253, 3, v250
v_add_lshl_u32 v253, s24, v253, 9
v_and_b32 v254, 3, v250
v_lshl_add_u32 v253, v254, s34, v253
v_bfe_u32 v254, v250, 2, 1
v_add_u32 v254, s25, v254
v_lshl_add_u32 v248, v254, s35, v253
s_lshl_b32 s0, 4, s54
main_kernel_w_drain:
s_waitcnt vmcnt(0)
s_barrier
s_cmp_lg_u32 s14, 0
s_cbranch_scc1 main_kernel_w_bar
s_bfm_b64 exec, s0, 0
buffer_store_dword v244, v248, s[4:7], s59 offen sc1
s_mov_b64 exec, -1
s_cmp_eq_u32 s58, -1
s_cbranch_scc1 main_kernel_w_chk
s_lshl_b32 s32, s27, 8
s_add_u32 s32, s32, 0x841e000
s_mov_b64 exec, 1
v_mov_b32 v249, 1
buffer_atomic_add v249, off, s[4:7], s32 sc0 sc1
s_mov_b64 exec, -1
s_branch main_kernel_w_dec
.section .rodata,"a"
.p2align 6
.amdhsa_kernel main_kernel
  .amdhsa_next_free_vgpr 512
  .amdhsa_next_free_sgpr 102
  .amdhsa_accum_offset 256
  .amdhsa_group_segment_fixed_size 0
  .amdhsa_kernarg_size 120
  .amdhsa_user_sgpr_count 2
  .amdhsa_user_sgpr_kernarg_segment_ptr 1
  .amdhsa_system_sgpr_workgroup_id_x 1
.end_amdhsa_kernel
```

```asm
; @launch kernel=main_kernel grid=(256,1,1) block=(256,1,1) lds=163840
.amdgcn_target "amdgcn-amd-amdhsa--gfx950"
.text
.text
.globl main_kernel
.p2align 8
.type main_kernel,@function
main_kernel:
s_load_dwordx4 s[20:23], s[0:1], 104
s_load_dwordx8 s[40:47], s[0:1], 16
s_load_dwordx8 s[64:71], s[0:1], 64
s_load_dwordx2 s[72:73], s[0:1], 0
s_load_dwordx2 s[74:75], s[0:1], 96
s_load_dwordx2 s[76:77], s[0:1], 8
s_cmp_ge_u32 s2, 256
s_cbranch_scc1 main_kernel_end
v_lshrrev_b32 v126, 6, v0
v_and_b32 v94, 63, v0
v_and_b32 v250, 63, v0
v_readfirstlane_b32 s14, v126
s_mov_b32 s29, 0x80000
s_waitcnt lgkmcnt(0)
s_mov_b32 s60, s20
s_and_b32 s61, s21, 0xffff
s_mov_b32 s62, 0x100
s_mov_b32 s63, 0x20000
s_mov_b32 s4, s22
s_and_b32 s5, s23, 0xffff
s_mov_b32 s6, 0x10000000
s_mov_b32 s7, 0x20000
s_cmp_lg_u32 s14, 0
s_cbranch_scc1 main_kernel_slot_wait
s_getreg_b32 s12, hwreg(HW_REG_XCC_ID, 0, 4)
s_and_b32 s12, s12, 7
s_lshl_b32 s32, s12, 5
v_mov_b32 v126, 0
v_mov_b32 v127, 1
s_mov_b64 exec, 1
buffer_atomic_add v127, v126, s[60:63], s32 offen sc0 sc1
s_waitcnt vmcnt(0)
s_mov_b64 exec, -1
v_readfirstlane_b32 s13, v127
s_nop 3
s_cmp_lt_u32 s13, 32
s_cbranch_scc1 main_kernel_slot_pub
v_and_b32 v126, 7, v94
v_lshlrev_b32 v126, 5, v126
main_kernel_ovf_cnt:
buffer_load_dword v127, v126, s[60:63], 0 offen sc1
s_waitcnt vmcnt(0)
v_readlane_b32 s48, v127, 0
v_readlane_b32 s49, v127, 1
v_readlane_b32 s50, v127, 2
v_readlane_b32 s51, v127, 3
v_readlane_b32 s52, v127, 4
v_readlane_b32 s53, v127, 5
v_readlane_b32 s54, v127, 6
v_readlane_b32 s55, v127, 7
s_nop 3
s_add_u32 s33, s48, s49
s_add_u32 s33, s33, s50
s_add_u32 s33, s33, s51
s_add_u32 s33, s33, s52
s_add_u32 s33, s33, s53
s_add_u32 s33, s33, s54
s_add_u32 s33, s33, s55
s_cmp_ge_u32 s33, 256
s_cbranch_scc1 main_kernel_ovf_cnt_ok
s_sub_u32 s29, s29, 1
s_cbranch_scc1 main_kernel_end
s_sleep 4
s_branch main_kernel_ovf_cnt
main_kernel_ovf_cnt_ok:
v_mov_b32 v126, 0
v_mov_b32 v127, 1
s_mov_b64 exec, 1
buffer_atomic_add v127, v126, s[60:63], 0 offen offset:8 sc0 sc1
s_waitcnt vmcnt(0)
s_mov_b64 exec, -1
v_readfirstlane_b32 s33, v127
s_nop 3
s_min_u32 s34, s48, 32
s_sub_u32 s35, 32, s34
s_mov_b32 s12, 0
s_add_u32 s13, s34, s33
s_cmp_lt_u32 s33, s35
s_cbranch_scc1 main_kernel_slot_pub
s_sub_u32 s33, s33, s35
s_min_u32 s34, s49, 32
s_sub_u32 s35, 32, s34
s_mov_b32 s12, 1
s_add_u32 s13, s34, s33
s_cmp_lt_u32 s33, s35
s_cbranch_scc1 main_kernel_slot_pub
s_sub_u32 s33, s33, s35
s_min_u32 s34, s50, 32
s_sub_u32 s35, 32, s34
s_mov_b32 s12, 2
s_add_u32 s13, s34, s33
s_cmp_lt_u32 s33, s35
s_cbranch_scc1 main_kernel_slot_pub
s_sub_u32 s33, s33, s35
s_min_u32 s34, s51, 32
s_sub_u32 s35, 32, s34
s_mov_b32 s12, 3
s_add_u32 s13, s34, s33
s_cmp_lt_u32 s33, s35
s_cbranch_scc1 main_kernel_slot_pub
s_sub_u32 s33, s33, s35
s_min_u32 s34, s52, 32
s_sub_u32 s35, 32, s34
s_mov_b32 s12, 4
s_add_u32 s13, s34, s33
s_cmp_lt_u32 s33, s35
s_cbranch_scc1 main_kernel_slot_pub
s_sub_u32 s33, s33, s35
s_min_u32 s34, s53, 32
s_sub_u32 s35, 32, s34
s_mov_b32 s12, 5
s_add_u32 s13, s34, s33
s_cmp_lt_u32 s33, s35
s_cbranch_scc1 main_kernel_slot_pub
s_sub_u32 s33, s33, s35
s_min_u32 s34, s54, 32
s_sub_u32 s35, 32, s34
s_mov_b32 s12, 6
s_add_u32 s13, s34, s33
s_cmp_lt_u32 s33, s35
s_cbranch_scc1 main_kernel_slot_pub
s_sub_u32 s33, s33, s35
s_min_u32 s34, s55, 32
s_sub_u32 s35, 32, s34
s_mov_b32 s12, 7
s_add_u32 s13, s34, s33
s_cmp_lt_u32 s33, s35
s_cbranch_scc1 main_kernel_slot_pub
s_sub_u32 s33, s33, s35
s_mov_b32 s12, 8
s_mov_b32 s13, 0
main_kernel_slot_pub:
v_mov_b32 v126, 0
v_mov_b32 v127, s12
v_mov_b32 v95, s13
ds_write_b32 v126, v127
ds_write_b32 v126, v95 offset:4
s_waitcnt lgkmcnt(0)
main_kernel_slot_wait:
s_barrier
v_mov_b32 v126, 0
ds_read_b32 v127, v126
ds_read_b32 v95, v126 offset:4
s_waitcnt lgkmcnt(0)
v_readfirstlane_b32 s12, v127
v_readfirstlane_b32 s13, v95
s_nop 3
s_barrier
s_cmp_ge_u32 s12, 8
s_cbranch_scc1 main_kernel_end
s_cmp_lt_u32 s12, 2
s_cbranch_scc1 main_kernel_chain
s_mov_b32 s96, s72
s_and_b32 s97, s73, 0xffff
s_mov_b32 s98, 0x400000
s_mov_b32 s99, 0x20000
s_mov_b32 s92, s74
s_and_b32 s93, s75, 0xffff
s_mov_b32 s94, 0x400000
s_mov_b32 s95, 0x20000
v_lshlrev_b32 v1, 4, v0
v_lshlrev_b32 v251, 4, v250
v_mov_b32 v4, 0
v_mov_b32 v8, -1
v_mov_b32 v5, 0
v_mov_b32 v9, -1
v_mov_b32 v6, 0
v_mov_b32 v10, -1
v_mov_b32 v7, 0
v_mov_b32 v11, -1
v_mul_u32_u24 v12, 128, v0
s_lshl_b32 s15, s12, 4
s_and_b32 s32, s12, 1
s_lshl_b32 s32, s32, 5
s_cmp_lt_u32 s12, 4
s_cselect_b32 s15, s32, s15
s_cselect_b32 s32, 32, 16
s_add_u32 s15, s15, s13
s_sub_u32 s16, s15, 80
s_sub_u32 s27, s12, 2
s_mov_b32 s52, 0
s_cmp_lt_u32 s13, s32
s_cbranch_scc1 main_kernel_s_ln
s_cmp_lg_u32 s13, 16
s_cbranch_scc1 main_kernel_s_fill
s_lshl_b32 s32, s16, 11
s_add_u32 s32, s32, 0x8400000
buffer_store_dwordx4 v[4:7], v1, s[4:7], s32 offen sc1
s_add_u32 s32, s32, 4096
buffer_store_dwordx4 v[4:7], v1, s[4:7], s32 offen sc1
s_add_u32 s32, s32, 4096
buffer_store_dwordx4 v[4:7], v1, s[4:7], s32 offen sc1
s_add_u32 s32, s32, 4096
buffer_store_dwordx4 v[4:7], v1, s[4:7], s32 offen sc1
s_add_u32 s32, s32, 4096
buffer_store_dwordx4 v[4:7], v1, s[4:7], s32 offen sc1
s_add_u32 s32, s32, 4096
buffer_store_dwordx4 v[4:7], v1, s[4:7], s32 offen sc1
s_add_u32 s32, s32, 4096
buffer_store_dwordx4 v[4:7], v1, s[4:7], s32 offen sc1
s_add_u32 s32, s32, 4096
buffer_store_dwordx4 v[4:7], v1, s[4:7], s32 offen sc1
s_add_u32 s32, s32, 4096
v_bfe_u32 v2, v0, 2, 1
s_lshr_b32 s32, s14, 1
v_and_b32 v2, s32, v2
s_bitcmp1_b32 s14, 0
s_cselect_b32 s32, 15, 0
s_cselect_b32 s33, 4161536, 0
v_xor_b32 v2, s32, v2
v_lshlrev_b32 v2, 4, v2
v_and_b32 v3, 3, v0
v_lshl_add_u32 v2, v3, 8, v2
v_lshrrev_b32 v3, 3, v0
v_lshl_add_u32 v2, v3, 10, v2
s_add_u32 s33, s33, 0x4808000
buffer_store_dwordx4 v[4:7], v2, s[4:7], s33 offen sc1
s_waitcnt vmcnt(0)
s_barrier
s_cmp_lg_u32 s14, 0
s_cbranch_scc1 main_kernel_s_fill
v_mov_b32 v2, 1
s_mov_b64 exec, 1
buffer_atomic_add v2, v4, s[60:63], 0 offen offset:12 sc1
s_mov_b64 exec, -1
s_branch main_kernel_s_fill
main_kernel_s_ln:
v_and_b32 v3, 15, v250
v_and_b32 v2, 48, v250
v_lshl_add_u32 v3, v3, 11, v2
s_lshl_b32 s34, s15, 15
s_lshl_b32 s32, s14, 9
s_add_u32 s32, s34, s32
buffer_load_dwordx4 v[32:35], v3, s[96:99], s32 offen offset:0
buffer_load_dwordx4 v[36:39], v3, s[96:99], s32 offen offset:64
buffer_load_dwordx4 v[40:43], v3, s[96:99], s32 offen offset:128
buffer_load_dwordx4 v[44:47], v3, s[96:99], s32 offen offset:192
buffer_load_dwordx4 v[48:51], v3, s[96:99], s32 offen offset:256
buffer_load_dwordx4 v[52:55], v3, s[96:99], s32 offen offset:320
buffer_load_dwordx4 v[56:59], v3, s[96:99], s32 offen offset:384
buffer_load_dwordx4 v[60:63], v3, s[96:99], s32 offen offset:448
v_and_b32 v255, 15, v250
v_lshlrev_b32 v254, 6, v255
v_add_u32 v254, 132096, v254
v_lshrrev_b32 v255, 4, v250
v_lshl_add_u32 v253, v255, 2, v254
v_lshl_add_u32 v253, s14, 4, v253
s_lshl_b32 s32, s14, 13
s_add_u32 s34, s34, s32
s_waitcnt vmcnt(0)
v_permlane16_swap_b32 v32, v34
v_permlane16_swap_b32 v33, v35
v_permlane16_swap_b32 v36, v38
v_permlane16_swap_b32 v37, v39
v_permlane16_swap_b32 v40, v42
v_permlane16_swap_b32 v41, v43
v_permlane16_swap_b32 v44, v46
v_permlane16_swap_b32 v45, v47
v_permlane16_swap_b32 v48, v50
v_permlane16_swap_b32 v49, v51
v_permlane16_swap_b32 v52, v54
v_permlane16_swap_b32 v53, v55
v_permlane16_swap_b32 v56, v58
v_permlane16_swap_b32 v57, v59
v_permlane16_swap_b32 v60, v62
v_permlane16_swap_b32 v61, v63
v_permlane32_swap_b32 v32, v34
v_permlane32_swap_b32 v33, v35
v_permlane32_swap_b32 v36, v38
v_permlane32_swap_b32 v37, v39
v_permlane32_swap_b32 v40, v42
v_permlane32_swap_b32 v41, v43
v_permlane32_swap_b32 v44, v46
v_permlane32_swap_b32 v45, v47
v_permlane32_swap_b32 v48, v50
v_permlane32_swap_b32 v49, v51
v_permlane32_swap_b32 v52, v54
v_permlane32_swap_b32 v53, v55
v_permlane32_swap_b32 v56, v58
v_permlane32_swap_b32 v57, v59
v_permlane32_swap_b32 v60, v62
v_permlane32_swap_b32 v61, v63
s_lshr_b32 s32, s15, 3
s_lshl_b32 s32, s32, 9
s_and_b32 s33, s15, 7
s_lshl_b32 s33, s33, 4
s_add_u32 s32, s32, s33
s_add_u32 s16, s32, 0x8416000
v_lshlrev_b32 v64, 16, v32
v_and_b32 v65, 0xffff0000, v32
v_lshlrev_b32 v66, 16, v33
v_and_b32 v67, 0xffff0000, v33
v_lshlrev_b32 v68, 16, v34
v_and_b32 v69, 0xffff0000, v34
v_lshlrev_b32 v70, 16, v35
v_and_b32 v71, 0xffff0000, v35
v_lshlrev_b32 v72, 16, v36
v_and_b32 v73, 0xffff0000, v36
v_lshlrev_b32 v74, 16, v37
v_and_b32 v75, 0xffff0000, v37
v_lshlrev_b32 v76, 16, v38
v_and_b32 v77, 0xffff0000, v38
v_lshlrev_b32 v78, 16, v39
v_and_b32 v79, 0xffff0000, v39
v_lshlrev_b32 v80, 16, v40
v_and_b32 v81, 0xffff0000, v40
v_lshlrev_b32 v82, 16, v41
v_and_b32 v83, 0xffff0000, v41
v_lshlrev_b32 v84, 16, v42
v_and_b32 v85, 0xffff0000, v42
v_lshlrev_b32 v86, 16, v43
v_and_b32 v87, 0xffff0000, v43
v_lshlrev_b32 v88, 16, v44
v_and_b32 v89, 0xffff0000, v44
v_lshlrev_b32 v90, 16, v45
v_and_b32 v91, 0xffff0000, v45
v_lshlrev_b32 v92, 16, v46
v_and_b32 v93, 0xffff0000, v46
v_lshlrev_b32 v94, 16, v47
v_and_b32 v95, 0xffff0000, v47
v_lshlrev_b32 v96, 16, v48
v_and_b32 v97, 0xffff0000, v48
v_lshlrev_b32 v98, 16, v49
v_and_b32 v99, 0xffff0000, v49
v_lshlrev_b32 v100, 16, v50
v_and_b32 v101, 0xffff0000, v50
v_lshlrev_b32 v102, 16, v51
v_and_b32 v103, 0xffff0000, v51
v_lshlrev_b32 v104, 16, v52
v_and_b32 v105, 0xffff0000, v52
v_lshlrev_b32 v106, 16, v53
v_and_b32 v107, 0xffff0000, v53
v_lshlrev_b32 v108, 16, v54
v_and_b32 v109, 0xffff0000, v54
v_lshlrev_b32 v110, 16, v55
v_and_b32 v111, 0xffff0000, v55
v_lshlrev_b32 v112, 16, v56
v_and_b32 v113, 0xffff0000, v56
v_lshlrev_b32 v114, 16, v57
v_and_b32 v115, 0xffff0000, v57
v_lshlrev_b32 v116, 16, v58
v_and_b32 v117, 0xffff0000, v58
v_lshlrev_b32 v118, 16, v59
v_and_b32 v119, 0xffff0000, v59
v_lshlrev_b32 v120, 16, v60
v_and_b32 v121, 0xffff0000, v60
v_lshlrev_b32 v122, 16, v61
v_and_b32 v123, 0xffff0000, v61
v_lshlrev_b32 v124, 16, v62
v_and_b32 v125, 0xffff0000, v62
v_lshlrev_b32 v126, 16, v63
v_and_b32 v127, 0xffff0000, v63
v_pk_add_f32 v[16:17], v[64:65], v[72:73]
v_pk_add_f32 v[18:19], v[66:67], v[74:75]
v_pk_add_f32 v[20:21], v[68:69], v[76:77]
v_pk_add_f32 v[22:23], v[70:71], v[78:79]
v_pk_add_f32 v[16:17], v[16:17], v[80:81]
v_pk_add_f32 v[18:19], v[18:19], v[82:83]
v_pk_add_f32 v[20:21], v[20:21], v[84:85]
v_pk_add_f32 v[22:23], v[22:23], v[86:87]
v_pk_add_f32 v[16:17], v[16:17], v[88:89]
v_pk_add_f32 v[18:19], v[18:19], v[90:91]
v_pk_add_f32 v[20:21], v[20:21], v[92:93]
v_pk_add_f32 v[22:23], v[22:23], v[94:95]
v_pk_add_f32 v[16:17], v[16:17], v[96:97]
v_pk_add_f32 v[18:19], v[18:19], v[98:99]
v_pk_add_f32 v[20:21], v[20:21], v[100:101]
v_pk_add_f32 v[22:23], v[22:23], v[102:103]
v_pk_add_f32 v[16:17], v[16:17], v[104:105]
v_pk_add_f32 v[18:19], v[18:19], v[106:107]
v_pk_add_f32 v[20:21], v[20:21], v[108:109]
v_pk_add_f32 v[22:23], v[22:23], v[110:111]
v_pk_add_f32 v[16:17], v[16:17], v[112:113]
v_pk_add_f32 v[18:19], v[18:19], v[114:115]
v_pk_add_f32 v[20:21], v[20:21], v[116:117]
v_pk_add_f32 v[22:23], v[22:23], v[118:119]
v_pk_add_f32 v[16:17], v[16:17], v[120:121]
v_pk_add_f32 v[18:19], v[18:19], v[122:123]
v_pk_add_f32 v[20:21], v[20:21], v[124:125]
v_pk_add_f32 v[22:23], v[22:23], v[126:127]
v_pk_add_f32 v[16:17], v[16:17], v[18:19]
v_pk_add_f32 v[20:21], v[20:21], v[22:23]
v_pk_add_f32 v[16:17], v[16:17], v[20:21]
v_add_f32 v16, v16, v17
ds_write_b32 v253, v16 offset:0
s_waitcnt lgkmcnt(0)
s_barrier
ds_read_b128 v[16:19], v254 offset:0
ds_read_b128 v[20:23], v254 offset:16
ds_read_b128 v[24:27], v254 offset:32
ds_read_b128 v[28:31], v254 offset:48
s_waitcnt lgkmcnt(2)
v_pk_add_f32 v[16:17], v[16:17], v[18:19]
v_pk_add_f32 v[20:21], v[20:21], v[22:23]
s_waitcnt lgkmcnt(0)
v_pk_add_f32 v[24:25], v[24:25], v[26:27]
v_pk_add_f32 v[28:29], v[28:29], v[30:31]
v_pk_add_f32 v[16:17], v[16:17], v[20:21]
v_pk_add_f32 v[24:25], v[24:25], v[28:29]
v_pk_add_f32 v[16:17], v[16:17], v[24:25]
v_add_f32 v16, v16, v17
v_mul_f32 v16, 0xba800000, v16
v_mov_b32 v17, v16
v_pk_add_f32 v[64:65], v[64:65], v[16:17]
v_pk_add_f32 v[66:67], v[66:67], v[16:17]
v_pk_add_f32 v[68:69], v[68:69], v[16:17]
v_pk_add_f32 v[70:71], v[70:71], v[16:17]
v_pk_add_f32 v[72:73], v[72:73], v[16:17]
v_pk_add_f32 v[74:75], v[74:75], v[16:17]
v_pk_add_f32 v[76:77], v[76:77], v[16:17]
v_pk_add_f32 v[78:79], v[78:79], v[16:17]
v_pk_add_f32 v[80:81], v[80:81], v[16:17]
v_pk_add_f32 v[82:83], v[82:83], v[16:17]
v_pk_add_f32 v[84:85], v[84:85], v[16:17]
v_pk_add_f32 v[86:87], v[86:87], v[16:17]
v_pk_add_f32 v[88:89], v[88:89], v[16:17]
v_pk_add_f32 v[90:91], v[90:91], v[16:17]
v_pk_add_f32 v[92:93], v[92:93], v[16:17]
v_pk_add_f32 v[94:95], v[94:95], v[16:17]
v_pk_add_f32 v[96:97], v[96:97], v[16:17]
v_pk_add_f32 v[98:99], v[98:99], v[16:17]
v_pk_add_f32 v[100:101], v[100:101], v[16:17]
v_pk_add_f32 v[102:103], v[102:103], v[16:17]
v_pk_add_f32 v[104:105], v[104:105], v[16:17]
v_pk_add_f32 v[106:107], v[106:107], v[16:17]
v_pk_add_f32 v[108:109], v[108:109], v[16:17]
v_pk_add_f32 v[110:111], v[110:111], v[16:17]
v_pk_add_f32 v[112:113], v[112:113], v[16:17]
v_pk_add_f32 v[114:115], v[114:115], v[16:17]
v_pk_add_f32 v[116:117], v[116:117], v[16:17]
v_pk_add_f32 v[118:119], v[118:119], v[16:17]
v_pk_add_f32 v[120:121], v[120:121], v[16:17]
v_pk_add_f32 v[122:123], v[122:123], v[16:17]
v_pk_add_f32 v[124:125], v[124:125], v[16:17]
v_pk_add_f32 v[126:127], v[126:127], v[16:17]
v_pk_mul_f32 v[16:17], v[64:65], v[64:65]
v_pk_mul_f32 v[18:19], v[66:67], v[66:67]
v_pk_mul_f32 v[20:21], v[68:69], v[68:69]
v_pk_mul_f32 v[22:23], v[70:71], v[70:71]
v_pk_fma_f32 v[16:17], v[72:73], v[72:73], v[16:17]
v_pk_fma_f32 v[18:19], v[74:75], v[74:75], v[18:19]
v_pk_fma_f32 v[20:21], v[76:77], v[76:77], v[20:21]
v_pk_fma_f32 v[22:23], v[78:79], v[78:79], v[22:23]
v_pk_fma_f32 v[16:17], v[80:81], v[80:81], v[16:17]
v_pk_fma_f32 v[18:19], v[82:83], v[82:83], v[18:19]
v_pk_fma_f32 v[20:21], v[84:85], v[84:85], v[20:21]
v_pk_fma_f32 v[22:23], v[86:87], v[86:87], v[22:23]
v_pk_fma_f32 v[16:17], v[88:89], v[88:89], v[16:17]
v_pk_fma_f32 v[18:19], v[90:91], v[90:91], v[18:19]
v_pk_fma_f32 v[20:21], v[92:93], v[92:93], v[20:21]
v_pk_fma_f32 v[22:23], v[94:95], v[94:95], v[22:23]
v_pk_fma_f32 v[16:17], v[96:97], v[96:97], v[16:17]
v_pk_fma_f32 v[18:19], v[98:99], v[98:99], v[18:19]
v_pk_fma_f32 v[20:21], v[100:101], v[100:101], v[20:21]
v_pk_fma_f32 v[22:23], v[102:103], v[102:103], v[22:23]
v_pk_fma_f32 v[16:17], v[104:105], v[104:105], v[16:17]
v_pk_fma_f32 v[18:19], v[106:107], v[106:107], v[18:19]
v_pk_fma_f32 v[20:21], v[108:109], v[108:109], v[20:21]
v_pk_fma_f32 v[22:23], v[110:111], v[110:111], v[22:23]
v_pk_fma_f32 v[16:17], v[112:113], v[112:113], v[16:17]
v_pk_fma_f32 v[18:19], v[114:115], v[114:115], v[18:19]
v_pk_fma_f32 v[20:21], v[116:117], v[116:117], v[20:21]
v_pk_fma_f32 v[22:23], v[118:119], v[118:119], v[22:23]
v_pk_fma_f32 v[16:17], v[120:121], v[120:121], v[16:17]
v_pk_fma_f32 v[18:19], v[122:123], v[122:123], v[18:19]
v_pk_fma_f32 v[20:21], v[124:125], v[124:125], v[20:21]
v_pk_fma_f32 v[22:23], v[126:127], v[126:127], v[22:23]
v_pk_add_f32 v[16:17], v[16:17], v[18:19]
v_pk_add_f32 v[20:21], v[20:21], v[22:23]
v_pk_add_f32 v[16:17], v[16:17], v[20:21]
v_add_f32 v16, v16, v17
ds_write_b32 v253, v16 offset:1024
s_waitcnt lgkmcnt(0)
s_barrier
ds_read_b128 v[16:19], v254 offset:1024
ds_read_b128 v[20:23], v254 offset:1040
ds_read_b128 v[24:27], v254 offset:1056
ds_read_b128 v[28:31], v254 offset:1072
s_waitcnt lgkmcnt(2)
v_pk_add_f32 v[16:17], v[16:17], v[18:19]
v_pk_add_f32 v[20:21], v[20:21], v[22:23]
s_waitcnt lgkmcnt(0)
v_pk_add_f32 v[24:25], v[24:25], v[26:27]
v_pk_add_f32 v[28:29], v[28:29], v[30:31]
v_pk_add_f32 v[16:17], v[16:17], v[20:21]
v_pk_add_f32 v[24:25], v[24:25], v[28:29]
v_pk_add_f32 v[16:17], v[16:17], v[24:25]
v_add_f32 v16, v16, v17
v_mov_b32 v17, 0x3727c5ac
v_fmac_f32 v17, 0x3a800000, v16
v_rsq_f32 v16, v17
s_nop 0
v_mov_b32 v17, v16
v_pk_mul_f32 v[64:65], v[64:65], v[16:17]
v_pk_mul_f32 v[66:67], v[66:67], v[16:17]
v_pk_mul_f32 v[68:69], v[68:69], v[16:17]
v_pk_mul_f32 v[70:71], v[70:71], v[16:17]
v_pk_mul_f32 v[72:73], v[72:73], v[16:17]
v_pk_mul_f32 v[74:75], v[74:75], v[16:17]
v_pk_mul_f32 v[76:77], v[76:77], v[16:17]
v_pk_mul_f32 v[78:79], v[78:79], v[16:17]
v_pk_mul_f32 v[80:81], v[80:81], v[16:17]
v_pk_mul_f32 v[82:83], v[82:83], v[16:17]
v_pk_mul_f32 v[84:85], v[84:85], v[16:17]
v_pk_mul_f32 v[86:87], v[86:87], v[16:17]
v_pk_mul_f32 v[88:89], v[88:89], v[16:17]
v_pk_mul_f32 v[90:91], v[90:91], v[16:17]
v_pk_mul_f32 v[92:93], v[92:93], v[16:17]
v_pk_mul_f32 v[94:95], v[94:95], v[16:17]
v_pk_mul_f32 v[96:97], v[96:97], v[16:17]
v_pk_mul_f32 v[98:99], v[98:99], v[16:17]
v_pk_mul_f32 v[100:101], v[100:101], v[16:17]
v_pk_mul_f32 v[102:103], v[102:103], v[16:17]
v_pk_mul_f32 v[104:105], v[104:105], v[16:17]
v_pk_mul_f32 v[106:107], v[106:107], v[16:17]
v_pk_mul_f32 v[108:109], v[108:109], v[16:17]
v_pk_mul_f32 v[110:111], v[110:111], v[16:17]
v_pk_mul_f32 v[112:113], v[112:113], v[16:17]
v_pk_mul_f32 v[114:115], v[114:115], v[16:17]
v_pk_mul_f32 v[116:117], v[116:117], v[16:17]
v_pk_mul_f32 v[118:119], v[118:119], v[16:17]
v_pk_mul_f32 v[120:121], v[120:121], v[16:17]
v_pk_mul_f32 v[122:123], v[122:123], v[16:17]
v_pk_mul_f32 v[124:125], v[124:125], v[16:17]
v_pk_mul_f32 v[126:127], v[126:127], v[16:17]
v_cvt_pk_bf16_f32 v128, v64, v65
v_cvt_pk_bf16_f32 v129, v66, v67
v_cvt_pk_bf16_f32 v130, v68, v69
v_cvt_pk_bf16_f32 v131, v70, v71
v_cvt_pk_bf16_f32 v132, v72, v73
v_cvt_pk_bf16_f32 v133, v74, v75
v_cvt_pk_bf16_f32 v134, v76, v77
v_cvt_pk_bf16_f32 v135, v78, v79
v_cvt_pk_bf16_f32 v136, v80, v81
v_cvt_pk_bf16_f32 v137, v82, v83
v_cvt_pk_bf16_f32 v138, v84, v85
v_cvt_pk_bf16_f32 v139, v86, v87
v_cvt_pk_bf16_f32 v140, v88, v89
v_cvt_pk_bf16_f32 v141, v90, v91
v_cvt_pk_bf16_f32 v142, v92, v93
v_cvt_pk_bf16_f32 v143, v94, v95
v_cvt_pk_bf16_f32 v144, v96, v97
v_cvt_pk_bf16_f32 v145, v98, v99
v_cvt_pk_bf16_f32 v146, v100, v101
v_cvt_pk_bf16_f32 v147, v102, v103
v_cvt_pk_bf16_f32 v148, v104, v105
v_cvt_pk_bf16_f32 v149, v106, v107
v_cvt_pk_bf16_f32 v150, v108, v109
v_cvt_pk_bf16_f32 v151, v110, v111
v_cvt_pk_bf16_f32 v152, v112, v113
v_cvt_pk_bf16_f32 v153, v114, v115
v_cvt_pk_bf16_f32 v154, v116, v117
v_cvt_pk_bf16_f32 v155, v118, v119
v_cvt_pk_bf16_f32 v156, v120, v121
v_cvt_pk_bf16_f32 v157, v122, v123
v_cvt_pk_bf16_f32 v158, v124, v125
v_cvt_pk_bf16_f32 v159, v126, v127
s_add_u32 s32, s34, 0x0
s_add_u32 s33, s32, 4096
buffer_store_dwordx4 v[128:131], v251, s[4:7], s32 offen offset:0 sc1
buffer_store_dwordx4 v[132:135], v251, s[4:7], s32 offen offset:1024 sc1
buffer_store_dwordx4 v[136:139], v251, s[4:7], s32 offen offset:2048 sc1
buffer_store_dwordx4 v[140:143], v251, s[4:7], s32 offen offset:3072 sc1
buffer_store_dwordx4 v[144:147], v251, s[4:7], s33 offen offset:0 sc1
buffer_store_dwordx4 v[148:151], v251, s[4:7], s33 offen offset:1024 sc1
buffer_store_dwordx4 v[152:155], v251, s[4:7], s33 offen offset:2048 sc1
buffer_store_dwordx4 v[156:159], v251, s[4:7], s33 offen offset:3072 sc1
buffer_load_dword v2, v4, s[60:63], 0 offen offset:12 sc1
v_lshlrev_b32 v64, 16, v128
v_and_b32 v65, 0xffff0000, v128
v_lshlrev_b32 v66, 16, v129
v_and_b32 v67, 0xffff0000, v129
v_lshlrev_b32 v68, 16, v130
v_and_b32 v69, 0xffff0000, v130
v_lshlrev_b32 v70, 16, v131
v_and_b32 v71, 0xffff0000, v131
v_lshlrev_b32 v72, 16, v132
v_and_b32 v73, 0xffff0000, v132
v_lshlrev_b32 v74, 16, v133
v_and_b32 v75, 0xffff0000, v133
v_lshlrev_b32 v76, 16, v134
v_and_b32 v77, 0xffff0000, v134
v_lshlrev_b32 v78, 16, v135
v_and_b32 v79, 0xffff0000, v135
v_lshlrev_b32 v80, 16, v136
v_and_b32 v81, 0xffff0000, v136
v_lshlrev_b32 v82, 16, v137
v_and_b32 v83, 0xffff0000, v137
v_lshlrev_b32 v84, 16, v138
v_and_b32 v85, 0xffff0000, v138
v_lshlrev_b32 v86, 16, v139
v_and_b32 v87, 0xffff0000, v139
v_lshlrev_b32 v88, 16, v140
v_and_b32 v89, 0xffff0000, v140
v_lshlrev_b32 v90, 16, v141
v_and_b32 v91, 0xffff0000, v141
v_lshlrev_b32 v92, 16, v142
v_and_b32 v93, 0xffff0000, v142
v_lshlrev_b32 v94, 16, v143
v_and_b32 v95, 0xffff0000, v143
v_lshlrev_b32 v96, 16, v144
v_and_b32 v97, 0xffff0000, v144
v_lshlrev_b32 v98, 16, v145
v_and_b32 v99, 0xffff0000, v145
v_lshlrev_b32 v100, 16, v146
v_and_b32 v101, 0xffff0000, v146
v_lshlrev_b32 v102, 16, v147
v_and_b32 v103, 0xffff0000, v147
v_lshlrev_b32 v104, 16, v148
v_and_b32 v105, 0xffff0000, v148
v_lshlrev_b32 v106, 16, v149
v_and_b32 v107, 0xffff0000, v149
v_lshlrev_b32 v108, 16, v150
v_and_b32 v109, 0xffff0000, v150
v_lshlrev_b32 v110, 16, v151
v_and_b32 v111, 0xffff0000, v151
v_lshlrev_b32 v112, 16, v152
v_and_b32 v113, 0xffff0000, v152
v_lshlrev_b32 v114, 16, v153
v_and_b32 v115, 0xffff0000, v153
v_lshlrev_b32 v116, 16, v154
v_and_b32 v117, 0xffff0000, v154
v_lshlrev_b32 v118, 16, v155
v_and_b32 v119, 0xffff0000, v155
v_lshlrev_b32 v120, 16, v156
v_and_b32 v121, 0xffff0000, v156
v_lshlrev_b32 v122, 16, v157
v_and_b32 v123, 0xffff0000, v157
v_lshlrev_b32 v124, 16, v158
v_and_b32 v125, 0xffff0000, v158
v_lshlrev_b32 v126, 16, v159
v_and_b32 v127, 0xffff0000, v159
v_pk_add_f32 v[16:17], v[64:65], v[72:73]
v_pk_add_f32 v[18:19], v[66:67], v[74:75]
v_pk_add_f32 v[20:21], v[68:69], v[76:77]
v_pk_add_f32 v[22:23], v[70:71], v[78:79]
v_pk_add_f32 v[16:17], v[16:17], v[80:81]
v_pk_add_f32 v[18:19], v[18:19], v[82:83]
v_pk_add_f32 v[20:21], v[20:21], v[84:85]
v_pk_add_f32 v[22:23], v[22:23], v[86:87]
v_pk_add_f32 v[16:17], v[16:17], v[88:89]
v_pk_add_f32 v[18:19], v[18:19], v[90:91]
v_pk_add_f32 v[20:21], v[20:21], v[92:93]
v_pk_add_f32 v[22:23], v[22:23], v[94:95]
v_pk_add_f32 v[16:17], v[16:17], v[96:97]
v_pk_add_f32 v[18:19], v[18:19], v[98:99]
v_pk_add_f32 v[20:21], v[20:21], v[100:101]
v_pk_add_f32 v[22:23], v[22:23], v[102:103]
v_pk_add_f32 v[16:17], v[16:17], v[104:105]
v_pk_add_f32 v[18:19], v[18:19], v[106:107]
v_pk_add_f32 v[20:21], v[20:21], v[108:109]
v_pk_add_f32 v[22:23], v[22:23], v[110:111]
v_pk_add_f32 v[16:17], v[16:17], v[112:113]
v_pk_add_f32 v[18:19], v[18:19], v[114:115]
v_pk_add_f32 v[20:21], v[20:21], v[116:117]
v_pk_add_f32 v[22:23], v[22:23], v[118:119]
v_pk_add_f32 v[16:17], v[16:17], v[120:121]
v_pk_add_f32 v[18:19], v[18:19], v[122:123]
v_pk_add_f32 v[20:21], v[20:21], v[124:125]
v_pk_add_f32 v[22:23], v[22:23], v[126:127]
v_pk_add_f32 v[16:17], v[16:17], v[18:19]
v_pk_add_f32 v[20:21], v[20:21], v[22:23]
v_pk_add_f32 v[16:17], v[16:17], v[20:21]
v_add_f32 v16, v16, v17
ds_write_b32 v253, v16 offset:0
s_waitcnt lgkmcnt(0)
s_barrier
ds_read_b128 v[16:19], v254 offset:0
ds_read_b128 v[20:23], v254 offset:16
ds_read_b128 v[24:27], v254 offset:32
ds_read_b128 v[28:31], v254 offset:48
s_waitcnt lgkmcnt(2)
v_pk_add_f32 v[16:17], v[16:17], v[18:19]
v_pk_add_f32 v[20:21], v[20:21], v[22:23]
s_waitcnt lgkmcnt(0)
v_pk_add_f32 v[24:25], v[24:25], v[26:27]
v_pk_add_f32 v[28:29], v[28:29], v[30:31]
v_pk_add_f32 v[16:17], v[16:17], v[20:21]
v_pk_add_f32 v[24:25], v[24:25], v[28:29]
v_pk_add_f32 v[16:17], v[16:17], v[24:25]
v_add_f32 v16, v16, v17
v_mul_f32 v16, 0xba800000, v16
v_mov_b32 v17, v16
v_pk_add_f32 v[64:65], v[64:65], v[16:17]
v_pk_add_f32 v[66:67], v[66:67], v[16:17]
v_pk_add_f32 v[68:69], v[68:69], v[16:17]
v_pk_add_f32 v[70:71], v[70:71], v[16:17]
v_pk_add_f32 v[72:73], v[72:73], v[16:17]
v_pk_add_f32 v[74:75], v[74:75], v[16:17]
v_pk_add_f32 v[76:77], v[76:77], v[16:17]
v_pk_add_f32 v[78:79], v[78:79], v[16:17]
v_pk_add_f32 v[80:81], v[80:81], v[16:17]
v_pk_add_f32 v[82:83], v[82:83], v[16:17]
v_pk_add_f32 v[84:85], v[84:85], v[16:17]
v_pk_add_f32 v[86:87], v[86:87], v[16:17]
v_pk_add_f32 v[88:89], v[88:89], v[16:17]
v_pk_add_f32 v[90:91], v[90:91], v[16:17]
v_pk_add_f32 v[92:93], v[92:93], v[16:17]
v_pk_add_f32 v[94:95], v[94:95], v[16:17]
v_pk_add_f32 v[96:97], v[96:97], v[16:17]
v_pk_add_f32 v[98:99], v[98:99], v[16:17]
v_pk_add_f32 v[100:101], v[100:101], v[16:17]
v_pk_add_f32 v[102:103], v[102:103], v[16:17]
v_pk_add_f32 v[104:105], v[104:105], v[16:17]
v_pk_add_f32 v[106:107], v[106:107], v[16:17]
v_pk_add_f32 v[108:109], v[108:109], v[16:17]
v_pk_add_f32 v[110:111], v[110:111], v[16:17]
v_pk_add_f32 v[112:113], v[112:113], v[16:17]
v_pk_add_f32 v[114:115], v[114:115], v[16:17]
v_pk_add_f32 v[116:117], v[116:117], v[16:17]
v_pk_add_f32 v[118:119], v[118:119], v[16:17]
v_pk_add_f32 v[120:121], v[120:121], v[16:17]
v_pk_add_f32 v[122:123], v[122:123], v[16:17]
v_pk_add_f32 v[124:125], v[124:125], v[16:17]
v_pk_add_f32 v[126:127], v[126:127], v[16:17]
v_pk_mul_f32 v[16:17], v[64:65], v[64:65]
v_pk_mul_f32 v[18:19], v[66:67], v[66:67]
v_pk_mul_f32 v[20:21], v[68:69], v[68:69]
v_pk_mul_f32 v[22:23], v[70:71], v[70:71]
v_pk_fma_f32 v[16:17], v[72:73], v[72:73], v[16:17]
v_pk_fma_f32 v[18:19], v[74:75], v[74:75], v[18:19]
v_pk_fma_f32 v[20:21], v[76:77], v[76:77], v[20:21]
v_pk_fma_f32 v[22:23], v[78:79], v[78:79], v[22:23]
v_pk_fma_f32 v[16:17], v[80:81], v[80:81], v[16:17]
v_pk_fma_f32 v[18:19], v[82:83], v[82:83], v[18:19]
v_pk_fma_f32 v[20:21], v[84:85], v[84:85], v[20:21]
v_pk_fma_f32 v[22:23], v[86:87], v[86:87], v[22:23]
v_pk_fma_f32 v[16:17], v[88:89], v[88:89], v[16:17]
v_pk_fma_f32 v[18:19], v[90:91], v[90:91], v[18:19]
v_pk_fma_f32 v[20:21], v[92:93], v[92:93], v[20:21]
v_pk_fma_f32 v[22:23], v[94:95], v[94:95], v[22:23]
v_pk_fma_f32 v[16:17], v[96:97], v[96:97], v[16:17]
v_pk_fma_f32 v[18:19], v[98:99], v[98:99], v[18:19]
v_pk_fma_f32 v[20:21], v[100:101], v[100:101], v[20:21]
v_pk_fma_f32 v[22:23], v[102:103], v[102:103], v[22:23]
v_pk_fma_f32 v[16:17], v[104:105], v[104:105], v[16:17]
v_pk_fma_f32 v[18:19], v[106:107], v[106:107], v[18:19]
v_pk_fma_f32 v[20:21], v[108:109], v[108:109], v[20:21]
v_pk_fma_f32 v[22:23], v[110:111], v[110:111], v[22:23]
v_pk_fma_f32 v[16:17], v[112:113], v[112:113], v[16:17]
v_pk_fma_f32 v[18:19], v[114:115], v[114:115], v[18:19]
v_pk_fma_f32 v[20:21], v[116:117], v[116:117], v[20:21]
v_pk_fma_f32 v[22:23], v[118:119], v[118:119], v[22:23]
v_pk_fma_f32 v[16:17], v[120:121], v[120:121], v[16:17]
v_pk_fma_f32 v[18:19], v[122:123], v[122:123], v[18:19]
v_pk_fma_f32 v[20:21], v[124:125], v[124:125], v[20:21]
v_pk_fma_f32 v[22:23], v[126:127], v[126:127], v[22:23]
v_pk_add_f32 v[16:17], v[16:17], v[18:19]
v_pk_add_f32 v[20:21], v[20:21], v[22:23]
v_pk_add_f32 v[16:17], v[16:17], v[20:21]
v_add_f32 v16, v16, v17
ds_write_b32 v253, v16 offset:1024
s_waitcnt lgkmcnt(0)
s_waitcnt vmcnt(0)
s_barrier
s_cmp_lg_u32 s14, 0
s_cbranch_scc1 main_kernel_s_nf
v_cmp_gt_u32 vcc, 4, v2
s_cbranch_vccz main_kernel_s_wa1_ok
v_mov_b32 v2, 0
main_kernel_s_wa1:
buffer_load_dword v3, v2, s[60:63], 0 offen offset:12 sc1
s_waitcnt vmcnt(0)
v_cmp_gt_u32 vcc, 4, v3
s_cbranch_vccz main_kernel_s_wa1_ok
s_sleep 4
s_sub_u32 s29, s29, 1
s_cbranch_scc0 main_kernel_s_wa1
s_branch main_kernel_end
main_kernel_s_wa1_ok:
s_mov_b64 exec, 1
buffer_store_dword v8, v4, s[4:7], s16 offen sc1
s_mov_b64 exec, -1
main_kernel_s_nf:
ds_read_b128 v[16:19], v254 offset:1024
ds_read_b128 v[20:23], v254 offset:1040
ds_read_b128 v[24:27], v254 offset:1056
ds_read_b128 v[28:31], v254 offset:1072
s_waitcnt lgkmcnt(2)
v_pk_add_f32 v[16:17], v[16:17], v[18:19]
v_pk_add_f32 v[20:21], v[20:21], v[22:23]
s_waitcnt lgkmcnt(0)
v_pk_add_f32 v[24:25], v[24:25], v[26:27]
v_pk_add_f32 v[28:29], v[28:29], v[30:31]
v_pk_add_f32 v[16:17], v[16:17], v[20:21]
v_pk_add_f32 v[24:25], v[24:25], v[28:29]
v_pk_add_f32 v[16:17], v[16:17], v[24:25]
v_add_f32 v16, v16, v17
v_mov_b32 v17, 0x3727c5ac
v_fmac_f32 v17, 0x3a800000, v16
v_rsq_f32 v16, v17
s_nop 0
v_mov_b32 v17, v16
v_pk_mul_f32 v[64:65], v[64:65], v[16:17]
v_pk_mul_f32 v[66:67], v[66:67], v[16:17]
v_pk_mul_f32 v[68:69], v[68:69], v[16:17]
v_pk_mul_f32 v[70:71], v[70:71], v[16:17]
v_pk_mul_f32 v[72:73], v[72:73], v[16:17]
v_pk_mul_f32 v[74:75], v[74:75], v[16:17]
v_pk_mul_f32 v[76:77], v[76:77], v[16:17]
v_pk_mul_f32 v[78:79], v[78:79], v[16:17]
v_pk_mul_f32 v[80:81], v[80:81], v[16:17]
v_pk_mul_f32 v[82:83], v[82:83], v[16:17]
v_pk_mul_f32 v[84:85], v[84:85], v[16:17]
v_pk_mul_f32 v[86:87], v[86:87], v[16:17]
v_pk_mul_f32 v[88:89], v[88:89], v[16:17]
v_pk_mul_f32 v[90:91], v[90:91], v[16:17]
v_pk_mul_f32 v[92:93], v[92:93], v[16:17]
v_pk_mul_f32 v[94:95], v[94:95], v[16:17]
v_pk_mul_f32 v[96:97], v[96:97], v[16:17]
v_pk_mul_f32 v[98:99], v[98:99], v[16:17]
v_pk_mul_f32 v[100:101], v[100:101], v[16:17]
v_pk_mul_f32 v[102:103], v[102:103], v[16:17]
v_pk_mul_f32 v[104:105], v[104:105], v[16:17]
v_pk_mul_f32 v[106:107], v[106:107], v[16:17]
v_pk_mul_f32 v[108:109], v[108:109], v[16:17]
v_pk_mul_f32 v[110:111], v[110:111], v[16:17]
v_pk_mul_f32 v[112:113], v[112:113], v[16:17]
v_pk_mul_f32 v[114:115], v[114:115], v[16:17]
v_pk_mul_f32 v[116:117], v[116:117], v[16:17]
v_pk_mul_f32 v[118:119], v[118:119], v[16:17]
v_pk_mul_f32 v[120:121], v[120:121], v[16:17]
v_pk_mul_f32 v[122:123], v[122:123], v[16:17]
v_pk_mul_f32 v[124:125], v[124:125], v[16:17]
v_pk_mul_f32 v[126:127], v[126:127], v[16:17]
v_cvt_pk_bf16_f32 v32, v64, v65
v_cvt_pk_bf16_f32 v33, v66, v67
v_cvt_pk_bf16_f32 v34, v68, v69
v_cvt_pk_bf16_f32 v35, v70, v71
v_cvt_pk_bf16_f32 v36, v72, v73
v_cvt_pk_bf16_f32 v37, v74, v75
v_cvt_pk_bf16_f32 v38, v76, v77
v_cvt_pk_bf16_f32 v39, v78, v79
v_cvt_pk_bf16_f32 v40, v80, v81
v_cvt_pk_bf16_f32 v41, v82, v83
v_cvt_pk_bf16_f32 v42, v84, v85
v_cvt_pk_bf16_f32 v43, v86, v87
v_cvt_pk_bf16_f32 v44, v88, v89
v_cvt_pk_bf16_f32 v45, v90, v91
v_cvt_pk_bf16_f32 v46, v92, v93
v_cvt_pk_bf16_f32 v47, v94, v95
v_cvt_pk_bf16_f32 v48, v96, v97
v_cvt_pk_bf16_f32 v49, v98, v99
v_cvt_pk_bf16_f32 v50, v100, v101
v_cvt_pk_bf16_f32 v51, v102, v103
v_cvt_pk_bf16_f32 v52, v104, v105
v_cvt_pk_bf16_f32 v53, v106, v107
v_cvt_pk_bf16_f32 v54, v108, v109
v_cvt_pk_bf16_f32 v55, v110, v111
v_cvt_pk_bf16_f32 v56, v112, v113
v_cvt_pk_bf16_f32 v57, v114, v115
v_cvt_pk_bf16_f32 v58, v116, v117
v_cvt_pk_bf16_f32 v59, v118, v119
v_cvt_pk_bf16_f32 v60, v120, v121
v_cvt_pk_bf16_f32 v61, v122, v123
v_cvt_pk_bf16_f32 v62, v124, v125
v_cvt_pk_bf16_f32 v63, v126, v127
s_add_u32 s32, s34, 0x400000
s_add_u32 s33, s32, 4096
buffer_store_dwordx4 v[32:35], v251, s[4:7], s32 offen offset:0 sc1
buffer_store_dwordx4 v[36:39], v251, s[4:7], s32 offen offset:1024 sc1
buffer_store_dwordx4 v[40:43], v251, s[4:7], s32 offen offset:2048 sc1
buffer_store_dwordx4 v[44:47], v251, s[4:7], s32 offen offset:3072 sc1
buffer_store_dwordx4 v[48:51], v251, s[4:7], s33 offen offset:0 sc1
buffer_store_dwordx4 v[52:55], v251, s[4:7], s33 offen offset:1024 sc1
buffer_store_dwordx4 v[56:59], v251, s[4:7], s33 offen offset:2048 sc1
buffer_store_dwordx4 v[60:63], v251, s[4:7], s33 offen offset:3072 sc1
s_add_u32 s16, s16, 4
s_branch main_kernel_s_wa2_ok
main_kernel_s_fill:
v_cmp_gt_u32 vcc, 128, v0
v_mov_b32 v20, 0x1f80
v_mov_b32 v21, 0x380
v_cndmask_b32 v20, v20, v21, vcc
v_mov_b32 v21, 0x1fff
v_mov_b32 v22, 0x1ff
v_cndmask_b32 v21, v21, v22, vcc
v_subrev_u32 v22, 128, v0
v_lshlrev_b32 v22, 13, v22
v_lshlrev_b32 v23, 10, v0
v_cndmask_b32 v22, v22, v23, vcc
v_cmp_gt_u32 vcc, 144, v0
v_mov_b32 v23, 0x40000000
s_nop 0
v_cndmask_b32 v22, v23, v22, vcc
s_mov_b32 s8, s42
s_and_b32 s9, s43, 0xffff
s_mov_b32 s10, 0x800000
s_mov_b32 s11, 0x20000
s_lshl_b32 s35, s16, 17
v_subrev_u32 v23, s42, v21
v_and_b32 v23, v23, v20
v_add_u32 v26, v23, v22
buffer_load_dwordx2 v[14:15], v26, s[8:11], s35 offen offset:60
s_add_u32 s35, s35, 8388608
s_mov_b32 s8, s44
s_and_b32 s9, s45, 0xffff
s_mov_b32 s10, 0x800000
s_mov_b32 s11, 0x20000
s_lshl_b32 s35, s16, 17
v_subrev_u32 v23, s44, v21
v_and_b32 v23, v23, v20
v_add_u32 v28, v23, v22
buffer_load_dwordx2 v[14:15], v28, s[8:11], s35 offen offset:60
s_add_u32 s35, s35, 8388608
s_lshl_b32 s32, s16, 2
s_sub_u32 s33, s32, 48
s_lshl_b32 s34, s32, 12
s_add_u32 s34, s34, 0x6c00000
s_cmp_lt_u32 s33, 16
s_cselect_b32 s34, 0x7f000000, s34
buffer_store_dwordx4 v[8:11], v1, s[4:7], s34 offen sc1
s_sub_u32 s33, s32, 47
s_lshl_b32 s34, s32, 12
s_add_u32 s34, s34, 0x6c01000
s_cmp_lt_u32 s33, 16
s_cselect_b32 s34, 0x7f000000, s34
buffer_store_dwordx4 v[8:11], v1, s[4:7], s34 offen sc1
s_sub_u32 s33, s32, 46
s_lshl_b32 s34, s32, 12
s_add_u32 s34, s34, 0x6c02000
s_cmp_lt_u32 s33, 16
s_cselect_b32 s34, 0x7f000000, s34
buffer_store_dwordx4 v[8:11], v1, s[4:7], s34 offen sc1
s_sub_u32 s33, s32, 45
s_lshl_b32 s34, s32, 12
s_add_u32 s34, s34, 0x6c03000
s_cmp_lt_u32 s33, 16
s_cselect_b32 s34, 0x7f000000, s34
buffer_store_dwordx4 v[8:11], v1, s[4:7], s34 offen sc1
s_lshl_b32 s32, s16, 12
s_add_u32 s33, s32, 0x8c00000
s_add_u32 s34, s32, 0x6e00000
buffer_store_dwordx4 v[8:11], v1, s[4:7], s34 offen sc1
s_add_u32 s32, s32, 0x8000000
buffer_store_dwordx4 v[8:11], v1, s[4:7], s32 offen sc1
buffer_store_dwordx4 v[8:11], v1, s[4:7], s33 offen sc1
s_lshl_b32 s16, s16, 2
s_add_u32 s16, s16, 0x841f000
s_cmp_lg_u32 s16, 0x841f034
s_cbranch_scc1 main_kernel_s_fd
s_mov_b32 s8, s76
s_and_b32 s9, s77, 0xffff
s_mov_b32 s10, 0x4000
s_mov_b32 s11, 0x20000
v_and_b32 v2, 7, v0
v_lshlrev_b32 v2, 11, v2
v_lshrrev_b32 v3, 6, v0
v_lshl_add_u32 v2, v3, 7, v2
v_bfe_u32 v3, v0, 4, 2
v_lshl_add_u32 v2, v3, 5, v2
v_bfe_u32 v3, v0, 3, 1
v_lshl_add_u32 v2, v3, 4, v2
buffer_load_dwordx4 v[16:19], v2, s[8:11], 0 offen offset:0
buffer_load_dwordx4 v[20:23], v2, s[8:11], 0 offen offset:512
buffer_load_dwordx4 v[24:27], v2, s[8:11], 0 offen offset:1024
buffer_load_dwordx4 v[28:31], v2, s[8:11], 0 offen offset:1536
s_mov_b32 s32, 0x6c30000
s_waitcnt vmcnt(0)
s_cmp_lt_u32 s14, 0
s_cbranch_scc1 main_kernel_s_m0b
v_lshlrev_b32 v2, 16, v16
v_and_b32 v3, 0xffff0000, v16
v_cvt_pk_f16_f32 v16, v2, v3
v_lshlrev_b32 v2, 16, v17
v_and_b32 v3, 0xffff0000, v17
v_cvt_pk_f16_f32 v17, v2, v3
v_lshlrev_b32 v2, 16, v18
v_and_b32 v3, 0xffff0000, v18
v_cvt_pk_f16_f32 v18, v2, v3
v_lshlrev_b32 v2, 16, v19
v_and_b32 v3, 0xffff0000, v19
v_cvt_pk_f16_f32 v19, v2, v3
v_lshlrev_b32 v2, 16, v20
v_and_b32 v3, 0xffff0000, v20
v_cvt_pk_f16_f32 v20, v2, v3
v_lshlrev_b32 v2, 16, v21
v_and_b32 v3, 0xffff0000, v21
v_cvt_pk_f16_f32 v21, v2, v3
v_lshlrev_b32 v2, 16, v22
v_and_b32 v3, 0xffff0000, v22
v_cvt_pk_f16_f32 v22, v2, v3
v_lshlrev_b32 v2, 16, v23
v_and_b32 v3, 0xffff0000, v23
v_cvt_pk_f16_f32 v23, v2, v3
v_lshlrev_b32 v2, 16, v24
v_and_b32 v3, 0xffff0000, v24
v_cvt_pk_f16_f32 v24, v2, v3
v_lshlrev_b32 v2, 16, v25
v_and_b32 v3, 0xffff0000, v25
v_cvt_pk_f16_f32 v25, v2, v3
v_lshlrev_b32 v2, 16, v26
v_and_b32 v3, 0xffff0000, v26
v_cvt_pk_f16_f32 v26, v2, v3
v_lshlrev_b32 v2, 16, v27
v_and_b32 v3, 0xffff0000, v27
v_cvt_pk_f16_f32 v27, v2, v3
v_lshlrev_b32 v2, 16, v28
v_and_b32 v3, 0xffff0000, v28
v_cvt_pk_f16_f32 v28, v2, v3
v_lshlrev_b32 v2, 16, v29
v_and_b32 v3, 0xffff0000, v29
v_cvt_pk_f16_f32 v29, v2, v3
v_lshlrev_b32 v2, 16, v30
v_and_b32 v3, 0xffff0000, v30
v_cvt_pk_f16_f32 v30, v2, v3
v_lshlrev_b32 v2, 16, v31
v_and_b32 v3, 0xffff0000, v31
v_cvt_pk_f16_f32 v31, v2, v3
main_kernel_s_m0b:
v_xor_b32 v2, 0, v1
buffer_store_dwordx4 v[16:19], v1, s[4:7], s32 offen sc1
s_add_u32 s32, s32, 4096
buffer_store_dwordx4 v[20:23], v2, s[4:7], s32 offen sc1
s_add_u32 s32, s32, 4096
buffer_store_dwordx4 v[24:27], v1, s[4:7], s32 offen sc1
s_add_u32 s32, s32, 4096
buffer_store_dwordx4 v[28:31], v2, s[4:7], s32 offen sc1
s_add_u32 s32, s32, 4096
buffer_store_dwordx4 v[4:7], v1, s[4:7], s32 offen sc1
s_add_u32 s32, s32, 4096
buffer_store_dwordx4 v[4:7], v2, s[4:7], s32 offen sc1
s_add_u32 s32, s32, 4096
buffer_store_dwordx4 v[4:7], v1, s[4:7], s32 offen sc1
s_add_u32 s32, s32, 4096
buffer_store_dwordx4 v[4:7], v2, s[4:7], s32 offen sc1
s_add_u32 s32, s32, 4096
buffer_store_dwordx4 v[16:19], v1, s[4:7], s32 offen sc1
s_add_u32 s32, s32, 4096
buffer_store_dwordx4 v[20:23], v2, s[4:7], s32 offen sc1
s_add_u32 s32, s32, 4096
buffer_store_dwordx4 v[24:27], v1, s[4:7], s32 offen sc1
s_add_u32 s32, s32, 4096
buffer_store_dwordx4 v[28:31], v2, s[4:7], s32 offen sc1
s_add_u32 s32, s32, 4096
buffer_store_dwordx4 v[4:7], v1, s[4:7], s32 offen sc1
s_add_u32 s32, s32, 4096
buffer_store_dwordx4 v[4:7], v2, s[4:7], s32 offen sc1
s_add_u32 s32, s32, 4096
buffer_store_dwordx4 v[4:7], v1, s[4:7], s32 offen sc1
s_add_u32 s32, s32, 4096
buffer_store_dwordx4 v[4:7], v2, s[4:7], s32 offen sc1
s_add_u32 s32, s32, 4096
v_mov_b32 v2, 0
main_kernel_s_wa3:
buffer_load_dword v3, v2, s[60:63], 0 offen offset:12 sc1
s_waitcnt vmcnt(0)
v_cmp_gt_u32 vcc, 4, v3
s_cbranch_vccz main_kernel_s_wa3_ok
s_sleep 4
s_sub_u32 s29, s29, 1
s_cbranch_scc0 main_kernel_s_wa3
s_branch main_kernel_end
main_kernel_s_wa3_ok:
v_lshlrev_b32 v2, 7, v250
s_mov_b32 s32, 0x841a000
s_mov_b64 exec, 15
buffer_store_dwordx4 v[8:11], v2, s[4:7], s32 offen sc1
s_mov_b64 exec, -1
main_kernel_s_fd:
s_cmp_lg_u32 s14, 0
s_cbranch_scc1 main_kernel_s_wa2_ok
v_mov_b32 v2, 0
main_kernel_s_wa2:
buffer_load_dword v3, v2, s[60:63], 0 offen offset:12 sc1
s_waitcnt vmcnt(0)
v_cmp_gt_u32 vcc, 4, v3
s_cbranch_vccz main_kernel_s_wa2_ok
s_sleep 4
s_sub_u32 s29, s29, 1
s_cbranch_scc0 main_kernel_s_wa2
s_branch main_kernel_end
main_kernel_s_wa2_ok:
s_waitcnt vmcnt(0)
s_barrier
s_cmp_lg_u32 s14, 0
s_cbranch_scc1 main_kernel_s_end
s_mov_b64 exec, 1
buffer_store_dword v8, v4, s[4:7], s16 offen sc1
s_mov_b64 exec, -1
main_kernel_s_end:
s_lshl_b32 s32, s12, 5
s_add_u32 s32, s32, s13
s_sub_u32 s32, s32, 96
s_cmp_lt_u32 s32, 16
s_cbranch_scc1 main_kernel_att
s_branch main_kernel_worker
main_kernel_end:
s_endpgm
main_kernel_chain:
s_lshr_b32 s15, s13, 1
s_lshl_b32 s32, s12, 4
s_add_u32 s15, s15, s32
s_and_b32 s16, s13, 1
s_lshl_b32 s36, s14, 15
s_add_u32 s36, s36, 32768
v_lshrrev_b32 v126, 3, v94
v_and_b32 v127, 7, v94
v_lshlrev_b32 v126, 13, v126
v_lshl_add_u32 v64, v127, 4, v126
v_lshrrev_b32 v126, 2, v94
v_and_b32 v70, 3, v94
v_lshlrev_b32 v126, 11, v126
v_lshl_add_u32 v65, v70, 4, v126
v_lshrrev_b32 v126, 5, v94
v_lshlrev_b32 v69, 4, v126
v_bfe_u32 v126, v94, 4, 1
v_lshl_add_u32 v69, v126, 2, v69
v_bfe_u32 v126, v94, 2, 1
v_add_u32 v69, v69, v126
v_bfe_u32 v126, v94, 3, 1
v_lshl_add_u32 v69, v126, 3, v69
v_lshl_add_u32 v126, v69, 7, s36
v_lshl_add_u32 v67, v70, 3, v126
v_lshl_add_u32 v126, v69, 6, s36
v_lshl_add_u32 v68, v70, 3, v126
v_lshlrev_b32 v116, 4, v94
v_add_u32 v113, s36, v116
v_lshlrev_b32 v126, 7, v69
v_lshl_add_u32 v41, v70, 3, v126
v_lshl_add_u32 v41, s14, 5, v41
v_and_b32 v127, 1, v70
v_lshl_add_u32 v40, v127, 3, v126
v_lshrrev_b32 v127, 1, v70
v_lshl_add_u32 v40, v127, 5, v40
s_lshr_b32 s32, s14, 1
s_and_b32 s33, s14, 1
v_lshl_add_u32 v40, s32, 6, v40
v_lshl_add_u32 v40, s33, 4, v40
s_xor_b32 s32, s14, 0
s_lshl_b32 s32, s32, 15
s_add_u32 s32, s32, 32768
v_add_u32 v32, s32, v40
v_add_u32 v36, s32, v41
s_xor_b32 s32, s14, 1
s_lshl_b32 s32, s32, 15
s_add_u32 s32, s32, 32768
v_add_u32 v33, s32, v40
v_add_u32 v37, s32, v41
s_xor_b32 s32, s14, 2
s_lshl_b32 s32, s32, 15
s_add_u32 s32, s32, 32768
v_add_u32 v34, s32, v40
v_add_u32 v38, s32, v41
s_xor_b32 s32, s14, 3
s_lshl_b32 s32, s32, 15
s_add_u32 s32, s32, 32768
v_add_u32 v35, s32, v40
v_add_u32 v39, s32, v41
s_lshl_b32 s34, s14, 21
s_lshl_b32 s32, s15, 8
s_add_u32 s34, s34, s32
s_lshl_b32 s32, s16, 7
s_add_u32 s34, s34, s32
s_lshl_b32 s35, s12, 22
s_lshl_b32 s32, s14, 20
s_add_u32 s35, s35, s32
s_lshl_b32 s32, s13, 6
s_add_u32 s35, s35, s32
s_xor_b32 s32, s14, s13
s_and_b32 s32, s32, 3
s_lshl_b32 s32, s32, 19
s_add_u32 s34, s34, s32
s_xor_b32 s32, s14, s13
s_and_b32 s32, s32, 7
s_lshl_b32 s32, s32, 17
s_add_u32 s35, s35, s32
v_min_u32 v73, 8, v94
v_lshlrev_b32 v73, 5, v73
v_mov_b32 v126, 12
v_cmp_gt_u32 vcc, 8, v94
v_lshlrev_b32 v74, 2, v94
v_add_u32 v74, 0x841f000, v74
v_cndmask_b32 v73, v126, v73, vcc
v_and_b32 v75, 1, v94
s_lshl_b32 s32, s15, 2
s_add_u32 s32, s32, 0x8406000
v_lshl_add_u32 v75, v75, 13, s32
s_mov_b32 s8, s42
s_and_b32 s9, s43, 0xffff
s_mov_b32 s10, 0x800000
s_mov_b32 s11, 0x20000
s_xor_b32 s32, s34, 0x0
s_add_u32 m0, s36, 0
s_nop 0
buffer_load_dwordx4 v64, s[8:11], s32 offen lds
s_xor_b32 s32, s34, 0x10000
s_add_u32 m0, s36, 1024
s_nop 0
buffer_load_dwordx4 v64, s[8:11], s32 offen lds
s_xor_b32 s32, s34, 0x20000
s_add_u32 m0, s36, 2048
s_nop 0
buffer_load_dwordx4 v64, s[8:11], s32 offen lds
s_xor_b32 s32, s34, 0x30000
s_add_u32 m0, s36, 3072
s_nop 0
buffer_load_dwordx4 v64, s[8:11], s32 offen lds
s_xor_b32 s32, s34, 0x40000
s_add_u32 m0, s36, 4096
s_nop 0
buffer_load_dwordx4 v64, s[8:11], s32 offen lds
s_xor_b32 s32, s34, 0x50000
s_add_u32 m0, s36, 5120
s_nop 0
buffer_load_dwordx4 v64, s[8:11], s32 offen lds
s_xor_b32 s32, s34, 0x60000
s_add_u32 m0, s36, 6144
s_nop 0
buffer_load_dwordx4 v64, s[8:11], s32 offen lds
s_xor_b32 s32, s34, 0x70000
s_add_u32 m0, s36, 7168
s_nop 0
buffer_load_dwordx4 v64, s[8:11], s32 offen lds
s_xor_b32 s32, s34, 0x80000
s_add_u32 m0, s36, 8192
s_nop 0
buffer_load_dwordx4 v64, s[8:11], s32 offen lds
s_xor_b32 s32, s34, 0x90000
s_add_u32 m0, s36, 9216
s_nop 0
buffer_load_dwordx4 v64, s[8:11], s32 offen lds
s_xor_b32 s32, s34, 0xa0000
s_add_u32 m0, s36, 10240
s_nop 0
buffer_load_dwordx4 v64, s[8:11], s32 offen lds
s_xor_b32 s32, s34, 0xb0000
s_add_u32 m0, s36, 11264
s_nop 0
buffer_load_dwordx4 v64, s[8:11], s32 offen lds
s_xor_b32 s32, s34, 0xc0000
s_add_u32 m0, s36, 12288
s_nop 0
buffer_load_dwordx4 v64, s[8:11], s32 offen lds
s_xor_b32 s32, s34, 0xd0000
s_add_u32 m0, s36, 13312
s_nop 0
buffer_load_dwordx4 v64, s[8:11], s32 offen lds
s_xor_b32 s32, s34, 0xe0000
s_add_u32 m0, s36, 14336
s_nop 0
buffer_load_dwordx4 v64, s[8:11], s32 offen lds
s_xor_b32 s32, s34, 0xf0000
s_add_u32 m0, s36, 15360
s_nop 0
buffer_load_dwordx4 v64, s[8:11], s32 offen lds
s_xor_b32 s32, s34, 0x100000
s_add_u32 m0, s36, 16384
s_nop 0
buffer_load_dwordx4 v64, s[8:11], s32 offen lds
s_xor_b32 s32, s34, 0x110000
s_add_u32 m0, s36, 17408
s_nop 0
buffer_load_dwordx4 v64, s[8:11], s32 offen lds
s_xor_b32 s32, s34, 0x120000
s_add_u32 m0, s36, 18432
s_nop 0
buffer_load_dwordx4 v64, s[8:11], s32 offen lds
s_xor_b32 s32, s34, 0x130000
s_add_u32 m0, s36, 19456
s_nop 0
buffer_load_dwordx4 v64, s[8:11], s32 offen lds
s_xor_b32 s32, s34, 0x140000
s_add_u32 m0, s36, 20480
s_nop 0
buffer_load_dwordx4 v64, s[8:11], s32 offen lds
s_xor_b32 s32, s34, 0x150000
s_add_u32 m0, s36, 21504
s_nop 0
buffer_load_dwordx4 v64, s[8:11], s32 offen lds
s_xor_b32 s32, s34, 0x160000
s_add_u32 m0, s36, 22528
s_nop 0
buffer_load_dwordx4 v64, s[8:11], s32 offen lds
s_xor_b32 s32, s34, 0x170000
s_add_u32 m0, s36, 23552
s_nop 0
buffer_load_dwordx4 v64, s[8:11], s32 offen lds
s_xor_b32 s32, s34, 0x180000
s_add_u32 m0, s36, 24576
s_nop 0
buffer_load_dwordx4 v64, s[8:11], s32 offen lds
s_xor_b32 s32, s34, 0x190000
s_add_u32 m0, s36, 25600
s_nop 0
buffer_load_dwordx4 v64, s[8:11], s32 offen lds
s_xor_b32 s32, s34, 0x1a0000
s_add_u32 m0, s36, 26624
s_nop 0
buffer_load_dwordx4 v64, s[8:11], s32 offen lds
s_xor_b32 s32, s34, 0x1b0000
s_add_u32 m0, s36, 27648
s_nop 0
buffer_load_dwordx4 v64, s[8:11], s32 offen lds
s_xor_b32 s32, s34, 0x1c0000
s_add_u32 m0, s36, 28672
s_nop 0
buffer_load_dwordx4 v64, s[8:11], s32 offen lds
s_xor_b32 s32, s34, 0x1d0000
s_add_u32 m0, s36, 29696
s_nop 0
buffer_load_dwordx4 v64, s[8:11], s32 offen lds
s_xor_b32 s32, s34, 0x1e0000
s_add_u32 m0, s36, 30720
s_nop 0
buffer_load_dwordx4 v64, s[8:11], s32 offen lds
s_xor_b32 s32, s34, 0x1f0000
s_add_u32 m0, s36, 31744
s_nop 0
buffer_load_dwordx4 v64, s[8:11], s32 offen lds
s_waitcnt vmcnt(24)
s_barrier
ds_read_b64_tr_b16 v[0:1], v32 offset:0
ds_read_b64_tr_b16 v[2:3], v32 offset:256
ds_read_b64_tr_b16 v[4:5], v32 offset:4096
ds_read_b64_tr_b16 v[6:7], v32 offset:4352
ds_read_b64_tr_b16 v[8:9], v33 offset:0
ds_read_b64_tr_b16 v[10:11], v33 offset:256
ds_read_b64_tr_b16 v[12:13], v33 offset:4096
ds_read_b64_tr_b16 v[14:15], v33 offset:4352
ds_read_b64_tr_b16 v[16:17], v34 offset:0
ds_read_b64_tr_b16 v[18:19], v34 offset:256
ds_read_b64_tr_b16 v[20:21], v34 offset:4096
ds_read_b64_tr_b16 v[22:23], v34 offset:4352
ds_read_b64_tr_b16 v[24:25], v35 offset:0
ds_read_b64_tr_b16 v[26:27], v35 offset:256
ds_read_b64_tr_b16 v[28:29], v35 offset:4096
ds_read_b64_tr_b16 v[30:31], v35 offset:4352
s_waitcnt lgkmcnt(0)
s_barrier
s_mov_b32 s8, s44
s_and_b32 s9, s45, 0xffff
s_mov_b32 s10, 0x800000
s_mov_b32 s11, 0x20000
s_xor_b32 s32, s34, 0x0
s_add_u32 m0, s36, 0
s_nop 0
buffer_load_dwordx4 v64, s[8:11], s32 offen lds
s_xor_b32 s32, s34, 0x10000
s_add_u32 m0, s36, 1024
s_nop 0
buffer_load_dwordx4 v64, s[8:11], s32 offen lds
s_xor_b32 s32, s34, 0x20000
s_add_u32 m0, s36, 2048
s_nop 0
buffer_load_dwordx4 v64, s[8:11], s32 offen lds
s_xor_b32 s32, s34, 0x30000
s_add_u32 m0, s36, 3072
s_nop 0
buffer_load_dwordx4 v64, s[8:11], s32 offen lds
s_xor_b32 s32, s34, 0x40000
s_add_u32 m0, s36, 4096
s_nop 0
buffer_load_dwordx4 v64, s[8:11], s32 offen lds
s_xor_b32 s32, s34, 0x50000
s_add_u32 m0, s36, 5120
s_nop 0
buffer_load_dwordx4 v64, s[8:11], s32 offen lds
s_xor_b32 s32, s34, 0x60000
s_add_u32 m0, s36, 6144
s_nop 0
buffer_load_dwordx4 v64, s[8:11], s32 offen lds
s_xor_b32 s32, s34, 0x70000
s_add_u32 m0, s36, 7168
s_nop 0
buffer_load_dwordx4 v64, s[8:11], s32 offen lds
v_lshlrev_b32 v42, 16, v0
v_and_b32 v43, 0xffff0000, v0
v_cvt_pk_f16_f32 v0, v42, v43
v_lshlrev_b32 v44, 16, v1
v_and_b32 v45, 0xffff0000, v1
v_cvt_pk_f16_f32 v1, v44, v45
v_lshlrev_b32 v42, 16, v2
v_and_b32 v43, 0xffff0000, v2
v_cvt_pk_f16_f32 v2, v42, v43
v_lshlrev_b32 v44, 16, v3
v_and_b32 v45, 0xffff0000, v3
v_cvt_pk_f16_f32 v3, v44, v45
v_lshlrev_b32 v42, 16, v4
v_and_b32 v43, 0xffff0000, v4
v_cvt_pk_f16_f32 v4, v42, v43
v_lshlrev_b32 v44, 16, v5
v_and_b32 v45, 0xffff0000, v5
v_cvt_pk_f16_f32 v5, v44, v45
v_lshlrev_b32 v42, 16, v6
v_and_b32 v43, 0xffff0000, v6
v_cvt_pk_f16_f32 v6, v42, v43
v_lshlrev_b32 v44, 16, v7
v_and_b32 v45, 0xffff0000, v7
v_cvt_pk_f16_f32 v7, v44, v45
v_accvgpr_write_b32 a128, v0
v_accvgpr_write_b32 a129, v1
v_accvgpr_write_b32 a130, v2
v_accvgpr_write_b32 a131, v3
v_accvgpr_write_b32 a132, v4
v_accvgpr_write_b32 a133, v5
v_accvgpr_write_b32 a134, v6
v_accvgpr_write_b32 a135, v7
v_lshlrev_b32 v42, 16, v8
v_and_b32 v43, 0xffff0000, v8
v_cvt_pk_f16_f32 v8, v42, v43
v_lshlrev_b32 v44, 16, v9
v_and_b32 v45, 0xffff0000, v9
v_cvt_pk_f16_f32 v9, v44, v45
v_lshlrev_b32 v42, 16, v10
v_and_b32 v43, 0xffff0000, v10
v_cvt_pk_f16_f32 v10, v42, v43
v_lshlrev_b32 v44, 16, v11
v_and_b32 v45, 0xffff0000, v11
v_cvt_pk_f16_f32 v11, v44, v45
v_lshlrev_b32 v42, 16, v12
v_and_b32 v43, 0xffff0000, v12
v_cvt_pk_f16_f32 v12, v42, v43
v_lshlrev_b32 v44, 16, v13
v_and_b32 v45, 0xffff0000, v13
v_cvt_pk_f16_f32 v13, v44, v45
v_lshlrev_b32 v42, 16, v14
v_and_b32 v43, 0xffff0000, v14
v_cvt_pk_f16_f32 v14, v42, v43
v_lshlrev_b32 v44, 16, v15
v_and_b32 v45, 0xffff0000, v15
v_cvt_pk_f16_f32 v15, v44, v45
v_accvgpr_write_b32 a160, v8
v_accvgpr_write_b32 a161, v9
v_accvgpr_write_b32 a162, v10
v_accvgpr_write_b32 a163, v11
v_accvgpr_write_b32 a164, v12
v_accvgpr_write_b32 a165, v13
v_accvgpr_write_b32 a166, v14
v_accvgpr_write_b32 a167, v15
v_lshlrev_b32 v42, 16, v16
v_and_b32 v43, 0xffff0000, v16
v_cvt_pk_f16_f32 v16, v42, v43
v_lshlrev_b32 v44, 16, v17
v_and_b32 v45, 0xffff0000, v17
v_cvt_pk_f16_f32 v17, v44, v45
v_lshlrev_b32 v42, 16, v18
v_and_b32 v43, 0xffff0000, v18
v_cvt_pk_f16_f32 v18, v42, v43
v_lshlrev_b32 v44, 16, v19
v_and_b32 v45, 0xffff0000, v19
v_cvt_pk_f16_f32 v19, v44, v45
v_lshlrev_b32 v42, 16, v20
v_and_b32 v43, 0xffff0000, v20
v_cvt_pk_f16_f32 v20, v42, v43
v_lshlrev_b32 v44, 16, v21
v_and_b32 v45, 0xffff0000, v21
v_cvt_pk_f16_f32 v21, v44, v45
v_lshlrev_b32 v42, 16, v22
v_and_b32 v43, 0xffff0000, v22
v_cvt_pk_f16_f32 v22, v42, v43
v_lshlrev_b32 v44, 16, v23
v_and_b32 v45, 0xffff0000, v23
v_cvt_pk_f16_f32 v23, v44, v45
v_accvgpr_write_b32 a192, v16
v_accvgpr_write_b32 a193, v17
v_accvgpr_write_b32 a194, v18
v_accvgpr_write_b32 a195, v19
v_accvgpr_write_b32 a196, v20
v_accvgpr_write_b32 a197, v21
v_accvgpr_write_b32 a198, v22
v_accvgpr_write_b32 a199, v23
v_lshlrev_b32 v42, 16, v24
v_and_b32 v43, 0xffff0000, v24
v_cvt_pk_f16_f32 v24, v42, v43
v_lshlrev_b32 v44, 16, v25
v_and_b32 v45, 0xffff0000, v25
v_cvt_pk_f16_f32 v25, v44, v45
v_lshlrev_b32 v42, 16, v26
v_and_b32 v43, 0xffff0000, v26
v_cvt_pk_f16_f32 v26, v42, v43
v_lshlrev_b32 v44, 16, v27
v_and_b32 v45, 0xffff0000, v27
v_cvt_pk_f16_f32 v27, v44, v45
v_lshlrev_b32 v42, 16, v28
v_and_b32 v43, 0xffff0000, v28
v_cvt_pk_f16_f32 v28, v42, v43
v_lshlrev_b32 v44, 16, v29
v_and_b32 v45, 0xffff0000, v29
v_cvt_pk_f16_f32 v29, v44, v45
v_lshlrev_b32 v42, 16, v30
v_and_b32 v43, 0xffff0000, v30
v_cvt_pk_f16_f32 v30, v42, v43
v_lshlrev_b32 v44, 16, v31
v_and_b32 v45, 0xffff0000, v31
v_cvt_pk_f16_f32 v31, v44, v45
v_accvgpr_write_b32 a224, v24
v_accvgpr_write_b32 a225, v25
v_accvgpr_write_b32 a226, v26
v_accvgpr_write_b32 a227, v27
v_accvgpr_write_b32 a228, v28
v_accvgpr_write_b32 a229, v29
v_accvgpr_write_b32 a230, v30
v_accvgpr_write_b32 a231, v31
s_waitcnt vmcnt(24)
s_barrier
ds_read_b64_tr_b16 v[0:1], v32 offset:8192
ds_read_b64_tr_b16 v[2:3], v32 offset:8448
ds_read_b64_tr_b16 v[4:5], v32 offset:12288
ds_read_b64_tr_b16 v[6:7], v32 offset:12544
ds_read_b64_tr_b16 v[8:9], v33 offset:8192
ds_read_b64_tr_b16 v[10:11], v33 offset:8448
ds_read_b64_tr_b16 v[12:13], v33 offset:12288
ds_read_b64_tr_b16 v[14:15], v33 offset:12544
ds_read_b64_tr_b16 v[16:17], v34 offset:8192
ds_read_b64_tr_b16 v[18:19], v34 offset:8448
ds_read_b64_tr_b16 v[20:21], v34 offset:12288
ds_read_b64_tr_b16 v[22:23], v34 offset:12544
ds_read_b64_tr_b16 v[24:25], v35 offset:8192
ds_read_b64_tr_b16 v[26:27], v35 offset:8448
ds_read_b64_tr_b16 v[28:29], v35 offset:12288
ds_read_b64_tr_b16 v[30:31], v35 offset:12544
s_waitcnt lgkmcnt(0)
s_barrier
s_xor_b32 s32, s34, 0x80000
s_add_u32 m0, s36, 8192
s_nop 0
buffer_load_dwordx4 v64, s[8:11], s32 offen lds
s_xor_b32 s32, s34, 0x90000
s_add_u32 m0, s36, 9216
s_nop 0
buffer_load_dwordx4 v64, s[8:11], s32 offen lds
s_xor_b32 s32, s34, 0xa0000
s_add_u32 m0, s36, 10240
s_nop 0
buffer_load_dwordx4 v64, s[8:11], s32 offen lds
s_xor_b32 s32, s34, 0xb0000
s_add_u32 m0, s36, 11264
s_nop 0
buffer_load_dwordx4 v64, s[8:11], s32 offen lds
s_xor_b32 s32, s34, 0xc0000
s_add_u32 m0, s36, 12288
s_nop 0
buffer_load_dwordx4 v64, s[8:11], s32 offen lds
s_xor_b32 s32, s34, 0xd0000
s_add_u32 m0, s36, 13312
s_nop 0
buffer_load_dwordx4 v64, s[8:11], s32 offen lds
s_xor_b32 s32, s34, 0xe0000
s_add_u32 m0, s36, 14336
s_nop 0
buffer_load_dwordx4 v64, s[8:11], s32 offen lds
s_xor_b32 s32, s34, 0xf0000
s_add_u32 m0, s36, 15360
s_nop 0
buffer_load_dwordx4 v64, s[8:11], s32 offen lds
v_lshlrev_b32 v42, 16, v0
v_and_b32 v43, 0xffff0000, v0
v_cvt_pk_f16_f32 v0, v42, v43
v_lshlrev_b32 v44, 16, v1
v_and_b32 v45, 0xffff0000, v1
v_cvt_pk_f16_f32 v1, v44, v45
v_lshlrev_b32 v42, 16, v2
v_and_b32 v43, 0xffff0000, v2
v_cvt_pk_f16_f32 v2, v42, v43
v_lshlrev_b32 v44, 16, v3
v_and_b32 v45, 0xffff0000, v3
v_cvt_pk_f16_f32 v3, v44, v45
v_lshlrev_b32 v42, 16, v4
v_and_b32 v43, 0xffff0000, v4
v_cvt_pk_f16_f32 v4, v42, v43
v_lshlrev_b32 v44, 16, v5
v_and_b32 v45, 0xffff0000, v5
v_cvt_pk_f16_f32 v5, v44, v45
v_lshlrev_b32 v42, 16, v6
v_and_b32 v43, 0xffff0000, v6
v_cvt_pk_f16_f32 v6, v42, v43
v_lshlrev_b32 v44, 16, v7
v_and_b32 v45, 0xffff0000, v7
v_cvt_pk_f16_f32 v7, v44, v45
v_accvgpr_write_b32 a136, v0
v_accvgpr_write_b32 a137, v1
v_accvgpr_write_b32 a138, v2
v_accvgpr_write_b32 a139, v3
v_accvgpr_write_b32 a140, v4
v_accvgpr_write_b32 a141, v5
v_accvgpr_write_b32 a142, v6
v_accvgpr_write_b32 a143, v7
v_lshlrev_b32 v42, 16, v8
v_and_b32 v43, 0xffff0000, v8
v_cvt_pk_f16_f32 v8, v42, v43
v_lshlrev_b32 v44, 16, v9
v_and_b32 v45, 0xffff0000, v9
v_cvt_pk_f16_f32 v9, v44, v45
v_lshlrev_b32 v42, 16, v10
v_and_b32 v43, 0xffff0000, v10
v_cvt_pk_f16_f32 v10, v42, v43
v_lshlrev_b32 v44, 16, v11
v_and_b32 v45, 0xffff0000, v11
v_cvt_pk_f16_f32 v11, v44, v45
v_lshlrev_b32 v42, 16, v12
v_and_b32 v43, 0xffff0000, v12
v_cvt_pk_f16_f32 v12, v42, v43
v_lshlrev_b32 v44, 16, v13
v_and_b32 v45, 0xffff0000, v13
v_cvt_pk_f16_f32 v13, v44, v45
v_lshlrev_b32 v42, 16, v14
v_and_b32 v43, 0xffff0000, v14
v_cvt_pk_f16_f32 v14, v42, v43
v_lshlrev_b32 v44, 16, v15
v_and_b32 v45, 0xffff0000, v15
v_cvt_pk_f16_f32 v15, v44, v45
v_accvgpr_write_b32 a168, v8
v_accvgpr_write_b32 a169, v9
v_accvgpr_write_b32 a170, v10
v_accvgpr_write_b32 a171, v11
v_accvgpr_write_b32 a172, v12
v_accvgpr_write_b32 a173, v13
v_accvgpr_write_b32 a174, v14
v_accvgpr_write_b32 a175, v15
v_lshlrev_b32 v42, 16, v16
v_and_b32 v43, 0xffff0000, v16
v_cvt_pk_f16_f32 v16, v42, v43
v_lshlrev_b32 v44, 16, v17
v_and_b32 v45, 0xffff0000, v17
v_cvt_pk_f16_f32 v17, v44, v45
v_lshlrev_b32 v42, 16, v18
v_and_b32 v43, 0xffff0000, v18
v_cvt_pk_f16_f32 v18, v42, v43
v_lshlrev_b32 v44, 16, v19
v_and_b32 v45, 0xffff0000, v19
v_cvt_pk_f16_f32 v19, v44, v45
v_lshlrev_b32 v42, 16, v20
v_and_b32 v43, 0xffff0000, v20
v_cvt_pk_f16_f32 v20, v42, v43
v_lshlrev_b32 v44, 16, v21
v_and_b32 v45, 0xffff0000, v21
v_cvt_pk_f16_f32 v21, v44, v45
v_lshlrev_b32 v42, 16, v22
v_and_b32 v43, 0xffff0000, v22
v_cvt_pk_f16_f32 v22, v42, v43
v_lshlrev_b32 v44, 16, v23
v_and_b32 v45, 0xffff0000, v23
v_cvt_pk_f16_f32 v23, v44, v45
v_accvgpr_write_b32 a200, v16
v_accvgpr_write_b32 a201, v17
v_accvgpr_write_b32 a202, v18
v_accvgpr_write_b32 a203, v19
v_accvgpr_write_b32 a204, v20
v_accvgpr_write_b32 a205, v21
v_accvgpr_write_b32 a206, v22
v_accvgpr_write_b32 a207, v23
v_lshlrev_b32 v42, 16, v24
v_and_b32 v43, 0xffff0000, v24
v_cvt_pk_f16_f32 v24, v42, v43
v_lshlrev_b32 v44, 16, v25
v_and_b32 v45, 0xffff0000, v25
v_cvt_pk_f16_f32 v25, v44, v45
v_lshlrev_b32 v42, 16, v26
v_and_b32 v43, 0xffff0000, v26
v_cvt_pk_f16_f32 v26, v42, v43
v_lshlrev_b32 v44, 16, v27
v_and_b32 v45, 0xffff0000, v27
v_cvt_pk_f16_f32 v27, v44, v45
v_lshlrev_b32 v42, 16, v28
v_and_b32 v43, 0xffff0000, v28
v_cvt_pk_f16_f32 v28, v42, v43
v_lshlrev_b32 v44, 16, v29
v_and_b32 v45, 0xffff0000, v29
v_cvt_pk_f16_f32 v29, v44, v45
v_lshlrev_b32 v42, 16, v30
v_and_b32 v43, 0xffff0000, v30
v_cvt_pk_f16_f32 v30, v42, v43
v_lshlrev_b32 v44, 16, v31
v_and_b32 v45, 0xffff0000, v31
v_cvt_pk_f16_f32 v31, v44, v45
v_accvgpr_write_b32 a232, v24
v_accvgpr_write_b32 a233, v25
v_accvgpr_write_b32 a234, v26
v_accvgpr_write_b32 a235, v27
v_accvgpr_write_b32 a236, v28
v_accvgpr_write_b32 a237, v29
v_accvgpr_write_b32 a238, v30
v_accvgpr_write_b32 a239, v31
s_waitcnt vmcnt(24)
s_barrier
ds_read_b64_tr_b16 v[0:1], v32 offset:16384
ds_read_b64_tr_b16 v[2:3], v32 offset:16640
ds_read_b64_tr_b16 v[4:5], v32 offset:20480
ds_read_b64_tr_b16 v[6:7], v32 offset:20736
ds_read_b64_tr_b16 v[8:9], v33 offset:16384
ds_read_b64_tr_b16 v[10:11], v33 offset:16640
ds_read_b64_tr_b16 v[12:13], v33 offset:20480
ds_read_b64_tr_b16 v[14:15], v33 offset:20736
ds_read_b64_tr_b16 v[16:17], v34 offset:16384
ds_read_b64_tr_b16 v[18:19], v34 offset:16640
ds_read_b64_tr_b16 v[20:21], v34 offset:20480
ds_read_b64_tr_b16 v[22:23], v34 offset:20736
ds_read_b64_tr_b16 v[24:25], v35 offset:16384
ds_read_b64_tr_b16 v[26:27], v35 offset:16640
ds_read_b64_tr_b16 v[28:29], v35 offset:20480
ds_read_b64_tr_b16 v[30:31], v35 offset:20736
s_waitcnt lgkmcnt(0)
s_barrier
s_xor_b32 s32, s34, 0x100000
s_add_u32 m0, s36, 16384
s_nop 0
buffer_load_dwordx4 v64, s[8:11], s32 offen lds
s_xor_b32 s32, s34, 0x110000
s_add_u32 m0, s36, 17408
s_nop 0
buffer_load_dwordx4 v64, s[8:11], s32 offen lds
s_xor_b32 s32, s34, 0x120000
s_add_u32 m0, s36, 18432
s_nop 0
buffer_load_dwordx4 v64, s[8:11], s32 offen lds
s_xor_b32 s32, s34, 0x130000
s_add_u32 m0, s36, 19456
s_nop 0
buffer_load_dwordx4 v64, s[8:11], s32 offen lds
s_xor_b32 s32, s34, 0x140000
s_add_u32 m0, s36, 20480
s_nop 0
buffer_load_dwordx4 v64, s[8:11], s32 offen lds
s_xor_b32 s32, s34, 0x150000
s_add_u32 m0, s36, 21504
s_nop 0
buffer_load_dwordx4 v64, s[8:11], s32 offen lds
s_xor_b32 s32, s34, 0x160000
s_add_u32 m0, s36, 22528
s_nop 0
buffer_load_dwordx4 v64, s[8:11], s32 offen lds
s_xor_b32 s32, s34, 0x170000
s_add_u32 m0, s36, 23552
s_nop 0
buffer_load_dwordx4 v64, s[8:11], s32 offen lds
v_lshlrev_b32 v42, 16, v0
v_and_b32 v43, 0xffff0000, v0
v_cvt_pk_f16_f32 v0, v42, v43
v_lshlrev_b32 v44, 16, v1
v_and_b32 v45, 0xffff0000, v1
v_cvt_pk_f16_f32 v1, v44, v45
v_lshlrev_b32 v42, 16, v2
v_and_b32 v43, 0xffff0000, v2
v_cvt_pk_f16_f32 v2, v42, v43
v_lshlrev_b32 v44, 16, v3
v_and_b32 v45, 0xffff0000, v3
v_cvt_pk_f16_f32 v3, v44, v45
v_lshlrev_b32 v42, 16, v4
v_and_b32 v43, 0xffff0000, v4
v_cvt_pk_f16_f32 v4, v42, v43
v_lshlrev_b32 v44, 16, v5
v_and_b32 v45, 0xffff0000, v5
v_cvt_pk_f16_f32 v5, v44, v45
v_lshlrev_b32 v42, 16, v6
v_and_b32 v43, 0xffff0000, v6
v_cvt_pk_f16_f32 v6, v42, v43
v_lshlrev_b32 v44, 16, v7
v_and_b32 v45, 0xffff0000, v7
v_cvt_pk_f16_f32 v7, v44, v45
v_accvgpr_write_b32 a144, v0
v_accvgpr_write_b32 a145, v1
v_accvgpr_write_b32 a146, v2
v_accvgpr_write_b32 a147, v3
v_accvgpr_write_b32 a148, v4
v_accvgpr_write_b32 a149, v5
v_accvgpr_write_b32 a150, v6
v_accvgpr_write_b32 a151, v7
v_lshlrev_b32 v42, 16, v8
v_and_b32 v43, 0xffff0000, v8
v_cvt_pk_f16_f32 v8, v42, v43
v_lshlrev_b32 v44, 16, v9
v_and_b32 v45, 0xffff0000, v9
v_cvt_pk_f16_f32 v9, v44, v45
v_lshlrev_b32 v42, 16, v10
v_and_b32 v43, 0xffff0000, v10
v_cvt_pk_f16_f32 v10, v42, v43
v_lshlrev_b32 v44, 16, v11
v_and_b32 v45, 0xffff0000, v11
v_cvt_pk_f16_f32 v11, v44, v45
v_lshlrev_b32 v42, 16, v12
v_and_b32 v43, 0xffff0000, v12
v_cvt_pk_f16_f32 v12, v42, v43
v_lshlrev_b32 v44, 16, v13
v_and_b32 v45, 0xffff0000, v13
v_cvt_pk_f16_f32 v13, v44, v45
v_lshlrev_b32 v42, 16, v14
v_and_b32 v43, 0xffff0000, v14
v_cvt_pk_f16_f32 v14, v42, v43
v_lshlrev_b32 v44, 16, v15
v_and_b32 v45, 0xffff0000, v15
v_cvt_pk_f16_f32 v15, v44, v45
v_accvgpr_write_b32 a176, v8
v_accvgpr_write_b32 a177, v9
v_accvgpr_write_b32 a178, v10
v_accvgpr_write_b32 a179, v11
v_accvgpr_write_b32 a180, v12
v_accvgpr_write_b32 a181, v13
v_accvgpr_write_b32 a182, v14
v_accvgpr_write_b32 a183, v15
v_lshlrev_b32 v42, 16, v16
v_and_b32 v43, 0xffff0000, v16
v_cvt_pk_f16_f32 v16, v42, v43
v_lshlrev_b32 v44, 16, v17
v_and_b32 v45, 0xffff0000, v17
v_cvt_pk_f16_f32 v17, v44, v45
v_lshlrev_b32 v42, 16, v18
v_and_b32 v43, 0xffff0000, v18
v_cvt_pk_f16_f32 v18, v42, v43
v_lshlrev_b32 v44, 16, v19
v_and_b32 v45, 0xffff0000, v19
v_cvt_pk_f16_f32 v19, v44, v45
v_lshlrev_b32 v42, 16, v20
v_and_b32 v43, 0xffff0000, v20
v_cvt_pk_f16_f32 v20, v42, v43
v_lshlrev_b32 v44, 16, v21
v_and_b32 v45, 0xffff0000, v21
v_cvt_pk_f16_f32 v21, v44, v45
v_lshlrev_b32 v42, 16, v22
v_and_b32 v43, 0xffff0000, v22
v_cvt_pk_f16_f32 v22, v42, v43
v_lshlrev_b32 v44, 16, v23
v_and_b32 v45, 0xffff0000, v23
v_cvt_pk_f16_f32 v23, v44, v45
v_accvgpr_write_b32 a208, v16
v_accvgpr_write_b32 a209, v17
v_accvgpr_write_b32 a210, v18
v_accvgpr_write_b32 a211, v19
v_accvgpr_write_b32 a212, v20
v_accvgpr_write_b32 a213, v21
v_accvgpr_write_b32 a214, v22
v_accvgpr_write_b32 a215, v23
v_lshlrev_b32 v42, 16, v24
v_and_b32 v43, 0xffff0000, v24
v_cvt_pk_f16_f32 v24, v42, v43
v_lshlrev_b32 v44, 16, v25
v_and_b32 v45, 0xffff0000, v25
v_cvt_pk_f16_f32 v25, v44, v45
v_lshlrev_b32 v42, 16, v26
v_and_b32 v43, 0xffff0000, v26
v_cvt_pk_f16_f32 v26, v42, v43
v_lshlrev_b32 v44, 16, v27
v_and_b32 v45, 0xffff0000, v27
v_cvt_pk_f16_f32 v27, v44, v45
v_lshlrev_b32 v42, 16, v28
v_and_b32 v43, 0xffff0000, v28
v_cvt_pk_f16_f32 v28, v42, v43
v_lshlrev_b32 v44, 16, v29
v_and_b32 v45, 0xffff0000, v29
v_cvt_pk_f16_f32 v29, v44, v45
v_lshlrev_b32 v42, 16, v30
v_and_b32 v43, 0xffff0000, v30
v_cvt_pk_f16_f32 v30, v42, v43
v_lshlrev_b32 v44, 16, v31
v_and_b32 v45, 0xffff0000, v31
v_cvt_pk_f16_f32 v31, v44, v45
v_accvgpr_write_b32 a240, v24
v_accvgpr_write_b32 a241, v25
v_accvgpr_write_b32 a242, v26
v_accvgpr_write_b32 a243, v27
v_accvgpr_write_b32 a244, v28
v_accvgpr_write_b32 a245, v29
v_accvgpr_write_b32 a246, v30
v_accvgpr_write_b32 a247, v31
s_waitcnt vmcnt(24)
s_barrier
ds_read_b64_tr_b16 v[0:1], v32 offset:24576
ds_read_b64_tr_b16 v[2:3], v32 offset:24832
ds_read_b64_tr_b16 v[4:5], v32 offset:28672
ds_read_b64_tr_b16 v[6:7], v32 offset:28928
ds_read_b64_tr_b16 v[8:9], v33 offset:24576
ds_read_b64_tr_b16 v[10:11], v33 offset:24832
ds_read_b64_tr_b16 v[12:13], v33 offset:28672
ds_read_b64_tr_b16 v[14:15], v33 offset:28928
ds_read_b64_tr_b16 v[16:17], v34 offset:24576
ds_read_b64_tr_b16 v[18:19], v34 offset:24832
ds_read_b64_tr_b16 v[20:21], v34 offset:28672
ds_read_b64_tr_b16 v[22:23], v34 offset:28928
ds_read_b64_tr_b16 v[24:25], v35 offset:24576
ds_read_b64_tr_b16 v[26:27], v35 offset:24832
ds_read_b64_tr_b16 v[28:29], v35 offset:28672
ds_read_b64_tr_b16 v[30:31], v35 offset:28928
s_waitcnt lgkmcnt(0)
s_barrier
s_xor_b32 s32, s34, 0x180000
s_add_u32 m0, s36, 24576
s_nop 0
buffer_load_dwordx4 v64, s[8:11], s32 offen lds
s_xor_b32 s32, s34, 0x190000
s_add_u32 m0, s36, 25600
s_nop 0
buffer_load_dwordx4 v64, s[8:11], s32 offen lds
s_xor_b32 s32, s34, 0x1a0000
s_add_u32 m0, s36, 26624
s_nop 0
buffer_load_dwordx4 v64, s[8:11], s32 offen lds
s_xor_b32 s32, s34, 0x1b0000
s_add_u32 m0, s36, 27648
s_nop 0
buffer_load_dwordx4 v64, s[8:11], s32 offen lds
s_xor_b32 s32, s34, 0x1c0000
s_add_u32 m0, s36, 28672
s_nop 0
buffer_load_dwordx4 v64, s[8:11], s32 offen lds
s_xor_b32 s32, s34, 0x1d0000
s_add_u32 m0, s36, 29696
s_nop 0
buffer_load_dwordx4 v64, s[8:11], s32 offen lds
s_xor_b32 s32, s34, 0x1e0000
s_add_u32 m0, s36, 30720
s_nop 0
buffer_load_dwordx4 v64, s[8:11], s32 offen lds
s_xor_b32 s32, s34, 0x1f0000
s_add_u32 m0, s36, 31744
s_nop 0
buffer_load_dwordx4 v64, s[8:11], s32 offen lds
v_lshlrev_b32 v42, 16, v0
v_and_b32 v43, 0xffff0000, v0
v_cvt_pk_f16_f32 v0, v42, v43
v_lshlrev_b32 v44, 16, v1
v_and_b32 v45, 0xffff0000, v1
v_cvt_pk_f16_f32 v1, v44, v45
v_lshlrev_b32 v42, 16, v2
v_and_b32 v43, 0xffff0000, v2
v_cvt_pk_f16_f32 v2, v42, v43
v_lshlrev_b32 v44, 16, v3
v_and_b32 v45, 0xffff0000, v3
v_cvt_pk_f16_f32 v3, v44, v45
v_lshlrev_b32 v42, 16, v4
v_and_b32 v43, 0xffff0000, v4
v_cvt_pk_f16_f32 v4, v42, v43
v_lshlrev_b32 v44, 16, v5
v_and_b32 v45, 0xffff0000, v5
v_cvt_pk_f16_f32 v5, v44, v45
v_lshlrev_b32 v42, 16, v6
v_and_b32 v43, 0xffff0000, v6
v_cvt_pk_f16_f32 v6, v42, v43
v_lshlrev_b32 v44, 16, v7
v_and_b32 v45, 0xffff0000, v7
v_cvt_pk_f16_f32 v7, v44, v45
v_accvgpr_write_b32 a152, v0
v_accvgpr_write_b32 a153, v1
v_accvgpr_write_b32 a154, v2
v_accvgpr_write_b32 a155, v3
v_accvgpr_write_b32 a156, v4
v_accvgpr_write_b32 a157, v5
v_accvgpr_write_b32 a158, v6
v_accvgpr_write_b32 a159, v7
v_lshlrev_b32 v42, 16, v8
v_and_b32 v43, 0xffff0000, v8
v_cvt_pk_f16_f32 v8, v42, v43
v_lshlrev_b32 v44, 16, v9
v_and_b32 v45, 0xffff0000, v9
v_cvt_pk_f16_f32 v9, v44, v45
v_lshlrev_b32 v42, 16, v10
v_and_b32 v43, 0xffff0000, v10
v_cvt_pk_f16_f32 v10, v42, v43
v_lshlrev_b32 v44, 16, v11
v_and_b32 v45, 0xffff0000, v11
v_cvt_pk_f16_f32 v11, v44, v45
v_lshlrev_b32 v42, 16, v12
v_and_b32 v43, 0xffff0000, v12
v_cvt_pk_f16_f32 v12, v42, v43
v_lshlrev_b32 v44, 16, v13
v_and_b32 v45, 0xffff0000, v13
v_cvt_pk_f16_f32 v13, v44, v45
v_lshlrev_b32 v42, 16, v14
v_and_b32 v43, 0xffff0000, v14
v_cvt_pk_f16_f32 v14, v42, v43
v_lshlrev_b32 v44, 16, v15
v_and_b32 v45, 0xffff0000, v15
v_cvt_pk_f16_f32 v15, v44, v45
v_accvgpr_write_b32 a184, v8
v_accvgpr_write_b32 a185, v9
v_accvgpr_write_b32 a186, v10
v_accvgpr_write_b32 a187, v11
v_accvgpr_write_b32 a188, v12
v_accvgpr_write_b32 a189, v13
v_accvgpr_write_b32 a190, v14
v_accvgpr_write_b32 a191, v15
v_lshlrev_b32 v42, 16, v16
v_and_b32 v43, 0xffff0000, v16
v_cvt_pk_f16_f32 v16, v42, v43
v_lshlrev_b32 v44, 16, v17
v_and_b32 v45, 0xffff0000, v17
v_cvt_pk_f16_f32 v17, v44, v45
v_lshlrev_b32 v42, 16, v18
v_and_b32 v43, 0xffff0000, v18
v_cvt_pk_f16_f32 v18, v42, v43
v_lshlrev_b32 v44, 16, v19
v_and_b32 v45, 0xffff0000, v19
v_cvt_pk_f16_f32 v19, v44, v45
v_lshlrev_b32 v42, 16, v20
v_and_b32 v43, 0xffff0000, v20
v_cvt_pk_f16_f32 v20, v42, v43
v_lshlrev_b32 v44, 16, v21
v_and_b32 v45, 0xffff0000, v21
v_cvt_pk_f16_f32 v21, v44, v45
v_lshlrev_b32 v42, 16, v22
v_and_b32 v43, 0xffff0000, v22
v_cvt_pk_f16_f32 v22, v42, v43
v_lshlrev_b32 v44, 16, v23
v_and_b32 v45, 0xffff0000, v23
v_cvt_pk_f16_f32 v23, v44, v45
v_accvgpr_write_b32 a216, v16
v_accvgpr_write_b32 a217, v17
v_accvgpr_write_b32 a218, v18
v_accvgpr_write_b32 a219, v19
v_accvgpr_write_b32 a220, v20
v_accvgpr_write_b32 a221, v21
v_accvgpr_write_b32 a222, v22
v_accvgpr_write_b32 a223, v23
v_lshlrev_b32 v42, 16, v24
v_and_b32 v43, 0xffff0000, v24
v_cvt_pk_f16_f32 v24, v42, v43
v_lshlrev_b32 v44, 16, v25
v_and_b32 v45, 0xffff0000, v25
v_cvt_pk_f16_f32 v25, v44, v45
v_lshlrev_b32 v42, 16, v26
v_and_b32 v43, 0xffff0000, v26
v_cvt_pk_f16_f32 v26, v42, v43
v_lshlrev_b32 v44, 16, v27
v_and_b32 v45, 0xffff0000, v27
v_cvt_pk_f16_f32 v27, v44, v45
v_lshlrev_b32 v42, 16, v28
v_and_b32 v43, 0xffff0000, v28
v_cvt_pk_f16_f32 v28, v42, v43
v_lshlrev_b32 v44, 16, v29
v_and_b32 v45, 0xffff0000, v29
v_cvt_pk_f16_f32 v29, v44, v45
v_lshlrev_b32 v42, 16, v30
v_and_b32 v43, 0xffff0000, v30
v_cvt_pk_f16_f32 v30, v42, v43
v_lshlrev_b32 v44, 16, v31
v_and_b32 v45, 0xffff0000, v31
v_cvt_pk_f16_f32 v31, v44, v45
v_accvgpr_write_b32 a248, v24
v_accvgpr_write_b32 a249, v25
v_accvgpr_write_b32 a250, v26
v_accvgpr_write_b32 a251, v27
v_accvgpr_write_b32 a252, v28
v_accvgpr_write_b32 a253, v29
v_accvgpr_write_b32 a254, v30
v_accvgpr_write_b32 a255, v31
s_waitcnt vmcnt(24)
s_barrier
ds_read_b64_tr_b16 v[128:129], v36 offset:0
ds_read_b64_tr_b16 v[130:131], v36 offset:256
ds_read_b64_tr_b16 v[132:133], v36 offset:4096
ds_read_b64_tr_b16 v[134:135], v36 offset:4352
ds_read_b64_tr_b16 v[136:137], v37 offset:0
ds_read_b64_tr_b16 v[138:139], v37 offset:256
ds_read_b64_tr_b16 v[140:141], v37 offset:4096
ds_read_b64_tr_b16 v[142:143], v37 offset:4352
ds_read_b64_tr_b16 v[144:145], v38 offset:0
ds_read_b64_tr_b16 v[146:147], v38 offset:256
ds_read_b64_tr_b16 v[148:149], v38 offset:4096
ds_read_b64_tr_b16 v[150:151], v38 offset:4352
ds_read_b64_tr_b16 v[152:153], v39 offset:0
ds_read_b64_tr_b16 v[154:155], v39 offset:256
ds_read_b64_tr_b16 v[156:157], v39 offset:4096
ds_read_b64_tr_b16 v[158:159], v39 offset:4352
s_waitcnt lgkmcnt(0)
s_barrier
s_mov_b32 s8, s40
s_and_b32 s9, s41, 0xffff
s_mov_b32 s10, 0x800000
s_mov_b32 s11, 0x20000
s_xor_b32 s32, s34, 0x0
s_add_u32 m0, s36, 0
s_nop 0
buffer_load_dwordx4 v64, s[8:11], s32 offen lds
s_xor_b32 s32, s34, 0x10000
s_add_u32 m0, s36, 1024
s_nop 0
buffer_load_dwordx4 v64, s[8:11], s32 offen lds
s_xor_b32 s32, s34, 0x20000
s_add_u32 m0, s36, 2048
s_nop 0
buffer_load_dwordx4 v64, s[8:11], s32 offen lds
s_xor_b32 s32, s34, 0x30000
s_add_u32 m0, s36, 3072
s_nop 0
buffer_load_dwordx4 v64, s[8:11], s32 offen lds
s_xor_b32 s32, s34, 0x40000
s_add_u32 m0, s36, 4096
s_nop 0
buffer_load_dwordx4 v64, s[8:11], s32 offen lds
s_xor_b32 s32, s34, 0x50000
s_add_u32 m0, s36, 5120
s_nop 0
buffer_load_dwordx4 v64, s[8:11], s32 offen lds
s_xor_b32 s32, s34, 0x60000
s_add_u32 m0, s36, 6144
s_nop 0
buffer_load_dwordx4 v64, s[8:11], s32 offen lds
s_xor_b32 s32, s34, 0x70000
s_add_u32 m0, s36, 7168
s_nop 0
buffer_load_dwordx4 v64, s[8:11], s32 offen lds
v_lshlrev_b32 v42, 16, v128
v_and_b32 v43, 0xffff0000, v128
v_cvt_pk_f16_f32 v128, v42, v43
v_lshlrev_b32 v44, 16, v129
v_and_b32 v45, 0xffff0000, v129
v_cvt_pk_f16_f32 v129, v44, v45
v_lshlrev_b32 v42, 16, v130
v_and_b32 v43, 0xffff0000, v130
v_cvt_pk_f16_f32 v130, v42, v43
v_lshlrev_b32 v44, 16, v131
v_and_b32 v45, 0xffff0000, v131
v_cvt_pk_f16_f32 v131, v44, v45
v_lshlrev_b32 v42, 16, v132
v_and_b32 v43, 0xffff0000, v132
v_cvt_pk_f16_f32 v132, v42, v43
v_lshlrev_b32 v44, 16, v133
v_and_b32 v45, 0xffff0000, v133
v_cvt_pk_f16_f32 v133, v44, v45
v_lshlrev_b32 v42, 16, v134
v_and_b32 v43, 0xffff0000, v134
v_cvt_pk_f16_f32 v134, v42, v43
v_lshlrev_b32 v44, 16, v135
v_and_b32 v45, 0xffff0000, v135
v_cvt_pk_f16_f32 v135, v44, v45
v_lshlrev_b32 v42, 16, v136
v_and_b32 v43, 0xffff0000, v136
v_cvt_pk_f16_f32 v136, v42, v43
v_lshlrev_b32 v44, 16, v137
v_and_b32 v45, 0xffff0000, v137
v_cvt_pk_f16_f32 v137, v44, v45
v_lshlrev_b32 v42, 16, v138
v_and_b32 v43, 0xffff0000, v138
v_cvt_pk_f16_f32 v138, v42, v43
v_lshlrev_b32 v44, 16, v139
v_and_b32 v45, 0xffff0000, v139
v_cvt_pk_f16_f32 v139, v44, v45
v_lshlrev_b32 v42, 16, v140
v_and_b32 v43, 0xffff0000, v140
v_cvt_pk_f16_f32 v140, v42, v43
v_lshlrev_b32 v44, 16, v141
v_and_b32 v45, 0xffff0000, v141
v_cvt_pk_f16_f32 v141, v44, v45
v_lshlrev_b32 v42, 16, v142
v_and_b32 v43, 0xffff0000, v142
v_cvt_pk_f16_f32 v142, v42, v43
v_lshlrev_b32 v44, 16, v143
v_and_b32 v45, 0xffff0000, v143
v_cvt_pk_f16_f32 v143, v44, v45
v_lshlrev_b32 v42, 16, v144
v_and_b32 v43, 0xffff0000, v144
v_cvt_pk_f16_f32 v144, v42, v43
v_lshlrev_b32 v44, 16, v145
v_and_b32 v45, 0xffff0000, v145
v_cvt_pk_f16_f32 v145, v44, v45
v_lshlrev_b32 v42, 16, v146
v_and_b32 v43, 0xffff0000, v146
v_cvt_pk_f16_f32 v146, v42, v43
v_lshlrev_b32 v44, 16, v147
v_and_b32 v45, 0xffff0000, v147
v_cvt_pk_f16_f32 v147, v44, v45
v_lshlrev_b32 v42, 16, v148
v_and_b32 v43, 0xffff0000, v148
v_cvt_pk_f16_f32 v148, v42, v43
v_lshlrev_b32 v44, 16, v149
v_and_b32 v45, 0xffff0000, v149
v_cvt_pk_f16_f32 v149, v44, v45
v_lshlrev_b32 v42, 16, v150
v_and_b32 v43, 0xffff0000, v150
v_cvt_pk_f16_f32 v150, v42, v43
v_lshlrev_b32 v44, 16, v151
v_and_b32 v45, 0xffff0000, v151
v_cvt_pk_f16_f32 v151, v44, v45
v_lshlrev_b32 v42, 16, v152
v_and_b32 v43, 0xffff0000, v152
v_cvt_pk_f16_f32 v152, v42, v43
v_lshlrev_b32 v44, 16, v153
v_and_b32 v45, 0xffff0000, v153
v_cvt_pk_f16_f32 v153, v44, v45
v_lshlrev_b32 v42, 16, v154
v_and_b32 v43, 0xffff0000, v154
v_cvt_pk_f16_f32 v154, v42, v43
v_lshlrev_b32 v44, 16, v155
v_and_b32 v45, 0xffff0000, v155
v_cvt_pk_f16_f32 v155, v44, v45
v_lshlrev_b32 v42, 16, v156
v_and_b32 v43, 0xffff0000, v156
v_cvt_pk_f16_f32 v156, v42, v43
v_lshlrev_b32 v44, 16, v157
v_and_b32 v45, 0xffff0000, v157
v_cvt_pk_f16_f32 v157, v44, v45
v_lshlrev_b32 v42, 16, v158
v_and_b32 v43, 0xffff0000, v158
v_cvt_pk_f16_f32 v158, v42, v43
v_lshlrev_b32 v44, 16, v159
v_and_b32 v45, 0xffff0000, v159
v_cvt_pk_f16_f32 v159, v44, v45
s_waitcnt vmcnt(24)
s_barrier
ds_read_b64_tr_b16 v[160:161], v36 offset:8192
ds_read_b64_tr_b16 v[162:163], v36 offset:8448
ds_read_b64_tr_b16 v[164:165], v36 offset:12288
ds_read_b64_tr_b16 v[166:167], v36 offset:12544
ds_read_b64_tr_b16 v[168:169], v37 offset:8192
ds_read_b64_tr_b16 v[170:171], v37 offset:8448
ds_read_b64_tr_b16 v[172:173], v37 offset:12288
ds_read_b64_tr_b16 v[174:175], v37 offset:12544
ds_read_b64_tr_b16 v[176:177], v38 offset:8192
ds_read_b64_tr_b16 v[178:179], v38 offset:8448
ds_read_b64_tr_b16 v[180:181], v38 offset:12288
ds_read_b64_tr_b16 v[182:183], v38 offset:12544
ds_read_b64_tr_b16 v[184:185], v39 offset:8192
ds_read_b64_tr_b16 v[186:187], v39 offset:8448
ds_read_b64_tr_b16 v[188:189], v39 offset:12288
ds_read_b64_tr_b16 v[190:191], v39 offset:12544
s_waitcnt lgkmcnt(0)
s_barrier
s_xor_b32 s32, s34, 0x80000
s_add_u32 m0, s36, 8192
s_nop 0
buffer_load_dwordx4 v64, s[8:11], s32 offen lds
s_xor_b32 s32, s34, 0x90000
s_add_u32 m0, s36, 9216
s_nop 0
buffer_load_dwordx4 v64, s[8:11], s32 offen lds
s_xor_b32 s32, s34, 0xa0000
s_add_u32 m0, s36, 10240
s_nop 0
buffer_load_dwordx4 v64, s[8:11], s32 offen lds
s_xor_b32 s32, s34, 0xb0000
s_add_u32 m0, s36, 11264
s_nop 0
buffer_load_dwordx4 v64, s[8:11], s32 offen lds
s_xor_b32 s32, s34, 0xc0000
s_add_u32 m0, s36, 12288
s_nop 0
buffer_load_dwordx4 v64, s[8:11], s32 offen lds
s_xor_b32 s32, s34, 0xd0000
s_add_u32 m0, s36, 13312
s_nop 0
buffer_load_dwordx4 v64, s[8:11], s32 offen lds
s_xor_b32 s32, s34, 0xe0000
s_add_u32 m0, s36, 14336
s_nop 0
buffer_load_dwordx4 v64, s[8:11], s32 offen lds
s_xor_b32 s32, s34, 0xf0000
s_add_u32 m0, s36, 15360
s_nop 0
buffer_load_dwordx4 v64, s[8:11], s32 offen lds
v_lshlrev_b32 v42, 16, v160
v_and_b32 v43, 0xffff0000, v160
v_cvt_pk_f16_f32 v160, v42, v43
v_lshlrev_b32 v44, 16, v161
v_and_b32 v45, 0xffff0000, v161
v_cvt_pk_f16_f32 v161, v44, v45
v_lshlrev_b32 v42, 16, v162
v_and_b32 v43, 0xffff0000, v162
v_cvt_pk_f16_f32 v162, v42, v43
v_lshlrev_b32 v44, 16, v163
v_and_b32 v45, 0xffff0000, v163
v_cvt_pk_f16_f32 v163, v44, v45
v_lshlrev_b32 v42, 16, v164
v_and_b32 v43, 0xffff0000, v164
v_cvt_pk_f16_f32 v164, v42, v43
v_lshlrev_b32 v44, 16, v165
v_and_b32 v45, 0xffff0000, v165
v_cvt_pk_f16_f32 v165, v44, v45
v_lshlrev_b32 v42, 16, v166
v_and_b32 v43, 0xffff0000, v166
v_cvt_pk_f16_f32 v166, v42, v43
v_lshlrev_b32 v44, 16, v167
v_and_b32 v45, 0xffff0000, v167
v_cvt_pk_f16_f32 v167, v44, v45
v_lshlrev_b32 v42, 16, v168
v_and_b32 v43, 0xffff0000, v168
v_cvt_pk_f16_f32 v168, v42, v43
v_lshlrev_b32 v44, 16, v169
v_and_b32 v45, 0xffff0000, v169
v_cvt_pk_f16_f32 v169, v44, v45
v_lshlrev_b32 v42, 16, v170
v_and_b32 v43, 0xffff0000, v170
v_cvt_pk_f16_f32 v170, v42, v43
v_lshlrev_b32 v44, 16, v171
v_and_b32 v45, 0xffff0000, v171
v_cvt_pk_f16_f32 v171, v44, v45
v_lshlrev_b32 v42, 16, v172
v_and_b32 v43, 0xffff0000, v172
v_cvt_pk_f16_f32 v172, v42, v43
v_lshlrev_b32 v44, 16, v173
v_and_b32 v45, 0xffff0000, v173
v_cvt_pk_f16_f32 v173, v44, v45
v_lshlrev_b32 v42, 16, v174
v_and_b32 v43, 0xffff0000, v174
v_cvt_pk_f16_f32 v174, v42, v43
v_lshlrev_b32 v44, 16, v175
v_and_b32 v45, 0xffff0000, v175
v_cvt_pk_f16_f32 v175, v44, v45
v_lshlrev_b32 v42, 16, v176
v_and_b32 v43, 0xffff0000, v176
v_cvt_pk_f16_f32 v176, v42, v43
v_lshlrev_b32 v44, 16, v177
v_and_b32 v45, 0xffff0000, v177
v_cvt_pk_f16_f32 v177, v44, v45
v_lshlrev_b32 v42, 16, v178
v_and_b32 v43, 0xffff0000, v178
v_cvt_pk_f16_f32 v178, v42, v43
v_lshlrev_b32 v44, 16, v179
v_and_b32 v45, 0xffff0000, v179
v_cvt_pk_f16_f32 v179, v44, v45
v_lshlrev_b32 v42, 16, v180
v_and_b32 v43, 0xffff0000, v180
v_cvt_pk_f16_f32 v180, v42, v43
v_lshlrev_b32 v44, 16, v181
v_and_b32 v45, 0xffff0000, v181
v_cvt_pk_f16_f32 v181, v44, v45
v_lshlrev_b32 v42, 16, v182
v_and_b32 v43, 0xffff0000, v182
v_cvt_pk_f16_f32 v182, v42, v43
v_lshlrev_b32 v44, 16, v183
v_and_b32 v45, 0xffff0000, v183
v_cvt_pk_f16_f32 v183, v44, v45
v_lshlrev_b32 v42, 16, v184
v_and_b32 v43, 0xffff0000, v184
v_cvt_pk_f16_f32 v184, v42, v43
v_lshlrev_b32 v44, 16, v185
v_and_b32 v45, 0xffff0000, v185
v_cvt_pk_f16_f32 v185, v44, v45
v_lshlrev_b32 v42, 16, v186
v_and_b32 v43, 0xffff0000, v186
v_cvt_pk_f16_f32 v186, v42, v43
v_lshlrev_b32 v44, 16, v187
v_and_b32 v45, 0xffff0000, v187
v_cvt_pk_f16_f32 v187, v44, v45
v_lshlrev_b32 v42, 16, v188
v_and_b32 v43, 0xffff0000, v188
v_cvt_pk_f16_f32 v188, v42, v43
v_lshlrev_b32 v44, 16, v189
v_and_b32 v45, 0xffff0000, v189
v_cvt_pk_f16_f32 v189, v44, v45
v_lshlrev_b32 v42, 16, v190
v_and_b32 v43, 0xffff0000, v190
v_cvt_pk_f16_f32 v190, v42, v43
v_lshlrev_b32 v44, 16, v191
v_and_b32 v45, 0xffff0000, v191
v_cvt_pk_f16_f32 v191, v44, v45
s_waitcnt vmcnt(24)
s_barrier
ds_read_b64_tr_b16 v[192:193], v36 offset:16384
ds_read_b64_tr_b16 v[194:195], v36 offset:16640
ds_read_b64_tr_b16 v[196:197], v36 offset:20480
ds_read_b64_tr_b16 v[198:199], v36 offset:20736
ds_read_b64_tr_b16 v[200:201], v37 offset:16384
ds_read_b64_tr_b16 v[202:203], v37 offset:16640
ds_read_b64_tr_b16 v[204:205], v37 offset:20480
ds_read_b64_tr_b16 v[206:207], v37 offset:20736
ds_read_b64_tr_b16 v[208:209], v38 offset:16384
ds_read_b64_tr_b16 v[210:211], v38 offset:16640
ds_read_b64_tr_b16 v[212:213], v38 offset:20480
ds_read_b64_tr_b16 v[214:215], v38 offset:20736
ds_read_b64_tr_b16 v[216:217], v39 offset:16384
ds_read_b64_tr_b16 v[218:219], v39 offset:16640
ds_read_b64_tr_b16 v[220:221], v39 offset:20480
ds_read_b64_tr_b16 v[222:223], v39 offset:20736
s_waitcnt lgkmcnt(0)
s_barrier
buffer_load_dword v72, v73, s[60:63], 0 offen sc1
buffer_load_dwordx2 v[84:85], off, s[60:63], 0 offset:16 sc1
s_xor_b32 s32, s34, 0x100000
s_add_u32 m0, s36, 16384
s_nop 0
buffer_load_dwordx4 v64, s[8:11], s32 offen lds
s_xor_b32 s32, s34, 0x110000
s_add_u32 m0, s36, 17408
s_nop 0
buffer_load_dwordx4 v64, s[8:11], s32 offen lds
s_xor_b32 s32, s34, 0x120000
s_add_u32 m0, s36, 18432
s_nop 0
buffer_load_dwordx4 v64, s[8:11], s32 offen lds
s_xor_b32 s32, s34, 0x130000
s_add_u32 m0, s36, 19456
s_nop 0
buffer_load_dwordx4 v64, s[8:11], s32 offen lds
s_xor_b32 s32, s34, 0x140000
s_add_u32 m0, s36, 20480
s_nop 0
buffer_load_dwordx4 v64, s[8:11], s32 offen lds
s_xor_b32 s32, s34, 0x150000
s_add_u32 m0, s36, 21504
s_nop 0
buffer_load_dwordx4 v64, s[8:11], s32 offen lds
s_xor_b32 s32, s34, 0x160000
s_add_u32 m0, s36, 22528
s_nop 0
buffer_load_dwordx4 v64, s[8:11], s32 offen lds
s_xor_b32 s32, s34, 0x170000
s_add_u32 m0, s36, 23552
s_nop 0
buffer_load_dwordx4 v64, s[8:11], s32 offen lds
v_lshlrev_b32 v42, 16, v192
v_and_b32 v43, 0xffff0000, v192
v_cvt_pk_f16_f32 v192, v42, v43
v_lshlrev_b32 v44, 16, v193
v_and_b32 v45, 0xffff0000, v193
v_cvt_pk_f16_f32 v193, v44, v45
v_lshlrev_b32 v42, 16, v194
v_and_b32 v43, 0xffff0000, v194
v_cvt_pk_f16_f32 v194, v42, v43
v_lshlrev_b32 v44, 16, v195
v_and_b32 v45, 0xffff0000, v195
v_cvt_pk_f16_f32 v195, v44, v45
v_lshlrev_b32 v42, 16, v196
v_and_b32 v43, 0xffff0000, v196
v_cvt_pk_f16_f32 v196, v42, v43
v_lshlrev_b32 v44, 16, v197
v_and_b32 v45, 0xffff0000, v197
v_cvt_pk_f16_f32 v197, v44, v45
v_lshlrev_b32 v42, 16, v198
v_and_b32 v43, 0xffff0000, v198
v_cvt_pk_f16_f32 v198, v42, v43
v_lshlrev_b32 v44, 16, v199
v_and_b32 v45, 0xffff0000, v199
v_cvt_pk_f16_f32 v199, v44, v45
v_lshlrev_b32 v42, 16, v200
v_and_b32 v43, 0xffff0000, v200
v_cvt_pk_f16_f32 v200, v42, v43
v_lshlrev_b32 v44, 16, v201
v_and_b32 v45, 0xffff0000, v201
v_cvt_pk_f16_f32 v201, v44, v45
v_lshlrev_b32 v42, 16, v202
v_and_b32 v43, 0xffff0000, v202
v_cvt_pk_f16_f32 v202, v42, v43
v_lshlrev_b32 v44, 16, v203
v_and_b32 v45, 0xffff0000, v203
v_cvt_pk_f16_f32 v203, v44, v45
v_lshlrev_b32 v42, 16, v204
v_and_b32 v43, 0xffff0000, v204
v_cvt_pk_f16_f32 v204, v42, v43
v_lshlrev_b32 v44, 16, v205
v_and_b32 v45, 0xffff0000, v205
v_cvt_pk_f16_f32 v205, v44, v45
v_lshlrev_b32 v42, 16, v206
v_and_b32 v43, 0xffff0000, v206
v_cvt_pk_f16_f32 v206, v42, v43
v_lshlrev_b32 v44, 16, v207
v_and_b32 v45, 0xffff0000, v207
v_cvt_pk_f16_f32 v207, v44, v45
v_lshlrev_b32 v42, 16, v208
v_and_b32 v43, 0xffff0000, v208
v_cvt_pk_f16_f32 v208, v42, v43
v_lshlrev_b32 v44, 16, v209
v_and_b32 v45, 0xffff0000, v209
v_cvt_pk_f16_f32 v209, v44, v45
v_lshlrev_b32 v42, 16, v210
v_and_b32 v43, 0xffff0000, v210
v_cvt_pk_f16_f32 v210, v42, v43
v_lshlrev_b32 v44, 16, v211
v_and_b32 v45, 0xffff0000, v211
v_cvt_pk_f16_f32 v211, v44, v45
v_lshlrev_b32 v42, 16, v212
v_and_b32 v43, 0xffff0000, v212
v_cvt_pk_f16_f32 v212, v42, v43
v_lshlrev_b32 v44, 16, v213
v_and_b32 v45, 0xffff0000, v213
v_cvt_pk_f16_f32 v213, v44, v45
v_lshlrev_b32 v42, 16, v214
v_and_b32 v43, 0xffff0000, v214
v_cvt_pk_f16_f32 v214, v42, v43
v_lshlrev_b32 v44, 16, v215
v_and_b32 v45, 0xffff0000, v215
v_cvt_pk_f16_f32 v215, v44, v45
v_lshlrev_b32 v42, 16, v216
v_and_b32 v43, 0xffff0000, v216
v_cvt_pk_f16_f32 v216, v42, v43
v_lshlrev_b32 v44, 16, v217
v_and_b32 v45, 0xffff0000, v217
v_cvt_pk_f16_f32 v217, v44, v45
v_lshlrev_b32 v42, 16, v218
v_and_b32 v43, 0xffff0000, v218
v_cvt_pk_f16_f32 v218, v42, v43
v_lshlrev_b32 v44, 16, v219
v_and_b32 v45, 0xffff0000, v219
v_cvt_pk_f16_f32 v219, v44, v45
v_lshlrev_b32 v42, 16, v220
v_and_b32 v43, 0xffff0000, v220
v_cvt_pk_f16_f32 v220, v42, v43
v_lshlrev_b32 v44, 16, v221
v_and_b32 v45, 0xffff0000, v221
v_cvt_pk_f16_f32 v221, v44, v45
v_lshlrev_b32 v42, 16, v222
v_and_b32 v43, 0xffff0000, v222
v_cvt_pk_f16_f32 v222, v42, v43
v_lshlrev_b32 v44, 16, v223
v_and_b32 v45, 0xffff0000, v223
v_cvt_pk_f16_f32 v223, v44, v45
s_waitcnt vmcnt(26)
s_barrier
ds_read_b64_tr_b16 v[224:225], v36 offset:24576
ds_read_b64_tr_b16 v[226:227], v36 offset:24832
ds_read_b64_tr_b16 v[228:229], v36 offset:28672
ds_read_b64_tr_b16 v[230:231], v36 offset:28928
ds_read_b64_tr_b16 v[232:233], v37 offset:24576
ds_read_b64_tr_b16 v[234:235], v37 offset:24832
ds_read_b64_tr_b16 v[236:237], v37 offset:28672
ds_read_b64_tr_b16 v[238:239], v37 offset:28928
ds_read_b64_tr_b16 v[240:241], v38 offset:24576
ds_read_b64_tr_b16 v[242:243], v38 offset:24832
ds_read_b64_tr_b16 v[244:245], v38 offset:28672
ds_read_b64_tr_b16 v[246:247], v38 offset:28928
ds_read_b64_tr_b16 v[248:249], v39 offset:24576
ds_read_b64_tr_b16 v[250:251], v39 offset:24832
ds_read_b64_tr_b16 v[252:253], v39 offset:28672
ds_read_b64_tr_b16 v[254:255], v39 offset:28928
s_waitcnt lgkmcnt(0)
s_barrier
s_xor_b32 s32, s34, 0x180000
s_add_u32 m0, s36, 24576
s_nop 0
buffer_load_dwordx4 v64, s[8:11], s32 offen lds
s_xor_b32 s32, s34, 0x190000
s_add_u32 m0, s36, 25600
s_nop 0
buffer_load_dwordx4 v64, s[8:11], s32 offen lds
s_xor_b32 s32, s34, 0x1a0000
s_add_u32 m0, s36, 26624
s_nop 0
buffer_load_dwordx4 v64, s[8:11], s32 offen lds
s_xor_b32 s32, s34, 0x1b0000
s_add_u32 m0, s36, 27648
s_nop 0
buffer_load_dwordx4 v64, s[8:11], s32 offen lds
s_xor_b32 s32, s34, 0x1c0000
s_add_u32 m0, s36, 28672
s_nop 0
buffer_load_dwordx4 v64, s[8:11], s32 offen lds
s_xor_b32 s32, s34, 0x1d0000
s_add_u32 m0, s36, 29696
s_nop 0
buffer_load_dwordx4 v64, s[8:11], s32 offen lds
s_xor_b32 s32, s34, 0x1e0000
s_add_u32 m0, s36, 30720
s_nop 0
buffer_load_dwordx4 v64, s[8:11], s32 offen lds
s_xor_b32 s32, s34, 0x1f0000
s_add_u32 m0, s36, 31744
s_nop 0
buffer_load_dwordx4 v64, s[8:11], s32 offen lds
v_lshlrev_b32 v42, 16, v224
v_and_b32 v43, 0xffff0000, v224
v_cvt_pk_f16_f32 v224, v42, v43
v_lshlrev_b32 v44, 16, v225
v_and_b32 v45, 0xffff0000, v225
v_cvt_pk_f16_f32 v225, v44, v45
v_lshlrev_b32 v42, 16, v226
v_and_b32 v43, 0xffff0000, v226
v_cvt_pk_f16_f32 v226, v42, v43
v_lshlrev_b32 v44, 16, v227
v_and_b32 v45, 0xffff0000, v227
v_cvt_pk_f16_f32 v227, v44, v45
v_lshlrev_b32 v42, 16, v228
v_and_b32 v43, 0xffff0000, v228
v_cvt_pk_f16_f32 v228, v42, v43
v_lshlrev_b32 v44, 16, v229
v_and_b32 v45, 0xffff0000, v229
v_cvt_pk_f16_f32 v229, v44, v45
v_lshlrev_b32 v42, 16, v230
v_and_b32 v43, 0xffff0000, v230
v_cvt_pk_f16_f32 v230, v42, v43
v_lshlrev_b32 v44, 16, v231
v_and_b32 v45, 0xffff0000, v231
v_cvt_pk_f16_f32 v231, v44, v45
v_lshlrev_b32 v42, 16, v232
v_and_b32 v43, 0xffff0000, v232
v_cvt_pk_f16_f32 v232, v42, v43
v_lshlrev_b32 v44, 16, v233
v_and_b32 v45, 0xffff0000, v233
v_cvt_pk_f16_f32 v233, v44, v45
v_lshlrev_b32 v42, 16, v234
v_and_b32 v43, 0xffff0000, v234
v_cvt_pk_f16_f32 v234, v42, v43
v_lshlrev_b32 v44, 16, v235
v_and_b32 v45, 0xffff0000, v235
v_cvt_pk_f16_f32 v235, v44, v45
v_lshlrev_b32 v42, 16, v236
v_and_b32 v43, 0xffff0000, v236
v_cvt_pk_f16_f32 v236, v42, v43
v_lshlrev_b32 v44, 16, v237
v_and_b32 v45, 0xffff0000, v237
v_cvt_pk_f16_f32 v237, v44, v45
v_lshlrev_b32 v42, 16, v238
v_and_b32 v43, 0xffff0000, v238
v_cvt_pk_f16_f32 v238, v42, v43
v_lshlrev_b32 v44, 16, v239
v_and_b32 v45, 0xffff0000, v239
v_cvt_pk_f16_f32 v239, v44, v45
v_lshlrev_b32 v42, 16, v240
v_and_b32 v43, 0xffff0000, v240
v_cvt_pk_f16_f32 v240, v42, v43
v_lshlrev_b32 v44, 16, v241
v_and_b32 v45, 0xffff0000, v241
v_cvt_pk_f16_f32 v241, v44, v45
v_lshlrev_b32 v42, 16, v242
v_and_b32 v43, 0xffff0000, v242
v_cvt_pk_f16_f32 v242, v42, v43
v_lshlrev_b32 v44, 16, v243
v_and_b32 v45, 0xffff0000, v243
v_cvt_pk_f16_f32 v243, v44, v45
v_lshlrev_b32 v42, 16, v244
v_and_b32 v43, 0xffff0000, v244
v_cvt_pk_f16_f32 v244, v42, v43
v_lshlrev_b32 v44, 16, v245
v_and_b32 v45, 0xffff0000, v245
v_cvt_pk_f16_f32 v245, v44, v45
v_lshlrev_b32 v42, 16, v246
v_and_b32 v43, 0xffff0000, v246
v_cvt_pk_f16_f32 v246, v42, v43
v_lshlrev_b32 v44, 16, v247
v_and_b32 v45, 0xffff0000, v247
v_cvt_pk_f16_f32 v247, v44, v45
v_lshlrev_b32 v42, 16, v248
v_and_b32 v43, 0xffff0000, v248
v_cvt_pk_f16_f32 v248, v42, v43
v_lshlrev_b32 v44, 16, v249
v_and_b32 v45, 0xffff0000, v249
v_cvt_pk_f16_f32 v249, v44, v45
v_lshlrev_b32 v42, 16, v250
v_and_b32 v43, 0xffff0000, v250
v_cvt_pk_f16_f32 v250, v42, v43
v_lshlrev_b32 v44, 16, v251
v_and_b32 v45, 0xffff0000, v251
v_cvt_pk_f16_f32 v251, v44, v45
v_lshlrev_b32 v42, 16, v252
v_and_b32 v43, 0xffff0000, v252
v_cvt_pk_f16_f32 v252, v42, v43
v_lshlrev_b32 v44, 16, v253
v_and_b32 v45, 0xffff0000, v253
v_cvt_pk_f16_f32 v253, v44, v45
v_lshlrev_b32 v42, 16, v254
v_and_b32 v43, 0xffff0000, v254
v_cvt_pk_f16_f32 v254, v42, v43
v_lshlrev_b32 v44, 16, v255
v_and_b32 v45, 0xffff0000, v255
v_cvt_pk_f16_f32 v255, v44, v45
s_waitcnt vmcnt(26)
s_barrier
ds_read_b64_tr_b16 v[0:1], v32 offset:0
ds_read_b64_tr_b16 v[2:3], v32 offset:256
ds_read_b64_tr_b16 v[4:5], v32 offset:4096
ds_read_b64_tr_b16 v[6:7], v32 offset:4352
ds_read_b64_tr_b16 v[8:9], v33 offset:0
ds_read_b64_tr_b16 v[10:11], v33 offset:256
ds_read_b64_tr_b16 v[12:13], v33 offset:4096
ds_read_b64_tr_b16 v[14:15], v33 offset:4352
ds_read_b64_tr_b16 v[16:17], v34 offset:0
ds_read_b64_tr_b16 v[18:19], v34 offset:256
ds_read_b64_tr_b16 v[20:21], v34 offset:4096
ds_read_b64_tr_b16 v[22:23], v34 offset:4352
ds_read_b64_tr_b16 v[24:25], v35 offset:0
ds_read_b64_tr_b16 v[26:27], v35 offset:256
ds_read_b64_tr_b16 v[28:29], v35 offset:4096
ds_read_b64_tr_b16 v[30:31], v35 offset:4352
s_waitcnt lgkmcnt(0)
s_barrier
s_mov_b32 s8, s46
s_and_b32 s9, s47, 0xffff
s_mov_b32 s10, 0x800000
s_mov_b32 s11, 0x20000
s_xor_b32 s32, s35, 0x0
s_add_u32 m0, s36, 0
s_nop 0
buffer_load_dwordx4 v65, s[8:11], s32 offen lds
s_xor_b32 s32, s35, 0x8000
s_add_u32 m0, s36, 1024
s_nop 0
buffer_load_dwordx4 v65, s[8:11], s32 offen lds
s_xor_b32 s32, s35, 0x10000
s_add_u32 m0, s36, 2048
s_nop 0
buffer_load_dwordx4 v65, s[8:11], s32 offen lds
s_xor_b32 s32, s35, 0x18000
s_add_u32 m0, s36, 3072
s_nop 0
buffer_load_dwordx4 v65, s[8:11], s32 offen lds
s_xor_b32 s32, s35, 0x20000
s_add_u32 m0, s36, 4096
s_nop 0
buffer_load_dwordx4 v65, s[8:11], s32 offen lds
s_xor_b32 s32, s35, 0x28000
s_add_u32 m0, s36, 5120
s_nop 0
buffer_load_dwordx4 v65, s[8:11], s32 offen lds
s_xor_b32 s32, s35, 0x30000
s_add_u32 m0, s36, 6144
s_nop 0
buffer_load_dwordx4 v65, s[8:11], s32 offen lds
s_xor_b32 s32, s35, 0x38000
s_add_u32 m0, s36, 7168
s_nop 0
buffer_load_dwordx4 v65, s[8:11], s32 offen lds
v_lshlrev_b32 v42, 16, v0
v_and_b32 v43, 0xffff0000, v0
v_cvt_pk_f16_f32 v0, v42, v43
v_lshlrev_b32 v44, 16, v1
v_and_b32 v45, 0xffff0000, v1
v_cvt_pk_f16_f32 v1, v44, v45
v_lshlrev_b32 v42, 16, v2
v_and_b32 v43, 0xffff0000, v2
v_cvt_pk_f16_f32 v2, v42, v43
v_lshlrev_b32 v44, 16, v3
v_and_b32 v45, 0xffff0000, v3
v_cvt_pk_f16_f32 v3, v44, v45
v_lshlrev_b32 v42, 16, v4
v_and_b32 v43, 0xffff0000, v4
v_cvt_pk_f16_f32 v4, v42, v43
v_lshlrev_b32 v44, 16, v5
v_and_b32 v45, 0xffff0000, v5
v_cvt_pk_f16_f32 v5, v44, v45
v_lshlrev_b32 v42, 16, v6
v_and_b32 v43, 0xffff0000, v6
v_cvt_pk_f16_f32 v6, v42, v43
v_lshlrev_b32 v44, 16, v7
v_and_b32 v45, 0xffff0000, v7
v_cvt_pk_f16_f32 v7, v44, v45
v_accvgpr_write_b32 a0, v0
v_accvgpr_write_b32 a1, v1
v_accvgpr_write_b32 a2, v2
v_accvgpr_write_b32 a3, v3
v_accvgpr_write_b32 a4, v4
v_accvgpr_write_b32 a5, v5
v_accvgpr_write_b32 a6, v6
v_accvgpr_write_b32 a7, v7
v_lshlrev_b32 v42, 16, v8
v_and_b32 v43, 0xffff0000, v8
v_cvt_pk_f16_f32 v8, v42, v43
v_lshlrev_b32 v44, 16, v9
v_and_b32 v45, 0xffff0000, v9
v_cvt_pk_f16_f32 v9, v44, v45
v_lshlrev_b32 v42, 16, v10
v_and_b32 v43, 0xffff0000, v10
v_cvt_pk_f16_f32 v10, v42, v43
v_lshlrev_b32 v44, 16, v11
v_and_b32 v45, 0xffff0000, v11
v_cvt_pk_f16_f32 v11, v44, v45
v_lshlrev_b32 v42, 16, v12
v_and_b32 v43, 0xffff0000, v12
v_cvt_pk_f16_f32 v12, v42, v43
v_lshlrev_b32 v44, 16, v13
v_and_b32 v45, 0xffff0000, v13
v_cvt_pk_f16_f32 v13, v44, v45
v_lshlrev_b32 v42, 16, v14
v_and_b32 v43, 0xffff0000, v14
v_cvt_pk_f16_f32 v14, v42, v43
v_lshlrev_b32 v44, 16, v15
v_and_b32 v45, 0xffff0000, v15
v_cvt_pk_f16_f32 v15, v44, v45
v_accvgpr_write_b32 a32, v8
v_accvgpr_write_b32 a33, v9
v_accvgpr_write_b32 a34, v10
v_accvgpr_write_b32 a35, v11
v_accvgpr_write_b32 a36, v12
v_accvgpr_write_b32 a37, v13
v_accvgpr_write_b32 a38, v14
v_accvgpr_write_b32 a39, v15
v_lshlrev_b32 v42, 16, v16
v_and_b32 v43, 0xffff0000, v16
v_cvt_pk_f16_f32 v16, v42, v43
v_lshlrev_b32 v44, 16, v17
v_and_b32 v45, 0xffff0000, v17
v_cvt_pk_f16_f32 v17, v44, v45
v_lshlrev_b32 v42, 16, v18
v_and_b32 v43, 0xffff0000, v18
v_cvt_pk_f16_f32 v18, v42, v43
v_lshlrev_b32 v44, 16, v19
v_and_b32 v45, 0xffff0000, v19
v_cvt_pk_f16_f32 v19, v44, v45
v_lshlrev_b32 v42, 16, v20
v_and_b32 v43, 0xffff0000, v20
v_cvt_pk_f16_f32 v20, v42, v43
v_lshlrev_b32 v44, 16, v21
v_and_b32 v45, 0xffff0000, v21
v_cvt_pk_f16_f32 v21, v44, v45
v_lshlrev_b32 v42, 16, v22
v_and_b32 v43, 0xffff0000, v22
v_cvt_pk_f16_f32 v22, v42, v43
v_lshlrev_b32 v44, 16, v23
v_and_b32 v45, 0xffff0000, v23
v_cvt_pk_f16_f32 v23, v44, v45
v_accvgpr_write_b32 a64, v16
v_accvgpr_write_b32 a65, v17
v_accvgpr_write_b32 a66, v18
v_accvgpr_write_b32 a67, v19
v_accvgpr_write_b32 a68, v20
v_accvgpr_write_b32 a69, v21
v_accvgpr_write_b32 a70, v22
v_accvgpr_write_b32 a71, v23
v_lshlrev_b32 v42, 16, v24
v_and_b32 v43, 0xffff0000, v24
v_cvt_pk_f16_f32 v24, v42, v43
v_lshlrev_b32 v44, 16, v25
v_and_b32 v45, 0xffff0000, v25
v_cvt_pk_f16_f32 v25, v44, v45
v_lshlrev_b32 v42, 16, v26
v_and_b32 v43, 0xffff0000, v26
v_cvt_pk_f16_f32 v26, v42, v43
v_lshlrev_b32 v44, 16, v27
v_and_b32 v45, 0xffff0000, v27
v_cvt_pk_f16_f32 v27, v44, v45
v_lshlrev_b32 v42, 16, v28
v_and_b32 v43, 0xffff0000, v28
v_cvt_pk_f16_f32 v28, v42, v43
v_lshlrev_b32 v44, 16, v29
v_and_b32 v45, 0xffff0000, v29
v_cvt_pk_f16_f32 v29, v44, v45
v_lshlrev_b32 v42, 16, v30
v_and_b32 v43, 0xffff0000, v30
v_cvt_pk_f16_f32 v30, v42, v43
v_lshlrev_b32 v44, 16, v31
v_and_b32 v45, 0xffff0000, v31
v_cvt_pk_f16_f32 v31, v44, v45
v_accvgpr_write_b32 a96, v24
v_accvgpr_write_b32 a97, v25
v_accvgpr_write_b32 a98, v26
v_accvgpr_write_b32 a99, v27
v_accvgpr_write_b32 a100, v28
v_accvgpr_write_b32 a101, v29
v_accvgpr_write_b32 a102, v30
v_accvgpr_write_b32 a103, v31
s_waitcnt vmcnt(26)
s_barrier
ds_read_b64_tr_b16 v[0:1], v32 offset:8192
ds_read_b64_tr_b16 v[2:3], v32 offset:8448
ds_read_b64_tr_b16 v[4:5], v32 offset:12288
ds_read_b64_tr_b16 v[6:7], v32 offset:12544
ds_read_b64_tr_b16 v[8:9], v33 offset:8192
ds_read_b64_tr_b16 v[10:11], v33 offset:8448
ds_read_b64_tr_b16 v[12:13], v33 offset:12288
ds_read_b64_tr_b16 v[14:15], v33 offset:12544
ds_read_b64_tr_b16 v[16:17], v34 offset:8192
ds_read_b64_tr_b16 v[18:19], v34 offset:8448
ds_read_b64_tr_b16 v[20:21], v34 offset:12288
ds_read_b64_tr_b16 v[22:23], v34 offset:12544
ds_read_b64_tr_b16 v[24:25], v35 offset:8192
ds_read_b64_tr_b16 v[26:27], v35 offset:8448
ds_read_b64_tr_b16 v[28:29], v35 offset:12288
ds_read_b64_tr_b16 v[30:31], v35 offset:12544
s_waitcnt lgkmcnt(0)
s_barrier
s_xor_b32 s32, s35, 0x40000
s_add_u32 m0, s36, 8192
s_nop 0
buffer_load_dwordx4 v65, s[8:11], s32 offen lds
s_xor_b32 s32, s35, 0x48000
s_add_u32 m0, s36, 9216
s_nop 0
buffer_load_dwordx4 v65, s[8:11], s32 offen lds
s_xor_b32 s32, s35, 0x50000
s_add_u32 m0, s36, 10240
s_nop 0
buffer_load_dwordx4 v65, s[8:11], s32 offen lds
s_xor_b32 s32, s35, 0x58000
s_add_u32 m0, s36, 11264
s_nop 0
buffer_load_dwordx4 v65, s[8:11], s32 offen lds
s_xor_b32 s32, s35, 0x60000
s_add_u32 m0, s36, 12288
s_nop 0
buffer_load_dwordx4 v65, s[8:11], s32 offen lds
s_xor_b32 s32, s35, 0x68000
s_add_u32 m0, s36, 13312
s_nop 0
buffer_load_dwordx4 v65, s[8:11], s32 offen lds
s_xor_b32 s32, s35, 0x70000
s_add_u32 m0, s36, 14336
s_nop 0
buffer_load_dwordx4 v65, s[8:11], s32 offen lds
s_xor_b32 s32, s35, 0x78000
s_add_u32 m0, s36, 15360
s_nop 0
buffer_load_dwordx4 v65, s[8:11], s32 offen lds
v_lshlrev_b32 v42, 16, v0
v_and_b32 v43, 0xffff0000, v0
v_cvt_pk_f16_f32 v0, v42, v43
v_lshlrev_b32 v44, 16, v1
v_and_b32 v45, 0xffff0000, v1
v_cvt_pk_f16_f32 v1, v44, v45
v_lshlrev_b32 v42, 16, v2
v_and_b32 v43, 0xffff0000, v2
v_cvt_pk_f16_f32 v2, v42, v43
v_lshlrev_b32 v44, 16, v3
v_and_b32 v45, 0xffff0000, v3
v_cvt_pk_f16_f32 v3, v44, v45
v_lshlrev_b32 v42, 16, v4
v_and_b32 v43, 0xffff0000, v4
v_cvt_pk_f16_f32 v4, v42, v43
v_lshlrev_b32 v44, 16, v5
v_and_b32 v45, 0xffff0000, v5
v_cvt_pk_f16_f32 v5, v44, v45
v_lshlrev_b32 v42, 16, v6
v_and_b32 v43, 0xffff0000, v6
v_cvt_pk_f16_f32 v6, v42, v43
v_lshlrev_b32 v44, 16, v7
v_and_b32 v45, 0xffff0000, v7
v_cvt_pk_f16_f32 v7, v44, v45
v_accvgpr_write_b32 a8, v0
v_accvgpr_write_b32 a9, v1
v_accvgpr_write_b32 a10, v2
v_accvgpr_write_b32 a11, v3
v_accvgpr_write_b32 a12, v4
v_accvgpr_write_b32 a13, v5
v_accvgpr_write_b32 a14, v6
v_accvgpr_write_b32 a15, v7
v_lshlrev_b32 v42, 16, v8
v_and_b32 v43, 0xffff0000, v8
v_cvt_pk_f16_f32 v8, v42, v43
v_lshlrev_b32 v44, 16, v9
v_and_b32 v45, 0xffff0000, v9
v_cvt_pk_f16_f32 v9, v44, v45
v_lshlrev_b32 v42, 16, v10
v_and_b32 v43, 0xffff0000, v10
v_cvt_pk_f16_f32 v10, v42, v43
v_lshlrev_b32 v44, 16, v11
v_and_b32 v45, 0xffff0000, v11
v_cvt_pk_f16_f32 v11, v44, v45
v_lshlrev_b32 v42, 16, v12
v_and_b32 v43, 0xffff0000, v12
v_cvt_pk_f16_f32 v12, v42, v43
v_lshlrev_b32 v44, 16, v13
v_and_b32 v45, 0xffff0000, v13
v_cvt_pk_f16_f32 v13, v44, v45
v_lshlrev_b32 v42, 16, v14
v_and_b32 v43, 0xffff0000, v14
v_cvt_pk_f16_f32 v14, v42, v43
v_lshlrev_b32 v44, 16, v15
v_and_b32 v45, 0xffff0000, v15
v_cvt_pk_f16_f32 v15, v44, v45
v_accvgpr_write_b32 a40, v8
v_accvgpr_write_b32 a41, v9
v_accvgpr_write_b32 a42, v10
v_accvgpr_write_b32 a43, v11
v_accvgpr_write_b32 a44, v12
v_accvgpr_write_b32 a45, v13
v_accvgpr_write_b32 a46, v14
v_accvgpr_write_b32 a47, v15
v_lshlrev_b32 v42, 16, v16
v_and_b32 v43, 0xffff0000, v16
v_cvt_pk_f16_f32 v16, v42, v43
v_lshlrev_b32 v44, 16, v17
v_and_b32 v45, 0xffff0000, v17
v_cvt_pk_f16_f32 v17, v44, v45
v_lshlrev_b32 v42, 16, v18
v_and_b32 v43, 0xffff0000, v18
v_cvt_pk_f16_f32 v18, v42, v43
v_lshlrev_b32 v44, 16, v19
v_and_b32 v45, 0xffff0000, v19
v_cvt_pk_f16_f32 v19, v44, v45
v_lshlrev_b32 v42, 16, v20
v_and_b32 v43, 0xffff0000, v20
v_cvt_pk_f16_f32 v20, v42, v43
v_lshlrev_b32 v44, 16, v21
v_and_b32 v45, 0xffff0000, v21
v_cvt_pk_f16_f32 v21, v44, v45
v_lshlrev_b32 v42, 16, v22
v_and_b32 v43, 0xffff0000, v22
v_cvt_pk_f16_f32 v22, v42, v43
v_lshlrev_b32 v44, 16, v23
v_and_b32 v45, 0xffff0000, v23
v_cvt_pk_f16_f32 v23, v44, v45
v_accvgpr_write_b32 a72, v16
v_accvgpr_write_b32 a73, v17
v_accvgpr_write_b32 a74, v18
v_accvgpr_write_b32 a75, v19
v_accvgpr_write_b32 a76, v20
v_accvgpr_write_b32 a77, v21
v_accvgpr_write_b32 a78, v22
v_accvgpr_write_b32 a79, v23
v_lshlrev_b32 v42, 16, v24
v_and_b32 v43, 0xffff0000, v24
v_cvt_pk_f16_f32 v24, v42, v43
v_lshlrev_b32 v44, 16, v25
v_and_b32 v45, 0xffff0000, v25
v_cvt_pk_f16_f32 v25, v44, v45
v_lshlrev_b32 v42, 16, v26
v_and_b32 v43, 0xffff0000, v26
v_cvt_pk_f16_f32 v26, v42, v43
v_lshlrev_b32 v44, 16, v27
v_and_b32 v45, 0xffff0000, v27
v_cvt_pk_f16_f32 v27, v44, v45
v_lshlrev_b32 v42, 16, v28
v_and_b32 v43, 0xffff0000, v28
v_cvt_pk_f16_f32 v28, v42, v43
v_lshlrev_b32 v44, 16, v29
v_and_b32 v45, 0xffff0000, v29
v_cvt_pk_f16_f32 v29, v44, v45
v_lshlrev_b32 v42, 16, v30
v_and_b32 v43, 0xffff0000, v30
v_cvt_pk_f16_f32 v30, v42, v43
v_lshlrev_b32 v44, 16, v31
v_and_b32 v45, 0xffff0000, v31
v_cvt_pk_f16_f32 v31, v44, v45
v_accvgpr_write_b32 a104, v24
v_accvgpr_write_b32 a105, v25
v_accvgpr_write_b32 a106, v26
v_accvgpr_write_b32 a107, v27
v_accvgpr_write_b32 a108, v28
v_accvgpr_write_b32 a109, v29
v_accvgpr_write_b32 a110, v30
v_accvgpr_write_b32 a111, v31
s_waitcnt vmcnt(24)
v_readlane_b32 s48, v72, 0
v_readlane_b32 s49, v72, 1
v_readlane_b32 s50, v72, 2
v_readlane_b32 s51, v72, 3
v_readlane_b32 s52, v72, 4
v_readlane_b32 s53, v72, 5
v_readlane_b32 s54, v72, 6
v_readlane_b32 s55, v72, 7
v_readlane_b32 s38, v72, 8
s_nop 3
s_add_u32 s33, s48, s49
s_add_u32 s33, s33, s50
s_add_u32 s33, s33, s51
s_add_u32 s33, s33, s52
s_add_u32 s33, s33, s53
s_add_u32 s33, s33, s54
s_add_u32 s33, s33, s55
s_cmp_ge_u32 s38, 4
s_cselect_b32 s33, s33, 0
s_cmp_ge_u32 s33, 256
s_cselect_b32 s38, 0, 1
s_barrier
ds_read_b64_tr_b16 v[0:1], v32 offset:16384
ds_read_b64_tr_b16 v[2:3], v32 offset:16640
ds_read_b64_tr_b16 v[4:5], v32 offset:20480
ds_read_b64_tr_b16 v[6:7], v32 offset:20736
ds_read_b64_tr_b16 v[8:9], v33 offset:16384
ds_read_b64_tr_b16 v[10:11], v33 offset:16640
ds_read_b64_tr_b16 v[12:13], v33 offset:20480
ds_read_b64_tr_b16 v[14:15], v33 offset:20736
ds_read_b64_tr_b16 v[16:17], v34 offset:16384
ds_read_b64_tr_b16 v[18:19], v34 offset:16640
ds_read_b64_tr_b16 v[20:21], v34 offset:20480
ds_read_b64_tr_b16 v[22:23], v34 offset:20736
ds_read_b64_tr_b16 v[24:25], v35 offset:16384
ds_read_b64_tr_b16 v[26:27], v35 offset:16640
ds_read_b64_tr_b16 v[28:29], v35 offset:20480
ds_read_b64_tr_b16 v[30:31], v35 offset:20736
s_waitcnt lgkmcnt(0)
s_barrier
s_xor_b32 s32, s35, 0x80000
s_add_u32 m0, s36, 16384
s_nop 0
buffer_load_dwordx4 v65, s[8:11], s32 offen lds
s_xor_b32 s32, s35, 0x88000
s_add_u32 m0, s36, 17408
s_nop 0
buffer_load_dwordx4 v65, s[8:11], s32 offen lds
s_xor_b32 s32, s35, 0x90000
s_add_u32 m0, s36, 18432
s_nop 0
buffer_load_dwordx4 v65, s[8:11], s32 offen lds
s_xor_b32 s32, s35, 0x98000
s_add_u32 m0, s36, 19456
s_nop 0
buffer_load_dwordx4 v65, s[8:11], s32 offen lds
s_xor_b32 s32, s35, 0xa0000
s_add_u32 m0, s36, 20480
s_nop 0
buffer_load_dwordx4 v65, s[8:11], s32 offen lds
s_xor_b32 s32, s35, 0xa8000
s_add_u32 m0, s36, 21504
s_nop 0
buffer_load_dwordx4 v65, s[8:11], s32 offen lds
s_xor_b32 s32, s35, 0xb0000
s_add_u32 m0, s36, 22528
s_nop 0
buffer_load_dwordx4 v65, s[8:11], s32 offen lds
s_xor_b32 s32, s35, 0xb8000
s_add_u32 m0, s36, 23552
s_nop 0
buffer_load_dwordx4 v65, s[8:11], s32 offen lds
v_lshlrev_b32 v42, 16, v0
v_and_b32 v43, 0xffff0000, v0
v_cvt_pk_f16_f32 v0, v42, v43
v_lshlrev_b32 v44, 16, v1
v_and_b32 v45, 0xffff0000, v1
v_cvt_pk_f16_f32 v1, v44, v45
v_lshlrev_b32 v42, 16, v2
v_and_b32 v43, 0xffff0000, v2
v_cvt_pk_f16_f32 v2, v42, v43
v_lshlrev_b32 v44, 16, v3
v_and_b32 v45, 0xffff0000, v3
v_cvt_pk_f16_f32 v3, v44, v45
v_lshlrev_b32 v42, 16, v4
v_and_b32 v43, 0xffff0000, v4
v_cvt_pk_f16_f32 v4, v42, v43
v_lshlrev_b32 v44, 16, v5
v_and_b32 v45, 0xffff0000, v5
v_cvt_pk_f16_f32 v5, v44, v45
v_lshlrev_b32 v42, 16, v6
v_and_b32 v43, 0xffff0000, v6
v_cvt_pk_f16_f32 v6, v42, v43
v_lshlrev_b32 v44, 16, v7
v_and_b32 v45, 0xffff0000, v7
v_cvt_pk_f16_f32 v7, v44, v45
v_accvgpr_write_b32 a16, v0
v_accvgpr_write_b32 a17, v1
v_accvgpr_write_b32 a18, v2
v_accvgpr_write_b32 a19, v3
v_accvgpr_write_b32 a20, v4
v_accvgpr_write_b32 a21, v5
v_accvgpr_write_b32 a22, v6
v_accvgpr_write_b32 a23, v7
v_lshlrev_b32 v42, 16, v8
v_and_b32 v43, 0xffff0000, v8
v_cvt_pk_f16_f32 v8, v42, v43
v_lshlrev_b32 v44, 16, v9
v_and_b32 v45, 0xffff0000, v9
v_cvt_pk_f16_f32 v9, v44, v45
v_lshlrev_b32 v42, 16, v10
v_and_b32 v43, 0xffff0000, v10
v_cvt_pk_f16_f32 v10, v42, v43
v_lshlrev_b32 v44, 16, v11
v_and_b32 v45, 0xffff0000, v11
v_cvt_pk_f16_f32 v11, v44, v45
v_lshlrev_b32 v42, 16, v12
v_and_b32 v43, 0xffff0000, v12
v_cvt_pk_f16_f32 v12, v42, v43
v_lshlrev_b32 v44, 16, v13
v_and_b32 v45, 0xffff0000, v13
v_cvt_pk_f16_f32 v13, v44, v45
v_lshlrev_b32 v42, 16, v14
v_and_b32 v43, 0xffff0000, v14
v_cvt_pk_f16_f32 v14, v42, v43
v_lshlrev_b32 v44, 16, v15
v_and_b32 v45, 0xffff0000, v15
v_cvt_pk_f16_f32 v15, v44, v45
v_accvgpr_write_b32 a48, v8
v_accvgpr_write_b32 a49, v9
v_accvgpr_write_b32 a50, v10
v_accvgpr_write_b32 a51, v11
v_accvgpr_write_b32 a52, v12
v_accvgpr_write_b32 a53, v13
v_accvgpr_write_b32 a54, v14
v_accvgpr_write_b32 a55, v15
v_lshlrev_b32 v42, 16, v16
v_and_b32 v43, 0xffff0000, v16
v_cvt_pk_f16_f32 v16, v42, v43
v_lshlrev_b32 v44, 16, v17
v_and_b32 v45, 0xffff0000, v17
v_cvt_pk_f16_f32 v17, v44, v45
v_lshlrev_b32 v42, 16, v18
v_and_b32 v43, 0xffff0000, v18
v_cvt_pk_f16_f32 v18, v42, v43
v_lshlrev_b32 v44, 16, v19
v_and_b32 v45, 0xffff0000, v19
v_cvt_pk_f16_f32 v19, v44, v45
v_lshlrev_b32 v42, 16, v20
v_and_b32 v43, 0xffff0000, v20
v_cvt_pk_f16_f32 v20, v42, v43
v_lshlrev_b32 v44, 16, v21
v_and_b32 v45, 0xffff0000, v21
v_cvt_pk_f16_f32 v21, v44, v45
v_lshlrev_b32 v42, 16, v22
v_and_b32 v43, 0xffff0000, v22
v_cvt_pk_f16_f32 v22, v42, v43
v_lshlrev_b32 v44, 16, v23
v_and_b32 v45, 0xffff0000, v23
v_cvt_pk_f16_f32 v23, v44, v45
v_accvgpr_write_b32 a80, v16
v_accvgpr_write_b32 a81, v17
v_accvgpr_write_b32 a82, v18
v_accvgpr_write_b32 a83, v19
v_accvgpr_write_b32 a84, v20
v_accvgpr_write_b32 a85, v21
v_accvgpr_write_b32 a86, v22
v_accvgpr_write_b32 a87, v23
v_lshlrev_b32 v42, 16, v24
v_and_b32 v43, 0xffff0000, v24
v_cvt_pk_f16_f32 v24, v42, v43
v_lshlrev_b32 v44, 16, v25
v_and_b32 v45, 0xffff0000, v25
v_cvt_pk_f16_f32 v25, v44, v45
v_lshlrev_b32 v42, 16, v26
v_and_b32 v43, 0xffff0000, v26
v_cvt_pk_f16_f32 v26, v42, v43
v_lshlrev_b32 v44, 16, v27
v_and_b32 v45, 0xffff0000, v27
v_cvt_pk_f16_f32 v27, v44, v45
v_lshlrev_b32 v42, 16, v28
v_and_b32 v43, 0xffff0000, v28
v_cvt_pk_f16_f32 v28, v42, v43
v_lshlrev_b32 v44, 16, v29
v_and_b32 v45, 0xffff0000, v29
v_cvt_pk_f16_f32 v29, v44, v45
v_lshlrev_b32 v42, 16, v30
v_and_b32 v43, 0xffff0000, v30
v_cvt_pk_f16_f32 v30, v42, v43
v_lshlrev_b32 v44, 16, v31
v_and_b32 v45, 0xffff0000, v31
v_cvt_pk_f16_f32 v31, v44, v45
v_accvgpr_write_b32 a112, v24
v_accvgpr_write_b32 a113, v25
v_accvgpr_write_b32 a114, v26
v_accvgpr_write_b32 a115, v27
v_accvgpr_write_b32 a116, v28
v_accvgpr_write_b32 a117, v29
v_accvgpr_write_b32 a118, v30
v_accvgpr_write_b32 a119, v31
s_waitcnt vmcnt(24)
s_barrier
ds_read_b64_tr_b16 v[0:1], v32 offset:24576
ds_read_b64_tr_b16 v[2:3], v32 offset:24832
ds_read_b64_tr_b16 v[4:5], v32 offset:28672
ds_read_b64_tr_b16 v[6:7], v32 offset:28928
ds_read_b64_tr_b16 v[8:9], v33 offset:24576
ds_read_b64_tr_b16 v[10:11], v33 offset:24832
ds_read_b64_tr_b16 v[12:13], v33 offset:28672
ds_read_b64_tr_b16 v[14:15], v33 offset:28928
ds_read_b64_tr_b16 v[16:17], v34 offset:24576
ds_read_b64_tr_b16 v[18:19], v34 offset:24832
ds_read_b64_tr_b16 v[20:21], v34 offset:28672
ds_read_b64_tr_b16 v[22:23], v34 offset:28928
ds_read_b64_tr_b16 v[24:25], v35 offset:24576
ds_read_b64_tr_b16 v[26:27], v35 offset:24832
ds_read_b64_tr_b16 v[28:29], v35 offset:28672
ds_read_b64_tr_b16 v[30:31], v35 offset:28928
s_waitcnt lgkmcnt(0)
s_barrier
s_xor_b32 s32, s35, 0xc0000
s_add_u32 m0, s36, 24576
s_nop 0
buffer_load_dwordx4 v65, s[8:11], s32 offen lds
s_xor_b32 s32, s35, 0xc8000
s_add_u32 m0, s36, 25600
s_nop 0
buffer_load_dwordx4 v65, s[8:11], s32 offen lds
s_xor_b32 s32, s35, 0xd0000
s_add_u32 m0, s36, 26624
s_nop 0
buffer_load_dwordx4 v65, s[8:11], s32 offen lds
s_xor_b32 s32, s35, 0xd8000
s_add_u32 m0, s36, 27648
s_nop 0
buffer_load_dwordx4 v65, s[8:11], s32 offen lds
s_xor_b32 s32, s35, 0xe0000
s_add_u32 m0, s36, 28672
s_nop 0
buffer_load_dwordx4 v65, s[8:11], s32 offen lds
s_xor_b32 s32, s35, 0xe8000
s_add_u32 m0, s36, 29696
s_nop 0
buffer_load_dwordx4 v65, s[8:11], s32 offen lds
s_xor_b32 s32, s35, 0xf0000
s_add_u32 m0, s36, 30720
s_nop 0
buffer_load_dwordx4 v65, s[8:11], s32 offen lds
s_xor_b32 s32, s35, 0xf8000
s_add_u32 m0, s36, 31744
s_nop 0
buffer_load_dwordx4 v65, s[8:11], s32 offen lds
v_lshlrev_b32 v42, 16, v0
v_and_b32 v43, 0xffff0000, v0
v_cvt_pk_f16_f32 v0, v42, v43
v_lshlrev_b32 v44, 16, v1
v_and_b32 v45, 0xffff0000, v1
v_cvt_pk_f16_f32 v1, v44, v45
v_lshlrev_b32 v42, 16, v2
v_and_b32 v43, 0xffff0000, v2
v_cvt_pk_f16_f32 v2, v42, v43
v_lshlrev_b32 v44, 16, v3
v_and_b32 v45, 0xffff0000, v3
v_cvt_pk_f16_f32 v3, v44, v45
v_lshlrev_b32 v42, 16, v4
v_and_b32 v43, 0xffff0000, v4
v_cvt_pk_f16_f32 v4, v42, v43
v_lshlrev_b32 v44, 16, v5
v_and_b32 v45, 0xffff0000, v5
v_cvt_pk_f16_f32 v5, v44, v45
v_lshlrev_b32 v42, 16, v6
v_and_b32 v43, 0xffff0000, v6
v_cvt_pk_f16_f32 v6, v42, v43
v_lshlrev_b32 v44, 16, v7
v_and_b32 v45, 0xffff0000, v7
v_cvt_pk_f16_f32 v7, v44, v45
v_accvgpr_write_b32 a24, v0
v_accvgpr_write_b32 a25, v1
v_accvgpr_write_b32 a26, v2
v_accvgpr_write_b32 a27, v3
v_accvgpr_write_b32 a28, v4
v_accvgpr_write_b32 a29, v5
v_accvgpr_write_b32 a30, v6
v_accvgpr_write_b32 a31, v7
v_lshlrev_b32 v42, 16, v8
v_and_b32 v43, 0xffff0000, v8
v_cvt_pk_f16_f32 v8, v42, v43
v_lshlrev_b32 v44, 16, v9
v_and_b32 v45, 0xffff0000, v9
v_cvt_pk_f16_f32 v9, v44, v45
v_lshlrev_b32 v42, 16, v10
v_and_b32 v43, 0xffff0000, v10
v_cvt_pk_f16_f32 v10, v42, v43
v_lshlrev_b32 v44, 16, v11
v_and_b32 v45, 0xffff0000, v11
v_cvt_pk_f16_f32 v11, v44, v45
v_lshlrev_b32 v42, 16, v12
v_and_b32 v43, 0xffff0000, v12
v_cvt_pk_f16_f32 v12, v42, v43
v_lshlrev_b32 v44, 16, v13
v_and_b32 v45, 0xffff0000, v13
v_cvt_pk_f16_f32 v13, v44, v45
v_lshlrev_b32 v42, 16, v14
v_and_b32 v43, 0xffff0000, v14
v_cvt_pk_f16_f32 v14, v42, v43
v_lshlrev_b32 v44, 16, v15
v_and_b32 v45, 0xffff0000, v15
v_cvt_pk_f16_f32 v15, v44, v45
v_accvgpr_write_b32 a56, v8
v_accvgpr_write_b32 a57, v9
v_accvgpr_write_b32 a58, v10
v_accvgpr_write_b32 a59, v11
v_accvgpr_write_b32 a60, v12
v_accvgpr_write_b32 a61, v13
v_accvgpr_write_b32 a62, v14
v_accvgpr_write_b32 a63, v15
v_lshlrev_b32 v42, 16, v16
v_and_b32 v43, 0xffff0000, v16
v_cvt_pk_f16_f32 v16, v42, v43
v_lshlrev_b32 v44, 16, v17
v_and_b32 v45, 0xffff0000, v17
v_cvt_pk_f16_f32 v17, v44, v45
v_lshlrev_b32 v42, 16, v18
v_and_b32 v43, 0xffff0000, v18
v_cvt_pk_f16_f32 v18, v42, v43
v_lshlrev_b32 v44, 16, v19
v_and_b32 v45, 0xffff0000, v19
v_cvt_pk_f16_f32 v19, v44, v45
v_lshlrev_b32 v42, 16, v20
v_and_b32 v43, 0xffff0000, v20
v_cvt_pk_f16_f32 v20, v42, v43
v_lshlrev_b32 v44, 16, v21
v_and_b32 v45, 0xffff0000, v21
v_cvt_pk_f16_f32 v21, v44, v45
v_lshlrev_b32 v42, 16, v22
v_and_b32 v43, 0xffff0000, v22
v_cvt_pk_f16_f32 v22, v42, v43
v_lshlrev_b32 v44, 16, v23
v_and_b32 v45, 0xffff0000, v23
v_cvt_pk_f16_f32 v23, v44, v45
v_accvgpr_write_b32 a88, v16
v_accvgpr_write_b32 a89, v17
v_accvgpr_write_b32 a90, v18
v_accvgpr_write_b32 a91, v19
v_accvgpr_write_b32 a92, v20
v_accvgpr_write_b32 a93, v21
v_accvgpr_write_b32 a94, v22
v_accvgpr_write_b32 a95, v23
v_lshlrev_b32 v42, 16, v24
v_and_b32 v43, 0xffff0000, v24
v_cvt_pk_f16_f32 v24, v42, v43
v_lshlrev_b32 v44, 16, v25
v_and_b32 v45, 0xffff0000, v25
v_cvt_pk_f16_f32 v25, v44, v45
v_lshlrev_b32 v42, 16, v26
v_and_b32 v43, 0xffff0000, v26
v_cvt_pk_f16_f32 v26, v42, v43
v_lshlrev_b32 v44, 16, v27
v_and_b32 v45, 0xffff0000, v27
v_cvt_pk_f16_f32 v27, v44, v45
v_lshlrev_b32 v42, 16, v28
v_and_b32 v43, 0xffff0000, v28
v_cvt_pk_f16_f32 v28, v42, v43
v_lshlrev_b32 v44, 16, v29
v_and_b32 v45, 0xffff0000, v29
v_cvt_pk_f16_f32 v29, v44, v45
v_lshlrev_b32 v42, 16, v30
v_and_b32 v43, 0xffff0000, v30
v_cvt_pk_f16_f32 v30, v42, v43
v_lshlrev_b32 v44, 16, v31
v_and_b32 v45, 0xffff0000, v31
v_cvt_pk_f16_f32 v31, v44, v45
v_accvgpr_write_b32 a120, v24
v_accvgpr_write_b32 a121, v25
v_accvgpr_write_b32 a122, v26
v_accvgpr_write_b32 a123, v27
v_accvgpr_write_b32 a124, v28
v_accvgpr_write_b32 a125, v29
v_accvgpr_write_b32 a126, v30
v_accvgpr_write_b32 a127, v31
v_and_b32 v64, 15, v94
v_lshrrev_b32 v65, 4, v94
v_bfe_u32 v126, v94, 4, 1
v_lshlrev_b32 v126, 2, v126
v_sub_u32 v126, v64, v126
v_mov_b32 v66, 0x3f80
v_mov_b32 v67, 0x3f800000
s_and_b32 s33, s14, 1
s_lshl_b32 s32, s33, 3
v_subrev_u32 v71, s32, v126
v_lshrrev_b32 v70, 3, v64
v_and_b32 v69, 5, v64
v_lshl_add_u32 v69, v70, 1, v69
v_sub_u32 v126, v126, v64
v_add_u32 v126, v126, v69
v_and_b32 v70, 2, v64
v_lshl_add_u32 v126, v70, 4, v126
v_cmp_eq_u32 vcc, 32, v126
s_nop 1
v_cndmask_b32 v127, 0, v66, vcc
v_cmp_eq_u32 vcc, 33, v126
s_nop 1
v_cndmask_b32 v104, v127, v67, vcc
v_mov_b32 v106, v104
v_cmp_eq_u32 vcc, 34, v126
s_nop 1
v_cndmask_b32 v127, 0, v66, vcc
v_cmp_eq_u32 vcc, 35, v126
s_nop 1
v_cndmask_b32 v105, v127, v67, vcc
v_mov_b32 v107, v105
v_cmp_eq_u32 vcc, 0, v126
s_nop 1
v_cndmask_b32 v127, 0, v66, vcc
v_cmp_eq_u32 vcc, 1, v126
s_nop 1
v_cndmask_b32 v108, v127, v67, vcc
v_mov_b32 v110, v108
v_mov_b32 v106, v108
v_cmp_eq_u32 vcc, 2, v126
s_nop 1
v_cndmask_b32 v127, 0, v66, vcc
v_cmp_eq_u32 vcc, 3, v126
s_nop 1
v_cndmask_b32 v109, v127, v67, vcc
v_mov_b32 v111, v109
v_mov_b32 v107, v109
v_mov_b32 v127, 0x4444
v_mov_b32 v95, 0xeeee
v_cmp_gt_u32 vcc, 8, v64
s_nop 1
v_cndmask_b32 v112, v95, v127, vcc
v_lshrrev_b32 v126, 1, v65
v_lshlrev_b32 v126, 7, v126
v_lshl_add_u32 v126, v64, 4, v126
v_and_b32 v127, 1, v65
v_lshl_add_u32 v126, v127, 3, v126
v_mov_b32 v95, 0x7f000000
v_cndmask_b32 v118, v95, v126, vcc
v_lshlrev_b32 v126, 3, v64
v_lshl_add_u32 v126, v127, 7, v126
v_cmp_le_u32 vcc, 2, v65
s_nop 1
v_cndmask_b32 v120, v95, v126, vcc
v_mov_b32 v126, 0xf149f2ca
v_cndmask_b32 v124, v126, 0, vcc
v_lshrrev_b32 v126, 3, v64
v_cmp_eq_u32 vcc, s33, v126
v_and_b32 v126, 7, v64
v_lshlrev_b32 v126, 4, v126
v_lshl_add_u32 v126, v65, 7, v126
v_cndmask_b32 v117, v95, v116, vcc
v_cndmask_b32 v119, v95, v126, vcc
s_lshl_b32 s32, s14, 11
v_add_u32 v114, s32, v116
s_lshr_b32 s32, s14, 1
s_lshl_b32 s32, s32, 10
s_lshl_b32 s33, s33, 3
s_add_u32 s32, s32, s33
v_add_u32 v115, s32, v116
v_lshrrev_b32 v126, 3, v64
v_lshl_add_u32 v125, v126, 11, v116
v_lshrrev_b32 v71, 1, v65
v_cmp_ne_u32 vcc, 0, v70
v_lshlrev_b32 v126, 4, v64
v_lshl_add_u32 v126, v127, 8, v126
v_lshl_add_u32 v117, v71, 3, v126
v_lshrrev_b32 v120, 1, v117
v_lshlrev_b32 v69, 4, v69
v_lshl_add_u32 v126, v127, 7, v69
v_lshl_add_u32 v126, v71, 3, v126
v_cndmask_b32 v119, v126, v95, vcc
v_lshl_add_u32 v126, v71, 7, v69
v_lshl_add_u32 v126, v127, 3, v126
v_cndmask_b32 v125, v126, v95, vcc
v_cndmask_b32 v118, v95, v126, vcc
s_mov_b32 s17, 0
s_lshl_b32 s32, s12, 14
s_lshl_b32 s33, s14, 12
s_add_u32 s18, s32, s33
s_xor_b32 s33, s14, s13
s_and_b32 s33, s33, 3
s_lshl_b32 s33, s33, 10
s_add_u32 s18, s18, s33
s_xor_b32 s19, s18, 0x4000
s_add_u32 s18, s18, 0x6c30000
s_add_u32 s19, s19, 0x6c38000
s_lshl_b32 s20, s15, 12
s_add_u32 s20, s20, 0x6c00000
s_lshl_b32 s32, s16, 11
s_lshl_b32 s33, s14, 9
s_add_u32 s32, s32, s33
s_add_u32 s21, s20, s32
s_lshl_b32 s32, s16, 11
s_xor_b32 s32, s32, 2048
s_add_u32 s20, s20, s32
s_lshl_b32 s32, s12, 15
s_add_u32 s32, s32, 0x6c20000
s_lshl_b32 s33, s13, 10
s_add_u32 s22, s32, s33
s_lshl_b32 s33, s14, 8
s_add_u32 s22, s22, s33
s_lshl_b32 s33, s14, 13
s_add_u32 s23, s32, s33
s_add_u32 s24, s23, 4096
s_xor_b32 s33, s14, s13
s_and_b32 s33, s33, 7
s_lshl_b32 s33, s33, 10
s_add_u32 s23, s23, s33
s_lshl_b32 s32, s12, 14
s_lshl_b32 s33, s13, 9
s_add_u32 s32, s32, s33
s_bitcmp1_b32 s14, 0
s_cselect_b32 s33, 256, 0
s_add_u32 s32, s32, s33
s_add_u32 s25, s32, 0x6c30000
s_lshl_b32 s32, s16, 6
s_lshl_b32 s33, s14, 4
s_add_u32 s32, s32, s33
s_lshl_b32 s33, s15, 7
s_add_u32 s32, s32, s33
s_lshl_b32 s26, s32, 4
s_add_u32 s26, s26, 0x6e00000
s_lshl_b32 s37, s15, 2
s_lshl_b32 s33, s16, 1
s_add_u32 s37, s37, s33
s_lshr_b32 s33, s14, 1
s_add_u32 s37, s37, s33
s_lshl_b32 s37, s37, 9
s_add_u32 s37, s37, 0x8000000
s_bitcmp1_b32 s14, 0
s_cselect_b32 s33, 256, 0
s_add_u32 s37, s37, s33
s_lshl_b32 s28, s32, 6
s_add_u32 s28, s28, 0x2800000
s_lshl_b32 s27, s15, 12
s_lshl_b32 s36, s14, 11
s_and_b32 s33, s36, 2048
s_lshl_b32 s32, s16, 11
s_xor_b32 s33, s33, s32
s_add_u32 s27, s27, s33
s_lshr_b32 s33, s14, 1
s_lshl_b32 s33, s33, 17
s_add_u32 s27, s27, s33
s_add_u32 s27, s27, 0x1800000
s_add_u32 s36, s36, 24576
s_mov_b32 s30, 0x3e0293ee
s_mov_b32 s31, 0xbe0293ee
v_mov_b32 v100, 0x3f803f80
v_mov_b32 v101, 0x3f803f80
v_mov_b32 v102, 0x3f803f80
v_mov_b32 v103, 0x3f803f80
v_mov_b32 v121, 0x7f000000
v_mov_b32 v122, 0
v_and_b32 v127, 1, v94
v_mov_b32 v77, 0x7f000000
s_lshl_b32 s32, s16, 3
s_lshl_b64 exec, 0xff, s32
s_add_u32 s32, s27, 0x40000
v_lshl_add_u32 v121, v64, 7, s32
v_mov_b32 v122, 0x40000
s_mov_b32 exec_lo, 0xff0000
s_add_u32 s32, s28, 0x40000
v_lshl_add_u32 v121, v64, 7, s32
v_mov_b32 v122, 0x40000
s_mov_b32 exec_lo, 0x000f000f
s_mov_b32 exec_hi, 0x000f000f
s_and_b32 s33, s14, 1
s_lshl_b32 s33, s33, 7
s_add_u32 s32, s21, s33
v_lshl_add_u32 v77, v64, 7, s21
s_mov_b32 exec_lo, 0x00300030
s_mov_b32 exec_hi, 0x00300030
v_lshl_add_u32 v77, v127, 7, s22
s_mov_b32 exec_lo, 0x00400040
s_mov_b32 exec_hi, 0x00400040
s_lshl_b32 s32, s12, 14
s_lshl_b32 s33, s13, 9
s_add_u32 s33, s32, s33
s_add_u32 s33, s33, 0x6c30000
s_andn2_b32 s3, s33, 0x3ff
s_andn2_b32 s34, s22, 0x3ff
s_cmp_eq_u32 s14, 1
s_cselect_b32 s3, s34, s3
s_bitcmp0_b32 s14, 0
s_cselect_b32 s3, s21, s3
s_add_u32 s3, s3, 0x80000
s_lshl_b32 s34, s14, 7
s_add_u32 s33, s33, s34
v_mov_b32 v77, s33
s_mov_b32 exec_lo, 0x00800080
s_mov_b32 exec_hi, 0x00800080
s_add_u32 s32, s32, s34
s_add_u32 s32, s32, 0x6c38000
v_mov_b32 v77, s32
s_mov_b64 exec, -1
v_lshl_add_u32 v77, v65, 18, v77
s_mov_b32 exec_lo, 0
s_mov_b32 exec_hi, 0x300
s_lshl_b32 s32, s15, 2
s_add_u32 s32, s32, 0x8406000
v_lshl_add_u32 v121, v127, 13, s32
s_mov_b32 exec_hi, 0x3c00
s_mov_b32 s32, 0x8418158
v_lshl_add_u32 v121, v64, 2, s32
s_mov_b32 exec_hi, 0x3f00
v_mov_b32 v122, 128
s_mov_b64 exec, -1
s_lshl_b32 s32, s15, 3
s_lshl_b32 s33, s16, 2
s_add_u32 s32, s32, s33
s_add_u32 s32, s32, s14
s_mov_b32 s39, 0x7f000000
s_cmp_eq_u32 s32, 2
s_cselect_b32 s39, 0x841ec00, s39
s_waitcnt vmcnt(24)
ds_read_b64_tr_b16 v[0:1], v68 offset:0
ds_read_b64_tr_b16 v[2:3], v68 offset:128
ds_read_b64_tr_b16 v[4:5], v68 offset:2048
ds_read_b64_tr_b16 v[6:7], v68 offset:2176
ds_read_b64_tr_b16 v[8:9], v68 offset:32
ds_read_b64_tr_b16 v[10:11], v68 offset:160
ds_read_b64_tr_b16 v[12:13], v68 offset:2080
ds_read_b64_tr_b16 v[14:15], v68 offset:2208
ds_read_b64_tr_b16 v[16:17], v68 offset:4096
ds_read_b64_tr_b16 v[18:19], v68 offset:4224
ds_read_b64_tr_b16 v[20:21], v68 offset:6144
ds_read_b64_tr_b16 v[22:23], v68 offset:6272
ds_read_b64_tr_b16 v[24:25], v68 offset:4128
ds_read_b64_tr_b16 v[26:27], v68 offset:4256
ds_read_b64_tr_b16 v[28:29], v68 offset:6176
ds_read_b64_tr_b16 v[30:31], v68 offset:6304
s_waitcnt lgkmcnt(0)
ds_write_b128 v113, v[0:3] offset:0
ds_write_b128 v113, v[4:7] offset:1024
ds_write_b128 v113, v[8:11] offset:2048
ds_write_b128 v113, v[12:15] offset:3072
ds_write_b128 v113, v[16:19] offset:4096
ds_write_b128 v113, v[20:23] offset:5120
ds_write_b128 v113, v[24:27] offset:6144
ds_write_b128 v113, v[28:31] offset:7168
s_waitcnt lgkmcnt(0)
s_waitcnt vmcnt(16)
ds_read_b64_tr_b16 v[0:1], v68 offset:8192
ds_read_b64_tr_b16 v[2:3], v68 offset:8320
ds_read_b64_tr_b16 v[4:5], v68 offset:10240
ds_read_b64_tr_b16 v[6:7], v68 offset:10368
ds_read_b64_tr_b16 v[8:9], v68 offset:8224
ds_read_b64_tr_b16 v[10:11], v68 offset:8352
ds_read_b64_tr_b16 v[12:13], v68 offset:10272
ds_read_b64_tr_b16 v[14:15], v68 offset:10400
ds_read_b64_tr_b16 v[16:17], v68 offset:12288
ds_read_b64_tr_b16 v[18:19], v68 offset:12416
ds_read_b64_tr_b16 v[20:21], v68 offset:14336
ds_read_b64_tr_b16 v[22:23], v68 offset:14464
ds_read_b64_tr_b16 v[24:25], v68 offset:12320
ds_read_b64_tr_b16 v[26:27], v68 offset:12448
ds_read_b64_tr_b16 v[28:29], v68 offset:14368
ds_read_b64_tr_b16 v[30:31], v68 offset:14496
s_waitcnt lgkmcnt(0)
ds_write_b128 v113, v[0:3] offset:8192
ds_write_b128 v113, v[4:7] offset:9216
ds_write_b128 v113, v[8:11] offset:10240
ds_write_b128 v113, v[12:15] offset:11264
ds_write_b128 v113, v[16:19] offset:12288
ds_write_b128 v113, v[20:23] offset:13312
ds_write_b128 v113, v[24:27] offset:14336
ds_write_b128 v113, v[28:31] offset:15360
s_waitcnt lgkmcnt(0)
s_waitcnt vmcnt(8)
buffer_load_dword v76, v74, s[4:7], 0 offen sc1
buffer_load_dword v79, v75, s[4:7], 0 offen sc1
ds_read_b64_tr_b16 v[0:1], v68 offset:16384
ds_read_b64_tr_b16 v[2:3], v68 offset:16512
ds_read_b64_tr_b16 v[4:5], v68 offset:18432
ds_read_b64_tr_b16 v[6:7], v68 offset:18560
ds_read_b64_tr_b16 v[8:9], v68 offset:16416
ds_read_b64_tr_b16 v[10:11], v68 offset:16544
ds_read_b64_tr_b16 v[12:13], v68 offset:18464
ds_read_b64_tr_b16 v[14:15], v68 offset:18592
ds_read_b64_tr_b16 v[16:17], v68 offset:20480
ds_read_b64_tr_b16 v[18:19], v68 offset:20608
ds_read_b64_tr_b16 v[20:21], v68 offset:22528
ds_read_b64_tr_b16 v[22:23], v68 offset:22656
ds_read_b64_tr_b16 v[24:25], v68 offset:20512
ds_read_b64_tr_b16 v[26:27], v68 offset:20640
ds_read_b64_tr_b16 v[28:29], v68 offset:22560
ds_read_b64_tr_b16 v[30:31], v68 offset:22688
s_waitcnt lgkmcnt(0)
ds_write_b128 v113, v[0:3] offset:16384
ds_write_b128 v113, v[4:7] offset:17408
ds_write_b128 v113, v[8:11] offset:18432
ds_write_b128 v113, v[12:15] offset:19456
ds_write_b128 v113, v[16:19] offset:20480
ds_write_b128 v113, v[20:23] offset:21504
ds_write_b128 v113, v[24:27] offset:22528
ds_write_b128 v113, v[28:31] offset:23552
s_waitcnt lgkmcnt(0)
s_waitcnt vmcnt(2)
s_waitcnt vmcnt(0)
v_min_u32 v76, v76, v79
v_cmp_eq_u32 vcc, 0, v76
s_cmp_eq_u32 s38, 0
s_cbranch_scc0 main_kernel_c_sl0
s_cbranch_vccnz main_kernel_c_sl1
s_branch main_kernel_c_kv0_ok
main_kernel_c_sl0:
v_and_b32 v126, 7, v94
v_lshlrev_b32 v126, 5, v126
main_kernel_c_mode_cnt:
buffer_load_dword v127, v126, s[60:63], 0 offen sc1
s_waitcnt vmcnt(0)
v_readlane_b32 s48, v127, 0
v_readlane_b32 s49, v127, 1
v_readlane_b32 s50, v127, 2
v_readlane_b32 s51, v127, 3
v_readlane_b32 s52, v127, 4
v_readlane_b32 s53, v127, 5
v_readlane_b32 s54, v127, 6
v_readlane_b32 s55, v127, 7
s_nop 3
s_add_u32 s33, s48, s49
s_add_u32 s33, s33, s50
s_add_u32 s33, s33, s51
s_add_u32 s33, s33, s52
s_add_u32 s33, s33, s53
s_add_u32 s33, s33, s54
s_add_u32 s33, s33, s55
s_cmp_ge_u32 s33, 256
s_cbranch_scc1 main_kernel_c_mode_cnt_ok
s_sub_u32 s29, s29, 1
s_cbranch_scc1 main_kernel_end
s_sleep 4
s_branch main_kernel_c_mode_cnt
main_kernel_c_mode_cnt_ok:
v_mov_b32 v126, 0
main_kernel_c_wa:
buffer_load_dword v127, v126, s[60:63], 0 offen offset:12 sc1
s_waitcnt vmcnt(0)
v_cmp_gt_u32 vcc, 4, v127
s_cbranch_vccz main_kernel_c_wa_ok
s_sleep 4
s_sub_u32 s29, s29, 1
s_cbranch_scc0 main_kernel_c_wa
s_branch main_kernel_end
main_kernel_c_wa_ok:
main_kernel_c_sl1:
v_lshlrev_b32 v126, 2, v94
s_mov_b32 s32, 0x841f000
main_kernel_c_wf:
buffer_load_dword v0, v126, s[4:7], s32 offen sc1
s_waitcnt vmcnt(0)
v_cmp_eq_u32 vcc, 0, v0
s_cbranch_vccz main_kernel_c_wf_ok
s_sleep 4
s_sub_u32 s29, s29, 1
s_cbranch_scc0 main_kernel_c_wf
s_branch main_kernel_end
main_kernel_c_wf_ok:
s_mov_b32 exec_lo, 0
s_mov_b32 exec_hi, 0x300
v_subrev_u32 v127, 0, v121
main_kernel_c_kv0:
buffer_load_dword v126, v127, s[4:7], 0 offen sc1
s_waitcnt vmcnt(0)
v_cmp_eq_u32 vcc, 0, v126
s_cbranch_vccz main_kernel_c_kv0_ok
s_sleep 2
s_sub_u32 s29, s29, 1
s_cbranch_scc0 main_kernel_c_kv0
s_branch main_kernel_end
main_kernel_c_kv0_ok:
s_mov_b32 exec_lo, 0
s_mov_b32 exec_hi, 0x3f00
v_add_u32 v121, 128, v121
s_mov_b64 exec, -1
s_mov_b32 m0, s36
buffer_load_dwordx4 v[96:99], v116, s[4:7], s28 offen sc1
buffer_load_dwordx4 v116, s[4:7], s27 offen sc1 lds
buffer_load_dwordx4 v116, s[4:7], s27 offen offset:1024 sc1 lds
s_add_u32 s27, s27, 0x40000
s_lshl_b32 s32, s13, 8
s_add_u32 s32, s32, 0x8c08000
v_writelane_b32 v77, s37, 8
v_writelane_b32 v77, s26, 9
v_writelane_b32 v77, s28, 10
v_writelane_b32 v77, s32, 11
buffer_load_dword v123, v77, s[4:7], 0 offen sc1
ds_read_b64_tr_b16 v[0:1], v68 offset:24576
ds_read_b64_tr_b16 v[2:3], v68 offset:24704
ds_read_b64_tr_b16 v[4:5], v68 offset:26624
ds_read_b64_tr_b16 v[6:7], v68 offset:26752
ds_read_b64_tr_b16 v[8:9], v68 offset:24608
ds_read_b64_tr_b16 v[10:11], v68 offset:24736
ds_read_b64_tr_b16 v[12:13], v68 offset:26656
ds_read_b64_tr_b16 v[14:15], v68 offset:26784
ds_read_b64_tr_b16 v[16:17], v68 offset:28672
ds_read_b64_tr_b16 v[18:19], v68 offset:28800
ds_read_b64_tr_b16 v[20:21], v68 offset:30720
ds_read_b64_tr_b16 v[22:23], v68 offset:30848
ds_read_b64_tr_b16 v[24:25], v68 offset:28704
ds_read_b64_tr_b16 v[26:27], v68 offset:28832
ds_read_b64_tr_b16 v[28:29], v68 offset:30752
ds_read_b64_tr_b16 v[30:31], v68 offset:30880
s_waitcnt lgkmcnt(0)
ds_write_b128 v113, v[0:3] offset:24576
ds_write_b128 v113, v[4:7] offset:25600
ds_write_b128 v113, v[8:11] offset:26624
ds_write_b128 v113, v[12:15] offset:27648
ds_write_b128 v113, v[16:19] offset:28672
ds_write_b128 v113, v[20:23] offset:29696
ds_write_b128 v113, v[24:27] offset:30720
ds_write_b128 v113, v[28:31] offset:31744
s_waitcnt lgkmcnt(0)
main_kernel_c_nb:
v_readfirstlane_b32 s33, v84
v_readfirstlane_b32 s32, v85
s_nop 3
s_and_b32 s34, s32, s33
s_cbranch_scc1 main_kernel_c_nb_ok
buffer_load_dwordx2 v[84:85], off, s[60:63], 0 offset:16 sc1
s_sub_u32 s29, s29, 1
s_cbranch_scc1 main_kernel_end
s_waitcnt vmcnt(0)
s_branch main_kernel_c_nb
main_kernel_c_nb_ok:
s_and_b32 s33, s33, 1
s_lshl_b32 s33, s33, 13
s_add_u32 s52, s33, 0x8c10000
s_and_b32 s32, s32, 1
s_lshl_b32 s32, s32, 13
s_sub_u32 s53, s32, s33
s_add_u32 s53, s53, 65536
s_and_b32 s59, s25, 0x7fff
s_and_b32 s33, s59, 0x6000
s_add_u32 s59, s59, s33
s_and_b32 s54, s19, 0x7fff
s_and_b32 s33, s54, 0x6000
s_add_u32 s54, s54, s33
s_xor_b32 s34, s52, 0x2000
s_lshl_b32 s32, s14, 14
s_lshl_b32 s33, s13, 8
s_add_u32 s33, s33, s34
s_add_u32 s55, s32, s33
v_writelane_b32 v121, s55, 39
s_lshl_b32 s32, s12, 15
s_add_u32 s44, s32, s33
s_xor_b32 s32, s32, 0x8000
s_add_u32 s45, s32, s34
s_lshl_b32 s32, s12, 14
s_add_u32 s32, s32, 0x6c78000
s_lshl_b32 s33, s13, 3
s_add_u32 s46, s32, s33
s_andn2_b32 s32, s25, 0x3ff
s_add_u32 s32, s32, 0x80000
s_cmp_eq_u32 s14, 1
s_cselect_b32 s46, s32, s46
s_add_u32 s20, s20, 0xc0000
s_add_u32 s21, s21, 0xc0000
s_add_u32 s22, s22, 0xc0000
s_add_u32 s23, s23, 0xc0000
s_sub_u32 s3, s3, 0x40000
s_sub_u32 s37, s37, 65536
s_sub_u32 s26, s26, 65536
s_cmp_eq_u32 s14, 3
s_cselect_b32 s39, 0, s39
s_mov_b32 s15, 0
s_mov_b32 s16, 0
s_cselect_b32 s27, 0, s27
s_mov_b32 s17, -1
s_memrealtime s[32:33]
s_memtime s[40:41]
s_waitcnt lgkmcnt(0)
s_mul_i32 s32, s32, 22
s_sub_u32 s11, s40, s32
s_sub_u32 s31, s32, 0x20000
s_sub_u32 s43, s31, 0x20000
s_min_u32 s32, s48, s49
s_cmp_ge_u32 s32, 32
s_waitcnt vmcnt(0)
s_cselect_b32 s32, 0, 4
s_add_u32 s32, s32, s14
s_cmp_eq_u32 s32, 1
s_cbranch_scc1 main_kernel_c1_top
s_cmp_eq_u32 s32, 2
s_cbranch_scc1 main_kernel_c2_top
s_cmp_eq_u32 s32, 3
s_cbranch_scc1 main_kernel_c3_top
s_cmp_eq_u32 s32, 4
s_cbranch_scc1 main_kernel_c4_top
s_cmp_eq_u32 s32, 5
s_cbranch_scc1 main_kernel_c5_top
s_cmp_eq_u32 s32, 6
s_cbranch_scc1 main_kernel_c6_top
s_cmp_eq_u32 s32, 7
s_cbranch_scc1 main_kernel_c7_top
s_branch main_kernel_c0_top
.p2align 6
main_kernel_c0_top:
s_barrier
buffer_load_dwordx4 v[0:3], v116, s[4:7], s18 offen sc1
s_add_u32 s20, s20, 0x40000
s_bitset0_b32 s20, 20
s_add_u32 s21, s21, 0x40000
s_bitset0_b32 s21, 20
s_add_u32 s22, s22, 0x40000
s_bitset0_b32 s22, 20
s_add_u32 s23, s23, 0x40000
s_bitset0_b32 s23, 20
s_xor_b32 s32, s18, 1024
buffer_load_dwordx4 v[16:19], v116, s[4:7], s32 offen sc1
s_add_u32 s3, s3, 0x40000
s_bitset0_b32 s3, 20
s_add_u32 s17, s17, 1
s_bitcmp1_b32 0x77777777, s17
s_cselect_b32 s33, 0x800, 0
s_xor_b32 s54, s54, s33
s_xor_b32 s59, s59, s33
s_add_u32 s25, s52, s59
s_nop 0
buffer_load_dwordx4 v[64:67], v116, s[4:7], s19 offen sc1
v_mov_b32 v80, 0
v_mov_b32 v81, 0
s_nop 3
s_xor_b32 s32, s19, 1024
buffer_load_dwordx4 v[68:71], v116, s[4:7], s32 offen sc1
v_mov_b32 v82, 0
v_mov_b32 v83, 0
s_nop 3
s_xor_b32 s32, s18, 2048
buffer_load_dwordx4 v[32:35], v116, s[4:7], s32 offen sc1
v_mov_b32 v84, 0
v_mov_b32 v85, 0
s_nop 3
s_xor_b32 s32, s19, 2048
buffer_load_dwordx4 v[72:75], v116, s[4:7], s32 offen sc1
v_mov_b32 v86, 0
v_mov_b32 v87, 0
s_nop 3
s_xor_b32 s32, s18, 3072
buffer_load_dwordx4 v[48:51], v116, s[4:7], s32 offen sc1
v_mov_b32 v88, 0
v_mov_b32 v89, 0
s_nop 3
s_xor_b32 s32, s19, 3072
buffer_load_dwordx4 v[76:79], v116, s[4:7], s32 offen sc1
v_mov_b32 v90, 0
v_mov_b32 v91, 0
s_waitcnt vmcnt(5)
v_pk_add_f16 v0, v0, v64
v_pk_add_f16 v1, v1, v65
v_pk_add_f16 v2, v2, v66
v_pk_add_f16 v3, v3, v67
v_cmp_u_f16 vcc, v0, v2
s_cbranch_vccnz main_kernel_c0_m0_f
main_kernel_c0_m0:
v_smfmac_f32_16x16x64_f16 v[80:83], v[0:3], a[0:7], v112
ds_write_b128 v116, v[0:3] offset:0
v_smfmac_f32_16x16x64_f16 v[84:87], v[0:3], a[128:135], v112
buffer_load_dword v123, v121, s[4:7], 0 offen sc1
s_waitcnt vmcnt(5)
v_pk_add_f16 v16, v16, v68
v_pk_add_f16 v17, v17, v69
v_pk_add_f16 v18, v18, v70
v_pk_add_f16 v19, v19, v71
v_cmp_u_f16 vcc, v16, v18
s_waitcnt lgkmcnt(0)
s_barrier
ds_read_b128 v[4:7], v116 offset:1024
ds_write_b128 v116, v[16:19] offset:4096
s_cbranch_vccnz main_kernel_c0_m1_f
main_kernel_c0_m1:
v_smfmac_f32_16x16x64_f16 v[80:83], v[16:19], a[8:15], v112
v_smfmac_f32_16x16x64_f16 v[84:87], v[16:19], a[136:143], v112
ds_read_b128 v[8:11], v116 offset:2048
v_smfmac_f32_16x16x64_f16 v[88:91], v[0:3], v[128:135], v112
ds_read_b128 v[12:15], v116 offset:3072
s_waitcnt lgkmcnt(3)
v_smfmac_f32_16x16x64_f16 v[80:83], v[4:7], a[32:39], v112
v_smfmac_f32_16x16x64_f16 v[84:87], v[4:7], a[160:167], v112
v_smfmac_f32_16x16x64_f16 v[88:91], v[4:7], v[136:143], v112
s_waitcnt lgkmcnt(2)
s_barrier
s_waitcnt lgkmcnt(1)
v_smfmac_f32_16x16x64_f16 v[80:83], v[8:11], a[64:71], v112
s_waitcnt vmcnt(3)
ds_read_b128 v[20:23], v116 offset:5120
v_pk_add_f16 v32, v32, v72
v_smfmac_f32_16x16x64_f16 v[84:87], v[8:11], a[192:199], v112
ds_read_b128 v[24:27], v116 offset:6144
s_waitcnt lgkmcnt(2)
v_pk_add_f16 v33, v33, v73
v_smfmac_f32_16x16x64_f16 v[80:83], v[12:15], a[96:103], v112
ds_read_b128 v[28:31], v116 offset:7168
v_pk_add_f16 v34, v34, v74
v_smfmac_f32_16x16x64_f16 v[84:87], v[12:15], a[224:231], v112
s_waitcnt lgkmcnt(2)
v_pk_add_f16 v35, v35, v75
v_smfmac_f32_16x16x64_f16 v[80:83], v[20:23], a[40:47], v112
ds_write_b128 v116, v[32:35] offset:8192
v_cmp_u_f16 vcc, v32, v34
v_smfmac_f32_16x16x64_f16 v[84:87], v[20:23], a[168:175], v112
s_cbranch_vccnz main_kernel_c0_m2_f
main_kernel_c0_m2:
v_smfmac_f32_16x16x64_f16 v[80:83], v[32:35], a[16:23], v112
buffer_load_dwordx4 v[96:99], v116, s[4:7], s28 offen sc1
v_smfmac_f32_16x16x64_f16 v[84:87], v[32:35], a[144:151], v112
s_add_u32 s28, s28, 0x40000
s_waitcnt lgkmcnt(2)
v_smfmac_f32_16x16x64_f16 v[80:83], v[24:27], a[72:79], v112
s_waitcnt vmcnt(2)
v_pk_add_f16 v48, v48, v76
v_smfmac_f32_16x16x64_f16 v[84:87], v[24:27], a[200:207], v112
s_waitcnt lgkmcnt(0)
s_barrier
ds_read_b128 v[36:39], v116 offset:9216
v_pk_add_f16 v49, v49, v77
v_smfmac_f32_16x16x64_f16 v[80:83], v[28:31], a[104:111], v112
ds_read_b128 v[40:43], v116 offset:10240
v_pk_add_f16 v50, v50, v78
v_smfmac_f32_16x16x64_f16 v[84:87], v[28:31], a[232:239], v112
ds_read_b128 v[44:47], v116 offset:11264
v_pk_add_f16 v51, v51, v79
v_smfmac_f32_16x16x64_f16 v[88:91], v[8:11], v[144:151], v112
ds_write_b128 v116, v[48:51] offset:12288
s_waitcnt lgkmcnt(3)
v_cmp_u_f16 vcc, v48, v50
v_smfmac_f32_16x16x64_f16 v[80:83], v[36:39], a[48:55], v112
s_cbranch_vccnz main_kernel_c0_m3_f
main_kernel_c0_m3:
v_smfmac_f32_16x16x64_f16 v[80:83], v[48:51], a[24:31], v112
v_smfmac_f32_16x16x64_f16 v[84:87], v[48:51], a[152:159], v112
v_smfmac_f32_16x16x64_f16 v[84:87], v[36:39], a[176:183], v112
s_waitcnt lgkmcnt(2)
v_smfmac_f32_16x16x64_f16 v[80:83], v[40:43], a[80:87], v112
s_waitcnt lgkmcnt(0)
s_barrier
ds_read_b128 v[52:55], v116 offset:13312
v_smfmac_f32_16x16x64_f16 v[84:87], v[40:43], a[208:215], v112
s_add_u32 s19, s52, s54
ds_read_b128 v[56:59], v116 offset:14336
v_smfmac_f32_16x16x64_f16 v[80:83], v[44:47], a[112:119], v112
s_add_u32 s18, s18, 0x40000
ds_read_b128 v[60:63], v116 offset:15360
v_smfmac_f32_16x16x64_f16 v[84:87], v[44:47], a[240:247], v112
s_bitset0_b32 s18, 20
s_waitcnt lgkmcnt(2)
v_smfmac_f32_16x16x64_f16 v[80:83], v[52:55], a[56:63], v112
s_cmp_eq_u32 s17, 30
s_cselect_b32 s32, s53, 0x10000
s_waitcnt lgkmcnt(1)
v_smfmac_f32_16x16x64_f16 v[80:83], v[56:59], a[88:95], v112
s_add_u32 s52, s52, s32
s_waitcnt lgkmcnt(0)
v_smfmac_f32_16x16x64_f16 v[80:83], v[60:63], a[120:127], v112
s_sub_u32 s24, 0x20000, s32
ds_read_b128 v[64:67], v116 offset:24576
v_smfmac_f32_16x16x64_f16 v[84:87], v[52:55], a[184:191], v112
s_add_u32 s55, s55, s24
ds_read_b128 v[68:71], v116 offset:28672
v_smfmac_f32_16x16x64_f16 v[84:87], v[56:59], a[216:223], v112
ds_read_b128 v[72:75], v116 offset:25600
s_nop 0
v_cvt_pk_bf16_f32 v92, v80, v81
v_smfmac_f32_16x16x64_f16 v[84:87], v[60:63], a[248:255], v112
ds_read_b128 v[76:79], v116 offset:29696
s_nop 0
v_cvt_pk_bf16_f32 v93, v82, v83
v_smfmac_f32_16x16x64_f16 v[88:91], v[12:15], v[152:159], v112
s_nop 3
v_cvt_pk_bf16_f32 v94, v84, v85
v_cvt_pk_bf16_f32 v95, v86, v87
s_mov_b32 vcc_lo, 0xcccccccc
s_mov_b32 vcc_hi, 0xcccccccc
v_mfma_f32_16x16x32_bf16 v[84:87], v[92:95], v[104:107], 0
v_add_u32 v121, v121, v122
v_writelane_b32 v121, s55, 39
s_nop 0
v_smfmac_f32_16x16x64_f16 v[88:91], v[16:19], v[160:167], v112
s_nop 2
s_cmp_eq_u32 s17, 63
v_cvt_pk_bf16_f32 v114, v84, v85
v_cvt_pk_bf16_f32 v115, v86, v87
buffer_store_dwordx2 v[114:115], v117, s[4:7], s21 offen
s_cbranch_scc1 main_kernel_c0_last
ds_write_b64 v117, v[114:115] offset:16384
v_smfmac_f32_16x16x64_f16 v[88:91], v[20:23], v[168:175], v112
v_smfmac_f32_16x16x64_f16 v[88:91], v[24:27], v[176:183], v112
v_smfmac_f32_16x16x64_f16 v[88:91], v[28:31], v[184:191], v112
v_smfmac_f32_16x16x64_f16 v[88:91], v[32:35], v[192:199], v112
s_waitcnt lgkmcnt(0)
s_barrier
ds_read_b128 v[0:3], v116 offset:16384
v_smfmac_f32_16x16x64_f16 v[88:91], v[36:39], v[200:207], v112
ds_read_b128 v[4:7], v116 offset:17408
v_smfmac_f32_16x16x64_f16 v[88:91], v[40:43], v[208:215], v112
ds_read_b128 v[16:19], v116 offset:26624
v_smfmac_f32_16x16x64_f16 v[88:91], v[44:47], v[216:223], v112
ds_read_b128 v[20:23], v116 offset:30720
v_smfmac_f32_16x16x64_f16 v[88:91], v[48:51], v[224:231], v112
ds_read_b128 v[24:27], v116 offset:27648
v_smfmac_f32_16x16x64_f16 v[88:91], v[52:55], v[232:239], v112
ds_read_b128 v[28:31], v116 offset:31744
v_smfmac_f32_16x16x64_f16 v[88:91], v[56:59], v[240:247], v112
v_smfmac_f32_16x16x64_f16 v[88:91], v[60:63], v[248:255], v112
s_waitcnt lgkmcnt(5)
v_mfma_f32_16x16x32_bf16 v[80:83], v[64:67], v[0:3], 0
v_mfma_f32_16x16x32_bf16 v[84:87], v[68:71], v[0:3], 0
buffer_load_dwordx4 v[8:11], v116, s[4:7], s20 offen offset:0 sc1
v_mfma_f32_16x16x32_bf16 v[92:95], v[0:3], v[0:3], 0
buffer_load_dwordx4 v[12:15], v116, s[4:7], s20 offen offset:1024 sc1
v_permlane32_swap_b32 v88, v90
s_waitcnt lgkmcnt(4)
v_mfma_f32_16x16x32_bf16 v[80:83], v[72:75], v[4:7], v[80:83]
v_permlane32_swap_b32 v89, v91
v_mfma_f32_16x16x32_bf16 v[84:87], v[76:79], v[4:7], v[84:87]
v_pk_add_f32 v[88:89], v[88:89], v[90:91]
v_mfma_f32_16x16x32_bf16 v[92:95], v[4:7], v[4:7], v[92:95]
v_cvt_pk_bf16_f32 v124, v88, v89
v_mov_b32 v65, 0
s_waitcnt lgkmcnt(0)
s_waitcnt vmcnt(1)
v_mfma_f32_16x16x32_bf16 v[88:91], v[8:11], v[8:11], v[92:95]
v_mfma_f32_16x16x32_bf16 v[0:3], v[16:19], v[8:11], v[80:83]
v_cmp_u_f32 s[0:1], v8, v10
v_mfma_f32_16x16x32_bf16 v[4:7], v[20:23], v[8:11], v[84:87]
s_waitcnt vmcnt(0)
v_mfma_f32_16x16x32_bf16 v[88:91], v[12:15], v[12:15], v[88:91]
v_mfma_f32_16x16x32_bf16 v[0:3], v[24:27], v[12:15], v[0:3]
v_cmp_u_f32 s[32:33], v12, v14
v_mfma_f32_16x16x32_bf16 v[4:7], v[28:31], v[12:15], v[4:7]
s_or_b64 s[0:1], s[0:1], s[32:33]
s_cbranch_scc1 main_kernel_c0_z_f
main_kernel_c0_z:
v_mul_f32 v88, s30, v88
v_mul_f32 v89, s30, v89
v_exp_f32 v88, v88
v_exp_f32 v89, v89
v_cndmask_b32_dpp v0, v2, v0, vcc quad_perm:[2,3,2,3] row_mask:0xf bank_mask:0xf
v_cvt_pk_bf16_f32 v64, v88, v89
v_cndmask_b32_dpp v1, v3, v1, vcc quad_perm:[2,3,2,3] row_mask:0xf bank_mask:0xf
v_exp_f32 v0, v0
v_mfma_f32_16x16x16_bf16 v[16:19], v[100:101], v[64:65], 0
v_exp_f32 v1, v1
v_cndmask_b32_dpp v4, v6, v4, vcc quad_perm:[2,3,2,3] row_mask:0xf bank_mask:0xf
v_mfma_f32_16x16x16_bf16 v[8:11], v[124:125], v[64:65], 0
v_cndmask_b32_dpp v5, v7, v5, vcc quad_perm:[2,3,2,3] row_mask:0xf bank_mask:0xf
v_exp_f32 v4, v4
v_exp_f32 v5, v5
v_cvt_pk_bf16_f32 v92, v0, v1
v_cvt_pk_bf16_f32 v94, v4, v5
v_mov_b32 v80, 0
v_mov_b32_dpp v93, v92 quad_perm:[0,1,0,1] row_mask:0xf bank_mask:0xf
v_mov_b32_dpp v95, v94 quad_perm:[0,1,0,1] row_mask:0xf bank_mask:0xf
v_mov_b32 v81, 0
v_mov_b32 v82, 0
v_mfma_f32_16x16x32_bf16 v[16:19], v[100:103], v[92:95], v[16:19]
v_mov_b32 v83, 0
v_mov_b32 v84, 0
v_mfma_f32_16x16x32_bf16 v[8:11], v[96:99], v[92:95], v[8:11]
s_nop 1
v_mov_b32 v85, 0
v_mov_b32 v86, 0
v_mov_b32 v87, 0
v_rcp_f32 v126, v16
v_subrev_u32 v127, 0x21800000, v16
v_cmp_lt_u32 vcc, 0x3c000000, v127
v_pk_mul_f32 v[8:9], v[8:9], v[126:127] op_sel_hi:[1,0]
v_pk_mul_f32 v[10:11], v[10:11], v[126:127] op_sel_hi:[1,0]
s_and_b32 s32, vcc_lo, 0xcccc
v_cvt_pk_bf16_f32 v126, v8, v9
v_cvt_pk_bf16_f32 v127, v10, v11
s_cbranch_scc1 main_kernel_c0_sm_f
main_kernel_c0_ost:
buffer_store_dwordx2 v[126:127], v118, s[4:7], s22 offen
v_cmp_eq_u32 s[0:1], 0, v123
v_mov_b32 v24, -1
v_mov_b32 v25, -1
v_mov_b32 v26, -1
v_mov_b32 v27, -1
ds_read_b128 v[32:35], v113 offset:0
ds_read_b128 v[36:39], v113 offset:1024
ds_read_b128 v[40:43], v113 offset:2048
ds_read_b128 v[44:47], v113 offset:3072
ds_read_b128 v[48:51], v113 offset:4096
ds_read_b128 v[52:55], v113 offset:5120
s_and_b32 s10, s1, 0x3f00
buffer_store_dwordx4 v[24:27], v116, s[4:7], s3 offen
s_barrier
buffer_load_dwordx4 v[0:3], v116, s[4:7], s23 offen sc1
ds_read_b128 v[56:59], v113 offset:6144
ds_read_b128 v[60:63], v113 offset:7168
s_add_u32 s37, s37, 65536
s_add_u32 s26, s26, 65536
s_nop 1
s_xor_b32 s32, s23, 1024
buffer_load_dwordx4 v[4:7], v116, s[4:7], s32 offen sc1
ds_read_b128 v[64:67], v113 offset:8192
ds_read_b128 v[68:71], v113 offset:9216
s_nop 3
s_xor_b32 s32, s23, 2048
buffer_load_dwordx4 v[8:11], v116, s[4:7], s32 offen sc1
ds_read_b128 v[72:75], v113 offset:10240
ds_read_b128 v[76:79], v113 offset:11264
s_nop 3
s_xor_b32 s32, s23, 3072
buffer_load_dwordx4 v[12:15], v116, s[4:7], s32 offen sc1
ds_read_b128 v[88:91], v113 offset:12288
ds_read_b128 v[92:95], v113 offset:13312
s_nop 3
s_xor_b32 s32, s23, 4096
buffer_load_dwordx4 v[16:19], v116, s[4:7], s32 offen sc1
s_nop 7
s_xor_b32 s32, s23, 5120
buffer_load_dwordx4 v[20:23], v116, s[4:7], s32 offen sc1
s_nop 7
s_xor_b32 s32, s23, 6144
buffer_load_dwordx4 v[24:27], v116, s[4:7], s32 offen sc1
s_nop 7
s_xor_b32 s32, s23, 7168
buffer_load_dwordx4 v[28:31], v116, s[4:7], s32 offen sc1
s_waitcnt lgkmcnt(12)
s_waitcnt vmcnt(7)
v_cmp_u_f32 vcc, v0, v2
s_cbranch_vccnz main_kernel_c0_o0_f
main_kernel_c0_o0:
v_smfmac_f32_16x16x64_bf16 v[80:83], v[0:3], v[32:39], v112
ds_read_b128 v[32:35], v113 offset:14336
ds_read_b128 v[36:39], v113 offset:15360
s_waitcnt lgkmcnt(12)
s_waitcnt vmcnt(6)
v_cmp_u_f32 vcc, v4, v6
v_smfmac_f32_16x16x64_bf16 v[84:87], v[0:3], v[40:47], v112
ds_read_b128 v[40:43], v113 offset:16384
ds_read_b128 v[44:47], v113 offset:17408
buffer_store_dwordx2 v[114:115], v119, s[4:7], s37 offen sc1
s_cbranch_vccnz main_kernel_c0_o1_f
main_kernel_c0_o1:
s_waitcnt lgkmcnt(12)
v_smfmac_f32_16x16x64_bf16 v[80:83], v[4:7], v[48:55], v112
ds_read_b128 v[48:51], v113 offset:18432
ds_read_b128 v[52:55], v113 offset:19456
s_waitcnt lgkmcnt(12)
s_waitcnt vmcnt(6)
v_cmp_u_f32 vcc, v8, v10
v_smfmac_f32_16x16x64_bf16 v[84:87], v[4:7], v[56:63], v112
ds_read_b128 v[56:59], v113 offset:20480
ds_read_b128 v[60:63], v113 offset:21504
buffer_store_dword v124, v120, s[4:7], s26 offen sc1
s_cbranch_vccnz main_kernel_c0_o2_f
main_kernel_c0_o2:
s_waitcnt lgkmcnt(12)
v_smfmac_f32_16x16x64_bf16 v[80:83], v[8:11], v[64:71], v112
ds_read_b128 v[64:67], v113 offset:22528
ds_read_b128 v[68:71], v113 offset:23552
s_waitcnt lgkmcnt(12)
s_waitcnt vmcnt(6)
v_cmp_u_f32 vcc, v12, v14
v_smfmac_f32_16x16x64_bf16 v[84:87], v[8:11], v[72:79], v112
ds_read_b128 v[72:75], v113 offset:24576
ds_read_b128 v[76:79], v113 offset:25600
s_cbranch_vccnz main_kernel_c0_o3_f
main_kernel_c0_o3:
s_waitcnt lgkmcnt(12)
v_smfmac_f32_16x16x64_bf16 v[80:83], v[12:15], v[88:95], v112
ds_read_b128 v[88:91], v113 offset:26624
ds_read_b128 v[92:95], v113 offset:27648
s_waitcnt lgkmcnt(12)
s_waitcnt vmcnt(5)
v_cmp_u_f32 vcc, v16, v18
v_smfmac_f32_16x16x64_bf16 v[84:87], v[12:15], v[32:39], v112
ds_read_b128 v[32:35], v113 offset:28672
ds_read_b128 v[36:39], v113 offset:29696
s_cbranch_vccnz main_kernel_c0_o4_f
main_kernel_c0_o4:
s_waitcnt lgkmcnt(12)
v_smfmac_f32_16x16x64_bf16 v[80:83], v[16:19], v[40:47], v112
ds_read_b128 v[40:43], v113 offset:30720
ds_read_b128 v[44:47], v113 offset:31744
s_waitcnt lgkmcnt(12)
s_waitcnt vmcnt(4)
v_cmp_u_f32 vcc, v20, v22
v_smfmac_f32_16x16x64_bf16 v[84:87], v[16:19], v[48:55], v112
s_cbranch_vccnz main_kernel_c0_o5_f
main_kernel_c0_o5:
s_waitcnt lgkmcnt(10)
v_smfmac_f32_16x16x64_bf16 v[80:83], v[20:23], v[56:63], v112
s_waitcnt lgkmcnt(8)
s_waitcnt vmcnt(3)
v_cmp_u_f32 vcc, v24, v26
v_smfmac_f32_16x16x64_bf16 v[84:87], v[20:23], v[64:71], v112
s_cbranch_vccnz main_kernel_c0_o6_f
main_kernel_c0_o6:
s_waitcnt lgkmcnt(6)
v_smfmac_f32_16x16x64_bf16 v[80:83], v[24:27], v[72:79], v112
s_waitcnt lgkmcnt(4)
v_smfmac_f32_16x16x64_bf16 v[84:87], v[24:27], v[88:95], v112
s_waitcnt lgkmcnt(2)
s_waitcnt vmcnt(2)
v_cmp_u_f32 vcc, v28, v30
s_cbranch_vccnz main_kernel_c0_o7_f
main_kernel_c0_o7:
v_smfmac_f32_16x16x64_bf16 v[80:83], v[28:31], v[32:39], v112
s_waitcnt lgkmcnt(0)
v_smfmac_f32_16x16x64_bf16 v[84:87], v[28:31], v[40:47], v112
s_nop 4
v_cvt_pk_bf16_f32 v80, v80, v81
v_cvt_pk_bf16_f32 v81, v82, v83
ds_write_b64 v116, v[80:81] offset:20480
v_cvt_pk_bf16_f32 v82, v84, v85
v_cvt_pk_bf16_f32 v83, v86, v87
ds_write_b64 v116, v[82:83] offset:22528
s_waitcnt lgkmcnt(0)
s_barrier
ds_read_b128 v[72:75], v116 offset:20480
ds_read_b128 v[76:79], v116 offset:21504
s_mov_b32 m0, 24576
s_cmp_lg_u32 s10, 0
s_waitcnt lgkmcnt(1)
v_mfma_f32_16x16x32_bf16 v[64:67], v[72:75], v[108:111], 0
s_waitcnt lgkmcnt(0)
v_mfma_f32_16x16x32_bf16 v[64:67], v[76:79], v[108:111], v[64:67]
s_nop 7
v_cvt_pk_f16_f32 v68, v64, v65
v_cvt_pk_f16_f32 v69, v66, v67
buffer_store_dwordx2 v[68:69], v125, s[4:7], s25 offen sc1
s_cbranch_scc1 main_kernel_c0_kvw
main_kernel_c0_kvok:
s_nop 3
buffer_load_dwordx4 v116, s[4:7], s27 offen sc1 lds
buffer_load_dwordx4 v116, s[4:7], s27 offen offset:1024 sc1 lds
s_add_u32 s27, s27, 0x40000
s_branch main_kernel_c0_top
main_kernel_c0_kvw:
s_mov_b32 exec_lo, 0
s_mov_b32 exec_hi, 0x3f00
v_subrev_u32 v127, 128, v121
main_kernel_c0_kvp:
buffer_load_dword v126, v127, s[4:7], 0 offen sc1
s_waitcnt vmcnt(0)
v_cmp_eq_u32 vcc, 0, v126
s_cbranch_vccz main_kernel_c0_kvp_ok
s_sleep 2
s_sub_u32 s29, s29, 1
s_cbranch_scc0 main_kernel_c0_kvp
s_branch main_kernel_end
main_kernel_c0_kvp_ok:
s_mov_b64 exec, -1
s_branch main_kernel_c0_kvok
main_kernel_c0_last:
s_add_u32 s37, s37, 65536
s_add_u32 s26, s26, 65536
buffer_store_dwordx2 v[114:115], v119, s[4:7], s37 offen sc1
v_smfmac_f32_16x16x64_f16 v[88:91], v[20:23], v[168:175], v112
v_smfmac_f32_16x16x64_f16 v[88:91], v[24:27], v[176:183], v112
v_smfmac_f32_16x16x64_f16 v[88:91], v[28:31], v[184:191], v112
v_smfmac_f32_16x16x64_f16 v[88:91], v[32:35], v[192:199], v112
v_smfmac_f32_16x16x64_f16 v[88:91], v[36:39], v[200:207], v112
v_smfmac_f32_16x16x64_f16 v[88:91], v[40:43], v[208:215], v112
v_smfmac_f32_16x16x64_f16 v[88:91], v[44:47], v[216:223], v112
v_smfmac_f32_16x16x64_f16 v[88:91], v[48:51], v[224:231], v112
v_smfmac_f32_16x16x64_f16 v[88:91], v[52:55], v[232:239], v112
v_smfmac_f32_16x16x64_f16 v[88:91], v[56:59], v[240:247], v112
v_smfmac_f32_16x16x64_f16 v[88:91], v[60:63], v[248:255], v112
s_nop 7
v_permlane32_swap_b32 v88, v90
s_nop 1
v_permlane32_swap_b32 v89, v91
s_nop 1
v_pk_add_f32 v[88:89], v[88:89], v[90:91]
s_nop 1
v_cvt_pk_bf16_f32 v124, v88, v89
s_nop 1
buffer_store_dword v124, v120, s[4:7], s26 offen sc1
s_branch main_kernel_end
main_kernel_c0_m0_f:
s_waitcnt lgkmcnt(0)
buffer_load_dwordx4 v[0:3], v116, s[4:7], s18 offen sc1
buffer_load_dwordx4 v[64:67], v116, s[4:7], s19 offen sc1
s_xor_b32 s32, s18, 1024
buffer_load_dwordx4 v[16:19], v116, s[4:7], s32 offen sc1
s_xor_b32 s32, s19, 1024
buffer_load_dwordx4 v[68:71], v116, s[4:7], s32 offen sc1
s_xor_b32 s32, s18, 2048
buffer_load_dwordx4 v[32:35], v116, s[4:7], s32 offen sc1
s_xor_b32 s32, s19, 2048
buffer_load_dwordx4 v[72:75], v116, s[4:7], s32 offen sc1
s_xor_b32 s32, s18, 3072
buffer_load_dwordx4 v[48:51], v116, s[4:7], s32 offen sc1
s_xor_b32 s32, s19, 3072
buffer_load_dwordx4 v[76:79], v116, s[4:7], s32 offen sc1
s_sub_u32 s29, s29, 1
s_cbranch_scc1 main_kernel_end
s_waitcnt vmcnt(0)
v_max_u32 v126, v0, v2
v_max3_u32 v126, v126, v64, v66
v_cmp_eq_u32 vcc, -1, v126
s_cbranch_vccnz main_kernel_c0_m0_f
v_pk_add_f16 v0, v0, v64
v_pk_add_f16 v1, v1, v65
v_pk_add_f16 v2, v2, v66
v_pk_add_f16 v3, v3, v67
s_nop 0
s_branch main_kernel_c0_m0
main_kernel_c0_m1_f:
s_waitcnt lgkmcnt(0)
s_xor_b32 s32, s18, 1024
buffer_load_dwordx4 v[16:19], v116, s[4:7], s32 offen sc1
s_xor_b32 s32, s19, 1024
buffer_load_dwordx4 v[68:71], v116, s[4:7], s32 offen sc1
s_xor_b32 s32, s18, 2048
buffer_load_dwordx4 v[32:35], v116, s[4:7], s32 offen sc1
s_xor_b32 s32, s19, 2048
buffer_load_dwordx4 v[72:75], v116, s[4:7], s32 offen sc1
s_xor_b32 s32, s18, 3072
buffer_load_dwordx4 v[48:51], v116, s[4:7], s32 offen sc1
s_xor_b32 s32, s19, 3072
buffer_load_dwordx4 v[76:79], v116, s[4:7], s32 offen sc1
s_sub_u32 s29, s29, 1
s_cbranch_scc1 main_kernel_end
s_waitcnt vmcnt(0)
v_max_u32 v126, v16, v18
v_max3_u32 v126, v126, v68, v70
v_cmp_eq_u32 vcc, -1, v126
s_cbranch_vccnz main_kernel_c0_m1_f
v_pk_add_f16 v16, v16, v68
v_pk_add_f16 v17, v17, v69
v_pk_add_f16 v18, v18, v70
v_pk_add_f16 v19, v19, v71
ds_write_b128 v116, v[16:19] offset:4096
s_branch main_kernel_c0_m1
main_kernel_c0_m2_f:
s_waitcnt lgkmcnt(0)
s_xor_b32 s32, s18, 2048
buffer_load_dwordx4 v[32:35], v116, s[4:7], s32 offen sc1
s_xor_b32 s32, s19, 2048
buffer_load_dwordx4 v[72:75], v116, s[4:7], s32 offen sc1
s_xor_b32 s32, s18, 3072
buffer_load_dwordx4 v[48:51], v116, s[4:7], s32 offen sc1
s_xor_b32 s32, s19, 3072
buffer_load_dwordx4 v[76:79], v116, s[4:7], s32 offen sc1
s_sub_u32 s29, s29, 1
s_cbranch_scc1 main_kernel_end
s_waitcnt vmcnt(0)
v_max_u32 v126, v32, v34
v_max3_u32 v126, v126, v72, v74
v_cmp_eq_u32 vcc, -1, v126
s_cbranch_vccnz main_kernel_c0_m2_f
v_pk_add_f16 v32, v32, v72
v_pk_add_f16 v33, v33, v73
v_pk_add_f16 v34, v34, v74
v_pk_add_f16 v35, v35, v75
ds_write_b128 v116, v[32:35] offset:8192
s_branch main_kernel_c0_m2
main_kernel_c0_m3_f:
s_waitcnt lgkmcnt(0)
s_xor_b32 s32, s18, 3072
buffer_load_dwordx4 v[48:51], v116, s[4:7], s32 offen sc1
s_xor_b32 s32, s19, 3072
buffer_load_dwordx4 v[76:79], v116, s[4:7], s32 offen sc1
s_sub_u32 s29, s29, 1
s_cbranch_scc1 main_kernel_end
s_waitcnt vmcnt(0)
v_max_u32 v126, v48, v50
v_max3_u32 v126, v126, v76, v78
v_cmp_eq_u32 vcc, -1, v126
s_cbranch_vccnz main_kernel_c0_m3_f
v_pk_add_f16 v48, v48, v76
v_pk_add_f16 v49, v49, v77
v_pk_add_f16 v50, v50, v78
v_pk_add_f16 v51, v51, v79
ds_write_b128 v116, v[48:51] offset:12288
s_branch main_kernel_c0_m3
main_kernel_c0_z_f:
buffer_load_dwordx4 v[8:11], v116, s[4:7], s20 offen offset:0 sc1
buffer_load_dwordx4 v[12:15], v116, s[4:7], s20 offen offset:1024 sc1
s_memtime s[32:33]
ds_read_b32 v126, v116 offset:18432
s_sub_u32 s34, s19, s54
s_xor_b32 s34, s34, 0x2000
s_lshl_b32 s35, s12, 15
s_add_u32 s34, s34, s35
s_lshl_b32 s35, s13, 8
s_add_u32 s35, s35, s34
s_add_u32 s34, s34, 0x4000
s_waitcnt lgkmcnt(0)
s_sub_u32 s32, s32, 450
v_sub_u32 v127, s32, v126
buffer_store_dword v127, off, s[4:7], s34
s_sub_u32 s29, s29, 1
s_cbranch_scc1 main_kernel_end
s_waitcnt vmcnt(1)
main_kernel_c0_z_g:
v_max_u32 v126, v8, v10
v_max3_u32 v126, v126, v12, v14
v_cmp_eq_u32 vcc, -1, v126
s_cbranch_vccnz main_kernel_c0_z_h
v_mfma_f32_16x16x32_bf16 v[88:91], v[8:11], v[8:11], v[92:95]
v_mfma_f32_16x16x32_bf16 v[0:3], v[16:19], v[8:11], v[80:83]
v_mfma_f32_16x16x32_bf16 v[4:7], v[20:23], v[8:11], v[84:87]
v_mfma_f32_16x16x32_bf16 v[88:91], v[12:15], v[12:15], v[88:91]
v_mfma_f32_16x16x32_bf16 v[0:3], v[24:27], v[12:15], v[0:3]
v_mfma_f32_16x16x32_bf16 v[4:7], v[28:31], v[12:15], v[4:7]
buffer_store_dword v127, off, s[4:7], s35 offset:132 sc1
s_mov_b32 vcc_lo, 0xcccccccc
s_mov_b32 vcc_hi, 0xcccccccc
s_branch main_kernel_c0_z
main_kernel_c0_z_h:
buffer_load_dwordx4 v[8:11], v116, s[4:7], s20 offen offset:0 sc1
buffer_load_dwordx4 v[12:15], v116, s[4:7], s20 offen offset:1024 sc1
s_sub_u32 s29, s29, 1
s_cbranch_scc1 main_kernel_end
v_add_u32 v127, 300, v127
s_waitcnt vmcnt(0)
s_branch main_kernel_c0_z_g
main_kernel_c0_sm_f:
s_waitcnt vmcnt(0) lgkmcnt(0)
buffer_load_dwordx4 v[8:11], v116, s[4:7], s20 offen offset:0 sc1
buffer_load_dwordx4 v[12:15], v116, s[4:7], s20 offen offset:1024 sc1
ds_read_b128 v[0:3], v116 offset:16384
ds_read_b128 v[4:7], v116 offset:17408
ds_read_b128 v[64:67], v116 offset:24576
ds_read_b128 v[68:71], v116 offset:28672
ds_read_b128 v[72:75], v116 offset:25600
ds_read_b128 v[76:79], v116 offset:29696
ds_read_b128 v[16:19], v116 offset:26624
ds_read_b128 v[20:23], v116 offset:30720
ds_read_b128 v[24:27], v116 offset:27648
ds_read_b128 v[28:31], v116 offset:31744
s_waitcnt vmcnt(0)
s_waitcnt lgkmcnt(0)
v_mfma_f32_16x16x32_bf16 v[80:83], v[64:67], v[0:3], 0
v_mfma_f32_16x16x32_bf16 v[84:87], v[68:71], v[0:3], 0
v_mfma_f32_16x16x32_bf16 v[92:95], v[0:3], v[0:3], 0
v_mfma_f32_16x16x32_bf16 v[80:83], v[72:75], v[4:7], v[80:83]
v_mfma_f32_16x16x32_bf16 v[84:87], v[76:79], v[4:7], v[84:87]
v_mfma_f32_16x16x32_bf16 v[92:95], v[4:7], v[4:7], v[92:95]
v_mfma_f32_16x16x32_bf16 v[0:3], v[16:19], v[8:11], v[80:83]
v_mfma_f32_16x16x32_bf16 v[4:7], v[20:23], v[8:11], v[84:87]
v_mfma_f32_16x16x32_bf16 v[88:91], v[8:11], v[8:11], v[92:95]
v_mfma_f32_16x16x32_bf16 v[0:3], v[24:27], v[12:15], v[0:3]
v_mfma_f32_16x16x32_bf16 v[4:7], v[28:31], v[12:15], v[4:7]
v_mfma_f32_16x16x32_bf16 v[88:91], v[12:15], v[12:15], v[88:91]
s_nop 7
v_mov_b32 v65, 0
v_max_f32 v126, v88, v89
v_mul_f32 v126, s30, v126
v_max3_f32 v126, v126, v0, v1
v_max3_f32 v126, v126, v2, v3
v_max3_f32 v126, v126, v4, v5
v_max3_f32 v126, v126, v6, v7
v_mov_b32 v127, v126
s_nop 1
v_permlane32_swap_b32 v126, v127
v_max_f32 v126, v126, v127
v_mov_b32 v127, v126
s_nop 1
v_permlane16_swap_b32 v126, v127
v_max_f32 v126, v126, v127
v_mul_f32 v127, 0x40faf233, v126
s_mov_b32 vcc_lo, 0xcccccccc
s_mov_b32 vcc_hi, 0xcccccccc
v_sub_f32 v0, v0, v126
v_sub_f32 v1, v1, v126
v_sub_f32 v2, v2, v126
v_sub_f32 v3, v3, v126
v_sub_f32 v4, v4, v126
v_sub_f32 v5, v5, v126
v_sub_f32 v6, v6, v126
v_sub_f32 v7, v7, v126
v_sub_f32 v88, v88, v127
v_sub_f32 v89, v89, v127
s_waitcnt lgkmcnt(0)
s_nop 0
v_mul_f32 v88, s30, v88
v_mul_f32 v89, s30, v89
v_exp_f32 v88, v88
v_exp_f32 v89, v89
v_cndmask_b32_dpp v0, v2, v0, vcc quad_perm:[2,3,2,3] row_mask:0xf bank_mask:0xf
v_cvt_pk_bf16_f32 v64, v88, v89
v_cndmask_b32_dpp v1, v3, v1, vcc quad_perm:[2,3,2,3] row_mask:0xf bank_mask:0xf
v_exp_f32 v0, v0
v_mfma_f32_16x16x16_bf16 v[16:19], v[100:101], v[64:65], 0
v_exp_f32 v1, v1
v_cndmask_b32_dpp v4, v6, v4, vcc quad_perm:[2,3,2,3] row_mask:0xf bank_mask:0xf
v_mfma_f32_16x16x16_bf16 v[8:11], v[124:125], v[64:65], 0
v_cndmask_b32_dpp v5, v7, v5, vcc quad_perm:[2,3,2,3] row_mask:0xf bank_mask:0xf
v_exp_f32 v4, v4
v_exp_f32 v5, v5
v_cvt_pk_bf16_f32 v92, v0, v1
v_cvt_pk_bf16_f32 v94, v4, v5
v_mov_b32 v80, 0
v_mov_b32_dpp v93, v92 quad_perm:[0,1,0,1] row_mask:0xf bank_mask:0xf
v_mov_b32_dpp v95, v94 quad_perm:[0,1,0,1] row_mask:0xf bank_mask:0xf
v_mov_b32 v81, 0
v_mov_b32 v82, 0
v_mfma_f32_16x16x32_bf16 v[16:19], v[100:103], v[92:95], v[16:19]
v_mov_b32 v83, 0
v_mov_b32 v84, 0
v_mfma_f32_16x16x32_bf16 v[8:11], v[96:99], v[92:95], v[8:11]
s_nop 1
v_mov_b32 v85, 0
v_mov_b32 v86, 0
v_mov_b32 v87, 0
v_rcp_f32 v126, v16
v_subrev_u32 v127, 0x21800000, v16
v_cmp_lt_u32 vcc, 0x3c000000, v127
v_pk_mul_f32 v[8:9], v[8:9], v[126:127] op_sel_hi:[1,0]
v_pk_mul_f32 v[10:11], v[10:11], v[126:127] op_sel_hi:[1,0]
s_and_b32 s32, vcc_lo, 0xcccc
v_cvt_pk_bf16_f32 v126, v8, v9
v_cvt_pk_bf16_f32 v127, v10, v11
s_branch main_kernel_c0_ost
main_kernel_c0_o0_f:
s_nop 0
buffer_load_dwordx4 v[0:3], v116, s[4:7], s23 offen sc1
s_xor_b32 s32, s23, 1024
buffer_load_dwordx4 v[4:7], v116, s[4:7], s32 offen sc1
s_sub_u32 s29, s29, 1
s_cbranch_scc1 main_kernel_end
s_waitcnt vmcnt(0)
v_max_u32 v126, v0, v2
v_cmp_eq_u32 vcc, -1, v126
s_cbranch_vccnz main_kernel_c0_o0_f
s_branch main_kernel_c0_o0
main_kernel_c0_o1_f:
s_nop 0
s_xor_b32 s32, s23, 1024
buffer_load_dwordx4 v[4:7], v116, s[4:7], s32 offen sc1
s_xor_b32 s32, s23, 2048
buffer_load_dwordx4 v[8:11], v116, s[4:7], s32 offen sc1
s_sub_u32 s29, s29, 1
s_cbranch_scc1 main_kernel_end
s_waitcnt vmcnt(0)
v_max_u32 v126, v4, v6
v_cmp_eq_u32 vcc, -1, v126
s_cbranch_vccnz main_kernel_c0_o1_f
s_branch main_kernel_c0_o1
main_kernel_c0_o2_f:
s_nop 0
s_xor_b32 s32, s23, 2048
buffer_load_dwordx4 v[8:11], v116, s[4:7], s32 offen sc1
s_xor_b32 s32, s23, 3072
buffer_load_dwordx4 v[12:15], v116, s[4:7], s32 offen sc1
s_sub_u32 s29, s29, 1
s_cbranch_scc1 main_kernel_end
s_waitcnt vmcnt(0)
v_max_u32 v126, v8, v10
v_cmp_eq_u32 vcc, -1, v126
s_cbranch_vccnz main_kernel_c0_o2_f
s_branch main_kernel_c0_o2
main_kernel_c0_o3_f:
s_nop 0
s_xor_b32 s32, s23, 3072
buffer_load_dwordx4 v[12:15], v116, s[4:7], s32 offen sc1
s_xor_b32 s32, s23, 4096
buffer_load_dwordx4 v[16:19], v116, s[4:7], s32 offen sc1
s_sub_u32 s29, s29, 1
s_cbranch_scc1 main_kernel_end
s_waitcnt vmcnt(0)
v_max_u32 v126, v12, v14
v_cmp_eq_u32 vcc, -1, v126
s_cbranch_vccnz main_kernel_c0_o3_f
s_branch main_kernel_c0_o3
main_kernel_c0_o4_f:
s_nop 0
s_xor_b32 s32, s23, 4096
buffer_load_dwordx4 v[16:19], v116, s[4:7], s32 offen sc1
s_xor_b32 s32, s23, 5120
buffer_load_dwordx4 v[20:23], v116, s[4:7], s32 offen sc1
s_sub_u32 s29, s29, 1
s_cbranch_scc1 main_kernel_end
s_waitcnt vmcnt(0)
v_max_u32 v126, v16, v18
v_cmp_eq_u32 vcc, -1, v126
s_cbranch_vccnz main_kernel_c0_o4_f
s_branch main_kernel_c0_o4
main_kernel_c0_o5_f:
s_nop 0
s_xor_b32 s32, s23, 5120
buffer_load_dwordx4 v[20:23], v116, s[4:7], s32 offen sc1
s_xor_b32 s32, s23, 6144
buffer_load_dwordx4 v[24:27], v116, s[4:7], s32 offen sc1
s_sub_u32 s29, s29, 1
s_cbranch_scc1 main_kernel_end
s_waitcnt vmcnt(0)
v_max_u32 v126, v20, v22
v_cmp_eq_u32 vcc, -1, v126
s_cbranch_vccnz main_kernel_c0_o5_f
s_branch main_kernel_c0_o5
main_kernel_c0_o6_f:
s_nop 0
s_xor_b32 s32, s23, 6144
buffer_load_dwordx4 v[24:27], v116, s[4:7], s32 offen sc1
s_xor_b32 s32, s23, 7168
buffer_load_dwordx4 v[28:31], v116, s[4:7], s32 offen sc1
s_sub_u32 s29, s29, 1
s_cbranch_scc1 main_kernel_end
s_waitcnt vmcnt(0)
v_max_u32 v126, v24, v26
v_cmp_eq_u32 vcc, -1, v126
s_cbranch_vccnz main_kernel_c0_o6_f
s_branch main_kernel_c0_o6
main_kernel_c0_o7_f:
s_nop 0
s_xor_b32 s32, s23, 7168
buffer_load_dwordx4 v[28:31], v116, s[4:7], s32 offen sc1
s_sub_u32 s29, s29, 1
s_cbranch_scc1 main_kernel_end
s_waitcnt vmcnt(0)
v_max_u32 v126, v28, v30
v_cmp_eq_u32 vcc, -1, v126
s_cbranch_vccnz main_kernel_c0_o7_f
s_branch main_kernel_c0_o7
.p2align 6
main_kernel_c1_top:
s_barrier
buffer_load_dwordx4 v[0:3], v116, s[4:7], s18 offen sc1
s_add_u32 s20, s20, 0x40000
s_bitset0_b32 s20, 20
s_add_u32 s21, s21, 0x40000
s_bitset0_b32 s21, 20
s_add_u32 s22, s22, 0x40000
s_bitset0_b32 s22, 20
s_add_u32 s23, s23, 0x40000
s_bitset0_b32 s23, 20
s_xor_b32 s32, s18, 1024
buffer_load_dwordx4 v[16:19], v116, s[4:7], s32 offen sc1
s_add_u32 s3, s3, 0x40000
s_bitset0_b32 s3, 20
s_add_u32 s17, s17, 1
s_bitcmp1_b32 0x77777777, s17
s_cselect_b32 s33, 0x800, 0
s_xor_b32 s54, s54, s33
s_xor_b32 s59, s59, s33
s_add_u32 s25, s52, s59
s_nop 0
buffer_load_dwordx4 v[64:67], v116, s[4:7], s19 offen sc1
v_mov_b32 v80, 0
v_mov_b32 v81, 0
s_nop 3
s_xor_b32 s32, s19, 1024
buffer_load_dwordx4 v[68:71], v116, s[4:7], s32 offen sc1
v_mov_b32 v82, 0
v_mov_b32 v83, 0
s_nop 3
s_xor_b32 s32, s18, 2048
buffer_load_dwordx4 v[32:35], v116, s[4:7], s32 offen sc1
v_mov_b32 v84, 0
v_mov_b32 v85, 0
s_nop 3
s_xor_b32 s32, s19, 2048
buffer_load_dwordx4 v[72:75], v116, s[4:7], s32 offen sc1
v_mov_b32 v86, 0
v_mov_b32 v87, 0
s_nop 3
s_xor_b32 s32, s18, 3072
buffer_load_dwordx4 v[48:51], v116, s[4:7], s32 offen sc1
v_mov_b32 v88, 0
v_mov_b32 v89, 0
s_nop 3
s_xor_b32 s32, s19, 3072
buffer_load_dwordx4 v[76:79], v116, s[4:7], s32 offen sc1
v_mov_b32 v90, 0
v_mov_b32 v91, 0
s_waitcnt vmcnt(5)
v_pk_add_f16 v0, v0, v64
v_pk_add_f16 v1, v1, v65
v_pk_add_f16 v2, v2, v66
v_pk_add_f16 v3, v3, v67
v_cmp_u_f16 vcc, v0, v2
s_cbranch_vccnz main_kernel_c1_m0_f
main_kernel_c1_m0:
v_smfmac_f32_16x16x64_f16 v[80:83], v[0:3], a[0:7], v112
ds_write_b128 v116, v[0:3] offset:1024
v_smfmac_f32_16x16x64_f16 v[84:87], v[0:3], a[128:135], v112
buffer_load_dword v123, v121, s[4:7], 0 offen sc1
s_waitcnt vmcnt(5)
v_pk_add_f16 v16, v16, v68
v_pk_add_f16 v17, v17, v69
v_pk_add_f16 v18, v18, v70
v_pk_add_f16 v19, v19, v71
v_cmp_u_f16 vcc, v16, v18
s_waitcnt lgkmcnt(0)
s_barrier
ds_read_b128 v[4:7], v116 offset:0
ds_write_b128 v116, v[16:19] offset:5120
s_cbranch_vccnz main_kernel_c1_m1_f
main_kernel_c1_m1:
v_smfmac_f32_16x16x64_f16 v[80:83], v[16:19], a[8:15], v112
v_smfmac_f32_16x16x64_f16 v[84:87], v[16:19], a[136:143], v112
ds_read_b128 v[8:11], v116 offset:3072
v_smfmac_f32_16x16x64_f16 v[88:91], v[0:3], v[128:135], v112
ds_read_b128 v[12:15], v116 offset:2048
s_waitcnt lgkmcnt(3)
v_smfmac_f32_16x16x64_f16 v[80:83], v[4:7], a[32:39], v112
v_smfmac_f32_16x16x64_f16 v[84:87], v[4:7], a[160:167], v112
v_smfmac_f32_16x16x64_f16 v[88:91], v[4:7], v[136:143], v112
s_waitcnt lgkmcnt(2)
s_barrier
s_waitcnt lgkmcnt(1)
v_smfmac_f32_16x16x64_f16 v[80:83], v[8:11], a[64:71], v112
s_waitcnt vmcnt(3)
ds_read_b128 v[20:23], v116 offset:4096
v_pk_add_f16 v32, v32, v72
v_smfmac_f32_16x16x64_f16 v[84:87], v[8:11], a[192:199], v112
ds_read_b128 v[24:27], v116 offset:7168
s_waitcnt lgkmcnt(2)
v_pk_add_f16 v33, v33, v73
v_smfmac_f32_16x16x64_f16 v[80:83], v[12:15], a[96:103], v112
ds_read_b128 v[28:31], v116 offset:6144
v_pk_add_f16 v34, v34, v74
v_smfmac_f32_16x16x64_f16 v[84:87], v[12:15], a[224:231], v112
s_waitcnt lgkmcnt(2)
v_pk_add_f16 v35, v35, v75
v_smfmac_f32_16x16x64_f16 v[80:83], v[20:23], a[40:47], v112
ds_write_b128 v116, v[32:35] offset:9216
v_cmp_u_f16 vcc, v32, v34
v_smfmac_f32_16x16x64_f16 v[84:87], v[20:23], a[168:175], v112
s_cbranch_vccnz main_kernel_c1_m2_f
main_kernel_c1_m2:
v_smfmac_f32_16x16x64_f16 v[80:83], v[32:35], a[16:23], v112
buffer_load_dwordx4 v[96:99], v116, s[4:7], s28 offen sc1
v_smfmac_f32_16x16x64_f16 v[84:87], v[32:35], a[144:151], v112
s_add_u32 s28, s28, 0x40000
s_waitcnt lgkmcnt(2)
v_smfmac_f32_16x16x64_f16 v[80:83], v[24:27], a[72:79], v112
s_waitcnt vmcnt(2)
v_pk_add_f16 v48, v48, v76
v_smfmac_f32_16x16x64_f16 v[84:87], v[24:27], a[200:207], v112
s_waitcnt lgkmcnt(0)
s_barrier
ds_read_b128 v[36:39], v116 offset:8192
v_pk_add_f16 v49, v49, v77
v_smfmac_f32_16x16x64_f16 v[80:83], v[28:31], a[104:111], v112
ds_read_b128 v[40:43], v116 offset:11264
v_pk_add_f16 v50, v50, v78
v_smfmac_f32_16x16x64_f16 v[84:87], v[28:31], a[232:239], v112
ds_read_b128 v[44:47], v116 offset:10240
v_pk_add_f16 v51, v51, v79
v_smfmac_f32_16x16x64_f16 v[88:91], v[8:11], v[144:151], v112
ds_write_b128 v116, v[48:51] offset:13312
s_waitcnt lgkmcnt(3)
v_cmp_u_f16 vcc, v48, v50
v_smfmac_f32_16x16x64_f16 v[80:83], v[36:39], a[48:55], v112
s_cbranch_vccnz main_kernel_c1_m3_f
main_kernel_c1_m3:
v_smfmac_f32_16x16x64_f16 v[80:83], v[48:51], a[24:31], v112
v_smfmac_f32_16x16x64_f16 v[84:87], v[48:51], a[152:159], v112
v_smfmac_f32_16x16x64_f16 v[84:87], v[36:39], a[176:183], v112
s_waitcnt lgkmcnt(2)
v_smfmac_f32_16x16x64_f16 v[80:83], v[40:43], a[80:87], v112
s_waitcnt lgkmcnt(0)
s_barrier
ds_read_b128 v[52:55], v116 offset:12288
v_smfmac_f32_16x16x64_f16 v[84:87], v[40:43], a[208:215], v112
s_add_u32 s19, s52, s54
ds_read_b128 v[56:59], v116 offset:15360
v_smfmac_f32_16x16x64_f16 v[80:83], v[44:47], a[112:119], v112
s_add_u32 s18, s18, 0x40000
ds_read_b128 v[60:63], v116 offset:14336
v_smfmac_f32_16x16x64_f16 v[84:87], v[44:47], a[240:247], v112
s_bitset0_b32 s18, 20
s_waitcnt lgkmcnt(2)
v_smfmac_f32_16x16x64_f16 v[80:83], v[52:55], a[56:63], v112
s_cmp_eq_u32 s17, 30
s_cselect_b32 s32, s53, 0x10000
s_waitcnt lgkmcnt(1)
v_smfmac_f32_16x16x64_f16 v[80:83], v[56:59], a[88:95], v112
s_add_u32 s52, s52, s32
s_waitcnt lgkmcnt(0)
v_smfmac_f32_16x16x64_f16 v[80:83], v[60:63], a[120:127], v112
s_sub_u32 s24, 0x20000, s32
ds_read_b128 v[64:67], v116 offset:24576
v_smfmac_f32_16x16x64_f16 v[84:87], v[52:55], a[184:191], v112
s_add_u32 s55, s55, s24
ds_read_b128 v[68:71], v116 offset:28672
v_smfmac_f32_16x16x64_f16 v[84:87], v[56:59], a[216:223], v112
ds_read_b128 v[72:75], v116 offset:25600
s_nop 0
v_cvt_pk_bf16_f32 v92, v80, v81
v_smfmac_f32_16x16x64_f16 v[84:87], v[60:63], a[248:255], v112
ds_read_b128 v[76:79], v116 offset:29696
s_nop 0
v_cvt_pk_bf16_f32 v93, v82, v83
v_smfmac_f32_16x16x64_f16 v[88:91], v[12:15], v[152:159], v112
s_nop 3
v_cvt_pk_bf16_f32 v94, v84, v85
v_cvt_pk_bf16_f32 v95, v86, v87
s_mov_b32 vcc_lo, 0xcccccccc
s_mov_b32 vcc_hi, 0xcccccccc
v_mfma_f32_16x16x32_bf16 v[84:87], v[92:95], v[104:107], 0
v_add_u32 v121, v121, v122
v_writelane_b32 v121, s55, 39
s_nop 0
v_smfmac_f32_16x16x64_f16 v[88:91], v[16:19], v[160:167], v112
s_nop 2
s_cmp_eq_u32 s17, 63
v_cvt_pk_bf16_f32 v114, v84, v85
v_cvt_pk_bf16_f32 v115, v86, v87
buffer_store_dwordx2 v[114:115], v117, s[4:7], s21 offen
s_cbranch_scc1 main_kernel_c1_last
ds_write_b64 v117, v[114:115] offset:16896
v_smfmac_f32_16x16x64_f16 v[88:91], v[20:23], v[168:175], v112
v_smfmac_f32_16x16x64_f16 v[88:91], v[24:27], v[176:183], v112
v_smfmac_f32_16x16x64_f16 v[88:91], v[28:31], v[184:191], v112
v_smfmac_f32_16x16x64_f16 v[88:91], v[32:35], v[192:199], v112
s_waitcnt lgkmcnt(0)
s_barrier
ds_read_b128 v[0:3], v116 offset:16384
v_smfmac_f32_16x16x64_f16 v[88:91], v[36:39], v[200:207], v112
ds_read_b128 v[4:7], v116 offset:17408
v_smfmac_f32_16x16x64_f16 v[88:91], v[40:43], v[208:215], v112
ds_read_b128 v[16:19], v116 offset:26624
v_smfmac_f32_16x16x64_f16 v[88:91], v[44:47], v[216:223], v112
ds_read_b128 v[20:23], v116 offset:30720
v_smfmac_f32_16x16x64_f16 v[88:91], v[48:51], v[224:231], v112
ds_read_b128 v[24:27], v116 offset:27648
v_smfmac_f32_16x16x64_f16 v[88:91], v[52:55], v[232:239], v112
ds_read_b128 v[28:31], v116 offset:31744
v_smfmac_f32_16x16x64_f16 v[88:91], v[56:59], v[240:247], v112
v_smfmac_f32_16x16x64_f16 v[88:91], v[60:63], v[248:255], v112
s_waitcnt lgkmcnt(5)
v_mfma_f32_16x16x32_bf16 v[80:83], v[64:67], v[0:3], 0
v_mfma_f32_16x16x32_bf16 v[84:87], v[68:71], v[0:3], 0
buffer_load_dwordx4 v[8:11], v116, s[4:7], s20 offen offset:0 sc1
v_mfma_f32_16x16x32_bf16 v[92:95], v[0:3], v[0:3], 0
buffer_load_dwordx4 v[12:15], v116, s[4:7], s20 offen offset:1024 sc1
v_permlane32_swap_b32 v88, v90
s_waitcnt lgkmcnt(4)
v_mfma_f32_16x16x32_bf16 v[80:83], v[72:75], v[4:7], v[80:83]
v_permlane32_swap_b32 v89, v91
v_mfma_f32_16x16x32_bf16 v[84:87], v[76:79], v[4:7], v[84:87]
v_pk_add_f32 v[88:89], v[88:89], v[90:91]
v_mfma_f32_16x16x32_bf16 v[92:95], v[4:7], v[4:7], v[92:95]
v_cvt_pk_bf16_f32 v124, v88, v89
v_mov_b32 v65, 0
s_waitcnt lgkmcnt(0)
s_waitcnt vmcnt(1)
v_mfma_f32_16x16x32_bf16 v[88:91], v[8:11], v[8:11], v[92:95]
v_mfma_f32_16x16x32_bf16 v[0:3], v[16:19], v[8:11], v[80:83]
v_cmp_u_f32 s[0:1], v8, v10
v_mfma_f32_16x16x32_bf16 v[4:7], v[20:23], v[8:11], v[84:87]
s_waitcnt vmcnt(0)
v_mfma_f32_16x16x32_bf16 v[88:91], v[12:15], v[12:15], v[88:91]
v_mfma_f32_16x16x32_bf16 v[0:3], v[24:27], v[12:15], v[0:3]
v_cmp_u_f32 s[32:33], v12, v14
v_mfma_f32_16x16x32_bf16 v[4:7], v[28:31], v[12:15], v[4:7]
s_or_b64 s[0:1], s[0:1], s[32:33]
s_cbranch_scc1 main_kernel_c1_z_f
main_kernel_c1_z:
v_mul_f32 v88, s30, v88
v_mul_f32 v89, s30, v89
v_exp_f32 v88, v88
v_exp_f32 v89, v89
v_cndmask_b32_dpp v0, v2, v0, vcc quad_perm:[2,3,2,3] row_mask:0xf bank_mask:0xf
v_cvt_pk_bf16_f32 v64, v88, v89
v_cndmask_b32_dpp v1, v3, v1, vcc quad_perm:[2,3,2,3] row_mask:0xf bank_mask:0xf
v_exp_f32 v0, v0
v_mfma_f32_16x16x16_bf16 v[16:19], v[100:101], v[64:65], 0
v_exp_f32 v1, v1
v_cndmask_b32_dpp v4, v6, v4, vcc quad_perm:[2,3,2,3] row_mask:0xf bank_mask:0xf
v_mfma_f32_16x16x16_bf16 v[8:11], v[124:125], v[64:65], 0
v_cndmask_b32_dpp v5, v7, v5, vcc quad_perm:[2,3,2,3] row_mask:0xf bank_mask:0xf
v_exp_f32 v4, v4
v_exp_f32 v5, v5
v_cvt_pk_bf16_f32 v92, v0, v1
v_cvt_pk_bf16_f32 v94, v4, v5
v_mov_b32 v80, 0
v_mov_b32_dpp v93, v92 quad_perm:[0,1,0,1] row_mask:0xf bank_mask:0xf
v_mov_b32_dpp v95, v94 quad_perm:[0,1,0,1] row_mask:0xf bank_mask:0xf
v_mov_b32 v81, 0
v_mov_b32 v82, 0
v_mfma_f32_16x16x32_bf16 v[16:19], v[100:103], v[92:95], v[16:19]
v_mov_b32 v83, 0
v_mov_b32 v84, 0
v_mfma_f32_16x16x32_bf16 v[8:11], v[96:99], v[92:95], v[8:11]
s_nop 1
v_mov_b32 v85, 0
v_mov_b32 v86, 0
v_mov_b32 v87, 0
v_rcp_f32 v126, v16
v_subrev_u32 v127, 0x21800000, v16
v_cmp_lt_u32 vcc, 0x3c000000, v127
v_pk_mul_f32 v[8:9], v[8:9], v[126:127] op_sel_hi:[1,0]
v_pk_mul_f32 v[10:11], v[10:11], v[126:127] op_sel_hi:[1,0]
s_and_b32 s32, vcc_lo, 0xcccc
v_cvt_pk_bf16_f32 v126, v8, v9
v_cvt_pk_bf16_f32 v127, v10, v11
s_cbranch_scc1 main_kernel_c1_sm_f
main_kernel_c1_ost:
buffer_store_dwordx2 v[126:127], v118, s[4:7], s22 offen
v_cmp_eq_u32 s[0:1], 0, v123
v_mov_b32 v24, -1
v_mov_b32 v25, -1
v_mov_b32 v26, -1
v_mov_b32 v27, -1
ds_read_b128 v[32:35], v113 offset:0
ds_read_b128 v[36:39], v113 offset:1024
ds_read_b128 v[40:43], v113 offset:2048
ds_read_b128 v[44:47], v113 offset:3072
ds_read_b128 v[48:51], v113 offset:4096
ds_read_b128 v[52:55], v113 offset:5120
s_and_b32 s10, s1, 0x3f00
buffer_store_dwordx4 v[24:27], v116, s[4:7], s3 offen
buffer_store_dwordx4 v[24:27], v116, s[4:7], s46 offen
s_barrier
buffer_load_dwordx4 v[0:3], v116, s[4:7], s23 offen sc1
ds_read_b128 v[56:59], v113 offset:6144
ds_read_b128 v[60:63], v113 offset:7168
s_add_u32 s46, s46, 0x40000
s_bitset0_b32 s46, 20
s_add_u32 s37, s37, 65536
s_add_u32 s26, s26, 65536
s_xor_b32 s32, s23, 1024
buffer_load_dwordx4 v[4:7], v116, s[4:7], s32 offen sc1
ds_read_b128 v[64:67], v113 offset:8192
ds_read_b128 v[68:71], v113 offset:9216
s_nop 3
s_xor_b32 s32, s23, 2048
buffer_load_dwordx4 v[8:11], v116, s[4:7], s32 offen sc1
ds_read_b128 v[72:75], v113 offset:10240
ds_read_b128 v[76:79], v113 offset:11264
s_nop 3
s_xor_b32 s32, s23, 3072
buffer_load_dwordx4 v[12:15], v116, s[4:7], s32 offen sc1
ds_read_b128 v[88:91], v113 offset:12288
ds_read_b128 v[92:95], v113 offset:13312
s_nop 3
s_xor_b32 s32, s23, 4096
buffer_load_dwordx4 v[16:19], v116, s[4:7], s32 offen sc1
s_nop 7
s_xor_b32 s32, s23, 5120
buffer_load_dwordx4 v[20:23], v116, s[4:7], s32 offen sc1
s_nop 7
s_xor_b32 s32, s23, 6144
buffer_load_dwordx4 v[24:27], v116, s[4:7], s32 offen sc1
s_nop 7
s_xor_b32 s32, s23, 7168
buffer_load_dwordx4 v[28:31], v116, s[4:7], s32 offen sc1
s_waitcnt lgkmcnt(12)
s_waitcnt vmcnt(7)
v_cmp_u_f32 vcc, v0, v2
s_cbranch_vccnz main_kernel_c1_o0_f
main_kernel_c1_o0:
v_smfmac_f32_16x16x64_bf16 v[80:83], v[0:3], v[32:39], v112
ds_read_b128 v[32:35], v113 offset:14336
ds_read_b128 v[36:39], v113 offset:15360
s_waitcnt lgkmcnt(12)
s_waitcnt vmcnt(6)
v_cmp_u_f32 vcc, v4, v6
v_smfmac_f32_16x16x64_bf16 v[84:87], v[0:3], v[40:47], v112
ds_read_b128 v[40:43], v113 offset:16384
ds_read_b128 v[44:47], v113 offset:17408
buffer_store_dwordx2 v[114:115], v119, s[4:7], s37 offen sc1
s_cbranch_vccnz main_kernel_c1_o1_f
main_kernel_c1_o1:
s_waitcnt lgkmcnt(12)
v_smfmac_f32_16x16x64_bf16 v[80:83], v[4:7], v[48:55], v112
ds_read_b128 v[48:51], v113 offset:18432
ds_read_b128 v[52:55], v113 offset:19456
s_waitcnt lgkmcnt(12)
s_waitcnt vmcnt(6)
v_cmp_u_f32 vcc, v8, v10
v_smfmac_f32_16x16x64_bf16 v[84:87], v[4:7], v[56:63], v112
ds_read_b128 v[56:59], v113 offset:20480
ds_read_b128 v[60:63], v113 offset:21504
buffer_store_dword v124, v120, s[4:7], s26 offen sc1
s_cbranch_vccnz main_kernel_c1_o2_f
main_kernel_c1_o2:
s_waitcnt lgkmcnt(12)
v_smfmac_f32_16x16x64_bf16 v[80:83], v[8:11], v[64:71], v112
ds_read_b128 v[64:67], v113 offset:22528
ds_read_b128 v[68:71], v113 offset:23552
s_waitcnt lgkmcnt(12)
s_waitcnt vmcnt(6)
v_cmp_u_f32 vcc, v12, v14
v_smfmac_f32_16x16x64_bf16 v[84:87], v[8:11], v[72:79], v112
ds_read_b128 v[72:75], v113 offset:24576
ds_read_b128 v[76:79], v113 offset:25600
s_cbranch_vccnz main_kernel_c1_o3_f
main_kernel_c1_o3:
s_waitcnt lgkmcnt(12)
v_smfmac_f32_16x16x64_bf16 v[80:83], v[12:15], v[88:95], v112
ds_read_b128 v[88:91], v113 offset:26624
ds_read_b128 v[92:95], v113 offset:27648
s_waitcnt lgkmcnt(12)
s_waitcnt vmcnt(5)
v_cmp_u_f32 vcc, v16, v18
v_smfmac_f32_16x16x64_bf16 v[84:87], v[12:15], v[32:39], v112
ds_read_b128 v[32:35], v113 offset:28672
ds_read_b128 v[36:39], v113 offset:29696
s_cbranch_vccnz main_kernel_c1_o4_f
main_kernel_c1_o4:
s_waitcnt lgkmcnt(12)
v_smfmac_f32_16x16x64_bf16 v[80:83], v[16:19], v[40:47], v112
ds_read_b128 v[40:43], v113 offset:30720
ds_read_b128 v[44:47], v113 offset:31744
s_waitcnt lgkmcnt(12)
s_waitcnt vmcnt(4)
v_cmp_u_f32 vcc, v20, v22
v_smfmac_f32_16x16x64_bf16 v[84:87], v[16:19], v[48:55], v112
s_cbranch_vccnz main_kernel_c1_o5_f
main_kernel_c1_o5:
s_waitcnt lgkmcnt(10)
v_smfmac_f32_16x16x64_bf16 v[80:83], v[20:23], v[56:63], v112
s_waitcnt lgkmcnt(8)
s_waitcnt vmcnt(3)
v_cmp_u_f32 vcc, v24, v26
v_smfmac_f32_16x16x64_bf16 v[84:87], v[20:23], v[64:71], v112
s_cbranch_vccnz main_kernel_c1_o6_f
main_kernel_c1_o6:
s_waitcnt lgkmcnt(6)
v_smfmac_f32_16x16x64_bf16 v[80:83], v[24:27], v[72:79], v112
s_waitcnt lgkmcnt(4)
v_smfmac_f32_16x16x64_bf16 v[84:87], v[24:27], v[88:95], v112
s_waitcnt lgkmcnt(2)
s_waitcnt vmcnt(2)
v_cmp_u_f32 vcc, v28, v30
s_cbranch_vccnz main_kernel_c1_o7_f
main_kernel_c1_o7:
v_smfmac_f32_16x16x64_bf16 v[80:83], v[28:31], v[32:39], v112
s_waitcnt lgkmcnt(0)
v_smfmac_f32_16x16x64_bf16 v[84:87], v[28:31], v[40:47], v112
s_nop 4
v_cvt_pk_bf16_f32 v80, v80, v81
v_cvt_pk_bf16_f32 v81, v82, v83
ds_write_b64 v116, v[80:81] offset:20488
v_cvt_pk_bf16_f32 v82, v84, v85
v_cvt_pk_bf16_f32 v83, v86, v87
ds_write_b64 v116, v[82:83] offset:22536
s_waitcnt lgkmcnt(0)
s_barrier
ds_read_b128 v[72:75], v116 offset:22528
ds_read_b128 v[76:79], v116 offset:23552
s_mov_b32 m0, 26624
s_cmp_lg_u32 s10, 0
s_waitcnt lgkmcnt(1)
v_mfma_f32_16x16x32_bf16 v[64:67], v[72:75], v[108:111], 0
s_waitcnt lgkmcnt(0)
v_mfma_f32_16x16x32_bf16 v[64:67], v[76:79], v[108:111], v[64:67]
s_nop 7
v_cvt_pk_f16_f32 v68, v64, v65
v_cvt_pk_f16_f32 v69, v66, v67
buffer_store_dwordx2 v[68:69], v125, s[4:7], s25 offen sc1
s_cbranch_scc1 main_kernel_c1_kvw
main_kernel_c1_kvok:
s_nop 3
buffer_load_dwordx4 v116, s[4:7], s27 offen sc1 lds
buffer_load_dwordx4 v116, s[4:7], s27 offen offset:1024 sc1 lds
s_mov_b32 m0, 30720
s_xor_b32 s32, s27, 131072
buffer_load_dwordx4 v116, s[4:7], s32 offen offset:0 sc1 lds
s_add_u32 s27, s27, 0x40000
s_branch main_kernel_c1_top
main_kernel_c1_kvw:
s_mov_b32 exec_lo, 0
s_mov_b32 exec_hi, 0x3f00
v_subrev_u32 v127, 128, v121
main_kernel_c1_kvp:
buffer_load_dword v126, v127, s[4:7], 0 offen sc1
s_waitcnt vmcnt(0)
v_cmp_eq_u32 vcc, 0, v126
s_cbranch_vccz main_kernel_c1_kvp_ok
s_sleep 2
s_sub_u32 s29, s29, 1
s_cbranch_scc0 main_kernel_c1_kvp
s_branch main_kernel_end
main_kernel_c1_kvp_ok:
s_mov_b64 exec, -1
s_branch main_kernel_c1_kvok
main_kernel_c1_last:
s_add_u32 s37, s37, 65536
s_add_u32 s26, s26, 65536
buffer_store_dwordx2 v[114:115], v119, s[4:7], s37 offen sc1
v_smfmac_f32_16x16x64_f16 v[88:91], v[20:23], v[168:175], v112
v_smfmac_f32_16x16x64_f16 v[88:91], v[24:27], v[176:183], v112
v_smfmac_f32_16x16x64_f16 v[88:91], v[28:31], v[184:191], v112
v_smfmac_f32_16x16x64_f16 v[88:91], v[32:35], v[192:199], v112
v_smfmac_f32_16x16x64_f16 v[88:91], v[36:39], v[200:207], v112
v_smfmac_f32_16x16x64_f16 v[88:91], v[40:43], v[208:215], v112
v_smfmac_f32_16x16x64_f16 v[88:91], v[44:47], v[216:223], v112
v_smfmac_f32_16x16x64_f16 v[88:91], v[48:51], v[224:231], v112
v_smfmac_f32_16x16x64_f16 v[88:91], v[52:55], v[232:239], v112
v_smfmac_f32_16x16x64_f16 v[88:91], v[56:59], v[240:247], v112
v_smfmac_f32_16x16x64_f16 v[88:91], v[60:63], v[248:255], v112
s_nop 7
v_permlane32_swap_b32 v88, v90
s_nop 1
v_permlane32_swap_b32 v89, v91
s_nop 1
v_pk_add_f32 v[88:89], v[88:89], v[90:91]
s_nop 1
v_cvt_pk_bf16_f32 v124, v88, v89
s_nop 1
buffer_store_dword v124, v120, s[4:7], s26 offen sc1
s_branch main_kernel_end
main_kernel_c1_m0_f:
s_waitcnt lgkmcnt(0)
buffer_load_dwordx4 v[0:3], v116, s[4:7], s18 offen sc1
buffer_load_dwordx4 v[64:67], v116, s[4:7], s19 offen sc1
s_xor_b32 s32, s18, 1024
buffer_load_dwordx4 v[16:19], v116, s[4:7], s32 offen sc1
s_xor_b32 s32, s19, 1024
buffer_load_dwordx4 v[68:71], v116, s[4:7], s32 offen sc1
s_xor_b32 s32, s18, 2048
buffer_load_dwordx4 v[32:35], v116, s[4:7], s32 offen sc1
s_xor_b32 s32, s19, 2048
buffer_load_dwordx4 v[72:75], v116, s[4:7], s32 offen sc1
s_xor_b32 s32, s18, 3072
buffer_load_dwordx4 v[48:51], v116, s[4:7], s32 offen sc1
s_xor_b32 s32, s19, 3072
buffer_load_dwordx4 v[76:79], v116, s[4:7], s32 offen sc1
s_sub_u32 s29, s29, 1
s_cbranch_scc1 main_kernel_end
s_waitcnt vmcnt(0)
v_max_u32 v126, v0, v2
v_max3_u32 v126, v126, v64, v66
v_cmp_eq_u32 vcc, -1, v126
s_cbranch_vccnz main_kernel_c1_m0_f
v_pk_add_f16 v0, v0, v64
v_pk_add_f16 v1, v1, v65
v_pk_add_f16 v2, v2, v66
v_pk_add_f16 v3, v3, v67
s_nop 0
s_branch main_kernel_c1_m0
main_kernel_c1_m1_f:
s_waitcnt lgkmcnt(0)
s_xor_b32 s32, s18, 1024
buffer_load_dwordx4 v[16:19], v116, s[4:7], s32 offen sc1
s_xor_b32 s32, s19, 1024
buffer_load_dwordx4 v[68:71], v116, s[4:7], s32 offen sc1
s_xor_b32 s32, s18, 2048
buffer_load_dwordx4 v[32:35], v116, s[4:7], s32 offen sc1
s_xor_b32 s32, s19, 2048
buffer_load_dwordx4 v[72:75], v116, s[4:7], s32 offen sc1
s_xor_b32 s32, s18, 3072
buffer_load_dwordx4 v[48:51], v116, s[4:7], s32 offen sc1
s_xor_b32 s32, s19, 3072
buffer_load_dwordx4 v[76:79], v116, s[4:7], s32 offen sc1
s_sub_u32 s29, s29, 1
s_cbranch_scc1 main_kernel_end
s_waitcnt vmcnt(0)
v_max_u32 v126, v16, v18
v_max3_u32 v126, v126, v68, v70
v_cmp_eq_u32 vcc, -1, v126
s_cbranch_vccnz main_kernel_c1_m1_f
v_pk_add_f16 v16, v16, v68
v_pk_add_f16 v17, v17, v69
v_pk_add_f16 v18, v18, v70
v_pk_add_f16 v19, v19, v71
ds_write_b128 v116, v[16:19] offset:5120
s_branch main_kernel_c1_m1
main_kernel_c1_m2_f:
s_waitcnt lgkmcnt(0)
s_xor_b32 s32, s18, 2048
buffer_load_dwordx4 v[32:35], v116, s[4:7], s32 offen sc1
s_xor_b32 s32, s19, 2048
buffer_load_dwordx4 v[72:75], v116, s[4:7], s32 offen sc1
s_xor_b32 s32, s18, 3072
buffer_load_dwordx4 v[48:51], v116, s[4:7], s32 offen sc1
s_xor_b32 s32, s19, 3072
buffer_load_dwordx4 v[76:79], v116, s[4:7], s32 offen sc1
s_sub_u32 s29, s29, 1
s_cbranch_scc1 main_kernel_end
s_waitcnt vmcnt(0)
v_max_u32 v126, v32, v34
v_max3_u32 v126, v126, v72, v74
v_cmp_eq_u32 vcc, -1, v126
s_cbranch_vccnz main_kernel_c1_m2_f
v_pk_add_f16 v32, v32, v72
v_pk_add_f16 v33, v33, v73
v_pk_add_f16 v34, v34, v74
v_pk_add_f16 v35, v35, v75
ds_write_b128 v116, v[32:35] offset:9216
s_branch main_kernel_c1_m2
main_kernel_c1_m3_f:
s_waitcnt lgkmcnt(0)
s_xor_b32 s32, s18, 3072
buffer_load_dwordx4 v[48:51], v116, s[4:7], s32 offen sc1
s_xor_b32 s32, s19, 3072
buffer_load_dwordx4 v[76:79], v116, s[4:7], s32 offen sc1
s_sub_u32 s29, s29, 1
s_cbranch_scc1 main_kernel_end
s_waitcnt vmcnt(0)
v_max_u32 v126, v48, v50
v_max3_u32 v126, v126, v76, v78
v_cmp_eq_u32 vcc, -1, v126
s_cbranch_vccnz main_kernel_c1_m3_f
v_pk_add_f16 v48, v48, v76
v_pk_add_f16 v49, v49, v77
v_pk_add_f16 v50, v50, v78
v_pk_add_f16 v51, v51, v79
ds_write_b128 v116, v[48:51] offset:13312
s_branch main_kernel_c1_m3
main_kernel_c1_z_f:
buffer_load_dwordx4 v[8:11], v116, s[4:7], s20 offen offset:0 sc1
buffer_load_dwordx4 v[12:15], v116, s[4:7], s20 offen offset:1024 sc1
s_memtime s[32:33]
ds_read_b32 v126, v116 offset:18432
s_sub_u32 s34, s19, s54
s_xor_b32 s34, s34, 0x2000
s_lshl_b32 s35, s12, 15
s_add_u32 s34, s34, s35
s_lshl_b32 s35, s13, 8
s_add_u32 s35, s35, s34
s_add_u32 s34, s34, 0x4000
s_waitcnt lgkmcnt(0)
s_sub_u32 s32, s32, 450
v_sub_u32 v127, s32, v126
buffer_store_dword v127, off, s[4:7], s34
s_sub_u32 s29, s29, 1
s_cbranch_scc1 main_kernel_end
s_waitcnt vmcnt(1)
main_kernel_c1_z_g:
v_max_u32 v126, v8, v10
v_max3_u32 v126, v126, v12, v14
v_cmp_eq_u32 vcc, -1, v126
s_cbranch_vccnz main_kernel_c1_z_h
v_mfma_f32_16x16x32_bf16 v[88:91], v[8:11], v[8:11], v[92:95]
v_mfma_f32_16x16x32_bf16 v[0:3], v[16:19], v[8:11], v[80:83]
v_mfma_f32_16x16x32_bf16 v[4:7], v[20:23], v[8:11], v[84:87]
v_mfma_f32_16x16x32_bf16 v[88:91], v[12:15], v[12:15], v[88:91]
v_mfma_f32_16x16x32_bf16 v[0:3], v[24:27], v[12:15], v[0:3]
v_mfma_f32_16x16x32_bf16 v[4:7], v[28:31], v[12:15], v[4:7]
buffer_store_dword v127, off, s[4:7], s35 offset:132 sc1
s_mov_b32 vcc_lo, 0xcccccccc
s_mov_b32 vcc_hi, 0xcccccccc
s_branch main_kernel_c1_z
main_kernel_c1_z_h:
buffer_load_dwordx4 v[8:11], v116, s[4:7], s20 offen offset:0 sc1
buffer_load_dwordx4 v[12:15], v116, s[4:7], s20 offen offset:1024 sc1
s_sub_u32 s29, s29, 1
s_cbranch_scc1 main_kernel_end
v_add_u32 v127, 300, v127
s_waitcnt vmcnt(0)
s_branch main_kernel_c1_z_g
main_kernel_c1_sm_f:
s_waitcnt vmcnt(0) lgkmcnt(0)
buffer_load_dwordx4 v[8:11], v116, s[4:7], s20 offen offset:0 sc1
buffer_load_dwordx4 v[12:15], v116, s[4:7], s20 offen offset:1024 sc1
ds_read_b128 v[0:3], v116 offset:16384
ds_read_b128 v[4:7], v116 offset:17408
ds_read_b128 v[64:67], v116 offset:24576
ds_read_b128 v[68:71], v116 offset:28672
ds_read_b128 v[72:75], v116 offset:25600
ds_read_b128 v[76:79], v116 offset:29696
ds_read_b128 v[16:19], v116 offset:26624
ds_read_b128 v[20:23], v116 offset:30720
ds_read_b128 v[24:27], v116 offset:27648
ds_read_b128 v[28:31], v116 offset:31744
s_waitcnt vmcnt(0)
s_waitcnt lgkmcnt(0)
v_mfma_f32_16x16x32_bf16 v[80:83], v[64:67], v[0:3], 0
v_mfma_f32_16x16x32_bf16 v[84:87], v[68:71], v[0:3], 0
v_mfma_f32_16x16x32_bf16 v[92:95], v[0:3], v[0:3], 0
v_mfma_f32_16x16x32_bf16 v[80:83], v[72:75], v[4:7], v[80:83]
v_mfma_f32_16x16x32_bf16 v[84:87], v[76:79], v[4:7], v[84:87]
v_mfma_f32_16x16x32_bf16 v[92:95], v[4:7], v[4:7], v[92:95]
v_mfma_f32_16x16x32_bf16 v[0:3], v[16:19], v[8:11], v[80:83]
v_mfma_f32_16x16x32_bf16 v[4:7], v[20:23], v[8:11], v[84:87]
v_mfma_f32_16x16x32_bf16 v[88:91], v[8:11], v[8:11], v[92:95]
v_mfma_f32_16x16x32_bf16 v[0:3], v[24:27], v[12:15], v[0:3]
v_mfma_f32_16x16x32_bf16 v[4:7], v[28:31], v[12:15], v[4:7]
v_mfma_f32_16x16x32_bf16 v[88:91], v[12:15], v[12:15], v[88:91]
s_nop 7
v_mov_b32 v65, 0
v_max_f32 v126, v88, v89
v_mul_f32 v126, s30, v126
v_max3_f32 v126, v126, v0, v1
v_max3_f32 v126, v126, v2, v3
v_max3_f32 v126, v126, v4, v5
v_max3_f32 v126, v126, v6, v7
v_mov_b32 v127, v126
s_nop 1
v_permlane32_swap_b32 v126, v127
v_max_f32 v126, v126, v127
v_mov_b32 v127, v126
s_nop 1
v_permlane16_swap_b32 v126, v127
v_max_f32 v126, v126, v127
v_mul_f32 v127, 0x40faf233, v126
s_mov_b32 vcc_lo, 0xcccccccc
s_mov_b32 vcc_hi, 0xcccccccc
v_sub_f32 v0, v0, v126
v_sub_f32 v1, v1, v126
v_sub_f32 v2, v2, v126
v_sub_f32 v3, v3, v126
v_sub_f32 v4, v4, v126
v_sub_f32 v5, v5, v126
v_sub_f32 v6, v6, v126
v_sub_f32 v7, v7, v126
v_sub_f32 v88, v88, v127
v_sub_f32 v89, v89, v127
s_waitcnt lgkmcnt(0)
s_nop 0
v_mul_f32 v88, s30, v88
v_mul_f32 v89, s30, v89
v_exp_f32 v88, v88
v_exp_f32 v89, v89
v_cndmask_b32_dpp v0, v2, v0, vcc quad_perm:[2,3,2,3] row_mask:0xf bank_mask:0xf
v_cvt_pk_bf16_f32 v64, v88, v89
v_cndmask_b32_dpp v1, v3, v1, vcc quad_perm:[2,3,2,3] row_mask:0xf bank_mask:0xf
v_exp_f32 v0, v0
v_mfma_f32_16x16x16_bf16 v[16:19], v[100:101], v[64:65], 0
v_exp_f32 v1, v1
v_cndmask_b32_dpp v4, v6, v4, vcc quad_perm:[2,3,2,3] row_mask:0xf bank_mask:0xf
v_mfma_f32_16x16x16_bf16 v[8:11], v[124:125], v[64:65], 0
v_cndmask_b32_dpp v5, v7, v5, vcc quad_perm:[2,3,2,3] row_mask:0xf bank_mask:0xf
v_exp_f32 v4, v4
v_exp_f32 v5, v5
v_cvt_pk_bf16_f32 v92, v0, v1
v_cvt_pk_bf16_f32 v94, v4, v5
v_mov_b32 v80, 0
v_mov_b32_dpp v93, v92 quad_perm:[0,1,0,1] row_mask:0xf bank_mask:0xf
v_mov_b32_dpp v95, v94 quad_perm:[0,1,0,1] row_mask:0xf bank_mask:0xf
v_mov_b32 v81, 0
v_mov_b32 v82, 0
v_mfma_f32_16x16x32_bf16 v[16:19], v[100:103], v[92:95], v[16:19]
v_mov_b32 v83, 0
v_mov_b32 v84, 0
v_mfma_f32_16x16x32_bf16 v[8:11], v[96:99], v[92:95], v[8:11]
s_nop 1
v_mov_b32 v85, 0
v_mov_b32 v86, 0
v_mov_b32 v87, 0
v_rcp_f32 v126, v16
v_subrev_u32 v127, 0x21800000, v16
v_cmp_lt_u32 vcc, 0x3c000000, v127
v_pk_mul_f32 v[8:9], v[8:9], v[126:127] op_sel_hi:[1,0]
v_pk_mul_f32 v[10:11], v[10:11], v[126:127] op_sel_hi:[1,0]
s_and_b32 s32, vcc_lo, 0xcccc
v_cvt_pk_bf16_f32 v126, v8, v9
v_cvt_pk_bf16_f32 v127, v10, v11
s_branch main_kernel_c1_ost
main_kernel_c1_o0_f:
s_nop 0
buffer_load_dwordx4 v[0:3], v116, s[4:7], s23 offen sc1
s_xor_b32 s32, s23, 1024
buffer_load_dwordx4 v[4:7], v116, s[4:7], s32 offen sc1
s_sub_u32 s29, s29, 1
s_cbranch_scc1 main_kernel_end
s_waitcnt vmcnt(0)
v_max_u32 v126, v0, v2
v_cmp_eq_u32 vcc, -1, v126
s_cbranch_vccnz main_kernel_c1_o0_f
s_branch main_kernel_c1_o0
main_kernel_c1_o1_f:
s_nop 0
s_xor_b32 s32, s23, 1024
buffer_load_dwordx4 v[4:7], v116, s[4:7], s32 offen sc1
s_xor_b32 s32, s23, 2048
buffer_load_dwordx4 v[8:11], v116, s[4:7], s32 offen sc1
s_sub_u32 s29, s29, 1
s_cbranch_scc1 main_kernel_end
s_waitcnt vmcnt(0)
v_max_u32 v126, v4, v6
v_cmp_eq_u32 vcc, -1, v126
s_cbranch_vccnz main_kernel_c1_o1_f
s_branch main_kernel_c1_o1
main_kernel_c1_o2_f:
s_nop 0
s_xor_b32 s32, s23, 2048
buffer_load_dwordx4 v[8:11], v116, s[4:7], s32 offen sc1
s_xor_b32 s32, s23, 3072
buffer_load_dwordx4 v[12:15], v116, s[4:7], s32 offen sc1
s_sub_u32 s29, s29, 1
s_cbranch_scc1 main_kernel_end
s_waitcnt vmcnt(0)
v_max_u32 v126, v8, v10
v_cmp_eq_u32 vcc, -1, v126
s_cbranch_vccnz main_kernel_c1_o2_f
s_branch main_kernel_c1_o2
main_kernel_c1_o3_f:
s_nop 0
s_xor_b32 s32, s23, 3072
buffer_load_dwordx4 v[12:15], v116, s[4:7], s32 offen sc1
s_xor_b32 s32, s23, 4096
buffer_load_dwordx4 v[16:19], v116, s[4:7], s32 offen sc1
s_sub_u32 s29, s29, 1
s_cbranch_scc1 main_kernel_end
s_waitcnt vmcnt(0)
v_max_u32 v126, v12, v14
v_cmp_eq_u32 vcc, -1, v126
s_cbranch_vccnz main_kernel_c1_o3_f
s_branch main_kernel_c1_o3
main_kernel_c1_o4_f:
s_nop 0
s_xor_b32 s32, s23, 4096
buffer_load_dwordx4 v[16:19], v116, s[4:7], s32 offen sc1
s_xor_b32 s32, s23, 5120
buffer_load_dwordx4 v[20:23], v116, s[4:7], s32 offen sc1
s_sub_u32 s29, s29, 1
s_cbranch_scc1 main_kernel_end
s_waitcnt vmcnt(0)
v_max_u32 v126, v16, v18
v_cmp_eq_u32 vcc, -1, v126
s_cbranch_vccnz main_kernel_c1_o4_f
s_branch main_kernel_c1_o4
main_kernel_c1_o5_f:
s_nop 0
s_xor_b32 s32, s23, 5120
buffer_load_dwordx4 v[20:23], v116, s[4:7], s32 offen sc1
s_xor_b32 s32, s23, 6144
buffer_load_dwordx4 v[24:27], v116, s[4:7], s32 offen sc1
s_sub_u32 s29, s29, 1
s_cbranch_scc1 main_kernel_end
s_waitcnt vmcnt(0)
v_max_u32 v126, v20, v22
v_cmp_eq_u32 vcc, -1, v126
s_cbranch_vccnz main_kernel_c1_o5_f
s_branch main_kernel_c1_o5
main_kernel_c1_o6_f:
s_nop 0
s_xor_b32 s32, s23, 6144
buffer_load_dwordx4 v[24:27], v116, s[4:7], s32 offen sc1
s_xor_b32 s32, s23, 7168
buffer_load_dwordx4 v[28:31], v116, s[4:7], s32 offen sc1
s_sub_u32 s29, s29, 1
s_cbranch_scc1 main_kernel_end
s_waitcnt vmcnt(0)
v_max_u32 v126, v24, v26
v_cmp_eq_u32 vcc, -1, v126
s_cbranch_vccnz main_kernel_c1_o6_f
s_branch main_kernel_c1_o6
main_kernel_c1_o7_f:
s_nop 0
s_xor_b32 s32, s23, 7168
buffer_load_dwordx4 v[28:31], v116, s[4:7], s32 offen sc1
s_sub_u32 s29, s29, 1
s_cbranch_scc1 main_kernel_end
s_waitcnt vmcnt(0)
v_max_u32 v126, v28, v30
v_cmp_eq_u32 vcc, -1, v126
s_cbranch_vccnz main_kernel_c1_o7_f
s_branch main_kernel_c1_o7
.p2align 6
main_kernel_c2_top:
s_barrier
buffer_load_dwordx4 v[0:3], v116, s[4:7], s18 offen sc1
s_add_u32 s20, s20, 0x40000
s_bitset0_b32 s20, 20
s_add_u32 s21, s21, 0x40000
s_bitset0_b32 s21, 20
s_add_u32 s22, s22, 0x40000
s_bitset0_b32 s22, 20
s_add_u32 s23, s23, 0x40000
s_bitset0_b32 s23, 20
s_xor_b32 s32, s18, 1024
buffer_load_dwordx4 v[16:19], v116, s[4:7], s32 offen sc1
s_add_u32 s3, s3, 0x40000
s_bitset0_b32 s3, 20
s_add_u32 s17, s17, 1
s_bitcmp1_b32 0x77777777, s17
s_cselect_b32 s33, 0x800, 0
s_xor_b32 s54, s54, s33
s_add_u32 s25, s25, 0x40000
s_bitset0_b32 s25, 20
s_nop 0
buffer_load_dwordx4 v[64:67], v116, s[4:7], s19 offen sc1
v_mov_b32 v80, 0
v_mov_b32 v81, 0
s_nop 3
s_xor_b32 s32, s19, 1024
buffer_load_dwordx4 v[68:71], v116, s[4:7], s32 offen sc1
v_mov_b32 v82, 0
v_mov_b32 v83, 0
s_nop 3
s_xor_b32 s32, s18, 2048
buffer_load_dwordx4 v[32:35], v116, s[4:7], s32 offen sc1
v_mov_b32 v84, 0
v_mov_b32 v85, 0
s_nop 3
s_xor_b32 s32, s19, 2048
buffer_load_dwordx4 v[72:75], v116, s[4:7], s32 offen sc1
v_mov_b32 v86, 0
v_mov_b32 v87, 0
s_nop 3
s_xor_b32 s32, s18, 3072
buffer_load_dwordx4 v[48:51], v116, s[4:7], s32 offen sc1
v_mov_b32 v88, 0
v_mov_b32 v89, 0
s_nop 3
s_xor_b32 s32, s19, 3072
buffer_load_dwordx4 v[76:79], v116, s[4:7], s32 offen sc1
v_mov_b32 v90, 0
v_mov_b32 v91, 0
s_waitcnt vmcnt(5)
v_pk_add_f16 v0, v0, v64
v_pk_add_f16 v1, v1, v65
v_pk_add_f16 v2, v2, v66
v_pk_add_f16 v3, v3, v67
v_cmp_u_f16 vcc, v0, v2
s_cbranch_vccnz main_kernel_c2_m0_f
main_kernel_c2_m0:
v_smfmac_f32_16x16x64_f16 v[80:83], v[0:3], a[0:7], v112
ds_write_b128 v116, v[0:3] offset:2048
v_smfmac_f32_16x16x64_f16 v[84:87], v[0:3], a[128:135], v112
buffer_load_dword v123, v121, s[4:7], 0 offen sc1
s_waitcnt vmcnt(5)
v_pk_add_f16 v16, v16, v68
v_pk_add_f16 v17, v17, v69
v_pk_add_f16 v18, v18, v70
v_pk_add_f16 v19, v19, v71
v_cmp_u_f16 vcc, v16, v18
s_waitcnt lgkmcnt(0)
s_barrier
ds_read_b128 v[4:7], v116 offset:3072
s_cbranch_vccnz main_kernel_c2_m1_f
main_kernel_c2_m1:
v_smfmac_f32_16x16x64_f16 v[80:83], v[16:19], a[8:15], v112
ds_write_b128 v116, v[16:19] offset:6144
v_smfmac_f32_16x16x64_f16 v[84:87], v[16:19], a[136:143], v112
ds_read_b128 v[8:11], v116 offset:0
v_smfmac_f32_16x16x64_f16 v[88:91], v[0:3], v[128:135], v112
ds_read_b128 v[12:15], v116 offset:1024
s_waitcnt lgkmcnt(3)
v_smfmac_f32_16x16x64_f16 v[80:83], v[4:7], a[32:39], v112
v_smfmac_f32_16x16x64_f16 v[84:87], v[4:7], a[160:167], v112
v_smfmac_f32_16x16x64_f16 v[88:91], v[4:7], v[136:143], v112
s_waitcnt lgkmcnt(2)
s_barrier
s_waitcnt lgkmcnt(1)
v_smfmac_f32_16x16x64_f16 v[80:83], v[8:11], a[64:71], v112
s_waitcnt vmcnt(3)
ds_read_b128 v[20:23], v116 offset:7168
v_pk_add_f16 v32, v32, v72
v_smfmac_f32_16x16x64_f16 v[84:87], v[8:11], a[192:199], v112
ds_read_b128 v[24:27], v116 offset:4096
s_waitcnt lgkmcnt(2)
v_pk_add_f16 v33, v33, v73
v_smfmac_f32_16x16x64_f16 v[80:83], v[12:15], a[96:103], v112
ds_read_b128 v[28:31], v116 offset:5120
v_pk_add_f16 v34, v34, v74
v_smfmac_f32_16x16x64_f16 v[84:87], v[12:15], a[224:231], v112
s_waitcnt lgkmcnt(2)
v_pk_add_f16 v35, v35, v75
v_smfmac_f32_16x16x64_f16 v[80:83], v[20:23], a[40:47], v112
v_cmp_u_f16 vcc, v32, v34
v_smfmac_f32_16x16x64_f16 v[84:87], v[20:23], a[168:175], v112
ds_write_b128 v116, v[32:35] offset:10240
s_cbranch_vccnz main_kernel_c2_m2_f
main_kernel_c2_m2:
v_smfmac_f32_16x16x64_f16 v[80:83], v[32:35], a[16:23], v112
buffer_load_dwordx4 v[96:99], v116, s[4:7], s28 offen sc1
v_smfmac_f32_16x16x64_f16 v[84:87], v[32:35], a[144:151], v112
s_add_u32 s28, s28, 0x40000
s_waitcnt lgkmcnt(2)
v_smfmac_f32_16x16x64_f16 v[80:83], v[24:27], a[72:79], v112
s_waitcnt vmcnt(2)
v_pk_add_f16 v48, v48, v76
v_smfmac_f32_16x16x64_f16 v[84:87], v[24:27], a[200:207], v112
s_waitcnt lgkmcnt(0)
s_barrier
ds_read_b128 v[36:39], v116 offset:11264
v_pk_add_f16 v49, v49, v77
v_smfmac_f32_16x16x64_f16 v[80:83], v[28:31], a[104:111], v112
ds_read_b128 v[40:43], v116 offset:8192
v_pk_add_f16 v50, v50, v78
v_smfmac_f32_16x16x64_f16 v[84:87], v[28:31], a[232:239], v112
ds_read_b128 v[44:47], v116 offset:9216
v_pk_add_f16 v51, v51, v79
v_smfmac_f32_16x16x64_f16 v[88:91], v[8:11], v[144:151], v112
s_waitcnt lgkmcnt(2)
v_cmp_u_f16 vcc, v48, v50
v_smfmac_f32_16x16x64_f16 v[80:83], v[36:39], a[48:55], v112
ds_write_b128 v116, v[48:51] offset:14336
s_cbranch_vccnz main_kernel_c2_m3_f
main_kernel_c2_m3:
v_smfmac_f32_16x16x64_f16 v[80:83], v[48:51], a[24:31], v112
v_smfmac_f32_16x16x64_f16 v[84:87], v[48:51], a[152:159], v112
v_smfmac_f32_16x16x64_f16 v[84:87], v[36:39], a[176:183], v112
s_waitcnt lgkmcnt(2)
v_smfmac_f32_16x16x64_f16 v[80:83], v[40:43], a[80:87], v112
s_waitcnt lgkmcnt(0)
s_barrier
ds_read_b128 v[52:55], v116 offset:15360
v_smfmac_f32_16x16x64_f16 v[84:87], v[40:43], a[208:215], v112
s_add_u32 s19, s52, s54
ds_read_b128 v[56:59], v116 offset:12288
v_smfmac_f32_16x16x64_f16 v[80:83], v[44:47], a[112:119], v112
s_add_u32 s18, s18, 0x40000
ds_read_b128 v[60:63], v116 offset:13312
v_smfmac_f32_16x16x64_f16 v[84:87], v[44:47], a[240:247], v112
s_bitset0_b32 s18, 20
s_waitcnt lgkmcnt(2)
v_smfmac_f32_16x16x64_f16 v[80:83], v[52:55], a[56:63], v112
s_cmp_eq_u32 s17, 30
s_cselect_b32 s32, s53, 0x10000
s_waitcnt lgkmcnt(1)
v_smfmac_f32_16x16x64_f16 v[80:83], v[56:59], a[88:95], v112
s_add_u32 s52, s52, s32
s_waitcnt lgkmcnt(0)
v_smfmac_f32_16x16x64_f16 v[80:83], v[60:63], a[120:127], v112
s_sub_u32 s24, 0x20000, s32
ds_read_b128 v[64:67], v116 offset:24576
v_smfmac_f32_16x16x64_f16 v[84:87], v[52:55], a[184:191], v112
s_add_u32 s55, s55, s24
ds_read_b128 v[68:71], v116 offset:28672
v_smfmac_f32_16x16x64_f16 v[84:87], v[56:59], a[216:223], v112
ds_read_b128 v[72:75], v116 offset:25600
s_nop 0
v_cvt_pk_bf16_f32 v92, v80, v81
v_smfmac_f32_16x16x64_f16 v[84:87], v[60:63], a[248:255], v112
ds_read_b128 v[76:79], v116 offset:29696
s_nop 0
v_cvt_pk_bf16_f32 v93, v82, v83
v_smfmac_f32_16x16x64_f16 v[88:91], v[12:15], v[152:159], v112
s_nop 3
v_cvt_pk_bf16_f32 v94, v84, v85
v_cvt_pk_bf16_f32 v95, v86, v87
s_mov_b32 vcc_lo, 0xcccccccc
s_mov_b32 vcc_hi, 0xcccccccc
v_mfma_f32_16x16x32_bf16 v[84:87], v[92:95], v[104:107], 0
v_add_u32 v121, v121, v122
v_writelane_b32 v121, s55, 39
s_nop 0
v_smfmac_f32_16x16x64_f16 v[88:91], v[16:19], v[160:167], v112
s_nop 2
s_cmp_eq_u32 s17, 63
v_cvt_pk_bf16_f32 v114, v84, v85
v_cvt_pk_bf16_f32 v115, v86, v87
buffer_store_dwordx2 v[114:115], v117, s[4:7], s21 offen
s_cbranch_scc1 main_kernel_c2_last
ds_write_b64 v117, v[114:115] offset:17408
v_smfmac_f32_16x16x64_f16 v[88:91], v[20:23], v[168:175], v112
v_smfmac_f32_16x16x64_f16 v[88:91], v[24:27], v[176:183], v112
v_smfmac_f32_16x16x64_f16 v[88:91], v[28:31], v[184:191], v112
v_smfmac_f32_16x16x64_f16 v[88:91], v[32:35], v[192:199], v112
s_waitcnt lgkmcnt(0)
s_barrier
ds_read_b128 v[0:3], v116 offset:16384
v_smfmac_f32_16x16x64_f16 v[88:91], v[36:39], v[200:207], v112
ds_read_b128 v[4:7], v116 offset:17408
v_smfmac_f32_16x16x64_f16 v[88:91], v[40:43], v[208:215], v112
ds_read_b128 v[16:19], v116 offset:26624
v_smfmac_f32_16x16x64_f16 v[88:91], v[44:47], v[216:223], v112
ds_read_b128 v[20:23], v116 offset:30720
v_smfmac_f32_16x16x64_f16 v[88:91], v[48:51], v[224:231], v112
ds_read_b128 v[24:27], v116 offset:27648
v_smfmac_f32_16x16x64_f16 v[88:91], v[52:55], v[232:239], v112
ds_read_b128 v[28:31], v116 offset:31744
v_smfmac_f32_16x16x64_f16 v[88:91], v[56:59], v[240:247], v112
v_smfmac_f32_16x16x64_f16 v[88:91], v[60:63], v[248:255], v112
s_waitcnt lgkmcnt(5)
v_mfma_f32_16x16x32_bf16 v[80:83], v[64:67], v[0:3], 0
v_mfma_f32_16x16x32_bf16 v[84:87], v[68:71], v[0:3], 0
buffer_load_dwordx4 v[8:11], v116, s[4:7], s20 offen offset:0 sc1
v_mfma_f32_16x16x32_bf16 v[92:95], v[0:3], v[0:3], 0
buffer_load_dwordx4 v[12:15], v116, s[4:7], s20 offen offset:1024 sc1
v_permlane32_swap_b32 v88, v90
s_waitcnt lgkmcnt(4)
v_mfma_f32_16x16x32_bf16 v[80:83], v[72:75], v[4:7], v[80:83]
v_permlane32_swap_b32 v89, v91
v_mfma_f32_16x16x32_bf16 v[84:87], v[76:79], v[4:7], v[84:87]
v_pk_add_f32 v[88:89], v[88:89], v[90:91]
v_mfma_f32_16x16x32_bf16 v[92:95], v[4:7], v[4:7], v[92:95]
v_cvt_pk_bf16_f32 v124, v88, v89
v_mov_b32 v65, 0
s_waitcnt lgkmcnt(0)
s_waitcnt vmcnt(1)
v_mfma_f32_16x16x32_bf16 v[88:91], v[8:11], v[8:11], v[92:95]
v_mfma_f32_16x16x32_bf16 v[0:3], v[16:19], v[8:11], v[80:83]
v_cmp_u_f32 s[0:1], v8, v10
v_mfma_f32_16x16x32_bf16 v[4:7], v[20:23], v[8:11], v[84:87]
s_waitcnt vmcnt(0)
v_mfma_f32_16x16x32_bf16 v[88:91], v[12:15], v[12:15], v[88:91]
v_mfma_f32_16x16x32_bf16 v[0:3], v[24:27], v[12:15], v[0:3]
v_cmp_u_f32 s[32:33], v12, v14
v_mfma_f32_16x16x32_bf16 v[4:7], v[28:31], v[12:15], v[4:7]
s_or_b64 s[0:1], s[0:1], s[32:33]
s_cbranch_scc1 main_kernel_c2_z_f
main_kernel_c2_z:
v_mul_f32 v88, s30, v88
v_mul_f32 v89, s30, v89
v_exp_f32 v88, v88
v_exp_f32 v89, v89
v_cndmask_b32_dpp v0, v2, v0, vcc quad_perm:[2,3,2,3] row_mask:0xf bank_mask:0xf
v_cvt_pk_bf16_f32 v64, v88, v89
v_cndmask_b32_dpp v1, v3, v1, vcc quad_perm:[2,3,2,3] row_mask:0xf bank_mask:0xf
v_exp_f32 v0, v0
v_mfma_f32_16x16x16_bf16 v[16:19], v[100:101], v[64:65], 0
v_exp_f32 v1, v1
v_cndmask_b32_dpp v4, v6, v4, vcc quad_perm:[2,3,2,3] row_mask:0xf bank_mask:0xf
v_mfma_f32_16x16x16_bf16 v[8:11], v[124:125], v[64:65], 0
v_cndmask_b32_dpp v5, v7, v5, vcc quad_perm:[2,3,2,3] row_mask:0xf bank_mask:0xf
v_exp_f32 v4, v4
v_exp_f32 v5, v5
v_cvt_pk_bf16_f32 v92, v0, v1
v_cvt_pk_bf16_f32 v94, v4, v5
v_mov_b32 v80, 0
v_mov_b32_dpp v93, v92 quad_perm:[0,1,0,1] row_mask:0xf bank_mask:0xf
v_mov_b32_dpp v95, v94 quad_perm:[0,1,0,1] row_mask:0xf bank_mask:0xf
v_mov_b32 v81, 0
v_mov_b32 v82, 0
v_mfma_f32_16x16x32_bf16 v[16:19], v[100:103], v[92:95], v[16:19]
v_mov_b32 v83, 0
v_mov_b32 v84, 0
v_mfma_f32_16x16x32_bf16 v[8:11], v[96:99], v[92:95], v[8:11]
s_nop 1
v_mov_b32 v85, 0
v_mov_b32 v86, 0
v_mov_b32 v87, 0
v_rcp_f32 v126, v16
v_subrev_u32 v127, 0x21800000, v16
v_cmp_lt_u32 vcc, 0x3c000000, v127
v_pk_mul_f32 v[8:9], v[8:9], v[126:127] op_sel_hi:[1,0]
v_pk_mul_f32 v[10:11], v[10:11], v[126:127] op_sel_hi:[1,0]
s_and_b32 s32, vcc_lo, 0xcccc
v_cvt_pk_bf16_f32 v126, v8, v9
v_cvt_pk_bf16_f32 v127, v10, v11
s_cbranch_scc1 main_kernel_c2_sm_f
main_kernel_c2_ost:
buffer_store_dwordx2 v[126:127], v118, s[4:7], s22 offen
v_cmp_eq_u32 s[0:1], 0, v123
v_mov_b32 v24, -1
v_mov_b32 v25, -1
v_mov_b32 v26, -1
v_mov_b32 v27, -1
ds_read_b128 v[32:35], v113 offset:0
ds_read_b128 v[36:39], v113 offset:1024
ds_read_b128 v[40:43], v113 offset:2048
ds_read_b128 v[44:47], v113 offset:3072
ds_read_b128 v[48:51], v113 offset:4096
ds_read_b128 v[52:55], v113 offset:5120
s_and_b32 s10, s1, 0x3f00
buffer_store_dwordx4 v[24:27], v116, s[4:7], s3 offen
s_barrier
buffer_load_dwordx4 v[0:3], v116, s[4:7], s23 offen sc1
ds_read_b128 v[56:59], v113 offset:6144
ds_read_b128 v[60:63], v113 offset:7168
s_add_u32 s37, s37, 65536
s_add_u32 s26, s26, 65536
s_nop 1
s_xor_b32 s32, s23, 1024
buffer_load_dwordx4 v[4:7], v116, s[4:7], s32 offen sc1
ds_read_b128 v[64:67], v113 offset:8192
ds_read_b128 v[68:71], v113 offset:9216
s_nop 3
s_xor_b32 s32, s23, 2048
buffer_load_dwordx4 v[8:11], v116, s[4:7], s32 offen sc1
ds_read_b128 v[72:75], v113 offset:10240
ds_read_b128 v[76:79], v113 offset:11264
s_nop 3
s_xor_b32 s32, s23, 3072
buffer_load_dwordx4 v[12:15], v116, s[4:7], s32 offen sc1
ds_read_b128 v[88:91], v113 offset:12288
ds_read_b128 v[92:95], v113 offset:13312
s_nop 3
s_xor_b32 s32, s23, 4096
buffer_load_dwordx4 v[16:19], v116, s[4:7], s32 offen sc1
s_nop 7
s_xor_b32 s32, s23, 5120
buffer_load_dwordx4 v[20:23], v116, s[4:7], s32 offen sc1
s_nop 7
s_xor_b32 s32, s23, 6144
buffer_load_dwordx4 v[24:27], v116, s[4:7], s32 offen sc1
s_nop 7
s_xor_b32 s32, s23, 7168
buffer_load_dwordx4 v[28:31], v116, s[4:7], s32 offen sc1
s_waitcnt lgkmcnt(12)
s_waitcnt vmcnt(7)
v_cmp_u_f32 vcc, v0, v2
s_cbranch_vccnz main_kernel_c2_o0_f
main_kernel_c2_o0:
v_smfmac_f32_16x16x64_bf16 v[80:83], v[0:3], v[32:39], v112
ds_read_b128 v[32:35], v113 offset:14336
ds_read_b128 v[36:39], v113 offset:15360
s_waitcnt lgkmcnt(12)
s_waitcnt vmcnt(6)
v_cmp_u_f32 vcc, v4, v6
v_smfmac_f32_16x16x64_bf16 v[84:87], v[0:3], v[40:47], v112
ds_read_b128 v[40:43], v113 offset:16384
ds_read_b128 v[44:47], v113 offset:17408
buffer_store_dwordx2 v[114:115], v119, s[4:7], s37 offen sc1
s_cbranch_vccnz main_kernel_c2_o1_f
main_kernel_c2_o1:
s_waitcnt lgkmcnt(12)
v_smfmac_f32_16x16x64_bf16 v[80:83], v[4:7], v[48:55], v112
ds_read_b128 v[48:51], v113 offset:18432
ds_read_b128 v[52:55], v113 offset:19456
s_waitcnt lgkmcnt(12)
s_waitcnt vmcnt(6)
v_cmp_u_f32 vcc, v8, v10
v_smfmac_f32_16x16x64_bf16 v[84:87], v[4:7], v[56:63], v112
ds_read_b128 v[56:59], v113 offset:20480
ds_read_b128 v[60:63], v113 offset:21504
buffer_store_dword v124, v120, s[4:7], s26 offen sc1
s_cbranch_vccnz main_kernel_c2_o2_f
main_kernel_c2_o2:
s_waitcnt lgkmcnt(12)
v_smfmac_f32_16x16x64_bf16 v[80:83], v[8:11], v[64:71], v112
ds_read_b128 v[64:67], v113 offset:22528
ds_read_b128 v[68:71], v113 offset:23552
s_waitcnt lgkmcnt(12)
s_waitcnt vmcnt(6)
v_cmp_u_f32 vcc, v12, v14
v_smfmac_f32_16x16x64_bf16 v[84:87], v[8:11], v[72:79], v112
ds_read_b128 v[72:75], v113 offset:24576
ds_read_b128 v[76:79], v113 offset:25600
s_cbranch_vccnz main_kernel_c2_o3_f
main_kernel_c2_o3:
s_waitcnt lgkmcnt(12)
v_smfmac_f32_16x16x64_bf16 v[80:83], v[12:15], v[88:95], v112
ds_read_b128 v[88:91], v113 offset:26624
ds_read_b128 v[92:95], v113 offset:27648
s_waitcnt lgkmcnt(12)
s_waitcnt vmcnt(5)
v_cmp_u_f32 vcc, v16, v18
v_smfmac_f32_16x16x64_bf16 v[84:87], v[12:15], v[32:39], v112
ds_read_b128 v[32:35], v113 offset:28672
ds_read_b128 v[36:39], v113 offset:29696
s_cbranch_vccnz main_kernel_c2_o4_f
main_kernel_c2_o4:
s_waitcnt lgkmcnt(12)
v_smfmac_f32_16x16x64_bf16 v[80:83], v[16:19], v[40:47], v112
ds_read_b128 v[40:43], v113 offset:30720
ds_read_b128 v[44:47], v113 offset:31744
s_waitcnt lgkmcnt(12)
s_waitcnt vmcnt(4)
v_cmp_u_f32 vcc, v20, v22
v_smfmac_f32_16x16x64_bf16 v[84:87], v[16:19], v[48:55], v112
s_cbranch_vccnz main_kernel_c2_o5_f
main_kernel_c2_o5:
s_waitcnt lgkmcnt(10)
v_smfmac_f32_16x16x64_bf16 v[80:83], v[20:23], v[56:63], v112
s_waitcnt lgkmcnt(8)
s_waitcnt vmcnt(3)
v_cmp_u_f32 vcc, v24, v26
v_smfmac_f32_16x16x64_bf16 v[84:87], v[20:23], v[64:71], v112
s_cbranch_vccnz main_kernel_c2_o6_f
main_kernel_c2_o6:
s_waitcnt lgkmcnt(6)
v_smfmac_f32_16x16x64_bf16 v[80:83], v[24:27], v[72:79], v112
s_waitcnt lgkmcnt(4)
v_smfmac_f32_16x16x64_bf16 v[84:87], v[24:27], v[88:95], v112
s_waitcnt lgkmcnt(2)
s_waitcnt vmcnt(2)
v_cmp_u_f32 vcc, v28, v30
s_cbranch_vccnz main_kernel_c2_o7_f
main_kernel_c2_o7:
v_smfmac_f32_16x16x64_bf16 v[80:83], v[28:31], v[32:39], v112
s_waitcnt lgkmcnt(0)
v_smfmac_f32_16x16x64_bf16 v[84:87], v[28:31], v[40:47], v112
s_nop 4
v_cvt_pk_bf16_f32 v80, v80, v81
v_cvt_pk_bf16_f32 v81, v82, v83
ds_write_b64 v116, v[80:81] offset:21504
v_cvt_pk_bf16_f32 v82, v84, v85
v_cvt_pk_bf16_f32 v83, v86, v87
ds_write_b64 v116, v[82:83] offset:23552
s_waitcnt lgkmcnt(0)
s_barrier
ds_read_b128 v[72:75], v116 offset:20480
ds_read_b128 v[76:79], v116 offset:21504
s_mov_b32 m0, 28672
s_cmp_lg_u32 s10, 0
s_waitcnt lgkmcnt(1)
v_mfma_f32_16x16x32_bf16 v[64:67], v[72:75], v[108:111], 0
s_waitcnt lgkmcnt(0)
v_mfma_f32_16x16x32_bf16 v[64:67], v[76:79], v[108:111], v[64:67]
s_nop 7
v_cvt_pk_f16_f32 v68, v64, v65
v_cvt_pk_f16_f32 v69, v66, v67
buffer_store_dwordx2 v[68:69], v125, s[4:7], s25 offen
s_cbranch_scc1 main_kernel_c2_kvw
main_kernel_c2_kvok:
s_nop 3
buffer_load_dwordx4 v116, s[4:7], s27 offen sc1 lds
buffer_load_dwordx4 v116, s[4:7], s27 offen offset:1024 sc1 lds
s_mov_b32 m0, 30720
s_xor_b32 s32, s27, 2048
buffer_load_dwordx4 v116, s[4:7], s32 offen offset:1024 sc1 lds
s_add_u32 s27, s27, 0x40000
s_branch main_kernel_c2_top
main_kernel_c2_kvw:
s_mov_b32 exec_lo, 0
s_mov_b32 exec_hi, 0x3f00
v_subrev_u32 v127, 128, v121
main_kernel_c2_kvp:
buffer_load_dword v126, v127, s[4:7], 0 offen sc1
s_waitcnt vmcnt(0)
v_cmp_eq_u32 vcc, 0, v126
s_cbranch_vccz main_kernel_c2_kvp_ok
s_sleep 2
s_sub_u32 s29, s29, 1
s_cbranch_scc0 main_kernel_c2_kvp
s_branch main_kernel_end
main_kernel_c2_kvp_ok:
s_mov_b64 exec, -1
s_branch main_kernel_c2_kvok
main_kernel_c2_last:
s_add_u32 s37, s37, 65536
s_add_u32 s26, s26, 65536
buffer_store_dwordx2 v[114:115], v119, s[4:7], s37 offen sc1
v_smfmac_f32_16x16x64_f16 v[88:91], v[20:23], v[168:175], v112
v_smfmac_f32_16x16x64_f16 v[88:91], v[24:27], v[176:183], v112
v_smfmac_f32_16x16x64_f16 v[88:91], v[28:31], v[184:191], v112
v_smfmac_f32_16x16x64_f16 v[88:91], v[32:35], v[192:199], v112
v_smfmac_f32_16x16x64_f16 v[88:91], v[36:39], v[200:207], v112
v_smfmac_f32_16x16x64_f16 v[88:91], v[40:43], v[208:215], v112
v_smfmac_f32_16x16x64_f16 v[88:91], v[44:47], v[216:223], v112
v_smfmac_f32_16x16x64_f16 v[88:91], v[48:51], v[224:231], v112
v_smfmac_f32_16x16x64_f16 v[88:91], v[52:55], v[232:239], v112
v_smfmac_f32_16x16x64_f16 v[88:91], v[56:59], v[240:247], v112
v_smfmac_f32_16x16x64_f16 v[88:91], v[60:63], v[248:255], v112
s_nop 7
v_permlane32_swap_b32 v88, v90
s_nop 1
v_permlane32_swap_b32 v89, v91
s_nop 1
v_pk_add_f32 v[88:89], v[88:89], v[90:91]
s_nop 1
v_cvt_pk_bf16_f32 v124, v88, v89
s_nop 1
buffer_store_dword v124, v120, s[4:7], s26 offen sc1
s_branch main_kernel_end
main_kernel_c2_m0_f:
s_waitcnt lgkmcnt(0)
buffer_load_dwordx4 v[0:3], v116, s[4:7], s18 offen sc1
buffer_load_dwordx4 v[64:67], v116, s[4:7], s19 offen sc1
s_xor_b32 s32, s18, 1024
buffer_load_dwordx4 v[16:19], v116, s[4:7], s32 offen sc1
s_xor_b32 s32, s19, 1024
buffer_load_dwordx4 v[68:71], v116, s[4:7], s32 offen sc1
s_xor_b32 s32, s18, 2048
buffer_load_dwordx4 v[32:35], v116, s[4:7], s32 offen sc1
s_xor_b32 s32, s19, 2048
buffer_load_dwordx4 v[72:75], v116, s[4:7], s32 offen sc1
s_xor_b32 s32, s18, 3072
buffer_load_dwordx4 v[48:51], v116, s[4:7], s32 offen sc1
s_xor_b32 s32, s19, 3072
buffer_load_dwordx4 v[76:79], v116, s[4:7], s32 offen sc1
s_sub_u32 s29, s29, 1
s_cbranch_scc1 main_kernel_end
s_waitcnt vmcnt(0)
v_max_u32 v126, v0, v2
v_max3_u32 v126, v126, v64, v66
v_cmp_eq_u32 vcc, -1, v126
s_cbranch_vccnz main_kernel_c2_m0_f
v_pk_add_f16 v0, v0, v64
v_pk_add_f16 v1, v1, v65
v_pk_add_f16 v2, v2, v66
v_pk_add_f16 v3, v3, v67
s_nop 0
s_branch main_kernel_c2_m0
main_kernel_c2_m1_f:
s_waitcnt lgkmcnt(0)
s_xor_b32 s32, s18, 1024
buffer_load_dwordx4 v[16:19], v116, s[4:7], s32 offen sc1
s_xor_b32 s32, s19, 1024
buffer_load_dwordx4 v[68:71], v116, s[4:7], s32 offen sc1
s_xor_b32 s32, s18, 2048
buffer_load_dwordx4 v[32:35], v116, s[4:7], s32 offen sc1
s_xor_b32 s32, s19, 2048
buffer_load_dwordx4 v[72:75], v116, s[4:7], s32 offen sc1
s_xor_b32 s32, s18, 3072
buffer_load_dwordx4 v[48:51], v116, s[4:7], s32 offen sc1
s_xor_b32 s32, s19, 3072
buffer_load_dwordx4 v[76:79], v116, s[4:7], s32 offen sc1
s_sub_u32 s29, s29, 1
s_cbranch_scc1 main_kernel_end
s_waitcnt vmcnt(0)
v_max_u32 v126, v16, v18
v_max3_u32 v126, v126, v68, v70
v_cmp_eq_u32 vcc, -1, v126
s_cbranch_vccnz main_kernel_c2_m1_f
v_pk_add_f16 v16, v16, v68
v_pk_add_f16 v17, v17, v69
v_pk_add_f16 v18, v18, v70
v_pk_add_f16 v19, v19, v71
s_nop 0
s_branch main_kernel_c2_m1
main_kernel_c2_m2_f:
s_waitcnt lgkmcnt(0)
s_xor_b32 s32, s18, 2048
buffer_load_dwordx4 v[32:35], v116, s[4:7], s32 offen sc1
s_xor_b32 s32, s19, 2048
buffer_load_dwordx4 v[72:75], v116, s[4:7], s32 offen sc1
s_xor_b32 s32, s18, 3072
buffer_load_dwordx4 v[48:51], v116, s[4:7], s32 offen sc1
s_xor_b32 s32, s19, 3072
buffer_load_dwordx4 v[76:79], v116, s[4:7], s32 offen sc1
s_sub_u32 s29, s29, 1
s_cbranch_scc1 main_kernel_end
s_waitcnt vmcnt(0)
v_max_u32 v126, v32, v34
v_max3_u32 v126, v126, v72, v74
v_cmp_eq_u32 vcc, -1, v126
s_cbranch_vccnz main_kernel_c2_m2_f
v_pk_add_f16 v32, v32, v72
v_pk_add_f16 v33, v33, v73
v_pk_add_f16 v34, v34, v74
v_pk_add_f16 v35, v35, v75
ds_write_b128 v116, v[32:35] offset:10240
s_branch main_kernel_c2_m2
main_kernel_c2_m3_f:
s_waitcnt lgkmcnt(0)
s_xor_b32 s32, s18, 3072
buffer_load_dwordx4 v[48:51], v116, s[4:7], s32 offen sc1
s_xor_b32 s32, s19, 3072
buffer_load_dwordx4 v[76:79], v116, s[4:7], s32 offen sc1
s_sub_u32 s29, s29, 1
s_cbranch_scc1 main_kernel_end
s_waitcnt vmcnt(0)
v_max_u32 v126, v48, v50
v_max3_u32 v126, v126, v76, v78
v_cmp_eq_u32 vcc, -1, v126
s_cbranch_vccnz main_kernel_c2_m3_f
v_pk_add_f16 v48, v48, v76
v_pk_add_f16 v49, v49, v77
v_pk_add_f16 v50, v50, v78
v_pk_add_f16 v51, v51, v79
ds_write_b128 v116, v[48:51] offset:14336
s_branch main_kernel_c2_m3
main_kernel_c2_z_f:
buffer_load_dwordx4 v[8:11], v116, s[4:7], s20 offen offset:0 sc1
buffer_load_dwordx4 v[12:15], v116, s[4:7], s20 offen offset:1024 sc1
s_memtime s[32:33]
ds_read_b32 v126, v116 offset:18432
s_sub_u32 s34, s19, s54
s_xor_b32 s34, s34, 0x2000
s_lshl_b32 s35, s12, 15
s_add_u32 s34, s34, s35
s_lshl_b32 s35, s13, 8
s_add_u32 s35, s35, s34
s_add_u32 s34, s34, 0x4000
s_waitcnt lgkmcnt(0)
s_sub_u32 s32, s32, 450
v_sub_u32 v127, s32, v126
buffer_store_dword v127, off, s[4:7], s34
s_sub_u32 s29, s29, 1
s_cbranch_scc1 main_kernel_end
s_waitcnt vmcnt(1)
main_kernel_c2_z_g:
v_max_u32 v126, v8, v10
v_max3_u32 v126, v126, v12, v14
v_cmp_eq_u32 vcc, -1, v126
s_cbranch_vccnz main_kernel_c2_z_h
v_mfma_f32_16x16x32_bf16 v[88:91], v[8:11], v[8:11], v[92:95]
v_mfma_f32_16x16x32_bf16 v[0:3], v[16:19], v[8:11], v[80:83]
v_mfma_f32_16x16x32_bf16 v[4:7], v[20:23], v[8:11], v[84:87]
v_mfma_f32_16x16x32_bf16 v[88:91], v[12:15], v[12:15], v[88:91]
v_mfma_f32_16x16x32_bf16 v[0:3], v[24:27], v[12:15], v[0:3]
v_mfma_f32_16x16x32_bf16 v[4:7], v[28:31], v[12:15], v[4:7]
buffer_store_dword v127, off, s[4:7], s35 offset:132 sc1
s_mov_b32 vcc_lo, 0xcccccccc
s_mov_b32 vcc_hi, 0xcccccccc
s_branch main_kernel_c2_z
main_kernel_c2_z_h:
buffer_load_dwordx4 v[8:11], v116, s[4:7], s20 offen offset:0 sc1
buffer_load_dwordx4 v[12:15], v116, s[4:7], s20 offen offset:1024 sc1
s_sub_u32 s29, s29, 1
s_cbranch_scc1 main_kernel_end
v_add_u32 v127, 300, v127
s_waitcnt vmcnt(0)
s_branch main_kernel_c2_z_g
main_kernel_c2_sm_f:
s_waitcnt vmcnt(0) lgkmcnt(0)
buffer_load_dwordx4 v[8:11], v116, s[4:7], s20 offen offset:0 sc1
buffer_load_dwordx4 v[12:15], v116, s[4:7], s20 offen offset:1024 sc1
ds_read_b128 v[0:3], v116 offset:16384
ds_read_b128 v[4:7], v116 offset:17408
ds_read_b128 v[64:67], v116 offset:24576
ds_read_b128 v[68:71], v116 offset:28672
ds_read_b128 v[72:75], v116 offset:25600
ds_read_b128 v[76:79], v116 offset:29696
ds_read_b128 v[16:19], v116 offset:26624
ds_read_b128 v[20:23], v116 offset:30720
ds_read_b128 v[24:27], v116 offset:27648
ds_read_b128 v[28:31], v116 offset:31744
s_waitcnt vmcnt(0)
s_waitcnt lgkmcnt(0)
v_mfma_f32_16x16x32_bf16 v[80:83], v[64:67], v[0:3], 0
v_mfma_f32_16x16x32_bf16 v[84:87], v[68:71], v[0:3], 0
v_mfma_f32_16x16x32_bf16 v[92:95], v[0:3], v[0:3], 0
v_mfma_f32_16x16x32_bf16 v[80:83], v[72:75], v[4:7], v[80:83]
v_mfma_f32_16x16x32_bf16 v[84:87], v[76:79], v[4:7], v[84:87]
v_mfma_f32_16x16x32_bf16 v[92:95], v[4:7], v[4:7], v[92:95]
v_mfma_f32_16x16x32_bf16 v[0:3], v[16:19], v[8:11], v[80:83]
v_mfma_f32_16x16x32_bf16 v[4:7], v[20:23], v[8:11], v[84:87]
v_mfma_f32_16x16x32_bf16 v[88:91], v[8:11], v[8:11], v[92:95]
v_mfma_f32_16x16x32_bf16 v[0:3], v[24:27], v[12:15], v[0:3]
v_mfma_f32_16x16x32_bf16 v[4:7], v[28:31], v[12:15], v[4:7]
v_mfma_f32_16x16x32_bf16 v[88:91], v[12:15], v[12:15], v[88:91]
s_nop 7
v_mov_b32 v65, 0
v_max_f32 v126, v88, v89
v_mul_f32 v126, s30, v126
v_max3_f32 v126, v126, v0, v1
v_max3_f32 v126, v126, v2, v3
v_max3_f32 v126, v126, v4, v5
v_max3_f32 v126, v126, v6, v7
v_mov_b32 v127, v126
s_nop 1
v_permlane32_swap_b32 v126, v127
v_max_f32 v126, v126, v127
v_mov_b32 v127, v126
s_nop 1
v_permlane16_swap_b32 v126, v127
v_max_f32 v126, v126, v127
v_mul_f32 v127, 0x40faf233, v126
s_mov_b32 vcc_lo, 0xcccccccc
s_mov_b32 vcc_hi, 0xcccccccc
v_sub_f32 v0, v0, v126
v_sub_f32 v1, v1, v126
v_sub_f32 v2, v2, v126
v_sub_f32 v3, v3, v126
v_sub_f32 v4, v4, v126
v_sub_f32 v5, v5, v126
v_sub_f32 v6, v6, v126
v_sub_f32 v7, v7, v126
v_sub_f32 v88, v88, v127
v_sub_f32 v89, v89, v127
s_waitcnt lgkmcnt(0)
s_nop 0
v_mul_f32 v88, s30, v88
v_mul_f32 v89, s30, v89
v_exp_f32 v88, v88
v_exp_f32 v89, v89
v_cndmask_b32_dpp v0, v2, v0, vcc quad_perm:[2,3,2,3] row_mask:0xf bank_mask:0xf
v_cvt_pk_bf16_f32 v64, v88, v89
v_cndmask_b32_dpp v1, v3, v1, vcc quad_perm:[2,3,2,3] row_mask:0xf bank_mask:0xf
v_exp_f32 v0, v0
v_mfma_f32_16x16x16_bf16 v[16:19], v[100:101], v[64:65], 0
v_exp_f32 v1, v1
v_cndmask_b32_dpp v4, v6, v4, vcc quad_perm:[2,3,2,3] row_mask:0xf bank_mask:0xf
v_mfma_f32_16x16x16_bf16 v[8:11], v[124:125], v[64:65], 0
v_cndmask_b32_dpp v5, v7, v5, vcc quad_perm:[2,3,2,3] row_mask:0xf bank_mask:0xf
v_exp_f32 v4, v4
v_exp_f32 v5, v5
v_cvt_pk_bf16_f32 v92, v0, v1
v_cvt_pk_bf16_f32 v94, v4, v5
v_mov_b32 v80, 0
v_mov_b32_dpp v93, v92 quad_perm:[0,1,0,1] row_mask:0xf bank_mask:0xf
v_mov_b32_dpp v95, v94 quad_perm:[0,1,0,1] row_mask:0xf bank_mask:0xf
v_mov_b32 v81, 0
v_mov_b32 v82, 0
v_mfma_f32_16x16x32_bf16 v[16:19], v[100:103], v[92:95], v[16:19]
v_mov_b32 v83, 0
v_mov_b32 v84, 0
v_mfma_f32_16x16x32_bf16 v[8:11], v[96:99], v[92:95], v[8:11]
s_nop 1
v_mov_b32 v85, 0
v_mov_b32 v86, 0
v_mov_b32 v87, 0
v_rcp_f32 v126, v16
v_subrev_u32 v127, 0x21800000, v16
v_cmp_lt_u32 vcc, 0x3c000000, v127
v_pk_mul_f32 v[8:9], v[8:9], v[126:127] op_sel_hi:[1,0]
v_pk_mul_f32 v[10:11], v[10:11], v[126:127] op_sel_hi:[1,0]
s_and_b32 s32, vcc_lo, 0xcccc
v_cvt_pk_bf16_f32 v126, v8, v9
v_cvt_pk_bf16_f32 v127, v10, v11
s_branch main_kernel_c2_ost
main_kernel_c2_o0_f:
s_nop 0
buffer_load_dwordx4 v[0:3], v116, s[4:7], s23 offen sc1
s_xor_b32 s32, s23, 1024
buffer_load_dwordx4 v[4:7], v116, s[4:7], s32 offen sc1
s_sub_u32 s29, s29, 1
s_cbranch_scc1 main_kernel_end
s_waitcnt vmcnt(0)
v_max_u32 v126, v0, v2
v_cmp_eq_u32 vcc, -1, v126
s_cbranch_vccnz main_kernel_c2_o0_f
s_branch main_kernel_c2_o0
main_kernel_c2_o1_f:
s_nop 0
s_xor_b32 s32, s23, 1024
buffer_load_dwordx4 v[4:7], v116, s[4:7], s32 offen sc1
s_xor_b32 s32, s23, 2048
buffer_load_dwordx4 v[8:11], v116, s[4:7], s32 offen sc1
s_sub_u32 s29, s29, 1
s_cbranch_scc1 main_kernel_end
s_waitcnt vmcnt(0)
v_max_u32 v126, v4, v6
v_cmp_eq_u32 vcc, -1, v126
s_cbranch_vccnz main_kernel_c2_o1_f
s_branch main_kernel_c2_o1
main_kernel_c2_o2_f:
s_nop 0
s_xor_b32 s32, s23, 2048
buffer_load_dwordx4 v[8:11], v116, s[4:7], s32 offen sc1
s_xor_b32 s32, s23, 3072
buffer_load_dwordx4 v[12:15], v116, s[4:7], s32 offen sc1
s_sub_u32 s29, s29, 1
s_cbranch_scc1 main_kernel_end
s_waitcnt vmcnt(0)
v_max_u32 v126, v8, v10
v_cmp_eq_u32 vcc, -1, v126
s_cbranch_vccnz main_kernel_c2_o2_f
s_branch main_kernel_c2_o2
main_kernel_c2_o3_f:
s_nop 0
s_xor_b32 s32, s23, 3072
buffer_load_dwordx4 v[12:15], v116, s[4:7], s32 offen sc1
s_xor_b32 s32, s23, 4096
buffer_load_dwordx4 v[16:19], v116, s[4:7], s32 offen sc1
s_sub_u32 s29, s29, 1
s_cbranch_scc1 main_kernel_end
s_waitcnt vmcnt(0)
v_max_u32 v126, v12, v14
v_cmp_eq_u32 vcc, -1, v126
s_cbranch_vccnz main_kernel_c2_o3_f
s_branch main_kernel_c2_o3
main_kernel_c2_o4_f:
s_nop 0
s_xor_b32 s32, s23, 4096
buffer_load_dwordx4 v[16:19], v116, s[4:7], s32 offen sc1
s_xor_b32 s32, s23, 5120
buffer_load_dwordx4 v[20:23], v116, s[4:7], s32 offen sc1
s_sub_u32 s29, s29, 1
s_cbranch_scc1 main_kernel_end
s_waitcnt vmcnt(0)
v_max_u32 v126, v16, v18
v_cmp_eq_u32 vcc, -1, v126
s_cbranch_vccnz main_kernel_c2_o4_f
s_branch main_kernel_c2_o4
main_kernel_c2_o5_f:
s_nop 0
s_xor_b32 s32, s23, 5120
buffer_load_dwordx4 v[20:23], v116, s[4:7], s32 offen sc1
s_xor_b32 s32, s23, 6144
buffer_load_dwordx4 v[24:27], v116, s[4:7], s32 offen sc1
s_sub_u32 s29, s29, 1
s_cbranch_scc1 main_kernel_end
s_waitcnt vmcnt(0)
v_max_u32 v126, v20, v22
v_cmp_eq_u32 vcc, -1, v126
s_cbranch_vccnz main_kernel_c2_o5_f
s_branch main_kernel_c2_o5
main_kernel_c2_o6_f:
s_nop 0
s_xor_b32 s32, s23, 6144
buffer_load_dwordx4 v[24:27], v116, s[4:7], s32 offen sc1
s_xor_b32 s32, s23, 7168
buffer_load_dwordx4 v[28:31], v116, s[4:7], s32 offen sc1
s_sub_u32 s29, s29, 1
s_cbranch_scc1 main_kernel_end
s_waitcnt vmcnt(0)
v_max_u32 v126, v24, v26
v_cmp_eq_u32 vcc, -1, v126
s_cbranch_vccnz main_kernel_c2_o6_f
s_branch main_kernel_c2_o6
main_kernel_c2_o7_f:
s_nop 0
s_xor_b32 s32, s23, 7168
buffer_load_dwordx4 v[28:31], v116, s[4:7], s32 offen sc1
s_sub_u32 s29, s29, 1
s_cbranch_scc1 main_kernel_end
s_waitcnt vmcnt(0)
v_max_u32 v126, v28, v30
v_cmp_eq_u32 vcc, -1, v126
s_cbranch_vccnz main_kernel_c2_o7_f
s_branch main_kernel_c2_o7
.p2align 6
main_kernel_c3_top:
s_barrier
buffer_load_dwordx4 v[0:3], v116, s[4:7], s18 offen sc1
s_add_u32 s20, s20, 0x40000
s_bitset0_b32 s20, 20
s_add_u32 s21, s21, 0x40000
s_bitset0_b32 s21, 20
s_add_u32 s22, s22, 0x40000
s_bitset0_b32 s22, 20
s_add_u32 s23, s23, 0x40000
s_bitset0_b32 s23, 20
s_xor_b32 s32, s18, 1024
buffer_load_dwordx4 v[16:19], v116, s[4:7], s32 offen sc1
s_add_u32 s3, s3, 0x40000
s_bitset0_b32 s3, 20
s_add_u32 s17, s17, 1
s_bitcmp1_b32 0x77777777, s17
s_cselect_b32 s33, 0x800, 0
s_xor_b32 s54, s54, s33
s_add_u32 s25, s25, 0x40000
s_bitset0_b32 s25, 20
s_nop 0
buffer_load_dwordx4 v[64:67], v116, s[4:7], s19 offen sc1
v_mov_b32 v80, 0
v_mov_b32 v81, 0
s_nop 3
s_xor_b32 s32, s19, 1024
buffer_load_dwordx4 v[68:71], v116, s[4:7], s32 offen sc1
v_mov_b32 v82, 0
v_mov_b32 v83, 0
s_nop 3
s_xor_b32 s32, s18, 2048
buffer_load_dwordx4 v[32:35], v116, s[4:7], s32 offen sc1
v_mov_b32 v84, 0
v_mov_b32 v85, 0
s_nop 3
s_xor_b32 s32, s19, 2048
buffer_load_dwordx4 v[72:75], v116, s[4:7], s32 offen sc1
v_mov_b32 v86, 0
v_mov_b32 v87, 0
s_nop 3
s_xor_b32 s32, s18, 3072
buffer_load_dwordx4 v[48:51], v116, s[4:7], s32 offen sc1
v_mov_b32 v88, 0
v_mov_b32 v89, 0
s_nop 3
s_xor_b32 s32, s19, 3072
buffer_load_dwordx4 v[76:79], v116, s[4:7], s32 offen sc1
s_memtime s[40:41]
s_memrealtime s[80:81]
s_memrealtime s[82:83]
s_memrealtime s[84:85]
s_memrealtime s[86:87]
s_memrealtime s[88:89]
s_memrealtime s[90:91]
s_memrealtime s[92:93]
s_memrealtime s[94:95]
s_memrealtime s[96:97]
s_memrealtime s[98:99]
s_memrealtime s[100:101]
s_sub_u32 s32, s15, s16
s_lshr_b32 s33, s17, 1
s_min_u32 s33, s33, 3
s_ashr_i32 s32, s32, s33
s_add_u32 s11, s11, s32
s_sub_u32 s32, s16, s27
s_sub_u32 s32, s32, s39
s_ashr_i32 s32, s32, 2
s_add_u32 s39, s39, s32
s_mov_b32 s27, s16
s_mov_b32 s2, s31
v_mov_b32 v126, s11
s_add_u32 s32, s43, 1590
v_mov_b32 v127, s32
s_waitcnt lgkmcnt(0)
ds_write_b32 v116, v126 offset:18432
s_add_u32 s80, s80, s82
s_add_u32 s80, s80, s84
s_add_u32 s80, s80, s86
s_add_u32 s80, s80, s88
s_add_u32 s80, s80, s90
s_add_u32 s80, s80, s92
s_add_u32 s80, s80, s94
s_add_u32 s80, s80, s96
s_add_u32 s80, s80, s98
s_add_u32 s80, s80, s100
s_lshl1_add_u32 s80, s80, s11
s_sub_u32 s15, s40, s80
s_add_u32 s32, s15, s39
v_mov_b32 v126, s32
buffer_store_dwordx2 v[126:127], off, s[4:7], s44 offset:128 sc1
v_mov_b32 v90, 0
v_mov_b32 v91, 0
s_waitcnt vmcnt(6)
v_pk_add_f16 v0, v0, v64
v_pk_add_f16 v1, v1, v65
v_pk_add_f16 v2, v2, v66
v_pk_add_f16 v3, v3, v67
v_cmp_u_f16 vcc, v0, v2
s_cbranch_vccnz main_kernel_c3_m0_f
main_kernel_c3_m0:
v_smfmac_f32_16x16x64_f16 v[80:83], v[0:3], a[0:7], v112
ds_write_b128 v116, v[0:3] offset:3072
v_smfmac_f32_16x16x64_f16 v[84:87], v[0:3], a[128:135], v112
buffer_load_dword v123, v121, s[4:7], 0 offen sc1
s_waitcnt vmcnt(6)
v_pk_add_f16 v16, v16, v68
v_pk_add_f16 v17, v17, v69
v_pk_add_f16 v18, v18, v70
v_pk_add_f16 v19, v19, v71
v_cmp_u_f16 vcc, v16, v18
s_waitcnt lgkmcnt(0)
s_barrier
ds_read_b128 v[4:7], v116 offset:2048
s_cbranch_vccnz main_kernel_c3_m1_f
main_kernel_c3_m1:
v_smfmac_f32_16x16x64_f16 v[80:83], v[16:19], a[8:15], v112
ds_write_b128 v116, v[16:19] offset:7168
v_smfmac_f32_16x16x64_f16 v[84:87], v[16:19], a[136:143], v112
ds_read_b128 v[8:11], v116 offset:1024
v_smfmac_f32_16x16x64_f16 v[88:91], v[0:3], v[128:135], v112
ds_read_b128 v[12:15], v116 offset:0
s_waitcnt lgkmcnt(3)
v_smfmac_f32_16x16x64_f16 v[80:83], v[4:7], a[32:39], v112
v_smfmac_f32_16x16x64_f16 v[84:87], v[4:7], a[160:167], v112
v_smfmac_f32_16x16x64_f16 v[88:91], v[4:7], v[136:143], v112
s_waitcnt lgkmcnt(2)
s_barrier
s_waitcnt lgkmcnt(1)
v_smfmac_f32_16x16x64_f16 v[80:83], v[8:11], a[64:71], v112
s_waitcnt vmcnt(4)
ds_read_b128 v[20:23], v116 offset:6144
v_pk_add_f16 v32, v32, v72
v_smfmac_f32_16x16x64_f16 v[84:87], v[8:11], a[192:199], v112
ds_read_b128 v[24:27], v116 offset:5120
s_waitcnt lgkmcnt(2)
v_pk_add_f16 v33, v33, v73
v_smfmac_f32_16x16x64_f16 v[80:83], v[12:15], a[96:103], v112
ds_read_b128 v[28:31], v116 offset:4096
v_pk_add_f16 v34, v34, v74
v_smfmac_f32_16x16x64_f16 v[84:87], v[12:15], a[224:231], v112
s_waitcnt lgkmcnt(2)
v_pk_add_f16 v35, v35, v75
v_smfmac_f32_16x16x64_f16 v[80:83], v[20:23], a[40:47], v112
v_cmp_u_f16 vcc, v32, v34
v_smfmac_f32_16x16x64_f16 v[84:87], v[20:23], a[168:175], v112
ds_write_b128 v116, v[32:35] offset:11264
s_cbranch_vccnz main_kernel_c3_m2_f
main_kernel_c3_m2:
v_smfmac_f32_16x16x64_f16 v[80:83], v[32:35], a[16:23], v112
buffer_load_dwordx4 v[96:99], v116, s[4:7], s28 offen sc1
v_smfmac_f32_16x16x64_f16 v[84:87], v[32:35], a[144:151], v112
s_add_u32 s28, s28, 0x40000
s_waitcnt lgkmcnt(2)
v_smfmac_f32_16x16x64_f16 v[80:83], v[24:27], a[72:79], v112
s_waitcnt vmcnt(3)
v_pk_add_f16 v48, v48, v76
v_smfmac_f32_16x16x64_f16 v[84:87], v[24:27], a[200:207], v112
s_waitcnt lgkmcnt(0)
s_barrier
ds_read_b128 v[36:39], v116 offset:10240
v_pk_add_f16 v49, v49, v77
v_smfmac_f32_16x16x64_f16 v[80:83], v[28:31], a[104:111], v112
ds_read_b128 v[40:43], v116 offset:9216
v_pk_add_f16 v50, v50, v78
v_smfmac_f32_16x16x64_f16 v[84:87], v[28:31], a[232:239], v112
ds_read_b128 v[44:47], v116 offset:8192
v_pk_add_f16 v51, v51, v79
v_smfmac_f32_16x16x64_f16 v[88:91], v[8:11], v[144:151], v112
s_waitcnt lgkmcnt(2)
v_cmp_u_f16 vcc, v48, v50
v_smfmac_f32_16x16x64_f16 v[80:83], v[36:39], a[48:55], v112
ds_write_b128 v116, v[48:51] offset:15360
s_cbranch_vccnz main_kernel_c3_m3_f
main_kernel_c3_m3:
v_smfmac_f32_16x16x64_f16 v[80:83], v[48:51], a[24:31], v112
v_smfmac_f32_16x16x64_f16 v[84:87], v[48:51], a[152:159], v112
v_smfmac_f32_16x16x64_f16 v[84:87], v[36:39], a[176:183], v112
s_waitcnt lgkmcnt(2)
v_smfmac_f32_16x16x64_f16 v[80:83], v[40:43], a[80:87], v112
s_waitcnt lgkmcnt(0)
s_barrier
ds_read_b128 v[52:55], v116 offset:14336
v_smfmac_f32_16x16x64_f16 v[84:87], v[40:43], a[208:215], v112
s_memtime s[40:41]
ds_read_b128 v[56:59], v116 offset:13312
v_smfmac_f32_16x16x64_f16 v[80:83], v[44:47], a[112:119], v112
s_add_u32 s19, s52, s54
ds_read_b128 v[60:63], v116 offset:12288
v_smfmac_f32_16x16x64_f16 v[84:87], v[44:47], a[240:247], v112
s_add_u32 s18, s18, 0x40000
s_waitcnt lgkmcnt(2)
v_smfmac_f32_16x16x64_f16 v[80:83], v[52:55], a[56:63], v112
s_bitset0_b32 s18, 20
s_waitcnt lgkmcnt(1)
v_smfmac_f32_16x16x64_f16 v[80:83], v[56:59], a[88:95], v112
s_cmp_eq_u32 s17, 30
s_cselect_b32 s32, s53, 0x10000
s_waitcnt lgkmcnt(0)
v_smfmac_f32_16x16x64_f16 v[80:83], v[60:63], a[120:127], v112
s_add_u32 s52, s52, s32
ds_read_b128 v[64:67], v116 offset:24576
v_smfmac_f32_16x16x64_f16 v[84:87], v[52:55], a[184:191], v112
s_sub_u32 s24, 0x20000, s32
ds_read_b128 v[68:71], v116 offset:28672
v_smfmac_f32_16x16x64_f16 v[84:87], v[56:59], a[216:223], v112
ds_read_b128 v[72:75], v116 offset:25600
s_add_u32 s55, s55, s24
v_cvt_pk_bf16_f32 v92, v80, v81
v_smfmac_f32_16x16x64_f16 v[84:87], v[60:63], a[248:255], v112
ds_read_b128 v[76:79], v116 offset:29696
s_nop 0
v_cvt_pk_bf16_f32 v93, v82, v83
v_smfmac_f32_16x16x64_f16 v[88:91], v[12:15], v[152:159], v112
s_nop 3
v_cvt_pk_bf16_f32 v94, v84, v85
v_cvt_pk_bf16_f32 v95, v86, v87
s_mov_b32 vcc_lo, 0xcccccccc
s_mov_b32 vcc_hi, 0xcccccccc
v_mfma_f32_16x16x32_bf16 v[84:87], v[92:95], v[104:107], 0
v_add_u32 v121, v121, v122
s_waitcnt lgkmcnt(0)
s_sub_u32 s31, s40, s11
v_smfmac_f32_16x16x64_f16 v[88:91], v[16:19], v[160:167], v112
s_sub_u32 s32, s31, s43
s_sub_u32 s47, 1590, s32
s_max_i32 s47, s47, 0
s_cmp_eq_u32 s17, 63
v_cvt_pk_bf16_f32 v114, v84, v85
v_cvt_pk_bf16_f32 v115, v86, v87
buffer_store_dwordx2 v[114:115], v117, s[4:7], s21 offen
s_cbranch_scc1 main_kernel_c3_last
ds_write_b64 v117, v[114:115] offset:17920
v_smfmac_f32_16x16x64_f16 v[88:91], v[20:23], v[168:175], v112
s_cmp_gt_u32 s32, 1790
s_cselect_b32 s33, 900, s47
v_smfmac_f32_16x16x64_f16 v[88:91], v[24:27], v[176:183], v112
s_add_u32 s10, s33, s31
s_andn2_b32 s42, s44, 0x1f00
v_mov_b32 v126, s15
v_smfmac_f32_16x16x64_f16 v[88:91], v[28:31], v[184:191], v112
s_add_u32 s42, s42, 0x4000
v_mov_b32 v127, s10
v_smfmac_f32_16x16x64_f16 v[88:91], v[32:35], v[192:199], v112
.p2align 3
main_kernel_c3_b21:
s_sub_u32 s47, s47, 28
s_cbranch_scc0 main_kernel_c3_b21
s_waitcnt lgkmcnt(0)
s_barrier
ds_read_b128 v[0:3], v116 offset:16384
v_smfmac_f32_16x16x64_f16 v[88:91], v[36:39], v[200:207], v112
ds_read_b128 v[4:7], v116 offset:17408
buffer_store_dwordx2 v[126:127], off, s[4:7], s46
v_smfmac_f32_16x16x64_f16 v[88:91], v[40:43], v[208:215], v112
ds_read_b128 v[16:19], v116 offset:26624
s_cmp_gt_u32 s32, 1790
s_cselect_b32 s80, s44, 0x7f000000
v_smfmac_f32_16x16x64_f16 v[88:91], v[44:47], v[216:223], v112
ds_read_b128 v[20:23], v116 offset:30720
v_writelane_b32 v121, s55, 39
v_smfmac_f32_16x16x64_f16 v[88:91], v[48:51], v[224:231], v112
ds_read_b128 v[24:27], v116 offset:27648
v_smfmac_f32_16x16x64_f16 v[88:91], v[52:55], v[232:239], v112
ds_read_b128 v[28:31], v116 offset:31744
v_smfmac_f32_16x16x64_f16 v[88:91], v[56:59], v[240:247], v112
v_smfmac_f32_16x16x64_f16 v[88:91], v[60:63], v[248:255], v112
s_waitcnt lgkmcnt(5)
v_mfma_f32_16x16x32_bf16 v[80:83], v[64:67], v[0:3], 0
v_mfma_f32_16x16x32_bf16 v[84:87], v[68:71], v[0:3], 0
buffer_load_dwordx4 v[8:11], v116, s[4:7], s20 offen offset:0 sc1
v_mfma_f32_16x16x32_bf16 v[92:95], v[0:3], v[0:3], 0
buffer_load_dwordx4 v[12:15], v116, s[4:7], s20 offen offset:1024 sc1
v_permlane32_swap_b32 v88, v90
s_waitcnt lgkmcnt(4)
v_mfma_f32_16x16x32_bf16 v[80:83], v[72:75], v[4:7], v[80:83]
v_permlane32_swap_b32 v89, v91
v_mfma_f32_16x16x32_bf16 v[84:87], v[76:79], v[4:7], v[84:87]
v_pk_add_f32 v[88:89], v[88:89], v[90:91]
v_mfma_f32_16x16x32_bf16 v[92:95], v[4:7], v[4:7], v[92:95]
v_cvt_pk_bf16_f32 v124, v88, v89
s_andn2_b32 s35, s46, 0xff
v_bfe_u32 v68, v116, 1, 8
v_mov_b32 v65, 0
buffer_load_dwordx2 v[66:67], v68, s[4:7], s35 offen sc1
buffer_store_dword v127, off, s[4:7], s80 offset:132 sc1
s_waitcnt lgkmcnt(0)
s_waitcnt vmcnt(3)
v_mfma_f32_16x16x32_bf16 v[88:91], v[8:11], v[8:11], v[92:95]
v_mfma_f32_16x16x32_bf16 v[0:3], v[16:19], v[8:11], v[80:83]
v_cmp_u_f32 s[0:1], v8, v10
v_mfma_f32_16x16x32_bf16 v[4:7], v[20:23], v[8:11], v[84:87]
s_waitcnt vmcnt(2)
v_mfma_f32_16x16x32_bf16 v[88:91], v[12:15], v[12:15], v[88:91]
v_mfma_f32_16x16x32_bf16 v[0:3], v[24:27], v[12:15], v[0:3]
v_cmp_u_f32 s[32:33], v12, v14
v_mfma_f32_16x16x32_bf16 v[4:7], v[28:31], v[12:15], v[4:7]
s_or_b64 s[0:1], s[0:1], s[32:33]
s_cbranch_scc1 main_kernel_c3_z_f
main_kernel_c3_z:
v_mul_f32 v88, s30, v88
v_mul_f32 v89, s30, v89
v_exp_f32 v88, v88
v_exp_f32 v89, v89
v_cndmask_b32_dpp v0, v2, v0, vcc quad_perm:[2,3,2,3] row_mask:0xf bank_mask:0xf
v_cvt_pk_bf16_f32 v64, v88, v89
v_cndmask_b32_dpp v1, v3, v1, vcc quad_perm:[2,3,2,3] row_mask:0xf bank_mask:0xf
v_exp_f32 v0, v0
v_mfma_f32_16x16x16_bf16 v[16:19], v[100:101], v[64:65], 0
v_exp_f32 v1, v1
v_cndmask_b32_dpp v4, v6, v4, vcc quad_perm:[2,3,2,3] row_mask:0xf bank_mask:0xf
v_mfma_f32_16x16x16_bf16 v[8:11], v[124:125], v[64:65], 0
v_cndmask_b32_dpp v5, v7, v5, vcc quad_perm:[2,3,2,3] row_mask:0xf bank_mask:0xf
v_exp_f32 v4, v4
v_exp_f32 v5, v5
v_cvt_pk_bf16_f32 v92, v0, v1
v_cvt_pk_bf16_f32 v94, v4, v5
v_mov_b32 v80, 0
v_mov_b32_dpp v93, v92 quad_perm:[0,1,0,1] row_mask:0xf bank_mask:0xf
v_mov_b32_dpp v95, v94 quad_perm:[0,1,0,1] row_mask:0xf bank_mask:0xf
v_mov_b32 v81, 0
v_mov_b32 v82, 0
v_mfma_f32_16x16x32_bf16 v[16:19], v[100:103], v[92:95], v[16:19]
v_mov_b32 v83, 0
v_mov_b32 v84, 0
v_mfma_f32_16x16x32_bf16 v[8:11], v[96:99], v[92:95], v[8:11]
s_buffer_load_dword s42, s[4:7], s42
s_nop 1
v_mov_b32 v85, 0
v_mov_b32 v86, 0
v_mov_b32 v87, 0
v_rcp_f32 v126, v16
v_subrev_u32 v127, 0x21800000, v16
v_cmp_lt_u32 vcc, 0x3c000000, v127
v_pk_mul_f32 v[8:9], v[8:9], v[126:127] op_sel_hi:[1,0]
v_pk_mul_f32 v[10:11], v[10:11], v[126:127] op_sel_hi:[1,0]
s_and_b32 s32, vcc_lo, 0xcccc
v_cvt_pk_bf16_f32 v126, v8, v9
v_cvt_pk_bf16_f32 v127, v10, v11
s_cbranch_scc1 main_kernel_c3_sm_f
main_kernel_c3_ost:
buffer_store_dwordx2 v[126:127], v118, s[4:7], s22 offen
s_waitcnt vmcnt(2)
main_kernel_c3_to0:
s_memtime s[40:41]
v_readlane_b32 s16, v66, 0
v_subrev_u32 v67, s2, v67
s_add_u32 s34, s11, s2
s_nop 0
v_max_u32_dpp v67, v67, v67 row_ror:8 row_mask:0xf bank_mask:0xf
s_nop 1
v_max_u32_dpp v67, v67, v67 row_ror:4 row_mask:0xf bank_mask:0xf
s_nop 1
v_max_u32_dpp v67, v67, v67 row_ror:2 row_mask:0xf bank_mask:0xf
s_nop 1
v_max_u32_dpp v67, v67, v67 row_ror:1 row_mask:0xf bank_mask:0xf
s_waitcnt lgkmcnt(0)
v_readlane_b32 s32, v67, 0
v_readlane_b32 s33, v67, 16
s_sub_u32 s34, s40, s34
s_max_u32 s32, s32, s33
s_add_u32 s35, s34, 1536
s_cmp_gt_u32 s32, s35
s_cbranch_scc1 main_kernel_c3_to2
main_kernel_c3_to3:
s_sub_u32 s33, s42, s2
s_cmp_le_u32 s33, s35
s_cselect_b32 s33, s33, 0
s_max_u32 s32, s32, s33
s_add_u32 s36, s32, 2720
s_add_u32 s32, s32, 1270
s_sub_u32 s47, s32, s34
s_max_i32 s47, s47, 0
.p2align 3
main_kernel_c3_to1:
s_sub_u32 s47, s47, 28
s_cbranch_scc0 main_kernel_c3_to1
s_barrier
buffer_load_dwordx4 v[0:3], v116, s[4:7], s23 offen sc1
ds_read_b128 v[32:35], v113 offset:0
ds_read_b128 v[36:39], v113 offset:1024
s_add_u32 s46, s46, 0x40000
s_bitset0_b32 s46, 20
s_add_u32 s37, s37, 65536
s_add_u32 s26, s26, 65536
s_xor_b32 s32, s23, 1024
buffer_load_dwordx4 v[4:7], v116, s[4:7], s32 offen sc1
ds_read_b128 v[40:43], v113 offset:2048
ds_read_b128 v[44:47], v113 offset:3072
s_add_u32 s44, s44, s24
s_nop 2
s_xor_b32 s32, s23, 2048
buffer_load_dwordx4 v[8:11], v116, s[4:7], s32 offen sc1
ds_read_b128 v[48:51], v113 offset:4096
ds_read_b128 v[52:55], v113 offset:5120
s_nop 3
s_xor_b32 s32, s23, 3072
buffer_load_dwordx4 v[12:15], v116, s[4:7], s32 offen sc1
ds_read_b128 v[56:59], v113 offset:6144
ds_read_b128 v[60:63], v113 offset:7168
s_nop 3
s_xor_b32 s32, s23, 4096
buffer_load_dwordx4 v[16:19], v116, s[4:7], s32 offen sc1
ds_read_b128 v[64:67], v113 offset:8192
ds_read_b128 v[68:71], v113 offset:9216
s_nop 3
s_xor_b32 s32, s23, 5120
buffer_load_dwordx4 v[20:23], v116, s[4:7], s32 offen sc1
ds_read_b128 v[72:75], v113 offset:10240
ds_read_b128 v[76:79], v113 offset:11264
s_nop 3
s_xor_b32 s32, s23, 6144
buffer_load_dwordx4 v[24:27], v116, s[4:7], s32 offen sc1
ds_read_b128 v[88:91], v113 offset:12288
ds_read_b128 v[92:95], v113 offset:13312
s_nop 3
s_xor_b32 s32, s23, 7168
buffer_load_dwordx4 v[28:31], v116, s[4:7], s32 offen sc1
v_and_b32 v127, 0x1f0, v116
v_lshlrev_b32 v127, 4, v127
s_waitcnt lgkmcnt(12)
s_waitcnt vmcnt(7)
v_cmp_u_f32 vcc, v0, v2
s_cbranch_vccnz main_kernel_c3_o0_f
main_kernel_c3_o0:
v_smfmac_f32_16x16x64_bf16 v[80:83], v[0:3], v[32:39], v112
ds_read_b128 v[32:35], v113 offset:14336
ds_read_b128 v[36:39], v113 offset:15360
buffer_load_dwordx2 v[96:97], v127, s[4:7], s45 offen offset:128 sc1
s_waitcnt lgkmcnt(12)
s_waitcnt vmcnt(7)
v_cmp_u_f32 vcc, v4, v6
v_smfmac_f32_16x16x64_bf16 v[84:87], v[0:3], v[40:47], v112
ds_read_b128 v[40:43], v113 offset:16384
ds_read_b128 v[44:47], v113 offset:17408
buffer_store_dwordx2 v[114:115], v119, s[4:7], s37 offen sc1
s_cbranch_vccnz main_kernel_c3_o1_f
main_kernel_c3_o1:
s_waitcnt lgkmcnt(12)
v_smfmac_f32_16x16x64_bf16 v[80:83], v[4:7], v[48:55], v112
ds_read_b128 v[48:51], v113 offset:18432
ds_read_b128 v[52:55], v113 offset:19456
s_waitcnt lgkmcnt(12)
s_waitcnt vmcnt(7)
v_cmp_u_f32 vcc, v8, v10
v_smfmac_f32_16x16x64_bf16 v[84:87], v[4:7], v[56:63], v112
ds_read_b128 v[56:59], v113 offset:20480
ds_read_b128 v[60:63], v113 offset:21504
buffer_store_dword v124, v120, s[4:7], s26 offen sc1
s_cbranch_vccnz main_kernel_c3_o2_f
main_kernel_c3_o2:
s_waitcnt lgkmcnt(12)
v_smfmac_f32_16x16x64_bf16 v[80:83], v[8:11], v[64:71], v112
ds_read_b128 v[64:67], v113 offset:22528
ds_read_b128 v[68:71], v113 offset:23552
s_waitcnt lgkmcnt(12)
s_waitcnt vmcnt(7)
v_cmp_u_f32 vcc, v12, v14
v_smfmac_f32_16x16x64_bf16 v[84:87], v[8:11], v[72:79], v112
ds_read_b128 v[72:75], v113 offset:24576
ds_read_b128 v[76:79], v113 offset:25600
s_cbranch_vccnz main_kernel_c3_o3_f
main_kernel_c3_o3:
s_waitcnt lgkmcnt(12)
v_smfmac_f32_16x16x64_bf16 v[80:83], v[12:15], v[88:95], v112
ds_read_b128 v[88:91], v113 offset:26624
ds_read_b128 v[92:95], v113 offset:27648
s_waitcnt lgkmcnt(12)
s_waitcnt vmcnt(6)
v_cmp_u_f32 vcc, v16, v18
v_smfmac_f32_16x16x64_bf16 v[84:87], v[12:15], v[32:39], v112
ds_read_b128 v[32:35], v113 offset:28672
ds_read_b128 v[36:39], v113 offset:29696
s_cbranch_vccnz main_kernel_c3_o4_f
main_kernel_c3_o4:
s_waitcnt lgkmcnt(12)
v_smfmac_f32_16x16x64_bf16 v[80:83], v[16:19], v[40:47], v112
ds_read_b128 v[40:43], v113 offset:30720
ds_read_b128 v[44:47], v113 offset:31744
s_waitcnt lgkmcnt(12)
s_waitcnt vmcnt(5)
v_cmp_u_f32 vcc, v20, v22
v_smfmac_f32_16x16x64_bf16 v[84:87], v[16:19], v[48:55], v112
s_cbranch_vccnz main_kernel_c3_o5_f
main_kernel_c3_o5:
s_waitcnt lgkmcnt(10)
v_smfmac_f32_16x16x64_bf16 v[80:83], v[20:23], v[56:63], v112
s_waitcnt lgkmcnt(8)
s_waitcnt vmcnt(4)
v_cmp_u_f32 vcc, v24, v26
v_smfmac_f32_16x16x64_bf16 v[84:87], v[20:23], v[64:71], v112
s_cbranch_vccnz main_kernel_c3_o6_f
main_kernel_c3_o6:
s_waitcnt lgkmcnt(6)
v_smfmac_f32_16x16x64_bf16 v[80:83], v[24:27], v[72:79], v112
s_waitcnt lgkmcnt(4)
v_smfmac_f32_16x16x64_bf16 v[84:87], v[24:27], v[88:95], v112
s_waitcnt lgkmcnt(2)
s_waitcnt vmcnt(3)
v_cmp_u_f32 vcc, v28, v30
s_cbranch_vccnz main_kernel_c3_o7_f
main_kernel_c3_o7:
v_smfmac_f32_16x16x64_bf16 v[80:83], v[28:31], v[32:39], v112
s_waitcnt lgkmcnt(0)
v_smfmac_f32_16x16x64_bf16 v[84:87], v[28:31], v[40:47], v112
s_nop 4
v_cvt_pk_bf16_f32 v80, v80, v81
v_cvt_pk_bf16_f32 v81, v82, v83
ds_write_b64 v116, v[80:81] offset:21512
v_cvt_pk_bf16_f32 v82, v84, v85
v_cvt_pk_bf16_f32 v83, v86, v87
ds_write_b64 v116, v[82:83] offset:23560
s_waitcnt lgkmcnt(0)
s_barrier
ds_read_b128 v[72:75], v116 offset:22528
ds_read_b128 v[76:79], v116 offset:23552
s_waitcnt lgkmcnt(1)
v_mfma_f32_16x16x32_bf16 v[64:67], v[72:75], v[108:111], 0
s_waitcnt lgkmcnt(0)
v_mfma_f32_16x16x32_bf16 v[64:67], v[76:79], v[108:111], v[64:67]
s_nop 7
v_cvt_pk_f16_f32 v68, v64, v65
v_cvt_pk_f16_f32 v69, v66, v67
buffer_store_dwordx2 v[68:69], v125, s[4:7], s25 offen
s_sub_u32 s0, s2, s16
s_sub_u32 s0, s0, s39
s_waitcnt vmcnt(3)
main_kernel_c3_tm0:
s_memtime s[40:41]
v_sub_u32 v97, v97, v96
v_subrev_u32 v97, s0, v97
s_add_u32 s34, s11, s2
s_nop 0
v_max_u32_dpp v97, v97, v97 row_ror:8 row_mask:0xf bank_mask:0xf
s_nop 1
v_max_u32_dpp v97, v97, v97 row_ror:4 row_mask:0xf bank_mask:0xf
s_nop 1
v_max_u32_dpp v97, v97, v97 row_ror:2 row_mask:0xf bank_mask:0xf
s_nop 1
v_max_u32_dpp v97, v97, v97 row_ror:1 row_mask:0xf bank_mask:0xf
s_waitcnt lgkmcnt(0)
v_readlane_b32 s32, v97, 0
v_readlane_b32 s33, v97, 16
s_sub_u32 s34, s40, s34
s_max_u32 s32, s32, s33
s_add_u32 s35, s34, 1536
s_cmp_gt_u32 s32, s35
s_cbranch_scc1 main_kernel_c3_tm2
main_kernel_c3_tm3:
s_add_u32 s32, s32, 2720
s_max_u32 s32, s32, s36
s_ashr_i32 s33, s39, 2
s_max_i32 s33, s33, -70
s_min_i32 s33, s33, 30
s_add_u32 s32, s32, s33
s_add_u32 s43, s32, s2
s_sub_u32 s47, s32, s34
s_max_i32 s47, s47, 0
.p2align 3
main_kernel_c3_tm1:
s_sub_u32 s47, s47, 28
s_cbranch_scc0 main_kernel_c3_tm1
s_add_u32 s45, s45, s24
s_branch main_kernel_c3_top
main_kernel_c3_to2:
s_mov_b32 s32, s34
s_mov_b32 s16, s15
s_cmp_gt_u32 s34, 0x40000
s_cbranch_scc1 main_kernel_c3_to3
s_andn2_b32 s35, s46, 0xff
v_bfe_u32 v68, v116, 1, 8
buffer_load_dwordx2 v[66:67], v68, s[4:7], s35 offen sc1
s_sub_u32 s29, s29, 1
s_cbranch_scc1 main_kernel_end
s_cmp_lg_u32 s17, 0
s_cbranch_scc1 main_kernel_c3_to7
s_memtime s[40:41]
s_memrealtime s[80:81]
s_memrealtime s[82:83]
s_memrealtime s[84:85]
s_memrealtime s[86:87]
s_memrealtime s[88:89]
s_memrealtime s[90:91]
s_memrealtime s[92:93]
s_memrealtime s[94:95]
s_memrealtime s[96:97]
s_memrealtime s[98:99]
s_memrealtime s[100:101]
s_waitcnt lgkmcnt(0)
s_add_u32 s80, s80, s82
s_add_u32 s80, s80, s84
s_add_u32 s80, s80, s86
s_add_u32 s80, s80, s88
s_add_u32 s80, s80, s90
s_add_u32 s80, s80, s92
s_add_u32 s80, s80, s94
s_add_u32 s80, s80, s96
s_add_u32 s80, s80, s98
s_add_u32 s80, s80, s100
s_lshl1_add_u32 s80, s80, s15
s_sub_u32 s11, s40, s80
main_kernel_c3_to7:
s_waitcnt vmcnt(0)
s_branch main_kernel_c3_to0
main_kernel_c3_tm2:
s_mov_b32 s32, s34
s_cmp_gt_u32 s34, 0x40000
s_cbranch_scc1 main_kernel_c3_tm3
v_and_b32 v127, 0x1f0, v116
v_lshlrev_b32 v127, 4, v127
buffer_load_dwordx2 v[96:97], v127, s[4:7], s45 offen offset:128 sc1
s_sub_u32 s29, s29, 1
s_cbranch_scc1 main_kernel_end
s_cmp_lg_u32 s17, 0
s_cbranch_scc1 main_kernel_c3_tm7
s_memtime s[40:41]
s_memrealtime s[80:81]
s_memrealtime s[82:83]
s_memrealtime s[84:85]
s_memrealtime s[86:87]
s_memrealtime s[88:89]
s_memrealtime s[90:91]
s_memrealtime s[92:93]
s_memrealtime s[94:95]
s_memrealtime s[96:97]
s_memrealtime s[98:99]
s_memrealtime s[100:101]
s_waitcnt lgkmcnt(0)
s_add_u32 s80, s80, s82
s_add_u32 s80, s80, s84
s_add_u32 s80, s80, s86
s_add_u32 s80, s80, s88
s_add_u32 s80, s80, s90
s_add_u32 s80, s80, s92
s_add_u32 s80, s80, s94
s_add_u32 s80, s80, s96
s_add_u32 s80, s80, s98
s_add_u32 s80, s80, s100
s_lshl1_add_u32 s80, s80, s15
s_sub_u32 s11, s40, s80
main_kernel_c3_tm7:
s_waitcnt vmcnt(0)
s_branch main_kernel_c3_tm0
main_kernel_c3_last:
s_add_u32 s37, s37, 65536
s_add_u32 s26, s26, 65536
buffer_store_dwordx2 v[114:115], v119, s[4:7], s37 offen sc1
v_smfmac_f32_16x16x64_f16 v[88:91], v[20:23], v[168:175], v112
v_smfmac_f32_16x16x64_f16 v[88:91], v[24:27], v[176:183], v112
v_smfmac_f32_16x16x64_f16 v[88:91], v[28:31], v[184:191], v112
v_smfmac_f32_16x16x64_f16 v[88:91], v[32:35], v[192:199], v112
v_smfmac_f32_16x16x64_f16 v[88:91], v[36:39], v[200:207], v112
v_smfmac_f32_16x16x64_f16 v[88:91], v[40:43], v[208:215], v112
v_smfmac_f32_16x16x64_f16 v[88:91], v[44:47], v[216:223], v112
v_smfmac_f32_16x16x64_f16 v[88:91], v[48:51], v[224:231], v112
v_smfmac_f32_16x16x64_f16 v[88:91], v[52:55], v[232:239], v112
v_smfmac_f32_16x16x64_f16 v[88:91], v[56:59], v[240:247], v112
v_smfmac_f32_16x16x64_f16 v[88:91], v[60:63], v[248:255], v112
s_nop 7
v_permlane32_swap_b32 v88, v90
s_nop 1
v_permlane32_swap_b32 v89, v91
s_nop 1
v_pk_add_f32 v[88:89], v[88:89], v[90:91]
s_nop 1
v_cvt_pk_bf16_f32 v124, v88, v89
s_nop 1
buffer_store_dword v124, v120, s[4:7], s26 offen sc1
s_branch main_kernel_end
main_kernel_c3_m0_f:
s_waitcnt lgkmcnt(0)
buffer_load_dwordx4 v[0:3], v116, s[4:7], s18 offen sc1
buffer_load_dwordx4 v[64:67], v116, s[4:7], s19 offen sc1
s_xor_b32 s32, s18, 1024
buffer_load_dwordx4 v[16:19], v116, s[4:7], s32 offen sc1
s_xor_b32 s32, s19, 1024
buffer_load_dwordx4 v[68:71], v116, s[4:7], s32 offen sc1
s_xor_b32 s32, s18, 2048
buffer_load_dwordx4 v[32:35], v116, s[4:7], s32 offen sc1
s_xor_b32 s32, s19, 2048
buffer_load_dwordx4 v[72:75], v116, s[4:7], s32 offen sc1
s_xor_b32 s32, s18, 3072
buffer_load_dwordx4 v[48:51], v116, s[4:7], s32 offen sc1
s_xor_b32 s32, s19, 3072
buffer_load_dwordx4 v[76:79], v116, s[4:7], s32 offen sc1
s_sub_u32 s29, s29, 1
s_cbranch_scc1 main_kernel_end
s_waitcnt vmcnt(0)
v_max_u32 v126, v0, v2
v_max3_u32 v126, v126, v64, v66
v_cmp_eq_u32 vcc, -1, v126
s_cbranch_vccnz main_kernel_c3_m0_f
v_pk_add_f16 v0, v0, v64
v_pk_add_f16 v1, v1, v65
v_pk_add_f16 v2, v2, v66
v_pk_add_f16 v3, v3, v67
s_nop 0
s_branch main_kernel_c3_m0
main_kernel_c3_m1_f:
s_waitcnt lgkmcnt(0)
s_xor_b32 s32, s18, 1024
buffer_load_dwordx4 v[16:19], v116, s[4:7], s32 offen sc1
s_xor_b32 s32, s19, 1024
buffer_load_dwordx4 v[68:71], v116, s[4:7], s32 offen sc1
s_xor_b32 s32, s18, 2048
buffer_load_dwordx4 v[32:35], v116, s[4:7], s32 offen sc1
s_xor_b32 s32, s19, 2048
buffer_load_dwordx4 v[72:75], v116, s[4:7], s32 offen sc1
s_xor_b32 s32, s18, 3072
buffer_load_dwordx4 v[48:51], v116, s[4:7], s32 offen sc1
s_xor_b32 s32, s19, 3072
buffer_load_dwordx4 v[76:79], v116, s[4:7], s32 offen sc1
s_sub_u32 s29, s29, 1
s_cbranch_scc1 main_kernel_end
s_waitcnt vmcnt(0)
v_max_u32 v126, v16, v18
v_max3_u32 v126, v126, v68, v70
v_cmp_eq_u32 vcc, -1, v126
s_cbranch_vccnz main_kernel_c3_m1_f
v_pk_add_f16 v16, v16, v68
v_pk_add_f16 v17, v17, v69
v_pk_add_f16 v18, v18, v70
v_pk_add_f16 v19, v19, v71
s_nop 0
s_branch main_kernel_c3_m1
main_kernel_c3_m2_f:
s_waitcnt lgkmcnt(0)
s_xor_b32 s32, s18, 2048
buffer_load_dwordx4 v[32:35], v116, s[4:7], s32 offen sc1
s_xor_b32 s32, s19, 2048
buffer_load_dwordx4 v[72:75], v116, s[4:7], s32 offen sc1
s_xor_b32 s32, s18, 3072
buffer_load_dwordx4 v[48:51], v116, s[4:7], s32 offen sc1
s_xor_b32 s32, s19, 3072
buffer_load_dwordx4 v[76:79], v116, s[4:7], s32 offen sc1
s_sub_u32 s29, s29, 1
s_cbranch_scc1 main_kernel_end
s_waitcnt vmcnt(0)
v_max_u32 v126, v32, v34
v_max3_u32 v126, v126, v72, v74
v_cmp_eq_u32 vcc, -1, v126
s_cbranch_vccnz main_kernel_c3_m2_f
v_pk_add_f16 v32, v32, v72
v_pk_add_f16 v33, v33, v73
v_pk_add_f16 v34, v34, v74
v_pk_add_f16 v35, v35, v75
ds_write_b128 v116, v[32:35] offset:11264
s_branch main_kernel_c3_m2
main_kernel_c3_m3_f:
s_waitcnt lgkmcnt(0)
s_xor_b32 s32, s18, 3072
buffer_load_dwordx4 v[48:51], v116, s[4:7], s32 offen sc1
s_xor_b32 s32, s19, 3072
buffer_load_dwordx4 v[76:79], v116, s[4:7], s32 offen sc1
s_sub_u32 s29, s29, 1
s_cbranch_scc1 main_kernel_end
s_waitcnt vmcnt(0)
v_max_u32 v126, v48, v50
v_max3_u32 v126, v126, v76, v78
v_cmp_eq_u32 vcc, -1, v126
s_cbranch_vccnz main_kernel_c3_m3_f
v_pk_add_f16 v48, v48, v76
v_pk_add_f16 v49, v49, v77
v_pk_add_f16 v50, v50, v78
v_pk_add_f16 v51, v51, v79
ds_write_b128 v116, v[48:51] offset:15360
s_branch main_kernel_c3_m3
main_kernel_c3_z_f:
buffer_load_dwordx4 v[8:11], v116, s[4:7], s20 offen offset:0 sc1
buffer_load_dwordx4 v[12:15], v116, s[4:7], s20 offen offset:1024 sc1
s_memtime s[32:33]
ds_read_b32 v126, v116 offset:18432
s_sub_u32 s34, s19, s54
s_xor_b32 s34, s34, 0x2000
s_lshl_b32 s35, s12, 15
s_add_u32 s34, s34, s35
s_lshl_b32 s35, s13, 8
s_add_u32 s35, s35, s34
s_add_u32 s34, s34, 0x4000
s_waitcnt lgkmcnt(0)
s_sub_u32 s32, s32, 450
v_sub_u32 v126, s32, v126
v_max_u32 v127, v126, v127
buffer_store_dword v127, off, s[4:7], s34
s_sub_u32 s29, s29, 1
s_cbranch_scc1 main_kernel_end
s_waitcnt vmcnt(1)
main_kernel_c3_z_g:
v_max_u32 v126, v8, v10
v_max3_u32 v126, v126, v12, v14
v_cmp_eq_u32 vcc, -1, v126
s_cbranch_vccnz main_kernel_c3_z_h
v_mfma_f32_16x16x32_bf16 v[88:91], v[8:11], v[8:11], v[92:95]
v_mfma_f32_16x16x32_bf16 v[0:3], v[16:19], v[8:11], v[80:83]
v_mfma_f32_16x16x32_bf16 v[4:7], v[20:23], v[8:11], v[84:87]
v_mfma_f32_16x16x32_bf16 v[88:91], v[12:15], v[12:15], v[88:91]
v_mfma_f32_16x16x32_bf16 v[0:3], v[24:27], v[12:15], v[0:3]
v_mfma_f32_16x16x32_bf16 v[4:7], v[28:31], v[12:15], v[4:7]
buffer_store_dword v127, off, s[4:7], s35 offset:132 sc1
s_mov_b32 vcc_lo, 0xcccccccc
s_mov_b32 vcc_hi, 0xcccccccc
s_branch main_kernel_c3_z
main_kernel_c3_z_h:
buffer_load_dwordx4 v[8:11], v116, s[4:7], s20 offen offset:0 sc1
buffer_load_dwordx4 v[12:15], v116, s[4:7], s20 offen offset:1024 sc1
s_sub_u32 s29, s29, 1
s_cbranch_scc1 main_kernel_end
v_add_u32 v127, 300, v127
s_waitcnt vmcnt(0)
s_branch main_kernel_c3_z_g
main_kernel_c3_sm_f:
s_waitcnt vmcnt(0) lgkmcnt(0)
buffer_load_dwordx4 v[8:11], v116, s[4:7], s20 offen offset:0 sc1
buffer_load_dwordx4 v[12:15], v116, s[4:7], s20 offen offset:1024 sc1
ds_read_b128 v[0:3], v116 offset:16384
ds_read_b128 v[4:7], v116 offset:17408
ds_read_b128 v[64:67], v116 offset:24576
ds_read_b128 v[68:71], v116 offset:28672
ds_read_b128 v[72:75], v116 offset:25600
ds_read_b128 v[76:79], v116 offset:29696
ds_read_b128 v[16:19], v116 offset:26624
ds_read_b128 v[20:23], v116 offset:30720
ds_read_b128 v[24:27], v116 offset:27648
ds_read_b128 v[28:31], v116 offset:31744
s_waitcnt vmcnt(0)
s_waitcnt lgkmcnt(0)
v_mfma_f32_16x16x32_bf16 v[80:83], v[64:67], v[0:3], 0
v_mfma_f32_16x16x32_bf16 v[84:87], v[68:71], v[0:3], 0
v_mfma_f32_16x16x32_bf16 v[92:95], v[0:3], v[0:3], 0
v_mfma_f32_16x16x32_bf16 v[80:83], v[72:75], v[4:7], v[80:83]
v_mfma_f32_16x16x32_bf16 v[84:87], v[76:79], v[4:7], v[84:87]
v_mfma_f32_16x16x32_bf16 v[92:95], v[4:7], v[4:7], v[92:95]
v_mfma_f32_16x16x32_bf16 v[0:3], v[16:19], v[8:11], v[80:83]
v_mfma_f32_16x16x32_bf16 v[4:7], v[20:23], v[8:11], v[84:87]
v_mfma_f32_16x16x32_bf16 v[88:91], v[8:11], v[8:11], v[92:95]
v_mfma_f32_16x16x32_bf16 v[0:3], v[24:27], v[12:15], v[0:3]
v_mfma_f32_16x16x32_bf16 v[4:7], v[28:31], v[12:15], v[4:7]
v_mfma_f32_16x16x32_bf16 v[88:91], v[12:15], v[12:15], v[88:91]
s_nop 7
v_mov_b32 v65, 0
v_max_f32 v126, v88, v89
v_mul_f32 v126, s30, v126
v_max3_f32 v126, v126, v0, v1
v_max3_f32 v126, v126, v2, v3
v_max3_f32 v126, v126, v4, v5
v_max3_f32 v126, v126, v6, v7
v_mov_b32 v127, v126
s_nop 1
v_permlane32_swap_b32 v126, v127
v_max_f32 v126, v126, v127
v_mov_b32 v127, v126
s_nop 1
v_permlane16_swap_b32 v126, v127
v_max_f32 v126, v126, v127
v_mul_f32 v127, 0x40faf233, v126
s_mov_b32 vcc_lo, 0xcccccccc
s_mov_b32 vcc_hi, 0xcccccccc
v_sub_f32 v0, v0, v126
v_sub_f32 v1, v1, v126
v_sub_f32 v2, v2, v126
v_sub_f32 v3, v3, v126
v_sub_f32 v4, v4, v126
v_sub_f32 v5, v5, v126
v_sub_f32 v6, v6, v126
v_sub_f32 v7, v7, v126
v_sub_f32 v88, v88, v127
v_sub_f32 v89, v89, v127
s_waitcnt lgkmcnt(0)
s_nop 0
v_mul_f32 v88, s30, v88
v_mul_f32 v89, s30, v89
v_exp_f32 v88, v88
v_exp_f32 v89, v89
v_cndmask_b32_dpp v0, v2, v0, vcc quad_perm:[2,3,2,3] row_mask:0xf bank_mask:0xf
v_cvt_pk_bf16_f32 v64, v88, v89
v_cndmask_b32_dpp v1, v3, v1, vcc quad_perm:[2,3,2,3] row_mask:0xf bank_mask:0xf
v_exp_f32 v0, v0
v_mfma_f32_16x16x16_bf16 v[16:19], v[100:101], v[64:65], 0
v_exp_f32 v1, v1
v_cndmask_b32_dpp v4, v6, v4, vcc quad_perm:[2,3,2,3] row_mask:0xf bank_mask:0xf
v_mfma_f32_16x16x16_bf16 v[8:11], v[124:125], v[64:65], 0
v_cndmask_b32_dpp v5, v7, v5, vcc quad_perm:[2,3,2,3] row_mask:0xf bank_mask:0xf
v_exp_f32 v4, v4
v_exp_f32 v5, v5
v_cvt_pk_bf16_f32 v92, v0, v1
v_cvt_pk_bf16_f32 v94, v4, v5
v_mov_b32 v80, 0
v_mov_b32_dpp v93, v92 quad_perm:[0,1,0,1] row_mask:0xf bank_mask:0xf
v_mov_b32_dpp v95, v94 quad_perm:[0,1,0,1] row_mask:0xf bank_mask:0xf
v_mov_b32 v81, 0
v_mov_b32 v82, 0
v_mfma_f32_16x16x32_bf16 v[16:19], v[100:103], v[92:95], v[16:19]
v_mov_b32 v83, 0
v_mov_b32 v84, 0
v_mfma_f32_16x16x32_bf16 v[8:11], v[96:99], v[92:95], v[8:11]
s_nop 1
v_mov_b32 v85, 0
v_mov_b32 v86, 0
v_mov_b32 v87, 0
v_rcp_f32 v126, v16
v_subrev_u32 v127, 0x21800000, v16
v_cmp_lt_u32 vcc, 0x3c000000, v127
v_pk_mul_f32 v[8:9], v[8:9], v[126:127] op_sel_hi:[1,0]
v_pk_mul_f32 v[10:11], v[10:11], v[126:127] op_sel_hi:[1,0]
s_and_b32 s32, vcc_lo, 0xcccc
v_cvt_pk_bf16_f32 v126, v8, v9
v_cvt_pk_bf16_f32 v127, v10, v11
s_andn2_b32 s35, s46, 0xff
v_bfe_u32 v68, v116, 1, 8
buffer_load_dwordx2 v[66:67], v68, s[4:7], s35 offen sc1
s_waitcnt vmcnt(0)
s_branch main_kernel_c3_ost
main_kernel_c3_o0_f:
s_nop 0
buffer_load_dwordx4 v[0:3], v116, s[4:7], s23 offen sc1
s_xor_b32 s32, s23, 1024
buffer_load_dwordx4 v[4:7], v116, s[4:7], s32 offen sc1
s_sub_u32 s29, s29, 1
s_cbranch_scc1 main_kernel_end
s_waitcnt vmcnt(0)
v_max_u32 v126, v0, v2
v_cmp_eq_u32 vcc, -1, v126
s_cbranch_vccnz main_kernel_c3_o0_f
s_branch main_kernel_c3_o0
main_kernel_c3_o1_f:
s_nop 0
s_xor_b32 s32, s23, 1024
buffer_load_dwordx4 v[4:7], v116, s[4:7], s32 offen sc1
s_xor_b32 s32, s23, 2048
buffer_load_dwordx4 v[8:11], v116, s[4:7], s32 offen sc1
s_sub_u32 s29, s29, 1
s_cbranch_scc1 main_kernel_end
s_waitcnt vmcnt(0)
v_max_u32 v126, v4, v6
v_cmp_eq_u32 vcc, -1, v126
s_cbranch_vccnz main_kernel_c3_o1_f
s_branch main_kernel_c3_o1
main_kernel_c3_o2_f:
s_nop 0
s_xor_b32 s32, s23, 2048
buffer_load_dwordx4 v[8:11], v116, s[4:7], s32 offen sc1
s_xor_b32 s32, s23, 3072
buffer_load_dwordx4 v[12:15], v116, s[4:7], s32 offen sc1
s_sub_u32 s29, s29, 1
s_cbranch_scc1 main_kernel_end
s_waitcnt vmcnt(0)
v_max_u32 v126, v8, v10
v_cmp_eq_u32 vcc, -1, v126
s_cbranch_vccnz main_kernel_c3_o2_f
s_branch main_kernel_c3_o2
main_kernel_c3_o3_f:
s_nop 0
s_xor_b32 s32, s23, 3072
buffer_load_dwordx4 v[12:15], v116, s[4:7], s32 offen sc1
s_xor_b32 s32, s23, 4096
buffer_load_dwordx4 v[16:19], v116, s[4:7], s32 offen sc1
s_sub_u32 s29, s29, 1
s_cbranch_scc1 main_kernel_end
s_waitcnt vmcnt(0)
v_max_u32 v126, v12, v14
v_cmp_eq_u32 vcc, -1, v126
s_cbranch_vccnz main_kernel_c3_o3_f
s_branch main_kernel_c3_o3
main_kernel_c3_o4_f:
s_nop 0
s_xor_b32 s32, s23, 4096
buffer_load_dwordx4 v[16:19], v116, s[4:7], s32 offen sc1
s_xor_b32 s32, s23, 5120
buffer_load_dwordx4 v[20:23], v116, s[4:7], s32 offen sc1
s_sub_u32 s29, s29, 1
s_cbranch_scc1 main_kernel_end
s_waitcnt vmcnt(0)
v_max_u32 v126, v16, v18
v_cmp_eq_u32 vcc, -1, v126
s_cbranch_vccnz main_kernel_c3_o4_f
s_branch main_kernel_c3_o4
main_kernel_c3_o5_f:
s_nop 0
s_xor_b32 s32, s23, 5120
buffer_load_dwordx4 v[20:23], v116, s[4:7], s32 offen sc1
s_xor_b32 s32, s23, 6144
buffer_load_dwordx4 v[24:27], v116, s[4:7], s32 offen sc1
s_sub_u32 s29, s29, 1
s_cbranch_scc1 main_kernel_end
s_waitcnt vmcnt(0)
v_max_u32 v126, v20, v22
v_cmp_eq_u32 vcc, -1, v126
s_cbranch_vccnz main_kernel_c3_o5_f
s_branch main_kernel_c3_o5
main_kernel_c3_o6_f:
s_nop 0
s_xor_b32 s32, s23, 6144
buffer_load_dwordx4 v[24:27], v116, s[4:7], s32 offen sc1
s_xor_b32 s32, s23, 7168
buffer_load_dwordx4 v[28:31], v116, s[4:7], s32 offen sc1
s_sub_u32 s29, s29, 1
s_cbranch_scc1 main_kernel_end
s_waitcnt vmcnt(0)
v_max_u32 v126, v24, v26
v_cmp_eq_u32 vcc, -1, v126
s_cbranch_vccnz main_kernel_c3_o6_f
s_branch main_kernel_c3_o6
main_kernel_c3_o7_f:
s_nop 0
s_xor_b32 s32, s23, 7168
buffer_load_dwordx4 v[28:31], v116, s[4:7], s32 offen sc1
s_sub_u32 s29, s29, 1
s_cbranch_scc1 main_kernel_end
s_waitcnt vmcnt(0)
v_max_u32 v126, v28, v30
v_cmp_eq_u32 vcc, -1, v126
s_cbranch_vccnz main_kernel_c3_o7_f
s_branch main_kernel_c3_o7
.p2align 6
main_kernel_c4_top:
s_barrier
buffer_load_dwordx4 v[0:3], v116, s[4:7], s18 offen sc1
s_add_u32 s20, s20, 0x40000
s_bitset0_b32 s20, 20
s_add_u32 s21, s21, 0x40000
s_bitset0_b32 s21, 20
s_add_u32 s22, s22, 0x40000
s_bitset0_b32 s22, 20
s_add_u32 s23, s23, 0x40000
s_bitset0_b32 s23, 20
s_xor_b32 s32, s18, 1024
buffer_load_dwordx4 v[16:19], v116, s[4:7], s32 offen sc1
s_add_u32 s3, s3, 0x40000
s_bitset0_b32 s3, 20
s_add_u32 s17, s17, 1
s_bitcmp1_b32 0x77777777, s17
s_cselect_b32 s33, 0x800, 0
s_xor_b32 s54, s54, s33
s_xor_b32 s59, s59, s33
s_add_u32 s25, s52, s59
s_nop 0
buffer_load_dwordx4 v[64:67], v116, s[4:7], s19 offen sc1
v_mov_b32 v80, 0
v_mov_b32 v81, 0
s_nop 3
s_xor_b32 s32, s19, 1024
buffer_load_dwordx4 v[68:71], v116, s[4:7], s32 offen sc1
v_mov_b32 v82, 0
v_mov_b32 v83, 0
s_nop 3
s_xor_b32 s32, s18, 2048
buffer_load_dwordx4 v[32:35], v116, s[4:7], s32 offen sc1
v_mov_b32 v84, 0
v_mov_b32 v85, 0
s_nop 3
s_xor_b32 s32, s19, 2048
buffer_load_dwordx4 v[72:75], v116, s[4:7], s32 offen sc1
v_mov_b32 v86, 0
v_mov_b32 v87, 0
s_nop 3
s_xor_b32 s32, s18, 3072
buffer_load_dwordx4 v[48:51], v116, s[4:7], s32 offen sc1
v_mov_b32 v88, 0
v_mov_b32 v89, 0
s_nop 3
s_xor_b32 s32, s19, 3072
buffer_load_dwordx4 v[76:79], v116, s[4:7], s32 offen sc1
v_mov_b32 v90, 0
v_mov_b32 v91, 0
s_waitcnt vmcnt(5)
v_pk_add_f16 v0, v0, v64
v_pk_add_f16 v1, v1, v65
v_pk_add_f16 v2, v2, v66
v_pk_add_f16 v3, v3, v67
v_cmp_u_f16 vcc, v0, v2
s_cbranch_vccnz main_kernel_c4_m0_f
main_kernel_c4_m0:
v_smfmac_f32_16x16x64_f16 v[80:83], v[0:3], a[0:7], v112
ds_write_b128 v116, v[0:3] offset:0
v_smfmac_f32_16x16x64_f16 v[84:87], v[0:3], a[128:135], v112
buffer_load_dword v123, v121, s[4:7], 0 offen sc1
s_waitcnt vmcnt(5)
v_pk_add_f16 v16, v16, v68
v_pk_add_f16 v17, v17, v69
v_pk_add_f16 v18, v18, v70
v_pk_add_f16 v19, v19, v71
v_cmp_u_f16 vcc, v16, v18
s_waitcnt lgkmcnt(0)
s_barrier
ds_read_b128 v[4:7], v116 offset:1024
ds_write_b128 v116, v[16:19] offset:4096
s_cbranch_vccnz main_kernel_c4_m1_f
main_kernel_c4_m1:
v_smfmac_f32_16x16x64_f16 v[80:83], v[16:19], a[8:15], v112
v_smfmac_f32_16x16x64_f16 v[84:87], v[16:19], a[136:143], v112
ds_read_b128 v[8:11], v116 offset:2048
v_smfmac_f32_16x16x64_f16 v[88:91], v[0:3], v[128:135], v112
ds_read_b128 v[12:15], v116 offset:3072
s_waitcnt lgkmcnt(3)
v_smfmac_f32_16x16x64_f16 v[80:83], v[4:7], a[32:39], v112
v_smfmac_f32_16x16x64_f16 v[84:87], v[4:7], a[160:167], v112
v_smfmac_f32_16x16x64_f16 v[88:91], v[4:7], v[136:143], v112
s_waitcnt lgkmcnt(2)
s_barrier
s_waitcnt lgkmcnt(1)
v_smfmac_f32_16x16x64_f16 v[80:83], v[8:11], a[64:71], v112
s_waitcnt vmcnt(3)
ds_read_b128 v[20:23], v116 offset:5120
v_pk_add_f16 v32, v32, v72
v_smfmac_f32_16x16x64_f16 v[84:87], v[8:11], a[192:199], v112
ds_read_b128 v[24:27], v116 offset:6144
s_waitcnt lgkmcnt(2)
v_pk_add_f16 v33, v33, v73
v_smfmac_f32_16x16x64_f16 v[80:83], v[12:15], a[96:103], v112
ds_read_b128 v[28:31], v116 offset:7168
v_pk_add_f16 v34, v34, v74
v_smfmac_f32_16x16x64_f16 v[84:87], v[12:15], a[224:231], v112
s_waitcnt lgkmcnt(2)
v_pk_add_f16 v35, v35, v75
v_smfmac_f32_16x16x64_f16 v[80:83], v[20:23], a[40:47], v112
ds_write_b128 v116, v[32:35] offset:8192
v_cmp_u_f16 vcc, v32, v34
v_smfmac_f32_16x16x64_f16 v[84:87], v[20:23], a[168:175], v112
s_cbranch_vccnz main_kernel_c4_m2_f
main_kernel_c4_m2:
v_smfmac_f32_16x16x64_f16 v[80:83], v[32:35], a[16:23], v112
buffer_load_dwordx4 v[96:99], v116, s[4:7], s28 offen sc1
v_smfmac_f32_16x16x64_f16 v[84:87], v[32:35], a[144:151], v112
s_add_u32 s28, s28, 0x40000
s_waitcnt lgkmcnt(2)
v_smfmac_f32_16x16x64_f16 v[80:83], v[24:27], a[72:79], v112
s_waitcnt vmcnt(2)
v_pk_add_f16 v48, v48, v76
v_smfmac_f32_16x16x64_f16 v[84:87], v[24:27], a[200:207], v112
s_waitcnt lgkmcnt(0)
s_barrier
ds_read_b128 v[36:39], v116 offset:9216
v_pk_add_f16 v49, v49, v77
v_smfmac_f32_16x16x64_f16 v[80:83], v[28:31], a[104:111], v112
ds_read_b128 v[40:43], v116 offset:10240
v_pk_add_f16 v50, v50, v78
v_smfmac_f32_16x16x64_f16 v[84:87], v[28:31], a[232:239], v112
ds_read_b128 v[44:47], v116 offset:11264
v_pk_add_f16 v51, v51, v79
v_smfmac_f32_16x16x64_f16 v[88:91], v[8:11], v[144:151], v112
ds_write_b128 v116, v[48:51] offset:12288
s_waitcnt lgkmcnt(3)
v_cmp_u_f16 vcc, v48, v50
v_smfmac_f32_16x16x64_f16 v[80:83], v[36:39], a[48:55], v112
s_cbranch_vccnz main_kernel_c4_m3_f
main_kernel_c4_m3:
v_smfmac_f32_16x16x64_f16 v[80:83], v[48:51], a[24:31], v112
v_smfmac_f32_16x16x64_f16 v[84:87], v[48:51], a[152:159], v112
v_smfmac_f32_16x16x64_f16 v[84:87], v[36:39], a[176:183], v112
s_waitcnt lgkmcnt(2)
v_smfmac_f32_16x16x64_f16 v[80:83], v[40:43], a[80:87], v112
s_waitcnt lgkmcnt(0)
s_barrier
ds_read_b128 v[52:55], v116 offset:13312
v_smfmac_f32_16x16x64_f16 v[84:87], v[40:43], a[208:215], v112
s_add_u32 s19, s52, s54
ds_read_b128 v[56:59], v116 offset:14336
v_smfmac_f32_16x16x64_f16 v[80:83], v[44:47], a[112:119], v112
s_add_u32 s18, s18, 0x40000
ds_read_b128 v[60:63], v116 offset:15360
v_smfmac_f32_16x16x64_f16 v[84:87], v[44:47], a[240:247], v112
s_bitset0_b32 s18, 20
s_waitcnt lgkmcnt(2)
v_smfmac_f32_16x16x64_f16 v[80:83], v[52:55], a[56:63], v112
s_cmp_eq_u32 s17, 30
s_cselect_b32 s32, s53, 0x10000
s_waitcnt lgkmcnt(1)
v_smfmac_f32_16x16x64_f16 v[80:83], v[56:59], a[88:95], v112
s_add_u32 s52, s52, s32
s_waitcnt lgkmcnt(0)
v_smfmac_f32_16x16x64_f16 v[80:83], v[60:63], a[120:127], v112
s_sub_u32 s24, 0x20000, s32
ds_read_b128 v[64:67], v116 offset:24576
v_smfmac_f32_16x16x64_f16 v[84:87], v[52:55], a[184:191], v112
s_add_u32 s55, s55, s24
ds_read_b128 v[68:71], v116 offset:28672
v_smfmac_f32_16x16x64_f16 v[84:87], v[56:59], a[216:223], v112
ds_read_b128 v[72:75], v116 offset:25600
s_nop 0
v_cvt_pk_bf16_f32 v92, v80, v81
v_smfmac_f32_16x16x64_f16 v[84:87], v[60:63], a[248:255], v112
ds_read_b128 v[76:79], v116 offset:29696
s_nop 0
v_cvt_pk_bf16_f32 v93, v82, v83
v_smfmac_f32_16x16x64_f16 v[88:91], v[12:15], v[152:159], v112
s_nop 3
v_cvt_pk_bf16_f32 v94, v84, v85
v_cvt_pk_bf16_f32 v95, v86, v87
s_mov_b32 vcc_lo, 0xcccccccc
s_mov_b32 vcc_hi, 0xcccccccc
v_mfma_f32_16x16x32_bf16 v[84:87], v[92:95], v[104:107], 0
v_add_u32 v121, v121, v122
v_writelane_b32 v121, s55, 39
s_nop 0
v_smfmac_f32_16x16x64_f16 v[88:91], v[16:19], v[160:167], v112
s_nop 2
s_cmp_eq_u32 s17, 63
v_cvt_pk_bf16_f32 v114, v84, v85
v_cvt_pk_bf16_f32 v115, v86, v87
buffer_store_dwordx2 v[114:115], v117, s[4:7], s21 offen sc1
s_cbranch_scc1 main_kernel_c4_last
ds_write_b64 v117, v[114:115] offset:16384
v_smfmac_f32_16x16x64_f16 v[88:91], v[20:23], v[168:175], v112
v_smfmac_f32_16x16x64_f16 v[88:91], v[24:27], v[176:183], v112
v_smfmac_f32_16x16x64_f16 v[88:91], v[28:31], v[184:191], v112
v_smfmac_f32_16x16x64_f16 v[88:91], v[32:35], v[192:199], v112
s_waitcnt lgkmcnt(0)
s_barrier
ds_read_b128 v[0:3], v116 offset:16384
v_smfmac_f32_16x16x64_f16 v[88:91], v[36:39], v[200:207], v112
ds_read_b128 v[4:7], v116 offset:17408
v_smfmac_f32_16x16x64_f16 v[88:91], v[40:43], v[208:215], v112
ds_read_b128 v[16:19], v116 offset:26624
v_smfmac_f32_16x16x64_f16 v[88:91], v[44:47], v[216:223], v112
ds_read_b128 v[20:23], v116 offset:30720
v_smfmac_f32_16x16x64_f16 v[88:91], v[48:51], v[224:231], v112
ds_read_b128 v[24:27], v116 offset:27648
v_smfmac_f32_16x16x64_f16 v[88:91], v[52:55], v[232:239], v112
ds_read_b128 v[28:31], v116 offset:31744
v_smfmac_f32_16x16x64_f16 v[88:91], v[56:59], v[240:247], v112
v_smfmac_f32_16x16x64_f16 v[88:91], v[60:63], v[248:255], v112
s_waitcnt lgkmcnt(5)
v_mfma_f32_16x16x32_bf16 v[80:83], v[64:67], v[0:3], 0
v_mfma_f32_16x16x32_bf16 v[84:87], v[68:71], v[0:3], 0
buffer_load_dwordx4 v[8:11], v116, s[4:7], s20 offen offset:0 sc1
v_mfma_f32_16x16x32_bf16 v[92:95], v[0:3], v[0:3], 0
buffer_load_dwordx4 v[12:15], v116, s[4:7], s20 offen offset:1024 sc1
v_permlane32_swap_b32 v88, v90
s_waitcnt lgkmcnt(4)
v_mfma_f32_16x16x32_bf16 v[80:83], v[72:75], v[4:7], v[80:83]
v_permlane32_swap_b32 v89, v91
v_mfma_f32_16x16x32_bf16 v[84:87], v[76:79], v[4:7], v[84:87]
v_pk_add_f32 v[88:89], v[88:89], v[90:91]
v_mfma_f32_16x16x32_bf16 v[92:95], v[4:7], v[4:7], v[92:95]
v_cvt_pk_bf16_f32 v124, v88, v89
v_mov_b32 v65, 0
s_waitcnt lgkmcnt(0)
s_waitcnt vmcnt(1)
v_mfma_f32_16x16x32_bf16 v[88:91], v[8:11], v[8:11], v[92:95]
v_mfma_f32_16x16x32_bf16 v[0:3], v[16:19], v[8:11], v[80:83]
v_cmp_u_f32 s[0:1], v8, v10
v_mfma_f32_16x16x32_bf16 v[4:7], v[20:23], v[8:11], v[84:87]
s_waitcnt vmcnt(0)
v_mfma_f32_16x16x32_bf16 v[88:91], v[12:15], v[12:15], v[88:91]
v_mfma_f32_16x16x32_bf16 v[0:3], v[24:27], v[12:15], v[0:3]
v_cmp_u_f32 s[32:33], v12, v14
v_mfma_f32_16x16x32_bf16 v[4:7], v[28:31], v[12:15], v[4:7]
s_or_b64 s[0:1], s[0:1], s[32:33]
s_cbranch_scc1 main_kernel_c4_z_f
main_kernel_c4_z:
v_mul_f32 v88, s30, v88
v_mul_f32 v89, s30, v89
v_exp_f32 v88, v88
v_exp_f32 v89, v89
v_cndmask_b32_dpp v0, v2, v0, vcc quad_perm:[2,3,2,3] row_mask:0xf bank_mask:0xf
v_cvt_pk_bf16_f32 v64, v88, v89
v_cndmask_b32_dpp v1, v3, v1, vcc quad_perm:[2,3,2,3] row_mask:0xf bank_mask:0xf
v_exp_f32 v0, v0
v_mfma_f32_16x16x16_bf16 v[16:19], v[100:101], v[64:65], 0
v_exp_f32 v1, v1
v_cndmask_b32_dpp v4, v6, v4, vcc quad_perm:[2,3,2,3] row_mask:0xf bank_mask:0xf
v_mfma_f32_16x16x16_bf16 v[8:11], v[124:125], v[64:65], 0
v_cndmask_b32_dpp v5, v7, v5, vcc quad_perm:[2,3,2,3] row_mask:0xf bank_mask:0xf
v_exp_f32 v4, v4
v_exp_f32 v5, v5
v_cvt_pk_bf16_f32 v92, v0, v1
v_cvt_pk_bf16_f32 v94, v4, v5
v_mov_b32 v80, 0
v_mov_b32_dpp v93, v92 quad_perm:[0,1,0,1] row_mask:0xf bank_mask:0xf
v_mov_b32_dpp v95, v94 quad_perm:[0,1,0,1] row_mask:0xf bank_mask:0xf
v_mov_b32 v81, 0
v_mov_b32 v82, 0
v_mfma_f32_16x16x32_bf16 v[16:19], v[100:103], v[92:95], v[16:19]
v_mov_b32 v83, 0
v_mov_b32 v84, 0
v_mfma_f32_16x16x32_bf16 v[8:11], v[96:99], v[92:95], v[8:11]
s_nop 1
v_mov_b32 v85, 0
v_mov_b32 v86, 0
v_mov_b32 v87, 0
v_rcp_f32 v126, v16
v_subrev_u32 v127, 0x21800000, v16
v_cmp_lt_u32 vcc, 0x3c000000, v127
v_pk_mul_f32 v[8:9], v[8:9], v[126:127] op_sel_hi:[1,0]
v_pk_mul_f32 v[10:11], v[10:11], v[126:127] op_sel_hi:[1,0]
s_and_b32 s32, vcc_lo, 0xcccc
v_cvt_pk_bf16_f32 v126, v8, v9
v_cvt_pk_bf16_f32 v127, v10, v11
s_cbranch_scc1 main_kernel_c4_sm_f
main_kernel_c4_ost:
buffer_store_dwordx2 v[126:127], v118, s[4:7], s22 offen sc1
v_cmp_eq_u32 s[0:1], 0, v123
v_mov_b32 v24, -1
v_mov_b32 v25, -1
v_mov_b32 v26, -1
v_mov_b32 v27, -1
ds_read_b128 v[32:35], v113 offset:0
ds_read_b128 v[36:39], v113 offset:1024
ds_read_b128 v[40:43], v113 offset:2048
ds_read_b128 v[44:47], v113 offset:3072
ds_read_b128 v[48:51], v113 offset:4096
ds_read_b128 v[52:55], v113 offset:5120
s_and_b32 s10, s1, 0x3f00
buffer_store_dwordx4 v[24:27], v116, s[4:7], s3 offen sc1
s_barrier
buffer_load_dwordx4 v[0:3], v116, s[4:7], s23 offen sc1
ds_read_b128 v[56:59], v113 offset:6144
ds_read_b128 v[60:63], v113 offset:7168
s_add_u32 s37, s37, 65536
s_add_u32 s26, s26, 65536
s_nop 1
s_xor_b32 s32, s23, 1024
buffer_load_dwordx4 v[4:7], v116, s[4:7], s32 offen sc1
ds_read_b128 v[64:67], v113 offset:8192
ds_read_b128 v[68:71], v113 offset:9216
s_nop 3
s_xor_b32 s32, s23, 2048
buffer_load_dwordx4 v[8:11], v116, s[4:7], s32 offen sc1
ds_read_b128 v[72:75], v113 offset:10240
ds_read_b128 v[76:79], v113 offset:11264
s_nop 3
s_xor_b32 s32, s23, 3072
buffer_load_dwordx4 v[12:15], v116, s[4:7], s32 offen sc1
ds_read_b128 v[88:91], v113 offset:12288
ds_read_b128 v[92:95], v113 offset:13312
s_nop 3
s_xor_b32 s32, s23, 4096
buffer_load_dwordx4 v[16:19], v116, s[4:7], s32 offen sc1
s_nop 7
s_xor_b32 s32, s23, 5120
buffer_load_dwordx4 v[20:23], v116, s[4:7], s32 offen sc1
s_nop 7
s_xor_b32 s32, s23, 6144
buffer_load_dwordx4 v[24:27], v116, s[4:7], s32 offen sc1
s_nop 7
s_xor_b32 s32, s23, 7168
buffer_load_dwordx4 v[28:31], v116, s[4:7], s32 offen sc1
s_waitcnt lgkmcnt(12)
s_waitcnt vmcnt(7)
v_cmp_u_f32 vcc, v0, v2
s_cbranch_vccnz main_kernel_c4_o0_f
main_kernel_c4_o0:
v_smfmac_f32_16x16x64_bf16 v[80:83], v[0:3], v[32:39], v112
ds_read_b128 v[32:35], v113 offset:14336
ds_read_b128 v[36:39], v113 offset:15360
s_waitcnt lgkmcnt(12)
s_waitcnt vmcnt(6)
v_cmp_u_f32 vcc, v4, v6
v_smfmac_f32_16x16x64_bf16 v[84:87], v[0:3], v[40:47], v112
ds_read_b128 v[40:43], v113 offset:16384
ds_read_b128 v[44:47], v113 offset:17408
buffer_store_dwordx2 v[114:115], v119, s[4:7], s37 offen sc1
s_cbranch_vccnz main_kernel_c4_o1_f
main_kernel_c4_o1:
s_waitcnt lgkmcnt(12)
v_smfmac_f32_16x16x64_bf16 v[80:83], v[4:7], v[48:55], v112
ds_read_b128 v[48:51], v113 offset:18432
ds_read_b128 v[52:55], v113 offset:19456
s_waitcnt lgkmcnt(12)
s_waitcnt vmcnt(6)
v_cmp_u_f32 vcc, v8, v10
v_smfmac_f32_16x16x64_bf16 v[84:87], v[4:7], v[56:63], v112
ds_read_b128 v[56:59], v113 offset:20480
ds_read_b128 v[60:63], v113 offset:21504
buffer_store_dword v124, v120, s[4:7], s26 offen sc1
s_cbranch_vccnz main_kernel_c4_o2_f
main_kernel_c4_o2:
s_waitcnt lgkmcnt(12)
v_smfmac_f32_16x16x64_bf16 v[80:83], v[8:11], v[64:71], v112
ds_read_b128 v[64:67], v113 offset:22528
ds_read_b128 v[68:71], v113 offset:23552
s_waitcnt lgkmcnt(12)
s_waitcnt vmcnt(6)
v_cmp_u_f32 vcc, v12, v14
v_smfmac_f32_16x16x64_bf16 v[84:87], v[8:11], v[72:79], v112
ds_read_b128 v[72:75], v113 offset:24576
ds_read_b128 v[76:79], v113 offset:25600
s_cbranch_vccnz main_kernel_c4_o3_f
main_kernel_c4_o3:
s_waitcnt lgkmcnt(12)
v_smfmac_f32_16x16x64_bf16 v[80:83], v[12:15], v[88:95], v112
ds_read_b128 v[88:91], v113 offset:26624
ds_read_b128 v[92:95], v113 offset:27648
s_waitcnt lgkmcnt(12)
s_waitcnt vmcnt(5)
v_cmp_u_f32 vcc, v16, v18
v_smfmac_f32_16x16x64_bf16 v[84:87], v[12:15], v[32:39], v112
ds_read_b128 v[32:35], v113 offset:28672
ds_read_b128 v[36:39], v113 offset:29696
s_cbranch_vccnz main_kernel_c4_o4_f
main_kernel_c4_o4:
s_waitcnt lgkmcnt(12)
v_smfmac_f32_16x16x64_bf16 v[80:83], v[16:19], v[40:47], v112
ds_read_b128 v[40:43], v113 offset:30720
ds_read_b128 v[44:47], v113 offset:31744
s_waitcnt lgkmcnt(12)
s_waitcnt vmcnt(4)
v_cmp_u_f32 vcc, v20, v22
v_smfmac_f32_16x16x64_bf16 v[84:87], v[16:19], v[48:55], v112
s_cbranch_vccnz main_kernel_c4_o5_f
main_kernel_c4_o5:
s_waitcnt lgkmcnt(10)
v_smfmac_f32_16x16x64_bf16 v[80:83], v[20:23], v[56:63], v112
s_waitcnt lgkmcnt(8)
s_waitcnt vmcnt(3)
v_cmp_u_f32 vcc, v24, v26
v_smfmac_f32_16x16x64_bf16 v[84:87], v[20:23], v[64:71], v112
s_cbranch_vccnz main_kernel_c4_o6_f
main_kernel_c4_o6:
s_waitcnt lgkmcnt(6)
v_smfmac_f32_16x16x64_bf16 v[80:83], v[24:27], v[72:79], v112
s_waitcnt lgkmcnt(4)
v_smfmac_f32_16x16x64_bf16 v[84:87], v[24:27], v[88:95], v112
s_waitcnt lgkmcnt(2)
s_waitcnt vmcnt(2)
v_cmp_u_f32 vcc, v28, v30
s_cbranch_vccnz main_kernel_c4_o7_f
main_kernel_c4_o7:
v_smfmac_f32_16x16x64_bf16 v[80:83], v[28:31], v[32:39], v112
s_waitcnt lgkmcnt(0)
v_smfmac_f32_16x16x64_bf16 v[84:87], v[28:31], v[40:47], v112
s_nop 4
v_cvt_pk_bf16_f32 v80, v80, v81
v_cvt_pk_bf16_f32 v81, v82, v83
ds_write_b64 v116, v[80:81] offset:20480
v_cvt_pk_bf16_f32 v82, v84, v85
v_cvt_pk_bf16_f32 v83, v86, v87
ds_write_b64 v116, v[82:83] offset:22528
s_waitcnt lgkmcnt(0)
s_barrier
ds_read_b128 v[72:75], v116 offset:20480
ds_read_b128 v[76:79], v116 offset:21504
s_mov_b32 m0, 24576
s_cmp_lg_u32 s10, 0
s_waitcnt lgkmcnt(1)
v_mfma_f32_16x16x32_bf16 v[64:67], v[72:75], v[108:111], 0
s_waitcnt lgkmcnt(0)
v_mfma_f32_16x16x32_bf16 v[64:67], v[76:79], v[108:111], v[64:67]
s_nop 7
v_cvt_pk_f16_f32 v68, v64, v65
v_cvt_pk_f16_f32 v69, v66, v67
buffer_store_dwordx2 v[68:69], v125, s[4:7], s25 offen sc1
s_cbranch_scc1 main_kernel_c4_kvw
main_kernel_c4_kvok:
s_nop 3
buffer_load_dwordx4 v116, s[4:7], s27 offen sc1 lds
buffer_load_dwordx4 v116, s[4:7], s27 offen offset:1024 sc1 lds
s_add_u32 s27, s27, 0x40000
s_branch main_kernel_c4_top
main_kernel_c4_kvw:
s_mov_b32 exec_lo, 0
s_mov_b32 exec_hi, 0x3f00
v_subrev_u32 v127, 128, v121
main_kernel_c4_kvp:
buffer_load_dword v126, v127, s[4:7], 0 offen sc1
s_waitcnt vmcnt(0)
v_cmp_eq_u32 vcc, 0, v126
s_cbranch_vccz main_kernel_c4_kvp_ok
s_sleep 2
s_sub_u32 s29, s29, 1
s_cbranch_scc0 main_kernel_c4_kvp
s_branch main_kernel_end
main_kernel_c4_kvp_ok:
s_mov_b64 exec, -1
s_branch main_kernel_c4_kvok
main_kernel_c4_last:
s_add_u32 s37, s37, 65536
s_add_u32 s26, s26, 65536
buffer_store_dwordx2 v[114:115], v119, s[4:7], s37 offen sc1
v_smfmac_f32_16x16x64_f16 v[88:91], v[20:23], v[168:175], v112
v_smfmac_f32_16x16x64_f16 v[88:91], v[24:27], v[176:183], v112
v_smfmac_f32_16x16x64_f16 v[88:91], v[28:31], v[184:191], v112
v_smfmac_f32_16x16x64_f16 v[88:91], v[32:35], v[192:199], v112
v_smfmac_f32_16x16x64_f16 v[88:91], v[36:39], v[200:207], v112
v_smfmac_f32_16x16x64_f16 v[88:91], v[40:43], v[208:215], v112
v_smfmac_f32_16x16x64_f16 v[88:91], v[44:47], v[216:223], v112
v_smfmac_f32_16x16x64_f16 v[88:91], v[48:51], v[224:231], v112
v_smfmac_f32_16x16x64_f16 v[88:91], v[52:55], v[232:239], v112
v_smfmac_f32_16x16x64_f16 v[88:91], v[56:59], v[240:247], v112
v_smfmac_f32_16x16x64_f16 v[88:91], v[60:63], v[248:255], v112
s_nop 7
v_permlane32_swap_b32 v88, v90
s_nop 1
v_permlane32_swap_b32 v89, v91
s_nop 1
v_pk_add_f32 v[88:89], v[88:89], v[90:91]
s_nop 1
v_cvt_pk_bf16_f32 v124, v88, v89
s_nop 1
buffer_store_dword v124, v120, s[4:7], s26 offen sc1
s_branch main_kernel_end
main_kernel_c4_m0_f:
s_waitcnt lgkmcnt(0)
buffer_load_dwordx4 v[0:3], v116, s[4:7], s18 offen sc1
buffer_load_dwordx4 v[64:67], v116, s[4:7], s19 offen sc1
s_xor_b32 s32, s18, 1024
buffer_load_dwordx4 v[16:19], v116, s[4:7], s32 offen sc1
s_xor_b32 s32, s19, 1024
buffer_load_dwordx4 v[68:71], v116, s[4:7], s32 offen sc1
s_xor_b32 s32, s18, 2048
buffer_load_dwordx4 v[32:35], v116, s[4:7], s32 offen sc1
s_xor_b32 s32, s19, 2048
buffer_load_dwordx4 v[72:75], v116, s[4:7], s32 offen sc1
s_xor_b32 s32, s18, 3072
buffer_load_dwordx4 v[48:51], v116, s[4:7], s32 offen sc1
s_xor_b32 s32, s19, 3072
buffer_load_dwordx4 v[76:79], v116, s[4:7], s32 offen sc1
s_sub_u32 s29, s29, 1
s_cbranch_scc1 main_kernel_end
s_waitcnt vmcnt(0)
v_max_u32 v126, v0, v2
v_max3_u32 v126, v126, v64, v66
v_cmp_eq_u32 vcc, -1, v126
s_cbranch_vccnz main_kernel_c4_m0_f
v_pk_add_f16 v0, v0, v64
v_pk_add_f16 v1, v1, v65
v_pk_add_f16 v2, v2, v66
v_pk_add_f16 v3, v3, v67
s_nop 0
s_branch main_kernel_c4_m0
main_kernel_c4_m1_f:
s_waitcnt lgkmcnt(0)
s_xor_b32 s32, s18, 1024
buffer_load_dwordx4 v[16:19], v116, s[4:7], s32 offen sc1
s_xor_b32 s32, s19, 1024
buffer_load_dwordx4 v[68:71], v116, s[4:7], s32 offen sc1
s_xor_b32 s32, s18, 2048
buffer_load_dwordx4 v[32:35], v116, s[4:7], s32 offen sc1
s_xor_b32 s32, s19, 2048
buffer_load_dwordx4 v[72:75], v116, s[4:7], s32 offen sc1
s_xor_b32 s32, s18, 3072
buffer_load_dwordx4 v[48:51], v116, s[4:7], s32 offen sc1
s_xor_b32 s32, s19, 3072
buffer_load_dwordx4 v[76:79], v116, s[4:7], s32 offen sc1
s_sub_u32 s29, s29, 1
s_cbranch_scc1 main_kernel_end
s_waitcnt vmcnt(0)
v_max_u32 v126, v16, v18
v_max3_u32 v126, v126, v68, v70
v_cmp_eq_u32 vcc, -1, v126
s_cbranch_vccnz main_kernel_c4_m1_f
v_pk_add_f16 v16, v16, v68
v_pk_add_f16 v17, v17, v69
v_pk_add_f16 v18, v18, v70
v_pk_add_f16 v19, v19, v71
ds_write_b128 v116, v[16:19] offset:4096
s_branch main_kernel_c4_m1
main_kernel_c4_m2_f:
s_waitcnt lgkmcnt(0)
s_xor_b32 s32, s18, 2048
buffer_load_dwordx4 v[32:35], v116, s[4:7], s32 offen sc1
s_xor_b32 s32, s19, 2048
buffer_load_dwordx4 v[72:75], v116, s[4:7], s32 offen sc1
s_xor_b32 s32, s18, 3072
buffer_load_dwordx4 v[48:51], v116, s[4:7], s32 offen sc1
s_xor_b32 s32, s19, 3072
buffer_load_dwordx4 v[76:79], v116, s[4:7], s32 offen sc1
s_sub_u32 s29, s29, 1
s_cbranch_scc1 main_kernel_end
s_waitcnt vmcnt(0)
v_max_u32 v126, v32, v34
v_max3_u32 v126, v126, v72, v74
v_cmp_eq_u32 vcc, -1, v126
s_cbranch_vccnz main_kernel_c4_m2_f
v_pk_add_f16 v32, v32, v72
v_pk_add_f16 v33, v33, v73
v_pk_add_f16 v34, v34, v74
v_pk_add_f16 v35, v35, v75
ds_write_b128 v116, v[32:35] offset:8192
s_branch main_kernel_c4_m2
main_kernel_c4_m3_f:
s_waitcnt lgkmcnt(0)
s_xor_b32 s32, s18, 3072
buffer_load_dwordx4 v[48:51], v116, s[4:7], s32 offen sc1
s_xor_b32 s32, s19, 3072
buffer_load_dwordx4 v[76:79], v116, s[4:7], s32 offen sc1
s_sub_u32 s29, s29, 1
s_cbranch_scc1 main_kernel_end
s_waitcnt vmcnt(0)
v_max_u32 v126, v48, v50
v_max3_u32 v126, v126, v76, v78
v_cmp_eq_u32 vcc, -1, v126
s_cbranch_vccnz main_kernel_c4_m3_f
v_pk_add_f16 v48, v48, v76
v_pk_add_f16 v49, v49, v77
v_pk_add_f16 v50, v50, v78
v_pk_add_f16 v51, v51, v79
ds_write_b128 v116, v[48:51] offset:12288
s_branch main_kernel_c4_m3
main_kernel_c4_z_f:
buffer_load_dwordx4 v[8:11], v116, s[4:7], s20 offen offset:0 sc1
buffer_load_dwordx4 v[12:15], v116, s[4:7], s20 offen offset:1024 sc1
s_memtime s[32:33]
ds_read_b32 v126, v116 offset:18432
s_sub_u32 s34, s19, s54
s_xor_b32 s34, s34, 0x2000
s_lshl_b32 s35, s12, 15
s_add_u32 s34, s34, s35
s_lshl_b32 s35, s13, 8
s_add_u32 s35, s35, s34
s_add_u32 s34, s34, 0x4000
s_waitcnt lgkmcnt(0)
s_sub_u32 s32, s32, 450
v_sub_u32 v127, s32, v126
buffer_store_dword v127, off, s[4:7], s34 sc1
s_sub_u32 s29, s29, 1
s_cbranch_scc1 main_kernel_end
s_waitcnt vmcnt(1)
main_kernel_c4_z_g:
v_max_u32 v126, v8, v10
v_max3_u32 v126, v126, v12, v14
v_cmp_eq_u32 vcc, -1, v126
s_cbranch_vccnz main_kernel_c4_z_h
v_mfma_f32_16x16x32_bf16 v[88:91], v[8:11], v[8:11], v[92:95]
v_mfma_f32_16x16x32_bf16 v[0:3], v[16:19], v[8:11], v[80:83]
v_mfma_f32_16x16x32_bf16 v[4:7], v[20:23], v[8:11], v[84:87]
v_mfma_f32_16x16x32_bf16 v[88:91], v[12:15], v[12:15], v[88:91]
v_mfma_f32_16x16x32_bf16 v[0:3], v[24:27], v[12:15], v[0:3]
v_mfma_f32_16x16x32_bf16 v[4:7], v[28:31], v[12:15], v[4:7]
buffer_store_dword v127, off, s[4:7], s35 offset:132 sc1
s_mov_b32 vcc_lo, 0xcccccccc
s_mov_b32 vcc_hi, 0xcccccccc
s_branch main_kernel_c4_z
main_kernel_c4_z_h:
buffer_load_dwordx4 v[8:11], v116, s[4:7], s20 offen offset:0 sc1
buffer_load_dwordx4 v[12:15], v116, s[4:7], s20 offen offset:1024 sc1
s_sub_u32 s29, s29, 1
s_cbranch_scc1 main_kernel_end
v_add_u32 v127, 300, v127
s_waitcnt vmcnt(0)
s_branch main_kernel_c4_z_g
main_kernel_c4_sm_f:
s_waitcnt vmcnt(0) lgkmcnt(0)
buffer_load_dwordx4 v[8:11], v116, s[4:7], s20 offen offset:0 sc1
buffer_load_dwordx4 v[12:15], v116, s[4:7], s20 offen offset:1024 sc1
ds_read_b128 v[0:3], v116 offset:16384
ds_read_b128 v[4:7], v116 offset:17408
ds_read_b128 v[64:67], v116 offset:24576
ds_read_b128 v[68:71], v116 offset:28672
ds_read_b128 v[72:75], v116 offset:25600
ds_read_b128 v[76:79], v116 offset:29696
ds_read_b128 v[16:19], v116 offset:26624
ds_read_b128 v[20:23], v116 offset:30720
ds_read_b128 v[24:27], v116 offset:27648
ds_read_b128 v[28:31], v116 offset:31744
s_waitcnt vmcnt(0)
s_waitcnt lgkmcnt(0)
v_mfma_f32_16x16x32_bf16 v[80:83], v[64:67], v[0:3], 0
v_mfma_f32_16x16x32_bf16 v[84:87], v[68:71], v[0:3], 0
v_mfma_f32_16x16x32_bf16 v[92:95], v[0:3], v[0:3], 0
v_mfma_f32_16x16x32_bf16 v[80:83], v[72:75], v[4:7], v[80:83]
v_mfma_f32_16x16x32_bf16 v[84:87], v[76:79], v[4:7], v[84:87]
v_mfma_f32_16x16x32_bf16 v[92:95], v[4:7], v[4:7], v[92:95]
v_mfma_f32_16x16x32_bf16 v[0:3], v[16:19], v[8:11], v[80:83]
v_mfma_f32_16x16x32_bf16 v[4:7], v[20:23], v[8:11], v[84:87]
v_mfma_f32_16x16x32_bf16 v[88:91], v[8:11], v[8:11], v[92:95]
v_mfma_f32_16x16x32_bf16 v[0:3], v[24:27], v[12:15], v[0:3]
v_mfma_f32_16x16x32_bf16 v[4:7], v[28:31], v[12:15], v[4:7]
v_mfma_f32_16x16x32_bf16 v[88:91], v[12:15], v[12:15], v[88:91]
s_nop 7
v_mov_b32 v65, 0
v_max_f32 v126, v88, v89
v_mul_f32 v126, s30, v126
v_max3_f32 v126, v126, v0, v1
v_max3_f32 v126, v126, v2, v3
v_max3_f32 v126, v126, v4, v5
v_max3_f32 v126, v126, v6, v7
v_mov_b32 v127, v126
s_nop 1
v_permlane32_swap_b32 v126, v127
v_max_f32 v126, v126, v127
v_mov_b32 v127, v126
s_nop 1
v_permlane16_swap_b32 v126, v127
v_max_f32 v126, v126, v127
v_mul_f32 v127, 0x40faf233, v126
s_mov_b32 vcc_lo, 0xcccccccc
s_mov_b32 vcc_hi, 0xcccccccc
v_sub_f32 v0, v0, v126
v_sub_f32 v1, v1, v126
v_sub_f32 v2, v2, v126
v_sub_f32 v3, v3, v126
v_sub_f32 v4, v4, v126
v_sub_f32 v5, v5, v126
v_sub_f32 v6, v6, v126
v_sub_f32 v7, v7, v126
v_sub_f32 v88, v88, v127
v_sub_f32 v89, v89, v127
s_waitcnt lgkmcnt(0)
s_nop 0
v_mul_f32 v88, s30, v88
v_mul_f32 v89, s30, v89
v_exp_f32 v88, v88
v_exp_f32 v89, v89
v_cndmask_b32_dpp v0, v2, v0, vcc quad_perm:[2,3,2,3] row_mask:0xf bank_mask:0xf
v_cvt_pk_bf16_f32 v64, v88, v89
v_cndmask_b32_dpp v1, v3, v1, vcc quad_perm:[2,3,2,3] row_mask:0xf bank_mask:0xf
v_exp_f32 v0, v0
v_mfma_f32_16x16x16_bf16 v[16:19], v[100:101], v[64:65], 0
v_exp_f32 v1, v1
v_cndmask_b32_dpp v4, v6, v4, vcc quad_perm:[2,3,2,3] row_mask:0xf bank_mask:0xf
v_mfma_f32_16x16x16_bf16 v[8:11], v[124:125], v[64:65], 0
v_cndmask_b32_dpp v5, v7, v5, vcc quad_perm:[2,3,2,3] row_mask:0xf bank_mask:0xf
v_exp_f32 v4, v4
v_exp_f32 v5, v5
v_cvt_pk_bf16_f32 v92, v0, v1
v_cvt_pk_bf16_f32 v94, v4, v5
v_mov_b32 v80, 0
v_mov_b32_dpp v93, v92 quad_perm:[0,1,0,1] row_mask:0xf bank_mask:0xf
v_mov_b32_dpp v95, v94 quad_perm:[0,1,0,1] row_mask:0xf bank_mask:0xf
v_mov_b32 v81, 0
v_mov_b32 v82, 0
v_mfma_f32_16x16x32_bf16 v[16:19], v[100:103], v[92:95], v[16:19]
v_mov_b32 v83, 0
v_mov_b32 v84, 0
v_mfma_f32_16x16x32_bf16 v[8:11], v[96:99], v[92:95], v[8:11]
s_nop 1
v_mov_b32 v85, 0
v_mov_b32 v86, 0
v_mov_b32 v87, 0
v_rcp_f32 v126, v16
v_subrev_u32 v127, 0x21800000, v16
v_cmp_lt_u32 vcc, 0x3c000000, v127
v_pk_mul_f32 v[8:9], v[8:9], v[126:127] op_sel_hi:[1,0]
v_pk_mul_f32 v[10:11], v[10:11], v[126:127] op_sel_hi:[1,0]
s_and_b32 s32, vcc_lo, 0xcccc
v_cvt_pk_bf16_f32 v126, v8, v9
v_cvt_pk_bf16_f32 v127, v10, v11
s_branch main_kernel_c4_ost
main_kernel_c4_o0_f:
s_nop 0
buffer_load_dwordx4 v[0:3], v116, s[4:7], s23 offen sc1
s_xor_b32 s32, s23, 1024
buffer_load_dwordx4 v[4:7], v116, s[4:7], s32 offen sc1
s_sub_u32 s29, s29, 1
s_cbranch_scc1 main_kernel_end
s_waitcnt vmcnt(0)
v_max_u32 v126, v0, v2
v_cmp_eq_u32 vcc, -1, v126
s_cbranch_vccnz main_kernel_c4_o0_f
s_branch main_kernel_c4_o0
main_kernel_c4_o1_f:
s_nop 0
s_xor_b32 s32, s23, 1024
buffer_load_dwordx4 v[4:7], v116, s[4:7], s32 offen sc1
s_xor_b32 s32, s23, 2048
buffer_load_dwordx4 v[8:11], v116, s[4:7], s32 offen sc1
s_sub_u32 s29, s29, 1
s_cbranch_scc1 main_kernel_end
s_waitcnt vmcnt(0)
v_max_u32 v126, v4, v6
v_cmp_eq_u32 vcc, -1, v126
s_cbranch_vccnz main_kernel_c4_o1_f
s_branch main_kernel_c4_o1
main_kernel_c4_o2_f:
s_nop 0
s_xor_b32 s32, s23, 2048
buffer_load_dwordx4 v[8:11], v116, s[4:7], s32 offen sc1
s_xor_b32 s32, s23, 3072
buffer_load_dwordx4 v[12:15], v116, s[4:7], s32 offen sc1
s_sub_u32 s29, s29, 1
s_cbranch_scc1 main_kernel_end
s_waitcnt vmcnt(0)
v_max_u32 v126, v8, v10
v_cmp_eq_u32 vcc, -1, v126
s_cbranch_vccnz main_kernel_c4_o2_f
s_branch main_kernel_c4_o2
main_kernel_c4_o3_f:
s_nop 0
s_xor_b32 s32, s23, 3072
buffer_load_dwordx4 v[12:15], v116, s[4:7], s32 offen sc1
s_xor_b32 s32, s23, 4096
buffer_load_dwordx4 v[16:19], v116, s[4:7], s32 offen sc1
s_sub_u32 s29, s29, 1
s_cbranch_scc1 main_kernel_end
s_waitcnt vmcnt(0)
v_max_u32 v126, v12, v14
v_cmp_eq_u32 vcc, -1, v126
s_cbranch_vccnz main_kernel_c4_o3_f
s_branch main_kernel_c4_o3
main_kernel_c4_o4_f:
s_nop 0
s_xor_b32 s32, s23, 4096
buffer_load_dwordx4 v[16:19], v116, s[4:7], s32 offen sc1
s_xor_b32 s32, s23, 5120
buffer_load_dwordx4 v[20:23], v116, s[4:7], s32 offen sc1
s_sub_u32 s29, s29, 1
s_cbranch_scc1 main_kernel_end
s_waitcnt vmcnt(0)
v_max_u32 v126, v16, v18
v_cmp_eq_u32 vcc, -1, v126
s_cbranch_vccnz main_kernel_c4_o4_f
s_branch main_kernel_c4_o4
main_kernel_c4_o5_f:
s_nop 0
s_xor_b32 s32, s23, 5120
buffer_load_dwordx4 v[20:23], v116, s[4:7], s32 offen sc1
s_xor_b32 s32, s23, 6144
buffer_load_dwordx4 v[24:27], v116, s[4:7], s32 offen sc1
s_sub_u32 s29, s29, 1
s_cbranch_scc1 main_kernel_end
s_waitcnt vmcnt(0)
v_max_u32 v126, v20, v22
v_cmp_eq_u32 vcc, -1, v126
s_cbranch_vccnz main_kernel_c4_o5_f
s_branch main_kernel_c4_o5
main_kernel_c4_o6_f:
s_nop 0
s_xor_b32 s32, s23, 6144
buffer_load_dwordx4 v[24:27], v116, s[4:7], s32 offen sc1
s_xor_b32 s32, s23, 7168
buffer_load_dwordx4 v[28:31], v116, s[4:7], s32 offen sc1
s_sub_u32 s29, s29, 1
s_cbranch_scc1 main_kernel_end
s_waitcnt vmcnt(0)
v_max_u32 v126, v24, v26
v_cmp_eq_u32 vcc, -1, v126
s_cbranch_vccnz main_kernel_c4_o6_f
s_branch main_kernel_c4_o6
main_kernel_c4_o7_f:
s_nop 0
s_xor_b32 s32, s23, 7168
buffer_load_dwordx4 v[28:31], v116, s[4:7], s32 offen sc1
s_sub_u32 s29, s29, 1
s_cbranch_scc1 main_kernel_end
s_waitcnt vmcnt(0)
v_max_u32 v126, v28, v30
v_cmp_eq_u32 vcc, -1, v126
s_cbranch_vccnz main_kernel_c4_o7_f
s_branch main_kernel_c4_o7
.p2align 6
main_kernel_c5_top:
s_barrier
buffer_load_dwordx4 v[0:3], v116, s[4:7], s18 offen sc1
s_add_u32 s20, s20, 0x40000
s_bitset0_b32 s20, 20
s_add_u32 s21, s21, 0x40000
s_bitset0_b32 s21, 20
s_add_u32 s22, s22, 0x40000
s_bitset0_b32 s22, 20
s_add_u32 s23, s23, 0x40000
s_bitset0_b32 s23, 20
s_xor_b32 s32, s18, 1024
buffer_load_dwordx4 v[16:19], v116, s[4:7], s32 offen sc1
s_add_u32 s3, s3, 0x40000
s_bitset0_b32 s3, 20
s_add_u32 s17, s17, 1
s_bitcmp1_b32 0x77777777, s17
s_cselect_b32 s33, 0x800, 0
s_xor_b32 s54, s54, s33
s_xor_b32 s59, s59, s33
s_add_u32 s25, s52, s59
s_nop 0
buffer_load_dwordx4 v[64:67], v116, s[4:7], s19 offen sc1
v_mov_b32 v80, 0
v_mov_b32 v81, 0
s_nop 3
s_xor_b32 s32, s19, 1024
buffer_load_dwordx4 v[68:71], v116, s[4:7], s32 offen sc1
v_mov_b32 v82, 0
v_mov_b32 v83, 0
s_nop 3
s_xor_b32 s32, s18, 2048
buffer_load_dwordx4 v[32:35], v116, s[4:7], s32 offen sc1
v_mov_b32 v84, 0
v_mov_b32 v85, 0
s_nop 3
s_xor_b32 s32, s19, 2048
buffer_load_dwordx4 v[72:75], v116, s[4:7], s32 offen sc1
v_mov_b32 v86, 0
v_mov_b32 v87, 0
s_nop 3
s_xor_b32 s32, s18, 3072
buffer_load_dwordx4 v[48:51], v116, s[4:7], s32 offen sc1
v_mov_b32 v88, 0
v_mov_b32 v89, 0
s_nop 3
s_xor_b32 s32, s19, 3072
buffer_load_dwordx4 v[76:79], v116, s[4:7], s32 offen sc1
v_mov_b32 v90, 0
v_mov_b32 v91, 0
s_waitcnt vmcnt(5)
v_pk_add_f16 v0, v0, v64
v_pk_add_f16 v1, v1, v65
v_pk_add_f16 v2, v2, v66
v_pk_add_f16 v3, v3, v67
v_cmp_u_f16 vcc, v0, v2
s_cbranch_vccnz main_kernel_c5_m0_f
main_kernel_c5_m0:
v_smfmac_f32_16x16x64_f16 v[80:83], v[0:3], a[0:7], v112
ds_write_b128 v116, v[0:3] offset:1024
v_smfmac_f32_16x16x64_f16 v[84:87], v[0:3], a[128:135], v112
buffer_load_dword v123, v121, s[4:7], 0 offen sc1
s_waitcnt vmcnt(5)
v_pk_add_f16 v16, v16, v68
v_pk_add_f16 v17, v17, v69
v_pk_add_f16 v18, v18, v70
v_pk_add_f16 v19, v19, v71
v_cmp_u_f16 vcc, v16, v18
s_waitcnt lgkmcnt(0)
s_barrier
ds_read_b128 v[4:7], v116 offset:0
ds_write_b128 v116, v[16:19] offset:5120
s_cbranch_vccnz main_kernel_c5_m1_f
main_kernel_c5_m1:
v_smfmac_f32_16x16x64_f16 v[80:83], v[16:19], a[8:15], v112
v_smfmac_f32_16x16x64_f16 v[84:87], v[16:19], a[136:143], v112
ds_read_b128 v[8:11], v116 offset:3072
v_smfmac_f32_16x16x64_f16 v[88:91], v[0:3], v[128:135], v112
ds_read_b128 v[12:15], v116 offset:2048
s_waitcnt lgkmcnt(3)
v_smfmac_f32_16x16x64_f16 v[80:83], v[4:7], a[32:39], v112
v_smfmac_f32_16x16x64_f16 v[84:87], v[4:7], a[160:167], v112
v_smfmac_f32_16x16x64_f16 v[88:91], v[4:7], v[136:143], v112
s_waitcnt lgkmcnt(2)
s_barrier
s_waitcnt lgkmcnt(1)
v_smfmac_f32_16x16x64_f16 v[80:83], v[8:11], a[64:71], v112
s_waitcnt vmcnt(3)
ds_read_b128 v[20:23], v116 offset:4096
v_pk_add_f16 v32, v32, v72
v_smfmac_f32_16x16x64_f16 v[84:87], v[8:11], a[192:199], v112
ds_read_b128 v[24:27], v116 offset:7168
s_waitcnt lgkmcnt(2)
v_pk_add_f16 v33, v33, v73
v_smfmac_f32_16x16x64_f16 v[80:83], v[12:15], a[96:103], v112
ds_read_b128 v[28:31], v116 offset:6144
v_pk_add_f16 v34, v34, v74
v_smfmac_f32_16x16x64_f16 v[84:87], v[12:15], a[224:231], v112
s_waitcnt lgkmcnt(2)
v_pk_add_f16 v35, v35, v75
v_smfmac_f32_16x16x64_f16 v[80:83], v[20:23], a[40:47], v112
ds_write_b128 v116, v[32:35] offset:9216
v_cmp_u_f16 vcc, v32, v34
v_smfmac_f32_16x16x64_f16 v[84:87], v[20:23], a[168:175], v112
s_cbranch_vccnz main_kernel_c5_m2_f
main_kernel_c5_m2:
v_smfmac_f32_16x16x64_f16 v[80:83], v[32:35], a[16:23], v112
buffer_load_dwordx4 v[96:99], v116, s[4:7], s28 offen sc1
v_smfmac_f32_16x16x64_f16 v[84:87], v[32:35], a[144:151], v112
s_add_u32 s28, s28, 0x40000
s_waitcnt lgkmcnt(2)
v_smfmac_f32_16x16x64_f16 v[80:83], v[24:27], a[72:79], v112
s_waitcnt vmcnt(2)
v_pk_add_f16 v48, v48, v76
v_smfmac_f32_16x16x64_f16 v[84:87], v[24:27], a[200:207], v112
s_waitcnt lgkmcnt(0)
s_barrier
ds_read_b128 v[36:39], v116 offset:8192
v_pk_add_f16 v49, v49, v77
v_smfmac_f32_16x16x64_f16 v[80:83], v[28:31], a[104:111], v112
ds_read_b128 v[40:43], v116 offset:11264
v_pk_add_f16 v50, v50, v78
v_smfmac_f32_16x16x64_f16 v[84:87], v[28:31], a[232:239], v112
ds_read_b128 v[44:47], v116 offset:10240
v_pk_add_f16 v51, v51, v79
v_smfmac_f32_16x16x64_f16 v[88:91], v[8:11], v[144:151], v112
ds_write_b128 v116, v[48:51] offset:13312
s_waitcnt lgkmcnt(3)
v_cmp_u_f16 vcc, v48, v50
v_smfmac_f32_16x16x64_f16 v[80:83], v[36:39], a[48:55], v112
s_cbranch_vccnz main_kernel_c5_m3_f
main_kernel_c5_m3:
v_smfmac_f32_16x16x64_f16 v[80:83], v[48:51], a[24:31], v112
v_smfmac_f32_16x16x64_f16 v[84:87], v[48:51], a[152:159], v112
v_smfmac_f32_16x16x64_f16 v[84:87], v[36:39], a[176:183], v112
s_waitcnt lgkmcnt(2)
v_smfmac_f32_16x16x64_f16 v[80:83], v[40:43], a[80:87], v112
s_waitcnt lgkmcnt(0)
s_barrier
ds_read_b128 v[52:55], v116 offset:12288
v_smfmac_f32_16x16x64_f16 v[84:87], v[40:43], a[208:215], v112
s_add_u32 s19, s52, s54
ds_read_b128 v[56:59], v116 offset:15360
v_smfmac_f32_16x16x64_f16 v[80:83], v[44:47], a[112:119], v112
s_add_u32 s18, s18, 0x40000
ds_read_b128 v[60:63], v116 offset:14336
v_smfmac_f32_16x16x64_f16 v[84:87], v[44:47], a[240:247], v112
s_bitset0_b32 s18, 20
s_waitcnt lgkmcnt(2)
v_smfmac_f32_16x16x64_f16 v[80:83], v[52:55], a[56:63], v112
s_cmp_eq_u32 s17, 30
s_cselect_b32 s32, s53, 0x10000
s_waitcnt lgkmcnt(1)
v_smfmac_f32_16x16x64_f16 v[80:83], v[56:59], a[88:95], v112
s_add_u32 s52, s52, s32
s_waitcnt lgkmcnt(0)
v_smfmac_f32_16x16x64_f16 v[80:83], v[60:63], a[120:127], v112
s_sub_u32 s24, 0x20000, s32
ds_read_b128 v[64:67], v116 offset:24576
v_smfmac_f32_16x16x64_f16 v[84:87], v[52:55], a[184:191], v112
s_add_u32 s55, s55, s24
ds_read_b128 v[68:71], v116 offset:28672
v_smfmac_f32_16x16x64_f16 v[84:87], v[56:59], a[216:223], v112
ds_read_b128 v[72:75], v116 offset:25600
s_nop 0
v_cvt_pk_bf16_f32 v92, v80, v81
v_smfmac_f32_16x16x64_f16 v[84:87], v[60:63], a[248:255], v112
ds_read_b128 v[76:79], v116 offset:29696
s_nop 0
v_cvt_pk_bf16_f32 v93, v82, v83
v_smfmac_f32_16x16x64_f16 v[88:91], v[12:15], v[152:159], v112
s_nop 3
v_cvt_pk_bf16_f32 v94, v84, v85
v_cvt_pk_bf16_f32 v95, v86, v87
s_mov_b32 vcc_lo, 0xcccccccc
s_mov_b32 vcc_hi, 0xcccccccc
v_mfma_f32_16x16x32_bf16 v[84:87], v[92:95], v[104:107], 0
v_add_u32 v121, v121, v122
v_writelane_b32 v121, s55, 39
s_nop 0
v_smfmac_f32_16x16x64_f16 v[88:91], v[16:19], v[160:167], v112
s_nop 2
s_cmp_eq_u32 s17, 63
v_cvt_pk_bf16_f32 v114, v84, v85
v_cvt_pk_bf16_f32 v115, v86, v87
buffer_store_dwordx2 v[114:115], v117, s[4:7], s21 offen sc1
s_cbranch_scc1 main_kernel_c5_last
ds_write_b64 v117, v[114:115] offset:16896
v_smfmac_f32_16x16x64_f16 v[88:91], v[20:23], v[168:175], v112
v_smfmac_f32_16x16x64_f16 v[88:91], v[24:27], v[176:183], v112
v_smfmac_f32_16x16x64_f16 v[88:91], v[28:31], v[184:191], v112
v_smfmac_f32_16x16x64_f16 v[88:91], v[32:35], v[192:199], v112
s_waitcnt lgkmcnt(0)
s_barrier
ds_read_b128 v[0:3], v116 offset:16384
v_smfmac_f32_16x16x64_f16 v[88:91], v[36:39], v[200:207], v112
ds_read_b128 v[4:7], v116 offset:17408
v_smfmac_f32_16x16x64_f16 v[88:91], v[40:43], v[208:215], v112
ds_read_b128 v[16:19], v116 offset:26624
v_smfmac_f32_16x16x64_f16 v[88:91], v[44:47], v[216:223], v112
ds_read_b128 v[20:23], v116 offset:30720
v_smfmac_f32_16x16x64_f16 v[88:91], v[48:51], v[224:231], v112
ds_read_b128 v[24:27], v116 offset:27648
v_smfmac_f32_16x16x64_f16 v[88:91], v[52:55], v[232:239], v112
ds_read_b128 v[28:31], v116 offset:31744
v_smfmac_f32_16x16x64_f16 v[88:91], v[56:59], v[240:247], v112
v_smfmac_f32_16x16x64_f16 v[88:91], v[60:63], v[248:255], v112
s_waitcnt lgkmcnt(5)
v_mfma_f32_16x16x32_bf16 v[80:83], v[64:67], v[0:3], 0
v_mfma_f32_16x16x32_bf16 v[84:87], v[68:71], v[0:3], 0
buffer_load_dwordx4 v[8:11], v116, s[4:7], s20 offen offset:0 sc1
v_mfma_f32_16x16x32_bf16 v[92:95], v[0:3], v[0:3], 0
buffer_load_dwordx4 v[12:15], v116, s[4:7], s20 offen offset:1024 sc1
v_permlane32_swap_b32 v88, v90
s_waitcnt lgkmcnt(4)
v_mfma_f32_16x16x32_bf16 v[80:83], v[72:75], v[4:7], v[80:83]
v_permlane32_swap_b32 v89, v91
v_mfma_f32_16x16x32_bf16 v[84:87], v[76:79], v[4:7], v[84:87]
v_pk_add_f32 v[88:89], v[88:89], v[90:91]
v_mfma_f32_16x16x32_bf16 v[92:95], v[4:7], v[4:7], v[92:95]
v_cvt_pk_bf16_f32 v124, v88, v89
v_mov_b32 v65, 0
s_waitcnt lgkmcnt(0)
s_waitcnt vmcnt(1)
v_mfma_f32_16x16x32_bf16 v[88:91], v[8:11], v[8:11], v[92:95]
v_mfma_f32_16x16x32_bf16 v[0:3], v[16:19], v[8:11], v[80:83]
v_cmp_u_f32 s[0:1], v8, v10
v_mfma_f32_16x16x32_bf16 v[4:7], v[20:23], v[8:11], v[84:87]
s_waitcnt vmcnt(0)
v_mfma_f32_16x16x32_bf16 v[88:91], v[12:15], v[12:15], v[88:91]
v_mfma_f32_16x16x32_bf16 v[0:3], v[24:27], v[12:15], v[0:3]
v_cmp_u_f32 s[32:33], v12, v14
v_mfma_f32_16x16x32_bf16 v[4:7], v[28:31], v[12:15], v[4:7]
s_or_b64 s[0:1], s[0:1], s[32:33]
s_cbranch_scc1 main_kernel_c5_z_f
main_kernel_c5_z:
v_mul_f32 v88, s30, v88
v_mul_f32 v89, s30, v89
v_exp_f32 v88, v88
v_exp_f32 v89, v89
v_cndmask_b32_dpp v0, v2, v0, vcc quad_perm:[2,3,2,3] row_mask:0xf bank_mask:0xf
v_cvt_pk_bf16_f32 v64, v88, v89
v_cndmask_b32_dpp v1, v3, v1, vcc quad_perm:[2,3,2,3] row_mask:0xf bank_mask:0xf
v_exp_f32 v0, v0
v_mfma_f32_16x16x16_bf16 v[16:19], v[100:101], v[64:65], 0
v_exp_f32 v1, v1
v_cndmask_b32_dpp v4, v6, v4, vcc quad_perm:[2,3,2,3] row_mask:0xf bank_mask:0xf
v_mfma_f32_16x16x16_bf16 v[8:11], v[124:125], v[64:65], 0
v_cndmask_b32_dpp v5, v7, v5, vcc quad_perm:[2,3,2,3] row_mask:0xf bank_mask:0xf
v_exp_f32 v4, v4
v_exp_f32 v5, v5
v_cvt_pk_bf16_f32 v92, v0, v1
v_cvt_pk_bf16_f32 v94, v4, v5
v_mov_b32 v80, 0
v_mov_b32_dpp v93, v92 quad_perm:[0,1,0,1] row_mask:0xf bank_mask:0xf
v_mov_b32_dpp v95, v94 quad_perm:[0,1,0,1] row_mask:0xf bank_mask:0xf
v_mov_b32 v81, 0
v_mov_b32 v82, 0
v_mfma_f32_16x16x32_bf16 v[16:19], v[100:103], v[92:95], v[16:19]
v_mov_b32 v83, 0
v_mov_b32 v84, 0
v_mfma_f32_16x16x32_bf16 v[8:11], v[96:99], v[92:95], v[8:11]
s_nop 1
v_mov_b32 v85, 0
v_mov_b32 v86, 0
v_mov_b32 v87, 0
v_rcp_f32 v126, v16
v_subrev_u32 v127, 0x21800000, v16
v_cmp_lt_u32 vcc, 0x3c000000, v127
v_pk_mul_f32 v[8:9], v[8:9], v[126:127] op_sel_hi:[1,0]
v_pk_mul_f32 v[10:11], v[10:11], v[126:127] op_sel_hi:[1,0]
s_and_b32 s32, vcc_lo, 0xcccc
v_cvt_pk_bf16_f32 v126, v8, v9
v_cvt_pk_bf16_f32 v127, v10, v11
s_cbranch_scc1 main_kernel_c5_sm_f
main_kernel_c5_ost:
buffer_store_dwordx2 v[126:127], v118, s[4:7], s22 offen sc1
v_cmp_eq_u32 s[0:1], 0, v123
v_mov_b32 v24, -1
v_mov_b32 v25, -1
v_mov_b32 v26, -1
v_mov_b32 v27, -1
ds_read_b128 v[32:35], v113 offset:0
ds_read_b128 v[36:39], v113 offset:1024
ds_read_b128 v[40:43], v113 offset:2048
ds_read_b128 v[44:47], v113 offset:3072
ds_read_b128 v[48:51], v113 offset:4096
ds_read_b128 v[52:55], v113 offset:5120
s_and_b32 s10, s1, 0x3f00
buffer_store_dwordx4 v[24:27], v116, s[4:7], s3 offen sc1
buffer_store_dwordx4 v[24:27], v116, s[4:7], s46 offen sc1
s_barrier
buffer_load_dwordx4 v[0:3], v116, s[4:7], s23 offen sc1
ds_read_b128 v[56:59], v113 offset:6144
ds_read_b128 v[60:63], v113 offset:7168
s_add_u32 s46, s46, 0x40000
s_bitset0_b32 s46, 20
s_add_u32 s37, s37, 65536
s_add_u32 s26, s26, 65536
s_xor_b32 s32, s23, 1024
buffer_load_dwordx4 v[4:7], v116, s[4:7], s32 offen sc1
ds_read_b128 v[64:67], v113 offset:8192
ds_read_b128 v[68:71], v113 offset:9216
s_nop 3
s_xor_b32 s32, s23, 2048
buffer_load_dwordx4 v[8:11], v116, s[4:7], s32 offen sc1
ds_read_b128 v[72:75], v113 offset:10240
ds_read_b128 v[76:79], v113 offset:11264
s_nop 3
s_xor_b32 s32, s23, 3072
buffer_load_dwordx4 v[12:15], v116, s[4:7], s32 offen sc1
ds_read_b128 v[88:91], v113 offset:12288
ds_read_b128 v[92:95], v113 offset:13312
s_nop 3
s_xor_b32 s32, s23, 4096
buffer_load_dwordx4 v[16:19], v116, s[4:7], s32 offen sc1
s_nop 7
s_xor_b32 s32, s23, 5120
buffer_load_dwordx4 v[20:23], v116, s[4:7], s32 offen sc1
s_nop 7
s_xor_b32 s32, s23, 6144
buffer_load_dwordx4 v[24:27], v116, s[4:7], s32 offen sc1
s_nop 7
s_xor_b32 s32, s23, 7168
buffer_load_dwordx4 v[28:31], v116, s[4:7], s32 offen sc1
s_waitcnt lgkmcnt(12)
s_waitcnt vmcnt(7)
v_cmp_u_f32 vcc, v0, v2
s_cbranch_vccnz main_kernel_c5_o0_f
main_kernel_c5_o0:
v_smfmac_f32_16x16x64_bf16 v[80:83], v[0:3], v[32:39], v112
ds_read_b128 v[32:35], v113 offset:14336
ds_read_b128 v[36:39], v113 offset:15360
s_waitcnt lgkmcnt(12)
s_waitcnt vmcnt(6)
v_cmp_u_f32 vcc, v4, v6
v_smfmac_f32_16x16x64_bf16 v[84:87], v[0:3], v[40:47], v112
ds_read_b128 v[40:43], v113 offset:16384
ds_read_b128 v[44:47], v113 offset:17408
buffer_store_dwordx2 v[114:115], v119, s[4:7], s37 offen sc1
s_cbranch_vccnz main_kernel_c5_o1_f
main_kernel_c5_o1:
s_waitcnt lgkmcnt(12)
v_smfmac_f32_16x16x64_bf16 v[80:83], v[4:7], v[48:55], v112
ds_read_b128 v[48:51], v113 offset:18432
ds_read_b128 v[52:55], v113 offset:19456
s_waitcnt lgkmcnt(12)
s_waitcnt vmcnt(6)
v_cmp_u_f32 vcc, v8, v10
v_smfmac_f32_16x16x64_bf16 v[84:87], v[4:7], v[56:63], v112
ds_read_b128 v[56:59], v113 offset:20480
ds_read_b128 v[60:63], v113 offset:21504
buffer_store_dword v124, v120, s[4:7], s26 offen sc1
s_cbranch_vccnz main_kernel_c5_o2_f
main_kernel_c5_o2:
s_waitcnt lgkmcnt(12)
v_smfmac_f32_16x16x64_bf16 v[80:83], v[8:11], v[64:71], v112
ds_read_b128 v[64:67], v113 offset:22528
ds_read_b128 v[68:71], v113 offset:23552
s_waitcnt lgkmcnt(12)
s_waitcnt vmcnt(6)
v_cmp_u_f32 vcc, v12, v14
v_smfmac_f32_16x16x64_bf16 v[84:87], v[8:11], v[72:79], v112
ds_read_b128 v[72:75], v113 offset:24576
ds_read_b128 v[76:79], v113 offset:25600
s_cbranch_vccnz main_kernel_c5_o3_f
main_kernel_c5_o3:
s_waitcnt lgkmcnt(12)
v_smfmac_f32_16x16x64_bf16 v[80:83], v[12:15], v[88:95], v112
ds_read_b128 v[88:91], v113 offset:26624
ds_read_b128 v[92:95], v113 offset:27648
s_waitcnt lgkmcnt(12)
s_waitcnt vmcnt(5)
v_cmp_u_f32 vcc, v16, v18
v_smfmac_f32_16x16x64_bf16 v[84:87], v[12:15], v[32:39], v112
ds_read_b128 v[32:35], v113 offset:28672
ds_read_b128 v[36:39], v113 offset:29696
s_cbranch_vccnz main_kernel_c5_o4_f
main_kernel_c5_o4:
s_waitcnt lgkmcnt(12)
v_smfmac_f32_16x16x64_bf16 v[80:83], v[16:19], v[40:47], v112
ds_read_b128 v[40:43], v113 offset:30720
ds_read_b128 v[44:47], v113 offset:31744
s_waitcnt lgkmcnt(12)
s_waitcnt vmcnt(4)
v_cmp_u_f32 vcc, v20, v22
v_smfmac_f32_16x16x64_bf16 v[84:87], v[16:19], v[48:55], v112
s_cbranch_vccnz main_kernel_c5_o5_f
main_kernel_c5_o5:
s_waitcnt lgkmcnt(10)
v_smfmac_f32_16x16x64_bf16 v[80:83], v[20:23], v[56:63], v112
s_waitcnt lgkmcnt(8)
s_waitcnt vmcnt(3)
v_cmp_u_f32 vcc, v24, v26
v_smfmac_f32_16x16x64_bf16 v[84:87], v[20:23], v[64:71], v112
s_cbranch_vccnz main_kernel_c5_o6_f
main_kernel_c5_o6:
s_waitcnt lgkmcnt(6)
v_smfmac_f32_16x16x64_bf16 v[80:83], v[24:27], v[72:79], v112
s_waitcnt lgkmcnt(4)
v_smfmac_f32_16x16x64_bf16 v[84:87], v[24:27], v[88:95], v112
s_waitcnt lgkmcnt(2)
s_waitcnt vmcnt(2)
v_cmp_u_f32 vcc, v28, v30
s_cbranch_vccnz main_kernel_c5_o7_f
main_kernel_c5_o7:
v_smfmac_f32_16x16x64_bf16 v[80:83], v[28:31], v[32:39], v112
s_waitcnt lgkmcnt(0)
v_smfmac_f32_16x16x64_bf16 v[84:87], v[28:31], v[40:47], v112
s_nop 4
v_cvt_pk_bf16_f32 v80, v80, v81
v_cvt_pk_bf16_f32 v81, v82, v83
ds_write_b64 v116, v[80:81] offset:20488
v_cvt_pk_bf16_f32 v82, v84, v85
v_cvt_pk_bf16_f32 v83, v86, v87
ds_write_b64 v116, v[82:83] offset:22536
s_waitcnt lgkmcnt(0)
s_barrier
ds_read_b128 v[72:75], v116 offset:22528
ds_read_b128 v[76:79], v116 offset:23552
s_mov_b32 m0, 26624
s_cmp_lg_u32 s10, 0
s_waitcnt lgkmcnt(1)
v_mfma_f32_16x16x32_bf16 v[64:67], v[72:75], v[108:111], 0
s_waitcnt lgkmcnt(0)
v_mfma_f32_16x16x32_bf16 v[64:67], v[76:79], v[108:111], v[64:67]
s_nop 7
v_cvt_pk_f16_f32 v68, v64, v65
v_cvt_pk_f16_f32 v69, v66, v67
buffer_store_dwordx2 v[68:69], v125, s[4:7], s25 offen sc1
s_cbranch_scc1 main_kernel_c5_kvw
main_kernel_c5_kvok:
s_nop 3
buffer_load_dwordx4 v116, s[4:7], s27 offen sc1 lds
buffer_load_dwordx4 v116, s[4:7], s27 offen offset:1024 sc1 lds
s_mov_b32 m0, 30720
s_xor_b32 s32, s27, 131072
buffer_load_dwordx4 v116, s[4:7], s32 offen offset:0 sc1 lds
s_add_u32 s27, s27, 0x40000
s_branch main_kernel_c5_top
main_kernel_c5_kvw:
s_mov_b32 exec_lo, 0
s_mov_b32 exec_hi, 0x3f00
v_subrev_u32 v127, 128, v121
main_kernel_c5_kvp:
buffer_load_dword v126, v127, s[4:7], 0 offen sc1
s_waitcnt vmcnt(0)
v_cmp_eq_u32 vcc, 0, v126
s_cbranch_vccz main_kernel_c5_kvp_ok
s_sleep 2
s_sub_u32 s29, s29, 1
s_cbranch_scc0 main_kernel_c5_kvp
s_branch main_kernel_end
main_kernel_c5_kvp_ok:
s_mov_b64 exec, -1
s_branch main_kernel_c5_kvok
main_kernel_c5_last:
s_add_u32 s37, s37, 65536
s_add_u32 s26, s26, 65536
buffer_store_dwordx2 v[114:115], v119, s[4:7], s37 offen sc1
v_smfmac_f32_16x16x64_f16 v[88:91], v[20:23], v[168:175], v112
v_smfmac_f32_16x16x64_f16 v[88:91], v[24:27], v[176:183], v112
v_smfmac_f32_16x16x64_f16 v[88:91], v[28:31], v[184:191], v112
v_smfmac_f32_16x16x64_f16 v[88:91], v[32:35], v[192:199], v112
v_smfmac_f32_16x16x64_f16 v[88:91], v[36:39], v[200:207], v112
v_smfmac_f32_16x16x64_f16 v[88:91], v[40:43], v[208:215], v112
v_smfmac_f32_16x16x64_f16 v[88:91], v[44:47], v[216:223], v112
v_smfmac_f32_16x16x64_f16 v[88:91], v[48:51], v[224:231], v112
v_smfmac_f32_16x16x64_f16 v[88:91], v[52:55], v[232:239], v112
v_smfmac_f32_16x16x64_f16 v[88:91], v[56:59], v[240:247], v112
v_smfmac_f32_16x16x64_f16 v[88:91], v[60:63], v[248:255], v112
s_nop 7
v_permlane32_swap_b32 v88, v90
s_nop 1
v_permlane32_swap_b32 v89, v91
s_nop 1
v_pk_add_f32 v[88:89], v[88:89], v[90:91]
s_nop 1
v_cvt_pk_bf16_f32 v124, v88, v89
s_nop 1
buffer_store_dword v124, v120, s[4:7], s26 offen sc1
s_branch main_kernel_end
main_kernel_c5_m0_f:
s_waitcnt lgkmcnt(0)
buffer_load_dwordx4 v[0:3], v116, s[4:7], s18 offen sc1
buffer_load_dwordx4 v[64:67], v116, s[4:7], s19 offen sc1
s_xor_b32 s32, s18, 1024
buffer_load_dwordx4 v[16:19], v116, s[4:7], s32 offen sc1
s_xor_b32 s32, s19, 1024
buffer_load_dwordx4 v[68:71], v116, s[4:7], s32 offen sc1
s_xor_b32 s32, s18, 2048
buffer_load_dwordx4 v[32:35], v116, s[4:7], s32 offen sc1
s_xor_b32 s32, s19, 2048
buffer_load_dwordx4 v[72:75], v116, s[4:7], s32 offen sc1
s_xor_b32 s32, s18, 3072
buffer_load_dwordx4 v[48:51], v116, s[4:7], s32 offen sc1
s_xor_b32 s32, s19, 3072
buffer_load_dwordx4 v[76:79], v116, s[4:7], s32 offen sc1
s_sub_u32 s29, s29, 1
s_cbranch_scc1 main_kernel_end
s_waitcnt vmcnt(0)
v_max_u32 v126, v0, v2
v_max3_u32 v126, v126, v64, v66
v_cmp_eq_u32 vcc, -1, v126
s_cbranch_vccnz main_kernel_c5_m0_f
v_pk_add_f16 v0, v0, v64
v_pk_add_f16 v1, v1, v65
v_pk_add_f16 v2, v2, v66
v_pk_add_f16 v3, v3, v67
s_nop 0
s_branch main_kernel_c5_m0
main_kernel_c5_m1_f:
s_waitcnt lgkmcnt(0)
s_xor_b32 s32, s18, 1024
buffer_load_dwordx4 v[16:19], v116, s[4:7], s32 offen sc1
s_xor_b32 s32, s19, 1024
buffer_load_dwordx4 v[68:71], v116, s[4:7], s32 offen sc1
s_xor_b32 s32, s18, 2048
buffer_load_dwordx4 v[32:35], v116, s[4:7], s32 offen sc1
s_xor_b32 s32, s19, 2048
buffer_load_dwordx4 v[72:75], v116, s[4:7], s32 offen sc1
s_xor_b32 s32, s18, 3072
buffer_load_dwordx4 v[48:51], v116, s[4:7], s32 offen sc1
s_xor_b32 s32, s19, 3072
buffer_load_dwordx4 v[76:79], v116, s[4:7], s32 offen sc1
s_sub_u32 s29, s29, 1
s_cbranch_scc1 main_kernel_end
s_waitcnt vmcnt(0)
v_max_u32 v126, v16, v18
v_max3_u32 v126, v126, v68, v70
v_cmp_eq_u32 vcc, -1, v126
s_cbranch_vccnz main_kernel_c5_m1_f
v_pk_add_f16 v16, v16, v68
v_pk_add_f16 v17, v17, v69
v_pk_add_f16 v18, v18, v70
v_pk_add_f16 v19, v19, v71
ds_write_b128 v116, v[16:19] offset:5120
s_branch main_kernel_c5_m1
main_kernel_c5_m2_f:
s_waitcnt lgkmcnt(0)
s_xor_b32 s32, s18, 2048
buffer_load_dwordx4 v[32:35], v116, s[4:7], s32 offen sc1
s_xor_b32 s32, s19, 2048
buffer_load_dwordx4 v[72:75], v116, s[4:7], s32 offen sc1
s_xor_b32 s32, s18, 3072
buffer_load_dwordx4 v[48:51], v116, s[4:7], s32 offen sc1
s_xor_b32 s32, s19, 3072
buffer_load_dwordx4 v[76:79], v116, s[4:7], s32 offen sc1
s_sub_u32 s29, s29, 1
s_cbranch_scc1 main_kernel_end
s_waitcnt vmcnt(0)
v_max_u32 v126, v32, v34
v_max3_u32 v126, v126, v72, v74
v_cmp_eq_u32 vcc, -1, v126
s_cbranch_vccnz main_kernel_c5_m2_f
v_pk_add_f16 v32, v32, v72
v_pk_add_f16 v33, v33, v73
v_pk_add_f16 v34, v34, v74
v_pk_add_f16 v35, v35, v75
ds_write_b128 v116, v[32:35] offset:9216
s_branch main_kernel_c5_m2
main_kernel_c5_m3_f:
s_waitcnt lgkmcnt(0)
s_xor_b32 s32, s18, 3072
buffer_load_dwordx4 v[48:51], v116, s[4:7], s32 offen sc1
s_xor_b32 s32, s19, 3072
buffer_load_dwordx4 v[76:79], v116, s[4:7], s32 offen sc1
s_sub_u32 s29, s29, 1
s_cbranch_scc1 main_kernel_end
s_waitcnt vmcnt(0)
v_max_u32 v126, v48, v50
v_max3_u32 v126, v126, v76, v78
v_cmp_eq_u32 vcc, -1, v126
s_cbranch_vccnz main_kernel_c5_m3_f
v_pk_add_f16 v48, v48, v76
v_pk_add_f16 v49, v49, v77
v_pk_add_f16 v50, v50, v78
v_pk_add_f16 v51, v51, v79
ds_write_b128 v116, v[48:51] offset:13312
s_branch main_kernel_c5_m3
main_kernel_c5_z_f:
buffer_load_dwordx4 v[8:11], v116, s[4:7], s20 offen offset:0 sc1
buffer_load_dwordx4 v[12:15], v116, s[4:7], s20 offen offset:1024 sc1
s_memtime s[32:33]
ds_read_b32 v126, v116 offset:18432
s_sub_u32 s34, s19, s54
s_xor_b32 s34, s34, 0x2000
s_lshl_b32 s35, s12, 15
s_add_u32 s34, s34, s35
s_lshl_b32 s35, s13, 8
s_add_u32 s35, s35, s34
s_add_u32 s34, s34, 0x4000
s_waitcnt lgkmcnt(0)
s_sub_u32 s32, s32, 450
v_sub_u32 v127, s32, v126
buffer_store_dword v127, off, s[4:7], s34 sc1
s_sub_u32 s29, s29, 1
s_cbranch_scc1 main_kernel_end
s_waitcnt vmcnt(1)
main_kernel_c5_z_g:
v_max_u32 v126, v8, v10
v_max3_u32 v126, v126, v12, v14
v_cmp_eq_u32 vcc, -1, v126
s_cbranch_vccnz main_kernel_c5_z_h
v_mfma_f32_16x16x32_bf16 v[88:91], v[8:11], v[8:11], v[92:95]
v_mfma_f32_16x16x32_bf16 v[0:3], v[16:19], v[8:11], v[80:83]
v_mfma_f32_16x16x32_bf16 v[4:7], v[20:23], v[8:11], v[84:87]
v_mfma_f32_16x16x32_bf16 v[88:91], v[12:15], v[12:15], v[88:91]
v_mfma_f32_16x16x32_bf16 v[0:3], v[24:27], v[12:15], v[0:3]
v_mfma_f32_16x16x32_bf16 v[4:7], v[28:31], v[12:15], v[4:7]
buffer_store_dword v127, off, s[4:7], s35 offset:132 sc1
s_mov_b32 vcc_lo, 0xcccccccc
s_mov_b32 vcc_hi, 0xcccccccc
s_branch main_kernel_c5_z
main_kernel_c5_z_h:
buffer_load_dwordx4 v[8:11], v116, s[4:7], s20 offen offset:0 sc1
buffer_load_dwordx4 v[12:15], v116, s[4:7], s20 offen offset:1024 sc1
s_sub_u32 s29, s29, 1
s_cbranch_scc1 main_kernel_end
v_add_u32 v127, 300, v127
s_waitcnt vmcnt(0)
s_branch main_kernel_c5_z_g
main_kernel_c5_sm_f:
s_waitcnt vmcnt(0) lgkmcnt(0)
buffer_load_dwordx4 v[8:11], v116, s[4:7], s20 offen offset:0 sc1
buffer_load_dwordx4 v[12:15], v116, s[4:7], s20 offen offset:1024 sc1
ds_read_b128 v[0:3], v116 offset:16384
ds_read_b128 v[4:7], v116 offset:17408
ds_read_b128 v[64:67], v116 offset:24576
ds_read_b128 v[68:71], v116 offset:28672
ds_read_b128 v[72:75], v116 offset:25600
ds_read_b128 v[76:79], v116 offset:29696
ds_read_b128 v[16:19], v116 offset:26624
ds_read_b128 v[20:23], v116 offset:30720
ds_read_b128 v[24:27], v116 offset:27648
ds_read_b128 v[28:31], v116 offset:31744
s_waitcnt vmcnt(0)
s_waitcnt lgkmcnt(0)
v_mfma_f32_16x16x32_bf16 v[80:83], v[64:67], v[0:3], 0
v_mfma_f32_16x16x32_bf16 v[84:87], v[68:71], v[0:3], 0
v_mfma_f32_16x16x32_bf16 v[92:95], v[0:3], v[0:3], 0
v_mfma_f32_16x16x32_bf16 v[80:83], v[72:75], v[4:7], v[80:83]
v_mfma_f32_16x16x32_bf16 v[84:87], v[76:79], v[4:7], v[84:87]
v_mfma_f32_16x16x32_bf16 v[92:95], v[4:7], v[4:7], v[92:95]
v_mfma_f32_16x16x32_bf16 v[0:3], v[16:19], v[8:11], v[80:83]
v_mfma_f32_16x16x32_bf16 v[4:7], v[20:23], v[8:11], v[84:87]
v_mfma_f32_16x16x32_bf16 v[88:91], v[8:11], v[8:11], v[92:95]
v_mfma_f32_16x16x32_bf16 v[0:3], v[24:27], v[12:15], v[0:3]
v_mfma_f32_16x16x32_bf16 v[4:7], v[28:31], v[12:15], v[4:7]
v_mfma_f32_16x16x32_bf16 v[88:91], v[12:15], v[12:15], v[88:91]
s_nop 7
v_mov_b32 v65, 0
v_max_f32 v126, v88, v89
v_mul_f32 v126, s30, v126
v_max3_f32 v126, v126, v0, v1
v_max3_f32 v126, v126, v2, v3
v_max3_f32 v126, v126, v4, v5
v_max3_f32 v126, v126, v6, v7
v_mov_b32 v127, v126
s_nop 1
v_permlane32_swap_b32 v126, v127
v_max_f32 v126, v126, v127
v_mov_b32 v127, v126
s_nop 1
v_permlane16_swap_b32 v126, v127
v_max_f32 v126, v126, v127
v_mul_f32 v127, 0x40faf233, v126
s_mov_b32 vcc_lo, 0xcccccccc
s_mov_b32 vcc_hi, 0xcccccccc
v_sub_f32 v0, v0, v126
v_sub_f32 v1, v1, v126
v_sub_f32 v2, v2, v126
v_sub_f32 v3, v3, v126
v_sub_f32 v4, v4, v126
v_sub_f32 v5, v5, v126
v_sub_f32 v6, v6, v126
v_sub_f32 v7, v7, v126
v_sub_f32 v88, v88, v127
v_sub_f32 v89, v89, v127
s_waitcnt lgkmcnt(0)
s_nop 0
v_mul_f32 v88, s30, v88
v_mul_f32 v89, s30, v89
v_exp_f32 v88, v88
v_exp_f32 v89, v89
v_cndmask_b32_dpp v0, v2, v0, vcc quad_perm:[2,3,2,3] row_mask:0xf bank_mask:0xf
v_cvt_pk_bf16_f32 v64, v88, v89
v_cndmask_b32_dpp v1, v3, v1, vcc quad_perm:[2,3,2,3] row_mask:0xf bank_mask:0xf
v_exp_f32 v0, v0
v_mfma_f32_16x16x16_bf16 v[16:19], v[100:101], v[64:65], 0
v_exp_f32 v1, v1
v_cndmask_b32_dpp v4, v6, v4, vcc quad_perm:[2,3,2,3] row_mask:0xf bank_mask:0xf
v_mfma_f32_16x16x16_bf16 v[8:11], v[124:125], v[64:65], 0
v_cndmask_b32_dpp v5, v7, v5, vcc quad_perm:[2,3,2,3] row_mask:0xf bank_mask:0xf
v_exp_f32 v4, v4
v_exp_f32 v5, v5
v_cvt_pk_bf16_f32 v92, v0, v1
v_cvt_pk_bf16_f32 v94, v4, v5
v_mov_b32 v80, 0
v_mov_b32_dpp v93, v92 quad_perm:[0,1,0,1] row_mask:0xf bank_mask:0xf
v_mov_b32_dpp v95, v94 quad_perm:[0,1,0,1] row_mask:0xf bank_mask:0xf
v_mov_b32 v81, 0
v_mov_b32 v82, 0
v_mfma_f32_16x16x32_bf16 v[16:19], v[100:103], v[92:95], v[16:19]
v_mov_b32 v83, 0
v_mov_b32 v84, 0
v_mfma_f32_16x16x32_bf16 v[8:11], v[96:99], v[92:95], v[8:11]
s_nop 1
v_mov_b32 v85, 0
v_mov_b32 v86, 0
v_mov_b32 v87, 0
v_rcp_f32 v126, v16
v_subrev_u32 v127, 0x21800000, v16
v_cmp_lt_u32 vcc, 0x3c000000, v127
v_pk_mul_f32 v[8:9], v[8:9], v[126:127] op_sel_hi:[1,0]
v_pk_mul_f32 v[10:11], v[10:11], v[126:127] op_sel_hi:[1,0]
s_and_b32 s32, vcc_lo, 0xcccc
v_cvt_pk_bf16_f32 v126, v8, v9
v_cvt_pk_bf16_f32 v127, v10, v11
s_branch main_kernel_c5_ost
main_kernel_c5_o0_f:
s_nop 0
buffer_load_dwordx4 v[0:3], v116, s[4:7], s23 offen sc1
s_xor_b32 s32, s23, 1024
buffer_load_dwordx4 v[4:7], v116, s[4:7], s32 offen sc1
s_sub_u32 s29, s29, 1
s_cbranch_scc1 main_kernel_end
s_waitcnt vmcnt(0)
v_max_u32 v126, v0, v2
v_cmp_eq_u32 vcc, -1, v126
s_cbranch_vccnz main_kernel_c5_o0_f
s_branch main_kernel_c5_o0
main_kernel_c5_o1_f:
s_nop 0
s_xor_b32 s32, s23, 1024
buffer_load_dwordx4 v[4:7], v116, s[4:7], s32 offen sc1
s_xor_b32 s32, s23, 2048
buffer_load_dwordx4 v[8:11], v116, s[4:7], s32 offen sc1
s_sub_u32 s29, s29, 1
s_cbranch_scc1 main_kernel_end
s_waitcnt vmcnt(0)
v_max_u32 v126, v4, v6
v_cmp_eq_u32 vcc, -1, v126
s_cbranch_vccnz main_kernel_c5_o1_f
s_branch main_kernel_c5_o1
main_kernel_c5_o2_f:
s_nop 0
s_xor_b32 s32, s23, 2048
buffer_load_dwordx4 v[8:11], v116, s[4:7], s32 offen sc1
s_xor_b32 s32, s23, 3072
buffer_load_dwordx4 v[12:15], v116, s[4:7], s32 offen sc1
s_sub_u32 s29, s29, 1
s_cbranch_scc1 main_kernel_end
s_waitcnt vmcnt(0)
v_max_u32 v126, v8, v10
v_cmp_eq_u32 vcc, -1, v126
s_cbranch_vccnz main_kernel_c5_o2_f
s_branch main_kernel_c5_o2
main_kernel_c5_o3_f:
s_nop 0
s_xor_b32 s32, s23, 3072
buffer_load_dwordx4 v[12:15], v116, s[4:7], s32 offen sc1
s_xor_b32 s32, s23, 4096
buffer_load_dwordx4 v[16:19], v116, s[4:7], s32 offen sc1
s_sub_u32 s29, s29, 1
s_cbranch_scc1 main_kernel_end
s_waitcnt vmcnt(0)
v_max_u32 v126, v12, v14
v_cmp_eq_u32 vcc, -1, v126
s_cbranch_vccnz main_kernel_c5_o3_f
s_branch main_kernel_c5_o3
main_kernel_c5_o4_f:
s_nop 0
s_xor_b32 s32, s23, 4096
buffer_load_dwordx4 v[16:19], v116, s[4:7], s32 offen sc1
s_xor_b32 s32, s23, 5120
buffer_load_dwordx4 v[20:23], v116, s[4:7], s32 offen sc1
s_sub_u32 s29, s29, 1
s_cbranch_scc1 main_kernel_end
s_waitcnt vmcnt(0)
v_max_u32 v126, v16, v18
v_cmp_eq_u32 vcc, -1, v126
s_cbranch_vccnz main_kernel_c5_o4_f
s_branch main_kernel_c5_o4
main_kernel_c5_o5_f:
s_nop 0
s_xor_b32 s32, s23, 5120
buffer_load_dwordx4 v[20:23], v116, s[4:7], s32 offen sc1
s_xor_b32 s32, s23, 6144
buffer_load_dwordx4 v[24:27], v116, s[4:7], s32 offen sc1
s_sub_u32 s29, s29, 1
s_cbranch_scc1 main_kernel_end
s_waitcnt vmcnt(0)
v_max_u32 v126, v20, v22
v_cmp_eq_u32 vcc, -1, v126
s_cbranch_vccnz main_kernel_c5_o5_f
s_branch main_kernel_c5_o5
main_kernel_c5_o6_f:
s_nop 0
s_xor_b32 s32, s23, 6144
buffer_load_dwordx4 v[24:27], v116, s[4:7], s32 offen sc1
s_xor_b32 s32, s23, 7168
buffer_load_dwordx4 v[28:31], v116, s[4:7], s32 offen sc1
s_sub_u32 s29, s29, 1
s_cbranch_scc1 main_kernel_end
s_waitcnt vmcnt(0)
v_max_u32 v126, v24, v26
v_cmp_eq_u32 vcc, -1, v126
s_cbranch_vccnz main_kernel_c5_o6_f
s_branch main_kernel_c5_o6
main_kernel_c5_o7_f:
s_nop 0
s_xor_b32 s32, s23, 7168
buffer_load_dwordx4 v[28:31], v116, s[4:7], s32 offen sc1
s_sub_u32 s29, s29, 1
s_cbranch_scc1 main_kernel_end
s_waitcnt vmcnt(0)
v_max_u32 v126, v28, v30
v_cmp_eq_u32 vcc, -1, v126
s_cbranch_vccnz main_kernel_c5_o7_f
s_branch main_kernel_c5_o7
.p2align 6
main_kernel_c6_top:
s_barrier
buffer_load_dwordx4 v[0:3], v116, s[4:7], s18 offen sc1
s_add_u32 s20, s20, 0x40000
s_bitset0_b32 s20, 20
s_add_u32 s21, s21, 0x40000
s_bitset0_b32 s21, 20
s_add_u32 s22, s22, 0x40000
s_bitset0_b32 s22, 20
s_add_u32 s23, s23, 0x40000
s_bitset0_b32 s23, 20
s_xor_b32 s32, s18, 1024
buffer_load_dwordx4 v[16:19], v116, s[4:7], s32 offen sc1
s_add_u32 s3, s3, 0x40000
s_bitset0_b32 s3, 20
s_add_u32 s17, s17, 1
s_bitcmp1_b32 0x77777777, s17
s_cselect_b32 s33, 0x800, 0
s_xor_b32 s54, s54, s33
s_add_u32 s25, s25, 0x40000
s_bitset0_b32 s25, 20
s_nop 0
buffer_load_dwordx4 v[64:67], v116, s[4:7], s19 offen sc1
v_mov_b32 v80, 0
v_mov_b32 v81, 0
s_nop 3
s_xor_b32 s32, s19, 1024
buffer_load_dwordx4 v[68:71], v116, s[4:7], s32 offen sc1
v_mov_b32 v82, 0
v_mov_b32 v83, 0
s_nop 3
s_xor_b32 s32, s18, 2048
buffer_load_dwordx4 v[32:35], v116, s[4:7], s32 offen sc1
v_mov_b32 v84, 0
v_mov_b32 v85, 0
s_nop 3
s_xor_b32 s32, s19, 2048
buffer_load_dwordx4 v[72:75], v116, s[4:7], s32 offen sc1
v_mov_b32 v86, 0
v_mov_b32 v87, 0
s_nop 3
s_xor_b32 s32, s18, 3072
buffer_load_dwordx4 v[48:51], v116, s[4:7], s32 offen sc1
v_mov_b32 v88, 0
v_mov_b32 v89, 0
s_nop 3
s_xor_b32 s32, s19, 3072
buffer_load_dwordx4 v[76:79], v116, s[4:7], s32 offen sc1
v_mov_b32 v90, 0
v_mov_b32 v91, 0
s_waitcnt vmcnt(5)
v_pk_add_f16 v0, v0, v64
v_pk_add_f16 v1, v1, v65
v_pk_add_f16 v2, v2, v66
v_pk_add_f16 v3, v3, v67
v_cmp_u_f16 vcc, v0, v2
s_cbranch_vccnz main_kernel_c6_m0_f
main_kernel_c6_m0:
v_smfmac_f32_16x16x64_f16 v[80:83], v[0:3], a[0:7], v112
ds_write_b128 v116, v[0:3] offset:2048
v_smfmac_f32_16x16x64_f16 v[84:87], v[0:3], a[128:135], v112
buffer_load_dword v123, v121, s[4:7], 0 offen sc1
s_waitcnt vmcnt(5)
v_pk_add_f16 v16, v16, v68
v_pk_add_f16 v17, v17, v69
v_pk_add_f16 v18, v18, v70
v_pk_add_f16 v19, v19, v71
v_cmp_u_f16 vcc, v16, v18
s_waitcnt lgkmcnt(0)
s_barrier
ds_read_b128 v[4:7], v116 offset:3072
s_cbranch_vccnz main_kernel_c6_m1_f
main_kernel_c6_m1:
v_smfmac_f32_16x16x64_f16 v[80:83], v[16:19], a[8:15], v112
ds_write_b128 v116, v[16:19] offset:6144
v_smfmac_f32_16x16x64_f16 v[84:87], v[16:19], a[136:143], v112
ds_read_b128 v[8:11], v116 offset:0
v_smfmac_f32_16x16x64_f16 v[88:91], v[0:3], v[128:135], v112
ds_read_b128 v[12:15], v116 offset:1024
s_waitcnt lgkmcnt(3)
v_smfmac_f32_16x16x64_f16 v[80:83], v[4:7], a[32:39], v112
v_smfmac_f32_16x16x64_f16 v[84:87], v[4:7], a[160:167], v112
v_smfmac_f32_16x16x64_f16 v[88:91], v[4:7], v[136:143], v112
s_waitcnt lgkmcnt(2)
s_barrier
s_waitcnt lgkmcnt(1)
v_smfmac_f32_16x16x64_f16 v[80:83], v[8:11], a[64:71], v112
s_waitcnt vmcnt(3)
ds_read_b128 v[20:23], v116 offset:7168
v_pk_add_f16 v32, v32, v72
v_smfmac_f32_16x16x64_f16 v[84:87], v[8:11], a[192:199], v112
ds_read_b128 v[24:27], v116 offset:4096
s_waitcnt lgkmcnt(2)
v_pk_add_f16 v33, v33, v73
v_smfmac_f32_16x16x64_f16 v[80:83], v[12:15], a[96:103], v112
ds_read_b128 v[28:31], v116 offset:5120
v_pk_add_f16 v34, v34, v74
v_smfmac_f32_16x16x64_f16 v[84:87], v[12:15], a[224:231], v112
s_waitcnt lgkmcnt(2)
v_pk_add_f16 v35, v35, v75
v_smfmac_f32_16x16x64_f16 v[80:83], v[20:23], a[40:47], v112
v_cmp_u_f16 vcc, v32, v34
v_smfmac_f32_16x16x64_f16 v[84:87], v[20:23], a[168:175], v112
ds_write_b128 v116, v[32:35] offset:10240
s_cbranch_vccnz main_kernel_c6_m2_f
main_kernel_c6_m2:
v_smfmac_f32_16x16x64_f16 v[80:83], v[32:35], a[16:23], v112
buffer_load_dwordx4 v[96:99], v116, s[4:7], s28 offen sc1
v_smfmac_f32_16x16x64_f16 v[84:87], v[32:35], a[144:151], v112
s_add_u32 s28, s28, 0x40000
s_waitcnt lgkmcnt(2)
v_smfmac_f32_16x16x64_f16 v[80:83], v[24:27], a[72:79], v112
s_waitcnt vmcnt(2)
v_pk_add_f16 v48, v48, v76
v_smfmac_f32_16x16x64_f16 v[84:87], v[24:27], a[200:207], v112
s_waitcnt lgkmcnt(0)
s_barrier
ds_read_b128 v[36:39], v116 offset:11264
v_pk_add_f16 v49, v49, v77
v_smfmac_f32_16x16x64_f16 v[80:83], v[28:31], a[104:111], v112
ds_read_b128 v[40:43], v116 offset:8192
v_pk_add_f16 v50, v50, v78
v_smfmac_f32_16x16x64_f16 v[84:87], v[28:31], a[232:239], v112
ds_read_b128 v[44:47], v116 offset:9216
v_pk_add_f16 v51, v51, v79
v_smfmac_f32_16x16x64_f16 v[88:91], v[8:11], v[144:151], v112
s_waitcnt lgkmcnt(2)
v_cmp_u_f16 vcc, v48, v50
v_smfmac_f32_16x16x64_f16 v[80:83], v[36:39], a[48:55], v112
ds_write_b128 v116, v[48:51] offset:14336
s_cbranch_vccnz main_kernel_c6_m3_f
main_kernel_c6_m3:
v_smfmac_f32_16x16x64_f16 v[80:83], v[48:51], a[24:31], v112
v_smfmac_f32_16x16x64_f16 v[84:87], v[48:51], a[152:159], v112
v_smfmac_f32_16x16x64_f16 v[84:87], v[36:39], a[176:183], v112
s_waitcnt lgkmcnt(2)
v_smfmac_f32_16x16x64_f16 v[80:83], v[40:43], a[80:87], v112
s_waitcnt lgkmcnt(0)
s_barrier
ds_read_b128 v[52:55], v116 offset:15360
v_smfmac_f32_16x16x64_f16 v[84:87], v[40:43], a[208:215], v112
s_add_u32 s19, s52, s54
ds_read_b128 v[56:59], v116 offset:12288
v_smfmac_f32_16x16x64_f16 v[80:83], v[44:47], a[112:119], v112
s_add_u32 s18, s18, 0x40000
ds_read_b128 v[60:63], v116 offset:13312
v_smfmac_f32_16x16x64_f16 v[84:87], v[44:47], a[240:247], v112
s_bitset0_b32 s18, 20
s_waitcnt lgkmcnt(2)
v_smfmac_f32_16x16x64_f16 v[80:83], v[52:55], a[56:63], v112
s_cmp_eq_u32 s17, 30
s_cselect_b32 s32, s53, 0x10000
s_waitcnt lgkmcnt(1)
v_smfmac_f32_16x16x64_f16 v[80:83], v[56:59], a[88:95], v112
s_add_u32 s52, s52, s32
s_waitcnt lgkmcnt(0)
v_smfmac_f32_16x16x64_f16 v[80:83], v[60:63], a[120:127], v112
s_sub_u32 s24, 0x20000, s32
ds_read_b128 v[64:67], v116 offset:24576
v_smfmac_f32_16x16x64_f16 v[84:87], v[52:55], a[184:191], v112
s_add_u32 s55, s55, s24
ds_read_b128 v[68:71], v116 offset:28672
v_smfmac_f32_16x16x64_f16 v[84:87], v[56:59], a[216:223], v112
ds_read_b128 v[72:75], v116 offset:25600
s_nop 0
v_cvt_pk_bf16_f32 v92, v80, v81
v_smfmac_f32_16x16x64_f16 v[84:87], v[60:63], a[248:255], v112
ds_read_b128 v[76:79], v116 offset:29696
s_nop 0
v_cvt_pk_bf16_f32 v93, v82, v83
v_smfmac_f32_16x16x64_f16 v[88:91], v[12:15], v[152:159], v112
s_nop 3
v_cvt_pk_bf16_f32 v94, v84, v85
v_cvt_pk_bf16_f32 v95, v86, v87
s_mov_b32 vcc_lo, 0xcccccccc
s_mov_b32 vcc_hi, 0xcccccccc
v_mfma_f32_16x16x32_bf16 v[84:87], v[92:95], v[104:107], 0
v_add_u32 v121, v121, v122
v_writelane_b32 v121, s55, 39
s_nop 0
v_smfmac_f32_16x16x64_f16 v[88:91], v[16:19], v[160:167], v112
s_nop 2
s_cmp_eq_u32 s17, 63
v_cvt_pk_bf16_f32 v114, v84, v85
v_cvt_pk_bf16_f32 v115, v86, v87
buffer_store_dwordx2 v[114:115], v117, s[4:7], s21 offen sc1
s_cbranch_scc1 main_kernel_c6_last
ds_write_b64 v117, v[114:115] offset:17408
v_smfmac_f32_16x16x64_f16 v[88:91], v[20:23], v[168:175], v112
v_smfmac_f32_16x16x64_f16 v[88:91], v[24:27], v[176:183], v112
v_smfmac_f32_16x16x64_f16 v[88:91], v[28:31], v[184:191], v112
v_smfmac_f32_16x16x64_f16 v[88:91], v[32:35], v[192:199], v112
s_waitcnt lgkmcnt(0)
s_barrier
ds_read_b128 v[0:3], v116 offset:16384
v_smfmac_f32_16x16x64_f16 v[88:91], v[36:39], v[200:207], v112
ds_read_b128 v[4:7], v116 offset:17408
v_smfmac_f32_16x16x64_f16 v[88:91], v[40:43], v[208:215], v112
ds_read_b128 v[16:19], v116 offset:26624
v_smfmac_f32_16x16x64_f16 v[88:91], v[44:47], v[216:223], v112
ds_read_b128 v[20:23], v116 offset:30720
v_smfmac_f32_16x16x64_f16 v[88:91], v[48:51], v[224:231], v112
ds_read_b128 v[24:27], v116 offset:27648
v_smfmac_f32_16x16x64_f16 v[88:91], v[52:55], v[232:239], v112
ds_read_b128 v[28:31], v116 offset:31744
v_smfmac_f32_16x16x64_f16 v[88:91], v[56:59], v[240:247], v112
v_smfmac_f32_16x16x64_f16 v[88:91], v[60:63], v[248:255], v112
s_waitcnt lgkmcnt(5)
v_mfma_f32_16x16x32_bf16 v[80:83], v[64:67], v[0:3], 0
v_mfma_f32_16x16x32_bf16 v[84:87], v[68:71], v[0:3], 0
buffer_load_dwordx4 v[8:11], v116, s[4:7], s20 offen offset:0 sc1
v_mfma_f32_16x16x32_bf16 v[92:95], v[0:3], v[0:3], 0
buffer_load_dwordx4 v[12:15], v116, s[4:7], s20 offen offset:1024 sc1
v_permlane32_swap_b32 v88, v90
s_waitcnt lgkmcnt(4)
v_mfma_f32_16x16x32_bf16 v[80:83], v[72:75], v[4:7], v[80:83]
v_permlane32_swap_b32 v89, v91
v_mfma_f32_16x16x32_bf16 v[84:87], v[76:79], v[4:7], v[84:87]
v_pk_add_f32 v[88:89], v[88:89], v[90:91]
v_mfma_f32_16x16x32_bf16 v[92:95], v[4:7], v[4:7], v[92:95]
v_cvt_pk_bf16_f32 v124, v88, v89
v_mov_b32 v65, 0
s_waitcnt lgkmcnt(0)
s_waitcnt vmcnt(1)
v_mfma_f32_16x16x32_bf16 v[88:91], v[8:11], v[8:11], v[92:95]
v_mfma_f32_16x16x32_bf16 v[0:3], v[16:19], v[8:11], v[80:83]
v_cmp_u_f32 s[0:1], v8, v10
v_mfma_f32_16x16x32_bf16 v[4:7], v[20:23], v[8:11], v[84:87]
s_waitcnt vmcnt(0)
v_mfma_f32_16x16x32_bf16 v[88:91], v[12:15], v[12:15], v[88:91]
v_mfma_f32_16x16x32_bf16 v[0:3], v[24:27], v[12:15], v[0:3]
v_cmp_u_f32 s[32:33], v12, v14
v_mfma_f32_16x16x32_bf16 v[4:7], v[28:31], v[12:15], v[4:7]
s_or_b64 s[0:1], s[0:1], s[32:33]
s_cbranch_scc1 main_kernel_c6_z_f
main_kernel_c6_z:
v_mul_f32 v88, s30, v88
v_mul_f32 v89, s30, v89
v_exp_f32 v88, v88
v_exp_f32 v89, v89
v_cndmask_b32_dpp v0, v2, v0, vcc quad_perm:[2,3,2,3] row_mask:0xf bank_mask:0xf
v_cvt_pk_bf16_f32 v64, v88, v89
v_cndmask_b32_dpp v1, v3, v1, vcc quad_perm:[2,3,2,3] row_mask:0xf bank_mask:0xf
v_exp_f32 v0, v0
v_mfma_f32_16x16x16_bf16 v[16:19], v[100:101], v[64:65], 0
v_exp_f32 v1, v1
v_cndmask_b32_dpp v4, v6, v4, vcc quad_perm:[2,3,2,3] row_mask:0xf bank_mask:0xf
v_mfma_f32_16x16x16_bf16 v[8:11], v[124:125], v[64:65], 0
v_cndmask_b32_dpp v5, v7, v5, vcc quad_perm:[2,3,2,3] row_mask:0xf bank_mask:0xf
v_exp_f32 v4, v4
v_exp_f32 v5, v5
v_cvt_pk_bf16_f32 v92, v0, v1
v_cvt_pk_bf16_f32 v94, v4, v5
v_mov_b32 v80, 0
v_mov_b32_dpp v93, v92 quad_perm:[0,1,0,1] row_mask:0xf bank_mask:0xf
v_mov_b32_dpp v95, v94 quad_perm:[0,1,0,1] row_mask:0xf bank_mask:0xf
v_mov_b32 v81, 0
v_mov_b32 v82, 0
v_mfma_f32_16x16x32_bf16 v[16:19], v[100:103], v[92:95], v[16:19]
v_mov_b32 v83, 0
v_mov_b32 v84, 0
v_mfma_f32_16x16x32_bf16 v[8:11], v[96:99], v[92:95], v[8:11]
s_nop 1
v_mov_b32 v85, 0
v_mov_b32 v86, 0
v_mov_b32 v87, 0
v_rcp_f32 v126, v16
v_subrev_u32 v127, 0x21800000, v16
v_cmp_lt_u32 vcc, 0x3c000000, v127
v_pk_mul_f32 v[8:9], v[8:9], v[126:127] op_sel_hi:[1,0]
v_pk_mul_f32 v[10:11], v[10:11], v[126:127] op_sel_hi:[1,0]
s_and_b32 s32, vcc_lo, 0xcccc
v_cvt_pk_bf16_f32 v126, v8, v9
v_cvt_pk_bf16_f32 v127, v10, v11
s_cbranch_scc1 main_kernel_c6_sm_f
main_kernel_c6_ost:
buffer_store_dwordx2 v[126:127], v118, s[4:7], s22 offen sc1
v_cmp_eq_u32 s[0:1], 0, v123
v_mov_b32 v24, -1
v_mov_b32 v25, -1
v_mov_b32 v26, -1
v_mov_b32 v27, -1
ds_read_b128 v[32:35], v113 offset:0
ds_read_b128 v[36:39], v113 offset:1024
ds_read_b128 v[40:43], v113 offset:2048
ds_read_b128 v[44:47], v113 offset:3072
ds_read_b128 v[48:51], v113 offset:4096
ds_read_b128 v[52:55], v113 offset:5120
s_and_b32 s10, s1, 0x3f00
buffer_store_dwordx4 v[24:27], v116, s[4:7], s3 offen sc1
s_barrier
buffer_load_dwordx4 v[0:3], v116, s[4:7], s23 offen sc1
ds_read_b128 v[56:59], v113 offset:6144
ds_read_b128 v[60:63], v113 offset:7168
s_add_u32 s37, s37, 65536
s_add_u32 s26, s26, 65536
s_nop 1
s_xor_b32 s32, s23, 1024
buffer_load_dwordx4 v[4:7], v116, s[4:7], s32 offen sc1
ds_read_b128 v[64:67], v113 offset:8192
ds_read_b128 v[68:71], v113 offset:9216
s_nop 3
s_xor_b32 s32, s23, 2048
buffer_load_dwordx4 v[8:11], v116, s[4:7], s32 offen sc1
ds_read_b128 v[72:75], v113 offset:10240
ds_read_b128 v[76:79], v113 offset:11264
s_nop 3
s_xor_b32 s32, s23, 3072
buffer_load_dwordx4 v[12:15], v116, s[4:7], s32 offen sc1
ds_read_b128 v[88:91], v113 offset:12288
ds_read_b128 v[92:95], v113 offset:13312
s_nop 3
s_xor_b32 s32, s23, 4096
buffer_load_dwordx4 v[16:19], v116, s[4:7], s32 offen sc1
s_nop 7
s_xor_b32 s32, s23, 5120
buffer_load_dwordx4 v[20:23], v116, s[4:7], s32 offen sc1
s_nop 7
s_xor_b32 s32, s23, 6144
buffer_load_dwordx4 v[24:27], v116, s[4:7], s32 offen sc1
s_nop 7
s_xor_b32 s32, s23, 7168
buffer_load_dwordx4 v[28:31], v116, s[4:7], s32 offen sc1
s_waitcnt lgkmcnt(12)
s_waitcnt vmcnt(7)
v_cmp_u_f32 vcc, v0, v2
s_cbranch_vccnz main_kernel_c6_o0_f
main_kernel_c6_o0:
v_smfmac_f32_16x16x64_bf16 v[80:83], v[0:3], v[32:39], v112
ds_read_b128 v[32:35], v113 offset:14336
ds_read_b128 v[36:39], v113 offset:15360
s_waitcnt lgkmcnt(12)
s_waitcnt vmcnt(6)
v_cmp_u_f32 vcc, v4, v6
v_smfmac_f32_16x16x64_bf16 v[84:87], v[0:3], v[40:47], v112
ds_read_b128 v[40:43], v113 offset:16384
ds_read_b128 v[44:47], v113 offset:17408
buffer_store_dwordx2 v[114:115], v119, s[4:7], s37 offen sc1
s_cbranch_vccnz main_kernel_c6_o1_f
main_kernel_c6_o1:
s_waitcnt lgkmcnt(12)
v_smfmac_f32_16x16x64_bf16 v[80:83], v[4:7], v[48:55], v112
ds_read_b128 v[48:51], v113 offset:18432
ds_read_b128 v[52:55], v113 offset:19456
s_waitcnt lgkmcnt(12)
s_waitcnt vmcnt(6)
v_cmp_u_f32 vcc, v8, v10
v_smfmac_f32_16x16x64_bf16 v[84:87], v[4:7], v[56:63], v112
ds_read_b128 v[56:59], v113 offset:20480
ds_read_b128 v[60:63], v113 offset:21504
buffer_store_dword v124, v120, s[4:7], s26 offen sc1
s_cbranch_vccnz main_kernel_c6_o2_f
main_kernel_c6_o2:
s_waitcnt lgkmcnt(12)
v_smfmac_f32_16x16x64_bf16 v[80:83], v[8:11], v[64:71], v112
ds_read_b128 v[64:67], v113 offset:22528
ds_read_b128 v[68:71], v113 offset:23552
s_waitcnt lgkmcnt(12)
s_waitcnt vmcnt(6)
v_cmp_u_f32 vcc, v12, v14
v_smfmac_f32_16x16x64_bf16 v[84:87], v[8:11], v[72:79], v112
ds_read_b128 v[72:75], v113 offset:24576
ds_read_b128 v[76:79], v113 offset:25600
s_cbranch_vccnz main_kernel_c6_o3_f
main_kernel_c6_o3:
s_waitcnt lgkmcnt(12)
v_smfmac_f32_16x16x64_bf16 v[80:83], v[12:15], v[88:95], v112
ds_read_b128 v[88:91], v113 offset:26624
ds_read_b128 v[92:95], v113 offset:27648
s_waitcnt lgkmcnt(12)
s_waitcnt vmcnt(5)
v_cmp_u_f32 vcc, v16, v18
v_smfmac_f32_16x16x64_bf16 v[84:87], v[12:15], v[32:39], v112
ds_read_b128 v[32:35], v113 offset:28672
ds_read_b128 v[36:39], v113 offset:29696
s_cbranch_vccnz main_kernel_c6_o4_f
main_kernel_c6_o4:
s_waitcnt lgkmcnt(12)
v_smfmac_f32_16x16x64_bf16 v[80:83], v[16:19], v[40:47], v112
ds_read_b128 v[40:43], v113 offset:30720
ds_read_b128 v[44:47], v113 offset:31744
s_waitcnt lgkmcnt(12)
s_waitcnt vmcnt(4)
v_cmp_u_f32 vcc, v20, v22
v_smfmac_f32_16x16x64_bf16 v[84:87], v[16:19], v[48:55], v112
s_cbranch_vccnz main_kernel_c6_o5_f
main_kernel_c6_o5:
s_waitcnt lgkmcnt(10)
v_smfmac_f32_16x16x64_bf16 v[80:83], v[20:23], v[56:63], v112
s_waitcnt lgkmcnt(8)
s_waitcnt vmcnt(3)
v_cmp_u_f32 vcc, v24, v26
v_smfmac_f32_16x16x64_bf16 v[84:87], v[20:23], v[64:71], v112
s_cbranch_vccnz main_kernel_c6_o6_f
main_kernel_c6_o6:
s_waitcnt lgkmcnt(6)
v_smfmac_f32_16x16x64_bf16 v[80:83], v[24:27], v[72:79], v112
s_waitcnt lgkmcnt(4)
v_smfmac_f32_16x16x64_bf16 v[84:87], v[24:27], v[88:95], v112
s_waitcnt lgkmcnt(2)
s_waitcnt vmcnt(2)
v_cmp_u_f32 vcc, v28, v30
s_cbranch_vccnz main_kernel_c6_o7_f
main_kernel_c6_o7:
v_smfmac_f32_16x16x64_bf16 v[80:83], v[28:31], v[32:39], v112
s_waitcnt lgkmcnt(0)
v_smfmac_f32_16x16x64_bf16 v[84:87], v[28:31], v[40:47], v112
s_nop 4
v_cvt_pk_bf16_f32 v80, v80, v81
v_cvt_pk_bf16_f32 v81, v82, v83
ds_write_b64 v116, v[80:81] offset:21504
v_cvt_pk_bf16_f32 v82, v84, v85
v_cvt_pk_bf16_f32 v83, v86, v87
ds_write_b64 v116, v[82:83] offset:23552
s_waitcnt lgkmcnt(0)
s_barrier
ds_read_b128 v[72:75], v116 offset:20480
ds_read_b128 v[76:79], v116 offset:21504
s_mov_b32 m0, 28672
s_cmp_lg_u32 s10, 0
s_waitcnt lgkmcnt(1)
v_mfma_f32_16x16x32_bf16 v[64:67], v[72:75], v[108:111], 0
s_waitcnt lgkmcnt(0)
v_mfma_f32_16x16x32_bf16 v[64:67], v[76:79], v[108:111], v[64:67]
s_nop 7
v_cvt_pk_f16_f32 v68, v64, v65
v_cvt_pk_f16_f32 v69, v66, v67
buffer_store_dwordx2 v[68:69], v125, s[4:7], s25 offen sc1
s_cbranch_scc1 main_kernel_c6_kvw
main_kernel_c6_kvok:
s_nop 3
buffer_load_dwordx4 v116, s[4:7], s27 offen sc1 lds
buffer_load_dwordx4 v116, s[4:7], s27 offen offset:1024 sc1 lds
s_mov_b32 m0, 30720
s_xor_b32 s32, s27, 2048
buffer_load_dwordx4 v116, s[4:7], s32 offen offset:1024 sc1 lds
s_add_u32 s27, s27, 0x40000
s_branch main_kernel_c6_top
main_kernel_c6_kvw:
s_mov_b32 exec_lo, 0
s_mov_b32 exec_hi, 0x3f00
v_subrev_u32 v127, 128, v121
main_kernel_c6_kvp:
buffer_load_dword v126, v127, s[4:7], 0 offen sc1
s_waitcnt vmcnt(0)
v_cmp_eq_u32 vcc, 0, v126
s_cbranch_vccz main_kernel_c6_kvp_ok
s_sleep 2
s_sub_u32 s29, s29, 1
s_cbranch_scc0 main_kernel_c6_kvp
s_branch main_kernel_end
main_kernel_c6_kvp_ok:
s_mov_b64 exec, -1
s_branch main_kernel_c6_kvok
main_kernel_c6_last:
s_add_u32 s37, s37, 65536
s_add_u32 s26, s26, 65536
buffer_store_dwordx2 v[114:115], v119, s[4:7], s37 offen sc1
v_smfmac_f32_16x16x64_f16 v[88:91], v[20:23], v[168:175], v112
v_smfmac_f32_16x16x64_f16 v[88:91], v[24:27], v[176:183], v112
v_smfmac_f32_16x16x64_f16 v[88:91], v[28:31], v[184:191], v112
v_smfmac_f32_16x16x64_f16 v[88:91], v[32:35], v[192:199], v112
v_smfmac_f32_16x16x64_f16 v[88:91], v[36:39], v[200:207], v112
v_smfmac_f32_16x16x64_f16 v[88:91], v[40:43], v[208:215], v112
v_smfmac_f32_16x16x64_f16 v[88:91], v[44:47], v[216:223], v112
v_smfmac_f32_16x16x64_f16 v[88:91], v[48:51], v[224:231], v112
v_smfmac_f32_16x16x64_f16 v[88:91], v[52:55], v[232:239], v112
v_smfmac_f32_16x16x64_f16 v[88:91], v[56:59], v[240:247], v112
v_smfmac_f32_16x16x64_f16 v[88:91], v[60:63], v[248:255], v112
s_nop 7
v_permlane32_swap_b32 v88, v90
s_nop 1
v_permlane32_swap_b32 v89, v91
s_nop 1
v_pk_add_f32 v[88:89], v[88:89], v[90:91]
s_nop 1
v_cvt_pk_bf16_f32 v124, v88, v89
s_nop 1
buffer_store_dword v124, v120, s[4:7], s26 offen sc1
s_branch main_kernel_end
main_kernel_c6_m0_f:
s_waitcnt lgkmcnt(0)
buffer_load_dwordx4 v[0:3], v116, s[4:7], s18 offen sc1
buffer_load_dwordx4 v[64:67], v116, s[4:7], s19 offen sc1
s_xor_b32 s32, s18, 1024
buffer_load_dwordx4 v[16:19], v116, s[4:7], s32 offen sc1
s_xor_b32 s32, s19, 1024
buffer_load_dwordx4 v[68:71], v116, s[4:7], s32 offen sc1
s_xor_b32 s32, s18, 2048
buffer_load_dwordx4 v[32:35], v116, s[4:7], s32 offen sc1
s_xor_b32 s32, s19, 2048
buffer_load_dwordx4 v[72:75], v116, s[4:7], s32 offen sc1
s_xor_b32 s32, s18, 3072
buffer_load_dwordx4 v[48:51], v116, s[4:7], s32 offen sc1
s_xor_b32 s32, s19, 3072
buffer_load_dwordx4 v[76:79], v116, s[4:7], s32 offen sc1
s_sub_u32 s29, s29, 1
s_cbranch_scc1 main_kernel_end
s_waitcnt vmcnt(0)
v_max_u32 v126, v0, v2
v_max3_u32 v126, v126, v64, v66
v_cmp_eq_u32 vcc, -1, v126
s_cbranch_vccnz main_kernel_c6_m0_f
v_pk_add_f16 v0, v0, v64
v_pk_add_f16 v1, v1, v65
v_pk_add_f16 v2, v2, v66
v_pk_add_f16 v3, v3, v67
s_nop 0
s_branch main_kernel_c6_m0
main_kernel_c6_m1_f:
s_waitcnt lgkmcnt(0)
s_xor_b32 s32, s18, 1024
buffer_load_dwordx4 v[16:19], v116, s[4:7], s32 offen sc1
s_xor_b32 s32, s19, 1024
buffer_load_dwordx4 v[68:71], v116, s[4:7], s32 offen sc1
s_xor_b32 s32, s18, 2048
buffer_load_dwordx4 v[32:35], v116, s[4:7], s32 offen sc1
s_xor_b32 s32, s19, 2048
buffer_load_dwordx4 v[72:75], v116, s[4:7], s32 offen sc1
s_xor_b32 s32, s18, 3072
buffer_load_dwordx4 v[48:51], v116, s[4:7], s32 offen sc1
s_xor_b32 s32, s19, 3072
buffer_load_dwordx4 v[76:79], v116, s[4:7], s32 offen sc1
s_sub_u32 s29, s29, 1
s_cbranch_scc1 main_kernel_end
s_waitcnt vmcnt(0)
v_max_u32 v126, v16, v18
v_max3_u32 v126, v126, v68, v70
v_cmp_eq_u32 vcc, -1, v126
s_cbranch_vccnz main_kernel_c6_m1_f
v_pk_add_f16 v16, v16, v68
v_pk_add_f16 v17, v17, v69
v_pk_add_f16 v18, v18, v70
v_pk_add_f16 v19, v19, v71
s_nop 0
s_branch main_kernel_c6_m1
main_kernel_c6_m2_f:
s_waitcnt lgkmcnt(0)
s_xor_b32 s32, s18, 2048
buffer_load_dwordx4 v[32:35], v116, s[4:7], s32 offen sc1
s_xor_b32 s32, s19, 2048
buffer_load_dwordx4 v[72:75], v116, s[4:7], s32 offen sc1
s_xor_b32 s32, s18, 3072
buffer_load_dwordx4 v[48:51], v116, s[4:7], s32 offen sc1
s_xor_b32 s32, s19, 3072
buffer_load_dwordx4 v[76:79], v116, s[4:7], s32 offen sc1
s_sub_u32 s29, s29, 1
s_cbranch_scc1 main_kernel_end
s_waitcnt vmcnt(0)
v_max_u32 v126, v32, v34
v_max3_u32 v126, v126, v72, v74
v_cmp_eq_u32 vcc, -1, v126
s_cbranch_vccnz main_kernel_c6_m2_f
v_pk_add_f16 v32, v32, v72
v_pk_add_f16 v33, v33, v73
v_pk_add_f16 v34, v34, v74
v_pk_add_f16 v35, v35, v75
ds_write_b128 v116, v[32:35] offset:10240
s_branch main_kernel_c6_m2
main_kernel_c6_m3_f:
s_waitcnt lgkmcnt(0)
s_xor_b32 s32, s18, 3072
buffer_load_dwordx4 v[48:51], v116, s[4:7], s32 offen sc1
s_xor_b32 s32, s19, 3072
buffer_load_dwordx4 v[76:79], v116, s[4:7], s32 offen sc1
s_sub_u32 s29, s29, 1
s_cbranch_scc1 main_kernel_end
s_waitcnt vmcnt(0)
v_max_u32 v126, v48, v50
v_max3_u32 v126, v126, v76, v78
v_cmp_eq_u32 vcc, -1, v126
s_cbranch_vccnz main_kernel_c6_m3_f
v_pk_add_f16 v48, v48, v76
v_pk_add_f16 v49, v49, v77
v_pk_add_f16 v50, v50, v78
v_pk_add_f16 v51, v51, v79
ds_write_b128 v116, v[48:51] offset:14336
s_branch main_kernel_c6_m3
main_kernel_c6_z_f:
buffer_load_dwordx4 v[8:11], v116, s[4:7], s20 offen offset:0 sc1
buffer_load_dwordx4 v[12:15], v116, s[4:7], s20 offen offset:1024 sc1
s_memtime s[32:33]
ds_read_b32 v126, v116 offset:18432
s_sub_u32 s34, s19, s54
s_xor_b32 s34, s34, 0x2000
s_lshl_b32 s35, s12, 15
s_add_u32 s34, s34, s35
s_lshl_b32 s35, s13, 8
s_add_u32 s35, s35, s34
s_add_u32 s34, s34, 0x4000
s_waitcnt lgkmcnt(0)
s_sub_u32 s32, s32, 450
v_sub_u32 v127, s32, v126
buffer_store_dword v127, off, s[4:7], s34 sc1
s_sub_u32 s29, s29, 1
s_cbranch_scc1 main_kernel_end
s_waitcnt vmcnt(1)
main_kernel_c6_z_g:
v_max_u32 v126, v8, v10
v_max3_u32 v126, v126, v12, v14
v_cmp_eq_u32 vcc, -1, v126
s_cbranch_vccnz main_kernel_c6_z_h
v_mfma_f32_16x16x32_bf16 v[88:91], v[8:11], v[8:11], v[92:95]
v_mfma_f32_16x16x32_bf16 v[0:3], v[16:19], v[8:11], v[80:83]
v_mfma_f32_16x16x32_bf16 v[4:7], v[20:23], v[8:11], v[84:87]
v_mfma_f32_16x16x32_bf16 v[88:91], v[12:15], v[12:15], v[88:91]
v_mfma_f32_16x16x32_bf16 v[0:3], v[24:27], v[12:15], v[0:3]
v_mfma_f32_16x16x32_bf16 v[4:7], v[28:31], v[12:15], v[4:7]
buffer_store_dword v127, off, s[4:7], s35 offset:132 sc1
s_mov_b32 vcc_lo, 0xcccccccc
s_mov_b32 vcc_hi, 0xcccccccc
s_branch main_kernel_c6_z
main_kernel_c6_z_h:
buffer_load_dwordx4 v[8:11], v116, s[4:7], s20 offen offset:0 sc1
buffer_load_dwordx4 v[12:15], v116, s[4:7], s20 offen offset:1024 sc1
s_sub_u32 s29, s29, 1
s_cbranch_scc1 main_kernel_end
v_add_u32 v127, 300, v127
s_waitcnt vmcnt(0)
s_branch main_kernel_c6_z_g
main_kernel_c6_sm_f:
s_waitcnt vmcnt(0) lgkmcnt(0)
buffer_load_dwordx4 v[8:11], v116, s[4:7], s20 offen offset:0 sc1
buffer_load_dwordx4 v[12:15], v116, s[4:7], s20 offen offset:1024 sc1
ds_read_b128 v[0:3], v116 offset:16384
ds_read_b128 v[4:7], v116 offset:17408
ds_read_b128 v[64:67], v116 offset:24576
ds_read_b128 v[68:71], v116 offset:28672
ds_read_b128 v[72:75], v116 offset:25600
ds_read_b128 v[76:79], v116 offset:29696
ds_read_b128 v[16:19], v116 offset:26624
ds_read_b128 v[20:23], v116 offset:30720
ds_read_b128 v[24:27], v116 offset:27648
ds_read_b128 v[28:31], v116 offset:31744
s_waitcnt vmcnt(0)
s_waitcnt lgkmcnt(0)
v_mfma_f32_16x16x32_bf16 v[80:83], v[64:67], v[0:3], 0
v_mfma_f32_16x16x32_bf16 v[84:87], v[68:71], v[0:3], 0
v_mfma_f32_16x16x32_bf16 v[92:95], v[0:3], v[0:3], 0
v_mfma_f32_16x16x32_bf16 v[80:83], v[72:75], v[4:7], v[80:83]
v_mfma_f32_16x16x32_bf16 v[84:87], v[76:79], v[4:7], v[84:87]
v_mfma_f32_16x16x32_bf16 v[92:95], v[4:7], v[4:7], v[92:95]
v_mfma_f32_16x16x32_bf16 v[0:3], v[16:19], v[8:11], v[80:83]
v_mfma_f32_16x16x32_bf16 v[4:7], v[20:23], v[8:11], v[84:87]
v_mfma_f32_16x16x32_bf16 v[88:91], v[8:11], v[8:11], v[92:95]
v_mfma_f32_16x16x32_bf16 v[0:3], v[24:27], v[12:15], v[0:3]
v_mfma_f32_16x16x32_bf16 v[4:7], v[28:31], v[12:15], v[4:7]
v_mfma_f32_16x16x32_bf16 v[88:91], v[12:15], v[12:15], v[88:91]
s_nop 7
v_mov_b32 v65, 0
v_max_f32 v126, v88, v89
v_mul_f32 v126, s30, v126
v_max3_f32 v126, v126, v0, v1
v_max3_f32 v126, v126, v2, v3
v_max3_f32 v126, v126, v4, v5
v_max3_f32 v126, v126, v6, v7
v_mov_b32 v127, v126
s_nop 1
v_permlane32_swap_b32 v126, v127
v_max_f32 v126, v126, v127
v_mov_b32 v127, v126
s_nop 1
v_permlane16_swap_b32 v126, v127
v_max_f32 v126, v126, v127
v_mul_f32 v127, 0x40faf233, v126
s_mov_b32 vcc_lo, 0xcccccccc
s_mov_b32 vcc_hi, 0xcccccccc
v_sub_f32 v0, v0, v126
v_sub_f32 v1, v1, v126
v_sub_f32 v2, v2, v126
v_sub_f32 v3, v3, v126
v_sub_f32 v4, v4, v126
v_sub_f32 v5, v5, v126
v_sub_f32 v6, v6, v126
v_sub_f32 v7, v7, v126
v_sub_f32 v88, v88, v127
v_sub_f32 v89, v89, v127
s_waitcnt lgkmcnt(0)
s_nop 0
v_mul_f32 v88, s30, v88
v_mul_f32 v89, s30, v89
v_exp_f32 v88, v88
v_exp_f32 v89, v89
v_cndmask_b32_dpp v0, v2, v0, vcc quad_perm:[2,3,2,3] row_mask:0xf bank_mask:0xf
v_cvt_pk_bf16_f32 v64, v88, v89
v_cndmask_b32_dpp v1, v3, v1, vcc quad_perm:[2,3,2,3] row_mask:0xf bank_mask:0xf
v_exp_f32 v0, v0
v_mfma_f32_16x16x16_bf16 v[16:19], v[100:101], v[64:65], 0
v_exp_f32 v1, v1
v_cndmask_b32_dpp v4, v6, v4, vcc quad_perm:[2,3,2,3] row_mask:0xf bank_mask:0xf
v_mfma_f32_16x16x16_bf16 v[8:11], v[124:125], v[64:65], 0
v_cndmask_b32_dpp v5, v7, v5, vcc quad_perm:[2,3,2,3] row_mask:0xf bank_mask:0xf
v_exp_f32 v4, v4
v_exp_f32 v5, v5
v_cvt_pk_bf16_f32 v92, v0, v1
v_cvt_pk_bf16_f32 v94, v4, v5
v_mov_b32 v80, 0
v_mov_b32_dpp v93, v92 quad_perm:[0,1,0,1] row_mask:0xf bank_mask:0xf
v_mov_b32_dpp v95, v94 quad_perm:[0,1,0,1] row_mask:0xf bank_mask:0xf
v_mov_b32 v81, 0
v_mov_b32 v82, 0
v_mfma_f32_16x16x32_bf16 v[16:19], v[100:103], v[92:95], v[16:19]
v_mov_b32 v83, 0
v_mov_b32 v84, 0
v_mfma_f32_16x16x32_bf16 v[8:11], v[96:99], v[92:95], v[8:11]
s_nop 1
v_mov_b32 v85, 0
v_mov_b32 v86, 0
v_mov_b32 v87, 0
v_rcp_f32 v126, v16
v_subrev_u32 v127, 0x21800000, v16
v_cmp_lt_u32 vcc, 0x3c000000, v127
v_pk_mul_f32 v[8:9], v[8:9], v[126:127] op_sel_hi:[1,0]
v_pk_mul_f32 v[10:11], v[10:11], v[126:127] op_sel_hi:[1,0]
s_and_b32 s32, vcc_lo, 0xcccc
v_cvt_pk_bf16_f32 v126, v8, v9
v_cvt_pk_bf16_f32 v127, v10, v11
s_branch main_kernel_c6_ost
main_kernel_c6_o0_f:
s_nop 0
buffer_load_dwordx4 v[0:3], v116, s[4:7], s23 offen sc1
s_xor_b32 s32, s23, 1024
buffer_load_dwordx4 v[4:7], v116, s[4:7], s32 offen sc1
s_sub_u32 s29, s29, 1
s_cbranch_scc1 main_kernel_end
s_waitcnt vmcnt(0)
v_max_u32 v126, v0, v2
v_cmp_eq_u32 vcc, -1, v126
s_cbranch_vccnz main_kernel_c6_o0_f
s_branch main_kernel_c6_o0
main_kernel_c6_o1_f:
s_nop 0
s_xor_b32 s32, s23, 1024
buffer_load_dwordx4 v[4:7], v116, s[4:7], s32 offen sc1
s_xor_b32 s32, s23, 2048
buffer_load_dwordx4 v[8:11], v116, s[4:7], s32 offen sc1
s_sub_u32 s29, s29, 1
s_cbranch_scc1 main_kernel_end
s_waitcnt vmcnt(0)
v_max_u32 v126, v4, v6
v_cmp_eq_u32 vcc, -1, v126
s_cbranch_vccnz main_kernel_c6_o1_f
s_branch main_kernel_c6_o1
main_kernel_c6_o2_f:
s_nop 0
s_xor_b32 s32, s23, 2048
buffer_load_dwordx4 v[8:11], v116, s[4:7], s32 offen sc1
s_xor_b32 s32, s23, 3072
buffer_load_dwordx4 v[12:15], v116, s[4:7], s32 offen sc1
s_sub_u32 s29, s29, 1
s_cbranch_scc1 main_kernel_end
s_waitcnt vmcnt(0)
v_max_u32 v126, v8, v10
v_cmp_eq_u32 vcc, -1, v126
s_cbranch_vccnz main_kernel_c6_o2_f
s_branch main_kernel_c6_o2
main_kernel_c6_o3_f:
s_nop 0
s_xor_b32 s32, s23, 3072
buffer_load_dwordx4 v[12:15], v116, s[4:7], s32 offen sc1
s_xor_b32 s32, s23, 4096
buffer_load_dwordx4 v[16:19], v116, s[4:7], s32 offen sc1
s_sub_u32 s29, s29, 1
s_cbranch_scc1 main_kernel_end
s_waitcnt vmcnt(0)
v_max_u32 v126, v12, v14
v_cmp_eq_u32 vcc, -1, v126
s_cbranch_vccnz main_kernel_c6_o3_f
s_branch main_kernel_c6_o3
main_kernel_c6_o4_f:
s_nop 0
s_xor_b32 s32, s23, 4096
buffer_load_dwordx4 v[16:19], v116, s[4:7], s32 offen sc1
s_xor_b32 s32, s23, 5120
buffer_load_dwordx4 v[20:23], v116, s[4:7], s32 offen sc1
s_sub_u32 s29, s29, 1
s_cbranch_scc1 main_kernel_end
s_waitcnt vmcnt(0)
v_max_u32 v126, v16, v18
v_cmp_eq_u32 vcc, -1, v126
s_cbranch_vccnz main_kernel_c6_o4_f
s_branch main_kernel_c6_o4
main_kernel_c6_o5_f:
s_nop 0
s_xor_b32 s32, s23, 5120
buffer_load_dwordx4 v[20:23], v116, s[4:7], s32 offen sc1
s_xor_b32 s32, s23, 6144
buffer_load_dwordx4 v[24:27], v116, s[4:7], s32 offen sc1
s_sub_u32 s29, s29, 1
s_cbranch_scc1 main_kernel_end
s_waitcnt vmcnt(0)
v_max_u32 v126, v20, v22
v_cmp_eq_u32 vcc, -1, v126
s_cbranch_vccnz main_kernel_c6_o5_f
s_branch main_kernel_c6_o5
main_kernel_c6_o6_f:
s_nop 0
s_xor_b32 s32, s23, 6144
buffer_load_dwordx4 v[24:27], v116, s[4:7], s32 offen sc1
s_xor_b32 s32, s23, 7168
buffer_load_dwordx4 v[28:31], v116, s[4:7], s32 offen sc1
s_sub_u32 s29, s29, 1
s_cbranch_scc1 main_kernel_end
s_waitcnt vmcnt(0)
v_max_u32 v126, v24, v26
v_cmp_eq_u32 vcc, -1, v126
s_cbranch_vccnz main_kernel_c6_o6_f
s_branch main_kernel_c6_o6
main_kernel_c6_o7_f:
s_nop 0
s_xor_b32 s32, s23, 7168
buffer_load_dwordx4 v[28:31], v116, s[4:7], s32 offen sc1
s_sub_u32 s29, s29, 1
s_cbranch_scc1 main_kernel_end
s_waitcnt vmcnt(0)
v_max_u32 v126, v28, v30
v_cmp_eq_u32 vcc, -1, v126
s_cbranch_vccnz main_kernel_c6_o7_f
s_branch main_kernel_c6_o7
.p2align 6
main_kernel_c7_top:
s_barrier
buffer_load_dwordx4 v[0:3], v116, s[4:7], s18 offen sc1
s_add_u32 s20, s20, 0x40000
s_bitset0_b32 s20, 20
s_add_u32 s21, s21, 0x40000
s_bitset0_b32 s21, 20
s_add_u32 s22, s22, 0x40000
s_bitset0_b32 s22, 20
s_add_u32 s23, s23, 0x40000
s_bitset0_b32 s23, 20
s_xor_b32 s32, s18, 1024
buffer_load_dwordx4 v[16:19], v116, s[4:7], s32 offen sc1
s_add_u32 s3, s3, 0x40000
s_bitset0_b32 s3, 20
s_add_u32 s17, s17, 1
s_bitcmp1_b32 0x77777777, s17
s_cselect_b32 s33, 0x800, 0
s_xor_b32 s54, s54, s33
s_add_u32 s25, s25, 0x40000
s_bitset0_b32 s25, 20
s_nop 0
buffer_load_dwordx4 v[64:67], v116, s[4:7], s19 offen sc1
v_mov_b32 v80, 0
v_mov_b32 v81, 0
s_nop 3
s_xor_b32 s32, s19, 1024
buffer_load_dwordx4 v[68:71], v116, s[4:7], s32 offen sc1
v_mov_b32 v82, 0
v_mov_b32 v83, 0
s_nop 3
s_xor_b32 s32, s18, 2048
buffer_load_dwordx4 v[32:35], v116, s[4:7], s32 offen sc1
v_mov_b32 v84, 0
v_mov_b32 v85, 0
s_nop 3
s_xor_b32 s32, s19, 2048
buffer_load_dwordx4 v[72:75], v116, s[4:7], s32 offen sc1
v_mov_b32 v86, 0
v_mov_b32 v87, 0
s_nop 3
s_xor_b32 s32, s18, 3072
buffer_load_dwordx4 v[48:51], v116, s[4:7], s32 offen sc1
v_mov_b32 v88, 0
v_mov_b32 v89, 0
s_nop 3
s_xor_b32 s32, s19, 3072
buffer_load_dwordx4 v[76:79], v116, s[4:7], s32 offen sc1
s_memtime s[40:41]
s_memrealtime s[80:81]
s_memrealtime s[82:83]
s_memrealtime s[84:85]
s_memrealtime s[86:87]
s_memrealtime s[88:89]
s_memrealtime s[90:91]
s_memrealtime s[92:93]
s_memrealtime s[94:95]
s_memrealtime s[96:97]
s_memrealtime s[98:99]
s_memrealtime s[100:101]
s_sub_u32 s32, s15, s16
s_lshr_b32 s33, s17, 1
s_min_u32 s33, s33, 3
s_ashr_i32 s32, s32, s33
s_add_u32 s11, s11, s32
s_sub_u32 s32, s16, s27
s_sub_u32 s32, s32, s39
s_ashr_i32 s32, s32, 2
s_add_u32 s39, s39, s32
s_mov_b32 s27, s16
s_mov_b32 s2, s31
v_mov_b32 v126, s11
s_add_u32 s32, s43, 1590
v_mov_b32 v127, s32
s_waitcnt lgkmcnt(0)
ds_write_b32 v116, v126 offset:18432
s_add_u32 s80, s80, s82
s_add_u32 s80, s80, s84
s_add_u32 s80, s80, s86
s_add_u32 s80, s80, s88
s_add_u32 s80, s80, s90
s_add_u32 s80, s80, s92
s_add_u32 s80, s80, s94
s_add_u32 s80, s80, s96
s_add_u32 s80, s80, s98
s_add_u32 s80, s80, s100
s_lshl1_add_u32 s80, s80, s11
s_sub_u32 s15, s40, s80
s_add_u32 s32, s15, s39
v_mov_b32 v126, s32
buffer_store_dwordx2 v[126:127], off, s[4:7], s44 offset:128 sc1
v_mov_b32 v90, 0
v_mov_b32 v91, 0
s_waitcnt vmcnt(6)
v_pk_add_f16 v0, v0, v64
v_pk_add_f16 v1, v1, v65
v_pk_add_f16 v2, v2, v66
v_pk_add_f16 v3, v3, v67
v_cmp_u_f16 vcc, v0, v2
s_cbranch_vccnz main_kernel_c7_m0_f
main_kernel_c7_m0:
v_smfmac_f32_16x16x64_f16 v[80:83], v[0:3], a[0:7], v112
ds_write_b128 v116, v[0:3] offset:3072
v_smfmac_f32_16x16x64_f16 v[84:87], v[0:3], a[128:135], v112
buffer_load_dword v123, v121, s[4:7], 0 offen sc1
s_waitcnt vmcnt(6)
v_pk_add_f16 v16, v16, v68
v_pk_add_f16 v17, v17, v69
v_pk_add_f16 v18, v18, v70
v_pk_add_f16 v19, v19, v71
v_cmp_u_f16 vcc, v16, v18
s_waitcnt lgkmcnt(0)
s_barrier
ds_read_b128 v[4:7], v116 offset:2048
s_cbranch_vccnz main_kernel_c7_m1_f
main_kernel_c7_m1:
v_smfmac_f32_16x16x64_f16 v[80:83], v[16:19], a[8:15], v112
ds_write_b128 v116, v[16:19] offset:7168
v_smfmac_f32_16x16x64_f16 v[84:87], v[16:19], a[136:143], v112
ds_read_b128 v[8:11], v116 offset:1024
v_smfmac_f32_16x16x64_f16 v[88:91], v[0:3], v[128:135], v112
ds_read_b128 v[12:15], v116 offset:0
s_waitcnt lgkmcnt(3)
v_smfmac_f32_16x16x64_f16 v[80:83], v[4:7], a[32:39], v112
v_smfmac_f32_16x16x64_f16 v[84:87], v[4:7], a[160:167], v112
v_smfmac_f32_16x16x64_f16 v[88:91], v[4:7], v[136:143], v112
s_waitcnt lgkmcnt(2)
s_barrier
s_waitcnt lgkmcnt(1)
v_smfmac_f32_16x16x64_f16 v[80:83], v[8:11], a[64:71], v112
s_waitcnt vmcnt(4)
ds_read_b128 v[20:23], v116 offset:6144
v_pk_add_f16 v32, v32, v72
v_smfmac_f32_16x16x64_f16 v[84:87], v[8:11], a[192:199], v112
ds_read_b128 v[24:27], v116 offset:5120
s_waitcnt lgkmcnt(2)
v_pk_add_f16 v33, v33, v73
v_smfmac_f32_16x16x64_f16 v[80:83], v[12:15], a[96:103], v112
ds_read_b128 v[28:31], v116 offset:4096
v_pk_add_f16 v34, v34, v74
v_smfmac_f32_16x16x64_f16 v[84:87], v[12:15], a[224:231], v112
s_waitcnt lgkmcnt(2)
v_pk_add_f16 v35, v35, v75
v_smfmac_f32_16x16x64_f16 v[80:83], v[20:23], a[40:47], v112
v_cmp_u_f16 vcc, v32, v34
v_smfmac_f32_16x16x64_f16 v[84:87], v[20:23], a[168:175], v112
ds_write_b128 v116, v[32:35] offset:11264
s_cbranch_vccnz main_kernel_c7_m2_f
main_kernel_c7_m2:
v_smfmac_f32_16x16x64_f16 v[80:83], v[32:35], a[16:23], v112
buffer_load_dwordx4 v[96:99], v116, s[4:7], s28 offen sc1
v_smfmac_f32_16x16x64_f16 v[84:87], v[32:35], a[144:151], v112
s_add_u32 s28, s28, 0x40000
s_waitcnt lgkmcnt(2)
v_smfmac_f32_16x16x64_f16 v[80:83], v[24:27], a[72:79], v112
s_waitcnt vmcnt(3)
v_pk_add_f16 v48, v48, v76
v_smfmac_f32_16x16x64_f16 v[84:87], v[24:27], a[200:207], v112
s_waitcnt lgkmcnt(0)
s_barrier
ds_read_b128 v[36:39], v116 offset:10240
v_pk_add_f16 v49, v49, v77
v_smfmac_f32_16x16x64_f16 v[80:83], v[28:31], a[104:111], v112
ds_read_b128 v[40:43], v116 offset:9216
v_pk_add_f16 v50, v50, v78
v_smfmac_f32_16x16x64_f16 v[84:87], v[28:31], a[232:239], v112
ds_read_b128 v[44:47], v116 offset:8192
v_pk_add_f16 v51, v51, v79
v_smfmac_f32_16x16x64_f16 v[88:91], v[8:11], v[144:151], v112
s_waitcnt lgkmcnt(2)
v_cmp_u_f16 vcc, v48, v50
v_smfmac_f32_16x16x64_f16 v[80:83], v[36:39], a[48:55], v112
ds_write_b128 v116, v[48:51] offset:15360
s_cbranch_vccnz main_kernel_c7_m3_f
main_kernel_c7_m3:
v_smfmac_f32_16x16x64_f16 v[80:83], v[48:51], a[24:31], v112
v_smfmac_f32_16x16x64_f16 v[84:87], v[48:51], a[152:159], v112
v_smfmac_f32_16x16x64_f16 v[84:87], v[36:39], a[176:183], v112
s_waitcnt lgkmcnt(2)
v_smfmac_f32_16x16x64_f16 v[80:83], v[40:43], a[80:87], v112
s_waitcnt lgkmcnt(0)
s_barrier
ds_read_b128 v[52:55], v116 offset:14336
v_smfmac_f32_16x16x64_f16 v[84:87], v[40:43], a[208:215], v112
s_memtime s[40:41]
ds_read_b128 v[56:59], v116 offset:13312
v_smfmac_f32_16x16x64_f16 v[80:83], v[44:47], a[112:119], v112
s_add_u32 s19, s52, s54
ds_read_b128 v[60:63], v116 offset:12288
v_smfmac_f32_16x16x64_f16 v[84:87], v[44:47], a[240:247], v112
s_add_u32 s18, s18, 0x40000
s_waitcnt lgkmcnt(2)
v_smfmac_f32_16x16x64_f16 v[80:83], v[52:55], a[56:63], v112
s_bitset0_b32 s18, 20
s_waitcnt lgkmcnt(1)
v_smfmac_f32_16x16x64_f16 v[80:83], v[56:59], a[88:95], v112
s_cmp_eq_u32 s17, 30
s_cselect_b32 s32, s53, 0x10000
s_waitcnt lgkmcnt(0)
v_smfmac_f32_16x16x64_f16 v[80:83], v[60:63], a[120:127], v112
s_add_u32 s52, s52, s32
ds_read_b128 v[64:67], v116 offset:24576
v_smfmac_f32_16x16x64_f16 v[84:87], v[52:55], a[184:191], v112
s_sub_u32 s24, 0x20000, s32
ds_read_b128 v[68:71], v116 offset:28672
v_smfmac_f32_16x16x64_f16 v[84:87], v[56:59], a[216:223], v112
ds_read_b128 v[72:75], v116 offset:25600
s_add_u32 s55, s55, s24
v_cvt_pk_bf16_f32 v92, v80, v81
v_smfmac_f32_16x16x64_f16 v[84:87], v[60:63], a[248:255], v112
ds_read_b128 v[76:79], v116 offset:29696
s_nop 0
v_cvt_pk_bf16_f32 v93, v82, v83
v_smfmac_f32_16x16x64_f16 v[88:91], v[12:15], v[152:159], v112
s_nop 3
v_cvt_pk_bf16_f32 v94, v84, v85
v_cvt_pk_bf16_f32 v95, v86, v87
s_mov_b32 vcc_lo, 0xcccccccc
s_mov_b32 vcc_hi, 0xcccccccc
v_mfma_f32_16x16x32_bf16 v[84:87], v[92:95], v[104:107], 0
v_add_u32 v121, v121, v122
s_waitcnt lgkmcnt(0)
s_sub_u32 s31, s40, s11
v_smfmac_f32_16x16x64_f16 v[88:91], v[16:19], v[160:167], v112
s_sub_u32 s32, s31, s43
s_sub_u32 s47, 1590, s32
s_max_i32 s47, s47, 0
s_cmp_eq_u32 s17, 63
v_cvt_pk_bf16_f32 v114, v84, v85
v_cvt_pk_bf16_f32 v115, v86, v87
buffer_store_dwordx2 v[114:115], v117, s[4:7], s21 offen sc1
s_cbranch_scc1 main_kernel_c7_last
ds_write_b64 v117, v[114:115] offset:17920
v_smfmac_f32_16x16x64_f16 v[88:91], v[20:23], v[168:175], v112
s_cmp_gt_u32 s32, 1790
s_cselect_b32 s33, 900, s47
v_smfmac_f32_16x16x64_f16 v[88:91], v[24:27], v[176:183], v112
s_add_u32 s10, s33, s31
s_andn2_b32 s42, s44, 0x1f00
v_mov_b32 v126, s15
v_smfmac_f32_16x16x64_f16 v[88:91], v[28:31], v[184:191], v112
s_add_u32 s42, s42, 0x4000
v_mov_b32 v127, s10
v_smfmac_f32_16x16x64_f16 v[88:91], v[32:35], v[192:199], v112
.p2align 3
main_kernel_c7_b21:
s_sub_u32 s47, s47, 28
s_cbranch_scc0 main_kernel_c7_b21
s_waitcnt lgkmcnt(0)
s_barrier
ds_read_b128 v[0:3], v116 offset:16384
v_smfmac_f32_16x16x64_f16 v[88:91], v[36:39], v[200:207], v112
ds_read_b128 v[4:7], v116 offset:17408
buffer_store_dwordx2 v[126:127], off, s[4:7], s46 sc1
v_smfmac_f32_16x16x64_f16 v[88:91], v[40:43], v[208:215], v112
ds_read_b128 v[16:19], v116 offset:26624
s_cmp_gt_u32 s32, 1790
s_cselect_b32 s80, s44, 0x7f000000
v_smfmac_f32_16x16x64_f16 v[88:91], v[44:47], v[216:223], v112
ds_read_b128 v[20:23], v116 offset:30720
v_writelane_b32 v121, s55, 39
v_smfmac_f32_16x16x64_f16 v[88:91], v[48:51], v[224:231], v112
ds_read_b128 v[24:27], v116 offset:27648
v_smfmac_f32_16x16x64_f16 v[88:91], v[52:55], v[232:239], v112
ds_read_b128 v[28:31], v116 offset:31744
v_smfmac_f32_16x16x64_f16 v[88:91], v[56:59], v[240:247], v112
v_smfmac_f32_16x16x64_f16 v[88:91], v[60:63], v[248:255], v112
s_waitcnt lgkmcnt(5)
v_mfma_f32_16x16x32_bf16 v[80:83], v[64:67], v[0:3], 0
v_mfma_f32_16x16x32_bf16 v[84:87], v[68:71], v[0:3], 0
buffer_load_dwordx4 v[8:11], v116, s[4:7], s20 offen offset:0 sc1
v_mfma_f32_16x16x32_bf16 v[92:95], v[0:3], v[0:3], 0
buffer_load_dwordx4 v[12:15], v116, s[4:7], s20 offen offset:1024 sc1
v_permlane32_swap_b32 v88, v90
s_waitcnt lgkmcnt(4)
v_mfma_f32_16x16x32_bf16 v[80:83], v[72:75], v[4:7], v[80:83]
v_permlane32_swap_b32 v89, v91
v_mfma_f32_16x16x32_bf16 v[84:87], v[76:79], v[4:7], v[84:87]
v_pk_add_f32 v[88:89], v[88:89], v[90:91]
v_mfma_f32_16x16x32_bf16 v[92:95], v[4:7], v[4:7], v[92:95]
v_cvt_pk_bf16_f32 v124, v88, v89
s_andn2_b32 s35, s46, 0xff
v_bfe_u32 v68, v116, 1, 8
v_mov_b32 v65, 0
buffer_load_dwordx2 v[66:67], v68, s[4:7], s35 offen sc1
buffer_store_dword v127, off, s[4:7], s80 offset:132 sc1
s_waitcnt lgkmcnt(0)
s_waitcnt vmcnt(3)
v_mfma_f32_16x16x32_bf16 v[88:91], v[8:11], v[8:11], v[92:95]
v_mfma_f32_16x16x32_bf16 v[0:3], v[16:19], v[8:11], v[80:83]
v_cmp_u_f32 s[0:1], v8, v10
v_mfma_f32_16x16x32_bf16 v[4:7], v[20:23], v[8:11], v[84:87]
s_waitcnt vmcnt(2)
v_mfma_f32_16x16x32_bf16 v[88:91], v[12:15], v[12:15], v[88:91]
v_mfma_f32_16x16x32_bf16 v[0:3], v[24:27], v[12:15], v[0:3]
v_cmp_u_f32 s[32:33], v12, v14
v_mfma_f32_16x16x32_bf16 v[4:7], v[28:31], v[12:15], v[4:7]
s_or_b64 s[0:1], s[0:1], s[32:33]
s_cbranch_scc1 main_kernel_c7_z_f
main_kernel_c7_z:
v_mul_f32 v88, s30, v88
v_mul_f32 v89, s30, v89
v_exp_f32 v88, v88
v_exp_f32 v89, v89
v_cndmask_b32_dpp v0, v2, v0, vcc quad_perm:[2,3,2,3] row_mask:0xf bank_mask:0xf
v_cvt_pk_bf16_f32 v64, v88, v89
v_cndmask_b32_dpp v1, v3, v1, vcc quad_perm:[2,3,2,3] row_mask:0xf bank_mask:0xf
v_exp_f32 v0, v0
v_mfma_f32_16x16x16_bf16 v[16:19], v[100:101], v[64:65], 0
v_exp_f32 v1, v1
v_cndmask_b32_dpp v4, v6, v4, vcc quad_perm:[2,3,2,3] row_mask:0xf bank_mask:0xf
v_mfma_f32_16x16x16_bf16 v[8:11], v[124:125], v[64:65], 0
v_cndmask_b32_dpp v5, v7, v5, vcc quad_perm:[2,3,2,3] row_mask:0xf bank_mask:0xf
v_exp_f32 v4, v4
v_exp_f32 v5, v5
v_cvt_pk_bf16_f32 v92, v0, v1
v_cvt_pk_bf16_f32 v94, v4, v5
v_mov_b32 v80, 0
v_mov_b32_dpp v93, v92 quad_perm:[0,1,0,1] row_mask:0xf bank_mask:0xf
v_mov_b32_dpp v95, v94 quad_perm:[0,1,0,1] row_mask:0xf bank_mask:0xf
v_mov_b32 v81, 0
v_mov_b32 v82, 0
v_mfma_f32_16x16x32_bf16 v[16:19], v[100:103], v[92:95], v[16:19]
v_mov_b32 v83, 0
v_mov_b32 v84, 0
v_mfma_f32_16x16x32_bf16 v[8:11], v[96:99], v[92:95], v[8:11]
s_buffer_load_dword s42, s[4:7], s42
s_nop 1
v_mov_b32 v85, 0
v_mov_b32 v86, 0
v_mov_b32 v87, 0
v_rcp_f32 v126, v16
v_subrev_u32 v127, 0x21800000, v16
v_cmp_lt_u32 vcc, 0x3c000000, v127
v_pk_mul_f32 v[8:9], v[8:9], v[126:127] op_sel_hi:[1,0]
v_pk_mul_f32 v[10:11], v[10:11], v[126:127] op_sel_hi:[1,0]
s_and_b32 s32, vcc_lo, 0xcccc
v_cvt_pk_bf16_f32 v126, v8, v9
v_cvt_pk_bf16_f32 v127, v10, v11
s_cbranch_scc1 main_kernel_c7_sm_f
main_kernel_c7_ost:
buffer_store_dwordx2 v[126:127], v118, s[4:7], s22 offen sc1
s_waitcnt vmcnt(2)
main_kernel_c7_to0:
s_memtime s[40:41]
v_readlane_b32 s16, v66, 0
v_subrev_u32 v67, s2, v67
s_add_u32 s34, s11, s2
s_nop 0
v_max_u32_dpp v67, v67, v67 row_ror:8 row_mask:0xf bank_mask:0xf
s_nop 1
v_max_u32_dpp v67, v67, v67 row_ror:4 row_mask:0xf bank_mask:0xf
s_nop 1
v_max_u32_dpp v67, v67, v67 row_ror:2 row_mask:0xf bank_mask:0xf
s_nop 1
v_max_u32_dpp v67, v67, v67 row_ror:1 row_mask:0xf bank_mask:0xf
s_waitcnt lgkmcnt(0)
v_readlane_b32 s32, v67, 0
v_readlane_b32 s33, v67, 16
s_sub_u32 s34, s40, s34
s_max_u32 s32, s32, s33
s_add_u32 s35, s34, 1536
s_cmp_gt_u32 s32, s35
s_cbranch_scc1 main_kernel_c7_to2
main_kernel_c7_to3:
s_sub_u32 s33, s42, s2
s_cmp_le_u32 s33, s35
s_cselect_b32 s33, s33, 0
s_max_u32 s32, s32, s33
s_add_u32 s36, s32, 2720
s_add_u32 s32, s32, 1270
s_sub_u32 s47, s32, s34
s_max_i32 s47, s47, 0
.p2align 3
main_kernel_c7_to1:
s_sub_u32 s47, s47, 28
s_cbranch_scc0 main_kernel_c7_to1
s_barrier
buffer_load_dwordx4 v[0:3], v116, s[4:7], s23 offen sc1
ds_read_b128 v[32:35], v113 offset:0
ds_read_b128 v[36:39], v113 offset:1024
s_add_u32 s46, s46, 0x40000
s_bitset0_b32 s46, 20
s_add_u32 s37, s37, 65536
s_add_u32 s26, s26, 65536
s_xor_b32 s32, s23, 1024
buffer_load_dwordx4 v[4:7], v116, s[4:7], s32 offen sc1
ds_read_b128 v[40:43], v113 offset:2048
ds_read_b128 v[44:47], v113 offset:3072
s_add_u32 s44, s44, s24
s_nop 2
s_xor_b32 s32, s23, 2048
buffer_load_dwordx4 v[8:11], v116, s[4:7], s32 offen sc1
ds_read_b128 v[48:51], v113 offset:4096
ds_read_b128 v[52:55], v113 offset:5120
s_nop 3
s_xor_b32 s32, s23, 3072
buffer_load_dwordx4 v[12:15], v116, s[4:7], s32 offen sc1
ds_read_b128 v[56:59], v113 offset:6144
ds_read_b128 v[60:63], v113 offset:7168
s_nop 3
s_xor_b32 s32, s23, 4096
buffer_load_dwordx4 v[16:19], v116, s[4:7], s32 offen sc1
ds_read_b128 v[64:67], v113 offset:8192
ds_read_b128 v[68:71], v113 offset:9216
s_nop 3
s_xor_b32 s32, s23, 5120
buffer_load_dwordx4 v[20:23], v116, s[4:7], s32 offen sc1
ds_read_b128 v[72:75], v113 offset:10240
ds_read_b128 v[76:79], v113 offset:11264
s_nop 3
s_xor_b32 s32, s23, 6144
buffer_load_dwordx4 v[24:27], v116, s[4:7], s32 offen sc1
ds_read_b128 v[88:91], v113 offset:12288
ds_read_b128 v[92:95], v113 offset:13312
s_nop 3
s_xor_b32 s32, s23, 7168
buffer_load_dwordx4 v[28:31], v116, s[4:7], s32 offen sc1
v_and_b32 v127, 0x1f0, v116
v_lshlrev_b32 v127, 4, v127
s_waitcnt lgkmcnt(12)
s_waitcnt vmcnt(7)
v_cmp_u_f32 vcc, v0, v2
s_cbranch_vccnz main_kernel_c7_o0_f
main_kernel_c7_o0:
v_smfmac_f32_16x16x64_bf16 v[80:83], v[0:3], v[32:39], v112
ds_read_b128 v[32:35], v113 offset:14336
ds_read_b128 v[36:39], v113 offset:15360
buffer_load_dwordx2 v[96:97], v127, s[4:7], s45 offen offset:128 sc1
s_waitcnt lgkmcnt(12)
s_waitcnt vmcnt(7)
v_cmp_u_f32 vcc, v4, v6
v_smfmac_f32_16x16x64_bf16 v[84:87], v[0:3], v[40:47], v112
ds_read_b128 v[40:43], v113 offset:16384
ds_read_b128 v[44:47], v113 offset:17408
buffer_store_dwordx2 v[114:115], v119, s[4:7], s37 offen sc1
s_cbranch_vccnz main_kernel_c7_o1_f
main_kernel_c7_o1:
s_waitcnt lgkmcnt(12)
v_smfmac_f32_16x16x64_bf16 v[80:83], v[4:7], v[48:55], v112
ds_read_b128 v[48:51], v113 offset:18432
ds_read_b128 v[52:55], v113 offset:19456
s_waitcnt lgkmcnt(12)
s_waitcnt vmcnt(7)
v_cmp_u_f32 vcc, v8, v10
v_smfmac_f32_16x16x64_bf16 v[84:87], v[4:7], v[56:63], v112
ds_read_b128 v[56:59], v113 offset:20480
ds_read_b128 v[60:63], v113 offset:21504
buffer_store_dword v124, v120, s[4:7], s26 offen sc1
s_cbranch_vccnz main_kernel_c7_o2_f
main_kernel_c7_o2:
s_waitcnt lgkmcnt(12)
v_smfmac_f32_16x16x64_bf16 v[80:83], v[8:11], v[64:71], v112
ds_read_b128 v[64:67], v113 offset:22528
ds_read_b128 v[68:71], v113 offset:23552
s_waitcnt lgkmcnt(12)
s_waitcnt vmcnt(7)
v_cmp_u_f32 vcc, v12, v14
v_smfmac_f32_16x16x64_bf16 v[84:87], v[8:11], v[72:79], v112
ds_read_b128 v[72:75], v113 offset:24576
ds_read_b128 v[76:79], v113 offset:25600
s_cbranch_vccnz main_kernel_c7_o3_f
main_kernel_c7_o3:
s_waitcnt lgkmcnt(12)
v_smfmac_f32_16x16x64_bf16 v[80:83], v[12:15], v[88:95], v112
ds_read_b128 v[88:91], v113 offset:26624
ds_read_b128 v[92:95], v113 offset:27648
s_waitcnt lgkmcnt(12)
s_waitcnt vmcnt(6)
v_cmp_u_f32 vcc, v16, v18
v_smfmac_f32_16x16x64_bf16 v[84:87], v[12:15], v[32:39], v112
ds_read_b128 v[32:35], v113 offset:28672
ds_read_b128 v[36:39], v113 offset:29696
s_cbranch_vccnz main_kernel_c7_o4_f
main_kernel_c7_o4:
s_waitcnt lgkmcnt(12)
v_smfmac_f32_16x16x64_bf16 v[80:83], v[16:19], v[40:47], v112
ds_read_b128 v[40:43], v113 offset:30720
ds_read_b128 v[44:47], v113 offset:31744
s_waitcnt lgkmcnt(12)
s_waitcnt vmcnt(5)
v_cmp_u_f32 vcc, v20, v22
v_smfmac_f32_16x16x64_bf16 v[84:87], v[16:19], v[48:55], v112
s_cbranch_vccnz main_kernel_c7_o5_f
main_kernel_c7_o5:
s_waitcnt lgkmcnt(10)
v_smfmac_f32_16x16x64_bf16 v[80:83], v[20:23], v[56:63], v112
s_waitcnt lgkmcnt(8)
s_waitcnt vmcnt(4)
v_cmp_u_f32 vcc, v24, v26
v_smfmac_f32_16x16x64_bf16 v[84:87], v[20:23], v[64:71], v112
s_cbranch_vccnz main_kernel_c7_o6_f
main_kernel_c7_o6:
s_waitcnt lgkmcnt(6)
v_smfmac_f32_16x16x64_bf16 v[80:83], v[24:27], v[72:79], v112
s_waitcnt lgkmcnt(4)
v_smfmac_f32_16x16x64_bf16 v[84:87], v[24:27], v[88:95], v112
s_waitcnt lgkmcnt(2)
s_waitcnt vmcnt(3)
v_cmp_u_f32 vcc, v28, v30
s_cbranch_vccnz main_kernel_c7_o7_f
main_kernel_c7_o7:
v_smfmac_f32_16x16x64_bf16 v[80:83], v[28:31], v[32:39], v112
s_waitcnt lgkmcnt(0)
v_smfmac_f32_16x16x64_bf16 v[84:87], v[28:31], v[40:47], v112
s_nop 4
v_cvt_pk_bf16_f32 v80, v80, v81
v_cvt_pk_bf16_f32 v81, v82, v83
ds_write_b64 v116, v[80:81] offset:21512
v_cvt_pk_bf16_f32 v82, v84, v85
v_cvt_pk_bf16_f32 v83, v86, v87
ds_write_b64 v116, v[82:83] offset:23560
s_waitcnt lgkmcnt(0)
s_barrier
ds_read_b128 v[72:75], v116 offset:22528
ds_read_b128 v[76:79], v116 offset:23552
s_waitcnt lgkmcnt(1)
v_mfma_f32_16x16x32_bf16 v[64:67], v[72:75], v[108:111], 0
s_waitcnt lgkmcnt(0)
v_mfma_f32_16x16x32_bf16 v[64:67], v[76:79], v[108:111], v[64:67]
s_nop 7
v_cvt_pk_f16_f32 v68, v64, v65
v_cvt_pk_f16_f32 v69, v66, v67
buffer_store_dwordx2 v[68:69], v125, s[4:7], s25 offen sc1
s_sub_u32 s0, s2, s16
s_sub_u32 s0, s0, s39
s_waitcnt vmcnt(3)
main_kernel_c7_tm0:
s_memtime s[40:41]
v_sub_u32 v97, v97, v96
v_subrev_u32 v97, s0, v97
s_add_u32 s34, s11, s2
s_nop 0
v_max_u32_dpp v97, v97, v97 row_ror:8 row_mask:0xf bank_mask:0xf
s_nop 1
v_max_u32_dpp v97, v97, v97 row_ror:4 row_mask:0xf bank_mask:0xf
s_nop 1
v_max_u32_dpp v97, v97, v97 row_ror:2 row_mask:0xf bank_mask:0xf
s_nop 1
v_max_u32_dpp v97, v97, v97 row_ror:1 row_mask:0xf bank_mask:0xf
s_waitcnt lgkmcnt(0)
v_readlane_b32 s32, v97, 0
v_readlane_b32 s33, v97, 16
s_sub_u32 s34, s40, s34
s_max_u32 s32, s32, s33
s_add_u32 s35, s34, 1536
s_cmp_gt_u32 s32, s35
s_cbranch_scc1 main_kernel_c7_tm2
main_kernel_c7_tm3:
s_add_u32 s32, s32, 2720
s_max_u32 s32, s32, s36
s_ashr_i32 s33, s39, 2
s_max_i32 s33, s33, -70
s_min_i32 s33, s33, 30
s_add_u32 s32, s32, s33
s_add_u32 s43, s32, s2
s_sub_u32 s47, s32, s34
s_max_i32 s47, s47, 0
.p2align 3
main_kernel_c7_tm1:
s_sub_u32 s47, s47, 28
s_cbranch_scc0 main_kernel_c7_tm1
s_add_u32 s45, s45, s24
s_branch main_kernel_c7_top
main_kernel_c7_to2:
s_mov_b32 s32, s34
s_mov_b32 s16, s15
s_cmp_gt_u32 s34, 0x40000
s_cbranch_scc1 main_kernel_c7_to3
s_andn2_b32 s35, s46, 0xff
v_bfe_u32 v68, v116, 1, 8
buffer_load_dwordx2 v[66:67], v68, s[4:7], s35 offen sc1
s_sub_u32 s29, s29, 1
s_cbranch_scc1 main_kernel_end
s_cmp_lg_u32 s17, 0
s_cbranch_scc1 main_kernel_c7_to7
s_memtime s[40:41]
s_memrealtime s[80:81]
s_memrealtime s[82:83]
s_memrealtime s[84:85]
s_memrealtime s[86:87]
s_memrealtime s[88:89]
s_memrealtime s[90:91]
s_memrealtime s[92:93]
s_memrealtime s[94:95]
s_memrealtime s[96:97]
s_memrealtime s[98:99]
s_memrealtime s[100:101]
s_waitcnt lgkmcnt(0)
s_add_u32 s80, s80, s82
s_add_u32 s80, s80, s84
s_add_u32 s80, s80, s86
s_add_u32 s80, s80, s88
s_add_u32 s80, s80, s90
s_add_u32 s80, s80, s92
s_add_u32 s80, s80, s94
s_add_u32 s80, s80, s96
s_add_u32 s80, s80, s98
s_add_u32 s80, s80, s100
s_lshl1_add_u32 s80, s80, s15
s_sub_u32 s11, s40, s80
main_kernel_c7_to7:
s_waitcnt vmcnt(0)
s_branch main_kernel_c7_to0
main_kernel_c7_tm2:
s_mov_b32 s32, s34
s_cmp_gt_u32 s34, 0x40000
s_cbranch_scc1 main_kernel_c7_tm3
v_and_b32 v127, 0x1f0, v116
v_lshlrev_b32 v127, 4, v127
buffer_load_dwordx2 v[96:97], v127, s[4:7], s45 offen offset:128 sc1
s_sub_u32 s29, s29, 1
s_cbranch_scc1 main_kernel_end
s_cmp_lg_u32 s17, 0
s_cbranch_scc1 main_kernel_c7_tm7
s_memtime s[40:41]
s_memrealtime s[80:81]
s_memrealtime s[82:83]
s_memrealtime s[84:85]
s_memrealtime s[86:87]
s_memrealtime s[88:89]
s_memrealtime s[90:91]
s_memrealtime s[92:93]
s_memrealtime s[94:95]
s_memrealtime s[96:97]
s_memrealtime s[98:99]
s_memrealtime s[100:101]
s_waitcnt lgkmcnt(0)
s_add_u32 s80, s80, s82
s_add_u32 s80, s80, s84
s_add_u32 s80, s80, s86
s_add_u32 s80, s80, s88
s_add_u32 s80, s80, s90
s_add_u32 s80, s80, s92
s_add_u32 s80, s80, s94
s_add_u32 s80, s80, s96
s_add_u32 s80, s80, s98
s_add_u32 s80, s80, s100
s_lshl1_add_u32 s80, s80, s15
s_sub_u32 s11, s40, s80
main_kernel_c7_tm7:
s_waitcnt vmcnt(0)
s_branch main_kernel_c7_tm0
main_kernel_c7_last:
s_add_u32 s37, s37, 65536
s_add_u32 s26, s26, 65536
buffer_store_dwordx2 v[114:115], v119, s[4:7], s37 offen sc1
v_smfmac_f32_16x16x64_f16 v[88:91], v[20:23], v[168:175], v112
v_smfmac_f32_16x16x64_f16 v[88:91], v[24:27], v[176:183], v112
v_smfmac_f32_16x16x64_f16 v[88:91], v[28:31], v[184:191], v112
v_smfmac_f32_16x16x64_f16 v[88:91], v[32:35], v[192:199], v112
v_smfmac_f32_16x16x64_f16 v[88:91], v[36:39], v[200:207], v112
v_smfmac_f32_16x16x64_f16 v[88:91], v[40:43], v[208:215], v112
v_smfmac_f32_16x16x64_f16 v[88:91], v[44:47], v[216:223], v112
v_smfmac_f32_16x16x64_f16 v[88:91], v[48:51], v[224:231], v112
v_smfmac_f32_16x16x64_f16 v[88:91], v[52:55], v[232:239], v112
v_smfmac_f32_16x16x64_f16 v[88:91], v[56:59], v[240:247], v112
v_smfmac_f32_16x16x64_f16 v[88:91], v[60:63], v[248:255], v112
s_nop 7
v_permlane32_swap_b32 v88, v90
s_nop 1
v_permlane32_swap_b32 v89, v91
s_nop 1
v_pk_add_f32 v[88:89], v[88:89], v[90:91]
s_nop 1
v_cvt_pk_bf16_f32 v124, v88, v89
s_nop 1
buffer_store_dword v124, v120, s[4:7], s26 offen sc1
s_branch main_kernel_end
main_kernel_c7_m0_f:
s_waitcnt lgkmcnt(0)
buffer_load_dwordx4 v[0:3], v116, s[4:7], s18 offen sc1
buffer_load_dwordx4 v[64:67], v116, s[4:7], s19 offen sc1
s_xor_b32 s32, s18, 1024
buffer_load_dwordx4 v[16:19], v116, s[4:7], s32 offen sc1
s_xor_b32 s32, s19, 1024
buffer_load_dwordx4 v[68:71], v116, s[4:7], s32 offen sc1
s_xor_b32 s32, s18, 2048
buffer_load_dwordx4 v[32:35], v116, s[4:7], s32 offen sc1
s_xor_b32 s32, s19, 2048
buffer_load_dwordx4 v[72:75], v116, s[4:7], s32 offen sc1
s_xor_b32 s32, s18, 3072
buffer_load_dwordx4 v[48:51], v116, s[4:7], s32 offen sc1
s_xor_b32 s32, s19, 3072
buffer_load_dwordx4 v[76:79], v116, s[4:7], s32 offen sc1
s_sub_u32 s29, s29, 1
s_cbranch_scc1 main_kernel_end
s_waitcnt vmcnt(0)
v_max_u32 v126, v0, v2
v_max3_u32 v126, v126, v64, v66
v_cmp_eq_u32 vcc, -1, v126
s_cbranch_vccnz main_kernel_c7_m0_f
v_pk_add_f16 v0, v0, v64
v_pk_add_f16 v1, v1, v65
v_pk_add_f16 v2, v2, v66
v_pk_add_f16 v3, v3, v67
s_nop 0
s_branch main_kernel_c7_m0
main_kernel_c7_m1_f:
s_waitcnt lgkmcnt(0)
s_xor_b32 s32, s18, 1024
buffer_load_dwordx4 v[16:19], v116, s[4:7], s32 offen sc1
s_xor_b32 s32, s19, 1024
buffer_load_dwordx4 v[68:71], v116, s[4:7], s32 offen sc1
s_xor_b32 s32, s18, 2048
buffer_load_dwordx4 v[32:35], v116, s[4:7], s32 offen sc1
s_xor_b32 s32, s19, 2048
buffer_load_dwordx4 v[72:75], v116, s[4:7], s32 offen sc1
s_xor_b32 s32, s18, 3072
buffer_load_dwordx4 v[48:51], v116, s[4:7], s32 offen sc1
s_xor_b32 s32, s19, 3072
buffer_load_dwordx4 v[76:79], v116, s[4:7], s32 offen sc1
s_sub_u32 s29, s29, 1
s_cbranch_scc1 main_kernel_end
s_waitcnt vmcnt(0)
v_max_u32 v126, v16, v18
v_max3_u32 v126, v126, v68, v70
v_cmp_eq_u32 vcc, -1, v126
s_cbranch_vccnz main_kernel_c7_m1_f
v_pk_add_f16 v16, v16, v68
v_pk_add_f16 v17, v17, v69
v_pk_add_f16 v18, v18, v70
v_pk_add_f16 v19, v19, v71
s_nop 0
s_branch main_kernel_c7_m1
main_kernel_c7_m2_f:
s_waitcnt lgkmcnt(0)
s_xor_b32 s32, s18, 2048
buffer_load_dwordx4 v[32:35], v116, s[4:7], s32 offen sc1
s_xor_b32 s32, s19, 2048
buffer_load_dwordx4 v[72:75], v116, s[4:7], s32 offen sc1
s_xor_b32 s32, s18, 3072
buffer_load_dwordx4 v[48:51], v116, s[4:7], s32 offen sc1
s_xor_b32 s32, s19, 3072
buffer_load_dwordx4 v[76:79], v116, s[4:7], s32 offen sc1
s_sub_u32 s29, s29, 1
s_cbranch_scc1 main_kernel_end
s_waitcnt vmcnt(0)
v_max_u32 v126, v32, v34
v_max3_u32 v126, v126, v72, v74
v_cmp_eq_u32 vcc, -1, v126
s_cbranch_vccnz main_kernel_c7_m2_f
v_pk_add_f16 v32, v32, v72
v_pk_add_f16 v33, v33, v73
v_pk_add_f16 v34, v34, v74
v_pk_add_f16 v35, v35, v75
ds_write_b128 v116, v[32:35] offset:11264
s_branch main_kernel_c7_m2
main_kernel_c7_m3_f:
s_waitcnt lgkmcnt(0)
s_xor_b32 s32, s18, 3072
buffer_load_dwordx4 v[48:51], v116, s[4:7], s32 offen sc1
s_xor_b32 s32, s19, 3072
buffer_load_dwordx4 v[76:79], v116, s[4:7], s32 offen sc1
s_sub_u32 s29, s29, 1
s_cbranch_scc1 main_kernel_end
s_waitcnt vmcnt(0)
v_max_u32 v126, v48, v50
v_max3_u32 v126, v126, v76, v78
v_cmp_eq_u32 vcc, -1, v126
s_cbranch_vccnz main_kernel_c7_m3_f
v_pk_add_f16 v48, v48, v76
v_pk_add_f16 v49, v49, v77
v_pk_add_f16 v50, v50, v78
v_pk_add_f16 v51, v51, v79
ds_write_b128 v116, v[48:51] offset:15360
s_branch main_kernel_c7_m3
main_kernel_c7_z_f:
buffer_load_dwordx4 v[8:11], v116, s[4:7], s20 offen offset:0 sc1
buffer_load_dwordx4 v[12:15], v116, s[4:7], s20 offen offset:1024 sc1
s_memtime s[32:33]
ds_read_b32 v126, v116 offset:18432
s_sub_u32 s34, s19, s54
s_xor_b32 s34, s34, 0x2000
s_lshl_b32 s35, s12, 15
s_add_u32 s34, s34, s35
s_lshl_b32 s35, s13, 8
s_add_u32 s35, s35, s34
s_add_u32 s34, s34, 0x4000
s_waitcnt lgkmcnt(0)
s_sub_u32 s32, s32, 450
v_sub_u32 v126, s32, v126
v_max_u32 v127, v126, v127
buffer_store_dword v127, off, s[4:7], s34 sc1
s_sub_u32 s29, s29, 1
s_cbranch_scc1 main_kernel_end
s_waitcnt vmcnt(1)
main_kernel_c7_z_g:
v_max_u32 v126, v8, v10
v_max3_u32 v126, v126, v12, v14
v_cmp_eq_u32 vcc, -1, v126
s_cbranch_vccnz main_kernel_c7_z_h
v_mfma_f32_16x16x32_bf16 v[88:91], v[8:11], v[8:11], v[92:95]
v_mfma_f32_16x16x32_bf16 v[0:3], v[16:19], v[8:11], v[80:83]
v_mfma_f32_16x16x32_bf16 v[4:7], v[20:23], v[8:11], v[84:87]
v_mfma_f32_16x16x32_bf16 v[88:91], v[12:15], v[12:15], v[88:91]
v_mfma_f32_16x16x32_bf16 v[0:3], v[24:27], v[12:15], v[0:3]
v_mfma_f32_16x16x32_bf16 v[4:7], v[28:31], v[12:15], v[4:7]
buffer_store_dword v127, off, s[4:7], s35 offset:132 sc1
s_mov_b32 vcc_lo, 0xcccccccc
s_mov_b32 vcc_hi, 0xcccccccc
s_branch main_kernel_c7_z
main_kernel_c7_z_h:
buffer_load_dwordx4 v[8:11], v116, s[4:7], s20 offen offset:0 sc1
buffer_load_dwordx4 v[12:15], v116, s[4:7], s20 offen offset:1024 sc1
s_sub_u32 s29, s29, 1
s_cbranch_scc1 main_kernel_end
v_add_u32 v127, 300, v127
s_waitcnt vmcnt(0)
s_branch main_kernel_c7_z_g
main_kernel_c7_sm_f:
s_waitcnt vmcnt(0) lgkmcnt(0)
buffer_load_dwordx4 v[8:11], v116, s[4:7], s20 offen offset:0 sc1
buffer_load_dwordx4 v[12:15], v116, s[4:7], s20 offen offset:1024 sc1
ds_read_b128 v[0:3], v116 offset:16384
ds_read_b128 v[4:7], v116 offset:17408
ds_read_b128 v[64:67], v116 offset:24576
ds_read_b128 v[68:71], v116 offset:28672
ds_read_b128 v[72:75], v116 offset:25600
ds_read_b128 v[76:79], v116 offset:29696
ds_read_b128 v[16:19], v116 offset:26624
ds_read_b128 v[20:23], v116 offset:30720
ds_read_b128 v[24:27], v116 offset:27648
ds_read_b128 v[28:31], v116 offset:31744
s_waitcnt vmcnt(0)
s_waitcnt lgkmcnt(0)
v_mfma_f32_16x16x32_bf16 v[80:83], v[64:67], v[0:3], 0
v_mfma_f32_16x16x32_bf16 v[84:87], v[68:71], v[0:3], 0
v_mfma_f32_16x16x32_bf16 v[92:95], v[0:3], v[0:3], 0
v_mfma_f32_16x16x32_bf16 v[80:83], v[72:75], v[4:7], v[80:83]
v_mfma_f32_16x16x32_bf16 v[84:87], v[76:79], v[4:7], v[84:87]
v_mfma_f32_16x16x32_bf16 v[92:95], v[4:7], v[4:7], v[92:95]
v_mfma_f32_16x16x32_bf16 v[0:3], v[16:19], v[8:11], v[80:83]
v_mfma_f32_16x16x32_bf16 v[4:7], v[20:23], v[8:11], v[84:87]
v_mfma_f32_16x16x32_bf16 v[88:91], v[8:11], v[8:11], v[92:95]
v_mfma_f32_16x16x32_bf16 v[0:3], v[24:27], v[12:15], v[0:3]
v_mfma_f32_16x16x32_bf16 v[4:7], v[28:31], v[12:15], v[4:7]
v_mfma_f32_16x16x32_bf16 v[88:91], v[12:15], v[12:15], v[88:91]
s_nop 7
v_mov_b32 v65, 0
v_max_f32 v126, v88, v89
v_mul_f32 v126, s30, v126
v_max3_f32 v126, v126, v0, v1
v_max3_f32 v126, v126, v2, v3
v_max3_f32 v126, v126, v4, v5
v_max3_f32 v126, v126, v6, v7
v_mov_b32 v127, v126
s_nop 1
v_permlane32_swap_b32 v126, v127
v_max_f32 v126, v126, v127
v_mov_b32 v127, v126
s_nop 1
v_permlane16_swap_b32 v126, v127
v_max_f32 v126, v126, v127
v_mul_f32 v127, 0x40faf233, v126
s_mov_b32 vcc_lo, 0xcccccccc
s_mov_b32 vcc_hi, 0xcccccccc
v_sub_f32 v0, v0, v126
v_sub_f32 v1, v1, v126
v_sub_f32 v2, v2, v126
v_sub_f32 v3, v3, v126
v_sub_f32 v4, v4, v126
v_sub_f32 v5, v5, v126
v_sub_f32 v6, v6, v126
v_sub_f32 v7, v7, v126
v_sub_f32 v88, v88, v127
v_sub_f32 v89, v89, v127
s_waitcnt lgkmcnt(0)
s_nop 0
v_mul_f32 v88, s30, v88
v_mul_f32 v89, s30, v89
v_exp_f32 v88, v88
v_exp_f32 v89, v89
v_cndmask_b32_dpp v0, v2, v0, vcc quad_perm:[2,3,2,3] row_mask:0xf bank_mask:0xf
v_cvt_pk_bf16_f32 v64, v88, v89
v_cndmask_b32_dpp v1, v3, v1, vcc quad_perm:[2,3,2,3] row_mask:0xf bank_mask:0xf
v_exp_f32 v0, v0
v_mfma_f32_16x16x16_bf16 v[16:19], v[100:101], v[64:65], 0
v_exp_f32 v1, v1
v_cndmask_b32_dpp v4, v6, v4, vcc quad_perm:[2,3,2,3] row_mask:0xf bank_mask:0xf
v_mfma_f32_16x16x16_bf16 v[8:11], v[124:125], v[64:65], 0
v_cndmask_b32_dpp v5, v7, v5, vcc quad_perm:[2,3,2,3] row_mask:0xf bank_mask:0xf
v_exp_f32 v4, v4
v_exp_f32 v5, v5
v_cvt_pk_bf16_f32 v92, v0, v1
v_cvt_pk_bf16_f32 v94, v4, v5
v_mov_b32 v80, 0
v_mov_b32_dpp v93, v92 quad_perm:[0,1,0,1] row_mask:0xf bank_mask:0xf
v_mov_b32_dpp v95, v94 quad_perm:[0,1,0,1] row_mask:0xf bank_mask:0xf
v_mov_b32 v81, 0
v_mov_b32 v82, 0
v_mfma_f32_16x16x32_bf16 v[16:19], v[100:103], v[92:95], v[16:19]
v_mov_b32 v83, 0
v_mov_b32 v84, 0
v_mfma_f32_16x16x32_bf16 v[8:11], v[96:99], v[92:95], v[8:11]
s_nop 1
v_mov_b32 v85, 0
v_mov_b32 v86, 0
v_mov_b32 v87, 0
v_rcp_f32 v126, v16
v_subrev_u32 v127, 0x21800000, v16
v_cmp_lt_u32 vcc, 0x3c000000, v127
v_pk_mul_f32 v[8:9], v[8:9], v[126:127] op_sel_hi:[1,0]
v_pk_mul_f32 v[10:11], v[10:11], v[126:127] op_sel_hi:[1,0]
s_and_b32 s32, vcc_lo, 0xcccc
v_cvt_pk_bf16_f32 v126, v8, v9
v_cvt_pk_bf16_f32 v127, v10, v11
s_andn2_b32 s35, s46, 0xff
v_bfe_u32 v68, v116, 1, 8
buffer_load_dwordx2 v[66:67], v68, s[4:7], s35 offen sc1
s_waitcnt vmcnt(0)
s_branch main_kernel_c7_ost
main_kernel_c7_o0_f:
s_nop 0
buffer_load_dwordx4 v[0:3], v116, s[4:7], s23 offen sc1
s_xor_b32 s32, s23, 1024
buffer_load_dwordx4 v[4:7], v116, s[4:7], s32 offen sc1
s_sub_u32 s29, s29, 1
s_cbranch_scc1 main_kernel_end
s_waitcnt vmcnt(0)
v_max_u32 v126, v0, v2
v_cmp_eq_u32 vcc, -1, v126
s_cbranch_vccnz main_kernel_c7_o0_f
s_branch main_kernel_c7_o0
main_kernel_c7_o1_f:
s_nop 0
s_xor_b32 s32, s23, 1024
buffer_load_dwordx4 v[4:7], v116, s[4:7], s32 offen sc1
s_xor_b32 s32, s23, 2048
buffer_load_dwordx4 v[8:11], v116, s[4:7], s32 offen sc1
s_sub_u32 s29, s29, 1
s_cbranch_scc1 main_kernel_end
s_waitcnt vmcnt(0)
v_max_u32 v126, v4, v6
v_cmp_eq_u32 vcc, -1, v126
s_cbranch_vccnz main_kernel_c7_o1_f
s_branch main_kernel_c7_o1
main_kernel_c7_o2_f:
s_nop 0
s_xor_b32 s32, s23, 2048
buffer_load_dwordx4 v[8:11], v116, s[4:7], s32 offen sc1
s_xor_b32 s32, s23, 3072
buffer_load_dwordx4 v[12:15], v116, s[4:7], s32 offen sc1
s_sub_u32 s29, s29, 1
s_cbranch_scc1 main_kernel_end
s_waitcnt vmcnt(0)
v_max_u32 v126, v8, v10
v_cmp_eq_u32 vcc, -1, v126
s_cbranch_vccnz main_kernel_c7_o2_f
s_branch main_kernel_c7_o2
main_kernel_c7_o3_f:
s_nop 0
s_xor_b32 s32, s23, 3072
buffer_load_dwordx4 v[12:15], v116, s[4:7], s32 offen sc1
s_xor_b32 s32, s23, 4096
buffer_load_dwordx4 v[16:19], v116, s[4:7], s32 offen sc1
s_sub_u32 s29, s29, 1
s_cbranch_scc1 main_kernel_end
s_waitcnt vmcnt(0)
v_max_u32 v126, v12, v14
v_cmp_eq_u32 vcc, -1, v126
s_cbranch_vccnz main_kernel_c7_o3_f
s_branch main_kernel_c7_o3
main_kernel_c7_o4_f:
s_nop 0
s_xor_b32 s32, s23, 4096
buffer_load_dwordx4 v[16:19], v116, s[4:7], s32 offen sc1
s_xor_b32 s32, s23, 5120
buffer_load_dwordx4 v[20:23], v116, s[4:7], s32 offen sc1
s_sub_u32 s29, s29, 1
s_cbranch_scc1 main_kernel_end
s_waitcnt vmcnt(0)
v_max_u32 v126, v16, v18
v_cmp_eq_u32 vcc, -1, v126
s_cbranch_vccnz main_kernel_c7_o4_f
s_branch main_kernel_c7_o4
main_kernel_c7_o5_f:
s_nop 0
s_xor_b32 s32, s23, 5120
buffer_load_dwordx4 v[20:23], v116, s[4:7], s32 offen sc1
s_xor_b32 s32, s23, 6144
buffer_load_dwordx4 v[24:27], v116, s[4:7], s32 offen sc1
s_sub_u32 s29, s29, 1
s_cbranch_scc1 main_kernel_end
s_waitcnt vmcnt(0)
v_max_u32 v126, v20, v22
v_cmp_eq_u32 vcc, -1, v126
s_cbranch_vccnz main_kernel_c7_o5_f
s_branch main_kernel_c7_o5
main_kernel_c7_o6_f:
s_nop 0
s_xor_b32 s32, s23, 6144
buffer_load_dwordx4 v[24:27], v116, s[4:7], s32 offen sc1
s_xor_b32 s32, s23, 7168
buffer_load_dwordx4 v[28:31], v116, s[4:7], s32 offen sc1
s_sub_u32 s29, s29, 1
s_cbranch_scc1 main_kernel_end
s_waitcnt vmcnt(0)
v_max_u32 v126, v24, v26
v_cmp_eq_u32 vcc, -1, v126
s_cbranch_vccnz main_kernel_c7_o6_f
s_branch main_kernel_c7_o6
main_kernel_c7_o7_f:
s_nop 0
s_xor_b32 s32, s23, 7168
buffer_load_dwordx4 v[28:31], v116, s[4:7], s32 offen sc1
s_sub_u32 s29, s29, 1
s_cbranch_scc1 main_kernel_end
s_waitcnt vmcnt(0)
v_max_u32 v126, v28, v30
v_cmp_eq_u32 vcc, -1, v126
s_cbranch_vccnz main_kernel_c7_o7_f
s_branch main_kernel_c7_o7
main_kernel_att:
s_cmp_gt_u32 s13, 1
s_cbranch_scc1 main_kernel_p_end
s_cmp_lg_u32 s14, 0
s_cbranch_scc1 main_kernel_p_bar
s_lshl_b32 s32, s13, 21
s_add_u32 s32, s32, 0x8c00000
v_lshlrev_b32 v2, 2, v250
v_mov_b32 v3, -1
s_mov_b64 s[20:21], -1
s_mov_b32 s34, 6
s_mov_b32 exec_hi, 0
s_waitcnt vmcnt(0)
main_kernel_p_lp:
s_memtime s[16:17]
s_waitcnt lgkmcnt(0)
buffer_store_dword v3, v2, s[4:7], s32 offen sc1
s_waitcnt vmcnt(0)
s_memtime s[18:19]
s_xor_b32 s32, s32, 0x2000
s_waitcnt lgkmcnt(0)
s_sub_u32 s33, s18, s16
s_min_u32 s20, s20, s33
s_memtime s[16:17]
s_waitcnt lgkmcnt(0)
buffer_store_dword v3, v2, s[4:7], s32 offen sc1
s_waitcnt vmcnt(0)
s_memtime s[18:19]
s_xor_b32 s32, s32, 0x2000
s_waitcnt lgkmcnt(0)
s_sub_u32 s33, s18, s16
s_min_u32 s21, s21, s33
s_add_u32 s32, s32, 128
s_sub_u32 s34, s34, 1
s_cmp_lg_u32 s34, 0
s_cbranch_scc1 main_kernel_p_lp
s_cmp_lt_u32 s21, s20
s_cselect_b32 s32, 3, 2
s_lshl_b32 s33, s13, 2
v_mov_b32 v3, s32
s_mov_b64 exec, 1
buffer_store_dword v3, off, s[60:63], s33 offset:16 sc1
s_mov_b64 exec, -1
main_kernel_p_bar:
s_barrier
main_kernel_p_end:
v_cmp_gt_u32 vcc, 128, v0
v_mov_b32 v20, 0x1f80
v_mov_b32 v21, 0x380
v_cndmask_b32 v20, v20, v21, vcc
v_mov_b32 v21, 0x1fff
v_mov_b32 v22, 0x1ff
v_cndmask_b32 v21, v21, v22, vcc
v_subrev_u32 v22, 128, v0
v_lshlrev_b32 v22, 13, v22
v_lshlrev_b32 v23, 10, v0
v_cndmask_b32 v22, v22, v23, vcc
v_cmp_gt_u32 vcc, 144, v0
v_mov_b32 v23, 0x40000000
s_nop 0
v_cndmask_b32 v22, v23, v22, vcc
s_mov_b32 s8, s40
s_and_b32 s9, s41, 0xffff
s_mov_b32 s10, 0x800000
s_mov_b32 s11, 0x20000
s_lshl_b32 s35, s13, 17
v_subrev_u32 v23, s40, v21
v_and_b32 v23, v23, v20
v_add_u32 v24, v23, v22
buffer_load_dwordx2 v[14:15], v24, s[8:11], s35 offen offset:60
s_add_u32 s35, s35, 2097152
buffer_load_dwordx2 v[14:15], v24, s[8:11], s35 offen offset:60
s_add_u32 s35, s35, 2097152
buffer_load_dwordx2 v[14:15], v24, s[8:11], s35 offen offset:60
s_add_u32 s35, s35, 2097152
buffer_load_dwordx2 v[14:15], v24, s[8:11], s35 offen offset:60
s_add_u32 s35, s35, 2097152
s_mov_b32 s8, s46
s_and_b32 s9, s47, 0xffff
s_mov_b32 s10, 0x800000
s_mov_b32 s11, 0x20000
s_lshl_b32 s35, s13, 17
v_subrev_u32 v23, s46, v21
v_and_b32 v23, v23, v20
v_add_u32 v30, v23, v22
buffer_load_dwordx2 v[14:15], v30, s[8:11], s35 offen offset:60
s_add_u32 s35, s35, 2097152
buffer_load_dwordx2 v[14:15], v30, s[8:11], s35 offen offset:60
s_add_u32 s35, s35, 2097152
buffer_load_dwordx2 v[14:15], v30, s[8:11], s35 offen offset:60
s_add_u32 s35, s35, 2097152
buffer_load_dwordx2 v[14:15], v30, s[8:11], s35 offen offset:60
s_add_u32 s35, s35, 2097152
s_mov_b32 s8, s64
s_and_b32 s9, s65, 0xffff
s_mov_b32 s10, 0x200000
s_mov_b32 s11, 0x20000
s_mul_i32 s35, s13, 131072
buffer_load_dword v14, v12, s[8:11], s35 offen
s_add_u32 s35, s35, 32768
buffer_load_dword v14, v12, s[8:11], s35 offen
s_add_u32 s35, s35, 32768
buffer_load_dword v14, v12, s[8:11], s35 offen
s_add_u32 s35, s35, 32768
buffer_load_dword v14, v12, s[8:11], s35 offen
s_add_u32 s35, s35, 32768
s_mov_b32 s8, s66
s_and_b32 s9, s67, 0xffff
s_mov_b32 s10, 0x200000
s_mov_b32 s11, 0x20000
s_mul_i32 s35, s13, 131072
buffer_load_dword v14, v12, s[8:11], s35 offen
s_add_u32 s35, s35, 32768
buffer_load_dword v14, v12, s[8:11], s35 offen
s_add_u32 s35, s35, 32768
buffer_load_dword v14, v12, s[8:11], s35 offen
s_add_u32 s35, s35, 32768
buffer_load_dword v14, v12, s[8:11], s35 offen
s_add_u32 s35, s35, 32768
s_lshl_b32 s35, s13, 18
s_add_u32 s35, s35, 0x4808000
v_bfe_u32 v13, v0, 5, 1
v_mul_u32_u24 v13, 192, v13
v_lshl_add_u32 v13, v0, 8, v13
buffer_load_dword v14, v13, s[4:7], s35 offen
s_add_u32 s35, s35, 65536
buffer_load_dword v14, v13, s[4:7], s35 offen
s_add_u32 s35, s35, 65536
buffer_load_dword v14, v13, s[4:7], s35 offen
s_add_u32 s35, s35, 65536
buffer_load_dword v14, v13, s[4:7], s35 offen
s_add_u32 s35, s35, 65536
v_lshlrev_b32 v0, 2, v250
s_mov_b32 s32, 0x841f000
main_kernel_awf:
buffer_load_dword v2, v0, s[4:7], s32 offen sc1
s_waitcnt vmcnt(0)
v_cmp_eq_u32 vcc, 0, v2
s_cbranch_vccz main_kernel_awf_ok
s_sleep 4
s_sub_u32 s29, s29, 1
s_cbranch_scc0 main_kernel_awf
s_branch main_kernel_end
main_kernel_awf_ok:
s_mov_b32 s27, 6
s_branch main_kernel_worker
main_kernel_att2:
s_lshl_b32 s25, s13, 1
s_lshr_b32 s31, s14, 1
s_add_u32 s25, s25, s31
s_and_b32 s23, s14, 1
v_lshlrev_b32 v196, 4, v250
v_and_b32 v188, 15, v250
v_lshrrev_b32 v190, 4, v250
v_and_b32 v203, 7, v250
v_lshl_add_u32 v194, v190, 3, v203
v_lshlrev_b32 v197, 4, v194
v_lshlrev_b32 v203, 8, v203
v_bfe_u32 v198, v196, 1, 8
v_min_u32 v199, 2, v250
v_lshlrev_b32 v199, 13, v199
s_lshl_b32 s31, s25, 2
s_sub_u32 s31, 82416, s31
s_mov_b64 exec, 0xf0
v_lshl_add_u32 v199, v250, 2, s31
s_mov_b64 exec, -1
v_mov_b32 v200, 1
v_mov_b32 v201, 1
v_mov_b32 v202, 0
v_lshlrev_b32 v194, 2, v190
v_sub_u32 v188, v188, v194
v_mov_b32 v194, 0xf149f2ca
v_cmp_le_i32 vcc, 0, v188
s_nop 1
v_cndmask_b32 v152, v194, 0, vcc
v_cmp_le_i32 vcc, 1, v188
s_nop 1
v_cndmask_b32 v153, v194, 0, vcc
v_cmp_le_i32 vcc, 2, v188
s_nop 1
v_cndmask_b32 v154, v194, 0, vcc
v_cmp_le_i32 vcc, 3, v188
s_nop 1
v_cndmask_b32 v155, v194, 0, vcc
v_cmp_le_u32 vcc, 2, v190
s_nop 1
v_cndmask_b32 v156, v194, 0, vcc
v_mov_b32 v184, 0x3f803f80
v_cndmask_b32 v157, v194, 0, vcc
v_mov_b32 v185, 0x3f803f80
v_cndmask_b32 v158, v194, 0, vcc
v_mov_b32 v186, 0x3f803f80
v_cndmask_b32 v159, v194, 0, vcc
v_mov_b32 v187, 0x3f803f80
v_mov_b32 v162, 0
v_mov_b32 v163, 0
s_mov_b32 s24, 0x3e0293ee
s_lshl_b32 s31, s23, 18
s_lshl_b32 s32, s25, 12
s_add_u32 s31, s31, s32
s_add_u32 s15, s31, 0x800000
s_add_u32 s16, s31, 0x1800000
s_add_u32 s20, s31, 0x3800000
s_lshl_b32 s31, s23, 18
s_lshl_b32 s32, s25, 13
s_add_u32 s31, s31, s32
s_add_u32 s17, s31, 0x2800000
s_lshl_b32 s31, s23, 16
s_lshl_b32 s32, s25, 11
s_add_u32 s31, s31, s32
s_add_u32 s18, s31, 0x8000000
s_add_u32 s19, s31, 0x6e00000
s_lshl_b32 s31, s23, 7
s_lshl_b32 s32, s25, 2
s_add_u32 s31, s31, s32
s_add_u32 s21, s31, 0x8404000
s_lshl_b32 s31, s23, 8
s_lshl_b32 s32, s25, 3
s_add_u32 s31, s31, s32
s_add_u32 s22, s31, 0x8400000
main_kernel_a_fp:
buffer_load_dword v194, v199, s[4:7], s21 offen sc1
s_waitcnt vmcnt(0)
v_cmp_eq_u32 vcc, 0, v194
s_cbranch_vccz main_kernel_a_fok
s_sleep 8
s_sub_u32 s29, s29, 1
s_cbranch_scc0 main_kernel_a_fp
s_branch main_kernel_end
main_kernel_a_fok:
buffer_load_dwordx4 v[32:35], v196, s[4:7], s16 offen offset:0 sc1
buffer_load_dwordx4 v[36:39], v196, s[4:7], s16 offen offset:1024 sc1
buffer_load_dwordx4 v[40:43], v196, s[4:7], s16 offen offset:2048 sc1
buffer_load_dwordx4 v[44:47], v196, s[4:7], s16 offen offset:3072 sc1
s_add_u32 s16, s16, 131072
buffer_load_dwordx4 v[48:51], v196, s[4:7], s16 offen offset:0 sc1
buffer_load_dwordx4 v[52:55], v196, s[4:7], s16 offen offset:1024 sc1
buffer_load_dwordx4 v[56:59], v196, s[4:7], s16 offen offset:2048 sc1
buffer_load_dwordx4 v[60:63], v196, s[4:7], s16 offen offset:3072 sc1
s_add_u32 s16, s16, 393216
buffer_load_dwordx4 v[0:3], v196, s[4:7], s15 offen offset:0 sc1
buffer_load_dwordx4 v[4:7], v196, s[4:7], s15 offen offset:1024 sc1
buffer_load_dwordx4 v[8:11], v196, s[4:7], s15 offen offset:2048 sc1
buffer_load_dwordx4 v[12:15], v196, s[4:7], s15 offen offset:3072 sc1
s_add_u32 s15, s15, 131072
buffer_load_dwordx4 v[16:19], v196, s[4:7], s15 offen offset:0 sc1
buffer_load_dwordx4 v[20:23], v196, s[4:7], s15 offen offset:1024 sc1
buffer_load_dwordx4 v[24:27], v196, s[4:7], s15 offen offset:2048 sc1
buffer_load_dwordx4 v[28:31], v196, s[4:7], s15 offen offset:3072 sc1
s_add_u32 s15, s15, 393216
buffer_load_dwordx4 v[64:67], v196, s[4:7], s17 offen offset:0 sc1
buffer_load_dwordx4 v[68:71], v196, s[4:7], s17 offen offset:1024 sc1
buffer_load_dwordx4 v[72:75], v196, s[4:7], s17 offen offset:2048 sc1
buffer_load_dwordx4 v[76:79], v196, s[4:7], s17 offen offset:3072 sc1
s_add_u32 s17, s17, 4096
buffer_load_dwordx4 v[80:83], v196, s[4:7], s17 offen offset:0 sc1
buffer_load_dwordx4 v[84:87], v196, s[4:7], s17 offen offset:1024 sc1
buffer_load_dwordx4 v[88:91], v196, s[4:7], s17 offen offset:2048 sc1
buffer_load_dwordx4 v[92:95], v196, s[4:7], s17 offen offset:3072 sc1
s_add_u32 s17, s17, 520192
s_mov_b32 s26, 0
main_kernel_a_top:
s_add_u32 s21, s21, 256
s_waitcnt vmcnt(15)
v_mfma_f32_16x16x32_bf16 v[128:131], v[32:35], v[0:3], v[152:155]
s_waitcnt vmcnt(14)
v_mfma_f32_16x16x32_bf16 v[128:131], v[36:39], v[4:7], v[128:131]
s_waitcnt vmcnt(13)
v_mfma_f32_16x16x32_bf16 v[128:131], v[40:43], v[8:11], v[128:131]
s_waitcnt vmcnt(12)
v_mfma_f32_16x16x32_bf16 v[128:131], v[44:47], v[12:15], v[128:131]
s_waitcnt vmcnt(11)
v_mfma_f32_16x16x32_bf16 v[140:143], v[32:35], v[16:19], 0
v_mfma_f32_16x16x32_bf16 v[144:147], v[48:51], v[16:19], v[152:155]
s_waitcnt vmcnt(10)
v_mfma_f32_16x16x32_bf16 v[140:143], v[36:39], v[20:23], v[140:143]
v_mfma_f32_16x16x32_bf16 v[144:147], v[52:55], v[20:23], v[144:147]
s_waitcnt vmcnt(9)
v_mfma_f32_16x16x32_bf16 v[140:143], v[40:43], v[24:27], v[140:143]
v_mfma_f32_16x16x32_bf16 v[144:147], v[56:59], v[24:27], v[144:147]
s_waitcnt vmcnt(8)
v_mfma_f32_16x16x32_bf16 v[140:143], v[44:47], v[28:31], v[140:143]
v_mfma_f32_16x16x32_bf16 v[144:147], v[60:63], v[28:31], v[144:147]
v_max3_f32 v192, v128, v129, v130
v_max_f32 v192, v192, v131
s_cmp_lg_u32 s26, 0
s_nop 2
v_max3_f32 v193, v140, v141, v142
s_nop 1
v_max3_f32 v193, v193, v143, v144
v_max3_f32 v193, v193, v145, v146
v_max_f32 v193, v193, v147
s_cbranch_scc1 main_kernel_a_me
main_kernel_a_pp:
v_mov_b32 v204, 0
s_mov_b64 exec, 0xff
buffer_atomic_add v204, v203, s[4:7], s19 offen sc0 sc1
s_mov_b64 exec, -1
s_sub_u32 s29, s29, 1
s_cbranch_scc1 main_kernel_end
s_waitcnt vmcnt(0)
v_cmp_eq_u32 vcc, -1, v204
s_cbranch_vccnz main_kernel_a_pp
main_kernel_a_mp:
buffer_load_dwordx4 v[96:99], v197, s[4:7], s18 offen offset:0 sc1
buffer_load_dwordx4 v[100:103], v197, s[4:7], s18 offen offset:512 sc1
buffer_load_dwordx4 v[104:107], v197, s[4:7], s18 offen offset:1024 sc1
buffer_load_dwordx4 v[108:111], v197, s[4:7], s18 offen offset:1536 sc1
buffer_load_dwordx2 v[112:113], v198, s[4:7], s19 offen offset:0 sc1
buffer_load_dwordx2 v[114:115], v198, s[4:7], s19 offen offset:256 sc1
buffer_load_dwordx2 v[116:117], v198, s[4:7], s19 offen offset:512 sc1
buffer_load_dwordx2 v[118:119], v198, s[4:7], s19 offen offset:768 sc1
buffer_load_dwordx2 v[120:121], v198, s[4:7], s19 offen offset:1024 sc1
buffer_load_dwordx2 v[122:123], v198, s[4:7], s19 offen offset:1280 sc1
buffer_load_dwordx2 v[124:125], v198, s[4:7], s19 offen offset:1536 sc1
buffer_load_dwordx2 v[126:127], v198, s[4:7], s19 offen offset:1792 sc1
main_kernel_a_me:
buffer_load_dword v205, v199, s[4:7], s21 offen sc1
s_add_u32 s31, s19, 0x20000
s_cmp_ge_u32 s23, 54
s_cselect_b32 s31, 0x7f000000, s31
s_cselect_b32 s26, 0, 1
v_mov_b32 v204, 0
s_mov_b64 exec, 0xff
buffer_atomic_add v204, v203, s[4:7], s31 offen sc0 sc1
s_mov_b64 exec, -1
s_waitcnt vmcnt(13)
v_mfma_f32_16x16x32_bf16 v[132:135], v[96:99], v[0:3], v[156:159]
v_mfma_f32_16x16x32_bf16 v[148:151], v[96:99], v[16:19], v[156:159]
v_max3_u32 v194, v96, v96, v97
v_max3_u32 v194, v194, v98, v99
s_waitcnt vmcnt(12)
v_mfma_f32_16x16x32_bf16 v[132:135], v[100:103], v[4:7], v[132:135]
v_mfma_f32_16x16x32_bf16 v[148:151], v[100:103], v[20:23], v[148:151]
v_max3_u32 v194, v194, v100, v101
v_max3_u32 v194, v194, v102, v103
s_waitcnt vmcnt(11)
v_mfma_f32_16x16x32_bf16 v[132:135], v[104:107], v[8:11], v[132:135]
v_mfma_f32_16x16x32_bf16 v[148:151], v[104:107], v[24:27], v[148:151]
v_max3_u32 v194, v194, v104, v105
v_max3_u32 v194, v194, v106, v107
s_waitcnt vmcnt(10)
v_mfma_f32_16x16x32_bf16 v[132:135], v[108:111], v[12:15], v[132:135]
v_mfma_f32_16x16x32_bf16 v[148:151], v[108:111], v[28:31], v[148:151]
v_max3_u32 v194, v194, v108, v109
v_max3_u32 v194, v194, v110, v111
s_waitcnt vmcnt(8)
v_max3_u32 v194, v194, v112, v113
v_max3_u32 v194, v194, v114, v115
s_waitcnt vmcnt(6)
v_max3_u32 v194, v194, v116, v117
v_max3_u32 v194, v194, v118, v119
s_waitcnt vmcnt(4)
v_max3_u32 v194, v194, v120, v121
v_max3_u32 v194, v194, v122, v123
s_waitcnt vmcnt(2)
v_max3_u32 v194, v194, v124, v125
v_max3_u32 v194, v194, v126, v127
v_cmp_eq_u32 vcc, -1, v194
s_cbranch_vccz main_kernel_a_mok
s_waitcnt vmcnt(0)
s_sub_u32 s29, s29, 1
s_cbranch_scc0 main_kernel_a_mp
s_branch main_kernel_end
main_kernel_a_mok:
v_mul_f32 v148, s24, v148
v_mul_f32 v149, s24, v149
v_mul_f32 v150, s24, v150
v_mul_f32 v151, s24, v151
v_max3_f32 v190, v193, v148, v149
v_max3_f32 v190, v190, v150, v151
v_mov_b32 v191, v190
v_mul_f32 v132, s24, v132
v_mul_f32 v133, s24, v133
v_mul_f32 v134, s24, v134
v_mul_f32 v135, s24, v135
v_max3_f32 v188, v192, v132, v133
v_max3_f32 v188, v188, v134, v135
v_mov_b32 v189, v188
s_add_u32 s18, s18, 0x20000
s_add_u32 s19, s19, 0x20000
v_permlane32_swap_b32 v190, v191
v_max_f32 v190, v190, v191
v_mov_b32 v191, v190
v_permlane32_swap_b32 v188, v189
v_max_f32 v188, v188, v189
v_mov_b32 v189, v188
v_permlane16_swap_b32 v190, v191
v_max_f32 v190, v190, v191
v_permlane16_swap_b32 v188, v189
v_max_f32 v188, v188, v189
v_sub_f32 v140, v140, v190
v_sub_f32 v141, v141, v190
v_sub_f32 v142, v142, v190
v_sub_f32 v143, v143, v190
v_sub_f32 v144, v144, v190
v_sub_f32 v145, v145, v190
v_sub_f32 v146, v146, v190
v_sub_f32 v147, v147, v190
v_sub_f32 v148, v148, v190
v_sub_f32 v149, v149, v190
v_sub_f32 v150, v150, v190
v_sub_f32 v151, v151, v190
v_exp_f32 v140, v140
v_exp_f32 v141, v141
v_exp_f32 v142, v142
v_exp_f32 v143, v143
v_cvt_pk_bf16_f32 v168, v140, v141
v_exp_f32 v144, v144
v_exp_f32 v145, v145
v_cvt_pk_bf16_f32 v169, v142, v143
v_exp_f32 v146, v146
v_exp_f32 v147, v147
v_cvt_pk_bf16_f32 v170, v144, v145
v_exp_f32 v148, v148
v_exp_f32 v149, v149
v_cvt_pk_bf16_f32 v171, v146, v147
v_exp_f32 v150, v150
v_exp_f32 v151, v151
v_cvt_pk_bf16_f32 v172, v148, v149
s_nop 0
v_cvt_pk_bf16_f32 v173, v150, v151
s_add_u32 s31, s20, 131072
s_nop 0
v_mfma_f32_16x16x32_bf16 v[180:183], v[184:187], v[168:171], 0
v_sub_f32 v128, v128, v188
v_sub_f32 v129, v129, v188
v_sub_f32 v130, v130, v188
v_mfma_f32_16x16x32_bf16 v[32:35], v[64:67], v[168:171], 0
v_sub_f32 v131, v131, v188
v_sub_f32 v132, v132, v188
v_sub_f32 v133, v133, v188
v_mfma_f32_16x16x16_bf16 v[180:183], v[184:185], v[172:173], v[180:183]
v_sub_f32 v134, v134, v188
v_sub_f32 v135, v135, v188
v_exp_f32 v128, v128
v_mfma_f32_16x16x32_bf16 v[36:39], v[68:71], v[168:171], 0
v_exp_f32 v129, v129
v_exp_f32 v130, v130
v_exp_f32 v131, v131
v_mfma_f32_16x16x32_bf16 v[40:43], v[72:75], v[168:171], 0
v_cvt_pk_bf16_f32 v160, v128, v129
v_exp_f32 v132, v132
v_exp_f32 v133, v133
v_mfma_f32_16x16x32_bf16 v[44:47], v[76:79], v[168:171], 0
v_cvt_pk_bf16_f32 v161, v130, v131
v_exp_f32 v134, v134
v_exp_f32 v135, v135
v_mfma_f32_16x16x32_bf16 v[48:51], v[80:83], v[168:171], 0
v_cvt_pk_bf16_f32 v164, v132, v133
s_nop 0
v_cvt_pk_bf16_f32 v165, v134, v135
v_mfma_f32_16x16x32_bf16 v[52:55], v[84:87], v[168:171], 0
v_mfma_f32_16x16x32_bf16 v[56:59], v[88:91], v[168:171], 0
v_mfma_f32_16x16x32_bf16 v[60:63], v[92:95], v[168:171], 0
v_mfma_f32_16x16x16_bf16 v[32:35], v[112:113], v[172:173], v[32:35]
v_mfma_f32_16x16x16_bf16 v[36:39], v[114:115], v[172:173], v[36:39]
v_mfma_f32_16x16x16_bf16 v[40:43], v[116:117], v[172:173], v[40:43]
v_mfma_f32_16x16x16_bf16 v[44:47], v[118:119], v[172:173], v[44:47]
v_mfma_f32_16x16x16_bf16 v[48:51], v[120:121], v[172:173], v[48:51]
v_mfma_f32_16x16x16_bf16 v[52:55], v[122:123], v[172:173], v[52:55]
v_mfma_f32_16x16x16_bf16 v[56:59], v[124:125], v[172:173], v[56:59]
v_mfma_f32_16x16x16_bf16 v[60:63], v[126:127], v[172:173], v[60:63]
v_mfma_f32_16x16x32_bf16 v[176:179], v[184:187], v[160:163], 0
v_rcp_f32 v190, v180
s_nop 0
v_mov_b32 v191, v190
v_mfma_f32_16x16x32_bf16 v[0:3], v[64:67], v[160:163], 0
v_pk_mul_f32 v[32:33], v[32:33], v[190:191]
v_pk_mul_f32 v[34:35], v[34:35], v[190:191]
v_pk_mul_f32 v[36:37], v[36:37], v[190:191]
v_mfma_f32_16x16x16_bf16 v[176:179], v[184:185], v[164:165], v[176:179]
v_pk_mul_f32 v[38:39], v[38:39], v[190:191]
v_cvt_pk_bf16_f32 v208, v32, v33
v_cvt_pk_bf16_f32 v209, v34, v35
v_mfma_f32_16x16x32_bf16 v[4:7], v[68:71], v[160:163], 0
v_cvt_pk_bf16_f32 v210, v36, v37
v_cvt_pk_bf16_f32 v211, v38, v39
buffer_store_dwordx4 v[208:211], v196, s[4:7], s31 offen offset:0 sc1
v_mfma_f32_16x16x32_bf16 v[8:11], v[72:75], v[160:163], 0
v_pk_mul_f32 v[40:41], v[40:41], v[190:191]
v_pk_mul_f32 v[42:43], v[42:43], v[190:191]
v_pk_mul_f32 v[44:45], v[44:45], v[190:191]
v_mfma_f32_16x16x32_bf16 v[12:15], v[76:79], v[160:163], 0
v_pk_mul_f32 v[46:47], v[46:47], v[190:191]
v_cvt_pk_bf16_f32 v212, v40, v41
v_cvt_pk_bf16_f32 v213, v42, v43
v_mfma_f32_16x16x32_bf16 v[16:19], v[80:83], v[160:163], 0
v_cvt_pk_bf16_f32 v214, v44, v45
v_cvt_pk_bf16_f32 v215, v46, v47
buffer_store_dwordx4 v[212:215], v196, s[4:7], s31 offen offset:1024 sc1
v_mfma_f32_16x16x32_bf16 v[20:23], v[84:87], v[160:163], 0
v_pk_mul_f32 v[48:49], v[48:49], v[190:191]
v_pk_mul_f32 v[50:51], v[50:51], v[190:191]
v_pk_mul_f32 v[52:53], v[52:53], v[190:191]
v_mfma_f32_16x16x32_bf16 v[24:27], v[88:91], v[160:163], 0
v_pk_mul_f32 v[54:55], v[54:55], v[190:191]
v_cvt_pk_bf16_f32 v216, v48, v49
v_cvt_pk_bf16_f32 v217, v50, v51
v_mfma_f32_16x16x32_bf16 v[28:31], v[92:95], v[160:163], 0
v_cvt_pk_bf16_f32 v218, v52, v53
v_cvt_pk_bf16_f32 v219, v54, v55
buffer_store_dwordx4 v[216:219], v196, s[4:7], s31 offen offset:2048 sc1
v_mfma_f32_16x16x16_bf16 v[0:3], v[112:113], v[164:165], v[0:3]
v_pk_mul_f32 v[56:57], v[56:57], v[190:191]
v_mfma_f32_16x16x16_bf16 v[4:7], v[114:115], v[164:165], v[4:7]
v_pk_mul_f32 v[58:59], v[58:59], v[190:191]
v_mfma_f32_16x16x16_bf16 v[8:11], v[116:117], v[164:165], v[8:11]
v_pk_mul_f32 v[60:61], v[60:61], v[190:191]
v_mfma_f32_16x16x16_bf16 v[12:15], v[118:119], v[164:165], v[12:15]
v_pk_mul_f32 v[62:63], v[62:63], v[190:191]
v_mfma_f32_16x16x16_bf16 v[16:19], v[120:121], v[164:165], v[16:19]
v_cvt_pk_bf16_f32 v220, v56, v57
v_mfma_f32_16x16x16_bf16 v[20:23], v[122:123], v[164:165], v[20:23]
v_cvt_pk_bf16_f32 v221, v58, v59
v_mfma_f32_16x16x16_bf16 v[24:27], v[124:125], v[164:165], v[24:27]
v_cvt_pk_bf16_f32 v222, v60, v61
v_mfma_f32_16x16x16_bf16 v[28:31], v[126:127], v[164:165], v[28:31]
v_cvt_pk_bf16_f32 v223, v62, v63
buffer_store_dwordx4 v[220:223], v196, s[4:7], s31 offen offset:3072 sc1
s_add_u32 s23, s23, 2
v_rcp_f32 v188, v176
s_nop 0
v_mov_b32 v189, v188
v_pk_mul_f32 v[0:1], v[0:1], v[188:189]
v_pk_mul_f32 v[2:3], v[2:3], v[188:189]
v_pk_mul_f32 v[4:5], v[4:5], v[188:189]
v_pk_mul_f32 v[6:7], v[6:7], v[188:189]
v_cvt_pk_bf16_f32 v224, v0, v1
v_cvt_pk_bf16_f32 v225, v2, v3
v_cvt_pk_bf16_f32 v226, v4, v5
v_cvt_pk_bf16_f32 v227, v6, v7
buffer_store_dwordx4 v[224:227], v196, s[4:7], s20 offen offset:0 sc1
v_pk_mul_f32 v[8:9], v[8:9], v[188:189]
v_pk_mul_f32 v[10:11], v[10:11], v[188:189]
v_pk_mul_f32 v[12:13], v[12:13], v[188:189]
v_pk_mul_f32 v[14:15], v[14:15], v[188:189]
v_cvt_pk_bf16_f32 v228, v8, v9
v_cvt_pk_bf16_f32 v229, v10, v11
v_cvt_pk_bf16_f32 v230, v12, v13
v_cvt_pk_bf16_f32 v231, v14, v15
buffer_store_dwordx4 v[228:231], v196, s[4:7], s20 offen offset:1024 sc1
v_pk_mul_f32 v[16:17], v[16:17], v[188:189]
v_pk_mul_f32 v[18:19], v[18:19], v[188:189]
v_pk_mul_f32 v[20:21], v[20:21], v[188:189]
v_pk_mul_f32 v[22:23], v[22:23], v[188:189]
v_cvt_pk_bf16_f32 v232, v16, v17
v_cvt_pk_bf16_f32 v233, v18, v19
v_cvt_pk_bf16_f32 v234, v20, v21
v_cvt_pk_bf16_f32 v235, v22, v23
buffer_store_dwordx4 v[232:235], v196, s[4:7], s20 offen offset:2048 sc1
v_pk_mul_f32 v[24:25], v[24:25], v[188:189]
v_pk_mul_f32 v[26:27], v[26:27], v[188:189]
v_pk_mul_f32 v[28:29], v[28:29], v[188:189]
v_pk_mul_f32 v[30:31], v[30:31], v[188:189]
v_cvt_pk_bf16_f32 v236, v24, v25
v_cvt_pk_bf16_f32 v237, v26, v27
v_cvt_pk_bf16_f32 v238, v28, v29
v_cvt_pk_bf16_f32 v239, v30, v31
buffer_store_dwordx4 v[236:239], v196, s[4:7], s20 offen offset:3072 sc1
s_add_u32 s20, s20, 524288
s_cmp_ge_u32 s23, 60
s_cbranch_scc1 main_kernel_a_slow
s_waitcnt vmcnt(8)
v_cmp_eq_u32 vcc, 0, v205
s_cbranch_vccnz main_kernel_a_slow
v_cmp_eq_u32 vcc, -1, v204
buffer_load_dwordx4 v[32:35], v196, s[4:7], s16 offen offset:0 sc1
buffer_load_dwordx4 v[36:39], v196, s[4:7], s16 offen offset:1024 sc1
buffer_load_dwordx4 v[40:43], v196, s[4:7], s16 offen offset:2048 sc1
buffer_load_dwordx4 v[44:47], v196, s[4:7], s16 offen offset:3072 sc1
s_add_u32 s16, s16, 131072
buffer_load_dwordx4 v[48:51], v196, s[4:7], s16 offen offset:0 sc1
buffer_load_dwordx4 v[52:55], v196, s[4:7], s16 offen offset:1024 sc1
buffer_load_dwordx4 v[56:59], v196, s[4:7], s16 offen offset:2048 sc1
buffer_load_dwordx4 v[60:63], v196, s[4:7], s16 offen offset:3072 sc1
s_add_u32 s16, s16, 393216
buffer_load_dwordx4 v[0:3], v196, s[4:7], s15 offen offset:0 sc1
buffer_load_dwordx4 v[4:7], v196, s[4:7], s15 offen offset:1024 sc1
buffer_load_dwordx4 v[8:11], v196, s[4:7], s15 offen offset:2048 sc1
buffer_load_dwordx4 v[12:15], v196, s[4:7], s15 offen offset:3072 sc1
s_add_u32 s15, s15, 131072
buffer_load_dwordx4 v[16:19], v196, s[4:7], s15 offen offset:0 sc1
buffer_load_dwordx4 v[20:23], v196, s[4:7], s15 offen offset:1024 sc1
buffer_load_dwordx4 v[24:27], v196, s[4:7], s15 offen offset:2048 sc1
buffer_load_dwordx4 v[28:31], v196, s[4:7], s15 offen offset:3072 sc1
s_add_u32 s15, s15, 393216
buffer_load_dwordx4 v[64:67], v196, s[4:7], s17 offen offset:0 sc1
buffer_load_dwordx4 v[68:71], v196, s[4:7], s17 offen offset:1024 sc1
buffer_load_dwordx4 v[72:75], v196, s[4:7], s17 offen offset:2048 sc1
buffer_load_dwordx4 v[76:79], v196, s[4:7], s17 offen offset:3072 sc1
s_add_u32 s17, s17, 4096
buffer_load_dwordx4 v[80:83], v196, s[4:7], s17 offen offset:0 sc1
buffer_load_dwordx4 v[84:87], v196, s[4:7], s17 offen offset:1024 sc1
buffer_load_dwordx4 v[88:91], v196, s[4:7], s17 offen offset:2048 sc1
buffer_load_dwordx4 v[92:95], v196, s[4:7], s17 offen offset:3072 sc1
s_add_u32 s17, s17, 520192
s_cmp_eq_u64 vcc, 0
s_cselect_b32 s26, s26, 0
s_cmp_eq_u32 s26, 0
s_cbranch_scc1 main_kernel_a_nm
buffer_load_dwordx4 v[96:99], v197, s[4:7], s18 offen offset:0 sc1
buffer_load_dwordx4 v[100:103], v197, s[4:7], s18 offen offset:512 sc1
buffer_load_dwordx4 v[104:107], v197, s[4:7], s18 offen offset:1024 sc1
buffer_load_dwordx4 v[108:111], v197, s[4:7], s18 offen offset:1536 sc1
buffer_load_dwordx2 v[112:113], v198, s[4:7], s19 offen offset:0 sc1
buffer_load_dwordx2 v[114:115], v198, s[4:7], s19 offen offset:256 sc1
buffer_load_dwordx2 v[116:117], v198, s[4:7], s19 offen offset:512 sc1
buffer_load_dwordx2 v[118:119], v198, s[4:7], s19 offen offset:768 sc1
buffer_load_dwordx2 v[120:121], v198, s[4:7], s19 offen offset:1024 sc1
buffer_load_dwordx2 v[122:123], v198, s[4:7], s19 offen offset:1280 sc1
buffer_load_dwordx2 v[124:125], v198, s[4:7], s19 offen offset:1536 sc1
buffer_load_dwordx2 v[126:127], v198, s[4:7], s19 offen offset:1792 sc1
s_waitcnt vmcnt(36)
s_mov_b64 exec, 1
buffer_store_dwordx2 v[200:201], v202, s[4:7], s22 offen sc1
s_mov_b64 exec, -1
s_add_u32 s22, s22, 512
s_branch main_kernel_a_top
main_kernel_a_nm:
s_waitcnt vmcnt(24)
s_mov_b64 exec, 1
buffer_store_dwordx2 v[200:201], v202, s[4:7], s22 offen sc1
s_mov_b64 exec, -1
s_add_u32 s22, s22, 512
s_branch main_kernel_a_top
main_kernel_a_slow:
s_waitcnt vmcnt(0)
s_mov_b64 exec, 1
buffer_store_dwordx2 v[200:201], v202, s[4:7], s22 offen sc1
s_mov_b64 exec, -1
s_add_u32 s22, s22, 512
s_cmp_lt_u32 s23, 64
s_cbranch_scc1 main_kernel_a_fp
s_branch main_kernel_end
main_kernel_wo:
s_mov_b32 s8, s46
s_and_b32 s9, s47, 0xffff
s_mov_b32 s10, 0x800000
s_mov_b32 s11, 0x20000
v_lshlrev_b32 v170, 4, v250
s_lshr_b32 s23, s12, 2
s_sub_u32 s21, s12, 5
s_cselect_b32 s23, s23, s21
s_cselect_b32 s18, 40, 63
v_lshrrev_b32 v178, 2, v250
v_and_b32 v179, 3, v250
v_lshlrev_b32 v0, 11, v178
v_lshl_add_u32 v0, v179, 4, v0
s_lshl_b32 s19, s14, 15
v_lshl_add_u32 v1, v178, 6, s19
v_lshl_add_u32 v1, v179, 3, v1
s_lshl_b32 s20, s14, 21
s_lshl_b32 s21, s13, 6
s_add_u32 s20, s20, s21
s_add_u32 s21, s20, 0x0
s_add_u32 m0, s19, 0
s_nop 0
buffer_load_dwordx4 v0, s[8:11], s21 offen lds
s_add_u32 s21, s20, 0x8000
s_add_u32 m0, s19, 1024
s_nop 0
buffer_load_dwordx4 v0, s[8:11], s21 offen lds
s_add_u32 s21, s20, 0x10000
s_add_u32 m0, s19, 2048
s_nop 0
buffer_load_dwordx4 v0, s[8:11], s21 offen lds
s_add_u32 s21, s20, 0x18000
s_add_u32 m0, s19, 3072
s_nop 0
buffer_load_dwordx4 v0, s[8:11], s21 offen lds
s_add_u32 s21, s20, 0x20000
s_add_u32 m0, s19, 4096
s_nop 0
buffer_load_dwordx4 v0, s[8:11], s21 offen lds
s_add_u32 s21, s20, 0x28000
s_add_u32 m0, s19, 5120
s_nop 0
buffer_load_dwordx4 v0, s[8:11], s21 offen lds
s_add_u32 s21, s20, 0x30000
s_add_u32 m0, s19, 6144
s_nop 0
buffer_load_dwordx4 v0, s[8:11], s21 offen lds
s_add_u32 s21, s20, 0x38000
s_add_u32 m0, s19, 7168
s_nop 0
buffer_load_dwordx4 v0, s[8:11], s21 offen lds
s_add_u32 s21, s20, 0x40000
s_add_u32 m0, s19, 8192
s_nop 0
buffer_load_dwordx4 v0, s[8:11], s21 offen lds
s_add_u32 s21, s20, 0x48000
s_add_u32 m0, s19, 9216
s_nop 0
buffer_load_dwordx4 v0, s[8:11], s21 offen lds
s_add_u32 s21, s20, 0x50000
s_add_u32 m0, s19, 10240
s_nop 0
buffer_load_dwordx4 v0, s[8:11], s21 offen lds
s_add_u32 s21, s20, 0x58000
s_add_u32 m0, s19, 11264
s_nop 0
buffer_load_dwordx4 v0, s[8:11], s21 offen lds
s_add_u32 s21, s20, 0x60000
s_add_u32 m0, s19, 12288
s_nop 0
buffer_load_dwordx4 v0, s[8:11], s21 offen lds
s_add_u32 s21, s20, 0x68000
s_add_u32 m0, s19, 13312
s_nop 0
buffer_load_dwordx4 v0, s[8:11], s21 offen lds
s_add_u32 s21, s20, 0x70000
s_add_u32 m0, s19, 14336
s_nop 0
buffer_load_dwordx4 v0, s[8:11], s21 offen lds
s_add_u32 s21, s20, 0x78000
s_add_u32 m0, s19, 15360
s_nop 0
buffer_load_dwordx4 v0, s[8:11], s21 offen lds
s_add_u32 s21, s20, 0x80000
s_add_u32 m0, s19, 16384
s_nop 0
buffer_load_dwordx4 v0, s[8:11], s21 offen lds
s_add_u32 s21, s20, 0x88000
s_add_u32 m0, s19, 17408
s_nop 0
buffer_load_dwordx4 v0, s[8:11], s21 offen lds
s_add_u32 s21, s20, 0x90000
s_add_u32 m0, s19, 18432
s_nop 0
buffer_load_dwordx4 v0, s[8:11], s21 offen lds
s_add_u32 s21, s20, 0x98000
s_add_u32 m0, s19, 19456
s_nop 0
buffer_load_dwordx4 v0, s[8:11], s21 offen lds
s_add_u32 s21, s20, 0xa0000
s_add_u32 m0, s19, 20480
s_nop 0
buffer_load_dwordx4 v0, s[8:11], s21 offen lds
s_add_u32 s21, s20, 0xa8000
s_add_u32 m0, s19, 21504
s_nop 0
buffer_load_dwordx4 v0, s[8:11], s21 offen lds
s_add_u32 s21, s20, 0xb0000
s_add_u32 m0, s19, 22528
s_nop 0
buffer_load_dwordx4 v0, s[8:11], s21 offen lds
s_add_u32 s21, s20, 0xb8000
s_add_u32 m0, s19, 23552
s_nop 0
buffer_load_dwordx4 v0, s[8:11], s21 offen lds
s_add_u32 s21, s20, 0xc0000
s_add_u32 m0, s19, 24576
s_nop 0
buffer_load_dwordx4 v0, s[8:11], s21 offen lds
s_add_u32 s21, s20, 0xc8000
s_add_u32 m0, s19, 25600
s_nop 0
buffer_load_dwordx4 v0, s[8:11], s21 offen lds
s_add_u32 s21, s20, 0xd0000
s_add_u32 m0, s19, 26624
s_nop 0
buffer_load_dwordx4 v0, s[8:11], s21 offen lds
s_add_u32 s21, s20, 0xd8000
s_add_u32 m0, s19, 27648
s_nop 0
buffer_load_dwordx4 v0, s[8:11], s21 offen lds
s_add_u32 s21, s20, 0xe0000
s_add_u32 m0, s19, 28672
s_nop 0
buffer_load_dwordx4 v0, s[8:11], s21 offen lds
s_add_u32 s21, s20, 0xe8000
s_add_u32 m0, s19, 29696
s_nop 0
buffer_load_dwordx4 v0, s[8:11], s21 offen lds
s_add_u32 s21, s20, 0xf0000
s_add_u32 m0, s19, 30720
s_nop 0
buffer_load_dwordx4 v0, s[8:11], s21 offen lds
s_add_u32 s21, s20, 0xf8000
s_add_u32 m0, s19, 31744
s_nop 0
buffer_load_dwordx4 v0, s[8:11], s21 offen lds
v_and_b32 v178, 15, v250
v_lshrrev_b32 v179, 4, v250
v_lshlrev_b32 v175, 11, v178
v_lshl_add_u32 v175, v179, 3, v175
s_lshl_b32 s21, s14, 11
s_add_u32 s21, s21, 131072
v_add_u32 v176, s21, v170
s_lshl_b32 s21, s14, 10
s_add_u32 s21, s21, 131072
v_add_u32 v177, s21, v170
s_lshr_b32 s21, s13, 2
s_lshl_b32 s21, s21, 2
s_add_u32 s21, s21, 0x8412000
s_lshl_b32 s22, s18, 7
s_add_u32 s21, s22, s21
v_mov_b32 v172, s21
v_mov_b32 v173, 128
s_lshl_b32 s21, s14, 4
s_add_u32 s21, s21, s23
s_lshl_b32 s21, s21, 2
s_add_u32 s21, s21, 0x8400000
s_lshl_b32 s22, s18, 8
s_add_u32 s21, s21, s22
s_mov_b64 exec, 0xff
v_lshl_add_u32 v172, v250, 3, s21
v_mov_b32 v173, 0x100
s_mov_b64 exec, -1
s_lshl_b32 s15, s14, 15
s_lshl_b32 s21, s23, 17
s_add_u32 s15, s15, s21
s_add_u32 s15, s15, 0x3800000
s_lshl_b32 s21, s18, 18
s_add_u32 s15, s15, s21
s_lshl_b32 s21, s23, 15
s_lshl_b32 s22, s18, 16
s_add_u32 s21, s21, s22
s_and_b32 s22, s14, 1
s_lshl_b32 s16, s13, 1
s_add_u32 s16, s16, s22
s_lshl_b32 s16, s16, 5
s_add_u32 s16, s16, s21
s_lshl_b32 s17, s13, 7
s_add_u32 s17, s17, s22
s_lshl_b32 s17, s17, 3
s_add_u32 s17, s17, s21
s_add_u32 s17, s17, 0x6400000
s_waitcnt vmcnt(24)
ds_read_b64_tr_b16 a[0:1], v1 offset:0
ds_read_b64_tr_b16 a[2:3], v1 offset:1024
ds_read_b64_tr_b16 a[128:129], v1 offset:32
ds_read_b64_tr_b16 a[130:131], v1 offset:1056
ds_read_b64_tr_b16 a[4:5], v1 offset:2048
ds_read_b64_tr_b16 a[6:7], v1 offset:3072
ds_read_b64_tr_b16 a[132:133], v1 offset:2080
ds_read_b64_tr_b16 a[134:135], v1 offset:3104
ds_read_b64_tr_b16 a[8:9], v1 offset:4096
ds_read_b64_tr_b16 a[10:11], v1 offset:5120
ds_read_b64_tr_b16 a[136:137], v1 offset:4128
ds_read_b64_tr_b16 a[138:139], v1 offset:5152
ds_read_b64_tr_b16 a[12:13], v1 offset:6144
ds_read_b64_tr_b16 a[14:15], v1 offset:7168
ds_read_b64_tr_b16 a[140:141], v1 offset:6176
ds_read_b64_tr_b16 a[142:143], v1 offset:7200
s_waitcnt lgkmcnt(0)
s_add_u32 s21, s20, 0x100000
s_add_u32 m0, s19, 0
s_nop 0
buffer_load_dwordx4 v0, s[8:11], s21 offen lds
s_add_u32 s21, s20, 0x108000
s_add_u32 m0, s19, 1024
s_nop 0
buffer_load_dwordx4 v0, s[8:11], s21 offen lds
s_add_u32 s21, s20, 0x110000
s_add_u32 m0, s19, 2048
s_nop 0
buffer_load_dwordx4 v0, s[8:11], s21 offen lds
s_add_u32 s21, s20, 0x118000
s_add_u32 m0, s19, 3072
s_nop 0
buffer_load_dwordx4 v0, s[8:11], s21 offen lds
s_add_u32 s21, s20, 0x120000
s_add_u32 m0, s19, 4096
s_nop 0
buffer_load_dwordx4 v0, s[8:11], s21 offen lds
s_add_u32 s21, s20, 0x128000
s_add_u32 m0, s19, 5120
s_nop 0
buffer_load_dwordx4 v0, s[8:11], s21 offen lds
s_add_u32 s21, s20, 0x130000
s_add_u32 m0, s19, 6144
s_nop 0
buffer_load_dwordx4 v0, s[8:11], s21 offen lds
s_add_u32 s21, s20, 0x138000
s_add_u32 m0, s19, 7168
s_nop 0
buffer_load_dwordx4 v0, s[8:11], s21 offen lds
s_waitcnt vmcnt(24)
ds_read_b64_tr_b16 a[16:17], v1 offset:8192
ds_read_b64_tr_b16 a[18:19], v1 offset:9216
ds_read_b64_tr_b16 a[144:145], v1 offset:8224
ds_read_b64_tr_b16 a[146:147], v1 offset:9248
ds_read_b64_tr_b16 a[20:21], v1 offset:10240
ds_read_b64_tr_b16 a[22:23], v1 offset:11264
ds_read_b64_tr_b16 a[148:149], v1 offset:10272
ds_read_b64_tr_b16 a[150:151], v1 offset:11296
ds_read_b64_tr_b16 a[24:25], v1 offset:12288
ds_read_b64_tr_b16 a[26:27], v1 offset:13312
ds_read_b64_tr_b16 a[152:153], v1 offset:12320
ds_read_b64_tr_b16 a[154:155], v1 offset:13344
ds_read_b64_tr_b16 a[28:29], v1 offset:14336
ds_read_b64_tr_b16 a[30:31], v1 offset:15360
ds_read_b64_tr_b16 a[156:157], v1 offset:14368
ds_read_b64_tr_b16 a[158:159], v1 offset:15392
s_waitcnt lgkmcnt(0)
s_add_u32 s21, s20, 0x140000
s_add_u32 m0, s19, 8192
s_nop 0
buffer_load_dwordx4 v0, s[8:11], s21 offen lds
s_add_u32 s21, s20, 0x148000
s_add_u32 m0, s19, 9216
s_nop 0
buffer_load_dwordx4 v0, s[8:11], s21 offen lds
s_add_u32 s21, s20, 0x150000
s_add_u32 m0, s19, 10240
s_nop 0
buffer_load_dwordx4 v0, s[8:11], s21 offen lds
s_add_u32 s21, s20, 0x158000
s_add_u32 m0, s19, 11264
s_nop 0
buffer_load_dwordx4 v0, s[8:11], s21 offen lds
s_add_u32 s21, s20, 0x160000
s_add_u32 m0, s19, 12288
s_nop 0
buffer_load_dwordx4 v0, s[8:11], s21 offen lds
s_add_u32 s21, s20, 0x168000
s_add_u32 m0, s19, 13312
s_nop 0
buffer_load_dwordx4 v0, s[8:11], s21 offen lds
s_add_u32 s21, s20, 0x170000
s_add_u32 m0, s19, 14336
s_nop 0
buffer_load_dwordx4 v0, s[8:11], s21 offen lds
s_add_u32 s21, s20, 0x178000
s_add_u32 m0, s19, 15360
s_nop 0
buffer_load_dwordx4 v0, s[8:11], s21 offen lds
s_waitcnt vmcnt(24)
ds_read_b64_tr_b16 a[32:33], v1 offset:16384
ds_read_b64_tr_b16 a[34:35], v1 offset:17408
ds_read_b64_tr_b16 a[160:161], v1 offset:16416
ds_read_b64_tr_b16 a[162:163], v1 offset:17440
ds_read_b64_tr_b16 a[36:37], v1 offset:18432
ds_read_b64_tr_b16 a[38:39], v1 offset:19456
ds_read_b64_tr_b16 a[164:165], v1 offset:18464
ds_read_b64_tr_b16 a[166:167], v1 offset:19488
ds_read_b64_tr_b16 a[40:41], v1 offset:20480
ds_read_b64_tr_b16 a[42:43], v1 offset:21504
ds_read_b64_tr_b16 a[168:169], v1 offset:20512
ds_read_b64_tr_b16 a[170:171], v1 offset:21536
ds_read_b64_tr_b16 a[44:45], v1 offset:22528
ds_read_b64_tr_b16 a[46:47], v1 offset:23552
ds_read_b64_tr_b16 a[172:173], v1 offset:22560
ds_read_b64_tr_b16 a[174:175], v1 offset:23584
s_waitcnt lgkmcnt(0)
s_add_u32 s21, s20, 0x180000
s_add_u32 m0, s19, 16384
s_nop 0
buffer_load_dwordx4 v0, s[8:11], s21 offen lds
s_add_u32 s21, s20, 0x188000
s_add_u32 m0, s19, 17408
s_nop 0
buffer_load_dwordx4 v0, s[8:11], s21 offen lds
s_add_u32 s21, s20, 0x190000
s_add_u32 m0, s19, 18432
s_nop 0
buffer_load_dwordx4 v0, s[8:11], s21 offen lds
s_add_u32 s21, s20, 0x198000
s_add_u32 m0, s19, 19456
s_nop 0
buffer_load_dwordx4 v0, s[8:11], s21 offen lds
s_add_u32 s21, s20, 0x1a0000
s_add_u32 m0, s19, 20480
s_nop 0
buffer_load_dwordx4 v0, s[8:11], s21 offen lds
s_add_u32 s21, s20, 0x1a8000
s_add_u32 m0, s19, 21504
s_nop 0
buffer_load_dwordx4 v0, s[8:11], s21 offen lds
s_add_u32 s21, s20, 0x1b0000
s_add_u32 m0, s19, 22528
s_nop 0
buffer_load_dwordx4 v0, s[8:11], s21 offen lds
s_add_u32 s21, s20, 0x1b8000
s_add_u32 m0, s19, 23552
s_nop 0
buffer_load_dwordx4 v0, s[8:11], s21 offen lds
s_waitcnt vmcnt(24)
ds_read_b64_tr_b16 a[48:49], v1 offset:24576
ds_read_b64_tr_b16 a[50:51], v1 offset:25600
ds_read_b64_tr_b16 a[176:177], v1 offset:24608
ds_read_b64_tr_b16 a[178:179], v1 offset:25632
ds_read_b64_tr_b16 a[52:53], v1 offset:26624
ds_read_b64_tr_b16 a[54:55], v1 offset:27648
ds_read_b64_tr_b16 a[180:181], v1 offset:26656
ds_read_b64_tr_b16 a[182:183], v1 offset:27680
ds_read_b64_tr_b16 a[56:57], v1 offset:28672
ds_read_b64_tr_b16 a[58:59], v1 offset:29696
ds_read_b64_tr_b16 a[184:185], v1 offset:28704
ds_read_b64_tr_b16 a[186:187], v1 offset:29728
ds_read_b64_tr_b16 a[60:61], v1 offset:30720
ds_read_b64_tr_b16 a[62:63], v1 offset:31744
ds_read_b64_tr_b16 a[188:189], v1 offset:30752
ds_read_b64_tr_b16 a[190:191], v1 offset:31776
s_waitcnt lgkmcnt(0)
s_add_u32 s21, s20, 0x1c0000
s_add_u32 m0, s19, 24576
s_nop 0
buffer_load_dwordx4 v0, s[8:11], s21 offen lds
s_add_u32 s21, s20, 0x1c8000
s_add_u32 m0, s19, 25600
s_nop 0
buffer_load_dwordx4 v0, s[8:11], s21 offen lds
s_add_u32 s21, s20, 0x1d0000
s_add_u32 m0, s19, 26624
s_nop 0
buffer_load_dwordx4 v0, s[8:11], s21 offen lds
s_add_u32 s21, s20, 0x1d8000
s_add_u32 m0, s19, 27648
s_nop 0
buffer_load_dwordx4 v0, s[8:11], s21 offen lds
s_add_u32 s21, s20, 0x1e0000
s_add_u32 m0, s19, 28672
s_nop 0
buffer_load_dwordx4 v0, s[8:11], s21 offen lds
s_add_u32 s21, s20, 0x1e8000
s_add_u32 m0, s19, 29696
s_nop 0
buffer_load_dwordx4 v0, s[8:11], s21 offen lds
s_add_u32 s21, s20, 0x1f0000
s_add_u32 m0, s19, 30720
s_nop 0
buffer_load_dwordx4 v0, s[8:11], s21 offen lds
s_add_u32 s21, s20, 0x1f8000
s_add_u32 m0, s19, 31744
s_nop 0
buffer_load_dwordx4 v0, s[8:11], s21 offen lds
s_waitcnt vmcnt(24)
ds_read_b64_tr_b16 a[64:65], v1 offset:0
ds_read_b64_tr_b16 a[66:67], v1 offset:1024
ds_read_b64_tr_b16 a[192:193], v1 offset:32
ds_read_b64_tr_b16 a[194:195], v1 offset:1056
ds_read_b64_tr_b16 a[68:69], v1 offset:2048
ds_read_b64_tr_b16 a[70:71], v1 offset:3072
ds_read_b64_tr_b16 a[196:197], v1 offset:2080
ds_read_b64_tr_b16 a[198:199], v1 offset:3104
ds_read_b64_tr_b16 a[72:73], v1 offset:4096
ds_read_b64_tr_b16 a[74:75], v1 offset:5120
ds_read_b64_tr_b16 a[200:201], v1 offset:4128
ds_read_b64_tr_b16 a[202:203], v1 offset:5152
ds_read_b64_tr_b16 a[76:77], v1 offset:6144
ds_read_b64_tr_b16 a[78:79], v1 offset:7168
ds_read_b64_tr_b16 a[204:205], v1 offset:6176
ds_read_b64_tr_b16 a[206:207], v1 offset:7200
s_waitcnt lgkmcnt(0)
s_waitcnt vmcnt(16)
ds_read_b64_tr_b16 a[80:81], v1 offset:8192
ds_read_b64_tr_b16 a[82:83], v1 offset:9216
ds_read_b64_tr_b16 a[208:209], v1 offset:8224
ds_read_b64_tr_b16 a[210:211], v1 offset:9248
ds_read_b64_tr_b16 a[84:85], v1 offset:10240
ds_read_b64_tr_b16 a[86:87], v1 offset:11264
ds_read_b64_tr_b16 a[212:213], v1 offset:10272
ds_read_b64_tr_b16 a[214:215], v1 offset:11296
ds_read_b64_tr_b16 a[88:89], v1 offset:12288
ds_read_b64_tr_b16 a[90:91], v1 offset:13312
ds_read_b64_tr_b16 a[216:217], v1 offset:12320
ds_read_b64_tr_b16 a[218:219], v1 offset:13344
ds_read_b64_tr_b16 a[92:93], v1 offset:14336
ds_read_b64_tr_b16 a[94:95], v1 offset:15360
ds_read_b64_tr_b16 a[220:221], v1 offset:14368
ds_read_b64_tr_b16 a[222:223], v1 offset:15392
s_waitcnt lgkmcnt(0)
s_waitcnt vmcnt(8)
ds_read_b64_tr_b16 a[96:97], v1 offset:16384
ds_read_b64_tr_b16 a[98:99], v1 offset:17408
ds_read_b64_tr_b16 a[224:225], v1 offset:16416
ds_read_b64_tr_b16 a[226:227], v1 offset:17440
ds_read_b64_tr_b16 a[100:101], v1 offset:18432
ds_read_b64_tr_b16 a[102:103], v1 offset:19456
ds_read_b64_tr_b16 a[228:229], v1 offset:18464
ds_read_b64_tr_b16 a[230:231], v1 offset:19488
ds_read_b64_tr_b16 a[104:105], v1 offset:20480
ds_read_b64_tr_b16 a[106:107], v1 offset:21504
ds_read_b64_tr_b16 a[232:233], v1 offset:20512
ds_read_b64_tr_b16 a[234:235], v1 offset:21536
ds_read_b64_tr_b16 a[108:109], v1 offset:22528
ds_read_b64_tr_b16 a[110:111], v1 offset:23552
ds_read_b64_tr_b16 a[236:237], v1 offset:22560
ds_read_b64_tr_b16 a[238:239], v1 offset:23584
s_waitcnt lgkmcnt(0)
s_waitcnt vmcnt(0)
ds_read_b64_tr_b16 a[112:113], v1 offset:24576
ds_read_b64_tr_b16 a[114:115], v1 offset:25600
ds_read_b64_tr_b16 a[240:241], v1 offset:24608
ds_read_b64_tr_b16 a[242:243], v1 offset:25632
ds_read_b64_tr_b16 a[116:117], v1 offset:26624
ds_read_b64_tr_b16 a[118:119], v1 offset:27648
ds_read_b64_tr_b16 a[244:245], v1 offset:26656
ds_read_b64_tr_b16 a[246:247], v1 offset:27680
ds_read_b64_tr_b16 a[120:121], v1 offset:28672
ds_read_b64_tr_b16 a[122:123], v1 offset:29696
ds_read_b64_tr_b16 a[248:249], v1 offset:28704
ds_read_b64_tr_b16 a[250:251], v1 offset:29728
ds_read_b64_tr_b16 a[124:125], v1 offset:30720
ds_read_b64_tr_b16 a[126:127], v1 offset:31744
ds_read_b64_tr_b16 a[252:253], v1 offset:30752
ds_read_b64_tr_b16 a[254:255], v1 offset:31776
s_waitcnt lgkmcnt(0)
s_cmp_lt_u32 s12, 5
s_cbranch_scc1 main_kernel_o_top
v_mul_u32_u24 v178, 2, v173
v_sub_u32 v171, v172, v178
main_kernel_o_gp:
buffer_load_dword v174, v171, s[4:7], 0 offen sc1
s_waitcnt vmcnt(0)
v_cmp_eq_u32 vcc, 0, v174
s_cbranch_vccz main_kernel_o_top
s_sleep 32
s_sub_u32 s29, s29, 1
s_cbranch_scc0 main_kernel_o_gp
s_branch main_kernel_end
main_kernel_o_top:
buffer_load_dword v174, v172, s[4:7], 0 offen sc1
s_waitcnt vmcnt(0)
v_cmp_eq_u32 vcc, 0, v174
s_cbranch_vccz main_kernel_o_go
s_sleep 1
s_sub_u32 s29, s29, 1
s_cbranch_scc0 main_kernel_o_top
s_branch main_kernel_end
main_kernel_o_go:
v_add_u32 v172, v172, v173
buffer_load_dword v174, v172, s[4:7], 0 offen sc1
buffer_load_dwordx4 v[0:3], v170, s[4:7], s15 offen offset:0 sc1
buffer_load_dwordx4 v[4:7], v170, s[4:7], s15 offen offset:1024 sc1
buffer_load_dwordx4 v[8:11], v170, s[4:7], s15 offen offset:2048 sc1
buffer_load_dwordx4 v[12:15], v170, s[4:7], s15 offen offset:3072 sc1
s_add_u32 s15, s15, 4096
buffer_load_dwordx4 v[16:19], v170, s[4:7], s15 offen offset:0 sc1
buffer_load_dwordx4 v[20:23], v170, s[4:7], s15 offen offset:1024 sc1
buffer_load_dwordx4 v[24:27], v170, s[4:7], s15 offen offset:2048 sc1
buffer_load_dwordx4 v[28:31], v170, s[4:7], s15 offen offset:3072 sc1
s_add_u32 s15, s15, 4096
buffer_load_dwordx4 v[32:35], v170, s[4:7], s15 offen offset:0 sc1
buffer_load_dwordx4 v[36:39], v170, s[4:7], s15 offen offset:1024 sc1
buffer_load_dwordx4 v[40:43], v170, s[4:7], s15 offen offset:2048 sc1
buffer_load_dwordx4 v[44:47], v170, s[4:7], s15 offen offset:3072 sc1
s_add_u32 s15, s15, 4096
buffer_load_dwordx4 v[48:51], v170, s[4:7], s15 offen offset:0 sc1
buffer_load_dwordx4 v[52:55], v170, s[4:7], s15 offen offset:1024 sc1
buffer_load_dwordx4 v[56:59], v170, s[4:7], s15 offen offset:2048 sc1
buffer_load_dwordx4 v[60:63], v170, s[4:7], s15 offen offset:3072 sc1
s_add_u32 s15, s15, 4096
buffer_load_dwordx4 v[64:67], v170, s[4:7], s15 offen offset:0 sc1
buffer_load_dwordx4 v[68:71], v170, s[4:7], s15 offen offset:1024 sc1
buffer_load_dwordx4 v[72:75], v170, s[4:7], s15 offen offset:2048 sc1
buffer_load_dwordx4 v[76:79], v170, s[4:7], s15 offen offset:3072 sc1
s_add_u32 s15, s15, 4096
buffer_load_dwordx4 v[80:83], v170, s[4:7], s15 offen offset:0 sc1
buffer_load_dwordx4 v[84:87], v170, s[4:7], s15 offen offset:1024 sc1
buffer_load_dwordx4 v[88:91], v170, s[4:7], s15 offen offset:2048 sc1
buffer_load_dwordx4 v[92:95], v170, s[4:7], s15 offen offset:3072 sc1
s_add_u32 s15, s15, 4096
buffer_load_dwordx4 v[96:99], v170, s[4:7], s15 offen offset:0 sc1
buffer_load_dwordx4 v[100:103], v170, s[4:7], s15 offen offset:1024 sc1
buffer_load_dwordx4 v[104:107], v170, s[4:7], s15 offen offset:2048 sc1
buffer_load_dwordx4 v[108:111], v170, s[4:7], s15 offen offset:3072 sc1
s_add_u32 s15, s15, 4096
buffer_load_dwordx4 v[112:115], v170, s[4:7], s15 offen offset:0 sc1
buffer_load_dwordx4 v[116:119], v170, s[4:7], s15 offen offset:1024 sc1
buffer_load_dwordx4 v[120:123], v170, s[4:7], s15 offen offset:2048 sc1
buffer_load_dwordx4 v[124:127], v170, s[4:7], s15 offen offset:3072 sc1
s_add_u32 s15, s15, 233472
buffer_load_dwordx2 v[180:181], v175, s[96:99], s16 offen
buffer_load_dwordx2 v[182:183], v170, s[4:7], s17 offen sc1
s_add_u32 s17, s17, 65536
main_kernel_o_body:
s_add_u32 s18, s18, 1
s_waitcnt vmcnt(34)
v_cmp_eq_u32 vcc, 0, v174
s_cmp_gt_u32 s18, 62
s_cbranch_scc1 main_kernel_o_b0
s_cbranch_vccnz main_kernel_o_b0
v_add_u32 v172, v172, v173
buffer_load_dword v174, v172, s[4:7], 0 offen sc1
s_add_u32 s21, s16, 65536
s_waitcnt vmcnt(34)
v_mfma_f32_16x16x32_bf16 v[128:131], a[0:3], v[0:3], 0
v_mfma_f32_16x16x32_bf16 v[132:135], a[128:131], v[0:3], 0
s_waitcnt vmcnt(33)
v_mfma_f32_16x16x32_bf16 v[128:131], a[4:7], v[4:7], v[128:131]
v_mfma_f32_16x16x32_bf16 v[132:135], a[132:135], v[4:7], v[132:135]
buffer_load_dwordx4 v[0:3], v170, s[4:7], s15 offen offset:0 sc1
s_waitcnt vmcnt(33)
v_mfma_f32_16x16x32_bf16 v[128:131], a[8:11], v[8:11], v[128:131]
v_mfma_f32_16x16x32_bf16 v[132:135], a[136:139], v[8:11], v[132:135]
buffer_load_dwordx4 v[4:7], v170, s[4:7], s15 offen offset:1024 sc1
s_waitcnt vmcnt(33)
v_mfma_f32_16x16x32_bf16 v[128:131], a[12:15], v[12:15], v[128:131]
v_mfma_f32_16x16x32_bf16 v[132:135], a[140:143], v[12:15], v[132:135]
buffer_load_dwordx4 v[8:11], v170, s[4:7], s15 offen offset:2048 sc1
s_waitcnt vmcnt(33)
v_mfma_f32_16x16x32_bf16 v[128:131], a[16:19], v[16:19], v[128:131]
v_mfma_f32_16x16x32_bf16 v[132:135], a[144:147], v[16:19], v[132:135]
buffer_load_dwordx4 v[12:15], v170, s[4:7], s15 offen offset:3072 sc1
s_add_u32 s15, s15, 4096
s_waitcnt vmcnt(33)
v_mfma_f32_16x16x32_bf16 v[128:131], a[20:23], v[20:23], v[128:131]
v_mfma_f32_16x16x32_bf16 v[132:135], a[148:151], v[20:23], v[132:135]
buffer_load_dwordx4 v[16:19], v170, s[4:7], s15 offen offset:0 sc1
s_waitcnt vmcnt(33)
v_mfma_f32_16x16x32_bf16 v[128:131], a[24:27], v[24:27], v[128:131]
v_mfma_f32_16x16x32_bf16 v[132:135], a[152:155], v[24:27], v[132:135]
buffer_load_dwordx4 v[20:23], v170, s[4:7], s15 offen offset:1024 sc1
s_waitcnt vmcnt(33)
v_mfma_f32_16x16x32_bf16 v[128:131], a[28:31], v[28:31], v[128:131]
v_mfma_f32_16x16x32_bf16 v[132:135], a[156:159], v[28:31], v[132:135]
buffer_load_dwordx4 v[24:27], v170, s[4:7], s15 offen offset:2048 sc1
s_waitcnt vmcnt(33)
v_mfma_f32_16x16x32_bf16 v[128:131], a[32:35], v[32:35], v[128:131]
v_mfma_f32_16x16x32_bf16 v[132:135], a[160:163], v[32:35], v[132:135]
buffer_load_dwordx4 v[28:31], v170, s[4:7], s15 offen offset:3072 sc1
s_add_u32 s15, s15, 4096
s_waitcnt vmcnt(33)
v_mfma_f32_16x16x32_bf16 v[128:131], a[36:39], v[36:39], v[128:131]
v_mfma_f32_16x16x32_bf16 v[132:135], a[164:167], v[36:39], v[132:135]
buffer_load_dwordx4 v[32:35], v170, s[4:7], s15 offen offset:0 sc1
s_waitcnt vmcnt(33)
v_mfma_f32_16x16x32_bf16 v[128:131], a[40:43], v[40:43], v[128:131]
v_mfma_f32_16x16x32_bf16 v[132:135], a[168:171], v[40:43], v[132:135]
buffer_load_dwordx4 v[36:39], v170, s[4:7], s15 offen offset:1024 sc1
s_waitcnt vmcnt(33)
v_mfma_f32_16x16x32_bf16 v[128:131], a[44:47], v[44:47], v[128:131]
v_mfma_f32_16x16x32_bf16 v[132:135], a[172:175], v[44:47], v[132:135]
buffer_load_dwordx4 v[40:43], v170, s[4:7], s15 offen offset:2048 sc1
s_waitcnt vmcnt(33)
v_mfma_f32_16x16x32_bf16 v[128:131], a[48:51], v[48:51], v[128:131]
v_mfma_f32_16x16x32_bf16 v[132:135], a[176:179], v[48:51], v[132:135]
buffer_load_dwordx4 v[44:47], v170, s[4:7], s15 offen offset:3072 sc1
s_add_u32 s15, s15, 4096
s_waitcnt vmcnt(33)
v_mfma_f32_16x16x32_bf16 v[128:131], a[52:55], v[52:55], v[128:131]
v_mfma_f32_16x16x32_bf16 v[132:135], a[180:183], v[52:55], v[132:135]
buffer_load_dwordx4 v[48:51], v170, s[4:7], s15 offen offset:0 sc1
s_waitcnt vmcnt(33)
v_mfma_f32_16x16x32_bf16 v[128:131], a[56:59], v[56:59], v[128:131]
v_mfma_f32_16x16x32_bf16 v[132:135], a[184:187], v[56:59], v[132:135]
buffer_load_dwordx4 v[52:55], v170, s[4:7], s15 offen offset:1024 sc1
s_waitcnt vmcnt(33)
v_mfma_f32_16x16x32_bf16 v[128:131], a[60:63], v[60:63], v[128:131]
v_mfma_f32_16x16x32_bf16 v[132:135], a[188:191], v[60:63], v[132:135]
buffer_load_dwordx4 v[56:59], v170, s[4:7], s15 offen offset:2048 sc1
s_waitcnt vmcnt(33)
v_mfma_f32_16x16x32_bf16 v[128:131], a[64:67], v[64:67], v[128:131]
v_mfma_f32_16x16x32_bf16 v[132:135], a[192:195], v[64:67], v[132:135]
buffer_load_dwordx4 v[60:63], v170, s[4:7], s15 offen offset:3072 sc1
s_add_u32 s15, s15, 4096
s_waitcnt vmcnt(33)
v_mfma_f32_16x16x32_bf16 v[128:131], a[68:71], v[68:71], v[128:131]
v_mfma_f32_16x16x32_bf16 v[132:135], a[196:199], v[68:71], v[132:135]
buffer_load_dwordx4 v[64:67], v170, s[4:7], s15 offen offset:0 sc1
s_waitcnt vmcnt(33)
v_mfma_f32_16x16x32_bf16 v[128:131], a[72:75], v[72:75], v[128:131]
v_mfma_f32_16x16x32_bf16 v[132:135], a[200:203], v[72:75], v[132:135]
buffer_load_dwordx4 v[68:71], v170, s[4:7], s15 offen offset:1024 sc1
s_waitcnt vmcnt(33)
v_mfma_f32_16x16x32_bf16 v[128:131], a[76:79], v[76:79], v[128:131]
v_mfma_f32_16x16x32_bf16 v[132:135], a[204:207], v[76:79], v[132:135]
buffer_load_dwordx4 v[72:75], v170, s[4:7], s15 offen offset:2048 sc1
s_waitcnt vmcnt(33)
v_mfma_f32_16x16x32_bf16 v[128:131], a[80:83], v[80:83], v[128:131]
v_mfma_f32_16x16x32_bf16 v[132:135], a[208:211], v[80:83], v[132:135]
buffer_load_dwordx4 v[76:79], v170, s[4:7], s15 offen offset:3072 sc1
s_add_u32 s15, s15, 4096
s_waitcnt vmcnt(33)
v_mfma_f32_16x16x32_bf16 v[128:131], a[84:87], v[84:87], v[128:131]
v_mfma_f32_16x16x32_bf16 v[132:135], a[212:215], v[84:87], v[132:135]
buffer_load_dwordx4 v[80:83], v170, s[4:7], s15 offen offset:0 sc1
s_waitcnt vmcnt(33)
v_mfma_f32_16x16x32_bf16 v[128:131], a[88:91], v[88:91], v[128:131]
v_mfma_f32_16x16x32_bf16 v[132:135], a[216:219], v[88:91], v[132:135]
buffer_load_dwordx4 v[84:87], v170, s[4:7], s15 offen offset:1024 sc1
s_waitcnt vmcnt(33)
v_mfma_f32_16x16x32_bf16 v[128:131], a[92:95], v[92:95], v[128:131]
v_mfma_f32_16x16x32_bf16 v[132:135], a[220:223], v[92:95], v[132:135]
buffer_load_dwordx4 v[88:91], v170, s[4:7], s15 offen offset:2048 sc1
s_waitcnt vmcnt(33)
v_mfma_f32_16x16x32_bf16 v[128:131], a[96:99], v[96:99], v[128:131]
v_mfma_f32_16x16x32_bf16 v[132:135], a[224:227], v[96:99], v[132:135]
buffer_load_dwordx4 v[92:95], v170, s[4:7], s15 offen offset:3072 sc1
s_add_u32 s15, s15, 4096
s_waitcnt vmcnt(33)
v_mfma_f32_16x16x32_bf16 v[128:131], a[100:103], v[100:103], v[128:131]
v_mfma_f32_16x16x32_bf16 v[132:135], a[228:231], v[100:103], v[132:135]
buffer_load_dwordx4 v[96:99], v170, s[4:7], s15 offen offset:0 sc1
s_waitcnt vmcnt(33)
v_mfma_f32_16x16x32_bf16 v[128:131], a[104:107], v[104:107], v[128:131]
v_mfma_f32_16x16x32_bf16 v[132:135], a[232:235], v[104:107], v[132:135]
buffer_load_dwordx4 v[100:103], v170, s[4:7], s15 offen offset:1024 sc1
s_waitcnt vmcnt(33)
v_mfma_f32_16x16x32_bf16 v[128:131], a[108:111], v[108:111], v[128:131]
v_mfma_f32_16x16x32_bf16 v[132:135], a[236:239], v[108:111], v[132:135]
buffer_load_dwordx4 v[104:107], v170, s[4:7], s15 offen offset:2048 sc1
s_waitcnt vmcnt(33)
v_mfma_f32_16x16x32_bf16 v[128:131], a[112:115], v[112:115], v[128:131]
v_mfma_f32_16x16x32_bf16 v[132:135], a[240:243], v[112:115], v[132:135]
buffer_load_dwordx4 v[108:111], v170, s[4:7], s15 offen offset:3072 sc1
s_add_u32 s15, s15, 4096
s_waitcnt vmcnt(33)
v_mfma_f32_16x16x32_bf16 v[128:131], a[116:119], v[116:119], v[128:131]
v_mfma_f32_16x16x32_bf16 v[132:135], a[244:247], v[116:119], v[132:135]
buffer_load_dwordx4 v[112:115], v170, s[4:7], s15 offen offset:0 sc1
s_waitcnt vmcnt(33)
v_mfma_f32_16x16x32_bf16 v[128:131], a[120:123], v[120:123], v[128:131]
v_mfma_f32_16x16x32_bf16 v[132:135], a[248:251], v[120:123], v[132:135]
buffer_load_dwordx4 v[116:119], v170, s[4:7], s15 offen offset:1024 sc1
s_waitcnt vmcnt(33)
v_mfma_f32_16x16x32_bf16 v[128:131], a[124:127], v[124:127], v[128:131]
v_mfma_f32_16x16x32_bf16 v[132:135], a[252:255], v[124:127], v[132:135]
buffer_load_dwordx4 v[120:123], v170, s[4:7], s15 offen offset:2048 sc1
s_waitcnt vmcnt(32)
v_lshlrev_b32 v164, 16, v180
v_and_b32 v165, 0xffff0000, v180
v_lshlrev_b32 v166, 16, v181
v_and_b32 v167, 0xffff0000, v181
v_lshlrev_b32 v160, 16, v182
v_and_b32 v161, 0xffff0000, v182
v_lshlrev_b32 v162, 16, v183
v_and_b32 v163, 0xffff0000, v183
buffer_load_dwordx4 v[124:127], v170, s[4:7], s15 offen offset:3072 sc1
s_add_u32 s15, s15, 233472
buffer_load_dwordx2 v[180:181], v175, s[96:99], s21 offen
buffer_load_dwordx2 v[182:183], v170, s[4:7], s17 offen sc1
s_add_u32 s17, s17, 65536
s_cmp_ge_u32 s14, 2
ds_write_b128 v176, v[128:131] offset:0
ds_write_b128 v176, v[132:135] offset:1024
v_xor_b32 v176, 0x4000, v176
s_waitcnt lgkmcnt(0)
s_barrier
s_cbranch_scc1 main_kernel_o_nx1
ds_read_b128 v[144:147], v177 offset:0
ds_read_b128 v[148:151], v177 offset:2048
ds_read_b128 v[152:155], v177 offset:4096
ds_read_b128 v[156:159], v177 offset:6144
v_xor_b32 v177, 0x4000, v177
s_waitcnt lgkmcnt(2)
v_pk_add_f32 v[144:145], v[144:145], v[148:149]
v_pk_add_f32 v[146:147], v[146:147], v[150:151]
s_waitcnt lgkmcnt(0)
v_pk_add_f32 v[152:153], v[152:153], v[156:157]
v_pk_add_f32 v[154:155], v[154:155], v[158:159]
v_pk_add_f32 v[144:145], v[144:145], v[152:153]
v_pk_add_f32 v[146:147], v[146:147], v[154:155]
v_pk_fma_f32 v[144:145], v[144:145], v[160:161], v[164:165]
v_pk_fma_f32 v[146:147], v[146:147], v[162:163], v[166:167]
v_cvt_pk_bf16_f32 v148, v144, v145
v_cvt_pk_bf16_f32 v149, v146, v147
buffer_store_dwordx2 v[148:149], v175, s[92:95], s16 offen
main_kernel_o_nx1:
s_add_u32 s16, s16, 65536
s_branch main_kernel_o_body
main_kernel_o_b0:
s_waitcnt vmcnt(33)
v_mfma_f32_16x16x32_bf16 v[128:131], a[0:3], v[0:3], 0
v_mfma_f32_16x16x32_bf16 v[132:135], a[128:131], v[0:3], 0
s_waitcnt vmcnt(32)
v_mfma_f32_16x16x32_bf16 v[128:131], a[4:7], v[4:7], v[128:131]
v_mfma_f32_16x16x32_bf16 v[132:135], a[132:135], v[4:7], v[132:135]
s_waitcnt vmcnt(31)
v_mfma_f32_16x16x32_bf16 v[128:131], a[8:11], v[8:11], v[128:131]
v_mfma_f32_16x16x32_bf16 v[132:135], a[136:139], v[8:11], v[132:135]
s_waitcnt vmcnt(30)
v_mfma_f32_16x16x32_bf16 v[128:131], a[12:15], v[12:15], v[128:131]
v_mfma_f32_16x16x32_bf16 v[132:135], a[140:143], v[12:15], v[132:135]
s_waitcnt vmcnt(29)
v_mfma_f32_16x16x32_bf16 v[128:131], a[16:19], v[16:19], v[128:131]
v_mfma_f32_16x16x32_bf16 v[132:135], a[144:147], v[16:19], v[132:135]
s_waitcnt vmcnt(28)
v_mfma_f32_16x16x32_bf16 v[128:131], a[20:23], v[20:23], v[128:131]
v_mfma_f32_16x16x32_bf16 v[132:135], a[148:151], v[20:23], v[132:135]
s_waitcnt vmcnt(27)
v_mfma_f32_16x16x32_bf16 v[128:131], a[24:27], v[24:27], v[128:131]
v_mfma_f32_16x16x32_bf16 v[132:135], a[152:155], v[24:27], v[132:135]
s_waitcnt vmcnt(26)
v_mfma_f32_16x16x32_bf16 v[128:131], a[28:31], v[28:31], v[128:131]
v_mfma_f32_16x16x32_bf16 v[132:135], a[156:159], v[28:31], v[132:135]
s_waitcnt vmcnt(25)
v_mfma_f32_16x16x32_bf16 v[128:131], a[32:35], v[32:35], v[128:131]
v_mfma_f32_16x16x32_bf16 v[132:135], a[160:163], v[32:35], v[132:135]
s_waitcnt vmcnt(24)
v_mfma_f32_16x16x32_bf16 v[128:131], a[36:39], v[36:39], v[128:131]
v_mfma_f32_16x16x32_bf16 v[132:135], a[164:167], v[36:39], v[132:135]
s_waitcnt vmcnt(23)
v_mfma_f32_16x16x32_bf16 v[128:131], a[40:43], v[40:43], v[128:131]
v_mfma_f32_16x16x32_bf16 v[132:135], a[168:171], v[40:43], v[132:135]
s_waitcnt vmcnt(22)
v_mfma_f32_16x16x32_bf16 v[128:131], a[44:47], v[44:47], v[128:131]
v_mfma_f32_16x16x32_bf16 v[132:135], a[172:175], v[44:47], v[132:135]
s_waitcnt vmcnt(21)
v_mfma_f32_16x16x32_bf16 v[128:131], a[48:51], v[48:51], v[128:131]
v_mfma_f32_16x16x32_bf16 v[132:135], a[176:179], v[48:51], v[132:135]
s_waitcnt vmcnt(20)
v_mfma_f32_16x16x32_bf16 v[128:131], a[52:55], v[52:55], v[128:131]
v_mfma_f32_16x16x32_bf16 v[132:135], a[180:183], v[52:55], v[132:135]
s_waitcnt vmcnt(19)
v_mfma_f32_16x16x32_bf16 v[128:131], a[56:59], v[56:59], v[128:131]
v_mfma_f32_16x16x32_bf16 v[132:135], a[184:187], v[56:59], v[132:135]
s_waitcnt vmcnt(18)
v_mfma_f32_16x16x32_bf16 v[128:131], a[60:63], v[60:63], v[128:131]
v_mfma_f32_16x16x32_bf16 v[132:135], a[188:191], v[60:63], v[132:135]
s_waitcnt vmcnt(17)
v_mfma_f32_16x16x32_bf16 v[128:131], a[64:67], v[64:67], v[128:131]
v_mfma_f32_16x16x32_bf16 v[132:135], a[192:195], v[64:67], v[132:135]
s_waitcnt vmcnt(16)
v_mfma_f32_16x16x32_bf16 v[128:131], a[68:71], v[68:71], v[128:131]
v_mfma_f32_16x16x32_bf16 v[132:135], a[196:199], v[68:71], v[132:135]
s_waitcnt vmcnt(15)
v_mfma_f32_16x16x32_bf16 v[128:131], a[72:75], v[72:75], v[128:131]
v_mfma_f32_16x16x32_bf16 v[132:135], a[200:203], v[72:75], v[132:135]
s_waitcnt vmcnt(14)
v_mfma_f32_16x16x32_bf16 v[128:131], a[76:79], v[76:79], v[128:131]
v_mfma_f32_16x16x32_bf16 v[132:135], a[204:207], v[76:79], v[132:135]
s_waitcnt vmcnt(13)
v_mfma_f32_16x16x32_bf16 v[128:131], a[80:83], v[80:83], v[128:131]
v_mfma_f32_16x16x32_bf16 v[132:135], a[208:211], v[80:83], v[132:135]
s_waitcnt vmcnt(12)
v_mfma_f32_16x16x32_bf16 v[128:131], a[84:87], v[84:87], v[128:131]
v_mfma_f32_16x16x32_bf16 v[132:135], a[212:215], v[84:87], v[132:135]
s_waitcnt vmcnt(11)
v_mfma_f32_16x16x32_bf16 v[128:131], a[88:91], v[88:91], v[128:131]
v_mfma_f32_16x16x32_bf16 v[132:135], a[216:219], v[88:91], v[132:135]
s_waitcnt vmcnt(10)
v_mfma_f32_16x16x32_bf16 v[128:131], a[92:95], v[92:95], v[128:131]
v_mfma_f32_16x16x32_bf16 v[132:135], a[220:223], v[92:95], v[132:135]
s_waitcnt vmcnt(9)
v_mfma_f32_16x16x32_bf16 v[128:131], a[96:99], v[96:99], v[128:131]
v_mfma_f32_16x16x32_bf16 v[132:135], a[224:227], v[96:99], v[132:135]
s_waitcnt vmcnt(8)
v_mfma_f32_16x16x32_bf16 v[128:131], a[100:103], v[100:103], v[128:131]
v_mfma_f32_16x16x32_bf16 v[132:135], a[228:231], v[100:103], v[132:135]
s_waitcnt vmcnt(7)
v_mfma_f32_16x16x32_bf16 v[128:131], a[104:107], v[104:107], v[128:131]
v_mfma_f32_16x16x32_bf16 v[132:135], a[232:235], v[104:107], v[132:135]
s_waitcnt vmcnt(6)
v_mfma_f32_16x16x32_bf16 v[128:131], a[108:111], v[108:111], v[128:131]
v_mfma_f32_16x16x32_bf16 v[132:135], a[236:239], v[108:111], v[132:135]
s_waitcnt vmcnt(5)
v_mfma_f32_16x16x32_bf16 v[128:131], a[112:115], v[112:115], v[128:131]
v_mfma_f32_16x16x32_bf16 v[132:135], a[240:243], v[112:115], v[132:135]
s_waitcnt vmcnt(4)
v_mfma_f32_16x16x32_bf16 v[128:131], a[116:119], v[116:119], v[128:131]
v_mfma_f32_16x16x32_bf16 v[132:135], a[244:247], v[116:119], v[132:135]
s_waitcnt vmcnt(3)
v_mfma_f32_16x16x32_bf16 v[128:131], a[120:123], v[120:123], v[128:131]
v_mfma_f32_16x16x32_bf16 v[132:135], a[248:251], v[120:123], v[132:135]
s_waitcnt vmcnt(2)
v_mfma_f32_16x16x32_bf16 v[128:131], a[124:127], v[124:127], v[128:131]
v_mfma_f32_16x16x32_bf16 v[132:135], a[252:255], v[124:127], v[132:135]
s_waitcnt vmcnt(0)
v_lshlrev_b32 v164, 16, v180
v_and_b32 v165, 0xffff0000, v180
v_lshlrev_b32 v166, 16, v181
v_and_b32 v167, 0xffff0000, v181
v_lshlrev_b32 v160, 16, v182
v_and_b32 v161, 0xffff0000, v182
v_lshlrev_b32 v162, 16, v183
v_and_b32 v163, 0xffff0000, v183
s_cmp_ge_u32 s14, 2
s_nop 0
ds_write_b128 v176, v[128:131] offset:0
ds_write_b128 v176, v[132:135] offset:1024
v_xor_b32 v176, 0x4000, v176
s_waitcnt lgkmcnt(0)
s_barrier
s_cbranch_scc1 main_kernel_o_nx0
ds_read_b128 v[144:147], v177 offset:0
ds_read_b128 v[148:151], v177 offset:2048
ds_read_b128 v[152:155], v177 offset:4096
ds_read_b128 v[156:159], v177 offset:6144
v_xor_b32 v177, 0x4000, v177
s_waitcnt lgkmcnt(2)
v_pk_add_f32 v[144:145], v[144:145], v[148:149]
v_pk_add_f32 v[146:147], v[146:147], v[150:151]
s_waitcnt lgkmcnt(0)
v_pk_add_f32 v[152:153], v[152:153], v[156:157]
v_pk_add_f32 v[154:155], v[154:155], v[158:159]
v_pk_add_f32 v[144:145], v[144:145], v[152:153]
v_pk_add_f32 v[146:147], v[146:147], v[154:155]
v_pk_fma_f32 v[144:145], v[144:145], v[160:161], v[164:165]
v_pk_fma_f32 v[146:147], v[146:147], v[162:163], v[166:167]
v_cvt_pk_bf16_f32 v148, v144, v145
v_cvt_pk_bf16_f32 v149, v146, v147
buffer_store_dwordx2 v[148:149], v175, s[92:95], s16 offen
main_kernel_o_nx0:
s_add_u32 s16, s16, 65536
s_cmp_le_u32 s18, 62
s_cbranch_scc1 main_kernel_o_top
v_add_u32 v172, v172, v173
s_add_u32 s17, s17, 65536
s_add_u32 s16, s16, 65536
s_add_u32 s15, s15, 262144
s_add_u32 s18, s18, 1
s_cmp_lt_u32 s18, 64
s_cbranch_scc1 main_kernel_o_top
s_branch main_kernel_end
main_kernel_end2:
s_endpgm
main_kernel_worker:
v_lshlrev_b32 v251, 4, v250
v_mov_b32 v240, 0xc0135761
v_mov_b32 v241, 0xc0135761
v_mov_b32 v242, 0xbdd2d3e8
v_mov_b32 v243, 0xbdd2d3e8
v_mov_b32 v244, 0x3f800000
v_mov_b32 v245, 0x3f800000
v_mov_b32 v246, 0xbfb8aa3b
v_mov_b32 v247, 0xbfb8aa3b
s_lshr_b32 s37, s14, 1
s_and_b32 s38, s14, 1
v_mov_b32 v252, 0
v_mov_b32 v224, 0
v_mov_b32 v225, 0
v_mov_b32 v226, 0
v_mov_b32 v227, 0
v_mov_b32 v228, 0
v_mov_b32 v229, 0
v_mov_b32 v230, 0
v_mov_b32 v231, 0
v_mov_b32 v232, 0
v_mov_b32 v233, 0
v_mov_b32 v234, 0
v_mov_b32 v235, 0
v_mov_b32 v249, 0
v_mov_b32 v248, 0
v_mov_b32 v128, 0
v_mov_b32 v129, 0
v_mov_b32 v130, 0
v_mov_b32 v131, 0
v_mov_b32 v132, 0
v_mov_b32 v133, 0
v_mov_b32 v134, 0
v_mov_b32 v135, 0
v_mov_b32 v136, 0
v_mov_b32 v137, 0
v_mov_b32 v138, 0
v_mov_b32 v139, 0
v_mov_b32 v140, 0
v_mov_b32 v141, 0
v_mov_b32 v142, 0
v_mov_b32 v143, 0
v_mov_b32 v144, 0
v_mov_b32 v145, 0
v_mov_b32 v146, 0
v_mov_b32 v147, 0
v_mov_b32 v148, 0
v_mov_b32 v149, 0
v_mov_b32 v150, 0
v_mov_b32 v151, 0
v_mov_b32 v152, 0
v_mov_b32 v153, 0
v_mov_b32 v154, 0
s_cmp_eq_u32 s14, 0
s_cselect_b64 s[100:101], -1, 0
s_mov_b32 s21, 0
s_mov_b32 s22, 0
s_mov_b32 s26, 0
s_mov_b32 s0, 0
s_mov_b32 s1, 0
s_mov_b32 s2, 0
s_mov_b32 s3, 0
s_mov_b32 s59, 0
s_mov_b32 s60, 0
s_mov_b32 s39, 0
s_mov_b32 s8, s40
s_and_b32 s9, s41, 0xffff
s_mov_b32 s10, 0x0
s_mov_b32 s11, 0x20000
s_cmp_lg_u32 s14, 0
s_cbranch_scc1 main_kernel_w_bar
main_kernel_w_selq:
s_lshl_b32 s32, s27, 8
s_add_u32 s32, s32, 0x841e000
s_mov_b64 exec, 1
v_mov_b32 v249, 1
buffer_atomic_add v249, off, s[4:7], s32 sc0 sc1
s_mov_b64 exec, -1
v_mov_b32 v230, 0x7fff
s_cmp_lg_u32 s27, 0
s_cbranch_scc1 main_kernel_w_q1
s_mov_b32 s32, 0x45800
v_writelane_b32 v230, s32, 0
s_mov_b32 s32, 0x6580e
v_writelane_b32 v230, s32, 1
s_mov_b32 s32, 0x4206901c
v_writelane_b32 v230, s32, 2
s_mov_b32 s32, 0x40069024
v_writelane_b32 v230, s32, 3
s_mov_b32 s32, 0x4908902c
v_writelane_b32 v230, s32, 4
s_mov_b32 s32, 0x810503c
v_writelane_b32 v230, s32, 5
s_mov_b32 s32, 0x4a08804c
v_writelane_b32 v230, s32, 6
s_mov_b32 s32, 0x4a10805c
v_writelane_b32 v230, s32, 7
s_mov_b32 s32, 0x4a10906c
v_writelane_b32 v230, s32, 8
s_mov_b32 s32, 0x4a18907c
v_writelane_b32 v230, s32, 9
s_mov_b32 s32, 0x4908808c
v_writelane_b32 v230, s32, 10
s_mov_b32 s32, 0x4910809c
v_writelane_b32 v230, s32, 11
s_mov_b32 s32, 0x4ac0b0ac
v_writelane_b32 v230, s32, 12
s_mov_b32 s32, 0x4ad0b0b8
v_writelane_b32 v230, s32, 13
s_mov_b32 s32, 0x81850c4
v_writelane_b32 v230, s32, 14
s_mov_b32 s32, 0x80838d4
v_writelane_b32 v230, s32, 15
s_mov_b32 s32, 0x80038e4
v_writelane_b32 v230, s32, 16
s_mov_b32 s32, 0x78f4
v_writelane_b32 v230, s32, 17
s_branch main_kernel_w_qe
main_kernel_w_q1:
s_cmp_lg_u32 s27, 1
s_cbranch_scc1 main_kernel_w_q2
s_mov_b32 s32, 0x25000
v_writelane_b32 v230, s32, 0
s_mov_b32 s32, 0x4045004
v_writelane_b32 v230, s32, 1
s_mov_b32 s32, 0x4b08900c
v_writelane_b32 v230, s32, 2
s_mov_b32 s32, 0x4b08881c
v_writelane_b32 v230, s32, 3
s_mov_b32 s32, 0x400202c
v_writelane_b32 v230, s32, 4
s_mov_b32 s32, 0x808283c
v_writelane_b32 v230, s32, 5
s_mov_b32 s32, 0x4b10884c
v_writelane_b32 v230, s32, 6
s_mov_b32 s32, 0x4800b05c
v_writelane_b32 v230, s32, 7
s_mov_b32 s32, 0x4818906c
v_writelane_b32 v230, s32, 8
s_mov_b32 s32, 0x4a18807c
v_writelane_b32 v230, s32, 9
s_mov_b32 s32, 0x4918808c
v_writelane_b32 v230, s32, 10
s_mov_b32 s32, 0x409c
v_writelane_b32 v230, s32, 11
s_mov_b32 s32, 0x78a4
v_writelane_b32 v230, s32, 12
s_branch main_kernel_w_qe
main_kernel_w_q2:
s_cmp_lg_u32 s27, 2
s_cbranch_scc1 main_kernel_w_q3
s_mov_b32 s32, 0x800
v_writelane_b32 v230, s32, 0
s_mov_b32 s32, 0x1008
v_writelane_b32 v230, s32, 1
s_mov_b32 s32, 0x44028810
v_writelane_b32 v230, s32, 2
s_mov_b32 s32, 0x44029018
v_writelane_b32 v230, s32, 3
s_mov_b32 s32, 0x48009820
v_writelane_b32 v230, s32, 4
s_mov_b32 s32, 0x48109830
v_writelane_b32 v230, s32, 5
s_mov_b32 s32, 0x4082040
v_writelane_b32 v230, s32, 6
s_mov_b32 s32, 0x40c2050
v_writelane_b32 v230, s32, 7
s_mov_b32 s32, 0x44008060
v_writelane_b32 v230, s32, 8
s_mov_b32 s32, 0x44048070
v_writelane_b32 v230, s32, 9
s_mov_b32 s32, 0x8102880
v_writelane_b32 v230, s32, 10
s_mov_b32 s32, 0x4a108890
v_writelane_b32 v230, s32, 11
s_mov_b32 s32, 0x4a1888a0
v_writelane_b32 v230, s32, 12
s_mov_b32 s32, 0x4900b0b0
v_writelane_b32 v230, s32, 13
s_mov_b32 s32, 0x4910b0c0
v_writelane_b32 v230, s32, 14
s_mov_b32 s32, 0x88838d0
v_writelane_b32 v230, s32, 15
s_mov_b32 s32, 0x88038e0
v_writelane_b32 v230, s32, 16
s_mov_b32 s32, 0x78f0
v_writelane_b32 v230, s32, 17
s_branch main_kernel_w_qe
main_kernel_w_q3:
s_cmp_lg_u32 s27, 3
s_cbranch_scc1 main_kernel_w_q4
s_mov_b32 s32, 0x1000800
v_writelane_b32 v230, s32, 0
s_mov_b32 s32, 0x1001008
v_writelane_b32 v230, s32, 1
s_mov_b32 s32, 0x45028810
v_writelane_b32 v230, s32, 2
s_mov_b32 s32, 0x45029018
v_writelane_b32 v230, s32, 3
s_mov_b32 s32, 0x42068820
v_writelane_b32 v230, s32, 4
s_mov_b32 s32, 0x40068828
v_writelane_b32 v230, s32, 5
s_mov_b32 s32, 0x4b109030
v_writelane_b32 v230, s32, 6
s_mov_b32 s32, 0x48088840
v_writelane_b32 v230, s32, 7
s_mov_b32 s32, 0x48108850
v_writelane_b32 v230, s32, 8
s_mov_b32 s32, 0x46008060
v_writelane_b32 v230, s32, 9
s_mov_b32 s32, 0x46048070
v_writelane_b32 v230, s32, 10
s_mov_b32 s32, 0x4908b080
v_writelane_b32 v230, s32, 11
s_mov_b32 s32, 0x4ac8b090
v_writelane_b32 v230, s32, 12
s_mov_b32 s32, 0x4a08b09c
v_writelane_b32 v230, s32, 13
s_mov_b32 s32, 0x4a00b0a8
v_writelane_b32 v230, s32, 14
s_mov_b32 s32, 0x4a10b0b4
v_writelane_b32 v230, s32, 15
s_mov_b32 s32, 0x4918b0c0
v_writelane_b32 v230, s32, 16
s_mov_b32 s32, 0x4818b0d0
v_writelane_b32 v230, s32, 17
s_mov_b32 s32, 0x4b1880e0
v_writelane_b32 v230, s32, 18
s_mov_b32 s32, 0x481880f0
v_writelane_b32 v230, s32, 19
s_mov_b32 s32, 0xc4100
v_writelane_b32 v230, s32, 20
s_mov_b32 s32, 0xe4108
v_writelane_b32 v230, s32, 21
s_mov_b32 s32, 0xa4110
v_writelane_b32 v230, s32, 22
s_mov_b32 s32, 0x84118
v_writelane_b32 v230, s32, 23
s_mov_b32 s32, 0x7920
v_writelane_b32 v230, s32, 24
s_branch main_kernel_w_qe
main_kernel_w_q4:
s_cmp_lg_u32 s27, 4
s_cbranch_scc1 main_kernel_w_q5
s_mov_b32 s32, 0x2000800
v_writelane_b32 v230, s32, 0
s_mov_b32 s32, 0x2001008
v_writelane_b32 v230, s32, 1
s_mov_b32 s32, 0x46028810
v_writelane_b32 v230, s32, 2
s_mov_b32 s32, 0x46029018
v_writelane_b32 v230, s32, 3
s_mov_b32 s32, 0x4a088820
v_writelane_b32 v230, s32, 4
s_mov_b32 s32, 0x4a089030
v_writelane_b32 v230, s32, 5
s_mov_b32 s32, 0x48089040
v_writelane_b32 v230, s32, 6
s_mov_b32 s32, 0x48109050
v_writelane_b32 v230, s32, 7
s_mov_b32 s32, 0x4182060
v_writelane_b32 v230, s32, 8
s_mov_b32 s32, 0x41c2070
v_writelane_b32 v230, s32, 9
s_mov_b32 s32, 0x49108880
v_writelane_b32 v230, s32, 10
s_mov_b32 s32, 0x49188890
v_writelane_b32 v230, s32, 11
s_mov_b32 s32, 0x4808b0a0
v_writelane_b32 v230, s32, 12
s_mov_b32 s32, 0x4810b0b0
v_writelane_b32 v230, s32, 13
s_mov_b32 s32, 0x481888c0
v_writelane_b32 v230, s32, 14
s_mov_b32 s32, 0x491890d0
v_writelane_b32 v230, s32, 15
s_mov_b32 s32, 0x4b1888e0
v_writelane_b32 v230, s32, 16
s_mov_b32 s32, 0x4b1890f0
v_writelane_b32 v230, s32, 17
s_mov_b32 s32, 0x8983900
v_writelane_b32 v230, s32, 18
s_mov_b32 s32, 0x8183910
v_writelane_b32 v230, s32, 19
s_mov_b32 s32, 0x104120
v_writelane_b32 v230, s32, 20
s_mov_b32 s32, 0x124128
v_writelane_b32 v230, s32, 21
s_mov_b32 s32, 0x64130
v_writelane_b32 v230, s32, 22
s_mov_b32 s32, 0x7938
v_writelane_b32 v230, s32, 23
s_branch main_kernel_w_qe
main_kernel_w_q5:
s_cmp_lg_u32 s27, 5
s_cbranch_scc1 main_kernel_w_q6
s_mov_b32 s32, 0x3000800
v_writelane_b32 v230, s32, 0
s_mov_b32 s32, 0x3001008
v_writelane_b32 v230, s32, 1
s_mov_b32 s32, 0x47028810
v_writelane_b32 v230, s32, 2
s_mov_b32 s32, 0x47029018
v_writelane_b32 v230, s32, 3
s_mov_b32 s32, 0x48089820
v_writelane_b32 v230, s32, 4
s_mov_b32 s32, 0x8085030
v_writelane_b32 v230, s32, 5
s_mov_b32 s32, 0x48189840
v_writelane_b32 v230, s32, 6
s_mov_b32 s32, 0x4102050
v_writelane_b32 v230, s32, 7
s_mov_b32 s32, 0x4142060
v_writelane_b32 v230, s32, 8
s_mov_b32 s32, 0x48088070
v_writelane_b32 v230, s32, 9
s_mov_b32 s32, 0x48108080
v_writelane_b32 v230, s32, 10
s_mov_b32 s32, 0x8002890
v_writelane_b32 v230, s32, 11
s_mov_b32 s32, 0x81828a0
v_writelane_b32 v230, s32, 12
s_mov_b32 s32, 0x4b0880b0
v_writelane_b32 v230, s32, 13
s_mov_b32 s32, 0x4b1080c0
v_writelane_b32 v230, s32, 14
s_mov_b32 s32, 0x4ad8b0d0
v_writelane_b32 v230, s32, 15
s_mov_b32 s32, 0x4a18b0dc
v_writelane_b32 v230, s32, 16
s_mov_b32 s32, 0x81038e8
v_writelane_b32 v230, s32, 17
s_mov_b32 s32, 0x89038f8
v_writelane_b32 v230, s32, 18
s_mov_b32 s32, 0x44108
v_writelane_b32 v230, s32, 19
s_mov_b32 s32, 0x24110
v_writelane_b32 v230, s32, 20
s_mov_b32 s32, 0x7918
v_writelane_b32 v230, s32, 21
s_branch main_kernel_w_qe
main_kernel_w_q6:
s_mov_b32 s32, 0x49088800
v_writelane_b32 v230, s32, 0
s_mov_b32 s32, 0x4042010
v_writelane_b32 v230, s32, 1
s_mov_b32 s32, 0x49109020
v_writelane_b32 v230, s32, 2
s_mov_b32 s32, 0x7830
v_writelane_b32 v230, s32, 3
main_kernel_w_qe:
v_and_b32 v229, 0x7ff, v230
main_kernel_w_dec:
s_waitcnt vmcnt(0)
v_readfirstlane_b32 s28, v249
s_nop 1
v_cmp_ge_u32 vcc, s28, v229
s_nop 1
s_bcnt1_i32_b64 s32, vcc
s_sub_u32 s32, s32, 1
v_readlane_b32 s36, v230, s32
s_nop 1
s_and_b32 s32, s36, 0x7ff
s_sub_u32 s28, s28, s32
s_bfe_u32 s32, s36, 0x3001a
s_lshr_b32 s25, s28, s32
s_lshl_b32 s33, s25, s32
s_sub_u32 s24, s28, s33
s_bfe_u32 s34, s36, 0x1001d
s_lshl_b32 s24, s24, s34
s_bfe_u32 s35, s36, 0x1001e
s_lshl_b32 s25, s25, s35
s_bfe_u32 s32, s36, 0x40011
s_add_u32 s24, s24, s32
s_bfe_u32 s32, s36, 0x50015
s_add_u32 s25, s25, s32
s_bfe_u32 s23, s36, 0x4000b
s_bfe_u32 s36, s36, 0x6000b
s_lshl_b32 s32, s24, 8
s_or_b32 s36, s36, s32
s_lshl_b32 s32, s25, 16
s_or_b32 s36, s36, s32
s_cmp_eq_u32 s23, 4
s_cselect_b32 s32, 1, 0
s_sub_u32 s48, s24, s32
s_max_i32 s48, s48, 0
s_add_u32 s49, s24, s34
s_add_u32 s49, s49, s32
s_min_u32 s49, s49, 15
s_cmp_eq_u32 s23, 6
s_cselect_b32 s51, 3, 7
s_cmp_eq_u32 s23, 7
s_cselect_b32 s51, 27, s51
s_cselect_b32 s50, 5, 4
s_add_u32 s33, s25, s35
s_lshl_b32 s34, s24, 9
s_cmp_eq_u32 s23, 8
s_cselect_b32 s51, 0, s51
s_cselect_b32 s48, s25, s48
s_cselect_b32 s49, s33, s49
s_cmp_eq_u32 s23, 8
s_cselect_b32 s63, 2, 9
s_cselect_b32 s61, 0, 0x7f000000
s_cselect_b32 s34, s34, 0
v_lshrrev_b32 v228, s50, v250
v_lshlrev_b32 v254, s50, v228
v_sub_u32 v254, v250, v254
s_cmp_lt_u32 s23, 4
s_cselect_b32 s39, 10, s23
v_min_u32 v254, s51, v254
s_lshl_b32 s39, s39, 13
s_cmp_eq_u32 s23, 3
s_cselect_b32 s34, 4, s34
v_add_u32 v228, s48, v228
s_add_u32 s39, s39, s34
s_add_u32 s39, s39, 0x8402000
v_min_u32 v228, s49, v228
s_lshl_b32 s60, s24, 10
s_add_u32 s60, s60, 0x8400000
v_lshlrev_b32 v228, s63, v228
v_lshl_add_u32 v228, v254, 4, v228
v_or_b32 v146, s61, v251
main_kernel_w_chk:
s_and_b32 s23, s36, 15
s_cmp_lg_u32 s23, 15
s_cbranch_scc1 main_kernel_w_got
s_mov_b32 s36, -3
s_cmp_eq_u32 s27, 6
s_cbranch_scc1 main_kernel_w_pub
s_add_u32 s27, s27, 1
s_cmp_ge_u32 s27, 6
s_cselect_b32 s27, 0, s27
s_add_u32 s52, s52, 1
s_mov_b32 s36, -1
s_lshl_b32 s32, 1, s12
s_and_b32 s32, s32, 116
s_cselect_b32 s36, -2, -1
s_cbranch_scc1 main_kernel_w_pub
s_cmp_lt_u32 s52, 6
s_cbranch_scc1 main_kernel_w_selq
s_lshl_b32 s32, s12, 5
s_add_u32 s32, s32, s13
s_sub_u32 s32, s32, 160
s_cmp_lt_u32 s32, 0
s_cselect_b32 s36, -3, -1
s_cmp_lt_u32 s32, 64
s_cselect_b32 s36, -2, s36
s_branch main_kernel_w_pub
main_kernel_w_got:
s_cmp_ge_u32 s23, 10
s_cbranch_scc1 main_kernel_w_pub
main_kernel_w_poll:
buffer_load_dword v231, v228, s[4:7], s39 offen sc1
buffer_load_dwordx4 v[232:235], v146, s[4:7], s60 offen sc1
s_waitcnt vmcnt(0)
v_min3_u32 v253, v232, v233, v234
v_min_u32 v253, v253, v235
v_or_b32 v253, s61, v253
v_min_u32 v253, v253, v231
v_cmp_eq_u32 vcc, 0, v253
s_cbranch_vccz main_kernel_w_pub
s_sleep 8
s_sub_u32 s29, s29, 1
s_cbranch_scc0 main_kernel_w_poll
s_mov_b32 s36, -1
main_kernel_w_pub:
v_mov_b32 v253, 131072
v_mov_b32 v254, s36
ds_write_b32 v253, v254
s_waitcnt lgkmcnt(0)
main_kernel_w_bar:
s_barrier
v_mov_b32 v253, 131072
ds_read_b32 v254, v253
s_mov_b32 s56, 0
s_mov_b32 s73, -1
s_mov_b32 s58, -2
s_waitcnt lgkmcnt(0)
v_readfirstlane_b32 s62, v254
s_nop 3
s_cmp_eq_u32 s62, -1
s_cbranch_scc1 main_kernel_end2
s_cmp_eq_u32 s62, -2
s_cbranch_scc1 main_kernel_wo
s_cmp_eq_u32 s62, -3
s_cbranch_scc1 main_kernel_att2
s_and_b32 s23, s62, 15
s_bfe_u32 s54, s62, 0x20004
s_bfe_u32 s24, s62, 0x80008
s_lshr_b32 s25, s62, 16
s_cmp_eq_u32 s23, 5
s_cbranch_scc1 main_kernel_w_ln2
s_cmp_eq_u32 s23, 10
s_cbranch_scc1 main_kernel_w_fill
s_cmp_eq_u32 s23, 11
s_cbranch_scc1 main_kernel_w_pref
main_kernel_w_gemm:
s_cmp_eq_u32 s54, 1
s_cbranch_scc1 main_kernel_w_c1_task
main_kernel_w_c0_task:
s_cmp_eq_u32 s23, 1
s_cbranch_scc1 main_kernel_w_c0_set1
s_cmp_eq_u32 s23, 2
s_cbranch_scc1 main_kernel_w_c0_set2
s_cmp_eq_u32 s23, 4
s_cbranch_scc1 main_kernel_w_c0_set4
s_cmp_eq_u32 s23, 7
s_cbranch_scc1 main_kernel_w_c0_set7
s_cmp_eq_u32 s23, 8
s_cbranch_scc1 main_kernel_w_c0_set8
s_branch main_kernel_end2
main_kernel_w_c0_set1:
s_mov_b32 s57, 1
s_lshl_b32 s32, s25, 8
s_add_u32 s8, s42, s32
s_addc_u32 s9, s43, 0
s_and_b32 s9, s9, 0xffff
s_sub_u32 s10, 0x800000, s32
s_mov_b32 s11, 0x20000
s_mov_b32 s30, 8192
s_mov_b32 s31, 32768
s_mul_i32 s16, s24, 262144
s_add_u32 s16, s16, 0x0
s_mov_b32 s18, 3
s_lshl_b32 s32, s24, 3
s_mul_i32 s33, s38, 4
s_add_u32 s32, s32, s33
s_mul_i32 s32, s32, 131072
s_lshl_b32 s33, s25, 12
s_add_u32 s32, s32, s33
s_mul_i32 s33, s37, 2048
s_add_u32 s32, s32, s33
s_add_u32 s21, s32, 0x1800000
s_mov_b32 s22, 131072
s_mov_b32 s26, 0x7f000000
s_branch main_kernel_w_c0_go
main_kernel_w_c0_set2:
s_mov_b32 s57, 2
s_lshl_b32 s32, s25, 8
s_add_u32 s8, s44, s32
s_addc_u32 s9, s45, 0
s_and_b32 s9, s9, 0xffff
s_sub_u32 s10, 0x800000, s32
s_mov_b32 s11, 0x20000
s_mov_b32 s30, 8192
s_mov_b32 s31, 32768
s_mul_i32 s16, s24, 262144
s_add_u32 s16, s16, 0x0
s_mov_b32 s18, 3
s_lshl_b32 s32, s24, 2
s_mul_i32 s33, s38, 2
s_add_u32 s32, s32, s33
s_lshl_b32 s32, s32, 18
s_lshl_b32 s33, s25, 13
s_add_u32 s32, s32, s33
s_mul_i32 s33, s37, 4096
s_add_u32 s32, s32, s33
s_add_u32 s21, s32, 0x2800000
s_branch main_kernel_w_c0_gov
main_kernel_w_c0_set4:
s_mov_b32 s57, 3
s_lshl_b32 s32, s25, 8
s_add_u32 s8, s66, s32
s_addc_u32 s9, s67, 0
s_and_b32 s9, s9, 0xffff
s_sub_u32 s10, 0x200000, s32
s_mov_b32 s11, 0x20000
s_mov_b32 s30, 2048
s_mov_b32 s31, 32768
s_mul_i32 s16, s24, 262144
s_add_u32 s16, s16, 0x4808000
s_mov_b32 s18, 3
s_lshl_b32 s32, s24, 3
s_mul_i32 s33, s38, 4
s_add_u32 s32, s32, s33
s_mul_i32 s32, s32, 32768
s_lshl_b32 s33, s25, 12
s_add_u32 s32, s32, s33
s_mul_i32 s33, s37, 2048
s_add_u32 s32, s32, s33
s_add_u32 s21, s32, 0x5000000
s_mov_b32 s22, 32768
s_add_u32 s26, s32, 0x0
s_branch main_kernel_w_c0_go
main_kernel_w_c0_set7:
s_mov_b32 s57, 4
s_lshl_b32 s32, s25, 8
s_add_u32 s8, s70, s32
s_addc_u32 s9, s71, 0
s_and_b32 s9, s9, 0xffff
s_sub_u32 s10, 0x700000, s32
s_mov_b32 s11, 0x20000
s_mov_b32 s30, 2048
s_mov_b32 s31, 114688
s_mul_i32 s16, s24, 917504
s_add_u32 s16, s16, 0x5400000
s_mov_b32 s18, 13
s_lshl_b32 s32, s24, 3
s_mul_i32 s33, s38, 4
s_add_u32 s32, s32, s33
s_mul_i32 s32, s32, 32768
s_lshl_b32 s33, s25, 12
s_add_u32 s32, s32, s33
s_mul_i32 s33, s37, 2048
s_add_u32 s32, s32, s33
s_add_u32 s21, s32, 0x6400000
s_mov_b32 s22, 32768
s_add_u32 s26, s32, 0x5000000
s_branch main_kernel_w_c0_go
main_kernel_w_c0_set8:
s_mov_b32 s57, 5
s_lshl_b32 s32, s25, 8
s_add_u32 s8, s46, s32
s_addc_u32 s9, s47, 0
s_and_b32 s9, s9, 0xffff
s_sub_u32 s10, 0x800000, s32
s_mov_b32 s11, 0x20000
s_mov_b32 s30, 2048
s_mov_b32 s31, 131072
s_mul_i32 s16, s24, 1048576
s_add_u32 s16, s16, 0x3800000
s_mov_b32 s18, 15
s_lshl_b32 s32, s24, 3
s_mul_i32 s33, s38, 4
s_add_u32 s32, s32, s33
s_mul_i32 s32, s32, 32768
s_lshl_b32 s33, s25, 8
s_add_u32 s34, s32, s33
s_mul_i32 s33, s37, 128
s_add_u32 s34, s34, s33
s_lshl_b32 s33, s25, 12
s_add_u32 s32, s32, s33
s_mul_i32 s33, s37, 2048
s_add_u32 s32, s32, s33
s_add_u32 s21, s32, 0x0
s_mov_b32 s22, 32768
s_add_u32 s26, s32, 0x6400000
s_mov_b32 s21, s34
v_and_b32 v253, 15, v250
v_and_b32 v254, 48, v250
v_lshl_add_u32 v252, v253, 11, v254
s_branch main_kernel_w_c0_go
main_kernel_w_c0_str:
s_mul_i32 s32, s14, 2
s_mul_i32 s32, s32, s31
v_mad_u32_u24 v137, v147, s30, v151
v_mad_u32_u24 v138, v148, s30, v152
v_mad_u32_u24 v139, v149, s30, v153
v_mad_u32_u24 v140, v150, s30, v154
v_add_u32 v141, s32, v251
s_add_u32 s32, s32, s31
s_sub_u32 s32, s32, 2048
v_add_u32 v142, s32, v251
s_mul_i32 s17, s30, 64
s_mov_b32 s15, 0
s_mov_b32 s18, 1
s_cmp_eq_u32 s73, 0
s_cbranch_scc1 main_kernel_w_c0_n_mid
s_branch main_kernel_w_c0_v_mid
main_kernel_w_c0_go:
s_mov_b32 s58, 0
s_mov_b32 s72, s18
s_cmp_lg_u32 s73, -1
s_cbranch_scc1 main_kernel_w_c0_str
s_waitcnt lgkmcnt(0)
v_lshrrev_b32 v0, 4, v250
v_bfe_u32 v1, v250, 2, 2
v_lshl_add_u32 v4, v0, 2, v1
v_and_b32 v5, 7, v4
v_mul_u32_u24 v4, 256, v4
v_and_b32 v6, 3, v250
v_lshl_add_u32 v4, v6, 3, v4
s_mul_i32 s32, s37, 4
v_xor_b32 v5, s32, v5
v_lshl_add_u32 v128, v5, 5, v4
v_xor_b32 v129, 32, v128
v_xor_b32 v130, 64, v128
v_xor_b32 v131, 96, v128
s_mul_i32 s32, s38, 8192
s_add_u32 s32, s32, 65536
v_add_u32 v136, s32, v251
v_lshrrev_b32 v2, 4, v250
v_and_b32 v3, 15, v250
s_mul_i32 s32, s14, 16
v_add_u32 v147, s32, v2
v_and_b32 v6, 7, v147
v_lshlrev_b32 v6, 1, v6
v_xor_b32 v6, v6, v3
v_lshlrev_b32 v151, 4, v6
v_add_u32 v148, 4, v147
v_and_b32 v6, 7, v148
v_lshlrev_b32 v6, 1, v6
v_xor_b32 v6, v6, v3
v_lshlrev_b32 v152, 4, v6
v_subrev_u32 v152, 1024, v152
v_add_u32 v149, 8, v147
v_and_b32 v6, 7, v149
v_lshlrev_b32 v6, 1, v6
v_xor_b32 v6, v6, v3
v_lshlrev_b32 v153, 4, v6
v_subrev_u32 v153, 2048, v153
v_add_u32 v150, 12, v147
v_and_b32 v6, 7, v150
v_lshlrev_b32 v6, 1, v6
v_xor_b32 v6, v6, v3
v_lshlrev_b32 v154, 4, v6
v_subrev_u32 v154, 3072, v154
s_mul_i32 s19, s14, 4096
s_mul_i32 s20, s14, 4096
s_add_u32 s20, s20, 65536
s_mul_i32 s32, s14, 2
s_mul_i32 s32, s32, s31
v_mad_u32_u24 v137, v147, s30, v151
v_mad_u32_u24 v138, v148, s30, v152
v_mad_u32_u24 v139, v149, s30, v153
v_mad_u32_u24 v140, v150, s30, v154
v_add_u32 v141, s32, v251
s_add_u32 s32, s32, s31
s_sub_u32 s32, s32, 2048
v_add_u32 v142, s32, v251
s_mul_i32 s17, s30, 64
s_mov_b32 s15, 0
s_waitcnt vmcnt(0)
s_add_u32 m0, s20, 0
s_nop 0
buffer_load_dwordx4 v141, s[4:7], s16 offen offset:0 sc1 lds
buffer_load_dwordx4 v141, s[4:7], s16 offen offset:1024 sc1 lds
buffer_load_dwordx4 v142, s[4:7], s16 offen offset:2048 sc1 lds
buffer_load_dwordx4 v142, s[4:7], s16 offen offset:3072 sc1 lds
s_add_u32 s16, s16, 2048
s_add_u32 m0, s19, 0
s_nop 0
buffer_load_dwordx4 v137, s[8:11], s15 offen offset:0 lds
buffer_load_dwordx4 v138, s[8:11], s15 offen offset:1024 lds
buffer_load_dwordx4 v139, s[8:11], s15 offen offset:2048 lds
buffer_load_dwordx4 v140, s[8:11], s15 offen offset:3072 lds
s_add_u32 s15, s15, s17
s_add_u32 m0, s20, 16384
s_nop 0
buffer_load_dwordx4 v141, s[4:7], s16 offen offset:0 sc1 lds
buffer_load_dwordx4 v141, s[4:7], s16 offen offset:1024 sc1 lds
buffer_load_dwordx4 v142, s[4:7], s16 offen offset:2048 sc1 lds
buffer_load_dwordx4 v142, s[4:7], s16 offen offset:3072 sc1 lds
s_add_u32 s16, s16, 2048
s_add_u32 m0, s19, 16384
s_nop 0
buffer_load_dwordx4 v137, s[8:11], s15 offen offset:0 lds
buffer_load_dwordx4 v138, s[8:11], s15 offen offset:1024 lds
buffer_load_dwordx4 v139, s[8:11], s15 offen offset:2048 lds
buffer_load_dwordx4 v140, s[8:11], s15 offen offset:3072 lds
s_add_u32 s15, s15, s17
s_add_u32 m0, s20, 32768
s_nop 0
buffer_load_dwordx4 v141, s[4:7], s16 offen offset:0 sc1 lds
buffer_load_dwordx4 v141, s[4:7], s16 offen offset:1024 sc1 lds
buffer_load_dwordx4 v142, s[4:7], s16 offen offset:2048 sc1 lds
buffer_load_dwordx4 v142, s[4:7], s16 offen offset:3072 sc1 lds
s_add_u32 s16, s16, 2048
s_add_u32 m0, s19, 32768
s_nop 0
buffer_load_dwordx4 v137, s[8:11], s15 offen offset:0 lds
buffer_load_dwordx4 v138, s[8:11], s15 offen offset:1024 lds
buffer_load_dwordx4 v139, s[8:11], s15 offen offset:2048 lds
buffer_load_dwordx4 v140, s[8:11], s15 offen offset:3072 lds
s_add_u32 s15, s15, s17
s_add_u32 m0, s20, 49152
s_nop 0
buffer_load_dwordx4 v141, s[4:7], s16 offen offset:0 sc1 lds
buffer_load_dwordx4 v141, s[4:7], s16 offen offset:1024 sc1 lds
buffer_load_dwordx4 v142, s[4:7], s16 offen offset:2048 sc1 lds
buffer_load_dwordx4 v142, s[4:7], s16 offen offset:3072 sc1 lds
s_add_u32 s16, s16, 2048
s_cmp_lg_u32 s56, 0
s_cbranch_scc1 main_kernel_w_epi
main_kernel_w_c0_n_ent:
v_mfma_f32_32x32x16_bf16 v[64:79], v[224:227], v[224:227], 0
s_waitcnt vmcnt(20)
s_barrier
ds_read_b128 v[16:19], v136 offset:0
ds_read_b64_tr_b16 v[0:1], v128 offset:0
ds_read_b64_tr_b16 v[2:3], v128 offset:4096
v_mfma_f32_32x32x16_bf16 v[80:95], v[224:227], v[224:227], 0
ds_read_b64_tr_b16 v[4:5], v129 offset:0
ds_read_b64_tr_b16 v[6:7], v129 offset:4096
ds_read_b64_tr_b16 v[8:9], v130 offset:0
v_mfma_f32_32x32x16_bf16 v[96:111], v[224:227], v[224:227], 0
ds_read_b64_tr_b16 v[10:11], v130 offset:4096
ds_read_b64_tr_b16 v[12:13], v131 offset:0
ds_read_b64_tr_b16 v[14:15], v131 offset:4096
v_mfma_f32_32x32x16_bf16 v[112:127], v[224:227], v[224:227], 0
ds_read_b128 v[20:23], v136 offset:2048
ds_read_b128 v[24:27], v136 offset:4096
ds_read_b128 v[28:31], v136 offset:6144
s_sub_u32 s18, s72, 1
s_sub_u32 s55, s72, 2
s_orn2_b32 s55, s55, s100
s_mov_b32 s73, -1
s_nop 0
main_kernel_w_c0_n_loop:
s_waitcnt lgkmcnt(0)
ds_read_b128 v[48:51], v136 offset:1024
s_add_u32 m0, s19, 49152
s_nop 0
v_mfma_f32_16x16x32_bf16 v[64:67], v[0:3], v[16:19], v[64:67]
ds_read_b64_tr_b16 v[32:33], v128 offset:8192
v_mfma_f32_16x16x32_bf16 v[68:71], v[4:7], v[16:19], v[68:71]
ds_read_b64_tr_b16 v[34:35], v128 offset:12288
buffer_load_dwordx4 v137, s[8:11], s15 offen offset:0 lds
v_mfma_f32_16x16x32_bf16 v[72:75], v[8:11], v[16:19], v[72:75]
ds_read_b64_tr_b16 v[36:37], v129 offset:8192
v_mfma_f32_16x16x32_bf16 v[76:79], v[12:15], v[16:19], v[76:79]
ds_read_b64_tr_b16 v[38:39], v129 offset:12288
v_mfma_f32_16x16x32_bf16 v[80:83], v[0:3], v[20:23], v[80:83]
ds_read_b64_tr_b16 v[40:41], v130 offset:8192
buffer_load_dwordx4 v138, s[8:11], s15 offen offset:1024 lds
v_mfma_f32_16x16x32_bf16 v[84:87], v[4:7], v[20:23], v[84:87]
ds_read_b64_tr_b16 v[42:43], v130 offset:12288
v_mfma_f32_16x16x32_bf16 v[88:91], v[8:11], v[20:23], v[88:91]
ds_read_b64_tr_b16 v[44:45], v131 offset:8192
v_mfma_f32_16x16x32_bf16 v[92:95], v[12:15], v[20:23], v[92:95]
ds_read_b64_tr_b16 v[46:47], v131 offset:12288
buffer_load_dwordx4 v139, s[8:11], s15 offen offset:2048 lds
v_mfma_f32_16x16x32_bf16 v[96:99], v[0:3], v[24:27], v[96:99]
ds_read_b128 v[52:55], v136 offset:3072
v_mfma_f32_16x16x32_bf16 v[100:103], v[4:7], v[24:27], v[100:103]
ds_read_b128 v[56:59], v136 offset:5120
buffer_load_dwordx4 v140, s[8:11], s15 offen offset:3072 lds
v_mfma_f32_16x16x32_bf16 v[104:107], v[8:11], v[24:27], v[104:107]
ds_read_b128 v[60:63], v136 offset:7168
v_mfma_f32_16x16x32_bf16 v[108:111], v[12:15], v[24:27], v[108:111]
v_mfma_f32_16x16x32_bf16 v[112:115], v[0:3], v[28:31], v[112:115]
s_add_u32 s15, s15, s17
v_mfma_f32_16x16x32_bf16 v[116:119], v[4:7], v[28:31], v[116:119]
v_mfma_f32_16x16x32_bf16 v[120:123], v[8:11], v[28:31], v[120:123]
v_mfma_f32_16x16x32_bf16 v[124:127], v[12:15], v[28:31], v[124:127]
main_kernel_w_c0_n_mid:
s_waitcnt lgkmcnt(0)
v_mfma_f32_16x16x32_bf16 v[64:67], v[32:35], v[48:51], v[64:67]
s_waitcnt vmcnt(16)
s_barrier
ds_read_b128 v[16:19], v136 offset:16384
s_add_u32 m0, s20, 0
s_nop 0
v_mfma_f32_16x16x32_bf16 v[68:71], v[36:39], v[48:51], v[68:71]
ds_read_b64_tr_b16 v[0:1], v128 offset:16384
v_mfma_f32_16x16x32_bf16 v[72:75], v[40:43], v[48:51], v[72:75]
ds_read_b64_tr_b16 v[2:3], v128 offset:20480
buffer_load_dwordx4 v141, s[4:7], s16 offen offset:0 sc1 lds
v_mfma_f32_16x16x32_bf16 v[76:79], v[44:47], v[48:51], v[76:79]
ds_read_b64_tr_b16 v[4:5], v129 offset:16384
v_mfma_f32_16x16x32_bf16 v[80:83], v[32:35], v[52:55], v[80:83]
ds_read_b64_tr_b16 v[6:7], v129 offset:20480
v_mfma_f32_16x16x32_bf16 v[84:87], v[36:39], v[52:55], v[84:87]
ds_read_b64_tr_b16 v[8:9], v130 offset:16384
buffer_load_dwordx4 v141, s[4:7], s16 offen offset:1024 sc1 lds
v_mfma_f32_16x16x32_bf16 v[88:91], v[40:43], v[52:55], v[88:91]
ds_read_b64_tr_b16 v[10:11], v130 offset:20480
v_mfma_f32_16x16x32_bf16 v[92:95], v[44:47], v[52:55], v[92:95]
ds_read_b64_tr_b16 v[12:13], v131 offset:16384
buffer_load_dwordx4 v142, s[4:7], s16 offen offset:2048 sc1 lds
v_mfma_f32_16x16x32_bf16 v[96:99], v[32:35], v[56:59], v[96:99]
ds_read_b64_tr_b16 v[14:15], v131 offset:20480
v_mfma_f32_16x16x32_bf16 v[100:103], v[36:39], v[56:59], v[100:103]
ds_read_b128 v[20:23], v136 offset:18432
v_mfma_f32_16x16x32_bf16 v[104:107], v[40:43], v[56:59], v[104:107]
ds_read_b128 v[24:27], v136 offset:20480
buffer_load_dwordx4 v142, s[4:7], s16 offen offset:3072 sc1 lds
v_mfma_f32_16x16x32_bf16 v[108:111], v[44:47], v[56:59], v[108:111]
ds_read_b128 v[28:31], v136 offset:22528
v_mfma_f32_16x16x32_bf16 v[112:115], v[32:35], v[60:63], v[112:115]
s_add_u32 s16, s16, 2048
v_mfma_f32_16x16x32_bf16 v[116:119], v[36:39], v[60:63], v[116:119]
v_mfma_f32_16x16x32_bf16 v[120:123], v[40:43], v[60:63], v[120:123]
v_mfma_f32_16x16x32_bf16 v[124:127], v[44:47], v[60:63], v[124:127]
s_waitcnt lgkmcnt(0)
ds_read_b128 v[48:51], v136 offset:17408
s_add_u32 m0, s19, 0
s_nop 0
v_mfma_f32_16x16x32_bf16 v[64:67], v[0:3], v[16:19], v[64:67]
ds_read_b64_tr_b16 v[32:33], v128 offset:24576
v_mfma_f32_16x16x32_bf16 v[68:71], v[4:7], v[16:19], v[68:71]
ds_read_b64_tr_b16 v[34:35], v128 offset:28672
buffer_load_dwordx4 v137, s[8:11], s15 offen offset:0 lds
v_mfma_f32_16x16x32_bf16 v[72:75], v[8:11], v[16:19], v[72:75]
ds_read_b64_tr_b16 v[36:37], v129 offset:24576
v_mfma_f32_16x16x32_bf16 v[76:79], v[12:15], v[16:19], v[76:79]
ds_read_b64_tr_b16 v[38:39], v129 offset:28672
v_mfma_f32_16x16x32_bf16 v[80:83], v[0:3], v[20:23], v[80:83]
ds_read_b64_tr_b16 v[40:41], v130 offset:24576
buffer_load_dwordx4 v138, s[8:11], s15 offen offset:1024 lds
v_mfma_f32_16x16x32_bf16 v[84:87], v[4:7], v[20:23], v[84:87]
ds_read_b64_tr_b16 v[42:43], v130 offset:28672
v_mfma_f32_16x16x32_bf16 v[88:91], v[8:11], v[20:23], v[88:91]
ds_read_b64_tr_b16 v[44:45], v131 offset:24576
v_mfma_f32_16x16x32_bf16 v[92:95], v[12:15], v[20:23], v[92:95]
ds_read_b64_tr_b16 v[46:47], v131 offset:28672
buffer_load_dwordx4 v139, s[8:11], s15 offen offset:2048 lds
v_mfma_f32_16x16x32_bf16 v[96:99], v[0:3], v[24:27], v[96:99]
ds_read_b128 v[52:55], v136 offset:19456
v_mfma_f32_16x16x32_bf16 v[100:103], v[4:7], v[24:27], v[100:103]
ds_read_b128 v[56:59], v136 offset:21504
buffer_load_dwordx4 v140, s[8:11], s15 offen offset:3072 lds
v_mfma_f32_16x16x32_bf16 v[104:107], v[8:11], v[24:27], v[104:107]
ds_read_b128 v[60:63], v136 offset:23552
v_mfma_f32_16x16x32_bf16 v[108:111], v[12:15], v[24:27], v[108:111]
v_mfma_f32_16x16x32_bf16 v[112:115], v[0:3], v[28:31], v[112:115]
s_add_u32 s15, s15, s17
v_mfma_f32_16x16x32_bf16 v[116:119], v[4:7], v[28:31], v[116:119]
v_mfma_f32_16x16x32_bf16 v[120:123], v[8:11], v[28:31], v[120:123]
v_mfma_f32_16x16x32_bf16 v[124:127], v[12:15], v[28:31], v[124:127]
s_waitcnt lgkmcnt(0)
v_mfma_f32_16x16x32_bf16 v[64:67], v[32:35], v[48:51], v[64:67]
s_waitcnt vmcnt(16)
s_barrier
ds_read_b128 v[16:19], v136 offset:32768
s_add_u32 m0, s20, 16384
s_nop 0
v_mfma_f32_16x16x32_bf16 v[68:71], v[36:39], v[48:51], v[68:71]
ds_read_b64_tr_b16 v[0:1], v128 offset:32768
v_mfma_f32_16x16x32_bf16 v[72:75], v[40:43], v[48:51], v[72:75]
ds_read_b64_tr_b16 v[2:3], v128 offset:36864
buffer_load_dwordx4 v141, s[4:7], s16 offen offset:0 sc1 lds
v_mfma_f32_16x16x32_bf16 v[76:79], v[44:47], v[48:51], v[76:79]
ds_read_b64_tr_b16 v[4:5], v129 offset:32768
v_mfma_f32_16x16x32_bf16 v[80:83], v[32:35], v[52:55], v[80:83]
ds_read_b64_tr_b16 v[6:7], v129 offset:36864
v_mfma_f32_16x16x32_bf16 v[84:87], v[36:39], v[52:55], v[84:87]
ds_read_b64_tr_b16 v[8:9], v130 offset:32768
buffer_load_dwordx4 v141, s[4:7], s16 offen offset:1024 sc1 lds
v_mfma_f32_16x16x32_bf16 v[88:91], v[40:43], v[52:55], v[88:91]
ds_read_b64_tr_b16 v[10:11], v130 offset:36864
v_mfma_f32_16x16x32_bf16 v[92:95], v[44:47], v[52:55], v[92:95]
ds_read_b64_tr_b16 v[12:13], v131 offset:32768
buffer_load_dwordx4 v142, s[4:7], s16 offen offset:2048 sc1 lds
v_mfma_f32_16x16x32_bf16 v[96:99], v[32:35], v[56:59], v[96:99]
ds_read_b64_tr_b16 v[14:15], v131 offset:36864
v_mfma_f32_16x16x32_bf16 v[100:103], v[36:39], v[56:59], v[100:103]
ds_read_b128 v[20:23], v136 offset:34816
v_mfma_f32_16x16x32_bf16 v[104:107], v[40:43], v[56:59], v[104:107]
ds_read_b128 v[24:27], v136 offset:36864
buffer_load_dwordx4 v142, s[4:7], s16 offen offset:3072 sc1 lds
v_mfma_f32_16x16x32_bf16 v[108:111], v[44:47], v[56:59], v[108:111]
ds_read_b128 v[28:31], v136 offset:38912
v_mfma_f32_16x16x32_bf16 v[112:115], v[32:35], v[60:63], v[112:115]
s_add_u32 s16, s16, 2048
v_mfma_f32_16x16x32_bf16 v[116:119], v[36:39], v[60:63], v[116:119]
v_mfma_f32_16x16x32_bf16 v[120:123], v[40:43], v[60:63], v[120:123]
v_mfma_f32_16x16x32_bf16 v[124:127], v[44:47], v[60:63], v[124:127]
s_waitcnt lgkmcnt(0)
ds_read_b128 v[48:51], v136 offset:33792
s_add_u32 m0, s19, 16384
s_nop 0
v_mfma_f32_16x16x32_bf16 v[64:67], v[0:3], v[16:19], v[64:67]
ds_read_b64_tr_b16 v[32:33], v128 offset:40960
v_mfma_f32_16x16x32_bf16 v[68:71], v[4:7], v[16:19], v[68:71]
ds_read_b64_tr_b16 v[34:35], v128 offset:45056
buffer_load_dwordx4 v137, s[8:11], s15 offen offset:0 lds
v_mfma_f32_16x16x32_bf16 v[72:75], v[8:11], v[16:19], v[72:75]
ds_read_b64_tr_b16 v[36:37], v129 offset:40960
v_mfma_f32_16x16x32_bf16 v[76:79], v[12:15], v[16:19], v[76:79]
ds_read_b64_tr_b16 v[38:39], v129 offset:45056
v_mfma_f32_16x16x32_bf16 v[80:83], v[0:3], v[20:23], v[80:83]
ds_read_b64_tr_b16 v[40:41], v130 offset:40960
buffer_load_dwordx4 v138, s[8:11], s15 offen offset:1024 lds
v_mfma_f32_16x16x32_bf16 v[84:87], v[4:7], v[20:23], v[84:87]
ds_read_b64_tr_b16 v[42:43], v130 offset:45056
v_mfma_f32_16x16x32_bf16 v[88:91], v[8:11], v[20:23], v[88:91]
ds_read_b64_tr_b16 v[44:45], v131 offset:40960
v_mfma_f32_16x16x32_bf16 v[92:95], v[12:15], v[20:23], v[92:95]
ds_read_b64_tr_b16 v[46:47], v131 offset:45056
buffer_load_dwordx4 v139, s[8:11], s15 offen offset:2048 lds
v_mfma_f32_16x16x32_bf16 v[96:99], v[0:3], v[24:27], v[96:99]
ds_read_b128 v[52:55], v136 offset:35840
v_mfma_f32_16x16x32_bf16 v[100:103], v[4:7], v[24:27], v[100:103]
ds_read_b128 v[56:59], v136 offset:37888
buffer_load_dwordx4 v140, s[8:11], s15 offen offset:3072 lds
v_mfma_f32_16x16x32_bf16 v[104:107], v[8:11], v[24:27], v[104:107]
ds_read_b128 v[60:63], v136 offset:39936
v_mfma_f32_16x16x32_bf16 v[108:111], v[12:15], v[24:27], v[108:111]
v_mfma_f32_16x16x32_bf16 v[112:115], v[0:3], v[28:31], v[112:115]
s_add_u32 s15, s15, s17
v_mfma_f32_16x16x32_bf16 v[116:119], v[4:7], v[28:31], v[116:119]
v_mfma_f32_16x16x32_bf16 v[120:123], v[8:11], v[28:31], v[120:123]
v_mfma_f32_16x16x32_bf16 v[124:127], v[12:15], v[28:31], v[124:127]
s_waitcnt lgkmcnt(0)
v_mfma_f32_16x16x32_bf16 v[64:67], v[32:35], v[48:51], v[64:67]
s_waitcnt vmcnt(16)
s_barrier
ds_read_b128 v[16:19], v136 offset:49152
s_add_u32 m0, s20, 32768
s_nop 0
v_mfma_f32_16x16x32_bf16 v[68:71], v[36:39], v[48:51], v[68:71]
ds_read_b64_tr_b16 v[0:1], v128 offset:49152
v_mfma_f32_16x16x32_bf16 v[72:75], v[40:43], v[48:51], v[72:75]
ds_read_b64_tr_b16 v[2:3], v128 offset:53248
buffer_load_dwordx4 v141, s[4:7], s16 offen offset:0 sc1 lds
v_mfma_f32_16x16x32_bf16 v[76:79], v[44:47], v[48:51], v[76:79]
ds_read_b64_tr_b16 v[4:5], v129 offset:49152
v_mfma_f32_16x16x32_bf16 v[80:83], v[32:35], v[52:55], v[80:83]
ds_read_b64_tr_b16 v[6:7], v129 offset:53248
v_mfma_f32_16x16x32_bf16 v[84:87], v[36:39], v[52:55], v[84:87]
ds_read_b64_tr_b16 v[8:9], v130 offset:49152
buffer_load_dwordx4 v141, s[4:7], s16 offen offset:1024 sc1 lds
v_mfma_f32_16x16x32_bf16 v[88:91], v[40:43], v[52:55], v[88:91]
ds_read_b64_tr_b16 v[10:11], v130 offset:53248
v_mfma_f32_16x16x32_bf16 v[92:95], v[44:47], v[52:55], v[92:95]
ds_read_b64_tr_b16 v[12:13], v131 offset:49152
buffer_load_dwordx4 v142, s[4:7], s16 offen offset:2048 sc1 lds
v_mfma_f32_16x16x32_bf16 v[96:99], v[32:35], v[56:59], v[96:99]
ds_read_b64_tr_b16 v[14:15], v131 offset:53248
v_mfma_f32_16x16x32_bf16 v[100:103], v[36:39], v[56:59], v[100:103]
ds_read_b128 v[20:23], v136 offset:51200
v_mfma_f32_16x16x32_bf16 v[104:107], v[40:43], v[56:59], v[104:107]
ds_read_b128 v[24:27], v136 offset:53248
buffer_load_dwordx4 v142, s[4:7], s16 offen offset:3072 sc1 lds
v_mfma_f32_16x16x32_bf16 v[108:111], v[44:47], v[56:59], v[108:111]
ds_read_b128 v[28:31], v136 offset:55296
v_mfma_f32_16x16x32_bf16 v[112:115], v[32:35], v[60:63], v[112:115]
s_add_u32 s16, s16, 2048
v_mfma_f32_16x16x32_bf16 v[116:119], v[36:39], v[60:63], v[116:119]
v_mfma_f32_16x16x32_bf16 v[120:123], v[40:43], v[60:63], v[120:123]
v_mfma_f32_16x16x32_bf16 v[124:127], v[44:47], v[60:63], v[124:127]
s_waitcnt lgkmcnt(0)
ds_read_b128 v[48:51], v136 offset:50176
s_add_u32 m0, s19, 32768
s_nop 0
v_mfma_f32_16x16x32_bf16 v[64:67], v[0:3], v[16:19], v[64:67]
ds_read_b64_tr_b16 v[32:33], v128 offset:57344
v_mfma_f32_16x16x32_bf16 v[68:71], v[4:7], v[16:19], v[68:71]
ds_read_b64_tr_b16 v[34:35], v128 offset:61440
buffer_load_dwordx4 v137, s[8:11], s15 offen offset:0 lds
v_mfma_f32_16x16x32_bf16 v[72:75], v[8:11], v[16:19], v[72:75]
ds_read_b64_tr_b16 v[36:37], v129 offset:57344
v_mfma_f32_16x16x32_bf16 v[76:79], v[12:15], v[16:19], v[76:79]
ds_read_b64_tr_b16 v[38:39], v129 offset:61440
v_mfma_f32_16x16x32_bf16 v[80:83], v[0:3], v[20:23], v[80:83]
ds_read_b64_tr_b16 v[40:41], v130 offset:57344
buffer_load_dwordx4 v138, s[8:11], s15 offen offset:1024 lds
v_mfma_f32_16x16x32_bf16 v[84:87], v[4:7], v[20:23], v[84:87]
ds_read_b64_tr_b16 v[42:43], v130 offset:61440
v_mfma_f32_16x16x32_bf16 v[88:91], v[8:11], v[20:23], v[88:91]
ds_read_b64_tr_b16 v[44:45], v131 offset:57344
v_mfma_f32_16x16x32_bf16 v[92:95], v[12:15], v[20:23], v[92:95]
ds_read_b64_tr_b16 v[46:47], v131 offset:61440
buffer_load_dwordx4 v139, s[8:11], s15 offen offset:2048 lds
v_mfma_f32_16x16x32_bf16 v[96:99], v[0:3], v[24:27], v[96:99]
ds_read_b128 v[52:55], v136 offset:52224
v_mfma_f32_16x16x32_bf16 v[100:103], v[4:7], v[24:27], v[100:103]
ds_read_b128 v[56:59], v136 offset:54272
buffer_load_dwordx4 v140, s[8:11], s15 offen offset:3072 lds
v_mfma_f32_16x16x32_bf16 v[104:107], v[8:11], v[24:27], v[104:107]
ds_read_b128 v[60:63], v136 offset:56320
v_mfma_f32_16x16x32_bf16 v[108:111], v[12:15], v[24:27], v[108:111]
v_mfma_f32_16x16x32_bf16 v[112:115], v[0:3], v[28:31], v[112:115]
s_add_u32 s15, s15, s17
v_mfma_f32_16x16x32_bf16 v[116:119], v[4:7], v[28:31], v[116:119]
v_mfma_f32_16x16x32_bf16 v[120:123], v[8:11], v[28:31], v[120:123]
v_mfma_f32_16x16x32_bf16 v[124:127], v[12:15], v[28:31], v[124:127]
s_waitcnt lgkmcnt(0)
v_mfma_f32_16x16x32_bf16 v[64:67], v[32:35], v[48:51], v[64:67]
s_waitcnt vmcnt(16)
s_barrier
ds_read_b128 v[16:19], v136 offset:0
s_add_u32 m0, s20, 49152
s_nop 0
v_mfma_f32_16x16x32_bf16 v[68:71], v[36:39], v[48:51], v[68:71]
ds_read_b64_tr_b16 v[0:1], v128 offset:0
v_mfma_f32_16x16x32_bf16 v[72:75], v[40:43], v[48:51], v[72:75]
ds_read_b64_tr_b16 v[2:3], v128 offset:4096
buffer_load_dwordx4 v141, s[4:7], s16 offen offset:0 sc1 lds
v_mfma_f32_16x16x32_bf16 v[76:79], v[44:47], v[48:51], v[76:79]
ds_read_b64_tr_b16 v[4:5], v129 offset:0
v_mfma_f32_16x16x32_bf16 v[80:83], v[32:35], v[52:55], v[80:83]
ds_read_b64_tr_b16 v[6:7], v129 offset:4096
v_mfma_f32_16x16x32_bf16 v[84:87], v[36:39], v[52:55], v[84:87]
ds_read_b64_tr_b16 v[8:9], v130 offset:0
buffer_load_dwordx4 v141, s[4:7], s16 offen offset:1024 sc1 lds
v_mfma_f32_16x16x32_bf16 v[88:91], v[40:43], v[52:55], v[88:91]
ds_read_b64_tr_b16 v[10:11], v130 offset:4096
v_mfma_f32_16x16x32_bf16 v[92:95], v[44:47], v[52:55], v[92:95]
ds_read_b64_tr_b16 v[12:13], v131 offset:0
buffer_load_dwordx4 v142, s[4:7], s16 offen offset:2048 sc1 lds
v_mfma_f32_16x16x32_bf16 v[96:99], v[32:35], v[56:59], v[96:99]
ds_read_b64_tr_b16 v[14:15], v131 offset:4096
v_mfma_f32_16x16x32_bf16 v[100:103], v[36:39], v[56:59], v[100:103]
ds_read_b128 v[20:23], v136 offset:2048
v_mfma_f32_16x16x32_bf16 v[104:107], v[40:43], v[56:59], v[104:107]
ds_read_b128 v[24:27], v136 offset:4096
buffer_load_dwordx4 v142, s[4:7], s16 offen offset:3072 sc1 lds
v_mfma_f32_16x16x32_bf16 v[108:111], v[44:47], v[56:59], v[108:111]
ds_read_b128 v[28:31], v136 offset:6144
v_mfma_f32_16x16x32_bf16 v[112:115], v[32:35], v[60:63], v[112:115]
s_add_u32 s16, s16, 2048
v_mfma_f32_16x16x32_bf16 v[116:119], v[36:39], v[60:63], v[116:119]
v_mfma_f32_16x16x32_bf16 v[120:123], v[40:43], v[60:63], v[120:123]
v_mfma_f32_16x16x32_bf16 v[124:127], v[44:47], v[60:63], v[124:127]
s_sub_u32 s18, s18, 1
s_cmp_eq_u32 s18, s55
s_cbranch_scc1 main_kernel_w_c0_n_ev
s_cmp_lg_u32 s18, 0
s_cbranch_scc1 main_kernel_w_c0_n_loop
s_cmp_lg_u32 s73, -1
s_cbranch_scc1 main_kernel_w_epn
s_waitcnt lgkmcnt(0)
ds_read_b128 v[48:51], v136 offset:1024
s_add_u32 m0, s19, 49152
s_nop 0
v_mfma_f32_16x16x32_bf16 v[64:67], v[0:3], v[16:19], v[64:67]
ds_read_b64_tr_b16 v[32:33], v128 offset:8192
s_add_u32 s32, s23, 1
s_bitcmp0_b32 s32, 2
s_cselect_b32 s34, 7, 2
s_cselect_b32 s35, 2, 4
s_lshl_b32 s59, s23, 13
s_add_u32 s59, s59, 0x8404000
v_mfma_f32_16x16x32_bf16 v[68:71], v[4:7], v[16:19], v[68:71]
ds_read_b64_tr_b16 v[34:35], v128 offset:12288
buffer_load_dwordx4 v137, s[8:11], s15 offen offset:0 lds
v_lshrrev_b32 v253, 3, v250
v_add_lshl_u32 v253, s24, v253, 9
v_mfma_f32_16x16x32_bf16 v[72:75], v[8:11], v[16:19], v[72:75]
ds_read_b64_tr_b16 v[36:37], v129 offset:8192
v_and_b32 v254, 3, v250
v_lshl_add_u32 v253, v254, s34, v253
v_mfma_f32_16x16x32_bf16 v[76:79], v[12:15], v[16:19], v[76:79]
ds_read_b64_tr_b16 v[38:39], v129 offset:12288
v_bfe_u32 v254, v250, 2, 1
v_add_u32 v254, s25, v254
v_lshl_add_u32 v248, v254, s35, v253
v_mfma_f32_16x16x32_bf16 v[80:83], v[0:3], v[20:23], v[80:83]
ds_read_b64_tr_b16 v[40:41], v130 offset:8192
buffer_load_dwordx4 v138, s[8:11], s15 offen offset:1024 lds
s_lshl_b32 s0, 4, s54
v_readfirstlane_b32 s28, v249
v_mfma_f32_16x16x32_bf16 v[84:87], v[4:7], v[20:23], v[84:87]
ds_read_b64_tr_b16 v[42:43], v130 offset:12288
s_nop 1
v_cmp_ge_u32 vcc, s28, v229
v_mfma_f32_16x16x32_bf16 v[88:91], v[8:11], v[20:23], v[88:91]
ds_read_b64_tr_b16 v[44:45], v131 offset:8192
s_nop 1
s_bcnt1_i32_b64 s32, vcc
v_mfma_f32_16x16x32_bf16 v[92:95], v[12:15], v[20:23], v[92:95]
ds_read_b64_tr_b16 v[46:47], v131 offset:12288
buffer_load_dwordx4 v139, s[8:11], s15 offen offset:2048 lds
s_sub_u32 s32, s32, 1
v_readlane_b32 s36, v230, s32
s_nop 1
v_mfma_f32_16x16x32_bf16 v[96:99], v[0:3], v[24:27], v[96:99]
ds_read_b128 v[52:55], v136 offset:3072
s_and_b32 s32, s36, 0x7ff
s_sub_u32 s28, s28, s32
v_mfma_f32_16x16x32_bf16 v[100:103], v[4:7], v[24:27], v[100:103]
ds_read_b128 v[56:59], v136 offset:5120
buffer_load_dwordx4 v140, s[8:11], s15 offen offset:3072 lds
s_bfe_u32 s32, s36, 0x3001a
s_lshr_b32 s25, s28, s32
v_mfma_f32_16x16x32_bf16 v[104:107], v[8:11], v[24:27], v[104:107]
ds_read_b128 v[60:63], v136 offset:7168
s_lshl_b32 s33, s25, s32
s_sub_u32 s24, s28, s33
v_mfma_f32_16x16x32_bf16 v[108:111], v[12:15], v[24:27], v[108:111]
s_bfe_u32 s34, s36, 0x1001d
s_lshl_b32 s24, s24, s34
s_bfe_u32 s35, s36, 0x1001e
v_mfma_f32_16x16x32_bf16 v[112:115], v[0:3], v[28:31], v[112:115]
s_add_u32 s15, s15, s17
s_lshl_b32 s25, s25, s35
s_bfe_u32 s32, s36, 0x40011
v_mfma_f32_16x16x32_bf16 v[116:119], v[4:7], v[28:31], v[116:119]
s_add_u32 s24, s24, s32
s_bfe_u32 s32, s36, 0x50015
v_mfma_f32_16x16x32_bf16 v[120:123], v[8:11], v[28:31], v[120:123]
s_add_u32 s25, s25, s32
s_bfe_u32 s23, s36, 0x4000b
v_mfma_f32_16x16x32_bf16 v[124:127], v[12:15], v[28:31], v[124:127]
s_waitcnt lgkmcnt(0)
v_mfma_f32_16x16x32_bf16 v[64:67], v[32:35], v[48:51], v[64:67]
s_waitcnt vmcnt(16)
s_barrier
ds_read_b128 v[16:19], v136 offset:16384
s_add_u32 m0, s20, 0
s_nop 0
s_bfe_u32 s36, s36, 0x6000b
s_lshl_b32 s32, s24, 8
s_or_b32 s36, s36, s32
v_mfma_f32_16x16x32_bf16 v[68:71], v[36:39], v[48:51], v[68:71]
ds_read_b64_tr_b16 v[0:1], v128 offset:16384
s_lshl_b32 s32, s25, 16
s_or_b32 s36, s36, s32
v_mfma_f32_16x16x32_bf16 v[72:75], v[40:43], v[48:51], v[72:75]
ds_read_b64_tr_b16 v[2:3], v128 offset:20480
buffer_load_dwordx4 v141, s[4:7], s16 offen offset:0 sc1 lds
s_cmp_eq_u32 s23, 4
s_cselect_b32 s32, 1, 0
s_sub_u32 s48, s24, s32
v_mfma_f32_16x16x32_bf16 v[76:79], v[44:47], v[48:51], v[76:79]
ds_read_b64_tr_b16 v[4:5], v129 offset:16384
s_max_i32 s48, s48, 0
s_add_u32 s49, s24, s34
s_add_u32 s49, s49, s32
v_mfma_f32_16x16x32_bf16 v[80:83], v[32:35], v[52:55], v[80:83]
ds_read_b64_tr_b16 v[6:7], v129 offset:20480
s_min_u32 s49, s49, 15
s_cmp_eq_u32 s23, 6
s_cselect_b32 s51, 3, 7
v_mfma_f32_16x16x32_bf16 v[84:87], v[36:39], v[52:55], v[84:87]
ds_read_b64_tr_b16 v[8:9], v130 offset:16384
buffer_load_dwordx4 v141, s[4:7], s16 offen offset:1024 sc1 lds
s_cmp_eq_u32 s23, 7
s_cselect_b32 s51, 27, s51
s_cselect_b32 s50, 5, 4
s_add_u32 s33, s25, s35
v_mfma_f32_16x16x32_bf16 v[88:91], v[40:43], v[52:55], v[88:91]
ds_read_b64_tr_b16 v[10:11], v130 offset:20480
s_lshl_b32 s34, s24, 9
s_cmp_eq_u32 s23, 8
s_cselect_b32 s51, 0, s51
s_cselect_b32 s48, s25, s48
s_cselect_b32 s49, s33, s49
v_mfma_f32_16x16x32_bf16 v[92:95], v[44:47], v[52:55], v[92:95]
ds_read_b64_tr_b16 v[12:13], v131 offset:16384
buffer_load_dwordx4 v142, s[4:7], s16 offen offset:2048 sc1 lds
s_cmp_eq_u32 s23, 8
s_cselect_b32 s63, 2, 9
s_cselect_b32 s61, 0, 0x7f000000
s_cselect_b32 s34, s34, 0
v_lshrrev_b32 v228, s50, v250
v_lshlrev_b32 v254, s50, v228
v_mfma_f32_16x16x32_bf16 v[96:99], v[32:35], v[56:59], v[96:99]
ds_read_b64_tr_b16 v[14:15], v131 offset:20480
v_sub_u32 v254, v250, v254
s_cmp_lt_u32 s23, 4
s_cselect_b32 s39, 10, s23
v_mfma_f32_16x16x32_bf16 v[100:103], v[36:39], v[56:59], v[100:103]
ds_read_b128 v[20:23], v136 offset:18432
v_min_u32 v254, s51, v254
s_lshl_b32 s39, s39, 13
v_mfma_f32_16x16x32_bf16 v[104:107], v[40:43], v[56:59], v[104:107]
ds_read_b128 v[24:27], v136 offset:20480
buffer_load_dwordx4 v142, s[4:7], s16 offen offset:3072 sc1 lds
s_cmp_eq_u32 s23, 3
s_cselect_b32 s34, 4, s34
v_add_u32 v228, s48, v228
v_mfma_f32_16x16x32_bf16 v[108:111], v[44:47], v[56:59], v[108:111]
ds_read_b128 v[28:31], v136 offset:22528
s_add_u32 s39, s39, s34
s_add_u32 s39, s39, 0x8402000
v_min_u32 v228, s49, v228
v_mfma_f32_16x16x32_bf16 v[112:115], v[32:35], v[60:63], v[112:115]
s_add_u32 s16, s16, 2048
s_lshl_b32 s60, s24, 10
s_add_u32 s60, s60, 0x8400000
v_mfma_f32_16x16x32_bf16 v[116:119], v[36:39], v[60:63], v[116:119]
v_lshlrev_b32 v228, s63, v228
v_lshl_add_u32 v228, v254, 4, v228
v_mfma_f32_16x16x32_bf16 v[120:123], v[40:43], v[60:63], v[120:123]
v_or_b32 v146, s61, v251
s_mov_b64 exec, s[100:101]
buffer_load_dword v231, v228, s[4:7], s39 offen sc1
buffer_load_dwordx4 v[232:235], v146, s[4:7], s60 offen sc1
s_mov_b64 exec, -1
v_mfma_f32_16x16x32_bf16 v[124:127], v[44:47], v[60:63], v[124:127]
s_waitcnt lgkmcnt(0)
ds_read_b128 v[48:51], v136 offset:17408
s_add_u32 m0, s19, 0
s_nop 0
v_mfma_f32_16x16x32_bf16 v[64:67], v[0:3], v[16:19], v[64:67]
ds_read_b64_tr_b16 v[32:33], v128 offset:24576
s_mov_b32 s1, s21
v_mfma_f32_16x16x32_bf16 v[68:71], v[4:7], v[16:19], v[68:71]
ds_read_b64_tr_b16 v[34:35], v128 offset:28672
buffer_load_dwordx4 v137, s[8:11], s15 offen offset:0 lds
s_mov_b32 s2, s22
v_mfma_f32_16x16x32_bf16 v[72:75], v[8:11], v[16:19], v[72:75]
ds_read_b64_tr_b16 v[36:37], v129 offset:24576
s_mov_b32 s3, s26
v_mfma_f32_16x16x32_bf16 v[76:79], v[12:15], v[16:19], v[76:79]
ds_read_b64_tr_b16 v[38:39], v129 offset:28672
s_mov_b32 s56, s57
v_mfma_f32_16x16x32_bf16 v[80:83], v[0:3], v[20:23], v[80:83]
ds_read_b64_tr_b16 v[40:41], v130 offset:24576
buffer_load_dwordx4 v138, s[8:11], s15 offen offset:1024 lds
v_mfma_f32_16x16x32_bf16 v[84:87], v[4:7], v[20:23], v[84:87]
ds_read_b64_tr_b16 v[42:43], v130 offset:28672
v_mov_b32 v145, v252
v_mfma_f32_16x16x32_bf16 v[88:91], v[8:11], v[20:23], v[88:91]
ds_read_b64_tr_b16 v[44:45], v131 offset:24576
v_mov_b32 v255, 131072
v_mfma_f32_16x16x32_bf16 v[92:95], v[12:15], v[20:23], v[92:95]
ds_read_b64_tr_b16 v[46:47], v131 offset:28672
buffer_load_dwordx4 v139, s[8:11], s15 offen offset:2048 lds
s_add_u32 s32, s3, 0
v_mfma_f32_16x16x32_bf16 v[96:99], v[0:3], v[24:27], v[96:99]
ds_read_b128 v[52:55], v136 offset:19456
buffer_load_dwordx4 v[192:195], v251, s[4:7], s32 offen offset:0 sc1
v_mfma_f32_16x16x32_bf16 v[100:103], v[4:7], v[24:27], v[100:103]
ds_read_b128 v[56:59], v136 offset:21504
buffer_load_dwordx4 v140, s[8:11], s15 offen offset:3072 lds
v_mfma_f32_16x16x32_bf16 v[104:107], v[8:11], v[24:27], v[104:107]
ds_read_b128 v[60:63], v136 offset:23552
buffer_load_dwordx4 v[196:199], v251, s[4:7], s32 offen offset:1024 sc1
v_mfma_f32_16x16x32_bf16 v[108:111], v[12:15], v[24:27], v[108:111]
s_add_u32 s32, s3, 32768
v_mfma_f32_16x16x32_bf16 v[112:115], v[0:3], v[28:31], v[112:115]
s_add_u32 s15, s15, s17
buffer_load_dwordx4 v[200:203], v251, s[4:7], s32 offen offset:0 sc1
v_mfma_f32_16x16x32_bf16 v[116:119], v[4:7], v[28:31], v[116:119]
buffer_load_dwordx4 v[204:207], v251, s[4:7], s32 offen offset:1024 sc1
v_mfma_f32_16x16x32_bf16 v[120:123], v[8:11], v[28:31], v[120:123]
v_mfma_f32_16x16x32_bf16 v[124:127], v[12:15], v[28:31], v[124:127]
s_waitcnt lgkmcnt(0)
v_mfma_f32_16x16x32_bf16 v[64:67], v[32:35], v[48:51], v[64:67]
s_waitcnt vmcnt(20)
s_barrier
ds_read_b128 v[16:19], v136 offset:32768
s_add_u32 m0, s20, 16384
s_nop 0
s_add_u32 s32, s3, 65536
v_mfma_f32_16x16x32_bf16 v[68:71], v[36:39], v[48:51], v[68:71]
ds_read_b64_tr_b16 v[0:1], v128 offset:32768
v_mfma_f32_16x16x32_bf16 v[72:75], v[40:43], v[48:51], v[72:75]
ds_read_b64_tr_b16 v[2:3], v128 offset:36864
buffer_load_dwordx4 v141, s[4:7], s16 offen offset:0 sc1 lds
buffer_load_dwordx4 v[208:211], v251, s[4:7], s32 offen offset:0 sc1
v_mfma_f32_16x16x32_bf16 v[76:79], v[44:47], v[48:51], v[76:79]
ds_read_b64_tr_b16 v[4:5], v129 offset:32768
v_mfma_f32_16x16x32_bf16 v[80:83], v[32:35], v[52:55], v[80:83]
ds_read_b64_tr_b16 v[6:7], v129 offset:36864
v_mfma_f32_16x16x32_bf16 v[84:87], v[36:39], v[52:55], v[84:87]
ds_read_b64_tr_b16 v[8:9], v130 offset:32768
buffer_load_dwordx4 v141, s[4:7], s16 offen offset:1024 sc1 lds
buffer_load_dwordx4 v[212:215], v251, s[4:7], s32 offen offset:1024 sc1
v_mfma_f32_16x16x32_bf16 v[88:91], v[40:43], v[52:55], v[88:91]
ds_read_b64_tr_b16 v[10:11], v130 offset:36864
v_mfma_f32_16x16x32_bf16 v[92:95], v[44:47], v[52:55], v[92:95]
ds_read_b64_tr_b16 v[12:13], v131 offset:32768
buffer_load_dwordx4 v142, s[4:7], s16 offen offset:2048 sc1 lds
s_add_u32 s32, s3, 98304
v_mfma_f32_16x16x32_bf16 v[96:99], v[32:35], v[56:59], v[96:99]
ds_read_b64_tr_b16 v[14:15], v131 offset:36864
v_mfma_f32_16x16x32_bf16 v[100:103], v[36:39], v[56:59], v[100:103]
ds_read_b128 v[20:23], v136 offset:34816
v_mfma_f32_16x16x32_bf16 v[104:107], v[40:43], v[56:59], v[104:107]
ds_read_b128 v[24:27], v136 offset:36864
buffer_load_dwordx4 v142, s[4:7], s16 offen offset:3072 sc1 lds
buffer_load_dwordx4 v[216:219], v251, s[4:7], s32 offen offset:0 sc1
v_mfma_f32_16x16x32_bf16 v[108:111], v[44:47], v[56:59], v[108:111]
ds_read_b128 v[28:31], v136 offset:38912
v_mfma_f32_16x16x32_bf16 v[112:115], v[32:35], v[60:63], v[112:115]
s_add_u32 s16, s16, 2048
buffer_load_dwordx4 v[220:223], v251, s[4:7], s32 offen offset:1024 sc1
v_mfma_f32_16x16x32_bf16 v[116:119], v[36:39], v[60:63], v[116:119]
v_mfma_f32_16x16x32_bf16 v[120:123], v[40:43], v[60:63], v[120:123]
v_mfma_f32_16x16x32_bf16 v[124:127], v[44:47], v[60:63], v[124:127]
s_cmp_lg_u32 s56, 5
s_cbranch_scc1 main_kernel_w_c0_n_nox
s_add_u32 s32, s1, 0
buffer_load_dwordx4 v[160:163], v145, s[96:99], s32 offen offset:0
buffer_load_dwordx4 v[164:167], v145, s[96:99], s32 offen offset:64
s_add_u32 s32, s1, 32768
buffer_load_dwordx4 v[168:171], v145, s[96:99], s32 offen offset:0
buffer_load_dwordx4 v[172:175], v145, s[96:99], s32 offen offset:64
s_add_u32 s32, s1, 65536
buffer_load_dwordx4 v[176:179], v145, s[96:99], s32 offen offset:0
buffer_load_dwordx4 v[180:183], v145, s[96:99], s32 offen offset:64
s_add_u32 s32, s1, 98304
buffer_load_dwordx4 v[184:187], v145, s[96:99], s32 offen offset:0
buffer_load_dwordx4 v[188:191], v145, s[96:99], s32 offen offset:64
main_kernel_w_c0_n_nox:
s_waitcnt lgkmcnt(0)
ds_read_b128 v[48:51], v136 offset:33792
s_add_u32 m0, s19, 16384
s_nop 0
v_mfma_f32_16x16x32_bf16 v[64:67], v[0:3], v[16:19], v[64:67]
ds_read_b64_tr_b16 v[32:33], v128 offset:40960
v_mfma_f32_16x16x32_bf16 v[68:71], v[4:7], v[16:19], v[68:71]
ds_read_b64_tr_b16 v[34:35], v128 offset:45056
buffer_load_dwordx4 v137, s[8:11], s15 offen offset:0 lds
v_mfma_f32_16x16x32_bf16 v[72:75], v[8:11], v[16:19], v[72:75]
ds_read_b64_tr_b16 v[36:37], v129 offset:40960
v_mfma_f32_16x16x32_bf16 v[76:79], v[12:15], v[16:19], v[76:79]
ds_read_b64_tr_b16 v[38:39], v129 offset:45056
v_mfma_f32_16x16x32_bf16 v[80:83], v[0:3], v[20:23], v[80:83]
ds_read_b64_tr_b16 v[40:41], v130 offset:40960
buffer_load_dwordx4 v138, s[8:11], s15 offen offset:1024 lds
v_mfma_f32_16x16x32_bf16 v[84:87], v[4:7], v[20:23], v[84:87]
ds_read_b64_tr_b16 v[42:43], v130 offset:45056
v_mfma_f32_16x16x32_bf16 v[88:91], v[8:11], v[20:23], v[88:91]
ds_read_b64_tr_b16 v[44:45], v131 offset:40960
v_mfma_f32_16x16x32_bf16 v[92:95], v[12:15], v[20:23], v[92:95]
ds_read_b64_tr_b16 v[46:47], v131 offset:45056
buffer_load_dwordx4 v139, s[8:11], s15 offen offset:2048 lds
v_mfma_f32_16x16x32_bf16 v[96:99], v[0:3], v[24:27], v[96:99]
ds_read_b128 v[52:55], v136 offset:35840
v_mfma_f32_16x16x32_bf16 v[100:103], v[4:7], v[24:27], v[100:103]
ds_read_b128 v[56:59], v136 offset:37888
buffer_load_dwordx4 v140, s[8:11], s15 offen offset:3072 lds
v_mfma_f32_16x16x32_bf16 v[104:107], v[8:11], v[24:27], v[104:107]
ds_read_b128 v[60:63], v136 offset:39936
v_mfma_f32_16x16x32_bf16 v[108:111], v[12:15], v[24:27], v[108:111]
v_mfma_f32_16x16x32_bf16 v[112:115], v[0:3], v[28:31], v[112:115]
s_add_u32 s15, s15, s17
v_mfma_f32_16x16x32_bf16 v[116:119], v[4:7], v[28:31], v[116:119]
v_mfma_f32_16x16x32_bf16 v[120:123], v[8:11], v[28:31], v[120:123]
v_mfma_f32_16x16x32_bf16 v[124:127], v[12:15], v[28:31], v[124:127]
s_waitcnt lgkmcnt(0)
v_mfma_f32_16x16x32_bf16 v[64:67], v[32:35], v[48:51], v[64:67]
s_waitcnt vmcnt(24)
s_barrier
ds_read_b128 v[16:19], v136 offset:49152
s_add_u32 m0, s20, 32768
s_nop 0
v_mfma_f32_16x16x32_bf16 v[68:71], v[36:39], v[48:51], v[68:71]
ds_read_b64_tr_b16 v[0:1], v128 offset:49152
v_mfma_f32_16x16x32_bf16 v[72:75], v[40:43], v[48:51], v[72:75]
ds_read_b64_tr_b16 v[2:3], v128 offset:53248
buffer_load_dwordx4 v141, s[4:7], s16 offen offset:0 sc1 lds
v_mfma_f32_16x16x32_bf16 v[76:79], v[44:47], v[48:51], v[76:79]
ds_read_b64_tr_b16 v[4:5], v129 offset:49152
v_mfma_f32_16x16x32_bf16 v[80:83], v[32:35], v[52:55], v[80:83]
ds_read_b64_tr_b16 v[6:7], v129 offset:53248
s_waitcnt vmcnt(21)
v_min3_u32 v253, v232, v233, v234
v_mfma_f32_16x16x32_bf16 v[84:87], v[36:39], v[52:55], v[84:87]
ds_read_b64_tr_b16 v[8:9], v130 offset:49152
buffer_load_dwordx4 v141, s[4:7], s16 offen offset:1024 sc1 lds
v_min_u32 v253, v253, v235
v_mfma_f32_16x16x32_bf16 v[88:91], v[40:43], v[52:55], v[88:91]
ds_read_b64_tr_b16 v[10:11], v130 offset:53248
v_or_b32 v253, s61, v253
v_mfma_f32_16x16x32_bf16 v[92:95], v[44:47], v[52:55], v[92:95]
ds_read_b64_tr_b16 v[12:13], v131 offset:49152
buffer_load_dwordx4 v142, s[4:7], s16 offen offset:2048 sc1 lds
v_min_u32 v253, v253, v231
v_mfma_f32_16x16x32_bf16 v[96:99], v[32:35], v[56:59], v[96:99]
ds_read_b64_tr_b16 v[14:15], v131 offset:53248
v_cmp_eq_u32 vcc, 0, v253
v_mfma_f32_16x16x32_bf16 v[100:103], v[36:39], v[56:59], v[100:103]
ds_read_b128 v[20:23], v136 offset:51200
s_nop 1
v_mfma_f32_16x16x32_bf16 v[104:107], v[40:43], v[56:59], v[104:107]
ds_read_b128 v[24:27], v136 offset:53248
buffer_load_dwordx4 v142, s[4:7], s16 offen offset:3072 sc1 lds
s_cmp_eq_u64 vcc, 0
s_cselect_b32 s32, s36, -4
v_mfma_f32_16x16x32_bf16 v[108:111], v[44:47], v[56:59], v[108:111]
ds_read_b128 v[28:31], v136 offset:55296
s_bitcmp1_b32 0x1df, s23
s_cselect_b32 s32, s32, -4
v_mfma_f32_16x16x32_bf16 v[112:115], v[32:35], v[60:63], v[112:115]
s_add_u32 s16, s16, 2048
s_sub_u32 s33, s59, 0x8406000
s_cmp_lt_u32 s33, 0x4000
s_cselect_b32 s32, -4, s32
v_mfma_f32_16x16x32_bf16 v[116:119], v[36:39], v[60:63], v[116:119]
v_mov_b32 v254, s32
v_mfma_f32_16x16x32_bf16 v[120:123], v[40:43], v[60:63], v[120:123]
s_mov_b64 exec, s[100:101]
ds_write_b32 v255, v254
s_mov_b64 exec, -1
v_mfma_f32_16x16x32_bf16 v[124:127], v[44:47], v[60:63], v[124:127]
s_waitcnt lgkmcnt(0)
ds_read_b128 v[48:51], v136 offset:50176
s_add_u32 m0, s19, 32768
s_nop 0
v_mfma_f32_16x16x32_bf16 v[64:67], v[0:3], v[16:19], v[64:67]
ds_read_b64_tr_b16 v[32:33], v128 offset:57344
v_mfma_f32_16x16x32_bf16 v[68:71], v[4:7], v[16:19], v[68:71]
ds_read_b64_tr_b16 v[34:35], v128 offset:61440
buffer_load_dwordx4 v137, s[8:11], s15 offen offset:0 lds
v_mfma_f32_16x16x32_bf16 v[72:75], v[8:11], v[16:19], v[72:75]
ds_read_b64_tr_b16 v[36:37], v129 offset:57344
v_mfma_f32_16x16x32_bf16 v[76:79], v[12:15], v[16:19], v[76:79]
ds_read_b64_tr_b16 v[38:39], v129 offset:61440
v_mfma_f32_16x16x32_bf16 v[80:83], v[0:3], v[20:23], v[80:83]
ds_read_b64_tr_b16 v[40:41], v130 offset:57344
buffer_load_dwordx4 v138, s[8:11], s15 offen offset:1024 lds
v_mfma_f32_16x16x32_bf16 v[84:87], v[4:7], v[20:23], v[84:87]
ds_read_b64_tr_b16 v[42:43], v130 offset:61440
v_mfma_f32_16x16x32_bf16 v[88:91], v[8:11], v[20:23], v[88:91]
ds_read_b64_tr_b16 v[44:45], v131 offset:57344
v_mfma_f32_16x16x32_bf16 v[92:95], v[12:15], v[20:23], v[92:95]
ds_read_b64_tr_b16 v[46:47], v131 offset:61440
buffer_load_dwordx4 v139, s[8:11], s15 offen offset:2048 lds
v_mfma_f32_16x16x32_bf16 v[96:99], v[0:3], v[24:27], v[96:99]
ds_read_b128 v[52:55], v136 offset:52224
v_mfma_f32_16x16x32_bf16 v[100:103], v[4:7], v[24:27], v[100:103]
ds_read_b128 v[56:59], v136 offset:54272
buffer_load_dwordx4 v140, s[8:11], s15 offen offset:3072 lds
v_mfma_f32_16x16x32_bf16 v[104:107], v[8:11], v[24:27], v[104:107]
ds_read_b128 v[60:63], v136 offset:56320
v_mfma_f32_16x16x32_bf16 v[108:111], v[12:15], v[24:27], v[108:111]
v_mfma_f32_16x16x32_bf16 v[112:115], v[0:3], v[28:31], v[112:115]
s_add_u32 s15, s15, s17
v_mfma_f32_16x16x32_bf16 v[116:119], v[4:7], v[28:31], v[116:119]
v_mfma_f32_16x16x32_bf16 v[120:123], v[8:11], v[28:31], v[120:123]
v_mfma_f32_16x16x32_bf16 v[124:127], v[12:15], v[28:31], v[124:127]
s_waitcnt lgkmcnt(0)
v_mfma_f32_16x16x32_bf16 v[64:67], v[32:35], v[48:51], v[64:67]
s_waitcnt vmcnt(23)
s_barrier
ds_read_b128 v[16:19], v136 offset:0
s_add_u32 m0, s20, 49152
s_nop 0
ds_read_b32 v254, v255
v_mfma_f32_16x16x32_bf16 v[68:71], v[36:39], v[48:51], v[68:71]
ds_read_b64_tr_b16 v[0:1], v128 offset:0
v_mfma_f32_16x16x32_bf16 v[72:75], v[40:43], v[48:51], v[72:75]
ds_read_b64_tr_b16 v[2:3], v128 offset:4096
buffer_load_dwordx4 v141, s[4:7], s16 offen offset:0 sc1 lds
v_mfma_f32_16x16x32_bf16 v[76:79], v[44:47], v[48:51], v[76:79]
ds_read_b64_tr_b16 v[4:5], v129 offset:0
v_mfma_f32_16x16x32_bf16 v[80:83], v[32:35], v[52:55], v[80:83]
ds_read_b64_tr_b16 v[6:7], v129 offset:4096
v_mfma_f32_16x16x32_bf16 v[84:87], v[36:39], v[52:55], v[84:87]
ds_read_b64_tr_b16 v[8:9], v130 offset:0
buffer_load_dwordx4 v141, s[4:7], s16 offen offset:1024 sc1 lds
v_mfma_f32_16x16x32_bf16 v[88:91], v[40:43], v[52:55], v[88:91]
ds_read_b64_tr_b16 v[10:11], v130 offset:4096
v_mfma_f32_16x16x32_bf16 v[92:95], v[44:47], v[52:55], v[92:95]
ds_read_b64_tr_b16 v[12:13], v131 offset:0
buffer_load_dwordx4 v142, s[4:7], s16 offen offset:2048 sc1 lds
v_mfma_f32_16x16x32_bf16 v[96:99], v[32:35], v[56:59], v[96:99]
ds_read_b64_tr_b16 v[14:15], v131 offset:4096
v_mfma_f32_16x16x32_bf16 v[100:103], v[36:39], v[56:59], v[100:103]
ds_read_b128 v[20:23], v136 offset:2048
v_mfma_f32_16x16x32_bf16 v[104:107], v[40:43], v[56:59], v[104:107]
ds_read_b128 v[24:27], v136 offset:4096
buffer_load_dwordx4 v142, s[4:7], s16 offen offset:3072 sc1 lds
v_mfma_f32_16x16x32_bf16 v[108:111], v[44:47], v[56:59], v[108:111]
ds_read_b128 v[28:31], v136 offset:6144
v_mfma_f32_16x16x32_bf16 v[112:115], v[32:35], v[60:63], v[112:115]
s_add_u32 s16, s16, 2048
v_mfma_f32_16x16x32_bf16 v[116:119], v[36:39], v[60:63], v[116:119]
v_mfma_f32_16x16x32_bf16 v[120:123], v[40:43], v[60:63], v[120:123]
v_mfma_f32_16x16x32_bf16 v[124:127], v[44:47], v[60:63], v[124:127]
s_waitcnt lgkmcnt(0)
ds_read_b128 v[48:51], v136 offset:1024
s_add_u32 m0, s19, 49152
s_nop 0
v_mfma_f32_16x16x32_bf16 v[64:67], v[0:3], v[16:19], v[64:67]
ds_read_b64_tr_b16 v[32:33], v128 offset:8192
v_readfirstlane_b32 s62, v254
v_mfma_f32_16x16x32_bf16 v[68:71], v[4:7], v[16:19], v[68:71]
ds_read_b64_tr_b16 v[34:35], v128 offset:12288
buffer_load_dwordx4 v137, s[8:11], s15 offen offset:0 lds
v_mfma_f32_16x16x32_bf16 v[72:75], v[8:11], v[16:19], v[72:75]
ds_read_b64_tr_b16 v[36:37], v129 offset:8192
s_nop 1
v_mfma_f32_16x16x32_bf16 v[76:79], v[12:15], v[16:19], v[76:79]
ds_read_b64_tr_b16 v[38:39], v129 offset:12288
v_mfma_f32_16x16x32_bf16 v[80:83], v[0:3], v[20:23], v[80:83]
ds_read_b64_tr_b16 v[40:41], v130 offset:8192
buffer_load_dwordx4 v138, s[8:11], s15 offen offset:1024 lds
v_mfma_f32_16x16x32_bf16 v[84:87], v[4:7], v[20:23], v[84:87]
ds_read_b64_tr_b16 v[42:43], v130 offset:12288
s_and_b32 s23, s62, 15
v_mfma_f32_16x16x32_bf16 v[88:91], v[8:11], v[20:23], v[88:91]
ds_read_b64_tr_b16 v[44:45], v131 offset:8192
v_mfma_f32_16x16x32_bf16 v[92:95], v[12:15], v[20:23], v[92:95]
ds_read_b64_tr_b16 v[46:47], v131 offset:12288
buffer_load_dwordx4 v139, s[8:11], s15 offen offset:2048 lds
s_bfe_u32 s54, s62, 0x20004
v_mfma_f32_16x16x32_bf16 v[96:99], v[0:3], v[24:27], v[96:99]
ds_read_b128 v[52:55], v136 offset:3072
v_mfma_f32_16x16x32_bf16 v[100:103], v[4:7], v[24:27], v[100:103]
ds_read_b128 v[56:59], v136 offset:5120
buffer_load_dwordx4 v140, s[8:11], s15 offen offset:3072 lds
v_mfma_f32_16x16x32_bf16 v[104:107], v[8:11], v[24:27], v[104:107]
ds_read_b128 v[60:63], v136 offset:7168
s_bfe_u32 s24, s62, 0x80008
v_mfma_f32_16x16x32_bf16 v[108:111], v[12:15], v[24:27], v[108:111]
v_mfma_f32_16x16x32_bf16 v[112:115], v[0:3], v[28:31], v[112:115]
s_add_u32 s15, s15, s17
s_lshr_b32 s25, s62, 16
v_mfma_f32_16x16x32_bf16 v[116:119], v[4:7], v[28:31], v[116:119]
v_mfma_f32_16x16x32_bf16 v[120:123], v[8:11], v[28:31], v[120:123]
v_mfma_f32_16x16x32_bf16 v[124:127], v[12:15], v[28:31], v[124:127]
s_cmp_eq_u32 s54, 0
s_cselect_b32 s73, 0, -1
s_cbranch_scc1 main_kernel_w_c0_task
s_waitcnt lgkmcnt(0)
v_mfma_f32_16x16x32_bf16 v[64:67], v[32:35], v[48:51], v[64:67]
s_waitcnt vmcnt(16)
s_barrier
ds_read_b128 v[16:19], v136 offset:16384
v_mfma_f32_16x16x32_bf16 v[68:71], v[36:39], v[48:51], v[68:71]
ds_read_b64_tr_b16 v[0:1], v128 offset:16384
v_mfma_f32_16x16x32_bf16 v[72:75], v[40:43], v[48:51], v[72:75]
ds_read_b64_tr_b16 v[2:3], v128 offset:20480
v_mfma_f32_16x16x32_bf16 v[76:79], v[44:47], v[48:51], v[76:79]
ds_read_b64_tr_b16 v[4:5], v129 offset:16384
v_mfma_f32_16x16x32_bf16 v[80:83], v[32:35], v[52:55], v[80:83]
ds_read_b64_tr_b16 v[6:7], v129 offset:20480
v_mfma_f32_16x16x32_bf16 v[84:87], v[36:39], v[52:55], v[84:87]
ds_read_b64_tr_b16 v[8:9], v130 offset:16384
v_mfma_f32_16x16x32_bf16 v[88:91], v[40:43], v[52:55], v[88:91]
ds_read_b64_tr_b16 v[10:11], v130 offset:20480
v_mfma_f32_16x16x32_bf16 v[92:95], v[44:47], v[52:55], v[92:95]
ds_read_b64_tr_b16 v[12:13], v131 offset:16384
v_mfma_f32_16x16x32_bf16 v[96:99], v[32:35], v[56:59], v[96:99]
ds_read_b64_tr_b16 v[14:15], v131 offset:20480
v_mfma_f32_16x16x32_bf16 v[100:103], v[36:39], v[56:59], v[100:103]
ds_read_b128 v[20:23], v136 offset:18432
v_mfma_f32_16x16x32_bf16 v[104:107], v[40:43], v[56:59], v[104:107]
ds_read_b128 v[24:27], v136 offset:20480
v_mfma_f32_16x16x32_bf16 v[108:111], v[44:47], v[56:59], v[108:111]
ds_read_b128 v[28:31], v136 offset:22528
v_mfma_f32_16x16x32_bf16 v[112:115], v[32:35], v[60:63], v[112:115]
v_mfma_f32_16x16x32_bf16 v[116:119], v[36:39], v[60:63], v[116:119]
v_mfma_f32_16x16x32_bf16 v[120:123], v[40:43], v[60:63], v[120:123]
v_mfma_f32_16x16x32_bf16 v[124:127], v[44:47], v[60:63], v[124:127]
s_waitcnt lgkmcnt(0)
ds_read_b128 v[48:51], v136 offset:17408
v_mfma_f32_16x16x32_bf16 v[64:67], v[0:3], v[16:19], v[64:67]
ds_read_b64_tr_b16 v[32:33], v128 offset:24576
v_mfma_f32_16x16x32_bf16 v[68:71], v[4:7], v[16:19], v[68:71]
ds_read_b64_tr_b16 v[34:35], v128 offset:28672
v_mfma_f32_16x16x32_bf16 v[72:75], v[8:11], v[16:19], v[72:75]
ds_read_b64_tr_b16 v[36:37], v129 offset:24576
v_mfma_f32_16x16x32_bf16 v[76:79], v[12:15], v[16:19], v[76:79]
ds_read_b64_tr_b16 v[38:39], v129 offset:28672
v_mfma_f32_16x16x32_bf16 v[80:83], v[0:3], v[20:23], v[80:83]
ds_read_b64_tr_b16 v[40:41], v130 offset:24576
v_mfma_f32_16x16x32_bf16 v[84:87], v[4:7], v[20:23], v[84:87]
ds_read_b64_tr_b16 v[42:43], v130 offset:28672
v_mfma_f32_16x16x32_bf16 v[88:91], v[8:11], v[20:23], v[88:91]
ds_read_b64_tr_b16 v[44:45], v131 offset:24576
v_mfma_f32_16x16x32_bf16 v[92:95], v[12:15], v[20:23], v[92:95]
ds_read_b64_tr_b16 v[46:47], v131 offset:28672
v_mfma_f32_16x16x32_bf16 v[96:99], v[0:3], v[24:27], v[96:99]
ds_read_b128 v[52:55], v136 offset:19456
v_mfma_f32_16x16x32_bf16 v[100:103], v[4:7], v[24:27], v[100:103]
ds_read_b128 v[56:59], v136 offset:21504
v_mfma_f32_16x16x32_bf16 v[104:107], v[8:11], v[24:27], v[104:107]
ds_read_b128 v[60:63], v136 offset:23552
v_mfma_f32_16x16x32_bf16 v[108:111], v[12:15], v[24:27], v[108:111]
v_mfma_f32_16x16x32_bf16 v[112:115], v[0:3], v[28:31], v[112:115]
v_mfma_f32_16x16x32_bf16 v[116:119], v[4:7], v[28:31], v[116:119]
v_mfma_f32_16x16x32_bf16 v[120:123], v[8:11], v[28:31], v[120:123]
v_mfma_f32_16x16x32_bf16 v[124:127], v[12:15], v[28:31], v[124:127]
s_waitcnt lgkmcnt(0)
v_mfma_f32_16x16x32_bf16 v[64:67], v[32:35], v[48:51], v[64:67]
s_waitcnt vmcnt(8)
s_barrier
ds_read_b128 v[16:19], v136 offset:32768
v_mfma_f32_16x16x32_bf16 v[68:71], v[36:39], v[48:51], v[68:71]
ds_read_b64_tr_b16 v[0:1], v128 offset:32768
v_mfma_f32_16x16x32_bf16 v[72:75], v[40:43], v[48:51], v[72:75]
ds_read_b64_tr_b16 v[2:3], v128 offset:36864
v_mfma_f32_16x16x32_bf16 v[76:79], v[44:47], v[48:51], v[76:79]
ds_read_b64_tr_b16 v[4:5], v129 offset:32768
v_mfma_f32_16x16x32_bf16 v[80:83], v[32:35], v[52:55], v[80:83]
ds_read_b64_tr_b16 v[6:7], v129 offset:36864
v_mfma_f32_16x16x32_bf16 v[84:87], v[36:39], v[52:55], v[84:87]
ds_read_b64_tr_b16 v[8:9], v130 offset:32768
v_mfma_f32_16x16x32_bf16 v[88:91], v[40:43], v[52:55], v[88:91]
ds_read_b64_tr_b16 v[10:11], v130 offset:36864
v_mfma_f32_16x16x32_bf16 v[92:95], v[44:47], v[52:55], v[92:95]
ds_read_b64_tr_b16 v[12:13], v131 offset:32768
v_mfma_f32_16x16x32_bf16 v[96:99], v[32:35], v[56:59], v[96:99]
ds_read_b64_tr_b16 v[14:15], v131 offset:36864
v_mfma_f32_16x16x32_bf16 v[100:103], v[36:39], v[56:59], v[100:103]
ds_read_b128 v[20:23], v136 offset:34816
v_mfma_f32_16x16x32_bf16 v[104:107], v[40:43], v[56:59], v[104:107]
ds_read_b128 v[24:27], v136 offset:36864
v_mfma_f32_16x16x32_bf16 v[108:111], v[44:47], v[56:59], v[108:111]
ds_read_b128 v[28:31], v136 offset:38912
v_mfma_f32_16x16x32_bf16 v[112:115], v[32:35], v[60:63], v[112:115]
v_mfma_f32_16x16x32_bf16 v[116:119], v[36:39], v[60:63], v[116:119]
v_mfma_f32_16x16x32_bf16 v[120:123], v[40:43], v[60:63], v[120:123]
v_mfma_f32_16x16x32_bf16 v[124:127], v[44:47], v[60:63], v[124:127]
s_waitcnt lgkmcnt(0)
ds_read_b128 v[48:51], v136 offset:33792
v_mfma_f32_16x16x32_bf16 v[64:67], v[0:3], v[16:19], v[64:67]
ds_read_b64_tr_b16 v[32:33], v128 offset:40960
v_mfma_f32_16x16x32_bf16 v[68:71], v[4:7], v[16:19], v[68:71]
ds_read_b64_tr_b16 v[34:35], v128 offset:45056
v_mfma_f32_16x16x32_bf16 v[72:75], v[8:11], v[16:19], v[72:75]
ds_read_b64_tr_b16 v[36:37], v129 offset:40960
v_mfma_f32_16x16x32_bf16 v[76:79], v[12:15], v[16:19], v[76:79]
ds_read_b64_tr_b16 v[38:39], v129 offset:45056
v_mfma_f32_16x16x32_bf16 v[80:83], v[0:3], v[20:23], v[80:83]
ds_read_b64_tr_b16 v[40:41], v130 offset:40960
v_mfma_f32_16x16x32_bf16 v[84:87], v[4:7], v[20:23], v[84:87]
ds_read_b64_tr_b16 v[42:43], v130 offset:45056
v_mfma_f32_16x16x32_bf16 v[88:91], v[8:11], v[20:23], v[88:91]
ds_read_b64_tr_b16 v[44:45], v131 offset:40960
v_mfma_f32_16x16x32_bf16 v[92:95], v[12:15], v[20:23], v[92:95]
ds_read_b64_tr_b16 v[46:47], v131 offset:45056
v_mfma_f32_16x16x32_bf16 v[96:99], v[0:3], v[24:27], v[96:99]
ds_read_b128 v[52:55], v136 offset:35840
v_mfma_f32_16x16x32_bf16 v[100:103], v[4:7], v[24:27], v[100:103]
ds_read_b128 v[56:59], v136 offset:37888
v_mfma_f32_16x16x32_bf16 v[104:107], v[8:11], v[24:27], v[104:107]
ds_read_b128 v[60:63], v136 offset:39936
v_mfma_f32_16x16x32_bf16 v[108:111], v[12:15], v[24:27], v[108:111]
v_mfma_f32_16x16x32_bf16 v[112:115], v[0:3], v[28:31], v[112:115]
v_mfma_f32_16x16x32_bf16 v[116:119], v[4:7], v[28:31], v[116:119]
v_mfma_f32_16x16x32_bf16 v[120:123], v[8:11], v[28:31], v[120:123]
v_mfma_f32_16x16x32_bf16 v[124:127], v[12:15], v[28:31], v[124:127]
s_waitcnt lgkmcnt(0)
v_mfma_f32_16x16x32_bf16 v[64:67], v[32:35], v[48:51], v[64:67]
s_waitcnt vmcnt(0)
s_barrier
ds_read_b128 v[16:19], v136 offset:49152
v_mfma_f32_16x16x32_bf16 v[68:71], v[36:39], v[48:51], v[68:71]
ds_read_b64_tr_b16 v[0:1], v128 offset:49152
v_mfma_f32_16x16x32_bf16 v[72:75], v[40:43], v[48:51], v[72:75]
ds_read_b64_tr_b16 v[2:3], v128 offset:53248
v_mfma_f32_16x16x32_bf16 v[76:79], v[44:47], v[48:51], v[76:79]
ds_read_b64_tr_b16 v[4:5], v129 offset:49152
v_mfma_f32_16x16x32_bf16 v[80:83], v[32:35], v[52:55], v[80:83]
ds_read_b64_tr_b16 v[6:7], v129 offset:53248
v_mfma_f32_16x16x32_bf16 v[84:87], v[36:39], v[52:55], v[84:87]
ds_read_b64_tr_b16 v[8:9], v130 offset:49152
v_mfma_f32_16x16x32_bf16 v[88:91], v[40:43], v[52:55], v[88:91]
ds_read_b64_tr_b16 v[10:11], v130 offset:53248
v_mfma_f32_16x16x32_bf16 v[92:95], v[44:47], v[52:55], v[92:95]
ds_read_b64_tr_b16 v[12:13], v131 offset:49152
v_mfma_f32_16x16x32_bf16 v[96:99], v[32:35], v[56:59], v[96:99]
ds_read_b64_tr_b16 v[14:15], v131 offset:53248
v_mfma_f32_16x16x32_bf16 v[100:103], v[36:39], v[56:59], v[100:103]
ds_read_b128 v[20:23], v136 offset:51200
v_mfma_f32_16x16x32_bf16 v[104:107], v[40:43], v[56:59], v[104:107]
ds_read_b128 v[24:27], v136 offset:53248
v_mfma_f32_16x16x32_bf16 v[108:111], v[44:47], v[56:59], v[108:111]
ds_read_b128 v[28:31], v136 offset:55296
v_mfma_f32_16x16x32_bf16 v[112:115], v[32:35], v[60:63], v[112:115]
v_mfma_f32_16x16x32_bf16 v[116:119], v[36:39], v[60:63], v[116:119]
v_mfma_f32_16x16x32_bf16 v[120:123], v[40:43], v[60:63], v[120:123]
v_mfma_f32_16x16x32_bf16 v[124:127], v[44:47], v[60:63], v[124:127]
s_waitcnt lgkmcnt(0)
ds_read_b128 v[48:51], v136 offset:50176
v_mfma_f32_16x16x32_bf16 v[64:67], v[0:3], v[16:19], v[64:67]
ds_read_b64_tr_b16 v[32:33], v128 offset:57344
v_mfma_f32_16x16x32_bf16 v[68:71], v[4:7], v[16:19], v[68:71]
ds_read_b64_tr_b16 v[34:35], v128 offset:61440
v_mfma_f32_16x16x32_bf16 v[72:75], v[8:11], v[16:19], v[72:75]
ds_read_b64_tr_b16 v[36:37], v129 offset:57344
v_mfma_f32_16x16x32_bf16 v[76:79], v[12:15], v[16:19], v[76:79]
ds_read_b64_tr_b16 v[38:39], v129 offset:61440
v_mfma_f32_16x16x32_bf16 v[80:83], v[0:3], v[20:23], v[80:83]
ds_read_b64_tr_b16 v[40:41], v130 offset:57344
v_mfma_f32_16x16x32_bf16 v[84:87], v[4:7], v[20:23], v[84:87]
ds_read_b64_tr_b16 v[42:43], v130 offset:61440
v_mfma_f32_16x16x32_bf16 v[88:91], v[8:11], v[20:23], v[88:91]
ds_read_b64_tr_b16 v[44:45], v131 offset:57344
v_mfma_f32_16x16x32_bf16 v[92:95], v[12:15], v[20:23], v[92:95]
ds_read_b64_tr_b16 v[46:47], v131 offset:61440
v_mfma_f32_16x16x32_bf16 v[96:99], v[0:3], v[24:27], v[96:99]
ds_read_b128 v[52:55], v136 offset:52224
v_mfma_f32_16x16x32_bf16 v[100:103], v[4:7], v[24:27], v[100:103]
ds_read_b128 v[56:59], v136 offset:54272
v_mfma_f32_16x16x32_bf16 v[104:107], v[8:11], v[24:27], v[104:107]
ds_read_b128 v[60:63], v136 offset:56320
v_mfma_f32_16x16x32_bf16 v[108:111], v[12:15], v[24:27], v[108:111]
v_mfma_f32_16x16x32_bf16 v[112:115], v[0:3], v[28:31], v[112:115]
v_mfma_f32_16x16x32_bf16 v[116:119], v[4:7], v[28:31], v[116:119]
v_mfma_f32_16x16x32_bf16 v[120:123], v[8:11], v[28:31], v[120:123]
v_mfma_f32_16x16x32_bf16 v[124:127], v[12:15], v[28:31], v[124:127]
s_waitcnt lgkmcnt(0)
v_mfma_f32_16x16x32_bf16 v[64:67], v[32:35], v[48:51], v[64:67]
s_barrier
v_mfma_f32_16x16x32_bf16 v[68:71], v[36:39], v[48:51], v[68:71]
v_mfma_f32_16x16x32_bf16 v[72:75], v[40:43], v[48:51], v[72:75]
v_mfma_f32_16x16x32_bf16 v[76:79], v[44:47], v[48:51], v[76:79]
v_mfma_f32_16x16x32_bf16 v[80:83], v[32:35], v[52:55], v[80:83]
v_mfma_f32_16x16x32_bf16 v[84:87], v[36:39], v[52:55], v[84:87]
v_mfma_f32_16x16x32_bf16 v[88:91], v[40:43], v[52:55], v[88:91]
v_mfma_f32_16x16x32_bf16 v[92:95], v[44:47], v[52:55], v[92:95]
v_mfma_f32_16x16x32_bf16 v[96:99], v[32:35], v[56:59], v[96:99]
v_mfma_f32_16x16x32_bf16 v[100:103], v[36:39], v[56:59], v[100:103]
v_mfma_f32_16x16x32_bf16 v[104:107], v[40:43], v[56:59], v[104:107]
v_mfma_f32_16x16x32_bf16 v[108:111], v[44:47], v[56:59], v[108:111]
v_mfma_f32_16x16x32_bf16 v[112:115], v[32:35], v[60:63], v[112:115]
v_mfma_f32_16x16x32_bf16 v[116:119], v[36:39], v[60:63], v[116:119]
v_mfma_f32_16x16x32_bf16 v[120:123], v[40:43], v[60:63], v[120:123]
v_mfma_f32_16x16x32_bf16 v[124:127], v[44:47], v[60:63], v[124:127]
s_cmp_lg_u32 s62, -4
s_cbranch_scc1 main_kernel_w_gemm
s_branch main_kernel_w_slow
main_kernel_w_c0_n_ev:
s_mov_b32 s55, 1
s_cmp_eq_u32 s56, 0
s_cbranch_scc1 main_kernel_w_c0_n_et
s_bfm_b64 exec, s0, 0
buffer_store_dword v244, v248, s[4:7], s59 offen sc1
s_mov_b64 exec, -1
s_mov_b32 s56, 0
main_kernel_w_c0_n_et:
s_cmp_lg_u32 s18, 1
s_cbranch_scc1 main_kernel_w_c0_n_loop
s_lshl_b32 s32, s27, 8
s_add_u32 s32, s32, 0x841e000
s_mov_b64 exec, 1
v_mov_b32 v249, 1
buffer_atomic_add v249, off, s[4:7], s32 sc0 sc1
s_mov_b64 exec, -1
s_branch main_kernel_w_c0_n_loop
main_kernel_w_c0_gov:
s_mov_b32 s58, 1
s_mov_b32 s72, s18
s_cmp_lg_u32 s73, -1
s_cbranch_scc1 main_kernel_w_c0_str
s_waitcnt lgkmcnt(0)
v_lshrrev_b32 v0, 4, v250
v_bfe_u32 v1, v250, 2, 2
v_lshl_add_u32 v4, v0, 2, v1
v_and_b32 v5, 7, v4
v_mul_u32_u24 v4, 256, v4
v_and_b32 v6, 3, v250
v_lshl_add_u32 v4, v6, 3, v4
s_mul_i32 s32, s37, 4
v_xor_b32 v5, s32, v5
v_lshl_add_u32 v128, v5, 5, v4
v_xor_b32 v129, 32, v128
v_xor_b32 v130, 64, v128
v_xor_b32 v131, 96, v128
s_mul_i32 s32, s38, 8192
s_add_u32 s32, s32, 65536
v_add_u32 v136, s32, v251
v_lshrrev_b32 v2, 4, v250
v_and_b32 v3, 15, v250
s_mul_i32 s32, s14, 16
v_add_u32 v147, s32, v2
v_and_b32 v6, 7, v147
v_lshlrev_b32 v6, 1, v6
v_xor_b32 v6, v6, v3
v_lshlrev_b32 v151, 4, v6
v_add_u32 v148, 4, v147
v_and_b32 v6, 7, v148
v_lshlrev_b32 v6, 1, v6
v_xor_b32 v6, v6, v3
v_lshlrev_b32 v152, 4, v6
v_subrev_u32 v152, 1024, v152
v_add_u32 v149, 8, v147
v_and_b32 v6, 7, v149
v_lshlrev_b32 v6, 1, v6
v_xor_b32 v6, v6, v3
v_lshlrev_b32 v153, 4, v6
v_subrev_u32 v153, 2048, v153
v_add_u32 v150, 12, v147
v_and_b32 v6, 7, v150
v_lshlrev_b32 v6, 1, v6
v_xor_b32 v6, v6, v3
v_lshlrev_b32 v154, 4, v6
v_subrev_u32 v154, 3072, v154
s_mul_i32 s19, s14, 4096
s_mul_i32 s20, s14, 4096
s_add_u32 s20, s20, 65536
s_mul_i32 s32, s14, 2
s_mul_i32 s32, s32, s31
v_mad_u32_u24 v137, v147, s30, v151
v_mad_u32_u24 v138, v148, s30, v152
v_mad_u32_u24 v139, v149, s30, v153
v_mad_u32_u24 v140, v150, s30, v154
v_add_u32 v141, s32, v251
s_add_u32 s32, s32, s31
s_sub_u32 s32, s32, 2048
v_add_u32 v142, s32, v251
s_mul_i32 s17, s30, 64
s_mov_b32 s15, 0
s_waitcnt vmcnt(0)
s_add_u32 m0, s20, 0
s_nop 0
buffer_load_dwordx4 v141, s[4:7], s16 offen offset:0 sc1 lds
buffer_load_dwordx4 v141, s[4:7], s16 offen offset:1024 sc1 lds
buffer_load_dwordx4 v142, s[4:7], s16 offen offset:2048 sc1 lds
buffer_load_dwordx4 v142, s[4:7], s16 offen offset:3072 sc1 lds
s_add_u32 s16, s16, 2048
s_add_u32 m0, s19, 0
s_nop 0
buffer_load_dwordx4 v137, s[8:11], s15 offen offset:0 lds
buffer_load_dwordx4 v138, s[8:11], s15 offen offset:1024 lds
buffer_load_dwordx4 v139, s[8:11], s15 offen offset:2048 lds
buffer_load_dwordx4 v140, s[8:11], s15 offen offset:3072 lds
s_add_u32 s15, s15, s17
s_add_u32 m0, s20, 16384
s_nop 0
buffer_load_dwordx4 v141, s[4:7], s16 offen offset:0 sc1 lds
buffer_load_dwordx4 v141, s[4:7], s16 offen offset:1024 sc1 lds
buffer_load_dwordx4 v142, s[4:7], s16 offen offset:2048 sc1 lds
buffer_load_dwordx4 v142, s[4:7], s16 offen offset:3072 sc1 lds
s_add_u32 s16, s16, 2048
s_add_u32 m0, s19, 16384
s_nop 0
buffer_load_dwordx4 v137, s[8:11], s15 offen offset:0 lds
buffer_load_dwordx4 v138, s[8:11], s15 offen offset:1024 lds
buffer_load_dwordx4 v139, s[8:11], s15 offen offset:2048 lds
buffer_load_dwordx4 v140, s[8:11], s15 offen offset:3072 lds
s_add_u32 s15, s15, s17
s_add_u32 m0, s20, 32768
s_nop 0
buffer_load_dwordx4 v141, s[4:7], s16 offen offset:0 sc1 lds
buffer_load_dwordx4 v141, s[4:7], s16 offen offset:1024 sc1 lds
buffer_load_dwordx4 v142, s[4:7], s16 offen offset:2048 sc1 lds
buffer_load_dwordx4 v142, s[4:7], s16 offen offset:3072 sc1 lds
s_add_u32 s16, s16, 2048
s_add_u32 m0, s19, 32768
s_nop 0
buffer_load_dwordx4 v137, s[8:11], s15 offen offset:0 lds
buffer_load_dwordx4 v138, s[8:11], s15 offen offset:1024 lds
buffer_load_dwordx4 v139, s[8:11], s15 offen offset:2048 lds
buffer_load_dwordx4 v140, s[8:11], s15 offen offset:3072 lds
s_add_u32 s15, s15, s17
s_add_u32 m0, s20, 49152
s_nop 0
buffer_load_dwordx4 v141, s[4:7], s16 offen offset:0 sc1 lds
buffer_load_dwordx4 v141, s[4:7], s16 offen offset:1024 sc1 lds
buffer_load_dwordx4 v142, s[4:7], s16 offen offset:2048 sc1 lds
buffer_load_dwordx4 v142, s[4:7], s16 offen offset:3072 sc1 lds
s_add_u32 s16, s16, 2048
s_cmp_lg_u32 s56, 0
s_cbranch_scc1 main_kernel_w_epi
main_kernel_w_c0_v_ent:
v_mfma_f32_32x32x16_bf16 v[64:79], v[224:227], v[224:227], 0
s_waitcnt vmcnt(20)
s_barrier
ds_read_b128 v[16:19], v136 offset:0
ds_read_b64_tr_b16 v[0:1], v128 offset:0
ds_read_b64_tr_b16 v[2:3], v128 offset:4096
v_mfma_f32_32x32x16_bf16 v[80:95], v[224:227], v[224:227], 0
ds_read_b64_tr_b16 v[4:5], v129 offset:0
ds_read_b64_tr_b16 v[6:7], v129 offset:4096
ds_read_b64_tr_b16 v[8:9], v130 offset:0
v_mfma_f32_32x32x16_bf16 v[96:111], v[224:227], v[224:227], 0
ds_read_b64_tr_b16 v[10:11], v130 offset:4096
ds_read_b64_tr_b16 v[12:13], v131 offset:0
ds_read_b64_tr_b16 v[14:15], v131 offset:4096
v_mfma_f32_32x32x16_bf16 v[112:127], v[224:227], v[224:227], 0
ds_read_b128 v[20:23], v136 offset:2048
ds_read_b128 v[24:27], v136 offset:4096
ds_read_b128 v[28:31], v136 offset:6144
s_sub_u32 s18, s72, 1
s_sub_u32 s55, s72, 2
s_orn2_b32 s55, s55, s100
s_mov_b32 s73, -1
s_nop 0
main_kernel_w_c0_v_loop:
s_waitcnt lgkmcnt(0)
ds_read_b128 v[48:51], v136 offset:1024
s_add_u32 m0, s19, 49152
s_nop 0
v_mfma_f32_16x16x32_bf16 v[64:67], v[16:19], v[0:3], v[64:67]
ds_read_b64_tr_b16 v[32:33], v128 offset:8192
v_mfma_f32_16x16x32_bf16 v[68:71], v[16:19], v[4:7], v[68:71]
ds_read_b64_tr_b16 v[34:35], v128 offset:12288
buffer_load_dwordx4 v137, s[8:11], s15 offen offset:0 lds
v_mfma_f32_16x16x32_bf16 v[72:75], v[16:19], v[8:11], v[72:75]
ds_read_b64_tr_b16 v[36:37], v129 offset:8192
v_mfma_f32_16x16x32_bf16 v[76:79], v[16:19], v[12:15], v[76:79]
ds_read_b64_tr_b16 v[38:39], v129 offset:12288
v_mfma_f32_16x16x32_bf16 v[80:83], v[20:23], v[0:3], v[80:83]
ds_read_b64_tr_b16 v[40:41], v130 offset:8192
buffer_load_dwordx4 v138, s[8:11], s15 offen offset:1024 lds
v_mfma_f32_16x16x32_bf16 v[84:87], v[20:23], v[4:7], v[84:87]
ds_read_b64_tr_b16 v[42:43], v130 offset:12288
v_mfma_f32_16x16x32_bf16 v[88:91], v[20:23], v[8:11], v[88:91]
ds_read_b64_tr_b16 v[44:45], v131 offset:8192
v_mfma_f32_16x16x32_bf16 v[92:95], v[20:23], v[12:15], v[92:95]
ds_read_b64_tr_b16 v[46:47], v131 offset:12288
buffer_load_dwordx4 v139, s[8:11], s15 offen offset:2048 lds
v_mfma_f32_16x16x32_bf16 v[96:99], v[24:27], v[0:3], v[96:99]
ds_read_b128 v[52:55], v136 offset:3072
v_mfma_f32_16x16x32_bf16 v[100:103], v[24:27], v[4:7], v[100:103]
ds_read_b128 v[56:59], v136 offset:5120
buffer_load_dwordx4 v140, s[8:11], s15 offen offset:3072 lds
v_mfma_f32_16x16x32_bf16 v[104:107], v[24:27], v[8:11], v[104:107]
ds_read_b128 v[60:63], v136 offset:7168
v_mfma_f32_16x16x32_bf16 v[108:111], v[24:27], v[12:15], v[108:111]
v_mfma_f32_16x16x32_bf16 v[112:115], v[28:31], v[0:3], v[112:115]
s_add_u32 s15, s15, s17
v_mfma_f32_16x16x32_bf16 v[116:119], v[28:31], v[4:7], v[116:119]
v_mfma_f32_16x16x32_bf16 v[120:123], v[28:31], v[8:11], v[120:123]
v_mfma_f32_16x16x32_bf16 v[124:127], v[28:31], v[12:15], v[124:127]
main_kernel_w_c0_v_mid:
s_waitcnt lgkmcnt(0)
v_mfma_f32_16x16x32_bf16 v[64:67], v[48:51], v[32:35], v[64:67]
s_waitcnt vmcnt(16)
s_barrier
ds_read_b128 v[16:19], v136 offset:16384
s_add_u32 m0, s20, 0
s_nop 0
v_mfma_f32_16x16x32_bf16 v[68:71], v[48:51], v[36:39], v[68:71]
ds_read_b64_tr_b16 v[0:1], v128 offset:16384
v_mfma_f32_16x16x32_bf16 v[72:75], v[48:51], v[40:43], v[72:75]
ds_read_b64_tr_b16 v[2:3], v128 offset:20480
buffer_load_dwordx4 v141, s[4:7], s16 offen offset:0 sc1 lds
v_mfma_f32_16x16x32_bf16 v[76:79], v[48:51], v[44:47], v[76:79]
ds_read_b64_tr_b16 v[4:5], v129 offset:16384
v_mfma_f32_16x16x32_bf16 v[80:83], v[52:55], v[32:35], v[80:83]
ds_read_b64_tr_b16 v[6:7], v129 offset:20480
v_mfma_f32_16x16x32_bf16 v[84:87], v[52:55], v[36:39], v[84:87]
ds_read_b64_tr_b16 v[8:9], v130 offset:16384
buffer_load_dwordx4 v141, s[4:7], s16 offen offset:1024 sc1 lds
v_mfma_f32_16x16x32_bf16 v[88:91], v[52:55], v[40:43], v[88:91]
ds_read_b64_tr_b16 v[10:11], v130 offset:20480
v_mfma_f32_16x16x32_bf16 v[92:95], v[52:55], v[44:47], v[92:95]
ds_read_b64_tr_b16 v[12:13], v131 offset:16384
buffer_load_dwordx4 v142, s[4:7], s16 offen offset:2048 sc1 lds
v_mfma_f32_16x16x32_bf16 v[96:99], v[56:59], v[32:35], v[96:99]
ds_read_b64_tr_b16 v[14:15], v131 offset:20480
v_mfma_f32_16x16x32_bf16 v[100:103], v[56:59], v[36:39], v[100:103]
ds_read_b128 v[20:23], v136 offset:18432
v_mfma_f32_16x16x32_bf16 v[104:107], v[56:59], v[40:43], v[104:107]
ds_read_b128 v[24:27], v136 offset:20480
buffer_load_dwordx4 v142, s[4:7], s16 offen offset:3072 sc1 lds
v_mfma_f32_16x16x32_bf16 v[108:111], v[56:59], v[44:47], v[108:111]
ds_read_b128 v[28:31], v136 offset:22528
v_mfma_f32_16x16x32_bf16 v[112:115], v[60:63], v[32:35], v[112:115]
s_add_u32 s16, s16, 2048
v_mfma_f32_16x16x32_bf16 v[116:119], v[60:63], v[36:39], v[116:119]
v_mfma_f32_16x16x32_bf16 v[120:123], v[60:63], v[40:43], v[120:123]
v_mfma_f32_16x16x32_bf16 v[124:127], v[60:63], v[44:47], v[124:127]
s_waitcnt lgkmcnt(0)
ds_read_b128 v[48:51], v136 offset:17408
s_add_u32 m0, s19, 0
s_nop 0
v_mfma_f32_16x16x32_bf16 v[64:67], v[16:19], v[0:3], v[64:67]
ds_read_b64_tr_b16 v[32:33], v128 offset:24576
v_mfma_f32_16x16x32_bf16 v[68:71], v[16:19], v[4:7], v[68:71]
ds_read_b64_tr_b16 v[34:35], v128 offset:28672
buffer_load_dwordx4 v137, s[8:11], s15 offen offset:0 lds
v_mfma_f32_16x16x32_bf16 v[72:75], v[16:19], v[8:11], v[72:75]
ds_read_b64_tr_b16 v[36:37], v129 offset:24576
v_mfma_f32_16x16x32_bf16 v[76:79], v[16:19], v[12:15], v[76:79]
ds_read_b64_tr_b16 v[38:39], v129 offset:28672
v_mfma_f32_16x16x32_bf16 v[80:83], v[20:23], v[0:3], v[80:83]
ds_read_b64_tr_b16 v[40:41], v130 offset:24576
buffer_load_dwordx4 v138, s[8:11], s15 offen offset:1024 lds
v_mfma_f32_16x16x32_bf16 v[84:87], v[20:23], v[4:7], v[84:87]
ds_read_b64_tr_b16 v[42:43], v130 offset:28672
v_mfma_f32_16x16x32_bf16 v[88:91], v[20:23], v[8:11], v[88:91]
ds_read_b64_tr_b16 v[44:45], v131 offset:24576
v_mfma_f32_16x16x32_bf16 v[92:95], v[20:23], v[12:15], v[92:95]
ds_read_b64_tr_b16 v[46:47], v131 offset:28672
buffer_load_dwordx4 v139, s[8:11], s15 offen offset:2048 lds
v_mfma_f32_16x16x32_bf16 v[96:99], v[24:27], v[0:3], v[96:99]
ds_read_b128 v[52:55], v136 offset:19456
v_mfma_f32_16x16x32_bf16 v[100:103], v[24:27], v[4:7], v[100:103]
ds_read_b128 v[56:59], v136 offset:21504
buffer_load_dwordx4 v140, s[8:11], s15 offen offset:3072 lds
v_mfma_f32_16x16x32_bf16 v[104:107], v[24:27], v[8:11], v[104:107]
ds_read_b128 v[60:63], v136 offset:23552
v_mfma_f32_16x16x32_bf16 v[108:111], v[24:27], v[12:15], v[108:111]
v_mfma_f32_16x16x32_bf16 v[112:115], v[28:31], v[0:3], v[112:115]
s_add_u32 s15, s15, s17
v_mfma_f32_16x16x32_bf16 v[116:119], v[28:31], v[4:7], v[116:119]
v_mfma_f32_16x16x32_bf16 v[120:123], v[28:31], v[8:11], v[120:123]
v_mfma_f32_16x16x32_bf16 v[124:127], v[28:31], v[12:15], v[124:127]
s_waitcnt lgkmcnt(0)
v_mfma_f32_16x16x32_bf16 v[64:67], v[48:51], v[32:35], v[64:67]
s_waitcnt vmcnt(16)
s_barrier
ds_read_b128 v[16:19], v136 offset:32768
s_add_u32 m0, s20, 16384
s_nop 0
v_mfma_f32_16x16x32_bf16 v[68:71], v[48:51], v[36:39], v[68:71]
ds_read_b64_tr_b16 v[0:1], v128 offset:32768
v_mfma_f32_16x16x32_bf16 v[72:75], v[48:51], v[40:43], v[72:75]
ds_read_b64_tr_b16 v[2:3], v128 offset:36864
buffer_load_dwordx4 v141, s[4:7], s16 offen offset:0 sc1 lds
v_mfma_f32_16x16x32_bf16 v[76:79], v[48:51], v[44:47], v[76:79]
ds_read_b64_tr_b16 v[4:5], v129 offset:32768
v_mfma_f32_16x16x32_bf16 v[80:83], v[52:55], v[32:35], v[80:83]
ds_read_b64_tr_b16 v[6:7], v129 offset:36864
v_mfma_f32_16x16x32_bf16 v[84:87], v[52:55], v[36:39], v[84:87]
ds_read_b64_tr_b16 v[8:9], v130 offset:32768
buffer_load_dwordx4 v141, s[4:7], s16 offen offset:1024 sc1 lds
v_mfma_f32_16x16x32_bf16 v[88:91], v[52:55], v[40:43], v[88:91]
ds_read_b64_tr_b16 v[10:11], v130 offset:36864
v_mfma_f32_16x16x32_bf16 v[92:95], v[52:55], v[44:47], v[92:95]
ds_read_b64_tr_b16 v[12:13], v131 offset:32768
buffer_load_dwordx4 v142, s[4:7], s16 offen offset:2048 sc1 lds
v_mfma_f32_16x16x32_bf16 v[96:99], v[56:59], v[32:35], v[96:99]
ds_read_b64_tr_b16 v[14:15], v131 offset:36864
v_mfma_f32_16x16x32_bf16 v[100:103], v[56:59], v[36:39], v[100:103]
ds_read_b128 v[20:23], v136 offset:34816
v_mfma_f32_16x16x32_bf16 v[104:107], v[56:59], v[40:43], v[104:107]
ds_read_b128 v[24:27], v136 offset:36864
buffer_load_dwordx4 v142, s[4:7], s16 offen offset:3072 sc1 lds
v_mfma_f32_16x16x32_bf16 v[108:111], v[56:59], v[44:47], v[108:111]
ds_read_b128 v[28:31], v136 offset:38912
v_mfma_f32_16x16x32_bf16 v[112:115], v[60:63], v[32:35], v[112:115]
s_add_u32 s16, s16, 2048
v_mfma_f32_16x16x32_bf16 v[116:119], v[60:63], v[36:39], v[116:119]
v_mfma_f32_16x16x32_bf16 v[120:123], v[60:63], v[40:43], v[120:123]
v_mfma_f32_16x16x32_bf16 v[124:127], v[60:63], v[44:47], v[124:127]
s_waitcnt lgkmcnt(0)
ds_read_b128 v[48:51], v136 offset:33792
s_add_u32 m0, s19, 16384
s_nop 0
v_mfma_f32_16x16x32_bf16 v[64:67], v[16:19], v[0:3], v[64:67]
ds_read_b64_tr_b16 v[32:33], v128 offset:40960
v_mfma_f32_16x16x32_bf16 v[68:71], v[16:19], v[4:7], v[68:71]
ds_read_b64_tr_b16 v[34:35], v128 offset:45056
buffer_load_dwordx4 v137, s[8:11], s15 offen offset:0 lds
v_mfma_f32_16x16x32_bf16 v[72:75], v[16:19], v[8:11], v[72:75]
ds_read_b64_tr_b16 v[36:37], v129 offset:40960
v_mfma_f32_16x16x32_bf16 v[76:79], v[16:19], v[12:15], v[76:79]
ds_read_b64_tr_b16 v[38:39], v129 offset:45056
v_mfma_f32_16x16x32_bf16 v[80:83], v[20:23], v[0:3], v[80:83]
ds_read_b64_tr_b16 v[40:41], v130 offset:40960
buffer_load_dwordx4 v138, s[8:11], s15 offen offset:1024 lds
v_mfma_f32_16x16x32_bf16 v[84:87], v[20:23], v[4:7], v[84:87]
ds_read_b64_tr_b16 v[42:43], v130 offset:45056
v_mfma_f32_16x16x32_bf16 v[88:91], v[20:23], v[8:11], v[88:91]
ds_read_b64_tr_b16 v[44:45], v131 offset:40960
v_mfma_f32_16x16x32_bf16 v[92:95], v[20:23], v[12:15], v[92:95]
ds_read_b64_tr_b16 v[46:47], v131 offset:45056
buffer_load_dwordx4 v139, s[8:11], s15 offen offset:2048 lds
v_mfma_f32_16x16x32_bf16 v[96:99], v[24:27], v[0:3], v[96:99]
ds_read_b128 v[52:55], v136 offset:35840
v_mfma_f32_16x16x32_bf16 v[100:103], v[24:27], v[4:7], v[100:103]
ds_read_b128 v[56:59], v136 offset:37888
buffer_load_dwordx4 v140, s[8:11], s15 offen offset:3072 lds
v_mfma_f32_16x16x32_bf16 v[104:107], v[24:27], v[8:11], v[104:107]
ds_read_b128 v[60:63], v136 offset:39936
v_mfma_f32_16x16x32_bf16 v[108:111], v[24:27], v[12:15], v[108:111]
v_mfma_f32_16x16x32_bf16 v[112:115], v[28:31], v[0:3], v[112:115]
s_add_u32 s15, s15, s17
v_mfma_f32_16x16x32_bf16 v[116:119], v[28:31], v[4:7], v[116:119]
v_mfma_f32_16x16x32_bf16 v[120:123], v[28:31], v[8:11], v[120:123]
v_mfma_f32_16x16x32_bf16 v[124:127], v[28:31], v[12:15], v[124:127]
s_waitcnt lgkmcnt(0)
v_mfma_f32_16x16x32_bf16 v[64:67], v[48:51], v[32:35], v[64:67]
s_waitcnt vmcnt(16)
s_barrier
ds_read_b128 v[16:19], v136 offset:49152
s_add_u32 m0, s20, 32768
s_nop 0
v_mfma_f32_16x16x32_bf16 v[68:71], v[48:51], v[36:39], v[68:71]
ds_read_b64_tr_b16 v[0:1], v128 offset:49152
v_mfma_f32_16x16x32_bf16 v[72:75], v[48:51], v[40:43], v[72:75]
ds_read_b64_tr_b16 v[2:3], v128 offset:53248
buffer_load_dwordx4 v141, s[4:7], s16 offen offset:0 sc1 lds
v_mfma_f32_16x16x32_bf16 v[76:79], v[48:51], v[44:47], v[76:79]
ds_read_b64_tr_b16 v[4:5], v129 offset:49152
v_mfma_f32_16x16x32_bf16 v[80:83], v[52:55], v[32:35], v[80:83]
ds_read_b64_tr_b16 v[6:7], v129 offset:53248
v_mfma_f32_16x16x32_bf16 v[84:87], v[52:55], v[36:39], v[84:87]
ds_read_b64_tr_b16 v[8:9], v130 offset:49152
buffer_load_dwordx4 v141, s[4:7], s16 offen offset:1024 sc1 lds
v_mfma_f32_16x16x32_bf16 v[88:91], v[52:55], v[40:43], v[88:91]
ds_read_b64_tr_b16 v[10:11], v130 offset:53248
v_mfma_f32_16x16x32_bf16 v[92:95], v[52:55], v[44:47], v[92:95]
ds_read_b64_tr_b16 v[12:13], v131 offset:49152
buffer_load_dwordx4 v142, s[4:7], s16 offen offset:2048 sc1 lds
v_mfma_f32_16x16x32_bf16 v[96:99], v[56:59], v[32:35], v[96:99]
ds_read_b64_tr_b16 v[14:15], v131 offset:53248
v_mfma_f32_16x16x32_bf16 v[100:103], v[56:59], v[36:39], v[100:103]
ds_read_b128 v[20:23], v136 offset:51200
v_mfma_f32_16x16x32_bf16 v[104:107], v[56:59], v[40:43], v[104:107]
ds_read_b128 v[24:27], v136 offset:53248
buffer_load_dwordx4 v142, s[4:7], s16 offen offset:3072 sc1 lds
v_mfma_f32_16x16x32_bf16 v[108:111], v[56:59], v[44:47], v[108:111]
ds_read_b128 v[28:31], v136 offset:55296
v_mfma_f32_16x16x32_bf16 v[112:115], v[60:63], v[32:35], v[112:115]
s_add_u32 s16, s16, 2048
v_mfma_f32_16x16x32_bf16 v[116:119], v[60:63], v[36:39], v[116:119]
v_mfma_f32_16x16x32_bf16 v[120:123], v[60:63], v[40:43], v[120:123]
v_mfma_f32_16x16x32_bf16 v[124:127], v[60:63], v[44:47], v[124:127]
s_waitcnt lgkmcnt(0)
ds_read_b128 v[48:51], v136 offset:50176
s_add_u32 m0, s19, 32768
s_nop 0
v_mfma_f32_16x16x32_bf16 v[64:67], v[16:19], v[0:3], v[64:67]
ds_read_b64_tr_b16 v[32:33], v128 offset:57344
v_mfma_f32_16x16x32_bf16 v[68:71], v[16:19], v[4:7], v[68:71]
ds_read_b64_tr_b16 v[34:35], v128 offset:61440
buffer_load_dwordx4 v137, s[8:11], s15 offen offset:0 lds
v_mfma_f32_16x16x32_bf16 v[72:75], v[16:19], v[8:11], v[72:75]
ds_read_b64_tr_b16 v[36:37], v129 offset:57344
v_mfma_f32_16x16x32_bf16 v[76:79], v[16:19], v[12:15], v[76:79]
ds_read_b64_tr_b16 v[38:39], v129 offset:61440
v_mfma_f32_16x16x32_bf16 v[80:83], v[20:23], v[0:3], v[80:83]
ds_read_b64_tr_b16 v[40:41], v130 offset:57344
buffer_load_dwordx4 v138, s[8:11], s15 offen offset:1024 lds
v_mfma_f32_16x16x32_bf16 v[84:87], v[20:23], v[4:7], v[84:87]
ds_read_b64_tr_b16 v[42:43], v130 offset:61440
v_mfma_f32_16x16x32_bf16 v[88:91], v[20:23], v[8:11], v[88:91]
ds_read_b64_tr_b16 v[44:45], v131 offset:57344
v_mfma_f32_16x16x32_bf16 v[92:95], v[20:23], v[12:15], v[92:95]
ds_read_b64_tr_b16 v[46:47], v131 offset:61440
buffer_load_dwordx4 v139, s[8:11], s15 offen offset:2048 lds
v_mfma_f32_16x16x32_bf16 v[96:99], v[24:27], v[0:3], v[96:99]
ds_read_b128 v[52:55], v136 offset:52224
v_mfma_f32_16x16x32_bf16 v[100:103], v[24:27], v[4:7], v[100:103]
ds_read_b128 v[56:59], v136 offset:54272
buffer_load_dwordx4 v140, s[8:11], s15 offen offset:3072 lds
v_mfma_f32_16x16x32_bf16 v[104:107], v[24:27], v[8:11], v[104:107]
ds_read_b128 v[60:63], v136 offset:56320
v_mfma_f32_16x16x32_bf16 v[108:111], v[24:27], v[12:15], v[108:111]
v_mfma_f32_16x16x32_bf16 v[112:115], v[28:31], v[0:3], v[112:115]
s_add_u32 s15, s15, s17
v_mfma_f32_16x16x32_bf16 v[116:119], v[28:31], v[4:7], v[116:119]
v_mfma_f32_16x16x32_bf16 v[120:123], v[28:31], v[8:11], v[120:123]
v_mfma_f32_16x16x32_bf16 v[124:127], v[28:31], v[12:15], v[124:127]
s_waitcnt lgkmcnt(0)
v_mfma_f32_16x16x32_bf16 v[64:67], v[48:51], v[32:35], v[64:67]
s_waitcnt vmcnt(16)
s_barrier
ds_read_b128 v[16:19], v136 offset:0
s_add_u32 m0, s20, 49152
s_nop 0
v_mfma_f32_16x16x32_bf16 v[68:71], v[48:51], v[36:39], v[68:71]
ds_read_b64_tr_b16 v[0:1], v128 offset:0
v_mfma_f32_16x16x32_bf16 v[72:75], v[48:51], v[40:43], v[72:75]
ds_read_b64_tr_b16 v[2:3], v128 offset:4096
buffer_load_dwordx4 v141, s[4:7], s16 offen offset:0 sc1 lds
v_mfma_f32_16x16x32_bf16 v[76:79], v[48:51], v[44:47], v[76:79]
ds_read_b64_tr_b16 v[4:5], v129 offset:0
v_mfma_f32_16x16x32_bf16 v[80:83], v[52:55], v[32:35], v[80:83]
ds_read_b64_tr_b16 v[6:7], v129 offset:4096
v_mfma_f32_16x16x32_bf16 v[84:87], v[52:55], v[36:39], v[84:87]
ds_read_b64_tr_b16 v[8:9], v130 offset:0
buffer_load_dwordx4 v141, s[4:7], s16 offen offset:1024 sc1 lds
v_mfma_f32_16x16x32_bf16 v[88:91], v[52:55], v[40:43], v[88:91]
ds_read_b64_tr_b16 v[10:11], v130 offset:4096
v_mfma_f32_16x16x32_bf16 v[92:95], v[52:55], v[44:47], v[92:95]
ds_read_b64_tr_b16 v[12:13], v131 offset:0
buffer_load_dwordx4 v142, s[4:7], s16 offen offset:2048 sc1 lds
v_mfma_f32_16x16x32_bf16 v[96:99], v[56:59], v[32:35], v[96:99]
ds_read_b64_tr_b16 v[14:15], v131 offset:4096
v_mfma_f32_16x16x32_bf16 v[100:103], v[56:59], v[36:39], v[100:103]
ds_read_b128 v[20:23], v136 offset:2048
v_mfma_f32_16x16x32_bf16 v[104:107], v[56:59], v[40:43], v[104:107]
ds_read_b128 v[24:27], v136 offset:4096
buffer_load_dwordx4 v142, s[4:7], s16 offen offset:3072 sc1 lds
v_mfma_f32_16x16x32_bf16 v[108:111], v[56:59], v[44:47], v[108:111]
ds_read_b128 v[28:31], v136 offset:6144
v_mfma_f32_16x16x32_bf16 v[112:115], v[60:63], v[32:35], v[112:115]
s_add_u32 s16, s16, 2048
v_mfma_f32_16x16x32_bf16 v[116:119], v[60:63], v[36:39], v[116:119]
v_mfma_f32_16x16x32_bf16 v[120:123], v[60:63], v[40:43], v[120:123]
v_mfma_f32_16x16x32_bf16 v[124:127], v[60:63], v[44:47], v[124:127]
s_sub_u32 s18, s18, 1
s_cmp_eq_u32 s18, s55
s_cbranch_scc1 main_kernel_w_c0_v_ev
s_cmp_lg_u32 s18, 0
s_cbranch_scc1 main_kernel_w_c0_v_loop
s_cmp_lg_u32 s73, -1
s_cbranch_scc1 main_kernel_w_epn
s_waitcnt lgkmcnt(0)
ds_read_b128 v[48:51], v136 offset:1024
s_add_u32 m0, s19, 49152
s_nop 0
v_mfma_f32_16x16x32_bf16 v[64:67], v[16:19], v[0:3], v[64:67]
ds_read_b64_tr_b16 v[32:33], v128 offset:8192
s_add_u32 s32, s23, 1
s_bitcmp0_b32 s32, 2
s_cselect_b32 s34, 7, 2
s_cselect_b32 s35, 2, 4
s_lshl_b32 s59, s23, 13
s_add_u32 s59, s59, 0x8404000
v_mfma_f32_16x16x32_bf16 v[68:71], v[16:19], v[4:7], v[68:71]
ds_read_b64_tr_b16 v[34:35], v128 offset:12288
buffer_load_dwordx4 v137, s[8:11], s15 offen offset:0 lds
v_lshrrev_b32 v253, 3, v250
v_add_lshl_u32 v253, s24, v253, 9
v_mfma_f32_16x16x32_bf16 v[72:75], v[16:19], v[8:11], v[72:75]
ds_read_b64_tr_b16 v[36:37], v129 offset:8192
v_and_b32 v254, 3, v250
v_lshl_add_u32 v253, v254, s34, v253
v_mfma_f32_16x16x32_bf16 v[76:79], v[16:19], v[12:15], v[76:79]
ds_read_b64_tr_b16 v[38:39], v129 offset:12288
v_bfe_u32 v254, v250, 2, 1
v_add_u32 v254, s25, v254
v_lshl_add_u32 v248, v254, s35, v253
v_mfma_f32_16x16x32_bf16 v[80:83], v[20:23], v[0:3], v[80:83]
ds_read_b64_tr_b16 v[40:41], v130 offset:8192
buffer_load_dwordx4 v138, s[8:11], s15 offen offset:1024 lds
s_lshl_b32 s0, 4, s54
v_readfirstlane_b32 s28, v249
v_mfma_f32_16x16x32_bf16 v[84:87], v[20:23], v[4:7], v[84:87]
ds_read_b64_tr_b16 v[42:43], v130 offset:12288
s_nop 1
v_cmp_ge_u32 vcc, s28, v229
v_mfma_f32_16x16x32_bf16 v[88:91], v[20:23], v[8:11], v[88:91]
ds_read_b64_tr_b16 v[44:45], v131 offset:8192
s_nop 1
s_bcnt1_i32_b64 s32, vcc
v_mfma_f32_16x16x32_bf16 v[92:95], v[20:23], v[12:15], v[92:95]
ds_read_b64_tr_b16 v[46:47], v131 offset:12288
buffer_load_dwordx4 v139, s[8:11], s15 offen offset:2048 lds
s_sub_u32 s32, s32, 1
v_readlane_b32 s36, v230, s32
s_nop 1
v_mfma_f32_16x16x32_bf16 v[96:99], v[24:27], v[0:3], v[96:99]
ds_read_b128 v[52:55], v136 offset:3072
s_and_b32 s32, s36, 0x7ff
s_sub_u32 s28, s28, s32
v_mfma_f32_16x16x32_bf16 v[100:103], v[24:27], v[4:7], v[100:103]
ds_read_b128 v[56:59], v136 offset:5120
buffer_load_dwordx4 v140, s[8:11], s15 offen offset:3072 lds
s_bfe_u32 s32, s36, 0x3001a
s_lshr_b32 s25, s28, s32
v_mfma_f32_16x16x32_bf16 v[104:107], v[24:27], v[8:11], v[104:107]
ds_read_b128 v[60:63], v136 offset:7168
s_lshl_b32 s33, s25, s32
s_sub_u32 s24, s28, s33
v_mfma_f32_16x16x32_bf16 v[108:111], v[24:27], v[12:15], v[108:111]
s_bfe_u32 s34, s36, 0x1001d
s_lshl_b32 s24, s24, s34
s_bfe_u32 s35, s36, 0x1001e
v_mfma_f32_16x16x32_bf16 v[112:115], v[28:31], v[0:3], v[112:115]
s_add_u32 s15, s15, s17
s_lshl_b32 s25, s25, s35
s_bfe_u32 s32, s36, 0x40011
v_mfma_f32_16x16x32_bf16 v[116:119], v[28:31], v[4:7], v[116:119]
s_add_u32 s24, s24, s32
s_bfe_u32 s32, s36, 0x50015
v_mfma_f32_16x16x32_bf16 v[120:123], v[28:31], v[8:11], v[120:123]
s_add_u32 s25, s25, s32
s_bfe_u32 s23, s36, 0x4000b
v_mfma_f32_16x16x32_bf16 v[124:127], v[28:31], v[12:15], v[124:127]
s_waitcnt lgkmcnt(0)
v_mfma_f32_16x16x32_bf16 v[64:67], v[48:51], v[32:35], v[64:67]
s_waitcnt vmcnt(16)
s_barrier
ds_read_b128 v[16:19], v136 offset:16384
s_add_u32 m0, s20, 0
s_nop 0
s_bfe_u32 s36, s36, 0x6000b
s_lshl_b32 s32, s24, 8
s_or_b32 s36, s36, s32
v_mfma_f32_16x16x32_bf16 v[68:71], v[48:51], v[36:39], v[68:71]
ds_read_b64_tr_b16 v[0:1], v128 offset:16384
s_lshl_b32 s32, s25, 16
s_or_b32 s36, s36, s32
v_mfma_f32_16x16x32_bf16 v[72:75], v[48:51], v[40:43], v[72:75]
ds_read_b64_tr_b16 v[2:3], v128 offset:20480
buffer_load_dwordx4 v141, s[4:7], s16 offen offset:0 sc1 lds
s_cmp_eq_u32 s23, 4
s_cselect_b32 s32, 1, 0
s_sub_u32 s48, s24, s32
v_mfma_f32_16x16x32_bf16 v[76:79], v[48:51], v[44:47], v[76:79]
ds_read_b64_tr_b16 v[4:5], v129 offset:16384
s_max_i32 s48, s48, 0
s_add_u32 s49, s24, s34
s_add_u32 s49, s49, s32
v_mfma_f32_16x16x32_bf16 v[80:83], v[52:55], v[32:35], v[80:83]
ds_read_b64_tr_b16 v[6:7], v129 offset:20480
s_min_u32 s49, s49, 15
s_cmp_eq_u32 s23, 6
s_cselect_b32 s51, 3, 7
v_mfma_f32_16x16x32_bf16 v[84:87], v[52:55], v[36:39], v[84:87]
ds_read_b64_tr_b16 v[8:9], v130 offset:16384
buffer_load_dwordx4 v141, s[4:7], s16 offen offset:1024 sc1 lds
s_cmp_eq_u32 s23, 7
s_cselect_b32 s51, 27, s51
s_cselect_b32 s50, 5, 4
s_add_u32 s33, s25, s35
v_mfma_f32_16x16x32_bf16 v[88:91], v[52:55], v[40:43], v[88:91]
ds_read_b64_tr_b16 v[10:11], v130 offset:20480
s_lshl_b32 s34, s24, 9
s_cmp_eq_u32 s23, 8
s_cselect_b32 s51, 0, s51
s_cselect_b32 s48, s25, s48
s_cselect_b32 s49, s33, s49
v_mfma_f32_16x16x32_bf16 v[92:95], v[52:55], v[44:47], v[92:95]
ds_read_b64_tr_b16 v[12:13], v131 offset:16384
buffer_load_dwordx4 v142, s[4:7], s16 offen offset:2048 sc1 lds
s_cmp_eq_u32 s23, 8
s_cselect_b32 s63, 2, 9
s_cselect_b32 s61, 0, 0x7f000000
s_cselect_b32 s34, s34, 0
v_lshrrev_b32 v228, s50, v250
v_lshlrev_b32 v254, s50, v228
v_mfma_f32_16x16x32_bf16 v[96:99], v[56:59], v[32:35], v[96:99]
ds_read_b64_tr_b16 v[14:15], v131 offset:20480
v_sub_u32 v254, v250, v254
s_cmp_lt_u32 s23, 4
s_cselect_b32 s39, 10, s23
v_mfma_f32_16x16x32_bf16 v[100:103], v[56:59], v[36:39], v[100:103]
ds_read_b128 v[20:23], v136 offset:18432
v_min_u32 v254, s51, v254
s_lshl_b32 s39, s39, 13
v_mfma_f32_16x16x32_bf16 v[104:107], v[56:59], v[40:43], v[104:107]
ds_read_b128 v[24:27], v136 offset:20480
buffer_load_dwordx4 v142, s[4:7], s16 offen offset:3072 sc1 lds
s_cmp_eq_u32 s23, 3
s_cselect_b32 s34, 4, s34
v_add_u32 v228, s48, v228
v_mfma_f32_16x16x32_bf16 v[108:111], v[56:59], v[44:47], v[108:111]
ds_read_b128 v[28:31], v136 offset:22528
s_add_u32 s39, s39, s34
s_add_u32 s39, s39, 0x8402000
v_min_u32 v228, s49, v228
v_mfma_f32_16x16x32_bf16 v[112:115], v[60:63], v[32:35], v[112:115]
s_add_u32 s16, s16, 2048
s_lshl_b32 s60, s24, 10
s_add_u32 s60, s60, 0x8400000
v_mfma_f32_16x16x32_bf16 v[116:119], v[60:63], v[36:39], v[116:119]
v_lshlrev_b32 v228, s63, v228
v_lshl_add_u32 v228, v254, 4, v228
v_mfma_f32_16x16x32_bf16 v[120:123], v[60:63], v[40:43], v[120:123]
v_or_b32 v146, s61, v251
s_mov_b64 exec, s[100:101]
buffer_load_dword v231, v228, s[4:7], s39 offen sc1
buffer_load_dwordx4 v[232:235], v146, s[4:7], s60 offen sc1
s_mov_b64 exec, -1
v_mfma_f32_16x16x32_bf16 v[124:127], v[60:63], v[44:47], v[124:127]
s_waitcnt lgkmcnt(0)
ds_read_b128 v[48:51], v136 offset:17408
s_add_u32 m0, s19, 0
s_nop 0
v_mfma_f32_16x16x32_bf16 v[64:67], v[16:19], v[0:3], v[64:67]
ds_read_b64_tr_b16 v[32:33], v128 offset:24576
s_mov_b32 s1, s21
v_mfma_f32_16x16x32_bf16 v[68:71], v[16:19], v[4:7], v[68:71]
ds_read_b64_tr_b16 v[34:35], v128 offset:28672
buffer_load_dwordx4 v137, s[8:11], s15 offen offset:0 lds
v_mfma_f32_16x16x32_bf16 v[72:75], v[16:19], v[8:11], v[72:75]
ds_read_b64_tr_b16 v[36:37], v129 offset:24576
v_mfma_f32_16x16x32_bf16 v[76:79], v[16:19], v[12:15], v[76:79]
ds_read_b64_tr_b16 v[38:39], v129 offset:28672
s_mov_b32 s2, s22
v_mfma_f32_16x16x32_bf16 v[80:83], v[20:23], v[0:3], v[80:83]
ds_read_b64_tr_b16 v[40:41], v130 offset:24576
buffer_load_dwordx4 v138, s[8:11], s15 offen offset:1024 lds
v_mfma_f32_16x16x32_bf16 v[84:87], v[20:23], v[4:7], v[84:87]
ds_read_b64_tr_b16 v[42:43], v130 offset:28672
v_mfma_f32_16x16x32_bf16 v[88:91], v[20:23], v[8:11], v[88:91]
ds_read_b64_tr_b16 v[44:45], v131 offset:24576
v_mfma_f32_16x16x32_bf16 v[92:95], v[20:23], v[12:15], v[92:95]
ds_read_b64_tr_b16 v[46:47], v131 offset:28672
buffer_load_dwordx4 v139, s[8:11], s15 offen offset:2048 lds
s_mov_b32 s3, s26
v_mfma_f32_16x16x32_bf16 v[96:99], v[24:27], v[0:3], v[96:99]
ds_read_b128 v[52:55], v136 offset:19456
v_mfma_f32_16x16x32_bf16 v[100:103], v[24:27], v[4:7], v[100:103]
ds_read_b128 v[56:59], v136 offset:21504
buffer_load_dwordx4 v140, s[8:11], s15 offen offset:3072 lds
v_mfma_f32_16x16x32_bf16 v[104:107], v[24:27], v[8:11], v[104:107]
ds_read_b128 v[60:63], v136 offset:23552
v_mfma_f32_16x16x32_bf16 v[108:111], v[24:27], v[12:15], v[108:111]
s_mov_b32 s56, s57
v_mfma_f32_16x16x32_bf16 v[112:115], v[28:31], v[0:3], v[112:115]
s_add_u32 s15, s15, s17
v_mfma_f32_16x16x32_bf16 v[116:119], v[28:31], v[4:7], v[116:119]
v_mfma_f32_16x16x32_bf16 v[120:123], v[28:31], v[8:11], v[120:123]
v_mfma_f32_16x16x32_bf16 v[124:127], v[28:31], v[12:15], v[124:127]
s_waitcnt lgkmcnt(0)
v_mfma_f32_16x16x32_bf16 v[64:67], v[48:51], v[32:35], v[64:67]
s_waitcnt vmcnt(16)
s_barrier
ds_read_b128 v[16:19], v136 offset:32768
s_add_u32 m0, s20, 16384
s_nop 0
v_mov_b32 v145, v252
v_mfma_f32_16x16x32_bf16 v[68:71], v[48:51], v[36:39], v[68:71]
ds_read_b64_tr_b16 v[0:1], v128 offset:32768
v_mfma_f32_16x16x32_bf16 v[72:75], v[48:51], v[40:43], v[72:75]
ds_read_b64_tr_b16 v[2:3], v128 offset:36864
buffer_load_dwordx4 v141, s[4:7], s16 offen offset:0 sc1 lds
v_mfma_f32_16x16x32_bf16 v[76:79], v[48:51], v[44:47], v[76:79]
ds_read_b64_tr_b16 v[4:5], v129 offset:32768
v_mfma_f32_16x16x32_bf16 v[80:83], v[52:55], v[32:35], v[80:83]
ds_read_b64_tr_b16 v[6:7], v129 offset:36864
v_mfma_f32_16x16x32_bf16 v[84:87], v[52:55], v[36:39], v[84:87]
ds_read_b64_tr_b16 v[8:9], v130 offset:32768
buffer_load_dwordx4 v141, s[4:7], s16 offen offset:1024 sc1 lds
v_mfma_f32_16x16x32_bf16 v[88:91], v[52:55], v[40:43], v[88:91]
ds_read_b64_tr_b16 v[10:11], v130 offset:36864
v_mfma_f32_16x16x32_bf16 v[92:95], v[52:55], v[44:47], v[92:95]
ds_read_b64_tr_b16 v[12:13], v131 offset:32768
buffer_load_dwordx4 v142, s[4:7], s16 offen offset:2048 sc1 lds
v_mov_b32 v255, 131072
v_mfma_f32_16x16x32_bf16 v[96:99], v[56:59], v[32:35], v[96:99]
ds_read_b64_tr_b16 v[14:15], v131 offset:36864
v_mfma_f32_16x16x32_bf16 v[100:103], v[56:59], v[36:39], v[100:103]
ds_read_b128 v[20:23], v136 offset:34816
v_mfma_f32_16x16x32_bf16 v[104:107], v[56:59], v[40:43], v[104:107]
ds_read_b128 v[24:27], v136 offset:36864
buffer_load_dwordx4 v142, s[4:7], s16 offen offset:3072 sc1 lds
v_mfma_f32_16x16x32_bf16 v[108:111], v[56:59], v[44:47], v[108:111]
ds_read_b128 v[28:31], v136 offset:38912
v_mfma_f32_16x16x32_bf16 v[112:115], v[60:63], v[32:35], v[112:115]
s_add_u32 s16, s16, 2048
v_mfma_f32_16x16x32_bf16 v[116:119], v[60:63], v[36:39], v[116:119]
v_mfma_f32_16x16x32_bf16 v[120:123], v[60:63], v[40:43], v[120:123]
v_mfma_f32_16x16x32_bf16 v[124:127], v[60:63], v[44:47], v[124:127]
s_waitcnt lgkmcnt(0)
ds_read_b128 v[48:51], v136 offset:33792
s_add_u32 m0, s19, 16384
s_nop 0
v_mfma_f32_16x16x32_bf16 v[64:67], v[16:19], v[0:3], v[64:67]
ds_read_b64_tr_b16 v[32:33], v128 offset:40960
v_mfma_f32_16x16x32_bf16 v[68:71], v[16:19], v[4:7], v[68:71]
ds_read_b64_tr_b16 v[34:35], v128 offset:45056
buffer_load_dwordx4 v137, s[8:11], s15 offen offset:0 lds
v_mfma_f32_16x16x32_bf16 v[72:75], v[16:19], v[8:11], v[72:75]
ds_read_b64_tr_b16 v[36:37], v129 offset:40960
v_mfma_f32_16x16x32_bf16 v[76:79], v[16:19], v[12:15], v[76:79]
ds_read_b64_tr_b16 v[38:39], v129 offset:45056
v_mfma_f32_16x16x32_bf16 v[80:83], v[20:23], v[0:3], v[80:83]
ds_read_b64_tr_b16 v[40:41], v130 offset:40960
buffer_load_dwordx4 v138, s[8:11], s15 offen offset:1024 lds
v_mfma_f32_16x16x32_bf16 v[84:87], v[20:23], v[4:7], v[84:87]
ds_read_b64_tr_b16 v[42:43], v130 offset:45056
v_mfma_f32_16x16x32_bf16 v[88:91], v[20:23], v[8:11], v[88:91]
ds_read_b64_tr_b16 v[44:45], v131 offset:40960
v_mfma_f32_16x16x32_bf16 v[92:95], v[20:23], v[12:15], v[92:95]
ds_read_b64_tr_b16 v[46:47], v131 offset:45056
buffer_load_dwordx4 v139, s[8:11], s15 offen offset:2048 lds
v_mfma_f32_16x16x32_bf16 v[96:99], v[24:27], v[0:3], v[96:99]
ds_read_b128 v[52:55], v136 offset:35840
v_mfma_f32_16x16x32_bf16 v[100:103], v[24:27], v[4:7], v[100:103]
ds_read_b128 v[56:59], v136 offset:37888
buffer_load_dwordx4 v140, s[8:11], s15 offen offset:3072 lds
v_mfma_f32_16x16x32_bf16 v[104:107], v[24:27], v[8:11], v[104:107]
ds_read_b128 v[60:63], v136 offset:39936
v_mfma_f32_16x16x32_bf16 v[108:111], v[24:27], v[12:15], v[108:111]
v_mfma_f32_16x16x32_bf16 v[112:115], v[28:31], v[0:3], v[112:115]
s_add_u32 s15, s15, s17
v_mfma_f32_16x16x32_bf16 v[116:119], v[28:31], v[4:7], v[116:119]
v_mfma_f32_16x16x32_bf16 v[120:123], v[28:31], v[8:11], v[120:123]
v_mfma_f32_16x16x32_bf16 v[124:127], v[28:31], v[12:15], v[124:127]
s_waitcnt lgkmcnt(0)
v_mfma_f32_16x16x32_bf16 v[64:67], v[48:51], v[32:35], v[64:67]
s_waitcnt vmcnt(16)
s_barrier
ds_read_b128 v[16:19], v136 offset:49152
s_add_u32 m0, s20, 32768
s_nop 0
v_mfma_f32_16x16x32_bf16 v[68:71], v[48:51], v[36:39], v[68:71]
ds_read_b64_tr_b16 v[0:1], v128 offset:49152
v_mfma_f32_16x16x32_bf16 v[72:75], v[48:51], v[40:43], v[72:75]
ds_read_b64_tr_b16 v[2:3], v128 offset:53248
buffer_load_dwordx4 v141, s[4:7], s16 offen offset:0 sc1 lds
v_mfma_f32_16x16x32_bf16 v[76:79], v[48:51], v[44:47], v[76:79]
ds_read_b64_tr_b16 v[4:5], v129 offset:49152
v_mfma_f32_16x16x32_bf16 v[80:83], v[52:55], v[32:35], v[80:83]
ds_read_b64_tr_b16 v[6:7], v129 offset:53248
s_waitcnt vmcnt(13)
v_min3_u32 v253, v232, v233, v234
v_mfma_f32_16x16x32_bf16 v[84:87], v[52:55], v[36:39], v[84:87]
ds_read_b64_tr_b16 v[8:9], v130 offset:49152
buffer_load_dwordx4 v141, s[4:7], s16 offen offset:1024 sc1 lds
v_min_u32 v253, v253, v235
v_mfma_f32_16x16x32_bf16 v[88:91], v[52:55], v[40:43], v[88:91]
ds_read_b64_tr_b16 v[10:11], v130 offset:53248
v_or_b32 v253, s61, v253
v_mfma_f32_16x16x32_bf16 v[92:95], v[52:55], v[44:47], v[92:95]
ds_read_b64_tr_b16 v[12:13], v131 offset:49152
buffer_load_dwordx4 v142, s[4:7], s16 offen offset:2048 sc1 lds
v_min_u32 v253, v253, v231
v_mfma_f32_16x16x32_bf16 v[96:99], v[56:59], v[32:35], v[96:99]
ds_read_b64_tr_b16 v[14:15], v131 offset:53248
v_cmp_eq_u32 vcc, 0, v253
v_mfma_f32_16x16x32_bf16 v[100:103], v[56:59], v[36:39], v[100:103]
ds_read_b128 v[20:23], v136 offset:51200
s_nop 1
v_mfma_f32_16x16x32_bf16 v[104:107], v[56:59], v[40:43], v[104:107]
ds_read_b128 v[24:27], v136 offset:53248
buffer_load_dwordx4 v142, s[4:7], s16 offen offset:3072 sc1 lds
s_cmp_eq_u64 vcc, 0
s_cselect_b32 s32, s36, -4
v_mfma_f32_16x16x32_bf16 v[108:111], v[56:59], v[44:47], v[108:111]
ds_read_b128 v[28:31], v136 offset:55296
s_bitcmp1_b32 0x1df, s23
s_cselect_b32 s32, s32, -4
v_mfma_f32_16x16x32_bf16 v[112:115], v[60:63], v[32:35], v[112:115]
s_add_u32 s16, s16, 2048
s_sub_u32 s33, s59, 0x8406000
s_cmp_lt_u32 s33, 0x4000
s_cselect_b32 s32, -4, s32
v_mfma_f32_16x16x32_bf16 v[116:119], v[60:63], v[36:39], v[116:119]
v_mov_b32 v254, s32
v_mfma_f32_16x16x32_bf16 v[120:123], v[60:63], v[40:43], v[120:123]
s_mov_b64 exec, s[100:101]
ds_write_b32 v255, v254
s_mov_b64 exec, -1
v_mfma_f32_16x16x32_bf16 v[124:127], v[60:63], v[44:47], v[124:127]
s_waitcnt lgkmcnt(0)
ds_read_b128 v[48:51], v136 offset:50176
s_add_u32 m0, s19, 32768
s_nop 0
v_mfma_f32_16x16x32_bf16 v[64:67], v[16:19], v[0:3], v[64:67]
ds_read_b64_tr_b16 v[32:33], v128 offset:57344
v_mfma_f32_16x16x32_bf16 v[68:71], v[16:19], v[4:7], v[68:71]
ds_read_b64_tr_b16 v[34:35], v128 offset:61440
buffer_load_dwordx4 v137, s[8:11], s15 offen offset:0 lds
v_mfma_f32_16x16x32_bf16 v[72:75], v[16:19], v[8:11], v[72:75]
ds_read_b64_tr_b16 v[36:37], v129 offset:57344
v_mfma_f32_16x16x32_bf16 v[76:79], v[16:19], v[12:15], v[76:79]
ds_read_b64_tr_b16 v[38:39], v129 offset:61440
v_mfma_f32_16x16x32_bf16 v[80:83], v[20:23], v[0:3], v[80:83]
ds_read_b64_tr_b16 v[40:41], v130 offset:57344
buffer_load_dwordx4 v138, s[8:11], s15 offen offset:1024 lds
v_mfma_f32_16x16x32_bf16 v[84:87], v[20:23], v[4:7], v[84:87]
ds_read_b64_tr_b16 v[42:43], v130 offset:61440
v_mfma_f32_16x16x32_bf16 v[88:91], v[20:23], v[8:11], v[88:91]
ds_read_b64_tr_b16 v[44:45], v131 offset:57344
v_mfma_f32_16x16x32_bf16 v[92:95], v[20:23], v[12:15], v[92:95]
ds_read_b64_tr_b16 v[46:47], v131 offset:61440
buffer_load_dwordx4 v139, s[8:11], s15 offen offset:2048 lds
v_mfma_f32_16x16x32_bf16 v[96:99], v[24:27], v[0:3], v[96:99]
ds_read_b128 v[52:55], v136 offset:52224
v_mfma_f32_16x16x32_bf16 v[100:103], v[24:27], v[4:7], v[100:103]
ds_read_b128 v[56:59], v136 offset:54272
buffer_load_dwordx4 v140, s[8:11], s15 offen offset:3072 lds
v_mfma_f32_16x16x32_bf16 v[104:107], v[24:27], v[8:11], v[104:107]
ds_read_b128 v[60:63], v136 offset:56320
v_mfma_f32_16x16x32_bf16 v[108:111], v[24:27], v[12:15], v[108:111]
v_mfma_f32_16x16x32_bf16 v[112:115], v[28:31], v[0:3], v[112:115]
s_add_u32 s15, s15, s17
v_mfma_f32_16x16x32_bf16 v[116:119], v[28:31], v[4:7], v[116:119]
v_mfma_f32_16x16x32_bf16 v[120:123], v[28:31], v[8:11], v[120:123]
v_mfma_f32_16x16x32_bf16 v[124:127], v[28:31], v[12:15], v[124:127]
s_waitcnt lgkmcnt(0)
v_mfma_f32_16x16x32_bf16 v[64:67], v[48:51], v[32:35], v[64:67]
s_waitcnt vmcnt(16)
s_barrier
ds_read_b128 v[16:19], v136 offset:0
s_add_u32 m0, s20, 49152
s_nop 0
ds_read_b32 v254, v255
v_mfma_f32_16x16x32_bf16 v[68:71], v[48:51], v[36:39], v[68:71]
ds_read_b64_tr_b16 v[0:1], v128 offset:0
v_mfma_f32_16x16x32_bf16 v[72:75], v[48:51], v[40:43], v[72:75]
ds_read_b64_tr_b16 v[2:3], v128 offset:4096
buffer_load_dwordx4 v141, s[4:7], s16 offen offset:0 sc1 lds
v_mfma_f32_16x16x32_bf16 v[76:79], v[48:51], v[44:47], v[76:79]
ds_read_b64_tr_b16 v[4:5], v129 offset:0
v_mfma_f32_16x16x32_bf16 v[80:83], v[52:55], v[32:35], v[80:83]
ds_read_b64_tr_b16 v[6:7], v129 offset:4096
v_mfma_f32_16x16x32_bf16 v[84:87], v[52:55], v[36:39], v[84:87]
ds_read_b64_tr_b16 v[8:9], v130 offset:0
buffer_load_dwordx4 v141, s[4:7], s16 offen offset:1024 sc1 lds
v_mfma_f32_16x16x32_bf16 v[88:91], v[52:55], v[40:43], v[88:91]
ds_read_b64_tr_b16 v[10:11], v130 offset:4096
v_mfma_f32_16x16x32_bf16 v[92:95], v[52:55], v[44:47], v[92:95]
ds_read_b64_tr_b16 v[12:13], v131 offset:0
buffer_load_dwordx4 v142, s[4:7], s16 offen offset:2048 sc1 lds
v_mfma_f32_16x16x32_bf16 v[96:99], v[56:59], v[32:35], v[96:99]
ds_read_b64_tr_b16 v[14:15], v131 offset:4096
v_mfma_f32_16x16x32_bf16 v[100:103], v[56:59], v[36:39], v[100:103]
ds_read_b128 v[20:23], v136 offset:2048
v_mfma_f32_16x16x32_bf16 v[104:107], v[56:59], v[40:43], v[104:107]
ds_read_b128 v[24:27], v136 offset:4096
buffer_load_dwordx4 v142, s[4:7], s16 offen offset:3072 sc1 lds
v_mfma_f32_16x16x32_bf16 v[108:111], v[56:59], v[44:47], v[108:111]
ds_read_b128 v[28:31], v136 offset:6144
v_mfma_f32_16x16x32_bf16 v[112:115], v[60:63], v[32:35], v[112:115]
s_add_u32 s16, s16, 2048
v_mfma_f32_16x16x32_bf16 v[116:119], v[60:63], v[36:39], v[116:119]
v_mfma_f32_16x16x32_bf16 v[120:123], v[60:63], v[40:43], v[120:123]
v_mfma_f32_16x16x32_bf16 v[124:127], v[60:63], v[44:47], v[124:127]
s_waitcnt lgkmcnt(0)
ds_read_b128 v[48:51], v136 offset:1024
s_add_u32 m0, s19, 49152
s_nop 0
v_mfma_f32_16x16x32_bf16 v[64:67], v[16:19], v[0:3], v[64:67]
ds_read_b64_tr_b16 v[32:33], v128 offset:8192
v_readfirstlane_b32 s62, v254
v_mfma_f32_16x16x32_bf16 v[68:71], v[16:19], v[4:7], v[68:71]
ds_read_b64_tr_b16 v[34:35], v128 offset:12288
buffer_load_dwordx4 v137, s[8:11], s15 offen offset:0 lds
v_mfma_f32_16x16x32_bf16 v[72:75], v[16:19], v[8:11], v[72:75]
ds_read_b64_tr_b16 v[36:37], v129 offset:8192
s_nop 1
v_mfma_f32_16x16x32_bf16 v[76:79], v[16:19], v[12:15], v[76:79]
ds_read_b64_tr_b16 v[38:39], v129 offset:12288
v_mfma_f32_16x16x32_bf16 v[80:83], v[20:23], v[0:3], v[80:83]
ds_read_b64_tr_b16 v[40:41], v130 offset:8192
buffer_load_dwordx4 v138, s[8:11], s15 offen offset:1024 lds
v_mfma_f32_16x16x32_bf16 v[84:87], v[20:23], v[4:7], v[84:87]
ds_read_b64_tr_b16 v[42:43], v130 offset:12288
s_and_b32 s23, s62, 15
v_mfma_f32_16x16x32_bf16 v[88:91], v[20:23], v[8:11], v[88:91]
ds_read_b64_tr_b16 v[44:45], v131 offset:8192
v_mfma_f32_16x16x32_bf16 v[92:95], v[20:23], v[12:15], v[92:95]
ds_read_b64_tr_b16 v[46:47], v131 offset:12288
buffer_load_dwordx4 v139, s[8:11], s15 offen offset:2048 lds
s_bfe_u32 s54, s62, 0x20004
v_mfma_f32_16x16x32_bf16 v[96:99], v[24:27], v[0:3], v[96:99]
ds_read_b128 v[52:55], v136 offset:3072
v_mfma_f32_16x16x32_bf16 v[100:103], v[24:27], v[4:7], v[100:103]
ds_read_b128 v[56:59], v136 offset:5120
buffer_load_dwordx4 v140, s[8:11], s15 offen offset:3072 lds
v_mfma_f32_16x16x32_bf16 v[104:107], v[24:27], v[8:11], v[104:107]
ds_read_b128 v[60:63], v136 offset:7168
s_bfe_u32 s24, s62, 0x80008
v_mfma_f32_16x16x32_bf16 v[108:111], v[24:27], v[12:15], v[108:111]
v_mfma_f32_16x16x32_bf16 v[112:115], v[28:31], v[0:3], v[112:115]
s_add_u32 s15, s15, s17
s_lshr_b32 s25, s62, 16
v_mfma_f32_16x16x32_bf16 v[116:119], v[28:31], v[4:7], v[116:119]
v_mfma_f32_16x16x32_bf16 v[120:123], v[28:31], v[8:11], v[120:123]
v_mfma_f32_16x16x32_bf16 v[124:127], v[28:31], v[12:15], v[124:127]
s_cmp_eq_u32 s54, 0
s_cselect_b32 s73, 1, -1
s_cbranch_scc1 main_kernel_w_c0_task
s_waitcnt lgkmcnt(0)
v_mfma_f32_16x16x32_bf16 v[64:67], v[48:51], v[32:35], v[64:67]
s_waitcnt vmcnt(16)
s_barrier
ds_read_b128 v[16:19], v136 offset:16384
v_mfma_f32_16x16x32_bf16 v[68:71], v[48:51], v[36:39], v[68:71]
ds_read_b64_tr_b16 v[0:1], v128 offset:16384
v_mfma_f32_16x16x32_bf16 v[72:75], v[48:51], v[40:43], v[72:75]
ds_read_b64_tr_b16 v[2:3], v128 offset:20480
v_mfma_f32_16x16x32_bf16 v[76:79], v[48:51], v[44:47], v[76:79]
ds_read_b64_tr_b16 v[4:5], v129 offset:16384
v_mfma_f32_16x16x32_bf16 v[80:83], v[52:55], v[32:35], v[80:83]
ds_read_b64_tr_b16 v[6:7], v129 offset:20480
v_mfma_f32_16x16x32_bf16 v[84:87], v[52:55], v[36:39], v[84:87]
ds_read_b64_tr_b16 v[8:9], v130 offset:16384
v_mfma_f32_16x16x32_bf16 v[88:91], v[52:55], v[40:43], v[88:91]
ds_read_b64_tr_b16 v[10:11], v130 offset:20480
v_mfma_f32_16x16x32_bf16 v[92:95], v[52:55], v[44:47], v[92:95]
ds_read_b64_tr_b16 v[12:13], v131 offset:16384
v_mfma_f32_16x16x32_bf16 v[96:99], v[56:59], v[32:35], v[96:99]
ds_read_b64_tr_b16 v[14:15], v131 offset:20480
v_mfma_f32_16x16x32_bf16 v[100:103], v[56:59], v[36:39], v[100:103]
ds_read_b128 v[20:23], v136 offset:18432
v_mfma_f32_16x16x32_bf16 v[104:107], v[56:59], v[40:43], v[104:107]
ds_read_b128 v[24:27], v136 offset:20480
v_mfma_f32_16x16x32_bf16 v[108:111], v[56:59], v[44:47], v[108:111]
ds_read_b128 v[28:31], v136 offset:22528
v_mfma_f32_16x16x32_bf16 v[112:115], v[60:63], v[32:35], v[112:115]
v_mfma_f32_16x16x32_bf16 v[116:119], v[60:63], v[36:39], v[116:119]
v_mfma_f32_16x16x32_bf16 v[120:123], v[60:63], v[40:43], v[120:123]
v_mfma_f32_16x16x32_bf16 v[124:127], v[60:63], v[44:47], v[124:127]
s_waitcnt lgkmcnt(0)
ds_read_b128 v[48:51], v136 offset:17408
v_mfma_f32_16x16x32_bf16 v[64:67], v[16:19], v[0:3], v[64:67]
ds_read_b64_tr_b16 v[32:33], v128 offset:24576
v_mfma_f32_16x16x32_bf16 v[68:71], v[16:19], v[4:7], v[68:71]
ds_read_b64_tr_b16 v[34:35], v128 offset:28672
v_mfma_f32_16x16x32_bf16 v[72:75], v[16:19], v[8:11], v[72:75]
ds_read_b64_tr_b16 v[36:37], v129 offset:24576
v_mfma_f32_16x16x32_bf16 v[76:79], v[16:19], v[12:15], v[76:79]
ds_read_b64_tr_b16 v[38:39], v129 offset:28672
v_mfma_f32_16x16x32_bf16 v[80:83], v[20:23], v[0:3], v[80:83]
ds_read_b64_tr_b16 v[40:41], v130 offset:24576
v_mfma_f32_16x16x32_bf16 v[84:87], v[20:23], v[4:7], v[84:87]
ds_read_b64_tr_b16 v[42:43], v130 offset:28672
v_mfma_f32_16x16x32_bf16 v[88:91], v[20:23], v[8:11], v[88:91]
ds_read_b64_tr_b16 v[44:45], v131 offset:24576
v_mfma_f32_16x16x32_bf16 v[92:95], v[20:23], v[12:15], v[92:95]
ds_read_b64_tr_b16 v[46:47], v131 offset:28672
v_mfma_f32_16x16x32_bf16 v[96:99], v[24:27], v[0:3], v[96:99]
ds_read_b128 v[52:55], v136 offset:19456
v_mfma_f32_16x16x32_bf16 v[100:103], v[24:27], v[4:7], v[100:103]
ds_read_b128 v[56:59], v136 offset:21504
v_mfma_f32_16x16x32_bf16 v[104:107], v[24:27], v[8:11], v[104:107]
ds_read_b128 v[60:63], v136 offset:23552
v_mfma_f32_16x16x32_bf16 v[108:111], v[24:27], v[12:15], v[108:111]
v_mfma_f32_16x16x32_bf16 v[112:115], v[28:31], v[0:3], v[112:115]
v_mfma_f32_16x16x32_bf16 v[116:119], v[28:31], v[4:7], v[116:119]
v_mfma_f32_16x16x32_bf16 v[120:123], v[28:31], v[8:11], v[120:123]
v_mfma_f32_16x16x32_bf16 v[124:127], v[28:31], v[12:15], v[124:127]
s_waitcnt lgkmcnt(0)
v_mfma_f32_16x16x32_bf16 v[64:67], v[48:51], v[32:35], v[64:67]
s_waitcnt vmcnt(8)
s_barrier
ds_read_b128 v[16:19], v136 offset:32768
v_mfma_f32_16x16x32_bf16 v[68:71], v[48:51], v[36:39], v[68:71]
ds_read_b64_tr_b16 v[0:1], v128 offset:32768
v_mfma_f32_16x16x32_bf16 v[72:75], v[48:51], v[40:43], v[72:75]
ds_read_b64_tr_b16 v[2:3], v128 offset:36864
v_mfma_f32_16x16x32_bf16 v[76:79], v[48:51], v[44:47], v[76:79]
ds_read_b64_tr_b16 v[4:5], v129 offset:32768
v_mfma_f32_16x16x32_bf16 v[80:83], v[52:55], v[32:35], v[80:83]
ds_read_b64_tr_b16 v[6:7], v129 offset:36864
v_mfma_f32_16x16x32_bf16 v[84:87], v[52:55], v[36:39], v[84:87]
ds_read_b64_tr_b16 v[8:9], v130 offset:32768
v_mfma_f32_16x16x32_bf16 v[88:91], v[52:55], v[40:43], v[88:91]
ds_read_b64_tr_b16 v[10:11], v130 offset:36864
v_mfma_f32_16x16x32_bf16 v[92:95], v[52:55], v[44:47], v[92:95]
ds_read_b64_tr_b16 v[12:13], v131 offset:32768
v_mfma_f32_16x16x32_bf16 v[96:99], v[56:59], v[32:35], v[96:99]
ds_read_b64_tr_b16 v[14:15], v131 offset:36864
v_mfma_f32_16x16x32_bf16 v[100:103], v[56:59], v[36:39], v[100:103]
ds_read_b128 v[20:23], v136 offset:34816
v_mfma_f32_16x16x32_bf16 v[104:107], v[56:59], v[40:43], v[104:107]
ds_read_b128 v[24:27], v136 offset:36864
v_mfma_f32_16x16x32_bf16 v[108:111], v[56:59], v[44:47], v[108:111]
ds_read_b128 v[28:31], v136 offset:38912
v_mfma_f32_16x16x32_bf16 v[112:115], v[60:63], v[32:35], v[112:115]
v_mfma_f32_16x16x32_bf16 v[116:119], v[60:63], v[36:39], v[116:119]
v_mfma_f32_16x16x32_bf16 v[120:123], v[60:63], v[40:43], v[120:123]
v_mfma_f32_16x16x32_bf16 v[124:127], v[60:63], v[44:47], v[124:127]
s_waitcnt lgkmcnt(0)
ds_read_b128 v[48:51], v136 offset:33792
v_mfma_f32_16x16x32_bf16 v[64:67], v[16:19], v[0:3], v[64:67]
ds_read_b64_tr_b16 v[32:33], v128 offset:40960
v_mfma_f32_16x16x32_bf16 v[68:71], v[16:19], v[4:7], v[68:71]
ds_read_b64_tr_b16 v[34:35], v128 offset:45056
v_mfma_f32_16x16x32_bf16 v[72:75], v[16:19], v[8:11], v[72:75]
ds_read_b64_tr_b16 v[36:37], v129 offset:40960
v_mfma_f32_16x16x32_bf16 v[76:79], v[16:19], v[12:15], v[76:79]
ds_read_b64_tr_b16 v[38:39], v129 offset:45056
v_mfma_f32_16x16x32_bf16 v[80:83], v[20:23], v[0:3], v[80:83]
ds_read_b64_tr_b16 v[40:41], v130 offset:40960
v_mfma_f32_16x16x32_bf16 v[84:87], v[20:23], v[4:7], v[84:87]
ds_read_b64_tr_b16 v[42:43], v130 offset:45056
v_mfma_f32_16x16x32_bf16 v[88:91], v[20:23], v[8:11], v[88:91]
ds_read_b64_tr_b16 v[44:45], v131 offset:40960
v_mfma_f32_16x16x32_bf16 v[92:95], v[20:23], v[12:15], v[92:95]
ds_read_b64_tr_b16 v[46:47], v131 offset:45056
v_mfma_f32_16x16x32_bf16 v[96:99], v[24:27], v[0:3], v[96:99]
ds_read_b128 v[52:55], v136 offset:35840
v_mfma_f32_16x16x32_bf16 v[100:103], v[24:27], v[4:7], v[100:103]
ds_read_b128 v[56:59], v136 offset:37888
v_mfma_f32_16x16x32_bf16 v[104:107], v[24:27], v[8:11], v[104:107]
ds_read_b128 v[60:63], v136 offset:39936
v_mfma_f32_16x16x32_bf16 v[108:111], v[24:27], v[12:15], v[108:111]
v_mfma_f32_16x16x32_bf16 v[112:115], v[28:31], v[0:3], v[112:115]
v_mfma_f32_16x16x32_bf16 v[116:119], v[28:31], v[4:7], v[116:119]
v_mfma_f32_16x16x32_bf16 v[120:123], v[28:31], v[8:11], v[120:123]
v_mfma_f32_16x16x32_bf16 v[124:127], v[28:31], v[12:15], v[124:127]
s_waitcnt lgkmcnt(0)
v_mfma_f32_16x16x32_bf16 v[64:67], v[48:51], v[32:35], v[64:67]
s_waitcnt vmcnt(0)
s_barrier
ds_read_b128 v[16:19], v136 offset:49152
v_mfma_f32_16x16x32_bf16 v[68:71], v[48:51], v[36:39], v[68:71]
ds_read_b64_tr_b16 v[0:1], v128 offset:49152
v_mfma_f32_16x16x32_bf16 v[72:75], v[48:51], v[40:43], v[72:75]
ds_read_b64_tr_b16 v[2:3], v128 offset:53248
v_mfma_f32_16x16x32_bf16 v[76:79], v[48:51], v[44:47], v[76:79]
ds_read_b64_tr_b16 v[4:5], v129 offset:49152
v_mfma_f32_16x16x32_bf16 v[80:83], v[52:55], v[32:35], v[80:83]
ds_read_b64_tr_b16 v[6:7], v129 offset:53248
v_mfma_f32_16x16x32_bf16 v[84:87], v[52:55], v[36:39], v[84:87]
ds_read_b64_tr_b16 v[8:9], v130 offset:49152
v_mfma_f32_16x16x32_bf16 v[88:91], v[52:55], v[40:43], v[88:91]
ds_read_b64_tr_b16 v[10:11], v130 offset:53248
v_mfma_f32_16x16x32_bf16 v[92:95], v[52:55], v[44:47], v[92:95]
ds_read_b64_tr_b16 v[12:13], v131 offset:49152
v_mfma_f32_16x16x32_bf16 v[96:99], v[56:59], v[32:35], v[96:99]
ds_read_b64_tr_b16 v[14:15], v131 offset:53248
v_mfma_f32_16x16x32_bf16 v[100:103], v[56:59], v[36:39], v[100:103]
ds_read_b128 v[20:23], v136 offset:51200
v_mfma_f32_16x16x32_bf16 v[104:107], v[56:59], v[40:43], v[104:107]
ds_read_b128 v[24:27], v136 offset:53248
v_mfma_f32_16x16x32_bf16 v[108:111], v[56:59], v[44:47], v[108:111]
ds_read_b128 v[28:31], v136 offset:55296
v_mfma_f32_16x16x32_bf16 v[112:115], v[60:63], v[32:35], v[112:115]
v_mfma_f32_16x16x32_bf16 v[116:119], v[60:63], v[36:39], v[116:119]
v_mfma_f32_16x16x32_bf16 v[120:123], v[60:63], v[40:43], v[120:123]
v_mfma_f32_16x16x32_bf16 v[124:127], v[60:63], v[44:47], v[124:127]
s_waitcnt lgkmcnt(0)
ds_read_b128 v[48:51], v136 offset:50176
v_mfma_f32_16x16x32_bf16 v[64:67], v[16:19], v[0:3], v[64:67]
ds_read_b64_tr_b16 v[32:33], v128 offset:57344
v_mfma_f32_16x16x32_bf16 v[68:71], v[16:19], v[4:7], v[68:71]
ds_read_b64_tr_b16 v[34:35], v128 offset:61440
v_mfma_f32_16x16x32_bf16 v[72:75], v[16:19], v[8:11], v[72:75]
ds_read_b64_tr_b16 v[36:37], v129 offset:57344
v_mfma_f32_16x16x32_bf16 v[76:79], v[16:19], v[12:15], v[76:79]
ds_read_b64_tr_b16 v[38:39], v129 offset:61440
v_mfma_f32_16x16x32_bf16 v[80:83], v[20:23], v[0:3], v[80:83]
ds_read_b64_tr_b16 v[40:41], v130 offset:57344
v_mfma_f32_16x16x32_bf16 v[84:87], v[20:23], v[4:7], v[84:87]
ds_read_b64_tr_b16 v[42:43], v130 offset:61440
v_mfma_f32_16x16x32_bf16 v[88:91], v[20:23], v[8:11], v[88:91]
ds_read_b64_tr_b16 v[44:45], v131 offset:57344
v_mfma_f32_16x16x32_bf16 v[92:95], v[20:23], v[12:15], v[92:95]
ds_read_b64_tr_b16 v[46:47], v131 offset:61440
v_mfma_f32_16x16x32_bf16 v[96:99], v[24:27], v[0:3], v[96:99]
ds_read_b128 v[52:55], v136 offset:52224
v_mfma_f32_16x16x32_bf16 v[100:103], v[24:27], v[4:7], v[100:103]
ds_read_b128 v[56:59], v136 offset:54272
v_mfma_f32_16x16x32_bf16 v[104:107], v[24:27], v[8:11], v[104:107]
ds_read_b128 v[60:63], v136 offset:56320
v_mfma_f32_16x16x32_bf16 v[108:111], v[24:27], v[12:15], v[108:111]
v_mfma_f32_16x16x32_bf16 v[112:115], v[28:31], v[0:3], v[112:115]
v_mfma_f32_16x16x32_bf16 v[116:119], v[28:31], v[4:7], v[116:119]
v_mfma_f32_16x16x32_bf16 v[120:123], v[28:31], v[8:11], v[120:123]
v_mfma_f32_16x16x32_bf16 v[124:127], v[28:31], v[12:15], v[124:127]
s_waitcnt lgkmcnt(0)
v_mfma_f32_16x16x32_bf16 v[64:67], v[48:51], v[32:35], v[64:67]
s_barrier
v_mfma_f32_16x16x32_bf16 v[68:71], v[48:51], v[36:39], v[68:71]
v_mfma_f32_16x16x32_bf16 v[72:75], v[48:51], v[40:43], v[72:75]
v_mfma_f32_16x16x32_bf16 v[76:79], v[48:51], v[44:47], v[76:79]
v_mfma_f32_16x16x32_bf16 v[80:83], v[52:55], v[32:35], v[80:83]
v_mfma_f32_16x16x32_bf16 v[84:87], v[52:55], v[36:39], v[84:87]
v_mfma_f32_16x16x32_bf16 v[88:91], v[52:55], v[40:43], v[88:91]
v_mfma_f32_16x16x32_bf16 v[92:95], v[52:55], v[44:47], v[92:95]
v_mfma_f32_16x16x32_bf16 v[96:99], v[56:59], v[32:35], v[96:99]
v_mfma_f32_16x16x32_bf16 v[100:103], v[56:59], v[36:39], v[100:103]
v_mfma_f32_16x16x32_bf16 v[104:107], v[56:59], v[40:43], v[104:107]
v_mfma_f32_16x16x32_bf16 v[108:111], v[56:59], v[44:47], v[108:111]
v_mfma_f32_16x16x32_bf16 v[112:115], v[60:63], v[32:35], v[112:115]
v_mfma_f32_16x16x32_bf16 v[116:119], v[60:63], v[36:39], v[116:119]
v_mfma_f32_16x16x32_bf16 v[120:123], v[60:63], v[40:43], v[120:123]
v_mfma_f32_16x16x32_bf16 v[124:127], v[60:63], v[44:47], v[124:127]
s_cmp_lg_u32 s62, -4
s_cbranch_scc1 main_kernel_w_gemm
s_branch main_kernel_w_slow
main_kernel_w_c0_v_ev:
s_mov_b32 s55, 1
s_cmp_eq_u32 s56, 0
s_cbranch_scc1 main_kernel_w_c0_v_et
s_bfm_b64 exec, s0, 0
buffer_store_dword v244, v248, s[4:7], s59 offen sc1
s_mov_b64 exec, -1
s_mov_b32 s56, 0
main_kernel_w_c0_v_et:
s_cmp_lg_u32 s18, 1
s_cbranch_scc1 main_kernel_w_c0_v_loop
s_lshl_b32 s32, s27, 8
s_add_u32 s32, s32, 0x841e000
s_mov_b64 exec, 1
v_mov_b32 v249, 1
buffer_atomic_add v249, off, s[4:7], s32 sc0 sc1
s_mov_b64 exec, -1
s_branch main_kernel_w_c0_v_loop
main_kernel_w_c1_task:
s_cmp_eq_u32 s23, 0
s_cbranch_scc1 main_kernel_w_c1_set0
s_cmp_eq_u32 s23, 1
s_cbranch_scc1 main_kernel_w_c1_set1
s_cmp_eq_u32 s23, 2
s_cbranch_scc1 main_kernel_w_c1_set2
s_cmp_eq_u32 s23, 3
s_cbranch_scc1 main_kernel_w_c1_set3
s_cmp_eq_u32 s23, 6
s_cbranch_scc1 main_kernel_w_c1_set6
s_branch main_kernel_end2
main_kernel_w_c1_set0:
s_mov_b32 s57, 6
s_lshl_b32 s32, s25, 8
s_add_u32 s8, s40, s32
s_addc_u32 s9, s41, 0
s_and_b32 s9, s9, 0xffff
s_sub_u32 s10, 0x800000, s32
s_mov_b32 s11, 0x20000
s_mov_b32 s30, 8192
s_mov_b32 s31, 32768
s_mul_i32 s16, s24, 262144
s_add_u32 s16, s16, 0x0
s_mov_b32 s18, 7
s_lshl_b32 s32, s24, 3
s_mul_i32 s33, s38, 4
s_add_u32 s32, s32, s33
s_mul_i32 s32, s32, 131072
s_lshl_b32 s33, s25, 12
s_add_u32 s32, s32, s33
s_mul_i32 s33, s37, 4096
s_add_u32 s32, s32, s33
s_add_u32 s21, s32, 0x800000
s_mov_b32 s22, 131072
s_mov_b32 s26, 0x7f000000
s_branch main_kernel_w_c1_go
main_kernel_w_c1_set1:
s_mov_b32 s57, 7
s_lshl_b32 s32, s25, 8
s_add_u32 s8, s42, s32
s_addc_u32 s9, s43, 0
s_and_b32 s9, s9, 0xffff
s_sub_u32 s10, 0x800000, s32
s_mov_b32 s11, 0x20000
s_mov_b32 s30, 8192
s_mov_b32 s31, 32768
s_mul_i32 s16, s24, 262144
s_add_u32 s16, s16, 0x0
s_mov_b32 s18, 7
s_lshl_b32 s32, s24, 3
s_mul_i32 s33, s38, 4
s_add_u32 s32, s32, s33
s_mul_i32 s32, s32, 131072
s_lshl_b32 s33, s25, 12
s_add_u32 s32, s32, s33
s_mul_i32 s33, s37, 4096
s_add_u32 s32, s32, s33
s_add_u32 s21, s32, 0x1800000
s_mov_b32 s22, 131072
s_mov_b32 s26, 0x7f000000
s_branch main_kernel_w_c1_go
main_kernel_w_c1_set2:
s_mov_b32 s57, 8
s_lshl_b32 s32, s25, 8
s_add_u32 s8, s44, s32
s_addc_u32 s9, s45, 0
s_and_b32 s9, s9, 0xffff
s_sub_u32 s10, 0x800000, s32
s_mov_b32 s11, 0x20000
s_mov_b32 s30, 8192
s_mov_b32 s31, 32768
s_mul_i32 s16, s24, 262144
s_add_u32 s16, s16, 0x0
s_mov_b32 s18, 7
s_lshl_b32 s32, s24, 2
s_mul_i32 s33, s38, 2
s_add_u32 s32, s32, s33
s_lshl_b32 s32, s32, 18
s_lshl_b32 s33, s25, 13
s_add_u32 s32, s32, s33
s_mul_i32 s33, s37, 8192
s_add_u32 s32, s32, s33
s_add_u32 s21, s32, 0x2800000
s_branch main_kernel_w_c1_gov
main_kernel_w_c1_set3:
s_mov_b32 s57, 9
s_lshl_b32 s32, s25, 8
s_add_u32 s8, s64, s32
s_addc_u32 s9, s65, 0
s_and_b32 s9, s9, 0xffff
s_sub_u32 s10, 0x200000, s32
s_mov_b32 s11, 0x20000
s_mov_b32 s30, 2048
s_mov_b32 s31, 32768
s_mul_i32 s16, s24, 262144
s_add_u32 s16, s16, 0x400000
s_mov_b32 s18, 7
s_lshl_b32 s32, s24, 3
s_mul_i32 s33, s38, 4
s_add_u32 s32, s32, s33
s_mul_i32 s32, s32, 32768
s_lshl_b32 s33, s25, 12
s_add_u32 s32, s32, s33
s_mul_i32 s33, s37, 4096
s_add_u32 s32, s32, s33
s_add_u32 s21, s32, 0x4800000
s_mov_b32 s22, 32768
s_mov_b32 s26, 0x7f000000
s_lshr_b32 s32, s25, 2
s_add_u32 s32, s32, 1
s_sub_u32 s33, 0, s32
s_bitcmp1_b32 s25, 1
s_cselect_b32 s32, s33, s32
s_add_u32 s32, s32, 16
v_and_b32 v253, 15, v250
v_add_u32 v253, s32, v253
v_lshrrev_b32 v254, 4, v253
v_lshlrev_b32 v254, 15, v254
v_and_b32 v253, 15, v253
v_lshl_add_u32 v254, v253, 4, v254
v_and_b32 v253, 0x300, v251
v_add_u32 v252, v253, v254
s_branch main_kernel_w_c1_go
main_kernel_w_c1_set6:
s_mov_b32 s57, 10
s_lshl_b32 s32, s25, 8
s_add_u32 s8, s68, s32
s_addc_u32 s9, s69, 0
s_and_b32 s9, s9, 0xffff
s_sub_u32 s10, 0x700000, s32
s_mov_b32 s11, 0x20000
s_mov_b32 s30, 7168
s_mov_b32 s31, 32768
s_mul_i32 s16, s24, 262144
s_add_u32 s16, s16, 0x6800000
s_mov_b32 s18, 7
s_lshl_b32 s32, s24, 3
s_mul_i32 s33, s38, 4
s_add_u32 s32, s32, s33
s_mul_i32 s32, s32, 114688
s_lshl_b32 s33, s25, 12
s_add_u32 s32, s32, s33
s_mul_i32 s33, s37, 4096
s_add_u32 s32, s32, s33
s_add_u32 s21, s32, 0x5400000
s_mov_b32 s22, 114688
s_mov_b32 s26, 0x7f000000
s_branch main_kernel_w_c1_go
main_kernel_w_c1_str:
s_mul_i32 s32, s14, 2
s_mul_i32 s32, s32, s31
v_mad_u32_u24 v137, v147, s30, v151
v_mad_u32_u24 v138, v148, s30, v152
v_mad_u32_u24 v139, v149, s30, v153
v_mad_u32_u24 v140, v150, s30, v154
v_add_u32 v141, s32, v251
s_add_u32 s32, s32, s31
s_sub_u32 s32, s32, 1024
v_add_u32 v142, s32, v251
s_mul_i32 s17, s30, 32
s_mov_b32 s15, 0
s_mov_b32 s18, 1
s_cmp_eq_u32 s73, 2
s_cbranch_scc1 main_kernel_w_c1_n_mid
s_branch main_kernel_w_c1_v_mid
main_kernel_w_c1_go:
s_mov_b32 s58, 2
s_mov_b32 s72, s18
s_cmp_lg_u32 s73, -1
s_cbranch_scc1 main_kernel_w_c1_str
s_waitcnt lgkmcnt(0)
v_lshrrev_b32 v0, 4, v250
v_bfe_u32 v1, v250, 2, 2
v_lshl_add_u32 v4, v0, 2, v1
v_and_b32 v5, 7, v4
v_mul_u32_u24 v4, 512, v4
v_and_b32 v6, 3, v250
v_lshl_add_u32 v4, v6, 3, v4
s_mul_i32 s32, s37, 8
v_xor_b32 v5, s32, v5
v_lshl_add_u32 v128, v5, 5, v4
v_xor_b32 v129, 32, v128
v_xor_b32 v130, 64, v128
v_xor_b32 v131, 96, v128
v_xor_b32 v132, 128, v128
v_xor_b32 v133, 160, v128
v_xor_b32 v134, 192, v128
v_xor_b32 v135, 224, v128
s_mul_i32 s32, s38, 4096
s_add_u32 s32, s32, 65536
v_add_u32 v136, s32, v251
v_lshrrev_b32 v2, 5, v250
v_and_b32 v3, 31, v250
s_mul_i32 s32, s14, 8
v_add_u32 v147, s32, v2
v_and_b32 v6, 7, v147
v_lshlrev_b32 v6, 1, v6
v_xor_b32 v6, v6, v3
v_lshlrev_b32 v151, 4, v6
v_add_u32 v148, 2, v147
v_and_b32 v6, 7, v148
v_lshlrev_b32 v6, 1, v6
v_xor_b32 v6, v6, v3
v_lshlrev_b32 v152, 4, v6
v_subrev_u32 v152, 1024, v152
v_add_u32 v149, 4, v147
v_and_b32 v6, 7, v149
v_lshlrev_b32 v6, 1, v6
v_xor_b32 v6, v6, v3
v_lshlrev_b32 v153, 4, v6
v_subrev_u32 v153, 2048, v153
v_add_u32 v150, 6, v147
v_and_b32 v6, 7, v150
v_lshlrev_b32 v6, 1, v6
v_xor_b32 v6, v6, v3
v_lshlrev_b32 v154, 4, v6
v_subrev_u32 v154, 3072, v154
s_mul_i32 s19, s14, 4096
s_mul_i32 s20, s14, 2048
s_add_u32 s20, s20, 65536
s_mul_i32 s32, s14, 2
s_mul_i32 s32, s32, s31
v_mad_u32_u24 v137, v147, s30, v151
v_mad_u32_u24 v138, v148, s30, v152
v_mad_u32_u24 v139, v149, s30, v153
v_mad_u32_u24 v140, v150, s30, v154
v_add_u32 v141, s32, v251
s_add_u32 s32, s32, s31
s_sub_u32 s32, s32, 1024
v_add_u32 v142, s32, v251
s_mul_i32 s17, s30, 32
s_mov_b32 s15, 0
s_waitcnt vmcnt(0)
s_add_u32 m0, s20, 0
s_nop 0
buffer_load_dwordx4 v141, s[4:7], s16 offen offset:0 sc1 lds
buffer_load_dwordx4 v142, s[4:7], s16 offen offset:1024 sc1 lds
s_add_u32 s16, s16, 1024
s_add_u32 m0, s19, 0
s_nop 0
buffer_load_dwordx4 v137, s[8:11], s15 offen offset:0 lds
buffer_load_dwordx4 v138, s[8:11], s15 offen offset:1024 lds
buffer_load_dwordx4 v139, s[8:11], s15 offen offset:2048 lds
buffer_load_dwordx4 v140, s[8:11], s15 offen offset:3072 lds
s_add_u32 s15, s15, s17
s_add_u32 m0, s20, 8192
s_nop 0
buffer_load_dwordx4 v141, s[4:7], s16 offen offset:0 sc1 lds
buffer_load_dwordx4 v142, s[4:7], s16 offen offset:1024 sc1 lds
s_add_u32 s16, s16, 1024
s_add_u32 m0, s19, 16384
s_nop 0
buffer_load_dwordx4 v137, s[8:11], s15 offen offset:0 lds
buffer_load_dwordx4 v138, s[8:11], s15 offen offset:1024 lds
buffer_load_dwordx4 v139, s[8:11], s15 offen offset:2048 lds
buffer_load_dwordx4 v140, s[8:11], s15 offen offset:3072 lds
s_add_u32 s15, s15, s17
s_add_u32 m0, s20, 16384
s_nop 0
buffer_load_dwordx4 v141, s[4:7], s16 offen offset:0 sc1 lds
buffer_load_dwordx4 v142, s[4:7], s16 offen offset:1024 sc1 lds
s_add_u32 s16, s16, 1024
s_add_u32 m0, s19, 32768
s_nop 0
buffer_load_dwordx4 v137, s[8:11], s15 offen offset:0 lds
buffer_load_dwordx4 v138, s[8:11], s15 offen offset:1024 lds
buffer_load_dwordx4 v139, s[8:11], s15 offen offset:2048 lds
buffer_load_dwordx4 v140, s[8:11], s15 offen offset:3072 lds
s_add_u32 s15, s15, s17
s_add_u32 m0, s20, 24576
s_nop 0
buffer_load_dwordx4 v141, s[4:7], s16 offen offset:0 sc1 lds
buffer_load_dwordx4 v142, s[4:7], s16 offen offset:1024 sc1 lds
s_add_u32 s16, s16, 1024
s_add_u32 m0, s19, 49152
s_nop 0
buffer_load_dwordx4 v137, s[8:11], s15 offen offset:0 lds
buffer_load_dwordx4 v138, s[8:11], s15 offen offset:1024 lds
buffer_load_dwordx4 v139, s[8:11], s15 offen offset:2048 lds
buffer_load_dwordx4 v140, s[8:11], s15 offen offset:3072 lds
s_add_u32 s15, s15, s17
s_cmp_lg_u32 s56, 0
s_cbranch_scc1 main_kernel_w_epi
main_kernel_w_c1_n_ent:
v_mfma_f32_32x32x16_bf16 a[0:15], v[224:227], v[224:227], 0
s_waitcnt vmcnt(18)
s_barrier
ds_read_b128 v[32:35], v136 offset:0
ds_read_b64_tr_b16 v[0:1], v128 offset:0
ds_read_b64_tr_b16 v[2:3], v128 offset:8192
v_mfma_f32_32x32x16_bf16 a[16:31], v[224:227], v[224:227], 0
ds_read_b64_tr_b16 v[4:5], v129 offset:0
ds_read_b64_tr_b16 v[6:7], v129 offset:8192
ds_read_b64_tr_b16 v[8:9], v130 offset:0
v_mfma_f32_32x32x16_bf16 a[32:47], v[224:227], v[224:227], 0
ds_read_b64_tr_b16 v[10:11], v130 offset:8192
ds_read_b64_tr_b16 v[12:13], v131 offset:0
ds_read_b64_tr_b16 v[14:15], v131 offset:8192
v_mfma_f32_32x32x16_bf16 a[48:63], v[224:227], v[224:227], 0
ds_read_b64_tr_b16 v[16:17], v132 offset:0
ds_read_b64_tr_b16 v[18:19], v132 offset:8192
ds_read_b64_tr_b16 v[20:21], v133 offset:0
v_mfma_f32_32x32x16_bf16 a[64:79], v[224:227], v[224:227], 0
ds_read_b64_tr_b16 v[22:23], v133 offset:8192
ds_read_b64_tr_b16 v[24:25], v134 offset:0
ds_read_b64_tr_b16 v[26:27], v134 offset:8192
v_mfma_f32_32x32x16_bf16 a[80:95], v[224:227], v[224:227], 0
ds_read_b64_tr_b16 v[28:29], v135 offset:0
ds_read_b64_tr_b16 v[30:31], v135 offset:8192
ds_read_b128 v[36:39], v136 offset:1024
v_mfma_f32_32x32x16_bf16 a[96:111], v[224:227], v[224:227], 0
ds_read_b128 v[40:43], v136 offset:2048
ds_read_b128 v[44:47], v136 offset:3072
v_mfma_f32_32x32x16_bf16 a[112:127], v[224:227], v[224:227], 0
s_sub_u32 s18, s72, 1
s_sub_u32 s55, s72, 2
s_orn2_b32 s55, s55, s100
s_mov_b32 s73, -1
s_nop 0
main_kernel_w_c1_n_loop:
main_kernel_w_c1_n_mid:
s_waitcnt lgkmcnt(0)
v_mfma_f32_16x16x32_bf16 a[0:3], v[0:3], v[32:35], a[0:3]
s_waitcnt vmcnt(12)
s_barrier
ds_read_b128 v[80:83], v136 offset:8192
s_add_u32 m0, s20, 0
s_nop 0
v_mfma_f32_16x16x32_bf16 a[4:7], v[4:7], v[32:35], a[4:7]
ds_read_b64_tr_b16 v[48:49], v128 offset:16384
v_mfma_f32_16x16x32_bf16 a[8:11], v[8:11], v[32:35], a[8:11]
ds_read_b64_tr_b16 v[50:51], v128 offset:24576
v_mfma_f32_16x16x32_bf16 a[12:15], v[12:15], v[32:35], a[12:15]
ds_read_b64_tr_b16 v[52:53], v129 offset:16384
buffer_load_dwordx4 v141, s[4:7], s16 offen offset:0 sc1 lds
v_mfma_f32_16x16x32_bf16 a[16:19], v[16:19], v[32:35], a[16:19]
ds_read_b64_tr_b16 v[54:55], v129 offset:24576
v_mfma_f32_16x16x32_bf16 a[20:23], v[20:23], v[32:35], a[20:23]
ds_read_b64_tr_b16 v[56:57], v130 offset:16384
v_mfma_f32_16x16x32_bf16 a[24:27], v[24:27], v[32:35], a[24:27]
ds_read_b64_tr_b16 v[58:59], v130 offset:24576
buffer_load_dwordx4 v142, s[4:7], s16 offen offset:1024 sc1 lds
v_mfma_f32_16x16x32_bf16 a[28:31], v[28:31], v[32:35], a[28:31]
ds_read_b64_tr_b16 v[60:61], v131 offset:16384
v_mfma_f32_16x16x32_bf16 a[32:35], v[0:3], v[36:39], a[32:35]
ds_read_b64_tr_b16 v[62:63], v131 offset:24576
v_mfma_f32_16x16x32_bf16 a[36:39], v[4:7], v[36:39], a[36:39]
ds_read_b64_tr_b16 v[64:65], v132 offset:16384
s_add_u32 s16, s16, 1024
v_mfma_f32_16x16x32_bf16 a[40:43], v[8:11], v[36:39], a[40:43]
ds_read_b64_tr_b16 v[66:67], v132 offset:24576
v_mfma_f32_16x16x32_bf16 a[44:47], v[12:15], v[36:39], a[44:47]
ds_read_b64_tr_b16 v[68:69], v133 offset:16384
v_mfma_f32_16x16x32_bf16 a[48:51], v[16:19], v[36:39], a[48:51]
ds_read_b64_tr_b16 v[70:71], v133 offset:24576
s_add_u32 m0, s19, 0
s_nop 0
v_mfma_f32_16x16x32_bf16 a[52:55], v[20:23], v[36:39], a[52:55]
ds_read_b64_tr_b16 v[72:73], v134 offset:16384
v_mfma_f32_16x16x32_bf16 a[56:59], v[24:27], v[36:39], a[56:59]
ds_read_b64_tr_b16 v[74:75], v134 offset:24576
v_mfma_f32_16x16x32_bf16 a[60:63], v[28:31], v[36:39], a[60:63]
ds_read_b64_tr_b16 v[76:77], v135 offset:16384
buffer_load_dwordx4 v137, s[8:11], s15 offen offset:0 lds
v_mfma_f32_16x16x32_bf16 a[64:67], v[0:3], v[40:43], a[64:67]
ds_read_b64_tr_b16 v[78:79], v135 offset:24576
v_mfma_f32_16x16x32_bf16 a[68:71], v[4:7], v[40:43], a[68:71]
ds_read_b128 v[84:87], v136 offset:9216
v_mfma_f32_16x16x32_bf16 a[72:75], v[8:11], v[40:43], a[72:75]
ds_read_b128 v[88:91], v136 offset:10240
buffer_load_dwordx4 v138, s[8:11], s15 offen offset:1024 lds
v_mfma_f32_16x16x32_bf16 a[76:79], v[12:15], v[40:43], a[76:79]
ds_read_b128 v[92:95], v136 offset:11264
v_mfma_f32_16x16x32_bf16 a[80:83], v[16:19], v[40:43], a[80:83]
v_mfma_f32_16x16x32_bf16 a[84:87], v[20:23], v[40:43], a[84:87]
buffer_load_dwordx4 v139, s[8:11], s15 offen offset:2048 lds
v_mfma_f32_16x16x32_bf16 a[88:91], v[24:27], v[40:43], a[88:91]
v_mfma_f32_16x16x32_bf16 a[92:95], v[28:31], v[40:43], a[92:95]
v_mfma_f32_16x16x32_bf16 a[96:99], v[0:3], v[44:47], a[96:99]
buffer_load_dwordx4 v140, s[8:11], s15 offen offset:3072 lds
v_mfma_f32_16x16x32_bf16 a[100:103], v[4:7], v[44:47], a[100:103]
v_mfma_f32_16x16x32_bf16 a[104:107], v[8:11], v[44:47], a[104:107]
v_mfma_f32_16x16x32_bf16 a[108:111], v[12:15], v[44:47], a[108:111]
s_add_u32 s15, s15, s17
v_mfma_f32_16x16x32_bf16 a[112:115], v[16:19], v[44:47], a[112:115]
v_mfma_f32_16x16x32_bf16 a[116:119], v[20:23], v[44:47], a[116:119]
v_mfma_f32_16x16x32_bf16 a[120:123], v[24:27], v[44:47], a[120:123]
v_mfma_f32_16x16x32_bf16 a[124:127], v[28:31], v[44:47], a[124:127]
s_waitcnt lgkmcnt(0)
v_mfma_f32_16x16x32_bf16 a[0:3], v[48:51], v[80:83], a[0:3]
s_waitcnt vmcnt(12)
s_barrier
ds_read_b128 v[32:35], v136 offset:16384
s_add_u32 m0, s20, 8192
s_nop 0
v_mfma_f32_16x16x32_bf16 a[4:7], v[52:55], v[80:83], a[4:7]
ds_read_b64_tr_b16 v[0:1], v128 offset:32768
v_mfma_f32_16x16x32_bf16 a[8:11], v[56:59], v[80:83], a[8:11]
ds_read_b64_tr_b16 v[2:3], v128 offset:40960
v_mfma_f32_16x16x32_bf16 a[12:15], v[60:63], v[80:83], a[12:15]
ds_read_b64_tr_b16 v[4:5], v129 offset:32768
buffer_load_dwordx4 v141, s[4:7], s16 offen offset:0 sc1 lds
v_mfma_f32_16x16x32_bf16 a[16:19], v[64:67], v[80:83], a[16:19]
ds_read_b64_tr_b16 v[6:7], v129 offset:40960
v_mfma_f32_16x16x32_bf16 a[20:23], v[68:71], v[80:83], a[20:23]
ds_read_b64_tr_b16 v[8:9], v130 offset:32768
v_mfma_f32_16x16x32_bf16 a[24:27], v[72:75], v[80:83], a[24:27]
ds_read_b64_tr_b16 v[10:11], v130 offset:40960
buffer_load_dwordx4 v142, s[4:7], s16 offen offset:1024 sc1 lds
v_mfma_f32_16x16x32_bf16 a[28:31], v[76:79], v[80:83], a[28:31]
ds_read_b64_tr_b16 v[12:13], v131 offset:32768
v_mfma_f32_16x16x32_bf16 a[32:35], v[48:51], v[84:87], a[32:35]
ds_read_b64_tr_b16 v[14:15], v131 offset:40960
v_mfma_f32_16x16x32_bf16 a[36:39], v[52:55], v[84:87], a[36:39]
ds_read_b64_tr_b16 v[16:17], v132 offset:32768
s_add_u32 s16, s16, 1024
v_mfma_f32_16x16x32_bf16 a[40:43], v[56:59], v[84:87], a[40:43]
ds_read_b64_tr_b16 v[18:19], v132 offset:40960
v_mfma_f32_16x16x32_bf16 a[44:47], v[60:63], v[84:87], a[44:47]
ds_read_b64_tr_b16 v[20:21], v133 offset:32768
v_mfma_f32_16x16x32_bf16 a[48:51], v[64:67], v[84:87], a[48:51]
ds_read_b64_tr_b16 v[22:23], v133 offset:40960
s_add_u32 m0, s19, 16384
s_nop 0
v_mfma_f32_16x16x32_bf16 a[52:55], v[68:71], v[84:87], a[52:55]
ds_read_b64_tr_b16 v[24:25], v134 offset:32768
v_mfma_f32_16x16x32_bf16 a[56:59], v[72:75], v[84:87], a[56:59]
ds_read_b64_tr_b16 v[26:27], v134 offset:40960
v_mfma_f32_16x16x32_bf16 a[60:63], v[76:79], v[84:87], a[60:63]
ds_read_b64_tr_b16 v[28:29], v135 offset:32768
buffer_load_dwordx4 v137, s[8:11], s15 offen offset:0 lds
v_mfma_f32_16x16x32_bf16 a[64:67], v[48:51], v[88:91], a[64:67]
ds_read_b64_tr_b16 v[30:31], v135 offset:40960
v_mfma_f32_16x16x32_bf16 a[68:71], v[52:55], v[88:91], a[68:71]
ds_read_b128 v[36:39], v136 offset:17408
v_mfma_f32_16x16x32_bf16 a[72:75], v[56:59], v[88:91], a[72:75]
ds_read_b128 v[40:43], v136 offset:18432
buffer_load_dwordx4 v138, s[8:11], s15 offen offset:1024 lds
v_mfma_f32_16x16x32_bf16 a[76:79], v[60:63], v[88:91], a[76:79]
ds_read_b128 v[44:47], v136 offset:19456
v_mfma_f32_16x16x32_bf16 a[80:83], v[64:67], v[88:91], a[80:83]
v_mfma_f32_16x16x32_bf16 a[84:87], v[68:71], v[88:91], a[84:87]
buffer_load_dwordx4 v139, s[8:11], s15 offen offset:2048 lds
v_mfma_f32_16x16x32_bf16 a[88:91], v[72:75], v[88:91], a[88:91]
v_mfma_f32_16x16x32_bf16 a[92:95], v[76:79], v[88:91], a[92:95]
v_mfma_f32_16x16x32_bf16 a[96:99], v[48:51], v[92:95], a[96:99]
buffer_load_dwordx4 v140, s[8:11], s15 offen offset:3072 lds
v_mfma_f32_16x16x32_bf16 a[100:103], v[52:55], v[92:95], a[100:103]
v_mfma_f32_16x16x32_bf16 a[104:107], v[56:59], v[92:95], a[104:107]
v_mfma_f32_16x16x32_bf16 a[108:111], v[60:63], v[92:95], a[108:111]
s_add_u32 s15, s15, s17
v_mfma_f32_16x16x32_bf16 a[112:115], v[64:67], v[92:95], a[112:115]
v_mfma_f32_16x16x32_bf16 a[116:119], v[68:71], v[92:95], a[116:119]
v_mfma_f32_16x16x32_bf16 a[120:123], v[72:75], v[92:95], a[120:123]
v_mfma_f32_16x16x32_bf16 a[124:127], v[76:79], v[92:95], a[124:127]
s_waitcnt lgkmcnt(0)
v_mfma_f32_16x16x32_bf16 a[0:3], v[0:3], v[32:35], a[0:3]
s_waitcnt vmcnt(12)
s_barrier
ds_read_b128 v[80:83], v136 offset:24576
s_add_u32 m0, s20, 16384
s_nop 0
v_mfma_f32_16x16x32_bf16 a[4:7], v[4:7], v[32:35], a[4:7]
ds_read_b64_tr_b16 v[48:49], v128 offset:49152
v_mfma_f32_16x16x32_bf16 a[8:11], v[8:11], v[32:35], a[8:11]
ds_read_b64_tr_b16 v[50:51], v128 offset:57344
v_mfma_f32_16x16x32_bf16 a[12:15], v[12:15], v[32:35], a[12:15]
ds_read_b64_tr_b16 v[52:53], v129 offset:49152
buffer_load_dwordx4 v141, s[4:7], s16 offen offset:0 sc1 lds
v_mfma_f32_16x16x32_bf16 a[16:19], v[16:19], v[32:35], a[16:19]
ds_read_b64_tr_b16 v[54:55], v129 offset:57344
v_mfma_f32_16x16x32_bf16 a[20:23], v[20:23], v[32:35], a[20:23]
ds_read_b64_tr_b16 v[56:57], v130 offset:49152
v_mfma_f32_16x16x32_bf16 a[24:27], v[24:27], v[32:35], a[24:27]
ds_read_b64_tr_b16 v[58:59], v130 offset:57344
buffer_load_dwordx4 v142, s[4:7], s16 offen offset:1024 sc1 lds
v_mfma_f32_16x16x32_bf16 a[28:31], v[28:31], v[32:35], a[28:31]
ds_read_b64_tr_b16 v[60:61], v131 offset:49152
v_mfma_f32_16x16x32_bf16 a[32:35], v[0:3], v[36:39], a[32:35]
ds_read_b64_tr_b16 v[62:63], v131 offset:57344
v_mfma_f32_16x16x32_bf16 a[36:39], v[4:7], v[36:39], a[36:39]
ds_read_b64_tr_b16 v[64:65], v132 offset:49152
s_add_u32 s16, s16, 1024
v_mfma_f32_16x16x32_bf16 a[40:43], v[8:11], v[36:39], a[40:43]
ds_read_b64_tr_b16 v[66:67], v132 offset:57344
v_mfma_f32_16x16x32_bf16 a[44:47], v[12:15], v[36:39], a[44:47]
ds_read_b64_tr_b16 v[68:69], v133 offset:49152
v_mfma_f32_16x16x32_bf16 a[48:51], v[16:19], v[36:39], a[48:51]
ds_read_b64_tr_b16 v[70:71], v133 offset:57344
s_add_u32 m0, s19, 32768
s_nop 0
v_mfma_f32_16x16x32_bf16 a[52:55], v[20:23], v[36:39], a[52:55]
ds_read_b64_tr_b16 v[72:73], v134 offset:49152
v_mfma_f32_16x16x32_bf16 a[56:59], v[24:27], v[36:39], a[56:59]
ds_read_b64_tr_b16 v[74:75], v134 offset:57344
v_mfma_f32_16x16x32_bf16 a[60:63], v[28:31], v[36:39], a[60:63]
ds_read_b64_tr_b16 v[76:77], v135 offset:49152
buffer_load_dwordx4 v137, s[8:11], s15 offen offset:0 lds
v_mfma_f32_16x16x32_bf16 a[64:67], v[0:3], v[40:43], a[64:67]
ds_read_b64_tr_b16 v[78:79], v135 offset:57344
v_mfma_f32_16x16x32_bf16 a[68:71], v[4:7], v[40:43], a[68:71]
ds_read_b128 v[84:87], v136 offset:25600
v_mfma_f32_16x16x32_bf16 a[72:75], v[8:11], v[40:43], a[72:75]
ds_read_b128 v[88:91], v136 offset:26624
buffer_load_dwordx4 v138, s[8:11], s15 offen offset:1024 lds
v_mfma_f32_16x16x32_bf16 a[76:79], v[12:15], v[40:43], a[76:79]
ds_read_b128 v[92:95], v136 offset:27648
v_mfma_f32_16x16x32_bf16 a[80:83], v[16:19], v[40:43], a[80:83]
v_mfma_f32_16x16x32_bf16 a[84:87], v[20:23], v[40:43], a[84:87]
buffer_load_dwordx4 v139, s[8:11], s15 offen offset:2048 lds
v_mfma_f32_16x16x32_bf16 a[88:91], v[24:27], v[40:43], a[88:91]
v_mfma_f32_16x16x32_bf16 a[92:95], v[28:31], v[40:43], a[92:95]
v_mfma_f32_16x16x32_bf16 a[96:99], v[0:3], v[44:47], a[96:99]
buffer_load_dwordx4 v140, s[8:11], s15 offen offset:3072 lds
v_mfma_f32_16x16x32_bf16 a[100:103], v[4:7], v[44:47], a[100:103]
v_mfma_f32_16x16x32_bf16 a[104:107], v[8:11], v[44:47], a[104:107]
v_mfma_f32_16x16x32_bf16 a[108:111], v[12:15], v[44:47], a[108:111]
s_add_u32 s15, s15, s17
v_mfma_f32_16x16x32_bf16 a[112:115], v[16:19], v[44:47], a[112:115]
v_mfma_f32_16x16x32_bf16 a[116:119], v[20:23], v[44:47], a[116:119]
v_mfma_f32_16x16x32_bf16 a[120:123], v[24:27], v[44:47], a[120:123]
v_mfma_f32_16x16x32_bf16 a[124:127], v[28:31], v[44:47], a[124:127]
s_waitcnt lgkmcnt(0)
v_mfma_f32_16x16x32_bf16 a[0:3], v[48:51], v[80:83], a[0:3]
s_waitcnt vmcnt(12)
s_barrier
ds_read_b128 v[32:35], v136 offset:0
s_add_u32 m0, s20, 24576
s_nop 0
v_mfma_f32_16x16x32_bf16 a[4:7], v[52:55], v[80:83], a[4:7]
ds_read_b64_tr_b16 v[0:1], v128 offset:0
v_mfma_f32_16x16x32_bf16 a[8:11], v[56:59], v[80:83], a[8:11]
ds_read_b64_tr_b16 v[2:3], v128 offset:8192
v_mfma_f32_16x16x32_bf16 a[12:15], v[60:63], v[80:83], a[12:15]
ds_read_b64_tr_b16 v[4:5], v129 offset:0
buffer_load_dwordx4 v141, s[4:7], s16 offen offset:0 sc1 lds
v_mfma_f32_16x16x32_bf16 a[16:19], v[64:67], v[80:83], a[16:19]
ds_read_b64_tr_b16 v[6:7], v129 offset:8192
v_mfma_f32_16x16x32_bf16 a[20:23], v[68:71], v[80:83], a[20:23]
ds_read_b64_tr_b16 v[8:9], v130 offset:0
v_mfma_f32_16x16x32_bf16 a[24:27], v[72:75], v[80:83], a[24:27]
ds_read_b64_tr_b16 v[10:11], v130 offset:8192
buffer_load_dwordx4 v142, s[4:7], s16 offen offset:1024 sc1 lds
v_mfma_f32_16x16x32_bf16 a[28:31], v[76:79], v[80:83], a[28:31]
ds_read_b64_tr_b16 v[12:13], v131 offset:0
v_mfma_f32_16x16x32_bf16 a[32:35], v[48:51], v[84:87], a[32:35]
ds_read_b64_tr_b16 v[14:15], v131 offset:8192
v_mfma_f32_16x16x32_bf16 a[36:39], v[52:55], v[84:87], a[36:39]
ds_read_b64_tr_b16 v[16:17], v132 offset:0
s_add_u32 s16, s16, 1024
v_mfma_f32_16x16x32_bf16 a[40:43], v[56:59], v[84:87], a[40:43]
ds_read_b64_tr_b16 v[18:19], v132 offset:8192
v_mfma_f32_16x16x32_bf16 a[44:47], v[60:63], v[84:87], a[44:47]
ds_read_b64_tr_b16 v[20:21], v133 offset:0
v_mfma_f32_16x16x32_bf16 a[48:51], v[64:67], v[84:87], a[48:51]
ds_read_b64_tr_b16 v[22:23], v133 offset:8192
s_add_u32 m0, s19, 49152
s_nop 0
v_mfma_f32_16x16x32_bf16 a[52:55], v[68:71], v[84:87], a[52:55]
ds_read_b64_tr_b16 v[24:25], v134 offset:0
v_mfma_f32_16x16x32_bf16 a[56:59], v[72:75], v[84:87], a[56:59]
ds_read_b64_tr_b16 v[26:27], v134 offset:8192
v_mfma_f32_16x16x32_bf16 a[60:63], v[76:79], v[84:87], a[60:63]
ds_read_b64_tr_b16 v[28:29], v135 offset:0
buffer_load_dwordx4 v137, s[8:11], s15 offen offset:0 lds
v_mfma_f32_16x16x32_bf16 a[64:67], v[48:51], v[88:91], a[64:67]
ds_read_b64_tr_b16 v[30:31], v135 offset:8192
v_mfma_f32_16x16x32_bf16 a[68:71], v[52:55], v[88:91], a[68:71]
ds_read_b128 v[36:39], v136 offset:1024
v_mfma_f32_16x16x32_bf16 a[72:75], v[56:59], v[88:91], a[72:75]
ds_read_b128 v[40:43], v136 offset:2048
buffer_load_dwordx4 v138, s[8:11], s15 offen offset:1024 lds
v_mfma_f32_16x16x32_bf16 a[76:79], v[60:63], v[88:91], a[76:79]
ds_read_b128 v[44:47], v136 offset:3072
v_mfma_f32_16x16x32_bf16 a[80:83], v[64:67], v[88:91], a[80:83]
v_mfma_f32_16x16x32_bf16 a[84:87], v[68:71], v[88:91], a[84:87]
buffer_load_dwordx4 v139, s[8:11], s15 offen offset:2048 lds
v_mfma_f32_16x16x32_bf16 a[88:91], v[72:75], v[88:91], a[88:91]
v_mfma_f32_16x16x32_bf16 a[92:95], v[76:79], v[88:91], a[92:95]
v_mfma_f32_16x16x32_bf16 a[96:99], v[48:51], v[92:95], a[96:99]
buffer_load_dwordx4 v140, s[8:11], s15 offen offset:3072 lds
v_mfma_f32_16x16x32_bf16 a[100:103], v[52:55], v[92:95], a[100:103]
v_mfma_f32_16x16x32_bf16 a[104:107], v[56:59], v[92:95], a[104:107]
v_mfma_f32_16x16x32_bf16 a[108:111], v[60:63], v[92:95], a[108:111]
s_add_u32 s15, s15, s17
v_mfma_f32_16x16x32_bf16 a[112:115], v[64:67], v[92:95], a[112:115]
v_mfma_f32_16x16x32_bf16 a[116:119], v[68:71], v[92:95], a[116:119]
v_mfma_f32_16x16x32_bf16 a[120:123], v[72:75], v[92:95], a[120:123]
v_mfma_f32_16x16x32_bf16 a[124:127], v[76:79], v[92:95], a[124:127]
s_sub_u32 s18, s18, 1
s_cmp_eq_u32 s18, s55
s_cbranch_scc1 main_kernel_w_c1_n_ev
s_cmp_lg_u32 s18, 0
s_cbranch_scc1 main_kernel_w_c1_n_loop
s_cmp_lg_u32 s73, -1
s_cbranch_scc1 main_kernel_w_epn
s_waitcnt lgkmcnt(0)
v_mfma_f32_16x16x32_bf16 a[0:3], v[0:3], v[32:35], a[0:3]
s_waitcnt vmcnt(12)
s_barrier
ds_read_b128 v[80:83], v136 offset:8192
s_add_u32 m0, s20, 0
s_nop 0
s_add_u32 s32, s23, 1
s_bitcmp0_b32 s32, 2
s_cselect_b32 s34, 7, 2
s_cselect_b32 s35, 2, 4
s_lshl_b32 s59, s23, 13
s_add_u32 s59, s59, 0x8404000
v_mfma_f32_16x16x32_bf16 a[4:7], v[4:7], v[32:35], a[4:7]
ds_read_b64_tr_b16 v[48:49], v128 offset:16384
v_lshrrev_b32 v253, 3, v250
v_add_lshl_u32 v253, s24, v253, 9
v_mfma_f32_16x16x32_bf16 a[8:11], v[8:11], v[32:35], a[8:11]
ds_read_b64_tr_b16 v[50:51], v128 offset:24576
v_and_b32 v254, 3, v250
v_lshl_add_u32 v253, v254, s34, v253
v_mfma_f32_16x16x32_bf16 a[12:15], v[12:15], v[32:35], a[12:15]
ds_read_b64_tr_b16 v[52:53], v129 offset:16384
buffer_load_dwordx4 v141, s[4:7], s16 offen offset:0 sc1 lds
v_bfe_u32 v254, v250, 2, 1
v_add_u32 v254, s25, v254
v_mfma_f32_16x16x32_bf16 a[16:19], v[16:19], v[32:35], a[16:19]
ds_read_b64_tr_b16 v[54:55], v129 offset:24576
v_lshl_add_u32 v248, v254, s35, v253
s_lshl_b32 s0, 4, s54
v_mfma_f32_16x16x32_bf16 a[20:23], v[20:23], v[32:35], a[20:23]
ds_read_b64_tr_b16 v[56:57], v130 offset:16384
v_readfirstlane_b32 s28, v249
s_nop 1
v_cmp_ge_u32 vcc, s28, v229
v_mfma_f32_16x16x32_bf16 a[24:27], v[24:27], v[32:35], a[24:27]
ds_read_b64_tr_b16 v[58:59], v130 offset:24576
buffer_load_dwordx4 v142, s[4:7], s16 offen offset:1024 sc1 lds
s_nop 1
s_bcnt1_i32_b64 s32, vcc
v_mfma_f32_16x16x32_bf16 a[28:31], v[28:31], v[32:35], a[28:31]
ds_read_b64_tr_b16 v[60:61], v131 offset:16384
s_sub_u32 s32, s32, 1
v_readlane_b32 s36, v230, s32
v_mfma_f32_16x16x32_bf16 a[32:35], v[0:3], v[36:39], a[32:35]
ds_read_b64_tr_b16 v[62:63], v131 offset:24576
s_nop 1
s_and_b32 s32, s36, 0x7ff
v_mfma_f32_16x16x32_bf16 a[36:39], v[4:7], v[36:39], a[36:39]
ds_read_b64_tr_b16 v[64:65], v132 offset:16384
s_add_u32 s16, s16, 1024
s_sub_u32 s28, s28, s32
s_bfe_u32 s32, s36, 0x3001a
v_mfma_f32_16x16x32_bf16 a[40:43], v[8:11], v[36:39], a[40:43]
ds_read_b64_tr_b16 v[66:67], v132 offset:24576
s_lshr_b32 s25, s28, s32
s_lshl_b32 s33, s25, s32
s_sub_u32 s24, s28, s33
v_mfma_f32_16x16x32_bf16 a[44:47], v[12:15], v[36:39], a[44:47]
ds_read_b64_tr_b16 v[68:69], v133 offset:16384
s_bfe_u32 s34, s36, 0x1001d
s_lshl_b32 s24, s24, s34
v_mfma_f32_16x16x32_bf16 a[48:51], v[16:19], v[36:39], a[48:51]
ds_read_b64_tr_b16 v[70:71], v133 offset:24576
s_add_u32 m0, s19, 0
s_nop 0
s_bfe_u32 s35, s36, 0x1001e
s_lshl_b32 s25, s25, s35
v_mfma_f32_16x16x32_bf16 a[52:55], v[20:23], v[36:39], a[52:55]
ds_read_b64_tr_b16 v[72:73], v134 offset:16384
s_bfe_u32 s32, s36, 0x40011
s_add_u32 s24, s24, s32
v_mfma_f32_16x16x32_bf16 a[56:59], v[24:27], v[36:39], a[56:59]
ds_read_b64_tr_b16 v[74:75], v134 offset:24576
s_bfe_u32 s32, s36, 0x50015
s_add_u32 s25, s25, s32
v_mfma_f32_16x16x32_bf16 a[60:63], v[28:31], v[36:39], a[60:63]
ds_read_b64_tr_b16 v[76:77], v135 offset:16384
buffer_load_dwordx4 v137, s[8:11], s15 offen offset:0 lds
s_bfe_u32 s23, s36, 0x4000b
s_bfe_u32 s36, s36, 0x6000b
s_lshl_b32 s32, s24, 8
v_mfma_f32_16x16x32_bf16 a[64:67], v[0:3], v[40:43], a[64:67]
ds_read_b64_tr_b16 v[78:79], v135 offset:24576
s_or_b32 s36, s36, s32
s_lshl_b32 s32, s25, 16
v_mfma_f32_16x16x32_bf16 a[68:71], v[4:7], v[40:43], a[68:71]
ds_read_b128 v[84:87], v136 offset:9216
s_or_b32 s36, s36, s32
s_cmp_eq_u32 s23, 4
s_cselect_b32 s32, 1, 0
v_mfma_f32_16x16x32_bf16 a[72:75], v[8:11], v[40:43], a[72:75]
ds_read_b128 v[88:91], v136 offset:10240
buffer_load_dwordx4 v138, s[8:11], s15 offen offset:1024 lds
s_sub_u32 s48, s24, s32
s_max_i32 s48, s48, 0
v_mfma_f32_16x16x32_bf16 a[76:79], v[12:15], v[40:43], a[76:79]
ds_read_b128 v[92:95], v136 offset:11264
s_add_u32 s49, s24, s34
s_add_u32 s49, s49, s32
v_mfma_f32_16x16x32_bf16 a[80:83], v[16:19], v[40:43], a[80:83]
s_min_u32 s49, s49, 15
s_cmp_eq_u32 s23, 6
s_cselect_b32 s51, 3, 7
s_cmp_eq_u32 s23, 7
s_cselect_b32 s51, 27, s51
s_cselect_b32 s50, 5, 4
v_mfma_f32_16x16x32_bf16 a[84:87], v[20:23], v[40:43], a[84:87]
buffer_load_dwordx4 v139, s[8:11], s15 offen offset:2048 lds
s_add_u32 s33, s25, s35
s_lshl_b32 s34, s24, 9
v_mfma_f32_16x16x32_bf16 a[88:91], v[24:27], v[40:43], a[88:91]
s_cmp_eq_u32 s23, 8
s_cselect_b32 s51, 0, s51
s_cselect_b32 s48, s25, s48
s_cselect_b32 s49, s33, s49
s_cmp_eq_u32 s23, 8
s_cselect_b32 s63, 2, 9
s_cselect_b32 s61, 0, 0x7f000000
s_cselect_b32 s34, s34, 0
v_mfma_f32_16x16x32_bf16 a[92:95], v[28:31], v[40:43], a[92:95]
v_lshrrev_b32 v228, s50, v250
v_lshlrev_b32 v254, s50, v228
v_mfma_f32_16x16x32_bf16 a[96:99], v[0:3], v[44:47], a[96:99]
buffer_load_dwordx4 v140, s[8:11], s15 offen offset:3072 lds
v_sub_u32 v254, v250, v254
s_cmp_lt_u32 s23, 4
s_cselect_b32 s39, 10, s23
v_mfma_f32_16x16x32_bf16 a[100:103], v[4:7], v[44:47], a[100:103]
v_min_u32 v254, s51, v254
s_lshl_b32 s39, s39, 13
s_cmp_eq_u32 s23, 3
s_cselect_b32 s34, 4, s34
v_mfma_f32_16x16x32_bf16 a[104:107], v[8:11], v[44:47], a[104:107]
v_add_u32 v228, s48, v228
s_add_u32 s39, s39, s34
v_mfma_f32_16x16x32_bf16 a[108:111], v[12:15], v[44:47], a[108:111]
s_add_u32 s15, s15, s17
s_add_u32 s39, s39, 0x8402000
v_min_u32 v228, s49, v228
v_mfma_f32_16x16x32_bf16 a[112:115], v[16:19], v[44:47], a[112:115]
s_lshl_b32 s60, s24, 10
s_add_u32 s60, s60, 0x8400000
v_mfma_f32_16x16x32_bf16 a[116:119], v[20:23], v[44:47], a[116:119]
v_lshlrev_b32 v228, s63, v228
v_lshl_add_u32 v228, v254, 4, v228
v_mfma_f32_16x16x32_bf16 a[120:123], v[24:27], v[44:47], a[120:123]
v_or_b32 v146, s61, v251
s_mov_b64 exec, s[100:101]
buffer_load_dword v231, v228, s[4:7], s39 offen sc1
buffer_load_dwordx4 v[232:235], v146, s[4:7], s60 offen sc1
s_mov_b64 exec, -1
v_mfma_f32_16x16x32_bf16 a[124:127], v[28:31], v[44:47], a[124:127]
s_waitcnt lgkmcnt(0)
v_mfma_f32_16x16x32_bf16 a[0:3], v[48:51], v[80:83], a[0:3]
s_waitcnt vmcnt(12)
s_barrier
ds_read_b128 v[32:35], v136 offset:16384
s_add_u32 m0, s20, 8192
s_nop 0
s_mov_b32 s1, s21
v_mfma_f32_16x16x32_bf16 a[4:7], v[52:55], v[80:83], a[4:7]
ds_read_b64_tr_b16 v[0:1], v128 offset:32768
v_mfma_f32_16x16x32_bf16 a[8:11], v[56:59], v[80:83], a[8:11]
ds_read_b64_tr_b16 v[2:3], v128 offset:40960
v_mfma_f32_16x16x32_bf16 a[12:15], v[60:63], v[80:83], a[12:15]
ds_read_b64_tr_b16 v[4:5], v129 offset:32768
buffer_load_dwordx4 v141, s[4:7], s16 offen offset:0 sc1 lds
v_mfma_f32_16x16x32_bf16 a[16:19], v[64:67], v[80:83], a[16:19]
ds_read_b64_tr_b16 v[6:7], v129 offset:40960
v_mfma_f32_16x16x32_bf16 a[20:23], v[68:71], v[80:83], a[20:23]
ds_read_b64_tr_b16 v[8:9], v130 offset:32768
s_mov_b32 s2, s22
v_mfma_f32_16x16x32_bf16 a[24:27], v[72:75], v[80:83], a[24:27]
ds_read_b64_tr_b16 v[10:11], v130 offset:40960
buffer_load_dwordx4 v142, s[4:7], s16 offen offset:1024 sc1 lds
v_mfma_f32_16x16x32_bf16 a[28:31], v[76:79], v[80:83], a[28:31]
ds_read_b64_tr_b16 v[12:13], v131 offset:32768
v_mfma_f32_16x16x32_bf16 a[32:35], v[48:51], v[84:87], a[32:35]
ds_read_b64_tr_b16 v[14:15], v131 offset:40960
v_mfma_f32_16x16x32_bf16 a[36:39], v[52:55], v[84:87], a[36:39]
ds_read_b64_tr_b16 v[16:17], v132 offset:32768
s_add_u32 s16, s16, 1024
v_mfma_f32_16x16x32_bf16 a[40:43], v[56:59], v[84:87], a[40:43]
ds_read_b64_tr_b16 v[18:19], v132 offset:40960
s_mov_b32 s3, s26
v_mfma_f32_16x16x32_bf16 a[44:47], v[60:63], v[84:87], a[44:47]
ds_read_b64_tr_b16 v[20:21], v133 offset:32768
v_mfma_f32_16x16x32_bf16 a[48:51], v[64:67], v[84:87], a[48:51]
ds_read_b64_tr_b16 v[22:23], v133 offset:40960
s_add_u32 m0, s19, 16384
s_nop 0
v_mfma_f32_16x16x32_bf16 a[52:55], v[68:71], v[84:87], a[52:55]
ds_read_b64_tr_b16 v[24:25], v134 offset:32768
v_mfma_f32_16x16x32_bf16 a[56:59], v[72:75], v[84:87], a[56:59]
ds_read_b64_tr_b16 v[26:27], v134 offset:40960
v_mfma_f32_16x16x32_bf16 a[60:63], v[76:79], v[84:87], a[60:63]
ds_read_b64_tr_b16 v[28:29], v135 offset:32768
buffer_load_dwordx4 v137, s[8:11], s15 offen offset:0 lds
s_mov_b32 s56, s57
v_mfma_f32_16x16x32_bf16 a[64:67], v[48:51], v[88:91], a[64:67]
ds_read_b64_tr_b16 v[30:31], v135 offset:40960
v_mfma_f32_16x16x32_bf16 a[68:71], v[52:55], v[88:91], a[68:71]
ds_read_b128 v[36:39], v136 offset:17408
v_mfma_f32_16x16x32_bf16 a[72:75], v[56:59], v[88:91], a[72:75]
ds_read_b128 v[40:43], v136 offset:18432
buffer_load_dwordx4 v138, s[8:11], s15 offen offset:1024 lds
v_mfma_f32_16x16x32_bf16 a[76:79], v[60:63], v[88:91], a[76:79]
ds_read_b128 v[44:47], v136 offset:19456
v_mfma_f32_16x16x32_bf16 a[80:83], v[64:67], v[88:91], a[80:83]
v_mov_b32 v145, v252
v_mfma_f32_16x16x32_bf16 a[84:87], v[68:71], v[88:91], a[84:87]
buffer_load_dwordx4 v139, s[8:11], s15 offen offset:2048 lds
v_mfma_f32_16x16x32_bf16 a[88:91], v[72:75], v[88:91], a[88:91]
v_mfma_f32_16x16x32_bf16 a[92:95], v[76:79], v[88:91], a[92:95]
v_mfma_f32_16x16x32_bf16 a[96:99], v[48:51], v[92:95], a[96:99]
buffer_load_dwordx4 v140, s[8:11], s15 offen offset:3072 lds
v_mfma_f32_16x16x32_bf16 a[100:103], v[52:55], v[92:95], a[100:103]
v_mov_b32 v255, 131072
v_mfma_f32_16x16x32_bf16 a[104:107], v[56:59], v[92:95], a[104:107]
v_mfma_f32_16x16x32_bf16 a[108:111], v[60:63], v[92:95], a[108:111]
s_add_u32 s15, s15, s17
v_mfma_f32_16x16x32_bf16 a[112:115], v[64:67], v[92:95], a[112:115]
v_mfma_f32_16x16x32_bf16 a[116:119], v[68:71], v[92:95], a[116:119]
v_mfma_f32_16x16x32_bf16 a[120:123], v[72:75], v[92:95], a[120:123]
v_mfma_f32_16x16x32_bf16 a[124:127], v[76:79], v[92:95], a[124:127]
s_waitcnt lgkmcnt(0)
v_mfma_f32_16x16x32_bf16 a[0:3], v[0:3], v[32:35], a[0:3]
s_waitcnt vmcnt(12)
s_barrier
ds_read_b128 v[80:83], v136 offset:24576
s_add_u32 m0, s20, 16384
s_nop 0
v_mfma_f32_16x16x32_bf16 a[4:7], v[4:7], v[32:35], a[4:7]
ds_read_b64_tr_b16 v[48:49], v128 offset:49152
v_mfma_f32_16x16x32_bf16 a[8:11], v[8:11], v[32:35], a[8:11]
ds_read_b64_tr_b16 v[50:51], v128 offset:57344
v_mfma_f32_16x16x32_bf16 a[12:15], v[12:15], v[32:35], a[12:15]
ds_read_b64_tr_b16 v[52:53], v129 offset:49152
buffer_load_dwordx4 v141, s[4:7], s16 offen offset:0 sc1 lds
v_mfma_f32_16x16x32_bf16 a[16:19], v[16:19], v[32:35], a[16:19]
ds_read_b64_tr_b16 v[54:55], v129 offset:57344
v_mfma_f32_16x16x32_bf16 a[20:23], v[20:23], v[32:35], a[20:23]
ds_read_b64_tr_b16 v[56:57], v130 offset:49152
v_mfma_f32_16x16x32_bf16 a[24:27], v[24:27], v[32:35], a[24:27]
ds_read_b64_tr_b16 v[58:59], v130 offset:57344
buffer_load_dwordx4 v142, s[4:7], s16 offen offset:1024 sc1 lds
v_mfma_f32_16x16x32_bf16 a[28:31], v[28:31], v[32:35], a[28:31]
ds_read_b64_tr_b16 v[60:61], v131 offset:49152
v_mfma_f32_16x16x32_bf16 a[32:35], v[0:3], v[36:39], a[32:35]
ds_read_b64_tr_b16 v[62:63], v131 offset:57344
v_mfma_f32_16x16x32_bf16 a[36:39], v[4:7], v[36:39], a[36:39]
ds_read_b64_tr_b16 v[64:65], v132 offset:49152
s_add_u32 s16, s16, 1024
v_mfma_f32_16x16x32_bf16 a[40:43], v[8:11], v[36:39], a[40:43]
ds_read_b64_tr_b16 v[66:67], v132 offset:57344
v_mfma_f32_16x16x32_bf16 a[44:47], v[12:15], v[36:39], a[44:47]
ds_read_b64_tr_b16 v[68:69], v133 offset:49152
v_mfma_f32_16x16x32_bf16 a[48:51], v[16:19], v[36:39], a[48:51]
ds_read_b64_tr_b16 v[70:71], v133 offset:57344
s_add_u32 m0, s19, 32768
s_nop 0
v_mfma_f32_16x16x32_bf16 a[52:55], v[20:23], v[36:39], a[52:55]
ds_read_b64_tr_b16 v[72:73], v134 offset:49152
v_mfma_f32_16x16x32_bf16 a[56:59], v[24:27], v[36:39], a[56:59]
ds_read_b64_tr_b16 v[74:75], v134 offset:57344
v_mfma_f32_16x16x32_bf16 a[60:63], v[28:31], v[36:39], a[60:63]
ds_read_b64_tr_b16 v[76:77], v135 offset:49152
buffer_load_dwordx4 v137, s[8:11], s15 offen offset:0 lds
v_mfma_f32_16x16x32_bf16 a[64:67], v[0:3], v[40:43], a[64:67]
ds_read_b64_tr_b16 v[78:79], v135 offset:57344
v_mfma_f32_16x16x32_bf16 a[68:71], v[4:7], v[40:43], a[68:71]
ds_read_b128 v[84:87], v136 offset:25600
v_mfma_f32_16x16x32_bf16 a[72:75], v[8:11], v[40:43], a[72:75]
ds_read_b128 v[88:91], v136 offset:26624
buffer_load_dwordx4 v138, s[8:11], s15 offen offset:1024 lds
v_mfma_f32_16x16x32_bf16 a[76:79], v[12:15], v[40:43], a[76:79]
ds_read_b128 v[92:95], v136 offset:27648
v_mfma_f32_16x16x32_bf16 a[80:83], v[16:19], v[40:43], a[80:83]
s_waitcnt vmcnt(10)
v_mfma_f32_16x16x32_bf16 a[84:87], v[20:23], v[40:43], a[84:87]
buffer_load_dwordx4 v139, s[8:11], s15 offen offset:2048 lds
v_min3_u32 v253, v232, v233, v234
v_mfma_f32_16x16x32_bf16 a[88:91], v[24:27], v[40:43], a[88:91]
v_min_u32 v253, v253, v235
v_mfma_f32_16x16x32_bf16 a[92:95], v[28:31], v[40:43], a[92:95]
v_or_b32 v253, s61, v253
v_mfma_f32_16x16x32_bf16 a[96:99], v[0:3], v[44:47], a[96:99]
buffer_load_dwordx4 v140, s[8:11], s15 offen offset:3072 lds
v_min_u32 v253, v253, v231
v_mfma_f32_16x16x32_bf16 a[100:103], v[4:7], v[44:47], a[100:103]
v_cmp_eq_u32 vcc, 0, v253
v_mfma_f32_16x16x32_bf16 a[104:107], v[8:11], v[44:47], a[104:107]
s_nop 1
v_mfma_f32_16x16x32_bf16 a[108:111], v[12:15], v[44:47], a[108:111]
s_add_u32 s15, s15, s17
s_cmp_eq_u64 vcc, 0
s_cselect_b32 s32, s36, -4
v_mfma_f32_16x16x32_bf16 a[112:115], v[16:19], v[44:47], a[112:115]
s_bitcmp1_b32 0x1df, s23
s_cselect_b32 s32, s32, -4
v_mfma_f32_16x16x32_bf16 a[116:119], v[20:23], v[44:47], a[116:119]
v_mov_b32 v254, s32
v_mfma_f32_16x16x32_bf16 a[120:123], v[24:27], v[44:47], a[120:123]
s_mov_b64 exec, s[100:101]
ds_write_b32 v255, v254
s_mov_b64 exec, -1
v_mfma_f32_16x16x32_bf16 a[124:127], v[28:31], v[44:47], a[124:127]
s_waitcnt lgkmcnt(0)
v_mfma_f32_16x16x32_bf16 a[0:3], v[48:51], v[80:83], a[0:3]
s_waitcnt vmcnt(12)
s_barrier
ds_read_b128 v[32:35], v136 offset:0
s_add_u32 m0, s20, 24576
s_nop 0
ds_read_b32 v254, v255
v_mfma_f32_16x16x32_bf16 a[4:7], v[52:55], v[80:83], a[4:7]
ds_read_b64_tr_b16 v[0:1], v128 offset:0
v_mfma_f32_16x16x32_bf16 a[8:11], v[56:59], v[80:83], a[8:11]
ds_read_b64_tr_b16 v[2:3], v128 offset:8192
v_mfma_f32_16x16x32_bf16 a[12:15], v[60:63], v[80:83], a[12:15]
ds_read_b64_tr_b16 v[4:5], v129 offset:0
buffer_load_dwordx4 v141, s[4:7], s16 offen offset:0 sc1 lds
v_mfma_f32_16x16x32_bf16 a[16:19], v[64:67], v[80:83], a[16:19]
ds_read_b64_tr_b16 v[6:7], v129 offset:8192
v_mfma_f32_16x16x32_bf16 a[20:23], v[68:71], v[80:83], a[20:23]
ds_read_b64_tr_b16 v[8:9], v130 offset:0
v_mfma_f32_16x16x32_bf16 a[24:27], v[72:75], v[80:83], a[24:27]
ds_read_b64_tr_b16 v[10:11], v130 offset:8192
buffer_load_dwordx4 v142, s[4:7], s16 offen offset:1024 sc1 lds
v_mfma_f32_16x16x32_bf16 a[28:31], v[76:79], v[80:83], a[28:31]
ds_read_b64_tr_b16 v[12:13], v131 offset:0
v_mfma_f32_16x16x32_bf16 a[32:35], v[48:51], v[84:87], a[32:35]
ds_read_b64_tr_b16 v[14:15], v131 offset:8192
v_mfma_f32_16x16x32_bf16 a[36:39], v[52:55], v[84:87], a[36:39]
ds_read_b64_tr_b16 v[16:17], v132 offset:0
s_add_u32 s16, s16, 1024
v_mfma_f32_16x16x32_bf16 a[40:43], v[56:59], v[84:87], a[40:43]
ds_read_b64_tr_b16 v[18:19], v132 offset:8192
v_mfma_f32_16x16x32_bf16 a[44:47], v[60:63], v[84:87], a[44:47]
ds_read_b64_tr_b16 v[20:21], v133 offset:0
v_mfma_f32_16x16x32_bf16 a[48:51], v[64:67], v[84:87], a[48:51]
ds_read_b64_tr_b16 v[22:23], v133 offset:8192
s_add_u32 m0, s19, 49152
s_nop 0
v_mfma_f32_16x16x32_bf16 a[52:55], v[68:71], v[84:87], a[52:55]
ds_read_b64_tr_b16 v[24:25], v134 offset:0
v_mfma_f32_16x16x32_bf16 a[56:59], v[72:75], v[84:87], a[56:59]
ds_read_b64_tr_b16 v[26:27], v134 offset:8192
v_mfma_f32_16x16x32_bf16 a[60:63], v[76:79], v[84:87], a[60:63]
ds_read_b64_tr_b16 v[28:29], v135 offset:0
buffer_load_dwordx4 v137, s[8:11], s15 offen offset:0 lds
v_mfma_f32_16x16x32_bf16 a[64:67], v[48:51], v[88:91], a[64:67]
ds_read_b64_tr_b16 v[30:31], v135 offset:8192
v_mfma_f32_16x16x32_bf16 a[68:71], v[52:55], v[88:91], a[68:71]
ds_read_b128 v[36:39], v136 offset:1024
v_mfma_f32_16x16x32_bf16 a[72:75], v[56:59], v[88:91], a[72:75]
ds_read_b128 v[40:43], v136 offset:2048
buffer_load_dwordx4 v138, s[8:11], s15 offen offset:1024 lds
v_mfma_f32_16x16x32_bf16 a[76:79], v[60:63], v[88:91], a[76:79]
ds_read_b128 v[44:47], v136 offset:3072
v_mfma_f32_16x16x32_bf16 a[80:83], v[64:67], v[88:91], a[80:83]
s_waitcnt lgkmcnt(8)
v_mfma_f32_16x16x32_bf16 a[84:87], v[68:71], v[88:91], a[84:87]
buffer_load_dwordx4 v139, s[8:11], s15 offen offset:2048 lds
v_readfirstlane_b32 s62, v254
v_mfma_f32_16x16x32_bf16 a[88:91], v[72:75], v[88:91], a[88:91]
v_mfma_f32_16x16x32_bf16 a[92:95], v[76:79], v[88:91], a[92:95]
s_nop 1
v_mfma_f32_16x16x32_bf16 a[96:99], v[48:51], v[92:95], a[96:99]
buffer_load_dwordx4 v140, s[8:11], s15 offen offset:3072 lds
s_and_b32 s23, s62, 15
v_mfma_f32_16x16x32_bf16 a[100:103], v[52:55], v[92:95], a[100:103]
v_mfma_f32_16x16x32_bf16 a[104:107], v[56:59], v[92:95], a[104:107]
s_bfe_u32 s54, s62, 0x20004
v_mfma_f32_16x16x32_bf16 a[108:111], v[60:63], v[92:95], a[108:111]
s_add_u32 s15, s15, s17
s_bfe_u32 s24, s62, 0x80008
v_mfma_f32_16x16x32_bf16 a[112:115], v[64:67], v[92:95], a[112:115]
v_mfma_f32_16x16x32_bf16 a[116:119], v[68:71], v[92:95], a[116:119]
s_lshr_b32 s25, s62, 16
v_mfma_f32_16x16x32_bf16 a[120:123], v[72:75], v[92:95], a[120:123]
v_mfma_f32_16x16x32_bf16 a[124:127], v[76:79], v[92:95], a[124:127]
s_cmp_eq_u32 s54, 1
s_cselect_b32 s73, 2, -1
s_cbranch_scc1 main_kernel_w_c1_task
s_waitcnt lgkmcnt(0)
v_mfma_f32_16x16x32_bf16 a[0:3], v[0:3], v[32:35], a[0:3]
s_waitcnt vmcnt(12)
s_barrier
ds_read_b128 v[80:83], v136 offset:8192
v_mfma_f32_16x16x32_bf16 a[4:7], v[4:7], v[32:35], a[4:7]
ds_read_b64_tr_b16 v[48:49], v128 offset:16384
v_mfma_f32_16x16x32_bf16 a[8:11], v[8:11], v[32:35], a[8:11]
ds_read_b64_tr_b16 v[50:51], v128 offset:24576
v_mfma_f32_16x16x32_bf16 a[12:15], v[12:15], v[32:35], a[12:15]
ds_read_b64_tr_b16 v[52:53], v129 offset:16384
v_mfma_f32_16x16x32_bf16 a[16:19], v[16:19], v[32:35], a[16:19]
ds_read_b64_tr_b16 v[54:55], v129 offset:24576
v_mfma_f32_16x16x32_bf16 a[20:23], v[20:23], v[32:35], a[20:23]
ds_read_b64_tr_b16 v[56:57], v130 offset:16384
v_mfma_f32_16x16x32_bf16 a[24:27], v[24:27], v[32:35], a[24:27]
ds_read_b64_tr_b16 v[58:59], v130 offset:24576
v_mfma_f32_16x16x32_bf16 a[28:31], v[28:31], v[32:35], a[28:31]
ds_read_b64_tr_b16 v[60:61], v131 offset:16384
v_mfma_f32_16x16x32_bf16 a[32:35], v[0:3], v[36:39], a[32:35]
ds_read_b64_tr_b16 v[62:63], v131 offset:24576
v_mfma_f32_16x16x32_bf16 a[36:39], v[4:7], v[36:39], a[36:39]
ds_read_b64_tr_b16 v[64:65], v132 offset:16384
v_mfma_f32_16x16x32_bf16 a[40:43], v[8:11], v[36:39], a[40:43]
ds_read_b64_tr_b16 v[66:67], v132 offset:24576
v_mfma_f32_16x16x32_bf16 a[44:47], v[12:15], v[36:39], a[44:47]
ds_read_b64_tr_b16 v[68:69], v133 offset:16384
v_mfma_f32_16x16x32_bf16 a[48:51], v[16:19], v[36:39], a[48:51]
ds_read_b64_tr_b16 v[70:71], v133 offset:24576
v_mfma_f32_16x16x32_bf16 a[52:55], v[20:23], v[36:39], a[52:55]
ds_read_b64_tr_b16 v[72:73], v134 offset:16384
v_mfma_f32_16x16x32_bf16 a[56:59], v[24:27], v[36:39], a[56:59]
ds_read_b64_tr_b16 v[74:75], v134 offset:24576
v_mfma_f32_16x16x32_bf16 a[60:63], v[28:31], v[36:39], a[60:63]
ds_read_b64_tr_b16 v[76:77], v135 offset:16384
v_mfma_f32_16x16x32_bf16 a[64:67], v[0:3], v[40:43], a[64:67]
ds_read_b64_tr_b16 v[78:79], v135 offset:24576
v_mfma_f32_16x16x32_bf16 a[68:71], v[4:7], v[40:43], a[68:71]
ds_read_b128 v[84:87], v136 offset:9216
v_mfma_f32_16x16x32_bf16 a[72:75], v[8:11], v[40:43], a[72:75]
ds_read_b128 v[88:91], v136 offset:10240
v_mfma_f32_16x16x32_bf16 a[76:79], v[12:15], v[40:43], a[76:79]
ds_read_b128 v[92:95], v136 offset:11264
v_mfma_f32_16x16x32_bf16 a[80:83], v[16:19], v[40:43], a[80:83]
v_mfma_f32_16x16x32_bf16 a[84:87], v[20:23], v[40:43], a[84:87]
v_mfma_f32_16x16x32_bf16 a[88:91], v[24:27], v[40:43], a[88:91]
v_mfma_f32_16x16x32_bf16 a[92:95], v[28:31], v[40:43], a[92:95]
v_mfma_f32_16x16x32_bf16 a[96:99], v[0:3], v[44:47], a[96:99]
v_mfma_f32_16x16x32_bf16 a[100:103], v[4:7], v[44:47], a[100:103]
v_mfma_f32_16x16x32_bf16 a[104:107], v[8:11], v[44:47], a[104:107]
v_mfma_f32_16x16x32_bf16 a[108:111], v[12:15], v[44:47], a[108:111]
v_mfma_f32_16x16x32_bf16 a[112:115], v[16:19], v[44:47], a[112:115]
v_mfma_f32_16x16x32_bf16 a[116:119], v[20:23], v[44:47], a[116:119]
v_mfma_f32_16x16x32_bf16 a[120:123], v[24:27], v[44:47], a[120:123]
v_mfma_f32_16x16x32_bf16 a[124:127], v[28:31], v[44:47], a[124:127]
s_waitcnt lgkmcnt(0)
v_mfma_f32_16x16x32_bf16 a[0:3], v[48:51], v[80:83], a[0:3]
s_waitcnt vmcnt(6)
s_barrier
ds_read_b128 v[32:35], v136 offset:16384
v_mfma_f32_16x16x32_bf16 a[4:7], v[52:55], v[80:83], a[4:7]
ds_read_b64_tr_b16 v[0:1], v128 offset:32768
v_mfma_f32_16x16x32_bf16 a[8:11], v[56:59], v[80:83], a[8:11]
ds_read_b64_tr_b16 v[2:3], v128 offset:40960
v_mfma_f32_16x16x32_bf16 a[12:15], v[60:63], v[80:83], a[12:15]
ds_read_b64_tr_b16 v[4:5], v129 offset:32768
v_mfma_f32_16x16x32_bf16 a[16:19], v[64:67], v[80:83], a[16:19]
ds_read_b64_tr_b16 v[6:7], v129 offset:40960
v_mfma_f32_16x16x32_bf16 a[20:23], v[68:71], v[80:83], a[20:23]
ds_read_b64_tr_b16 v[8:9], v130 offset:32768
v_mfma_f32_16x16x32_bf16 a[24:27], v[72:75], v[80:83], a[24:27]
ds_read_b64_tr_b16 v[10:11], v130 offset:40960
v_mfma_f32_16x16x32_bf16 a[28:31], v[76:79], v[80:83], a[28:31]
ds_read_b64_tr_b16 v[12:13], v131 offset:32768
v_mfma_f32_16x16x32_bf16 a[32:35], v[48:51], v[84:87], a[32:35]
ds_read_b64_tr_b16 v[14:15], v131 offset:40960
v_mfma_f32_16x16x32_bf16 a[36:39], v[52:55], v[84:87], a[36:39]
ds_read_b64_tr_b16 v[16:17], v132 offset:32768
v_mfma_f32_16x16x32_bf16 a[40:43], v[56:59], v[84:87], a[40:43]
ds_read_b64_tr_b16 v[18:19], v132 offset:40960
v_mfma_f32_16x16x32_bf16 a[44:47], v[60:63], v[84:87], a[44:47]
ds_read_b64_tr_b16 v[20:21], v133 offset:32768
v_mfma_f32_16x16x32_bf16 a[48:51], v[64:67], v[84:87], a[48:51]
ds_read_b64_tr_b16 v[22:23], v133 offset:40960
v_mfma_f32_16x16x32_bf16 a[52:55], v[68:71], v[84:87], a[52:55]
ds_read_b64_tr_b16 v[24:25], v134 offset:32768
v_mfma_f32_16x16x32_bf16 a[56:59], v[72:75], v[84:87], a[56:59]
ds_read_b64_tr_b16 v[26:27], v134 offset:40960
v_mfma_f32_16x16x32_bf16 a[60:63], v[76:79], v[84:87], a[60:63]
ds_read_b64_tr_b16 v[28:29], v135 offset:32768
v_mfma_f32_16x16x32_bf16 a[64:67], v[48:51], v[88:91], a[64:67]
ds_read_b64_tr_b16 v[30:31], v135 offset:40960
v_mfma_f32_16x16x32_bf16 a[68:71], v[52:55], v[88:91], a[68:71]
ds_read_b128 v[36:39], v136 offset:17408
v_mfma_f32_16x16x32_bf16 a[72:75], v[56:59], v[88:91], a[72:75]
ds_read_b128 v[40:43], v136 offset:18432
v_mfma_f32_16x16x32_bf16 a[76:79], v[60:63], v[88:91], a[76:79]
ds_read_b128 v[44:47], v136 offset:19456
v_mfma_f32_16x16x32_bf16 a[80:83], v[64:67], v[88:91], a[80:83]
v_mfma_f32_16x16x32_bf16 a[84:87], v[68:71], v[88:91], a[84:87]
v_mfma_f32_16x16x32_bf16 a[88:91], v[72:75], v[88:91], a[88:91]
v_mfma_f32_16x16x32_bf16 a[92:95], v[76:79], v[88:91], a[92:95]
v_mfma_f32_16x16x32_bf16 a[96:99], v[48:51], v[92:95], a[96:99]
v_mfma_f32_16x16x32_bf16 a[100:103], v[52:55], v[92:95], a[100:103]
v_mfma_f32_16x16x32_bf16 a[104:107], v[56:59], v[92:95], a[104:107]
v_mfma_f32_16x16x32_bf16 a[108:111], v[60:63], v[92:95], a[108:111]
v_mfma_f32_16x16x32_bf16 a[112:115], v[64:67], v[92:95], a[112:115]
v_mfma_f32_16x16x32_bf16 a[116:119], v[68:71], v[92:95], a[116:119]
v_mfma_f32_16x16x32_bf16 a[120:123], v[72:75], v[92:95], a[120:123]
v_mfma_f32_16x16x32_bf16 a[124:127], v[76:79], v[92:95], a[124:127]
s_waitcnt lgkmcnt(0)
v_mfma_f32_16x16x32_bf16 a[0:3], v[0:3], v[32:35], a[0:3]
s_waitcnt vmcnt(0)
s_barrier
ds_read_b128 v[80:83], v136 offset:24576
v_mfma_f32_16x16x32_bf16 a[4:7], v[4:7], v[32:35], a[4:7]
ds_read_b64_tr_b16 v[48:49], v128 offset:49152
v_mfma_f32_16x16x32_bf16 a[8:11], v[8:11], v[32:35], a[8:11]
ds_read_b64_tr_b16 v[50:51], v128 offset:57344
v_mfma_f32_16x16x32_bf16 a[12:15], v[12:15], v[32:35], a[12:15]
ds_read_b64_tr_b16 v[52:53], v129 offset:49152
v_mfma_f32_16x16x32_bf16 a[16:19], v[16:19], v[32:35], a[16:19]
ds_read_b64_tr_b16 v[54:55], v129 offset:57344
v_mfma_f32_16x16x32_bf16 a[20:23], v[20:23], v[32:35], a[20:23]
ds_read_b64_tr_b16 v[56:57], v130 offset:49152
v_mfma_f32_16x16x32_bf16 a[24:27], v[24:27], v[32:35], a[24:27]
ds_read_b64_tr_b16 v[58:59], v130 offset:57344
v_mfma_f32_16x16x32_bf16 a[28:31], v[28:31], v[32:35], a[28:31]
ds_read_b64_tr_b16 v[60:61], v131 offset:49152
v_mfma_f32_16x16x32_bf16 a[32:35], v[0:3], v[36:39], a[32:35]
ds_read_b64_tr_b16 v[62:63], v131 offset:57344
v_mfma_f32_16x16x32_bf16 a[36:39], v[4:7], v[36:39], a[36:39]
ds_read_b64_tr_b16 v[64:65], v132 offset:49152
v_mfma_f32_16x16x32_bf16 a[40:43], v[8:11], v[36:39], a[40:43]
ds_read_b64_tr_b16 v[66:67], v132 offset:57344
v_mfma_f32_16x16x32_bf16 a[44:47], v[12:15], v[36:39], a[44:47]
ds_read_b64_tr_b16 v[68:69], v133 offset:49152
v_mfma_f32_16x16x32_bf16 a[48:51], v[16:19], v[36:39], a[48:51]
ds_read_b64_tr_b16 v[70:71], v133 offset:57344
v_mfma_f32_16x16x32_bf16 a[52:55], v[20:23], v[36:39], a[52:55]
ds_read_b64_tr_b16 v[72:73], v134 offset:49152
v_mfma_f32_16x16x32_bf16 a[56:59], v[24:27], v[36:39], a[56:59]
ds_read_b64_tr_b16 v[74:75], v134 offset:57344
v_mfma_f32_16x16x32_bf16 a[60:63], v[28:31], v[36:39], a[60:63]
ds_read_b64_tr_b16 v[76:77], v135 offset:49152
v_mfma_f32_16x16x32_bf16 a[64:67], v[0:3], v[40:43], a[64:67]
ds_read_b64_tr_b16 v[78:79], v135 offset:57344
v_mfma_f32_16x16x32_bf16 a[68:71], v[4:7], v[40:43], a[68:71]
ds_read_b128 v[84:87], v136 offset:25600
v_mfma_f32_16x16x32_bf16 a[72:75], v[8:11], v[40:43], a[72:75]
ds_read_b128 v[88:91], v136 offset:26624
v_mfma_f32_16x16x32_bf16 a[76:79], v[12:15], v[40:43], a[76:79]
ds_read_b128 v[92:95], v136 offset:27648
v_mfma_f32_16x16x32_bf16 a[80:83], v[16:19], v[40:43], a[80:83]
v_mfma_f32_16x16x32_bf16 a[84:87], v[20:23], v[40:43], a[84:87]
v_mfma_f32_16x16x32_bf16 a[88:91], v[24:27], v[40:43], a[88:91]
v_mfma_f32_16x16x32_bf16 a[92:95], v[28:31], v[40:43], a[92:95]
v_mfma_f32_16x16x32_bf16 a[96:99], v[0:3], v[44:47], a[96:99]
v_mfma_f32_16x16x32_bf16 a[100:103], v[4:7], v[44:47], a[100:103]
v_mfma_f32_16x16x32_bf16 a[104:107], v[8:11], v[44:47], a[104:107]
v_mfma_f32_16x16x32_bf16 a[108:111], v[12:15], v[44:47], a[108:111]
v_mfma_f32_16x16x32_bf16 a[112:115], v[16:19], v[44:47], a[112:115]
v_mfma_f32_16x16x32_bf16 a[116:119], v[20:23], v[44:47], a[116:119]
v_mfma_f32_16x16x32_bf16 a[120:123], v[24:27], v[44:47], a[120:123]
v_mfma_f32_16x16x32_bf16 a[124:127], v[28:31], v[44:47], a[124:127]
s_waitcnt lgkmcnt(0)
v_mfma_f32_16x16x32_bf16 a[0:3], v[48:51], v[80:83], a[0:3]
s_barrier
v_mfma_f32_16x16x32_bf16 a[4:7], v[52:55], v[80:83], a[4:7]
v_mfma_f32_16x16x32_bf16 a[8:11], v[56:59], v[80:83], a[8:11]
v_mfma_f32_16x16x32_bf16 a[12:15], v[60:63], v[80:83], a[12:15]
v_mfma_f32_16x16x32_bf16 a[16:19], v[64:67], v[80:83], a[16:19]
v_mfma_f32_16x16x32_bf16 a[20:23], v[68:71], v[80:83], a[20:23]
v_mfma_f32_16x16x32_bf16 a[24:27], v[72:75], v[80:83], a[24:27]
v_mfma_f32_16x16x32_bf16 a[28:31], v[76:79], v[80:83], a[28:31]
v_mfma_f32_16x16x32_bf16 a[32:35], v[48:51], v[84:87], a[32:35]
v_mfma_f32_16x16x32_bf16 a[36:39], v[52:55], v[84:87], a[36:39]
v_mfma_f32_16x16x32_bf16 a[40:43], v[56:59], v[84:87], a[40:43]
v_mfma_f32_16x16x32_bf16 a[44:47], v[60:63], v[84:87], a[44:47]
v_mfma_f32_16x16x32_bf16 a[48:51], v[64:67], v[84:87], a[48:51]
v_mfma_f32_16x16x32_bf16 a[52:55], v[68:71], v[84:87], a[52:55]
v_mfma_f32_16x16x32_bf16 a[56:59], v[72:75], v[84:87], a[56:59]
v_mfma_f32_16x16x32_bf16 a[60:63], v[76:79], v[84:87], a[60:63]
v_mfma_f32_16x16x32_bf16 a[64:67], v[48:51], v[88:91], a[64:67]
v_mfma_f32_16x16x32_bf16 a[68:71], v[52:55], v[88:91], a[68:71]
v_mfma_f32_16x16x32_bf16 a[72:75], v[56:59], v[88:91], a[72:75]
v_mfma_f32_16x16x32_bf16 a[76:79], v[60:63], v[88:91], a[76:79]
v_mfma_f32_16x16x32_bf16 a[80:83], v[64:67], v[88:91], a[80:83]
v_mfma_f32_16x16x32_bf16 a[84:87], v[68:71], v[88:91], a[84:87]
v_mfma_f32_16x16x32_bf16 a[88:91], v[72:75], v[88:91], a[88:91]
v_mfma_f32_16x16x32_bf16 a[92:95], v[76:79], v[88:91], a[92:95]
v_mfma_f32_16x16x32_bf16 a[96:99], v[48:51], v[92:95], a[96:99]
v_mfma_f32_16x16x32_bf16 a[100:103], v[52:55], v[92:95], a[100:103]
v_mfma_f32_16x16x32_bf16 a[104:107], v[56:59], v[92:95], a[104:107]
v_mfma_f32_16x16x32_bf16 a[108:111], v[60:63], v[92:95], a[108:111]
v_mfma_f32_16x16x32_bf16 a[112:115], v[64:67], v[92:95], a[112:115]
v_mfma_f32_16x16x32_bf16 a[116:119], v[68:71], v[92:95], a[116:119]
v_mfma_f32_16x16x32_bf16 a[120:123], v[72:75], v[92:95], a[120:123]
v_mfma_f32_16x16x32_bf16 a[124:127], v[76:79], v[92:95], a[124:127]
s_cmp_lg_u32 s62, -4
s_cbranch_scc1 main_kernel_w_gemm
s_branch main_kernel_w_slow
main_kernel_w_c1_n_ev:
s_mov_b32 s55, 1
s_cmp_eq_u32 s56, 0
s_cbranch_scc1 main_kernel_w_c1_n_et
s_bfm_b64 exec, s0, 0
buffer_store_dword v244, v248, s[4:7], s59 offen sc1
s_mov_b64 exec, -1
s_mov_b32 s56, 0
main_kernel_w_c1_n_et:
s_cmp_lg_u32 s18, 1
s_cbranch_scc1 main_kernel_w_c1_n_loop
s_lshl_b32 s32, s27, 8
s_add_u32 s32, s32, 0x841e000
s_mov_b64 exec, 1
v_mov_b32 v249, 1
buffer_atomic_add v249, off, s[4:7], s32 sc0 sc1
s_mov_b64 exec, -1
s_branch main_kernel_w_c1_n_loop
main_kernel_w_c1_gov:
s_mov_b32 s58, 3
s_mov_b32 s72, s18
s_cmp_lg_u32 s73, -1
s_cbranch_scc1 main_kernel_w_c1_str
s_waitcnt lgkmcnt(0)
v_lshrrev_b32 v0, 4, v250
v_bfe_u32 v1, v250, 2, 2
v_lshl_add_u32 v4, v0, 2, v1
v_and_b32 v5, 7, v4
v_mul_u32_u24 v4, 512, v4
v_and_b32 v6, 3, v250
v_lshl_add_u32 v4, v6, 3, v4
s_mul_i32 s32, s37, 8
v_xor_b32 v5, s32, v5
v_lshl_add_u32 v128, v5, 5, v4
v_xor_b32 v129, 32, v128
v_xor_b32 v130, 64, v128
v_xor_b32 v131, 96, v128
v_xor_b32 v132, 128, v128
v_xor_b32 v133, 160, v128
v_xor_b32 v134, 192, v128
v_xor_b32 v135, 224, v128
s_mul_i32 s32, s38, 4096
s_add_u32 s32, s32, 65536
v_add_u32 v136, s32, v251
v_lshrrev_b32 v2, 5, v250
v_and_b32 v3, 31, v250
s_mul_i32 s32, s14, 8
v_add_u32 v147, s32, v2
v_and_b32 v6, 7, v147
v_lshlrev_b32 v6, 1, v6
v_xor_b32 v6, v6, v3
v_lshlrev_b32 v151, 4, v6
v_add_u32 v148, 2, v147
v_and_b32 v6, 7, v148
v_lshlrev_b32 v6, 1, v6
v_xor_b32 v6, v6, v3
v_lshlrev_b32 v152, 4, v6
v_subrev_u32 v152, 1024, v152
v_add_u32 v149, 4, v147
v_and_b32 v6, 7, v149
v_lshlrev_b32 v6, 1, v6
v_xor_b32 v6, v6, v3
v_lshlrev_b32 v153, 4, v6
v_subrev_u32 v153, 2048, v153
v_add_u32 v150, 6, v147
v_and_b32 v6, 7, v150
v_lshlrev_b32 v6, 1, v6
v_xor_b32 v6, v6, v3
v_lshlrev_b32 v154, 4, v6
v_subrev_u32 v154, 3072, v154
s_mul_i32 s19, s14, 4096
s_mul_i32 s20, s14, 2048
s_add_u32 s20, s20, 65536
s_mul_i32 s32, s14, 2
s_mul_i32 s32, s32, s31
v_mad_u32_u24 v137, v147, s30, v151
v_mad_u32_u24 v138, v148, s30, v152
v_mad_u32_u24 v139, v149, s30, v153
v_mad_u32_u24 v140, v150, s30, v154
v_add_u32 v141, s32, v251
s_add_u32 s32, s32, s31
s_sub_u32 s32, s32, 1024
v_add_u32 v142, s32, v251
s_mul_i32 s17, s30, 32
s_mov_b32 s15, 0
s_waitcnt vmcnt(0)
s_add_u32 m0, s20, 0
s_nop 0
buffer_load_dwordx4 v141, s[4:7], s16 offen offset:0 sc1 lds
buffer_load_dwordx4 v142, s[4:7], s16 offen offset:1024 sc1 lds
s_add_u32 s16, s16, 1024
s_add_u32 m0, s19, 0
s_nop 0
buffer_load_dwordx4 v137, s[8:11], s15 offen offset:0 lds
buffer_load_dwordx4 v138, s[8:11], s15 offen offset:1024 lds
buffer_load_dwordx4 v139, s[8:11], s15 offen offset:2048 lds
buffer_load_dwordx4 v140, s[8:11], s15 offen offset:3072 lds
s_add_u32 s15, s15, s17
s_add_u32 m0, s20, 8192
s_nop 0
buffer_load_dwordx4 v141, s[4:7], s16 offen offset:0 sc1 lds
buffer_load_dwordx4 v142, s[4:7], s16 offen offset:1024 sc1 lds
s_add_u32 s16, s16, 1024
s_add_u32 m0, s19, 16384
s_nop 0
buffer_load_dwordx4 v137, s[8:11], s15 offen offset:0 lds
buffer_load_dwordx4 v138, s[8:11], s15 offen offset:1024 lds
buffer_load_dwordx4 v139, s[8:11], s15 offen offset:2048 lds
buffer_load_dwordx4 v140, s[8:11], s15 offen offset:3072 lds
s_add_u32 s15, s15, s17
s_add_u32 m0, s20, 16384
s_nop 0
buffer_load_dwordx4 v141, s[4:7], s16 offen offset:0 sc1 lds
buffer_load_dwordx4 v142, s[4:7], s16 offen offset:1024 sc1 lds
s_add_u32 s16, s16, 1024
s_add_u32 m0, s19, 32768
s_nop 0
buffer_load_dwordx4 v137, s[8:11], s15 offen offset:0 lds
buffer_load_dwordx4 v138, s[8:11], s15 offen offset:1024 lds
buffer_load_dwordx4 v139, s[8:11], s15 offen offset:2048 lds
buffer_load_dwordx4 v140, s[8:11], s15 offen offset:3072 lds
s_add_u32 s15, s15, s17
s_add_u32 m0, s20, 24576
s_nop 0
buffer_load_dwordx4 v141, s[4:7], s16 offen offset:0 sc1 lds
buffer_load_dwordx4 v142, s[4:7], s16 offen offset:1024 sc1 lds
s_add_u32 s16, s16, 1024
s_add_u32 m0, s19, 49152
s_nop 0
buffer_load_dwordx4 v137, s[8:11], s15 offen offset:0 lds
buffer_load_dwordx4 v138, s[8:11], s15 offen offset:1024 lds
buffer_load_dwordx4 v139, s[8:11], s15 offen offset:2048 lds
buffer_load_dwordx4 v140, s[8:11], s15 offen offset:3072 lds
s_add_u32 s15, s15, s17
s_cmp_lg_u32 s56, 0
s_cbranch_scc1 main_kernel_w_epi
main_kernel_w_c1_v_ent:
v_mfma_f32_32x32x16_bf16 a[0:15], v[224:227], v[224:227], 0
s_waitcnt vmcnt(18)
s_barrier
ds_read_b128 v[32:35], v136 offset:0
ds_read_b64_tr_b16 v[0:1], v128 offset:0
ds_read_b64_tr_b16 v[2:3], v128 offset:8192
v_mfma_f32_32x32x16_bf16 a[16:31], v[224:227], v[224:227], 0
ds_read_b64_tr_b16 v[4:5], v129 offset:0
ds_read_b64_tr_b16 v[6:7], v129 offset:8192
ds_read_b64_tr_b16 v[8:9], v130 offset:0
v_mfma_f32_32x32x16_bf16 a[32:47], v[224:227], v[224:227], 0
ds_read_b64_tr_b16 v[10:11], v130 offset:8192
ds_read_b64_tr_b16 v[12:13], v131 offset:0
ds_read_b64_tr_b16 v[14:15], v131 offset:8192
v_mfma_f32_32x32x16_bf16 a[48:63], v[224:227], v[224:227], 0
ds_read_b64_tr_b16 v[16:17], v132 offset:0
ds_read_b64_tr_b16 v[18:19], v132 offset:8192
ds_read_b64_tr_b16 v[20:21], v133 offset:0
v_mfma_f32_32x32x16_bf16 a[64:79], v[224:227], v[224:227], 0
ds_read_b64_tr_b16 v[22:23], v133 offset:8192
ds_read_b64_tr_b16 v[24:25], v134 offset:0
ds_read_b64_tr_b16 v[26:27], v134 offset:8192
v_mfma_f32_32x32x16_bf16 a[80:95], v[224:227], v[224:227], 0
ds_read_b64_tr_b16 v[28:29], v135 offset:0
ds_read_b64_tr_b16 v[30:31], v135 offset:8192
ds_read_b128 v[36:39], v136 offset:1024
v_mfma_f32_32x32x16_bf16 a[96:111], v[224:227], v[224:227], 0
ds_read_b128 v[40:43], v136 offset:2048
ds_read_b128 v[44:47], v136 offset:3072
v_mfma_f32_32x32x16_bf16 a[112:127], v[224:227], v[224:227], 0
s_sub_u32 s18, s72, 1
s_sub_u32 s55, s72, 2
s_orn2_b32 s55, s55, s100
s_mov_b32 s73, -1
s_nop 0
main_kernel_w_c1_v_loop:
main_kernel_w_c1_v_mid:
s_waitcnt lgkmcnt(0)
v_mfma_f32_16x16x32_bf16 a[0:3], v[32:35], v[0:3], a[0:3]
s_waitcnt vmcnt(12)
s_barrier
ds_read_b128 v[80:83], v136 offset:8192
s_add_u32 m0, s20, 0
s_nop 0
v_mfma_f32_16x16x32_bf16 a[4:7], v[32:35], v[4:7], a[4:7]
ds_read_b64_tr_b16 v[48:49], v128 offset:16384
v_mfma_f32_16x16x32_bf16 a[8:11], v[32:35], v[8:11], a[8:11]
ds_read_b64_tr_b16 v[50:51], v128 offset:24576
v_mfma_f32_16x16x32_bf16 a[12:15], v[32:35], v[12:15], a[12:15]
ds_read_b64_tr_b16 v[52:53], v129 offset:16384
buffer_load_dwordx4 v141, s[4:7], s16 offen offset:0 sc1 lds
v_mfma_f32_16x16x32_bf16 a[16:19], v[32:35], v[16:19], a[16:19]
ds_read_b64_tr_b16 v[54:55], v129 offset:24576
v_mfma_f32_16x16x32_bf16 a[20:23], v[32:35], v[20:23], a[20:23]
ds_read_b64_tr_b16 v[56:57], v130 offset:16384
v_mfma_f32_16x16x32_bf16 a[24:27], v[32:35], v[24:27], a[24:27]
ds_read_b64_tr_b16 v[58:59], v130 offset:24576
buffer_load_dwordx4 v142, s[4:7], s16 offen offset:1024 sc1 lds
v_mfma_f32_16x16x32_bf16 a[28:31], v[32:35], v[28:31], a[28:31]
ds_read_b64_tr_b16 v[60:61], v131 offset:16384
v_mfma_f32_16x16x32_bf16 a[32:35], v[36:39], v[0:3], a[32:35]
ds_read_b64_tr_b16 v[62:63], v131 offset:24576
v_mfma_f32_16x16x32_bf16 a[36:39], v[36:39], v[4:7], a[36:39]
ds_read_b64_tr_b16 v[64:65], v132 offset:16384
s_add_u32 s16, s16, 1024
v_mfma_f32_16x16x32_bf16 a[40:43], v[36:39], v[8:11], a[40:43]
ds_read_b64_tr_b16 v[66:67], v132 offset:24576
v_mfma_f32_16x16x32_bf16 a[44:47], v[36:39], v[12:15], a[44:47]
ds_read_b64_tr_b16 v[68:69], v133 offset:16384
v_mfma_f32_16x16x32_bf16 a[48:51], v[36:39], v[16:19], a[48:51]
ds_read_b64_tr_b16 v[70:71], v133 offset:24576
s_add_u32 m0, s19, 0
s_nop 0
v_mfma_f32_16x16x32_bf16 a[52:55], v[36:39], v[20:23], a[52:55]
ds_read_b64_tr_b16 v[72:73], v134 offset:16384
v_mfma_f32_16x16x32_bf16 a[56:59], v[36:39], v[24:27], a[56:59]
ds_read_b64_tr_b16 v[74:75], v134 offset:24576
v_mfma_f32_16x16x32_bf16 a[60:63], v[36:39], v[28:31], a[60:63]
ds_read_b64_tr_b16 v[76:77], v135 offset:16384
buffer_load_dwordx4 v137, s[8:11], s15 offen offset:0 lds
v_mfma_f32_16x16x32_bf16 a[64:67], v[40:43], v[0:3], a[64:67]
ds_read_b64_tr_b16 v[78:79], v135 offset:24576
v_mfma_f32_16x16x32_bf16 a[68:71], v[40:43], v[4:7], a[68:71]
ds_read_b128 v[84:87], v136 offset:9216
v_mfma_f32_16x16x32_bf16 a[72:75], v[40:43], v[8:11], a[72:75]
ds_read_b128 v[88:91], v136 offset:10240
buffer_load_dwordx4 v138, s[8:11], s15 offen offset:1024 lds
v_mfma_f32_16x16x32_bf16 a[76:79], v[40:43], v[12:15], a[76:79]
ds_read_b128 v[92:95], v136 offset:11264
v_mfma_f32_16x16x32_bf16 a[80:83], v[40:43], v[16:19], a[80:83]
v_mfma_f32_16x16x32_bf16 a[84:87], v[40:43], v[20:23], a[84:87]
buffer_load_dwordx4 v139, s[8:11], s15 offen offset:2048 lds
v_mfma_f32_16x16x32_bf16 a[88:91], v[40:43], v[24:27], a[88:91]
v_mfma_f32_16x16x32_bf16 a[92:95], v[40:43], v[28:31], a[92:95]
v_mfma_f32_16x16x32_bf16 a[96:99], v[44:47], v[0:3], a[96:99]
buffer_load_dwordx4 v140, s[8:11], s15 offen offset:3072 lds
v_mfma_f32_16x16x32_bf16 a[100:103], v[44:47], v[4:7], a[100:103]
v_mfma_f32_16x16x32_bf16 a[104:107], v[44:47], v[8:11], a[104:107]
v_mfma_f32_16x16x32_bf16 a[108:111], v[44:47], v[12:15], a[108:111]
s_add_u32 s15, s15, s17
v_mfma_f32_16x16x32_bf16 a[112:115], v[44:47], v[16:19], a[112:115]
v_mfma_f32_16x16x32_bf16 a[116:119], v[44:47], v[20:23], a[116:119]
v_mfma_f32_16x16x32_bf16 a[120:123], v[44:47], v[24:27], a[120:123]
v_mfma_f32_16x16x32_bf16 a[124:127], v[44:47], v[28:31], a[124:127]
s_waitcnt lgkmcnt(0)
v_mfma_f32_16x16x32_bf16 a[0:3], v[80:83], v[48:51], a[0:3]
s_waitcnt vmcnt(12)
s_barrier
ds_read_b128 v[32:35], v136 offset:16384
s_add_u32 m0, s20, 8192
s_nop 0
v_mfma_f32_16x16x32_bf16 a[4:7], v[80:83], v[52:55], a[4:7]
ds_read_b64_tr_b16 v[0:1], v128 offset:32768
v_mfma_f32_16x16x32_bf16 a[8:11], v[80:83], v[56:59], a[8:11]
ds_read_b64_tr_b16 v[2:3], v128 offset:40960
v_mfma_f32_16x16x32_bf16 a[12:15], v[80:83], v[60:63], a[12:15]
ds_read_b64_tr_b16 v[4:5], v129 offset:32768
buffer_load_dwordx4 v141, s[4:7], s16 offen offset:0 sc1 lds
v_mfma_f32_16x16x32_bf16 a[16:19], v[80:83], v[64:67], a[16:19]
ds_read_b64_tr_b16 v[6:7], v129 offset:40960
v_mfma_f32_16x16x32_bf16 a[20:23], v[80:83], v[68:71], a[20:23]
ds_read_b64_tr_b16 v[8:9], v130 offset:32768
v_mfma_f32_16x16x32_bf16 a[24:27], v[80:83], v[72:75], a[24:27]
ds_read_b64_tr_b16 v[10:11], v130 offset:40960
buffer_load_dwordx4 v142, s[4:7], s16 offen offset:1024 sc1 lds
v_mfma_f32_16x16x32_bf16 a[28:31], v[80:83], v[76:79], a[28:31]
ds_read_b64_tr_b16 v[12:13], v131 offset:32768
v_mfma_f32_16x16x32_bf16 a[32:35], v[84:87], v[48:51], a[32:35]
ds_read_b64_tr_b16 v[14:15], v131 offset:40960
v_mfma_f32_16x16x32_bf16 a[36:39], v[84:87], v[52:55], a[36:39]
ds_read_b64_tr_b16 v[16:17], v132 offset:32768
s_add_u32 s16, s16, 1024
v_mfma_f32_16x16x32_bf16 a[40:43], v[84:87], v[56:59], a[40:43]
ds_read_b64_tr_b16 v[18:19], v132 offset:40960
v_mfma_f32_16x16x32_bf16 a[44:47], v[84:87], v[60:63], a[44:47]
ds_read_b64_tr_b16 v[20:21], v133 offset:32768
v_mfma_f32_16x16x32_bf16 a[48:51], v[84:87], v[64:67], a[48:51]
ds_read_b64_tr_b16 v[22:23], v133 offset:40960
s_add_u32 m0, s19, 16384
s_nop 0
v_mfma_f32_16x16x32_bf16 a[52:55], v[84:87], v[68:71], a[52:55]
ds_read_b64_tr_b16 v[24:25], v134 offset:32768
v_mfma_f32_16x16x32_bf16 a[56:59], v[84:87], v[72:75], a[56:59]
ds_read_b64_tr_b16 v[26:27], v134 offset:40960
v_mfma_f32_16x16x32_bf16 a[60:63], v[84:87], v[76:79], a[60:63]
ds_read_b64_tr_b16 v[28:29], v135 offset:32768
buffer_load_dwordx4 v137, s[8:11], s15 offen offset:0 lds
v_mfma_f32_16x16x32_bf16 a[64:67], v[88:91], v[48:51], a[64:67]
ds_read_b64_tr_b16 v[30:31], v135 offset:40960
v_mfma_f32_16x16x32_bf16 a[68:71], v[88:91], v[52:55], a[68:71]
ds_read_b128 v[36:39], v136 offset:17408
v_mfma_f32_16x16x32_bf16 a[72:75], v[88:91], v[56:59], a[72:75]
ds_read_b128 v[40:43], v136 offset:18432
buffer_load_dwordx4 v138, s[8:11], s15 offen offset:1024 lds
v_mfma_f32_16x16x32_bf16 a[76:79], v[88:91], v[60:63], a[76:79]
ds_read_b128 v[44:47], v136 offset:19456
v_mfma_f32_16x16x32_bf16 a[80:83], v[88:91], v[64:67], a[80:83]
v_mfma_f32_16x16x32_bf16 a[84:87], v[88:91], v[68:71], a[84:87]
buffer_load_dwordx4 v139, s[8:11], s15 offen offset:2048 lds
v_mfma_f32_16x16x32_bf16 a[88:91], v[88:91], v[72:75], a[88:91]
v_mfma_f32_16x16x32_bf16 a[92:95], v[88:91], v[76:79], a[92:95]
v_mfma_f32_16x16x32_bf16 a[96:99], v[92:95], v[48:51], a[96:99]
buffer_load_dwordx4 v140, s[8:11], s15 offen offset:3072 lds
v_mfma_f32_16x16x32_bf16 a[100:103], v[92:95], v[52:55], a[100:103]
v_mfma_f32_16x16x32_bf16 a[104:107], v[92:95], v[56:59], a[104:107]
v_mfma_f32_16x16x32_bf16 a[108:111], v[92:95], v[60:63], a[108:111]
s_add_u32 s15, s15, s17
v_mfma_f32_16x16x32_bf16 a[112:115], v[92:95], v[64:67], a[112:115]
v_mfma_f32_16x16x32_bf16 a[116:119], v[92:95], v[68:71], a[116:119]
v_mfma_f32_16x16x32_bf16 a[120:123], v[92:95], v[72:75], a[120:123]
v_mfma_f32_16x16x32_bf16 a[124:127], v[92:95], v[76:79], a[124:127]
s_waitcnt lgkmcnt(0)
v_mfma_f32_16x16x32_bf16 a[0:3], v[32:35], v[0:3], a[0:3]
s_waitcnt vmcnt(12)
s_barrier
ds_read_b128 v[80:83], v136 offset:24576
s_add_u32 m0, s20, 16384
s_nop 0
v_mfma_f32_16x16x32_bf16 a[4:7], v[32:35], v[4:7], a[4:7]
ds_read_b64_tr_b16 v[48:49], v128 offset:49152
v_mfma_f32_16x16x32_bf16 a[8:11], v[32:35], v[8:11], a[8:11]
ds_read_b64_tr_b16 v[50:51], v128 offset:57344
v_mfma_f32_16x16x32_bf16 a[12:15], v[32:35], v[12:15], a[12:15]
ds_read_b64_tr_b16 v[52:53], v129 offset:49152
buffer_load_dwordx4 v141, s[4:7], s16 offen offset:0 sc1 lds
v_mfma_f32_16x16x32_bf16 a[16:19], v[32:35], v[16:19], a[16:19]
ds_read_b64_tr_b16 v[54:55], v129 offset:57344
v_mfma_f32_16x16x32_bf16 a[20:23], v[32:35], v[20:23], a[20:23]
ds_read_b64_tr_b16 v[56:57], v130 offset:49152
v_mfma_f32_16x16x32_bf16 a[24:27], v[32:35], v[24:27], a[24:27]
ds_read_b64_tr_b16 v[58:59], v130 offset:57344
buffer_load_dwordx4 v142, s[4:7], s16 offen offset:1024 sc1 lds
v_mfma_f32_16x16x32_bf16 a[28:31], v[32:35], v[28:31], a[28:31]
ds_read_b64_tr_b16 v[60:61], v131 offset:49152
v_mfma_f32_16x16x32_bf16 a[32:35], v[36:39], v[0:3], a[32:35]
ds_read_b64_tr_b16 v[62:63], v131 offset:57344
v_mfma_f32_16x16x32_bf16 a[36:39], v[36:39], v[4:7], a[36:39]
ds_read_b64_tr_b16 v[64:65], v132 offset:49152
s_add_u32 s16, s16, 1024
v_mfma_f32_16x16x32_bf16 a[40:43], v[36:39], v[8:11], a[40:43]
ds_read_b64_tr_b16 v[66:67], v132 offset:57344
v_mfma_f32_16x16x32_bf16 a[44:47], v[36:39], v[12:15], a[44:47]
ds_read_b64_tr_b16 v[68:69], v133 offset:49152
v_mfma_f32_16x16x32_bf16 a[48:51], v[36:39], v[16:19], a[48:51]
ds_read_b64_tr_b16 v[70:71], v133 offset:57344
s_add_u32 m0, s19, 32768
s_nop 0
v_mfma_f32_16x16x32_bf16 a[52:55], v[36:39], v[20:23], a[52:55]
ds_read_b64_tr_b16 v[72:73], v134 offset:49152
v_mfma_f32_16x16x32_bf16 a[56:59], v[36:39], v[24:27], a[56:59]
ds_read_b64_tr_b16 v[74:75], v134 offset:57344
v_mfma_f32_16x16x32_bf16 a[60:63], v[36:39], v[28:31], a[60:63]
ds_read_b64_tr_b16 v[76:77], v135 offset:49152
buffer_load_dwordx4 v137, s[8:11], s15 offen offset:0 lds
v_mfma_f32_16x16x32_bf16 a[64:67], v[40:43], v[0:3], a[64:67]
ds_read_b64_tr_b16 v[78:79], v135 offset:57344
v_mfma_f32_16x16x32_bf16 a[68:71], v[40:43], v[4:7], a[68:71]
ds_read_b128 v[84:87], v136 offset:25600
v_mfma_f32_16x16x32_bf16 a[72:75], v[40:43], v[8:11], a[72:75]
ds_read_b128 v[88:91], v136 offset:26624
buffer_load_dwordx4 v138, s[8:11], s15 offen offset:1024 lds
v_mfma_f32_16x16x32_bf16 a[76:79], v[40:43], v[12:15], a[76:79]
ds_read_b128 v[92:95], v136 offset:27648
v_mfma_f32_16x16x32_bf16 a[80:83], v[40:43], v[16:19], a[80:83]
v_mfma_f32_16x16x32_bf16 a[84:87], v[40:43], v[20:23], a[84:87]
buffer_load_dwordx4 v139, s[8:11], s15 offen offset:2048 lds
v_mfma_f32_16x16x32_bf16 a[88:91], v[40:43], v[24:27], a[88:91]
v_mfma_f32_16x16x32_bf16 a[92:95], v[40:43], v[28:31], a[92:95]
v_mfma_f32_16x16x32_bf16 a[96:99], v[44:47], v[0:3], a[96:99]
buffer_load_dwordx4 v140, s[8:11], s15 offen offset:3072 lds
v_mfma_f32_16x16x32_bf16 a[100:103], v[44:47], v[4:7], a[100:103]
v_mfma_f32_16x16x32_bf16 a[104:107], v[44:47], v[8:11], a[104:107]
v_mfma_f32_16x16x32_bf16 a[108:111], v[44:47], v[12:15], a[108:111]
s_add_u32 s15, s15, s17
v_mfma_f32_16x16x32_bf16 a[112:115], v[44:47], v[16:19], a[112:115]
v_mfma_f32_16x16x32_bf16 a[116:119], v[44:47], v[20:23], a[116:119]
v_mfma_f32_16x16x32_bf16 a[120:123], v[44:47], v[24:27], a[120:123]
v_mfma_f32_16x16x32_bf16 a[124:127], v[44:47], v[28:31], a[124:127]
s_waitcnt lgkmcnt(0)
v_mfma_f32_16x16x32_bf16 a[0:3], v[80:83], v[48:51], a[0:3]
s_waitcnt vmcnt(12)
s_barrier
ds_read_b128 v[32:35], v136 offset:0
s_add_u32 m0, s20, 24576
s_nop 0
v_mfma_f32_16x16x32_bf16 a[4:7], v[80:83], v[52:55], a[4:7]
ds_read_b64_tr_b16 v[0:1], v128 offset:0
v_mfma_f32_16x16x32_bf16 a[8:11], v[80:83], v[56:59], a[8:11]
ds_read_b64_tr_b16 v[2:3], v128 offset:8192
v_mfma_f32_16x16x32_bf16 a[12:15], v[80:83], v[60:63], a[12:15]
ds_read_b64_tr_b16 v[4:5], v129 offset:0
buffer_load_dwordx4 v141, s[4:7], s16 offen offset:0 sc1 lds
v_mfma_f32_16x16x32_bf16 a[16:19], v[80:83], v[64:67], a[16:19]
ds_read_b64_tr_b16 v[6:7], v129 offset:8192
v_mfma_f32_16x16x32_bf16 a[20:23], v[80:83], v[68:71], a[20:23]
ds_read_b64_tr_b16 v[8:9], v130 offset:0
v_mfma_f32_16x16x32_bf16 a[24:27], v[80:83], v[72:75], a[24:27]
ds_read_b64_tr_b16 v[10:11], v130 offset:8192
buffer_load_dwordx4 v142, s[4:7], s16 offen offset:1024 sc1 lds
v_mfma_f32_16x16x32_bf16 a[28:31], v[80:83], v[76:79], a[28:31]
ds_read_b64_tr_b16 v[12:13], v131 offset:0
v_mfma_f32_16x16x32_bf16 a[32:35], v[84:87], v[48:51], a[32:35]
ds_read_b64_tr_b16 v[14:15], v131 offset:8192
v_mfma_f32_16x16x32_bf16 a[36:39], v[84:87], v[52:55], a[36:39]
ds_read_b64_tr_b16 v[16:17], v132 offset:0
s_add_u32 s16, s16, 1024
v_mfma_f32_16x16x32_bf16 a[40:43], v[84:87], v[56:59], a[40:43]
ds_read_b64_tr_b16 v[18:19], v132 offset:8192
v_mfma_f32_16x16x32_bf16 a[44:47], v[84:87], v[60:63], a[44:47]
ds_read_b64_tr_b16 v[20:21], v133 offset:0
v_mfma_f32_16x16x32_bf16 a[48:51], v[84:87], v[64:67], a[48:51]
ds_read_b64_tr_b16 v[22:23], v133 offset:8192
s_add_u32 m0, s19, 49152
s_nop 0
v_mfma_f32_16x16x32_bf16 a[52:55], v[84:87], v[68:71], a[52:55]
ds_read_b64_tr_b16 v[24:25], v134 offset:0
v_mfma_f32_16x16x32_bf16 a[56:59], v[84:87], v[72:75], a[56:59]
ds_read_b64_tr_b16 v[26:27], v134 offset:8192
v_mfma_f32_16x16x32_bf16 a[60:63], v[84:87], v[76:79], a[60:63]
ds_read_b64_tr_b16 v[28:29], v135 offset:0
buffer_load_dwordx4 v137, s[8:11], s15 offen offset:0 lds
v_mfma_f32_16x16x32_bf16 a[64:67], v[88:91], v[48:51], a[64:67]
ds_read_b64_tr_b16 v[30:31], v135 offset:8192
v_mfma_f32_16x16x32_bf16 a[68:71], v[88:91], v[52:55], a[68:71]
ds_read_b128 v[36:39], v136 offset:1024
v_mfma_f32_16x16x32_bf16 a[72:75], v[88:91], v[56:59], a[72:75]
ds_read_b128 v[40:43], v136 offset:2048
buffer_load_dwordx4 v138, s[8:11], s15 offen offset:1024 lds
v_mfma_f32_16x16x32_bf16 a[76:79], v[88:91], v[60:63], a[76:79]
ds_read_b128 v[44:47], v136 offset:3072
v_mfma_f32_16x16x32_bf16 a[80:83], v[88:91], v[64:67], a[80:83]
v_mfma_f32_16x16x32_bf16 a[84:87], v[88:91], v[68:71], a[84:87]
buffer_load_dwordx4 v139, s[8:11], s15 offen offset:2048 lds
v_mfma_f32_16x16x32_bf16 a[88:91], v[88:91], v[72:75], a[88:91]
v_mfma_f32_16x16x32_bf16 a[92:95], v[88:91], v[76:79], a[92:95]
v_mfma_f32_16x16x32_bf16 a[96:99], v[92:95], v[48:51], a[96:99]
buffer_load_dwordx4 v140, s[8:11], s15 offen offset:3072 lds
v_mfma_f32_16x16x32_bf16 a[100:103], v[92:95], v[52:55], a[100:103]
v_mfma_f32_16x16x32_bf16 a[104:107], v[92:95], v[56:59], a[104:107]
v_mfma_f32_16x16x32_bf16 a[108:111], v[92:95], v[60:63], a[108:111]
s_add_u32 s15, s15, s17
v_mfma_f32_16x16x32_bf16 a[112:115], v[92:95], v[64:67], a[112:115]
v_mfma_f32_16x16x32_bf16 a[116:119], v[92:95], v[68:71], a[116:119]
v_mfma_f32_16x16x32_bf16 a[120:123], v[92:95], v[72:75], a[120:123]
v_mfma_f32_16x16x32_bf16 a[124:127], v[92:95], v[76:79], a[124:127]
s_sub_u32 s18, s18, 1
s_cmp_eq_u32 s18, s55
s_cbranch_scc1 main_kernel_w_c1_v_ev
s_cmp_lg_u32 s18, 0
s_cbranch_scc1 main_kernel_w_c1_v_loop
s_cmp_lg_u32 s73, -1
s_cbranch_scc1 main_kernel_w_epn
s_waitcnt lgkmcnt(0)
v_mfma_f32_16x16x32_bf16 a[0:3], v[32:35], v[0:3], a[0:3]
s_waitcnt vmcnt(12)
s_barrier
ds_read_b128 v[80:83], v136 offset:8192
s_add_u32 m0, s20, 0
s_nop 0
s_add_u32 s32, s23, 1
s_bitcmp0_b32 s32, 2
s_cselect_b32 s34, 7, 2
s_cselect_b32 s35, 2, 4
s_lshl_b32 s59, s23, 13
s_add_u32 s59, s59, 0x8404000
v_mfma_f32_16x16x32_bf16 a[4:7], v[32:35], v[4:7], a[4:7]
ds_read_b64_tr_b16 v[48:49], v128 offset:16384
v_lshrrev_b32 v253, 3, v250
v_add_lshl_u32 v253, s24, v253, 9
v_mfma_f32_16x16x32_bf16 a[8:11], v[32:35], v[8:11], a[8:11]
ds_read_b64_tr_b16 v[50:51], v128 offset:24576
v_and_b32 v254, 3, v250
v_lshl_add_u32 v253, v254, s34, v253
v_mfma_f32_16x16x32_bf16 a[12:15], v[32:35], v[12:15], a[12:15]
ds_read_b64_tr_b16 v[52:53], v129 offset:16384
buffer_load_dwordx4 v141, s[4:7], s16 offen offset:0 sc1 lds
v_bfe_u32 v254, v250, 2, 1
v_add_u32 v254, s25, v254
v_mfma_f32_16x16x32_bf16 a[16:19], v[32:35], v[16:19], a[16:19]
ds_read_b64_tr_b16 v[54:55], v129 offset:24576
v_lshl_add_u32 v248, v254, s35, v253
s_lshl_b32 s0, 4, s54
v_mfma_f32_16x16x32_bf16 a[20:23], v[32:35], v[20:23], a[20:23]
ds_read_b64_tr_b16 v[56:57], v130 offset:16384
v_readfirstlane_b32 s28, v249
s_nop 1
v_cmp_ge_u32 vcc, s28, v229
v_mfma_f32_16x16x32_bf16 a[24:27], v[32:35], v[24:27], a[24:27]
ds_read_b64_tr_b16 v[58:59], v130 offset:24576
buffer_load_dwordx4 v142, s[4:7], s16 offen offset:1024 sc1 lds
s_nop 1
s_bcnt1_i32_b64 s32, vcc
v_mfma_f32_16x16x32_bf16 a[28:31], v[32:35], v[28:31], a[28:31]
ds_read_b64_tr_b16 v[60:61], v131 offset:16384
s_sub_u32 s32, s32, 1
v_readlane_b32 s36, v230, s32
v_mfma_f32_16x16x32_bf16 a[32:35], v[36:39], v[0:3], a[32:35]
ds_read_b64_tr_b16 v[62:63], v131 offset:24576
s_nop 1
s_and_b32 s32, s36, 0x7ff
v_mfma_f32_16x16x32_bf16 a[36:39], v[36:39], v[4:7], a[36:39]
ds_read_b64_tr_b16 v[64:65], v132 offset:16384
s_add_u32 s16, s16, 1024
s_sub_u32 s28, s28, s32
s_bfe_u32 s32, s36, 0x3001a
v_mfma_f32_16x16x32_bf16 a[40:43], v[36:39], v[8:11], a[40:43]
ds_read_b64_tr_b16 v[66:67], v132 offset:24576
s_lshr_b32 s25, s28, s32
s_lshl_b32 s33, s25, s32
s_sub_u32 s24, s28, s33
v_mfma_f32_16x16x32_bf16 a[44:47], v[36:39], v[12:15], a[44:47]
ds_read_b64_tr_b16 v[68:69], v133 offset:16384
s_bfe_u32 s34, s36, 0x1001d
s_lshl_b32 s24, s24, s34
v_mfma_f32_16x16x32_bf16 a[48:51], v[36:39], v[16:19], a[48:51]
ds_read_b64_tr_b16 v[70:71], v133 offset:24576
s_add_u32 m0, s19, 0
s_nop 0
s_bfe_u32 s35, s36, 0x1001e
s_lshl_b32 s25, s25, s35
v_mfma_f32_16x16x32_bf16 a[52:55], v[36:39], v[20:23], a[52:55]
ds_read_b64_tr_b16 v[72:73], v134 offset:16384
s_bfe_u32 s32, s36, 0x40011
s_add_u32 s24, s24, s32
v_mfma_f32_16x16x32_bf16 a[56:59], v[36:39], v[24:27], a[56:59]
ds_read_b64_tr_b16 v[74:75], v134 offset:24576
s_bfe_u32 s32, s36, 0x50015
s_add_u32 s25, s25, s32
v_mfma_f32_16x16x32_bf16 a[60:63], v[36:39], v[28:31], a[60:63]
ds_read_b64_tr_b16 v[76:77], v135 offset:16384
buffer_load_dwordx4 v137, s[8:11], s15 offen offset:0 lds
s_bfe_u32 s23, s36, 0x4000b
s_bfe_u32 s36, s36, 0x6000b
s_lshl_b32 s32, s24, 8
v_mfma_f32_16x16x32_bf16 a[64:67], v[40:43], v[0:3], a[64:67]
ds_read_b64_tr_b16 v[78:79], v135 offset:24576
s_or_b32 s36, s36, s32
s_lshl_b32 s32, s25, 16
v_mfma_f32_16x16x32_bf16 a[68:71], v[40:43], v[4:7], a[68:71]
ds_read_b128 v[84:87], v136 offset:9216
s_or_b32 s36, s36, s32
s_cmp_eq_u32 s23, 4
s_cselect_b32 s32, 1, 0
v_mfma_f32_16x16x32_bf16 a[72:75], v[40:43], v[8:11], a[72:75]
ds_read_b128 v[88:91], v136 offset:10240
buffer_load_dwordx4 v138, s[8:11], s15 offen offset:1024 lds
s_sub_u32 s48, s24, s32
s_max_i32 s48, s48, 0
v_mfma_f32_16x16x32_bf16 a[76:79], v[40:43], v[12:15], a[76:79]
ds_read_b128 v[92:95], v136 offset:11264
s_add_u32 s49, s24, s34
s_add_u32 s49, s49, s32
v_mfma_f32_16x16x32_bf16 a[80:83], v[40:43], v[16:19], a[80:83]
s_min_u32 s49, s49, 15
s_cmp_eq_u32 s23, 6
s_cselect_b32 s51, 3, 7
s_cmp_eq_u32 s23, 7
s_cselect_b32 s51, 27, s51
s_cselect_b32 s50, 5, 4
v_mfma_f32_16x16x32_bf16 a[84:87], v[40:43], v[20:23], a[84:87]
buffer_load_dwordx4 v139, s[8:11], s15 offen offset:2048 lds
s_add_u32 s33, s25, s35
s_lshl_b32 s34, s24, 9
v_mfma_f32_16x16x32_bf16 a[88:91], v[40:43], v[24:27], a[88:91]
s_cmp_eq_u32 s23, 8
s_cselect_b32 s51, 0, s51
s_cselect_b32 s48, s25, s48
s_cselect_b32 s49, s33, s49
s_cmp_eq_u32 s23, 8
s_cselect_b32 s63, 2, 9
s_cselect_b32 s61, 0, 0x7f000000
s_cselect_b32 s34, s34, 0
v_mfma_f32_16x16x32_bf16 a[92:95], v[40:43], v[28:31], a[92:95]
v_lshrrev_b32 v228, s50, v250
v_lshlrev_b32 v254, s50, v228
v_mfma_f32_16x16x32_bf16 a[96:99], v[44:47], v[0:3], a[96:99]
buffer_load_dwordx4 v140, s[8:11], s15 offen offset:3072 lds
v_sub_u32 v254, v250, v254
s_cmp_lt_u32 s23, 4
s_cselect_b32 s39, 10, s23
v_mfma_f32_16x16x32_bf16 a[100:103], v[44:47], v[4:7], a[100:103]
v_min_u32 v254, s51, v254
s_lshl_b32 s39, s39, 13
s_cmp_eq_u32 s23, 3
s_cselect_b32 s34, 4, s34
v_mfma_f32_16x16x32_bf16 a[104:107], v[44:47], v[8:11], a[104:107]
v_add_u32 v228, s48, v228
s_add_u32 s39, s39, s34
v_mfma_f32_16x16x32_bf16 a[108:111], v[44:47], v[12:15], a[108:111]
s_add_u32 s15, s15, s17
s_add_u32 s39, s39, 0x8402000
v_min_u32 v228, s49, v228
v_mfma_f32_16x16x32_bf16 a[112:115], v[44:47], v[16:19], a[112:115]
s_lshl_b32 s60, s24, 10
s_add_u32 s60, s60, 0x8400000
v_mfma_f32_16x16x32_bf16 a[116:119], v[44:47], v[20:23], a[116:119]
v_lshlrev_b32 v228, s63, v228
v_lshl_add_u32 v228, v254, 4, v228
v_mfma_f32_16x16x32_bf16 a[120:123], v[44:47], v[24:27], a[120:123]
v_or_b32 v146, s61, v251
s_mov_b64 exec, s[100:101]
buffer_load_dword v231, v228, s[4:7], s39 offen sc1
buffer_load_dwordx4 v[232:235], v146, s[4:7], s60 offen sc1
s_mov_b64 exec, -1
v_mfma_f32_16x16x32_bf16 a[124:127], v[44:47], v[28:31], a[124:127]
s_waitcnt lgkmcnt(0)
v_mfma_f32_16x16x32_bf16 a[0:3], v[80:83], v[48:51], a[0:3]
s_waitcnt vmcnt(12)
s_barrier
ds_read_b128 v[32:35], v136 offset:16384
s_add_u32 m0, s20, 8192
s_nop 0
s_mov_b32 s1, s21
v_mfma_f32_16x16x32_bf16 a[4:7], v[80:83], v[52:55], a[4:7]
ds_read_b64_tr_b16 v[0:1], v128 offset:32768
v_mfma_f32_16x16x32_bf16 a[8:11], v[80:83], v[56:59], a[8:11]
ds_read_b64_tr_b16 v[2:3], v128 offset:40960
v_mfma_f32_16x16x32_bf16 a[12:15], v[80:83], v[60:63], a[12:15]
ds_read_b64_tr_b16 v[4:5], v129 offset:32768
buffer_load_dwordx4 v141, s[4:7], s16 offen offset:0 sc1 lds
v_mfma_f32_16x16x32_bf16 a[16:19], v[80:83], v[64:67], a[16:19]
ds_read_b64_tr_b16 v[6:7], v129 offset:40960
v_mfma_f32_16x16x32_bf16 a[20:23], v[80:83], v[68:71], a[20:23]
ds_read_b64_tr_b16 v[8:9], v130 offset:32768
s_mov_b32 s2, s22
v_mfma_f32_16x16x32_bf16 a[24:27], v[80:83], v[72:75], a[24:27]
ds_read_b64_tr_b16 v[10:11], v130 offset:40960
buffer_load_dwordx4 v142, s[4:7], s16 offen offset:1024 sc1 lds
v_mfma_f32_16x16x32_bf16 a[28:31], v[80:83], v[76:79], a[28:31]
ds_read_b64_tr_b16 v[12:13], v131 offset:32768
v_mfma_f32_16x16x32_bf16 a[32:35], v[84:87], v[48:51], a[32:35]
ds_read_b64_tr_b16 v[14:15], v131 offset:40960
v_mfma_f32_16x16x32_bf16 a[36:39], v[84:87], v[52:55], a[36:39]
ds_read_b64_tr_b16 v[16:17], v132 offset:32768
s_add_u32 s16, s16, 1024
v_mfma_f32_16x16x32_bf16 a[40:43], v[84:87], v[56:59], a[40:43]
ds_read_b64_tr_b16 v[18:19], v132 offset:40960
s_mov_b32 s3, s26
v_mfma_f32_16x16x32_bf16 a[44:47], v[84:87], v[60:63], a[44:47]
ds_read_b64_tr_b16 v[20:21], v133 offset:32768
v_mfma_f32_16x16x32_bf16 a[48:51], v[84:87], v[64:67], a[48:51]
ds_read_b64_tr_b16 v[22:23], v133 offset:40960
s_add_u32 m0, s19, 16384
s_nop 0
v_mfma_f32_16x16x32_bf16 a[52:55], v[84:87], v[68:71], a[52:55]
ds_read_b64_tr_b16 v[24:25], v134 offset:32768
v_mfma_f32_16x16x32_bf16 a[56:59], v[84:87], v[72:75], a[56:59]
ds_read_b64_tr_b16 v[26:27], v134 offset:40960
v_mfma_f32_16x16x32_bf16 a[60:63], v[84:87], v[76:79], a[60:63]
ds_read_b64_tr_b16 v[28:29], v135 offset:32768
buffer_load_dwordx4 v137, s[8:11], s15 offen offset:0 lds
s_mov_b32 s56, s57
v_mfma_f32_16x16x32_bf16 a[64:67], v[88:91], v[48:51], a[64:67]
ds_read_b64_tr_b16 v[30:31], v135 offset:40960
v_mfma_f32_16x16x32_bf16 a[68:71], v[88:91], v[52:55], a[68:71]
ds_read_b128 v[36:39], v136 offset:17408
v_mfma_f32_16x16x32_bf16 a[72:75], v[88:91], v[56:59], a[72:75]
ds_read_b128 v[40:43], v136 offset:18432
buffer_load_dwordx4 v138, s[8:11], s15 offen offset:1024 lds
v_mfma_f32_16x16x32_bf16 a[76:79], v[88:91], v[60:63], a[76:79]
ds_read_b128 v[44:47], v136 offset:19456
v_mfma_f32_16x16x32_bf16 a[80:83], v[88:91], v[64:67], a[80:83]
v_mov_b32 v145, v252
v_mfma_f32_16x16x32_bf16 a[84:87], v[88:91], v[68:71], a[84:87]
buffer_load_dwordx4 v139, s[8:11], s15 offen offset:2048 lds
v_mfma_f32_16x16x32_bf16 a[88:91], v[88:91], v[72:75], a[88:91]
v_mfma_f32_16x16x32_bf16 a[92:95], v[88:91], v[76:79], a[92:95]
v_mfma_f32_16x16x32_bf16 a[96:99], v[92:95], v[48:51], a[96:99]
buffer_load_dwordx4 v140, s[8:11], s15 offen offset:3072 lds
v_mfma_f32_16x16x32_bf16 a[100:103], v[92:95], v[52:55], a[100:103]
v_mov_b32 v255, 131072
v_mfma_f32_16x16x32_bf16 a[104:107], v[92:95], v[56:59], a[104:107]
v_mfma_f32_16x16x32_bf16 a[108:111], v[92:95], v[60:63], a[108:111]
s_add_u32 s15, s15, s17
v_mfma_f32_16x16x32_bf16 a[112:115], v[92:95], v[64:67], a[112:115]
v_mfma_f32_16x16x32_bf16 a[116:119], v[92:95], v[68:71], a[116:119]
v_mfma_f32_16x16x32_bf16 a[120:123], v[92:95], v[72:75], a[120:123]
v_mfma_f32_16x16x32_bf16 a[124:127], v[92:95], v[76:79], a[124:127]
s_waitcnt lgkmcnt(0)
v_mfma_f32_16x16x32_bf16 a[0:3], v[32:35], v[0:3], a[0:3]
s_waitcnt vmcnt(12)
s_barrier
ds_read_b128 v[80:83], v136 offset:24576
s_add_u32 m0, s20, 16384
s_nop 0
v_mfma_f32_16x16x32_bf16 a[4:7], v[32:35], v[4:7], a[4:7]
ds_read_b64_tr_b16 v[48:49], v128 offset:49152
v_mfma_f32_16x16x32_bf16 a[8:11], v[32:35], v[8:11], a[8:11]
ds_read_b64_tr_b16 v[50:51], v128 offset:57344
v_mfma_f32_16x16x32_bf16 a[12:15], v[32:35], v[12:15], a[12:15]
ds_read_b64_tr_b16 v[52:53], v129 offset:49152
buffer_load_dwordx4 v141, s[4:7], s16 offen offset:0 sc1 lds
v_mfma_f32_16x16x32_bf16 a[16:19], v[32:35], v[16:19], a[16:19]
ds_read_b64_tr_b16 v[54:55], v129 offset:57344
v_mfma_f32_16x16x32_bf16 a[20:23], v[32:35], v[20:23], a[20:23]
ds_read_b64_tr_b16 v[56:57], v130 offset:49152
v_mfma_f32_16x16x32_bf16 a[24:27], v[32:35], v[24:27], a[24:27]
ds_read_b64_tr_b16 v[58:59], v130 offset:57344
buffer_load_dwordx4 v142, s[4:7], s16 offen offset:1024 sc1 lds
v_mfma_f32_16x16x32_bf16 a[28:31], v[32:35], v[28:31], a[28:31]
ds_read_b64_tr_b16 v[60:61], v131 offset:49152
v_mfma_f32_16x16x32_bf16 a[32:35], v[36:39], v[0:3], a[32:35]
ds_read_b64_tr_b16 v[62:63], v131 offset:57344
v_mfma_f32_16x16x32_bf16 a[36:39], v[36:39], v[4:7], a[36:39]
ds_read_b64_tr_b16 v[64:65], v132 offset:49152
s_add_u32 s16, s16, 1024
v_mfma_f32_16x16x32_bf16 a[40:43], v[36:39], v[8:11], a[40:43]
ds_read_b64_tr_b16 v[66:67], v132 offset:57344
v_mfma_f32_16x16x32_bf16 a[44:47], v[36:39], v[12:15], a[44:47]
ds_read_b64_tr_b16 v[68:69], v133 offset:49152
v_mfma_f32_16x16x32_bf16 a[48:51], v[36:39], v[16:19], a[48:51]
ds_read_b64_tr_b16 v[70:71], v133 offset:57344
s_add_u32 m0, s19, 32768
s_nop 0
v_mfma_f32_16x16x32_bf16 a[52:55], v[36:39], v[20:23], a[52:55]
ds_read_b64_tr_b16 v[72:73], v134 offset:49152
v_mfma_f32_16x16x32_bf16 a[56:59], v[36:39], v[24:27], a[56:59]
ds_read_b64_tr_b16 v[74:75], v134 offset:57344
v_mfma_f32_16x16x32_bf16 a[60:63], v[36:39], v[28:31], a[60:63]
ds_read_b64_tr_b16 v[76:77], v135 offset:49152
buffer_load_dwordx4 v137, s[8:11], s15 offen offset:0 lds
v_mfma_f32_16x16x32_bf16 a[64:67], v[40:43], v[0:3], a[64:67]
ds_read_b64_tr_b16 v[78:79], v135 offset:57344
v_mfma_f32_16x16x32_bf16 a[68:71], v[40:43], v[4:7], a[68:71]
ds_read_b128 v[84:87], v136 offset:25600
v_mfma_f32_16x16x32_bf16 a[72:75], v[40:43], v[8:11], a[72:75]
ds_read_b128 v[88:91], v136 offset:26624
buffer_load_dwordx4 v138, s[8:11], s15 offen offset:1024 lds
v_mfma_f32_16x16x32_bf16 a[76:79], v[40:43], v[12:15], a[76:79]
ds_read_b128 v[92:95], v136 offset:27648
v_mfma_f32_16x16x32_bf16 a[80:83], v[40:43], v[16:19], a[80:83]
s_waitcnt vmcnt(10)
v_mfma_f32_16x16x32_bf16 a[84:87], v[40:43], v[20:23], a[84:87]
buffer_load_dwordx4 v139, s[8:11], s15 offen offset:2048 lds
v_min3_u32 v253, v232, v233, v234
v_mfma_f32_16x16x32_bf16 a[88:91], v[40:43], v[24:27], a[88:91]
v_min_u32 v253, v253, v235
v_mfma_f32_16x16x32_bf16 a[92:95], v[40:43], v[28:31], a[92:95]
v_or_b32 v253, s61, v253
v_mfma_f32_16x16x32_bf16 a[96:99], v[44:47], v[0:3], a[96:99]
buffer_load_dwordx4 v140, s[8:11], s15 offen offset:3072 lds
v_min_u32 v253, v253, v231
v_mfma_f32_16x16x32_bf16 a[100:103], v[44:47], v[4:7], a[100:103]
v_cmp_eq_u32 vcc, 0, v253
v_mfma_f32_16x16x32_bf16 a[104:107], v[44:47], v[8:11], a[104:107]
s_nop 1
v_mfma_f32_16x16x32_bf16 a[108:111], v[44:47], v[12:15], a[108:111]
s_add_u32 s15, s15, s17
s_cmp_eq_u64 vcc, 0
s_cselect_b32 s32, s36, -4
v_mfma_f32_16x16x32_bf16 a[112:115], v[44:47], v[16:19], a[112:115]
s_bitcmp1_b32 0x1df, s23
s_cselect_b32 s32, s32, -4
v_mfma_f32_16x16x32_bf16 a[116:119], v[44:47], v[20:23], a[116:119]
v_mov_b32 v254, s32
v_mfma_f32_16x16x32_bf16 a[120:123], v[44:47], v[24:27], a[120:123]
s_mov_b64 exec, s[100:101]
ds_write_b32 v255, v254
s_mov_b64 exec, -1
v_mfma_f32_16x16x32_bf16 a[124:127], v[44:47], v[28:31], a[124:127]
s_waitcnt lgkmcnt(0)
v_mfma_f32_16x16x32_bf16 a[0:3], v[80:83], v[48:51], a[0:3]
s_waitcnt vmcnt(12)
s_barrier
ds_read_b128 v[32:35], v136 offset:0
s_add_u32 m0, s20, 24576
s_nop 0
ds_read_b32 v254, v255
v_mfma_f32_16x16x32_bf16 a[4:7], v[80:83], v[52:55], a[4:7]
ds_read_b64_tr_b16 v[0:1], v128 offset:0
v_mfma_f32_16x16x32_bf16 a[8:11], v[80:83], v[56:59], a[8:11]
ds_read_b64_tr_b16 v[2:3], v128 offset:8192
v_mfma_f32_16x16x32_bf16 a[12:15], v[80:83], v[60:63], a[12:15]
ds_read_b64_tr_b16 v[4:5], v129 offset:0
buffer_load_dwordx4 v141, s[4:7], s16 offen offset:0 sc1 lds
v_mfma_f32_16x16x32_bf16 a[16:19], v[80:83], v[64:67], a[16:19]
ds_read_b64_tr_b16 v[6:7], v129 offset:8192
v_mfma_f32_16x16x32_bf16 a[20:23], v[80:83], v[68:71], a[20:23]
ds_read_b64_tr_b16 v[8:9], v130 offset:0
v_mfma_f32_16x16x32_bf16 a[24:27], v[80:83], v[72:75], a[24:27]
ds_read_b64_tr_b16 v[10:11], v130 offset:8192
buffer_load_dwordx4 v142, s[4:7], s16 offen offset:1024 sc1 lds
v_mfma_f32_16x16x32_bf16 a[28:31], v[80:83], v[76:79], a[28:31]
ds_read_b64_tr_b16 v[12:13], v131 offset:0
v_mfma_f32_16x16x32_bf16 a[32:35], v[84:87], v[48:51], a[32:35]
ds_read_b64_tr_b16 v[14:15], v131 offset:8192
v_mfma_f32_16x16x32_bf16 a[36:39], v[84:87], v[52:55], a[36:39]
ds_read_b64_tr_b16 v[16:17], v132 offset:0
s_add_u32 s16, s16, 1024
v_mfma_f32_16x16x32_bf16 a[40:43], v[84:87], v[56:59], a[40:43]
ds_read_b64_tr_b16 v[18:19], v132 offset:8192
v_mfma_f32_16x16x32_bf16 a[44:47], v[84:87], v[60:63], a[44:47]
ds_read_b64_tr_b16 v[20:21], v133 offset:0
v_mfma_f32_16x16x32_bf16 a[48:51], v[84:87], v[64:67], a[48:51]
ds_read_b64_tr_b16 v[22:23], v133 offset:8192
s_add_u32 m0, s19, 49152
s_nop 0
v_mfma_f32_16x16x32_bf16 a[52:55], v[84:87], v[68:71], a[52:55]
ds_read_b64_tr_b16 v[24:25], v134 offset:0
v_mfma_f32_16x16x32_bf16 a[56:59], v[84:87], v[72:75], a[56:59]
ds_read_b64_tr_b16 v[26:27], v134 offset:8192
v_mfma_f32_16x16x32_bf16 a[60:63], v[84:87], v[76:79], a[60:63]
ds_read_b64_tr_b16 v[28:29], v135 offset:0
buffer_load_dwordx4 v137, s[8:11], s15 offen offset:0 lds
v_mfma_f32_16x16x32_bf16 a[64:67], v[88:91], v[48:51], a[64:67]
ds_read_b64_tr_b16 v[30:31], v135 offset:8192
v_mfma_f32_16x16x32_bf16 a[68:71], v[88:91], v[52:55], a[68:71]
ds_read_b128 v[36:39], v136 offset:1024
v_mfma_f32_16x16x32_bf16 a[72:75], v[88:91], v[56:59], a[72:75]
ds_read_b128 v[40:43], v136 offset:2048
buffer_load_dwordx4 v138, s[8:11], s15 offen offset:1024 lds
v_mfma_f32_16x16x32_bf16 a[76:79], v[88:91], v[60:63], a[76:79]
ds_read_b128 v[44:47], v136 offset:3072
v_mfma_f32_16x16x32_bf16 a[80:83], v[88:91], v[64:67], a[80:83]
s_waitcnt lgkmcnt(8)
v_mfma_f32_16x16x32_bf16 a[84:87], v[88:91], v[68:71], a[84:87]
buffer_load_dwordx4 v139, s[8:11], s15 offen offset:2048 lds
v_readfirstlane_b32 s62, v254
v_mfma_f32_16x16x32_bf16 a[88:91], v[88:91], v[72:75], a[88:91]
v_mfma_f32_16x16x32_bf16 a[92:95], v[88:91], v[76:79], a[92:95]
s_nop 1
v_mfma_f32_16x16x32_bf16 a[96:99], v[92:95], v[48:51], a[96:99]
buffer_load_dwordx4 v140, s[8:11], s15 offen offset:3072 lds
s_and_b32 s23, s62, 15
v_mfma_f32_16x16x32_bf16 a[100:103], v[92:95], v[52:55], a[100:103]
v_mfma_f32_16x16x32_bf16 a[104:107], v[92:95], v[56:59], a[104:107]
s_bfe_u32 s54, s62, 0x20004
v_mfma_f32_16x16x32_bf16 a[108:111], v[92:95], v[60:63], a[108:111]
s_add_u32 s15, s15, s17
s_bfe_u32 s24, s62, 0x80008
v_mfma_f32_16x16x32_bf16 a[112:115], v[92:95], v[64:67], a[112:115]
v_mfma_f32_16x16x32_bf16 a[116:119], v[92:95], v[68:71], a[116:119]
s_lshr_b32 s25, s62, 16
v_mfma_f32_16x16x32_bf16 a[120:123], v[92:95], v[72:75], a[120:123]
v_mfma_f32_16x16x32_bf16 a[124:127], v[92:95], v[76:79], a[124:127]
s_cmp_eq_u32 s54, 1
s_cselect_b32 s73, 3, -1
s_cbranch_scc1 main_kernel_w_c1_task
s_waitcnt lgkmcnt(0)
v_mfma_f32_16x16x32_bf16 a[0:3], v[32:35], v[0:3], a[0:3]
s_waitcnt vmcnt(12)
s_barrier
ds_read_b128 v[80:83], v136 offset:8192
v_mfma_f32_16x16x32_bf16 a[4:7], v[32:35], v[4:7], a[4:7]
ds_read_b64_tr_b16 v[48:49], v128 offset:16384
v_mfma_f32_16x16x32_bf16 a[8:11], v[32:35], v[8:11], a[8:11]
ds_read_b64_tr_b16 v[50:51], v128 offset:24576
v_mfma_f32_16x16x32_bf16 a[12:15], v[32:35], v[12:15], a[12:15]
ds_read_b64_tr_b16 v[52:53], v129 offset:16384
v_mfma_f32_16x16x32_bf16 a[16:19], v[32:35], v[16:19], a[16:19]
ds_read_b64_tr_b16 v[54:55], v129 offset:24576
v_mfma_f32_16x16x32_bf16 a[20:23], v[32:35], v[20:23], a[20:23]
ds_read_b64_tr_b16 v[56:57], v130 offset:16384
v_mfma_f32_16x16x32_bf16 a[24:27], v[32:35], v[24:27], a[24:27]
ds_read_b64_tr_b16 v[58:59], v130 offset:24576
v_mfma_f32_16x16x32_bf16 a[28:31], v[32:35], v[28:31], a[28:31]
ds_read_b64_tr_b16 v[60:61], v131 offset:16384
v_mfma_f32_16x16x32_bf16 a[32:35], v[36:39], v[0:3], a[32:35]
ds_read_b64_tr_b16 v[62:63], v131 offset:24576
v_mfma_f32_16x16x32_bf16 a[36:39], v[36:39], v[4:7], a[36:39]
ds_read_b64_tr_b16 v[64:65], v132 offset:16384
v_mfma_f32_16x16x32_bf16 a[40:43], v[36:39], v[8:11], a[40:43]
ds_read_b64_tr_b16 v[66:67], v132 offset:24576
v_mfma_f32_16x16x32_bf16 a[44:47], v[36:39], v[12:15], a[44:47]
ds_read_b64_tr_b16 v[68:69], v133 offset:16384
v_mfma_f32_16x16x32_bf16 a[48:51], v[36:39], v[16:19], a[48:51]
ds_read_b64_tr_b16 v[70:71], v133 offset:24576
v_mfma_f32_16x16x32_bf16 a[52:55], v[36:39], v[20:23], a[52:55]
ds_read_b64_tr_b16 v[72:73], v134 offset:16384
v_mfma_f32_16x16x32_bf16 a[56:59], v[36:39], v[24:27], a[56:59]
ds_read_b64_tr_b16 v[74:75], v134 offset:24576
v_mfma_f32_16x16x32_bf16 a[60:63], v[36:39], v[28:31], a[60:63]
ds_read_b64_tr_b16 v[76:77], v135 offset:16384
v_mfma_f32_16x16x32_bf16 a[64:67], v[40:43], v[0:3], a[64:67]
ds_read_b64_tr_b16 v[78:79], v135 offset:24576
v_mfma_f32_16x16x32_bf16 a[68:71], v[40:43], v[4:7], a[68:71]
ds_read_b128 v[84:87], v136 offset:9216
v_mfma_f32_16x16x32_bf16 a[72:75], v[40:43], v[8:11], a[72:75]
ds_read_b128 v[88:91], v136 offset:10240
v_mfma_f32_16x16x32_bf16 a[76:79], v[40:43], v[12:15], a[76:79]
ds_read_b128 v[92:95], v136 offset:11264
v_mfma_f32_16x16x32_bf16 a[80:83], v[40:43], v[16:19], a[80:83]
v_mfma_f32_16x16x32_bf16 a[84:87], v[40:43], v[20:23], a[84:87]
v_mfma_f32_16x16x32_bf16 a[88:91], v[40:43], v[24:27], a[88:91]
v_mfma_f32_16x16x32_bf16 a[92:95], v[40:43], v[28:31], a[92:95]
v_mfma_f32_16x16x32_bf16 a[96:99], v[44:47], v[0:3], a[96:99]
v_mfma_f32_16x16x32_bf16 a[100:103], v[44:47], v[4:7], a[100:103]
v_mfma_f32_16x16x32_bf16 a[104:107], v[44:47], v[8:11], a[104:107]
v_mfma_f32_16x16x32_bf16 a[108:111], v[44:47], v[12:15], a[108:111]
v_mfma_f32_16x16x32_bf16 a[112:115], v[44:47], v[16:19], a[112:115]
v_mfma_f32_16x16x32_bf16 a[116:119], v[44:47], v[20:23], a[116:119]
v_mfma_f32_16x16x32_bf16 a[120:123], v[44:47], v[24:27], a[120:123]
v_mfma_f32_16x16x32_bf16 a[124:127], v[44:47], v[28:31], a[124:127]
s_waitcnt lgkmcnt(0)
v_mfma_f32_16x16x32_bf16 a[0:3], v[80:83], v[48:51], a[0:3]
s_waitcnt vmcnt(6)
s_barrier
ds_read_b128 v[32:35], v136 offset:16384
v_mfma_f32_16x16x32_bf16 a[4:7], v[80:83], v[52:55], a[4:7]
ds_read_b64_tr_b16 v[0:1], v128 offset:32768
v_mfma_f32_16x16x32_bf16 a[8:11], v[80:83], v[56:59], a[8:11]
ds_read_b64_tr_b16 v[2:3], v128 offset:40960
v_mfma_f32_16x16x32_bf16 a[12:15], v[80:83], v[60:63], a[12:15]
ds_read_b64_tr_b16 v[4:5], v129 offset:32768
v_mfma_f32_16x16x32_bf16 a[16:19], v[80:83], v[64:67], a[16:19]
ds_read_b64_tr_b16 v[6:7], v129 offset:40960
v_mfma_f32_16x16x32_bf16 a[20:23], v[80:83], v[68:71], a[20:23]
ds_read_b64_tr_b16 v[8:9], v130 offset:32768
v_mfma_f32_16x16x32_bf16 a[24:27], v[80:83], v[72:75], a[24:27]
ds_read_b64_tr_b16 v[10:11], v130 offset:40960
v_mfma_f32_16x16x32_bf16 a[28:31], v[80:83], v[76:79], a[28:31]
ds_read_b64_tr_b16 v[12:13], v131 offset:32768
v_mfma_f32_16x16x32_bf16 a[32:35], v[84:87], v[48:51], a[32:35]
ds_read_b64_tr_b16 v[14:15], v131 offset:40960
v_mfma_f32_16x16x32_bf16 a[36:39], v[84:87], v[52:55], a[36:39]
ds_read_b64_tr_b16 v[16:17], v132 offset:32768
v_mfma_f32_16x16x32_bf16 a[40:43], v[84:87], v[56:59], a[40:43]
ds_read_b64_tr_b16 v[18:19], v132 offset:40960
v_mfma_f32_16x16x32_bf16 a[44:47], v[84:87], v[60:63], a[44:47]
ds_read_b64_tr_b16 v[20:21], v133 offset:32768
v_mfma_f32_16x16x32_bf16 a[48:51], v[84:87], v[64:67], a[48:51]
ds_read_b64_tr_b16 v[22:23], v133 offset:40960
v_mfma_f32_16x16x32_bf16 a[52:55], v[84:87], v[68:71], a[52:55]
ds_read_b64_tr_b16 v[24:25], v134 offset:32768
v_mfma_f32_16x16x32_bf16 a[56:59], v[84:87], v[72:75], a[56:59]
ds_read_b64_tr_b16 v[26:27], v134 offset:40960
v_mfma_f32_16x16x32_bf16 a[60:63], v[84:87], v[76:79], a[60:63]
ds_read_b64_tr_b16 v[28:29], v135 offset:32768
v_mfma_f32_16x16x32_bf16 a[64:67], v[88:91], v[48:51], a[64:67]
ds_read_b64_tr_b16 v[30:31], v135 offset:40960
v_mfma_f32_16x16x32_bf16 a[68:71], v[88:91], v[52:55], a[68:71]
ds_read_b128 v[36:39], v136 offset:17408
v_mfma_f32_16x16x32_bf16 a[72:75], v[88:91], v[56:59], a[72:75]
ds_read_b128 v[40:43], v136 offset:18432
v_mfma_f32_16x16x32_bf16 a[76:79], v[88:91], v[60:63], a[76:79]
ds_read_b128 v[44:47], v136 offset:19456
v_mfma_f32_16x16x32_bf16 a[80:83], v[88:91], v[64:67], a[80:83]
v_mfma_f32_16x16x32_bf16 a[84:87], v[88:91], v[68:71], a[84:87]
v_mfma_f32_16x16x32_bf16 a[88:91], v[88:91], v[72:75], a[88:91]
v_mfma_f32_16x16x32_bf16 a[92:95], v[88:91], v[76:79], a[92:95]
v_mfma_f32_16x16x32_bf16 a[96:99], v[92:95], v[48:51], a[96:99]
v_mfma_f32_16x16x32_bf16 a[100:103], v[92:95], v[52:55], a[100:103]
v_mfma_f32_16x16x32_bf16 a[104:107], v[92:95], v[56:59], a[104:107]
v_mfma_f32_16x16x32_bf16 a[108:111], v[92:95], v[60:63], a[108:111]
v_mfma_f32_16x16x32_bf16 a[112:115], v[92:95], v[64:67], a[112:115]
v_mfma_f32_16x16x32_bf16 a[116:119], v[92:95], v[68:71], a[116:119]
v_mfma_f32_16x16x32_bf16 a[120:123], v[92:95], v[72:75], a[120:123]
v_mfma_f32_16x16x32_bf16 a[124:127], v[92:95], v[76:79], a[124:127]
s_waitcnt lgkmcnt(0)
v_mfma_f32_16x16x32_bf16 a[0:3], v[32:35], v[0:3], a[0:3]
s_waitcnt vmcnt(0)
s_barrier
ds_read_b128 v[80:83], v136 offset:24576
v_mfma_f32_16x16x32_bf16 a[4:7], v[32:35], v[4:7], a[4:7]
ds_read_b64_tr_b16 v[48:49], v128 offset:49152
v_mfma_f32_16x16x32_bf16 a[8:11], v[32:35], v[8:11], a[8:11]
ds_read_b64_tr_b16 v[50:51], v128 offset:57344
v_mfma_f32_16x16x32_bf16 a[12:15], v[32:35], v[12:15], a[12:15]
ds_read_b64_tr_b16 v[52:53], v129 offset:49152
v_mfma_f32_16x16x32_bf16 a[16:19], v[32:35], v[16:19], a[16:19]
ds_read_b64_tr_b16 v[54:55], v129 offset:57344
v_mfma_f32_16x16x32_bf16 a[20:23], v[32:35], v[20:23], a[20:23]
ds_read_b64_tr_b16 v[56:57], v130 offset:49152
v_mfma_f32_16x16x32_bf16 a[24:27], v[32:35], v[24:27], a[24:27]
ds_read_b64_tr_b16 v[58:59], v130 offset:57344
v_mfma_f32_16x16x32_bf16 a[28:31], v[32:35], v[28:31], a[28:31]
ds_read_b64_tr_b16 v[60:61], v131 offset:49152
v_mfma_f32_16x16x32_bf16 a[32:35], v[36:39], v[0:3], a[32:35]
ds_read_b64_tr_b16 v[62:63], v131 offset:57344
v_mfma_f32_16x16x32_bf16 a[36:39], v[36:39], v[4:7], a[36:39]
ds_read_b64_tr_b16 v[64:65], v132 offset:49152
v_mfma_f32_16x16x32_bf16 a[40:43], v[36:39], v[8:11], a[40:43]
ds_read_b64_tr_b16 v[66:67], v132 offset:57344
v_mfma_f32_16x16x32_bf16 a[44:47], v[36:39], v[12:15], a[44:47]
ds_read_b64_tr_b16 v[68:69], v133 offset:49152
v_mfma_f32_16x16x32_bf16 a[48:51], v[36:39], v[16:19], a[48:51]
ds_read_b64_tr_b16 v[70:71], v133 offset:57344
v_mfma_f32_16x16x32_bf16 a[52:55], v[36:39], v[20:23], a[52:55]
ds_read_b64_tr_b16 v[72:73], v134 offset:49152
v_mfma_f32_16x16x32_bf16 a[56:59], v[36:39], v[24:27], a[56:59]
ds_read_b64_tr_b16 v[74:75], v134 offset:57344
v_mfma_f32_16x16x32_bf16 a[60:63], v[36:39], v[28:31], a[60:63]
ds_read_b64_tr_b16 v[76:77], v135 offset:49152
v_mfma_f32_16x16x32_bf16 a[64:67], v[40:43], v[0:3], a[64:67]
ds_read_b64_tr_b16 v[78:79], v135 offset:57344
v_mfma_f32_16x16x32_bf16 a[68:71], v[40:43], v[4:7], a[68:71]
ds_read_b128 v[84:87], v136 offset:25600
v_mfma_f32_16x16x32_bf16 a[72:75], v[40:43], v[8:11], a[72:75]
ds_read_b128 v[88:91], v136 offset:26624
v_mfma_f32_16x16x32_bf16 a[76:79], v[40:43], v[12:15], a[76:79]
ds_read_b128 v[92:95], v136 offset:27648
v_mfma_f32_16x16x32_bf16 a[80:83], v[40:43], v[16:19], a[80:83]
v_mfma_f32_16x16x32_bf16 a[84:87], v[40:43], v[20:23], a[84:87]
v_mfma_f32_16x16x32_bf16 a[88:91], v[40:43], v[24:27], a[88:91]
v_mfma_f32_16x16x32_bf16 a[92:95], v[40:43], v[28:31], a[92:95]
v_mfma_f32_16x16x32_bf16 a[96:99], v[44:47], v[0:3], a[96:99]
v_mfma_f32_16x16x32_bf16 a[100:103], v[44:47], v[4:7], a[100:103]
v_mfma_f32_16x16x32_bf16 a[104:107], v[44:47], v[8:11], a[104:107]
v_mfma_f32_16x16x32_bf16 a[108:111], v[44:47], v[12:15], a[108:111]
v_mfma_f32_16x16x32_bf16 a[112:115], v[44:47], v[16:19], a[112:115]
v_mfma_f32_16x16x32_bf16 a[116:119], v[44:47], v[20:23], a[116:119]
v_mfma_f32_16x16x32_bf16 a[120:123], v[44:47], v[24:27], a[120:123]
v_mfma_f32_16x16x32_bf16 a[124:127], v[44:47], v[28:31], a[124:127]
s_waitcnt lgkmcnt(0)
v_mfma_f32_16x16x32_bf16 a[0:3], v[80:83], v[48:51], a[0:3]
s_barrier
v_mfma_f32_16x16x32_bf16 a[4:7], v[80:83], v[52:55], a[4:7]
v_mfma_f32_16x16x32_bf16 a[8:11], v[80:83], v[56:59], a[8:11]
v_mfma_f32_16x16x32_bf16 a[12:15], v[80:83], v[60:63], a[12:15]
v_mfma_f32_16x16x32_bf16 a[16:19], v[80:83], v[64:67], a[16:19]
v_mfma_f32_16x16x32_bf16 a[20:23], v[80:83], v[68:71], a[20:23]
v_mfma_f32_16x16x32_bf16 a[24:27], v[80:83], v[72:75], a[24:27]
v_mfma_f32_16x16x32_bf16 a[28:31], v[80:83], v[76:79], a[28:31]
v_mfma_f32_16x16x32_bf16 a[32:35], v[84:87], v[48:51], a[32:35]
v_mfma_f32_16x16x32_bf16 a[36:39], v[84:87], v[52:55], a[36:39]
v_mfma_f32_16x16x32_bf16 a[40:43], v[84:87], v[56:59], a[40:43]
v_mfma_f32_16x16x32_bf16 a[44:47], v[84:87], v[60:63], a[44:47]
v_mfma_f32_16x16x32_bf16 a[48:51], v[84:87], v[64:67], a[48:51]
v_mfma_f32_16x16x32_bf16 a[52:55], v[84:87], v[68:71], a[52:55]
v_mfma_f32_16x16x32_bf16 a[56:59], v[84:87], v[72:75], a[56:59]
v_mfma_f32_16x16x32_bf16 a[60:63], v[84:87], v[76:79], a[60:63]
v_mfma_f32_16x16x32_bf16 a[64:67], v[88:91], v[48:51], a[64:67]
v_mfma_f32_16x16x32_bf16 a[68:71], v[88:91], v[52:55], a[68:71]
v_mfma_f32_16x16x32_bf16 a[72:75], v[88:91], v[56:59], a[72:75]
v_mfma_f32_16x16x32_bf16 a[76:79], v[88:91], v[60:63], a[76:79]
v_mfma_f32_16x16x32_bf16 a[80:83], v[88:91], v[64:67], a[80:83]
v_mfma_f32_16x16x32_bf16 a[84:87], v[88:91], v[68:71], a[84:87]
v_mfma_f32_16x16x32_bf16 a[88:91], v[88:91], v[72:75], a[88:91]
v_mfma_f32_16x16x32_bf16 a[92:95], v[88:91], v[76:79], a[92:95]
v_mfma_f32_16x16x32_bf16 a[96:99], v[92:95], v[48:51], a[96:99]
v_mfma_f32_16x16x32_bf16 a[100:103], v[92:95], v[52:55], a[100:103]
v_mfma_f32_16x16x32_bf16 a[104:107], v[92:95], v[56:59], a[104:107]
v_mfma_f32_16x16x32_bf16 a[108:111], v[92:95], v[60:63], a[108:111]
v_mfma_f32_16x16x32_bf16 a[112:115], v[92:95], v[64:67], a[112:115]
v_mfma_f32_16x16x32_bf16 a[116:119], v[92:95], v[68:71], a[116:119]
v_mfma_f32_16x16x32_bf16 a[120:123], v[92:95], v[72:75], a[120:123]
v_mfma_f32_16x16x32_bf16 a[124:127], v[92:95], v[76:79], a[124:127]
s_cmp_lg_u32 s62, -4
s_cbranch_scc1 main_kernel_w_gemm
s_branch main_kernel_w_slow
main_kernel_w_c1_v_ev:
s_mov_b32 s55, 1
s_cmp_eq_u32 s56, 0
s_cbranch_scc1 main_kernel_w_c1_v_et
s_bfm_b64 exec, s0, 0
buffer_store_dword v244, v248, s[4:7], s59 offen sc1
s_mov_b64 exec, -1
s_mov_b32 s56, 0
main_kernel_w_c1_v_et:
s_cmp_lg_u32 s18, 1
s_cbranch_scc1 main_kernel_w_c1_v_loop
s_lshl_b32 s32, s27, 8
s_add_u32 s32, s32, 0x841e000
s_mov_b64 exec, 1
v_mov_b32 v249, 1
buffer_atomic_add v249, off, s[4:7], s32 sc0 sc1
s_mov_b64 exec, -1
s_branch main_kernel_w_c1_v_loop
main_kernel_w_epn:
s_waitcnt lgkmcnt(0)
s_branch main_kernel_w_epw
main_kernel_w_slow:
s_mov_b32 s58, -1
main_kernel_w_epw:
s_nop 5
main_kernel_w_epi:
s_cmp_eq_u32 s56, 2
s_cbranch_scc1 main_kernel_w_e2
s_cmp_eq_u32 s56, 3
s_cbranch_scc1 main_kernel_w_e3
s_cmp_eq_u32 s56, 4
s_cbranch_scc1 main_kernel_w_e4
s_cmp_eq_u32 s56, 5
s_cbranch_scc1 main_kernel_w_e5
s_cmp_eq_u32 s56, 6
s_cbranch_scc1 main_kernel_w_e6
s_cmp_eq_u32 s56, 7
s_cbranch_scc1 main_kernel_w_e7
s_cmp_eq_u32 s56, 8
s_cbranch_scc1 main_kernel_w_e8
s_cmp_eq_u32 s56, 9
s_cbranch_scc1 main_kernel_w_e9
s_cmp_eq_u32 s56, 10
s_cbranch_scc1 main_kernel_w_e10
main_kernel_w_e1:
s_mov_b32 s53, s1
v_mul_f32 v64, 0x3e0293ee, v64
v_mul_f32 v65, 0x3e0293ee, v65
v_mul_f32 v66, 0x3e0293ee, v66
v_mul_f32 v67, 0x3e0293ee, v67
v_mul_f32 v68, 0x3e0293ee, v68
v_mul_f32 v69, 0x3e0293ee, v69
v_mul_f32 v70, 0x3e0293ee, v70
v_mul_f32 v71, 0x3e0293ee, v71
v_cvt_pk_bf16_f32 v16, v64, v65
v_cvt_pk_bf16_f32 v17, v66, v67
v_cvt_pk_bf16_f32 v18, v68, v69
v_cvt_pk_bf16_f32 v19, v70, v71
buffer_store_dwordx4 v[16:19], v251, s[4:7], s53 offen offset:0 sc1
v_mul_f32 v72, 0x3e0293ee, v72
v_mul_f32 v73, 0x3e0293ee, v73
v_mul_f32 v74, 0x3e0293ee, v74
v_mul_f32 v75, 0x3e0293ee, v75
v_mul_f32 v76, 0x3e0293ee, v76
v_mul_f32 v77, 0x3e0293ee, v77
v_mul_f32 v78, 0x3e0293ee, v78
v_mul_f32 v79, 0x3e0293ee, v79
v_cvt_pk_bf16_f32 v36, v72, v73
v_cvt_pk_bf16_f32 v37, v74, v75
v_cvt_pk_bf16_f32 v38, v76, v77
v_cvt_pk_bf16_f32 v39, v78, v79
buffer_store_dwordx4 v[36:39], v251, s[4:7], s53 offen offset:1024 sc1
s_add_u32 s53, s53, s2
v_mul_f32 v80, 0x3e0293ee, v80
v_mul_f32 v81, 0x3e0293ee, v81
v_mul_f32 v82, 0x3e0293ee, v82
v_mul_f32 v83, 0x3e0293ee, v83
v_mul_f32 v84, 0x3e0293ee, v84
v_mul_f32 v85, 0x3e0293ee, v85
v_mul_f32 v86, 0x3e0293ee, v86
v_mul_f32 v87, 0x3e0293ee, v87
v_cvt_pk_bf16_f32 v56, v80, v81
v_cvt_pk_bf16_f32 v57, v82, v83
v_cvt_pk_bf16_f32 v58, v84, v85
v_cvt_pk_bf16_f32 v59, v86, v87
buffer_store_dwordx4 v[56:59], v251, s[4:7], s53 offen offset:0 sc1
v_mul_f32 v88, 0x3e0293ee, v88
v_mul_f32 v89, 0x3e0293ee, v89
v_mul_f32 v90, 0x3e0293ee, v90
v_mul_f32 v91, 0x3e0293ee, v91
v_mul_f32 v92, 0x3e0293ee, v92
v_mul_f32 v93, 0x3e0293ee, v93
v_mul_f32 v94, 0x3e0293ee, v94
v_mul_f32 v95, 0x3e0293ee, v95
v_cvt_pk_bf16_f32 v16, v88, v89
v_cvt_pk_bf16_f32 v17, v90, v91
v_cvt_pk_bf16_f32 v18, v92, v93
v_cvt_pk_bf16_f32 v19, v94, v95
buffer_store_dwordx4 v[16:19], v251, s[4:7], s53 offen offset:1024 sc1
s_add_u32 s53, s53, s2
v_mul_f32 v96, 0x3e0293ee, v96
v_mul_f32 v97, 0x3e0293ee, v97
v_mul_f32 v98, 0x3e0293ee, v98
v_mul_f32 v99, 0x3e0293ee, v99
v_mul_f32 v100, 0x3e0293ee, v100
v_mul_f32 v101, 0x3e0293ee, v101
v_mul_f32 v102, 0x3e0293ee, v102
v_mul_f32 v103, 0x3e0293ee, v103
v_cvt_pk_bf16_f32 v36, v96, v97
v_cvt_pk_bf16_f32 v37, v98, v99
v_cvt_pk_bf16_f32 v38, v100, v101
v_cvt_pk_bf16_f32 v39, v102, v103
buffer_store_dwordx4 v[36:39], v251, s[4:7], s53 offen offset:0 sc1
v_mul_f32 v104, 0x3e0293ee, v104
v_mul_f32 v105, 0x3e0293ee, v105
v_mul_f32 v106, 0x3e0293ee, v106
v_mul_f32 v107, 0x3e0293ee, v107
v_mul_f32 v108, 0x3e0293ee, v108
v_mul_f32 v109, 0x3e0293ee, v109
v_mul_f32 v110, 0x3e0293ee, v110
v_mul_f32 v111, 0x3e0293ee, v111
v_cvt_pk_bf16_f32 v56, v104, v105
v_cvt_pk_bf16_f32 v57, v106, v107
v_cvt_pk_bf16_f32 v58, v108, v109
v_cvt_pk_bf16_f32 v59, v110, v111
buffer_store_dwordx4 v[56:59], v251, s[4:7], s53 offen offset:1024 sc1
s_add_u32 s53, s53, s2
v_mul_f32 v112, 0x3e0293ee, v112
v_mul_f32 v113, 0x3e0293ee, v113
v_mul_f32 v114, 0x3e0293ee, v114
v_mul_f32 v115, 0x3e0293ee, v115
v_mul_f32 v116, 0x3e0293ee, v116
v_mul_f32 v117, 0x3e0293ee, v117
v_mul_f32 v118, 0x3e0293ee, v118
v_mul_f32 v119, 0x3e0293ee, v119
v_cvt_pk_bf16_f32 v16, v112, v113
v_cvt_pk_bf16_f32 v17, v114, v115
v_cvt_pk_bf16_f32 v18, v116, v117
v_cvt_pk_bf16_f32 v19, v118, v119
buffer_store_dwordx4 v[16:19], v251, s[4:7], s53 offen offset:0 sc1
v_mul_f32 v120, 0x3e0293ee, v120
v_mul_f32 v121, 0x3e0293ee, v121
v_mul_f32 v122, 0x3e0293ee, v122
v_mul_f32 v123, 0x3e0293ee, v123
v_mul_f32 v124, 0x3e0293ee, v124
v_mul_f32 v125, 0x3e0293ee, v125
v_mul_f32 v126, 0x3e0293ee, v126
v_mul_f32 v127, 0x3e0293ee, v127
v_cvt_pk_bf16_f32 v36, v120, v121
v_cvt_pk_bf16_f32 v37, v122, v123
v_cvt_pk_bf16_f32 v38, v124, v125
v_cvt_pk_bf16_f32 v39, v126, v127
buffer_store_dwordx4 v[36:39], v251, s[4:7], s53 offen offset:1024 sc1
s_branch main_kernel_w_ee
main_kernel_w_e2:
s_mov_b32 s53, s1
v_cvt_pk_bf16_f32 v8, v64, v65
v_cvt_pk_bf16_f32 v9, v66, v67
v_cvt_pk_bf16_f32 v10, v80, v81
v_cvt_pk_bf16_f32 v11, v82, v83
buffer_store_dwordx4 v[8:11], v251, s[4:7], s53 offen offset:0 sc1
v_cvt_pk_bf16_f32 v24, v68, v69
v_cvt_pk_bf16_f32 v25, v70, v71
v_cvt_pk_bf16_f32 v26, v84, v85
v_cvt_pk_bf16_f32 v27, v86, v87
buffer_store_dwordx4 v[24:27], v251, s[4:7], s53 offen offset:1024 sc1
v_cvt_pk_bf16_f32 v40, v72, v73
v_cvt_pk_bf16_f32 v41, v74, v75
v_cvt_pk_bf16_f32 v42, v88, v89
v_cvt_pk_bf16_f32 v43, v90, v91
buffer_store_dwordx4 v[40:43], v251, s[4:7], s53 offen offset:2048 sc1
v_cvt_pk_bf16_f32 v56, v76, v77
v_cvt_pk_bf16_f32 v57, v78, v79
v_cvt_pk_bf16_f32 v58, v92, v93
v_cvt_pk_bf16_f32 v59, v94, v95
buffer_store_dwordx4 v[56:59], v251, s[4:7], s53 offen offset:3072 sc1
s_add_u32 s53, s53, 262144
v_cvt_pk_bf16_f32 v8, v96, v97
v_cvt_pk_bf16_f32 v9, v98, v99
v_cvt_pk_bf16_f32 v10, v112, v113
v_cvt_pk_bf16_f32 v11, v114, v115
buffer_store_dwordx4 v[8:11], v251, s[4:7], s53 offen offset:0 sc1
v_cvt_pk_bf16_f32 v24, v100, v101
v_cvt_pk_bf16_f32 v25, v102, v103
v_cvt_pk_bf16_f32 v26, v116, v117
v_cvt_pk_bf16_f32 v27, v118, v119
buffer_store_dwordx4 v[24:27], v251, s[4:7], s53 offen offset:1024 sc1
v_cvt_pk_bf16_f32 v40, v104, v105
v_cvt_pk_bf16_f32 v41, v106, v107
v_cvt_pk_bf16_f32 v42, v120, v121
v_cvt_pk_bf16_f32 v43, v122, v123
buffer_store_dwordx4 v[40:43], v251, s[4:7], s53 offen offset:2048 sc1
v_cvt_pk_bf16_f32 v56, v108, v109
v_cvt_pk_bf16_f32 v57, v110, v111
v_cvt_pk_bf16_f32 v58, v124, v125
v_cvt_pk_bf16_f32 v59, v126, v127
buffer_store_dwordx4 v[56:59], v251, s[4:7], s53 offen offset:3072 sc1
s_add_u32 s53, s53, 262144
s_branch main_kernel_w_ee
main_kernel_w_e3:
s_mov_b32 s53, s1
v_lshlrev_b32 v8, 16, v192
v_and_b32 v9, 0xffff0000, v192
v_lshlrev_b32 v10, 16, v193
v_and_b32 v11, 0xffff0000, v193
v_lshlrev_b32 v12, 16, v194
v_and_b32 v13, 0xffff0000, v194
v_lshlrev_b32 v14, 16, v195
v_and_b32 v15, 0xffff0000, v195
v_pk_add_f32 v[64:65], v[64:65], v[8:9]
v_pk_add_f32 v[66:67], v[66:67], v[10:11]
v_pk_add_f32 v[68:69], v[68:69], v[12:13]
v_pk_add_f32 v[70:71], v[70:71], v[14:15]
v_cvt_pk_bf16_f32 v16, v64, v65
v_cvt_pk_bf16_f32 v17, v66, v67
v_cvt_pk_bf16_f32 v18, v68, v69
v_cvt_pk_bf16_f32 v19, v70, v71
buffer_store_dwordx4 v[16:19], v251, s[4:7], s53 offen offset:0 sc1
v_lshlrev_b32 v28, 16, v196
v_and_b32 v29, 0xffff0000, v196
v_lshlrev_b32 v30, 16, v197
v_and_b32 v31, 0xffff0000, v197
v_lshlrev_b32 v32, 16, v198
v_and_b32 v33, 0xffff0000, v198
v_lshlrev_b32 v34, 16, v199
v_and_b32 v35, 0xffff0000, v199
v_pk_add_f32 v[72:73], v[72:73], v[28:29]
v_pk_add_f32 v[74:75], v[74:75], v[30:31]
v_pk_add_f32 v[76:77], v[76:77], v[32:33]
v_pk_add_f32 v[78:79], v[78:79], v[34:35]
v_cvt_pk_bf16_f32 v36, v72, v73
v_cvt_pk_bf16_f32 v37, v74, v75
v_cvt_pk_bf16_f32 v38, v76, v77
v_cvt_pk_bf16_f32 v39, v78, v79
buffer_store_dwordx4 v[36:39], v251, s[4:7], s53 offen offset:1024 sc1
s_add_u32 s53, s53, s2
v_lshlrev_b32 v48, 16, v200
v_and_b32 v49, 0xffff0000, v200
v_lshlrev_b32 v50, 16, v201
v_and_b32 v51, 0xffff0000, v201
v_lshlrev_b32 v52, 16, v202
v_and_b32 v53, 0xffff0000, v202
v_lshlrev_b32 v54, 16, v203
v_and_b32 v55, 0xffff0000, v203
v_pk_add_f32 v[80:81], v[80:81], v[48:49]
v_pk_add_f32 v[82:83], v[82:83], v[50:51]
v_pk_add_f32 v[84:85], v[84:85], v[52:53]
v_pk_add_f32 v[86:87], v[86:87], v[54:55]
v_cvt_pk_bf16_f32 v56, v80, v81
v_cvt_pk_bf16_f32 v57, v82, v83
v_cvt_pk_bf16_f32 v58, v84, v85
v_cvt_pk_bf16_f32 v59, v86, v87
buffer_store_dwordx4 v[56:59], v251, s[4:7], s53 offen offset:0 sc1
v_lshlrev_b32 v8, 16, v204
v_and_b32 v9, 0xffff0000, v204
v_lshlrev_b32 v10, 16, v205
v_and_b32 v11, 0xffff0000, v205
v_lshlrev_b32 v12, 16, v206
v_and_b32 v13, 0xffff0000, v206
v_lshlrev_b32 v14, 16, v207
v_and_b32 v15, 0xffff0000, v207
v_pk_add_f32 v[88:89], v[88:89], v[8:9]
v_pk_add_f32 v[90:91], v[90:91], v[10:11]
v_pk_add_f32 v[92:93], v[92:93], v[12:13]
v_pk_add_f32 v[94:95], v[94:95], v[14:15]
v_cvt_pk_bf16_f32 v16, v88, v89
v_cvt_pk_bf16_f32 v17, v90, v91
v_cvt_pk_bf16_f32 v18, v92, v93
v_cvt_pk_bf16_f32 v19, v94, v95
buffer_store_dwordx4 v[16:19], v251, s[4:7], s53 offen offset:1024 sc1
s_add_u32 s53, s53, s2
v_lshlrev_b32 v28, 16, v208
v_and_b32 v29, 0xffff0000, v208
v_lshlrev_b32 v30, 16, v209
v_and_b32 v31, 0xffff0000, v209
v_lshlrev_b32 v32, 16, v210
v_and_b32 v33, 0xffff0000, v210
v_lshlrev_b32 v34, 16, v211
v_and_b32 v35, 0xffff0000, v211
v_pk_add_f32 v[96:97], v[96:97], v[28:29]
v_pk_add_f32 v[98:99], v[98:99], v[30:31]
v_pk_add_f32 v[100:101], v[100:101], v[32:33]
v_pk_add_f32 v[102:103], v[102:103], v[34:35]
v_cvt_pk_bf16_f32 v36, v96, v97
v_cvt_pk_bf16_f32 v37, v98, v99
v_cvt_pk_bf16_f32 v38, v100, v101
v_cvt_pk_bf16_f32 v39, v102, v103
buffer_store_dwordx4 v[36:39], v251, s[4:7], s53 offen offset:0 sc1
v_lshlrev_b32 v48, 16, v212
v_and_b32 v49, 0xffff0000, v212
v_lshlrev_b32 v50, 16, v213
v_and_b32 v51, 0xffff0000, v213
v_lshlrev_b32 v52, 16, v214
v_and_b32 v53, 0xffff0000, v214
v_lshlrev_b32 v54, 16, v215
v_and_b32 v55, 0xffff0000, v215
v_pk_add_f32 v[104:105], v[104:105], v[48:49]
v_pk_add_f32 v[106:107], v[106:107], v[50:51]
v_pk_add_f32 v[108:109], v[108:109], v[52:53]
v_pk_add_f32 v[110:111], v[110:111], v[54:55]
v_cvt_pk_bf16_f32 v56, v104, v105
v_cvt_pk_bf16_f32 v57, v106, v107
v_cvt_pk_bf16_f32 v58, v108, v109
v_cvt_pk_bf16_f32 v59, v110, v111
buffer_store_dwordx4 v[56:59], v251, s[4:7], s53 offen offset:1024 sc1
s_add_u32 s53, s53, s2
v_lshlrev_b32 v8, 16, v216
v_and_b32 v9, 0xffff0000, v216
v_lshlrev_b32 v10, 16, v217
v_and_b32 v11, 0xffff0000, v217
v_lshlrev_b32 v12, 16, v218
v_and_b32 v13, 0xffff0000, v218
v_lshlrev_b32 v14, 16, v219
v_and_b32 v15, 0xffff0000, v219
v_pk_add_f32 v[112:113], v[112:113], v[8:9]
v_pk_add_f32 v[114:115], v[114:115], v[10:11]
v_pk_add_f32 v[116:117], v[116:117], v[12:13]
v_pk_add_f32 v[118:119], v[118:119], v[14:15]
v_cvt_pk_bf16_f32 v16, v112, v113
v_cvt_pk_bf16_f32 v17, v114, v115
v_cvt_pk_bf16_f32 v18, v116, v117
v_cvt_pk_bf16_f32 v19, v118, v119
buffer_store_dwordx4 v[16:19], v251, s[4:7], s53 offen offset:0 sc1
v_lshlrev_b32 v28, 16, v220
v_and_b32 v29, 0xffff0000, v220
v_lshlrev_b32 v30, 16, v221
v_and_b32 v31, 0xffff0000, v221
v_lshlrev_b32 v32, 16, v222
v_and_b32 v33, 0xffff0000, v222
v_lshlrev_b32 v34, 16, v223
v_and_b32 v35, 0xffff0000, v223
v_pk_add_f32 v[120:121], v[120:121], v[28:29]
v_pk_add_f32 v[122:123], v[122:123], v[30:31]
v_pk_add_f32 v[124:125], v[124:125], v[32:33]
v_pk_add_f32 v[126:127], v[126:127], v[34:35]
v_cvt_pk_bf16_f32 v36, v120, v121
v_cvt_pk_bf16_f32 v37, v122, v123
v_cvt_pk_bf16_f32 v38, v124, v125
v_cvt_pk_bf16_f32 v39, v126, v127
buffer_store_dwordx4 v[36:39], v251, s[4:7], s53 offen offset:1024 sc1
s_branch main_kernel_w_ee
main_kernel_w_e4:
s_mov_b32 s53, s1
v_lshlrev_b32 v8, 16, v192
v_and_b32 v9, 0xffff0000, v192
v_lshlrev_b32 v10, 16, v193
v_and_b32 v11, 0xffff0000, v193
v_lshlrev_b32 v12, 16, v194
v_and_b32 v13, 0xffff0000, v194
v_lshlrev_b32 v14, 16, v195
v_and_b32 v15, 0xffff0000, v195
v_pk_add_f32 v[64:65], v[64:65], v[8:9]
v_pk_add_f32 v[66:67], v[66:67], v[10:11]
v_pk_add_f32 v[68:69], v[68:69], v[12:13]
v_pk_add_f32 v[70:71], v[70:71], v[14:15]
v_pk_mul_f32 v[8:9], v[64:65], v[246:247]
v_pk_mul_f32 v[10:11], v[66:67], v[246:247]
v_pk_mul_f32 v[12:13], v[68:69], v[246:247]
v_pk_mul_f32 v[14:15], v[70:71], v[246:247]
v_exp_f32 v8, v8
v_exp_f32 v9, v9
v_exp_f32 v10, v10
v_exp_f32 v11, v11
v_exp_f32 v12, v12
v_exp_f32 v13, v13
v_exp_f32 v14, v14
v_exp_f32 v15, v15
v_pk_add_f32 v[8:9], v[8:9], v[244:245]
v_pk_add_f32 v[10:11], v[10:11], v[244:245]
v_pk_add_f32 v[12:13], v[12:13], v[244:245]
v_pk_add_f32 v[14:15], v[14:15], v[244:245]
v_rcp_f32 v8, v8
v_rcp_f32 v9, v9
v_rcp_f32 v10, v10
v_rcp_f32 v11, v11
v_rcp_f32 v12, v12
v_rcp_f32 v13, v13
v_rcp_f32 v14, v14
v_rcp_f32 v15, v15
v_pk_mul_f32 v[64:65], v[8:9], v[64:65]
v_pk_mul_f32 v[66:67], v[10:11], v[66:67]
v_pk_mul_f32 v[68:69], v[12:13], v[68:69]
v_pk_mul_f32 v[70:71], v[14:15], v[70:71]
v_cvt_pk_bf16_f32 v16, v64, v65
v_cvt_pk_bf16_f32 v17, v66, v67
v_cvt_pk_bf16_f32 v18, v68, v69
v_cvt_pk_bf16_f32 v19, v70, v71
buffer_store_dwordx4 v[16:19], v251, s[4:7], s53 offen offset:0 sc1
v_lshlrev_b32 v28, 16, v196
v_and_b32 v29, 0xffff0000, v196
v_lshlrev_b32 v30, 16, v197
v_and_b32 v31, 0xffff0000, v197
v_lshlrev_b32 v32, 16, v198
v_and_b32 v33, 0xffff0000, v198
v_lshlrev_b32 v34, 16, v199
v_and_b32 v35, 0xffff0000, v199
v_pk_add_f32 v[72:73], v[72:73], v[28:29]
v_pk_add_f32 v[74:75], v[74:75], v[30:31]
v_pk_add_f32 v[76:77], v[76:77], v[32:33]
v_pk_add_f32 v[78:79], v[78:79], v[34:35]
v_pk_mul_f32 v[28:29], v[72:73], v[246:247]
v_pk_mul_f32 v[30:31], v[74:75], v[246:247]
v_pk_mul_f32 v[32:33], v[76:77], v[246:247]
v_pk_mul_f32 v[34:35], v[78:79], v[246:247]
v_exp_f32 v28, v28
v_exp_f32 v29, v29
v_exp_f32 v30, v30
v_exp_f32 v31, v31
v_exp_f32 v32, v32
v_exp_f32 v33, v33
v_exp_f32 v34, v34
v_exp_f32 v35, v35
v_pk_add_f32 v[28:29], v[28:29], v[244:245]
v_pk_add_f32 v[30:31], v[30:31], v[244:245]
v_pk_add_f32 v[32:33], v[32:33], v[244:245]
v_pk_add_f32 v[34:35], v[34:35], v[244:245]
v_rcp_f32 v28, v28
v_rcp_f32 v29, v29
v_rcp_f32 v30, v30
v_rcp_f32 v31, v31
v_rcp_f32 v32, v32
v_rcp_f32 v33, v33
v_rcp_f32 v34, v34
v_rcp_f32 v35, v35
v_pk_mul_f32 v[72:73], v[28:29], v[72:73]
v_pk_mul_f32 v[74:75], v[30:31], v[74:75]
v_pk_mul_f32 v[76:77], v[32:33], v[76:77]
v_pk_mul_f32 v[78:79], v[34:35], v[78:79]
v_cvt_pk_bf16_f32 v36, v72, v73
v_cvt_pk_bf16_f32 v37, v74, v75
v_cvt_pk_bf16_f32 v38, v76, v77
v_cvt_pk_bf16_f32 v39, v78, v79
buffer_store_dwordx4 v[36:39], v251, s[4:7], s53 offen offset:1024 sc1
s_add_u32 s53, s53, s2
v_lshlrev_b32 v48, 16, v200
v_and_b32 v49, 0xffff0000, v200
v_lshlrev_b32 v50, 16, v201
v_and_b32 v51, 0xffff0000, v201
v_lshlrev_b32 v52, 16, v202
v_and_b32 v53, 0xffff0000, v202
v_lshlrev_b32 v54, 16, v203
v_and_b32 v55, 0xffff0000, v203
v_pk_add_f32 v[80:81], v[80:81], v[48:49]
v_pk_add_f32 v[82:83], v[82:83], v[50:51]
v_pk_add_f32 v[84:85], v[84:85], v[52:53]
v_pk_add_f32 v[86:87], v[86:87], v[54:55]
v_pk_mul_f32 v[48:49], v[80:81], v[246:247]
v_pk_mul_f32 v[50:51], v[82:83], v[246:247]
v_pk_mul_f32 v[52:53], v[84:85], v[246:247]
v_pk_mul_f32 v[54:55], v[86:87], v[246:247]
v_exp_f32 v48, v48
v_exp_f32 v49, v49
v_exp_f32 v50, v50
v_exp_f32 v51, v51
v_exp_f32 v52, v52
v_exp_f32 v53, v53
v_exp_f32 v54, v54
v_exp_f32 v55, v55
v_pk_add_f32 v[48:49], v[48:49], v[244:245]
v_pk_add_f32 v[50:51], v[50:51], v[244:245]
v_pk_add_f32 v[52:53], v[52:53], v[244:245]
v_pk_add_f32 v[54:55], v[54:55], v[244:245]
v_rcp_f32 v48, v48
v_rcp_f32 v49, v49
v_rcp_f32 v50, v50
v_rcp_f32 v51, v51
v_rcp_f32 v52, v52
v_rcp_f32 v53, v53
v_rcp_f32 v54, v54
v_rcp_f32 v55, v55
v_pk_mul_f32 v[80:81], v[48:49], v[80:81]
v_pk_mul_f32 v[82:83], v[50:51], v[82:83]
v_pk_mul_f32 v[84:85], v[52:53], v[84:85]
v_pk_mul_f32 v[86:87], v[54:55], v[86:87]
v_cvt_pk_bf16_f32 v56, v80, v81
v_cvt_pk_bf16_f32 v57, v82, v83
v_cvt_pk_bf16_f32 v58, v84, v85
v_cvt_pk_bf16_f32 v59, v86, v87
buffer_store_dwordx4 v[56:59], v251, s[4:7], s53 offen offset:0 sc1
v_lshlrev_b32 v8, 16, v204
v_and_b32 v9, 0xffff0000, v204
v_lshlrev_b32 v10, 16, v205
v_and_b32 v11, 0xffff0000, v205
v_lshlrev_b32 v12, 16, v206
v_and_b32 v13, 0xffff0000, v206
v_lshlrev_b32 v14, 16, v207
v_and_b32 v15, 0xffff0000, v207
v_pk_add_f32 v[88:89], v[88:89], v[8:9]
v_pk_add_f32 v[90:91], v[90:91], v[10:11]
v_pk_add_f32 v[92:93], v[92:93], v[12:13]
v_pk_add_f32 v[94:95], v[94:95], v[14:15]
v_pk_mul_f32 v[8:9], v[88:89], v[246:247]
v_pk_mul_f32 v[10:11], v[90:91], v[246:247]
v_pk_mul_f32 v[12:13], v[92:93], v[246:247]
v_pk_mul_f32 v[14:15], v[94:95], v[246:247]
v_exp_f32 v8, v8
v_exp_f32 v9, v9
v_exp_f32 v10, v10
v_exp_f32 v11, v11
v_exp_f32 v12, v12
v_exp_f32 v13, v13
v_exp_f32 v14, v14
v_exp_f32 v15, v15
v_pk_add_f32 v[8:9], v[8:9], v[244:245]
v_pk_add_f32 v[10:11], v[10:11], v[244:245]
v_pk_add_f32 v[12:13], v[12:13], v[244:245]
v_pk_add_f32 v[14:15], v[14:15], v[244:245]
v_rcp_f32 v8, v8
v_rcp_f32 v9, v9
v_rcp_f32 v10, v10
v_rcp_f32 v11, v11
v_rcp_f32 v12, v12
v_rcp_f32 v13, v13
v_rcp_f32 v14, v14
v_rcp_f32 v15, v15
v_pk_mul_f32 v[88:89], v[8:9], v[88:89]
v_pk_mul_f32 v[90:91], v[10:11], v[90:91]
v_pk_mul_f32 v[92:93], v[12:13], v[92:93]
v_pk_mul_f32 v[94:95], v[14:15], v[94:95]
v_cvt_pk_bf16_f32 v16, v88, v89
v_cvt_pk_bf16_f32 v17, v90, v91
v_cvt_pk_bf16_f32 v18, v92, v93
v_cvt_pk_bf16_f32 v19, v94, v95
buffer_store_dwordx4 v[16:19], v251, s[4:7], s53 offen offset:1024 sc1
s_add_u32 s53, s53, s2
v_lshlrev_b32 v28, 16, v208
v_and_b32 v29, 0xffff0000, v208
v_lshlrev_b32 v30, 16, v209
v_and_b32 v31, 0xffff0000, v209
v_lshlrev_b32 v32, 16, v210
v_and_b32 v33, 0xffff0000, v210
v_lshlrev_b32 v34, 16, v211
v_and_b32 v35, 0xffff0000, v211
v_pk_add_f32 v[96:97], v[96:97], v[28:29]
v_pk_add_f32 v[98:99], v[98:99], v[30:31]
v_pk_add_f32 v[100:101], v[100:101], v[32:33]
v_pk_add_f32 v[102:103], v[102:103], v[34:35]
v_pk_mul_f32 v[28:29], v[96:97], v[246:247]
v_pk_mul_f32 v[30:31], v[98:99], v[246:247]
v_pk_mul_f32 v[32:33], v[100:101], v[246:247]
v_pk_mul_f32 v[34:35], v[102:103], v[246:247]
v_exp_f32 v28, v28
v_exp_f32 v29, v29
v_exp_f32 v30, v30
v_exp_f32 v31, v31
v_exp_f32 v32, v32
v_exp_f32 v33, v33
v_exp_f32 v34, v34
v_exp_f32 v35, v35
v_pk_add_f32 v[28:29], v[28:29], v[244:245]
v_pk_add_f32 v[30:31], v[30:31], v[244:245]
v_pk_add_f32 v[32:33], v[32:33], v[244:245]
v_pk_add_f32 v[34:35], v[34:35], v[244:245]
v_rcp_f32 v28, v28
v_rcp_f32 v29, v29
v_rcp_f32 v30, v30
v_rcp_f32 v31, v31
v_rcp_f32 v32, v32
v_rcp_f32 v33, v33
v_rcp_f32 v34, v34
v_rcp_f32 v35, v35
v_pk_mul_f32 v[96:97], v[28:29], v[96:97]
v_pk_mul_f32 v[98:99], v[30:31], v[98:99]
v_pk_mul_f32 v[100:101], v[32:33], v[100:101]
v_pk_mul_f32 v[102:103], v[34:35], v[102:103]
v_cvt_pk_bf16_f32 v36, v96, v97
v_cvt_pk_bf16_f32 v37, v98, v99
v_cvt_pk_bf16_f32 v38, v100, v101
v_cvt_pk_bf16_f32 v39, v102, v103
buffer_store_dwordx4 v[36:39], v251, s[4:7], s53 offen offset:0 sc1
v_lshlrev_b32 v48, 16, v212
v_and_b32 v49, 0xffff0000, v212
v_lshlrev_b32 v50, 16, v213
v_and_b32 v51, 0xffff0000, v213
v_lshlrev_b32 v52, 16, v214
v_and_b32 v53, 0xffff0000, v214
v_lshlrev_b32 v54, 16, v215
v_and_b32 v55, 0xffff0000, v215
v_pk_add_f32 v[104:105], v[104:105], v[48:49]
v_pk_add_f32 v[106:107], v[106:107], v[50:51]
v_pk_add_f32 v[108:109], v[108:109], v[52:53]
v_pk_add_f32 v[110:111], v[110:111], v[54:55]
v_pk_mul_f32 v[48:49], v[104:105], v[246:247]
v_pk_mul_f32 v[50:51], v[106:107], v[246:247]
v_pk_mul_f32 v[52:53], v[108:109], v[246:247]
v_pk_mul_f32 v[54:55], v[110:111], v[246:247]
v_exp_f32 v48, v48
v_exp_f32 v49, v49
v_exp_f32 v50, v50
v_exp_f32 v51, v51
v_exp_f32 v52, v52
v_exp_f32 v53, v53
v_exp_f32 v54, v54
v_exp_f32 v55, v55
v_pk_add_f32 v[48:49], v[48:49], v[244:245]
v_pk_add_f32 v[50:51], v[50:51], v[244:245]
v_pk_add_f32 v[52:53], v[52:53], v[244:245]
v_pk_add_f32 v[54:55], v[54:55], v[244:245]
v_rcp_f32 v48, v48
v_rcp_f32 v49, v49
v_rcp_f32 v50, v50
v_rcp_f32 v51, v51
v_rcp_f32 v52, v52
v_rcp_f32 v53, v53
v_rcp_f32 v54, v54
v_rcp_f32 v55, v55
v_pk_mul_f32 v[104:105], v[48:49], v[104:105]
v_pk_mul_f32 v[106:107], v[50:51], v[106:107]
v_pk_mul_f32 v[108:109], v[52:53], v[108:109]
v_pk_mul_f32 v[110:111], v[54:55], v[110:111]
v_cvt_pk_bf16_f32 v56, v104, v105
v_cvt_pk_bf16_f32 v57, v106, v107
v_cvt_pk_bf16_f32 v58, v108, v109
v_cvt_pk_bf16_f32 v59, v110, v111
buffer_store_dwordx4 v[56:59], v251, s[4:7], s53 offen offset:1024 sc1
s_add_u32 s53, s53, s2
v_lshlrev_b32 v8, 16, v216
v_and_b32 v9, 0xffff0000, v216
v_lshlrev_b32 v10, 16, v217
v_and_b32 v11, 0xffff0000, v217
v_lshlrev_b32 v12, 16, v218
v_and_b32 v13, 0xffff0000, v218
v_lshlrev_b32 v14, 16, v219
v_and_b32 v15, 0xffff0000, v219
v_pk_add_f32 v[112:113], v[112:113], v[8:9]
v_pk_add_f32 v[114:115], v[114:115], v[10:11]
v_pk_add_f32 v[116:117], v[116:117], v[12:13]
v_pk_add_f32 v[118:119], v[118:119], v[14:15]
v_pk_mul_f32 v[8:9], v[112:113], v[246:247]
v_pk_mul_f32 v[10:11], v[114:115], v[246:247]
v_pk_mul_f32 v[12:13], v[116:117], v[246:247]
v_pk_mul_f32 v[14:15], v[118:119], v[246:247]
v_exp_f32 v8, v8
v_exp_f32 v9, v9
v_exp_f32 v10, v10
v_exp_f32 v11, v11
v_exp_f32 v12, v12
v_exp_f32 v13, v13
v_exp_f32 v14, v14
v_exp_f32 v15, v15
v_pk_add_f32 v[8:9], v[8:9], v[244:245]
v_pk_add_f32 v[10:11], v[10:11], v[244:245]
v_pk_add_f32 v[12:13], v[12:13], v[244:245]
v_pk_add_f32 v[14:15], v[14:15], v[244:245]
v_rcp_f32 v8, v8
v_rcp_f32 v9, v9
v_rcp_f32 v10, v10
v_rcp_f32 v11, v11
v_rcp_f32 v12, v12
v_rcp_f32 v13, v13
v_rcp_f32 v14, v14
v_rcp_f32 v15, v15
v_pk_mul_f32 v[112:113], v[8:9], v[112:113]
v_pk_mul_f32 v[114:115], v[10:11], v[114:115]
v_pk_mul_f32 v[116:117], v[12:13], v[116:117]
v_pk_mul_f32 v[118:119], v[14:15], v[118:119]
v_cvt_pk_bf16_f32 v16, v112, v113
v_cvt_pk_bf16_f32 v17, v114, v115
v_cvt_pk_bf16_f32 v18, v116, v117
v_cvt_pk_bf16_f32 v19, v118, v119
buffer_store_dwordx4 v[16:19], v251, s[4:7], s53 offen offset:0 sc1
v_lshlrev_b32 v28, 16, v220
v_and_b32 v29, 0xffff0000, v220
v_lshlrev_b32 v30, 16, v221
v_and_b32 v31, 0xffff0000, v221
v_lshlrev_b32 v32, 16, v222
v_and_b32 v33, 0xffff0000, v222
v_lshlrev_b32 v34, 16, v223
v_and_b32 v35, 0xffff0000, v223
v_pk_add_f32 v[120:121], v[120:121], v[28:29]
v_pk_add_f32 v[122:123], v[122:123], v[30:31]
v_pk_add_f32 v[124:125], v[124:125], v[32:33]
v_pk_add_f32 v[126:127], v[126:127], v[34:35]
v_pk_mul_f32 v[28:29], v[120:121], v[246:247]
v_pk_mul_f32 v[30:31], v[122:123], v[246:247]
v_pk_mul_f32 v[32:33], v[124:125], v[246:247]
v_pk_mul_f32 v[34:35], v[126:127], v[246:247]
v_exp_f32 v28, v28
v_exp_f32 v29, v29
v_exp_f32 v30, v30
v_exp_f32 v31, v31
v_exp_f32 v32, v32
v_exp_f32 v33, v33
v_exp_f32 v34, v34
v_exp_f32 v35, v35
v_pk_add_f32 v[28:29], v[28:29], v[244:245]
v_pk_add_f32 v[30:31], v[30:31], v[244:245]
v_pk_add_f32 v[32:33], v[32:33], v[244:245]
v_pk_add_f32 v[34:35], v[34:35], v[244:245]
v_rcp_f32 v28, v28
v_rcp_f32 v29, v29
v_rcp_f32 v30, v30
v_rcp_f32 v31, v31
v_rcp_f32 v32, v32
v_rcp_f32 v33, v33
v_rcp_f32 v34, v34
v_rcp_f32 v35, v35
v_pk_mul_f32 v[120:121], v[28:29], v[120:121]
v_pk_mul_f32 v[122:123], v[30:31], v[122:123]
v_pk_mul_f32 v[124:125], v[32:33], v[124:125]
v_pk_mul_f32 v[126:127], v[34:35], v[126:127]
v_cvt_pk_bf16_f32 v36, v120, v121
v_cvt_pk_bf16_f32 v37, v122, v123
v_cvt_pk_bf16_f32 v38, v124, v125
v_cvt_pk_bf16_f32 v39, v126, v127
buffer_store_dwordx4 v[36:39], v251, s[4:7], s53 offen offset:1024 sc1
s_branch main_kernel_w_ee
main_kernel_w_e5:
s_mov_b32 s53, s1
v_permlane16_swap_b32 v160, v162
v_permlane16_swap_b32 v161, v163
v_lshlrev_b32 v8, 16, v192
v_and_b32 v9, 0xffff0000, v192
v_lshlrev_b32 v10, 16, v193
v_and_b32 v11, 0xffff0000, v193
v_lshlrev_b32 v12, 16, v194
v_and_b32 v13, 0xffff0000, v194
v_lshlrev_b32 v14, 16, v195
v_and_b32 v15, 0xffff0000, v195
v_permlane32_swap_b32 v160, v162
v_permlane32_swap_b32 v161, v163
v_lshlrev_b32 v16, 16, v160
v_and_b32 v17, 0xffff0000, v160
v_lshlrev_b32 v18, 16, v161
v_and_b32 v19, 0xffff0000, v161
v_lshlrev_b32 v20, 16, v162
v_and_b32 v21, 0xffff0000, v162
v_lshlrev_b32 v22, 16, v163
v_and_b32 v23, 0xffff0000, v163
v_pk_fma_f32 v[8:9], v[64:65], v[8:9], v[16:17]
v_pk_fma_f32 v[10:11], v[66:67], v[10:11], v[18:19]
v_pk_fma_f32 v[12:13], v[68:69], v[12:13], v[20:21]
v_pk_fma_f32 v[14:15], v[70:71], v[14:15], v[22:23]
v_cvt_pk_bf16_f32 v24, v8, v9
v_cvt_pk_bf16_f32 v25, v10, v11
v_cvt_pk_bf16_f32 v26, v12, v13
v_cvt_pk_bf16_f32 v27, v14, v15
s_nop 0
v_permlane32_swap_b32 v24, v26
v_permlane32_swap_b32 v25, v27
s_nop 0
v_permlane16_swap_b32 v24, v26
v_permlane16_swap_b32 v25, v27
buffer_store_dwordx4 v[24:27], v145, s[92:95], s53 offen offset:0
v_permlane16_swap_b32 v164, v166
v_permlane16_swap_b32 v165, v167
v_lshlrev_b32 v36, 16, v196
v_and_b32 v37, 0xffff0000, v196
v_lshlrev_b32 v38, 16, v197
v_and_b32 v39, 0xffff0000, v197
v_lshlrev_b32 v40, 16, v198
v_and_b32 v41, 0xffff0000, v198
v_lshlrev_b32 v42, 16, v199
v_and_b32 v43, 0xffff0000, v199
v_permlane32_swap_b32 v164, v166
v_permlane32_swap_b32 v165, v167
v_lshlrev_b32 v44, 16, v164
v_and_b32 v45, 0xffff0000, v164
v_lshlrev_b32 v46, 16, v165
v_and_b32 v47, 0xffff0000, v165
v_lshlrev_b32 v48, 16, v166
v_and_b32 v49, 0xffff0000, v166
v_lshlrev_b32 v50, 16, v167
v_and_b32 v51, 0xffff0000, v167
v_pk_fma_f32 v[36:37], v[72:73], v[36:37], v[44:45]
v_pk_fma_f32 v[38:39], v[74:75], v[38:39], v[46:47]
v_pk_fma_f32 v[40:41], v[76:77], v[40:41], v[48:49]
v_pk_fma_f32 v[42:43], v[78:79], v[42:43], v[50:51]
v_cvt_pk_bf16_f32 v52, v36, v37
v_cvt_pk_bf16_f32 v53, v38, v39
v_cvt_pk_bf16_f32 v54, v40, v41
v_cvt_pk_bf16_f32 v55, v42, v43
s_nop 0
v_permlane32_swap_b32 v52, v54
v_permlane32_swap_b32 v53, v55
s_nop 0
v_permlane16_swap_b32 v52, v54
v_permlane16_swap_b32 v53, v55
buffer_store_dwordx4 v[52:55], v145, s[92:95], s53 offen offset:64
s_add_u32 s53, s53, 32768
v_permlane16_swap_b32 v168, v170
v_permlane16_swap_b32 v169, v171
v_lshlrev_b32 v8, 16, v200
v_and_b32 v9, 0xffff0000, v200
v_lshlrev_b32 v10, 16, v201
v_and_b32 v11, 0xffff0000, v201
v_lshlrev_b32 v12, 16, v202
v_and_b32 v13, 0xffff0000, v202
v_lshlrev_b32 v14, 16, v203
v_and_b32 v15, 0xffff0000, v203
v_permlane32_swap_b32 v168, v170
v_permlane32_swap_b32 v169, v171
v_lshlrev_b32 v16, 16, v168
v_and_b32 v17, 0xffff0000, v168
v_lshlrev_b32 v18, 16, v169
v_and_b32 v19, 0xffff0000, v169
v_lshlrev_b32 v20, 16, v170
v_and_b32 v21, 0xffff0000, v170
v_lshlrev_b32 v22, 16, v171
v_and_b32 v23, 0xffff0000, v171
v_pk_fma_f32 v[8:9], v[80:81], v[8:9], v[16:17]
v_pk_fma_f32 v[10:11], v[82:83], v[10:11], v[18:19]
v_pk_fma_f32 v[12:13], v[84:85], v[12:13], v[20:21]
v_pk_fma_f32 v[14:15], v[86:87], v[14:15], v[22:23]
v_cvt_pk_bf16_f32 v24, v8, v9
v_cvt_pk_bf16_f32 v25, v10, v11
v_cvt_pk_bf16_f32 v26, v12, v13
v_cvt_pk_bf16_f32 v27, v14, v15
s_nop 0
v_permlane32_swap_b32 v24, v26
v_permlane32_swap_b32 v25, v27
s_nop 0
v_permlane16_swap_b32 v24, v26
v_permlane16_swap_b32 v25, v27
buffer_store_dwordx4 v[24:27], v145, s[92:95], s53 offen offset:0
v_permlane16_swap_b32 v172, v174
v_permlane16_swap_b32 v173, v175
v_lshlrev_b32 v36, 16, v204
v_and_b32 v37, 0xffff0000, v204
v_lshlrev_b32 v38, 16, v205
v_and_b32 v39, 0xffff0000, v205
v_lshlrev_b32 v40, 16, v206
v_and_b32 v41, 0xffff0000, v206
v_lshlrev_b32 v42, 16, v207
v_and_b32 v43, 0xffff0000, v207
v_permlane32_swap_b32 v172, v174
v_permlane32_swap_b32 v173, v175
v_lshlrev_b32 v44, 16, v172
v_and_b32 v45, 0xffff0000, v172
v_lshlrev_b32 v46, 16, v173
v_and_b32 v47, 0xffff0000, v173
v_lshlrev_b32 v48, 16, v174
v_and_b32 v49, 0xffff0000, v174
v_lshlrev_b32 v50, 16, v175
v_and_b32 v51, 0xffff0000, v175
v_pk_fma_f32 v[36:37], v[88:89], v[36:37], v[44:45]
v_pk_fma_f32 v[38:39], v[90:91], v[38:39], v[46:47]
v_pk_fma_f32 v[40:41], v[92:93], v[40:41], v[48:49]
v_pk_fma_f32 v[42:43], v[94:95], v[42:43], v[50:51]
v_cvt_pk_bf16_f32 v52, v36, v37
v_cvt_pk_bf16_f32 v53, v38, v39
v_cvt_pk_bf16_f32 v54, v40, v41
v_cvt_pk_bf16_f32 v55, v42, v43
s_nop 0
v_permlane32_swap_b32 v52, v54
v_permlane32_swap_b32 v53, v55
s_nop 0
v_permlane16_swap_b32 v52, v54
v_permlane16_swap_b32 v53, v55
buffer_store_dwordx4 v[52:55], v145, s[92:95], s53 offen offset:64
s_add_u32 s53, s53, 32768
v_permlane16_swap_b32 v176, v178
v_permlane16_swap_b32 v177, v179
v_lshlrev_b32 v8, 16, v208
v_and_b32 v9, 0xffff0000, v208
v_lshlrev_b32 v10, 16, v209
v_and_b32 v11, 0xffff0000, v209
v_lshlrev_b32 v12, 16, v210
v_and_b32 v13, 0xffff0000, v210
v_lshlrev_b32 v14, 16, v211
v_and_b32 v15, 0xffff0000, v211
v_permlane32_swap_b32 v176, v178
v_permlane32_swap_b32 v177, v179
v_lshlrev_b32 v16, 16, v176
v_and_b32 v17, 0xffff0000, v176
v_lshlrev_b32 v18, 16, v177
v_and_b32 v19, 0xffff0000, v177
v_lshlrev_b32 v20, 16, v178
v_and_b32 v21, 0xffff0000, v178
v_lshlrev_b32 v22, 16, v179
v_and_b32 v23, 0xffff0000, v179
v_pk_fma_f32 v[8:9], v[96:97], v[8:9], v[16:17]
v_pk_fma_f32 v[10:11], v[98:99], v[10:11], v[18:19]
v_pk_fma_f32 v[12:13], v[100:101], v[12:13], v[20:21]
v_pk_fma_f32 v[14:15], v[102:103], v[14:15], v[22:23]
v_cvt_pk_bf16_f32 v24, v8, v9
v_cvt_pk_bf16_f32 v25, v10, v11
v_cvt_pk_bf16_f32 v26, v12, v13
v_cvt_pk_bf16_f32 v27, v14, v15
s_nop 0
v_permlane32_swap_b32 v24, v26
v_permlane32_swap_b32 v25, v27
s_nop 0
v_permlane16_swap_b32 v24, v26
v_permlane16_swap_b32 v25, v27
buffer_store_dwordx4 v[24:27], v145, s[92:95], s53 offen offset:0
v_permlane16_swap_b32 v180, v182
v_permlane16_swap_b32 v181, v183
v_lshlrev_b32 v36, 16, v212
v_and_b32 v37, 0xffff0000, v212
v_lshlrev_b32 v38, 16, v213
v_and_b32 v39, 0xffff0000, v213
v_lshlrev_b32 v40, 16, v214
v_and_b32 v41, 0xffff0000, v214
v_lshlrev_b32 v42, 16, v215
v_and_b32 v43, 0xffff0000, v215
v_permlane32_swap_b32 v180, v182
v_permlane32_swap_b32 v181, v183
v_lshlrev_b32 v44, 16, v180
v_and_b32 v45, 0xffff0000, v180
v_lshlrev_b32 v46, 16, v181
v_and_b32 v47, 0xffff0000, v181
v_lshlrev_b32 v48, 16, v182
v_and_b32 v49, 0xffff0000, v182
v_lshlrev_b32 v50, 16, v183
v_and_b32 v51, 0xffff0000, v183
v_pk_fma_f32 v[36:37], v[104:105], v[36:37], v[44:45]
v_pk_fma_f32 v[38:39], v[106:107], v[38:39], v[46:47]
v_pk_fma_f32 v[40:41], v[108:109], v[40:41], v[48:49]
v_pk_fma_f32 v[42:43], v[110:111], v[42:43], v[50:51]
v_cvt_pk_bf16_f32 v52, v36, v37
v_cvt_pk_bf16_f32 v53, v38, v39
v_cvt_pk_bf16_f32 v54, v40, v41
v_cvt_pk_bf16_f32 v55, v42, v43
s_nop 0
v_permlane32_swap_b32 v52, v54
v_permlane32_swap_b32 v53, v55
s_nop 0
v_permlane16_swap_b32 v52, v54
v_permlane16_swap_b32 v53, v55
buffer_store_dwordx4 v[52:55], v145, s[92:95], s53 offen offset:64
s_add_u32 s53, s53, 32768
v_permlane16_swap_b32 v184, v186
v_permlane16_swap_b32 v185, v187
v_lshlrev_b32 v8, 16, v216
v_and_b32 v9, 0xffff0000, v216
v_lshlrev_b32 v10, 16, v217
v_and_b32 v11, 0xffff0000, v217
v_lshlrev_b32 v12, 16, v218
v_and_b32 v13, 0xffff0000, v218
v_lshlrev_b32 v14, 16, v219
v_and_b32 v15, 0xffff0000, v219
v_permlane32_swap_b32 v184, v186
v_permlane32_swap_b32 v185, v187
v_lshlrev_b32 v16, 16, v184
v_and_b32 v17, 0xffff0000, v184
v_lshlrev_b32 v18, 16, v185
v_and_b32 v19, 0xffff0000, v185
v_lshlrev_b32 v20, 16, v186
v_and_b32 v21, 0xffff0000, v186
v_lshlrev_b32 v22, 16, v187
v_and_b32 v23, 0xffff0000, v187
v_pk_fma_f32 v[8:9], v[112:113], v[8:9], v[16:17]
v_pk_fma_f32 v[10:11], v[114:115], v[10:11], v[18:19]
v_pk_fma_f32 v[12:13], v[116:117], v[12:13], v[20:21]
v_pk_fma_f32 v[14:15], v[118:119], v[14:15], v[22:23]
v_cvt_pk_bf16_f32 v24, v8, v9
v_cvt_pk_bf16_f32 v25, v10, v11
v_cvt_pk_bf16_f32 v26, v12, v13
v_cvt_pk_bf16_f32 v27, v14, v15
s_nop 0
v_permlane32_swap_b32 v24, v26
v_permlane32_swap_b32 v25, v27
s_nop 0
v_permlane16_swap_b32 v24, v26
v_permlane16_swap_b32 v25, v27
buffer_store_dwordx4 v[24:27], v145, s[92:95], s53 offen offset:0
v_permlane16_swap_b32 v188, v190
v_permlane16_swap_b32 v189, v191
v_lshlrev_b32 v36, 16, v220
v_and_b32 v37, 0xffff0000, v220
v_lshlrev_b32 v38, 16, v221
v_and_b32 v39, 0xffff0000, v221
v_lshlrev_b32 v40, 16, v222
v_and_b32 v41, 0xffff0000, v222
v_lshlrev_b32 v42, 16, v223
v_and_b32 v43, 0xffff0000, v223
v_permlane32_swap_b32 v188, v190
v_permlane32_swap_b32 v189, v191
v_lshlrev_b32 v44, 16, v188
v_and_b32 v45, 0xffff0000, v188
v_lshlrev_b32 v46, 16, v189
v_and_b32 v47, 0xffff0000, v189
v_lshlrev_b32 v48, 16, v190
v_and_b32 v49, 0xffff0000, v190
v_lshlrev_b32 v50, 16, v191
v_and_b32 v51, 0xffff0000, v191
v_pk_fma_f32 v[36:37], v[120:121], v[36:37], v[44:45]
v_pk_fma_f32 v[38:39], v[122:123], v[38:39], v[46:47]
v_pk_fma_f32 v[40:41], v[124:125], v[40:41], v[48:49]
v_pk_fma_f32 v[42:43], v[126:127], v[42:43], v[50:51]
v_cvt_pk_bf16_f32 v52, v36, v37
v_cvt_pk_bf16_f32 v53, v38, v39
v_cvt_pk_bf16_f32 v54, v40, v41
v_cvt_pk_bf16_f32 v55, v42, v43
s_nop 0
v_permlane32_swap_b32 v52, v54
v_permlane32_swap_b32 v53, v55
s_nop 0
v_permlane16_swap_b32 v52, v54
v_permlane16_swap_b32 v53, v55
buffer_store_dwordx4 v[52:55], v145, s[92:95], s53 offen offset:64
s_branch main_kernel_w_ee
main_kernel_w_e6:
s_mov_b32 s53, s1
v_accvgpr_read_b32 v0, a0
v_accvgpr_read_b32 v1, a1
v_accvgpr_read_b32 v2, a2
v_accvgpr_read_b32 v3, a3
v_accvgpr_read_b32 v4, a4
v_accvgpr_read_b32 v5, a5
v_accvgpr_read_b32 v6, a6
v_accvgpr_read_b32 v7, a7
v_cvt_pk_bf16_f32 v16, v0, v1
v_cvt_pk_bf16_f32 v17, v2, v3
v_cvt_pk_bf16_f32 v18, v4, v5
v_cvt_pk_bf16_f32 v19, v6, v7
buffer_store_dwordx4 v[16:19], v251, s[4:7], s53 offen offset:0 sc1
v_accvgpr_read_b32 v20, a8
v_accvgpr_read_b32 v21, a9
v_accvgpr_read_b32 v22, a10
v_accvgpr_read_b32 v23, a11
v_accvgpr_read_b32 v24, a12
v_accvgpr_read_b32 v25, a13
v_accvgpr_read_b32 v26, a14
v_accvgpr_read_b32 v27, a15
v_cvt_pk_bf16_f32 v36, v20, v21
v_cvt_pk_bf16_f32 v37, v22, v23
v_cvt_pk_bf16_f32 v38, v24, v25
v_cvt_pk_bf16_f32 v39, v26, v27
buffer_store_dwordx4 v[36:39], v251, s[4:7], s53 offen offset:1024 sc1
v_accvgpr_read_b32 v40, a16
v_accvgpr_read_b32 v41, a17
v_accvgpr_read_b32 v42, a18
v_accvgpr_read_b32 v43, a19
v_accvgpr_read_b32 v44, a20
v_accvgpr_read_b32 v45, a21
v_accvgpr_read_b32 v46, a22
v_accvgpr_read_b32 v47, a23
v_cvt_pk_bf16_f32 v56, v40, v41
v_cvt_pk_bf16_f32 v57, v42, v43
v_cvt_pk_bf16_f32 v58, v44, v45
v_cvt_pk_bf16_f32 v59, v46, v47
buffer_store_dwordx4 v[56:59], v251, s[4:7], s53 offen offset:2048 sc1
v_accvgpr_read_b32 v0, a24
v_accvgpr_read_b32 v1, a25
v_accvgpr_read_b32 v2, a26
v_accvgpr_read_b32 v3, a27
v_accvgpr_read_b32 v4, a28
v_accvgpr_read_b32 v5, a29
v_accvgpr_read_b32 v6, a30
v_accvgpr_read_b32 v7, a31
v_cvt_pk_bf16_f32 v16, v0, v1
v_cvt_pk_bf16_f32 v17, v2, v3
v_cvt_pk_bf16_f32 v18, v4, v5
v_cvt_pk_bf16_f32 v19, v6, v7
buffer_store_dwordx4 v[16:19], v251, s[4:7], s53 offen offset:3072 sc1
s_add_u32 s53, s53, s2
v_accvgpr_read_b32 v20, a32
v_accvgpr_read_b32 v21, a33
v_accvgpr_read_b32 v22, a34
v_accvgpr_read_b32 v23, a35
v_accvgpr_read_b32 v24, a36
v_accvgpr_read_b32 v25, a37
v_accvgpr_read_b32 v26, a38
v_accvgpr_read_b32 v27, a39
v_cvt_pk_bf16_f32 v36, v20, v21
v_cvt_pk_bf16_f32 v37, v22, v23
v_cvt_pk_bf16_f32 v38, v24, v25
v_cvt_pk_bf16_f32 v39, v26, v27
buffer_store_dwordx4 v[36:39], v251, s[4:7], s53 offen offset:0 sc1
v_accvgpr_read_b32 v40, a40
v_accvgpr_read_b32 v41, a41
v_accvgpr_read_b32 v42, a42
v_accvgpr_read_b32 v43, a43
v_accvgpr_read_b32 v44, a44
v_accvgpr_read_b32 v45, a45
v_accvgpr_read_b32 v46, a46
v_accvgpr_read_b32 v47, a47
v_cvt_pk_bf16_f32 v56, v40, v41
v_cvt_pk_bf16_f32 v57, v42, v43
v_cvt_pk_bf16_f32 v58, v44, v45
v_cvt_pk_bf16_f32 v59, v46, v47
buffer_store_dwordx4 v[56:59], v251, s[4:7], s53 offen offset:1024 sc1
v_accvgpr_read_b32 v0, a48
v_accvgpr_read_b32 v1, a49
v_accvgpr_read_b32 v2, a50
v_accvgpr_read_b32 v3, a51
v_accvgpr_read_b32 v4, a52
v_accvgpr_read_b32 v5, a53
v_accvgpr_read_b32 v6, a54
v_accvgpr_read_b32 v7, a55
v_cvt_pk_bf16_f32 v16, v0, v1
v_cvt_pk_bf16_f32 v17, v2, v3
v_cvt_pk_bf16_f32 v18, v4, v5
v_cvt_pk_bf16_f32 v19, v6, v7
buffer_store_dwordx4 v[16:19], v251, s[4:7], s53 offen offset:2048 sc1
v_accvgpr_read_b32 v20, a56
v_accvgpr_read_b32 v21, a57
v_accvgpr_read_b32 v22, a58
v_accvgpr_read_b32 v23, a59
v_accvgpr_read_b32 v24, a60
v_accvgpr_read_b32 v25, a61
v_accvgpr_read_b32 v26, a62
v_accvgpr_read_b32 v27, a63
v_cvt_pk_bf16_f32 v36, v20, v21
v_cvt_pk_bf16_f32 v37, v22, v23
v_cvt_pk_bf16_f32 v38, v24, v25
v_cvt_pk_bf16_f32 v39, v26, v27
buffer_store_dwordx4 v[36:39], v251, s[4:7], s53 offen offset:3072 sc1
s_add_u32 s53, s53, s2
v_accvgpr_read_b32 v40, a64
v_accvgpr_read_b32 v41, a65
v_accvgpr_read_b32 v42, a66
v_accvgpr_read_b32 v43, a67
v_accvgpr_read_b32 v44, a68
v_accvgpr_read_b32 v45, a69
v_accvgpr_read_b32 v46, a70
v_accvgpr_read_b32 v47, a71
v_cvt_pk_bf16_f32 v56, v40, v41
v_cvt_pk_bf16_f32 v57, v42, v43
v_cvt_pk_bf16_f32 v58, v44, v45
v_cvt_pk_bf16_f32 v59, v46, v47
buffer_store_dwordx4 v[56:59], v251, s[4:7], s53 offen offset:0 sc1
v_accvgpr_read_b32 v0, a72
v_accvgpr_read_b32 v1, a73
v_accvgpr_read_b32 v2, a74
v_accvgpr_read_b32 v3, a75
v_accvgpr_read_b32 v4, a76
v_accvgpr_read_b32 v5, a77
v_accvgpr_read_b32 v6, a78
v_accvgpr_read_b32 v7, a79
v_cvt_pk_bf16_f32 v16, v0, v1
v_cvt_pk_bf16_f32 v17, v2, v3
v_cvt_pk_bf16_f32 v18, v4, v5
v_cvt_pk_bf16_f32 v19, v6, v7
buffer_store_dwordx4 v[16:19], v251, s[4:7], s53 offen offset:1024 sc1
v_accvgpr_read_b32 v20, a80
v_accvgpr_read_b32 v21, a81
v_accvgpr_read_b32 v22, a82
v_accvgpr_read_b32 v23, a83
v_accvgpr_read_b32 v24, a84
v_accvgpr_read_b32 v25, a85
v_accvgpr_read_b32 v26, a86
v_accvgpr_read_b32 v27, a87
v_cvt_pk_bf16_f32 v36, v20, v21
v_cvt_pk_bf16_f32 v37, v22, v23
v_cvt_pk_bf16_f32 v38, v24, v25
v_cvt_pk_bf16_f32 v39, v26, v27
buffer_store_dwordx4 v[36:39], v251, s[4:7], s53 offen offset:2048 sc1
v_accvgpr_read_b32 v40, a88
v_accvgpr_read_b32 v41, a89
v_accvgpr_read_b32 v42, a90
v_accvgpr_read_b32 v43, a91
v_accvgpr_read_b32 v44, a92
v_accvgpr_read_b32 v45, a93
v_accvgpr_read_b32 v46, a94
v_accvgpr_read_b32 v47, a95
v_cvt_pk_bf16_f32 v56, v40, v41
v_cvt_pk_bf16_f32 v57, v42, v43
v_cvt_pk_bf16_f32 v58, v44, v45
v_cvt_pk_bf16_f32 v59, v46, v47
buffer_store_dwordx4 v[56:59], v251, s[4:7], s53 offen offset:3072 sc1
s_add_u32 s53, s53, s2
v_accvgpr_read_b32 v0, a96
v_accvgpr_read_b32 v1, a97
v_accvgpr_read_b32 v2, a98
v_accvgpr_read_b32 v3, a99
v_accvgpr_read_b32 v4, a100
v_accvgpr_read_b32 v5, a101
v_accvgpr_read_b32 v6, a102
v_accvgpr_read_b32 v7, a103
v_cvt_pk_bf16_f32 v16, v0, v1
v_cvt_pk_bf16_f32 v17, v2, v3
v_cvt_pk_bf16_f32 v18, v4, v5
v_cvt_pk_bf16_f32 v19, v6, v7
buffer_store_dwordx4 v[16:19], v251, s[4:7], s53 offen offset:0 sc1
v_accvgpr_read_b32 v20, a104
v_accvgpr_read_b32 v21, a105
v_accvgpr_read_b32 v22, a106
v_accvgpr_read_b32 v23, a107
v_accvgpr_read_b32 v24, a108
v_accvgpr_read_b32 v25, a109
v_accvgpr_read_b32 v26, a110
v_accvgpr_read_b32 v27, a111
v_cvt_pk_bf16_f32 v36, v20, v21
v_cvt_pk_bf16_f32 v37, v22, v23
v_cvt_pk_bf16_f32 v38, v24, v25
v_cvt_pk_bf16_f32 v39, v26, v27
buffer_store_dwordx4 v[36:39], v251, s[4:7], s53 offen offset:1024 sc1
v_accvgpr_read_b32 v40, a112
v_accvgpr_read_b32 v41, a113
v_accvgpr_read_b32 v42, a114
v_accvgpr_read_b32 v43, a115
v_accvgpr_read_b32 v44, a116
v_accvgpr_read_b32 v45, a117
v_accvgpr_read_b32 v46, a118
v_accvgpr_read_b32 v47, a119
v_cvt_pk_bf16_f32 v56, v40, v41
v_cvt_pk_bf16_f32 v57, v42, v43
v_cvt_pk_bf16_f32 v58, v44, v45
v_cvt_pk_bf16_f32 v59, v46, v47
buffer_store_dwordx4 v[56:59], v251, s[4:7], s53 offen offset:2048 sc1
v_accvgpr_read_b32 v0, a120
v_accvgpr_read_b32 v1, a121
v_accvgpr_read_b32 v2, a122
v_accvgpr_read_b32 v3, a123
v_accvgpr_read_b32 v4, a124
v_accvgpr_read_b32 v5, a125
v_accvgpr_read_b32 v6, a126
v_accvgpr_read_b32 v7, a127
v_cvt_pk_bf16_f32 v16, v0, v1
v_cvt_pk_bf16_f32 v17, v2, v3
v_cvt_pk_bf16_f32 v18, v4, v5
v_cvt_pk_bf16_f32 v19, v6, v7
buffer_store_dwordx4 v[16:19], v251, s[4:7], s53 offen offset:3072 sc1
s_branch main_kernel_w_ee
main_kernel_w_e7:
s_mov_b32 s53, s1
v_accvgpr_read_b32 v0, a0
v_accvgpr_read_b32 v1, a1
v_accvgpr_read_b32 v2, a2
v_accvgpr_read_b32 v3, a3
v_accvgpr_read_b32 v4, a4
v_accvgpr_read_b32 v5, a5
v_accvgpr_read_b32 v6, a6
v_accvgpr_read_b32 v7, a7
v_mul_f32 v0, 0x3e0293ee, v0
v_mul_f32 v1, 0x3e0293ee, v1
v_mul_f32 v2, 0x3e0293ee, v2
v_mul_f32 v3, 0x3e0293ee, v3
v_mul_f32 v4, 0x3e0293ee, v4
v_mul_f32 v5, 0x3e0293ee, v5
v_mul_f32 v6, 0x3e0293ee, v6
v_mul_f32 v7, 0x3e0293ee, v7
v_cvt_pk_bf16_f32 v16, v0, v1
v_cvt_pk_bf16_f32 v17, v2, v3
v_cvt_pk_bf16_f32 v18, v4, v5
v_cvt_pk_bf16_f32 v19, v6, v7
buffer_store_dwordx4 v[16:19], v251, s[4:7], s53 offen offset:0 sc1
v_accvgpr_read_b32 v20, a8
v_accvgpr_read_b32 v21, a9
v_accvgpr_read_b32 v22, a10
v_accvgpr_read_b32 v23, a11
v_accvgpr_read_b32 v24, a12
v_accvgpr_read_b32 v25, a13
v_accvgpr_read_b32 v26, a14
v_accvgpr_read_b32 v27, a15
v_mul_f32 v20, 0x3e0293ee, v20
v_mul_f32 v21, 0x3e0293ee, v21
v_mul_f32 v22, 0x3e0293ee, v22
v_mul_f32 v23, 0x3e0293ee, v23
v_mul_f32 v24, 0x3e0293ee, v24
v_mul_f32 v25, 0x3e0293ee, v25
v_mul_f32 v26, 0x3e0293ee, v26
v_mul_f32 v27, 0x3e0293ee, v27
v_cvt_pk_bf16_f32 v36, v20, v21
v_cvt_pk_bf16_f32 v37, v22, v23
v_cvt_pk_bf16_f32 v38, v24, v25
v_cvt_pk_bf16_f32 v39, v26, v27
buffer_store_dwordx4 v[36:39], v251, s[4:7], s53 offen offset:1024 sc1
v_accvgpr_read_b32 v40, a16
v_accvgpr_read_b32 v41, a17
v_accvgpr_read_b32 v42, a18
v_accvgpr_read_b32 v43, a19
v_accvgpr_read_b32 v44, a20
v_accvgpr_read_b32 v45, a21
v_accvgpr_read_b32 v46, a22
v_accvgpr_read_b32 v47, a23
v_mul_f32 v40, 0x3e0293ee, v40
v_mul_f32 v41, 0x3e0293ee, v41
v_mul_f32 v42, 0x3e0293ee, v42
v_mul_f32 v43, 0x3e0293ee, v43
v_mul_f32 v44, 0x3e0293ee, v44
v_mul_f32 v45, 0x3e0293ee, v45
v_mul_f32 v46, 0x3e0293ee, v46
v_mul_f32 v47, 0x3e0293ee, v47
v_cvt_pk_bf16_f32 v56, v40, v41
v_cvt_pk_bf16_f32 v57, v42, v43
v_cvt_pk_bf16_f32 v58, v44, v45
v_cvt_pk_bf16_f32 v59, v46, v47
buffer_store_dwordx4 v[56:59], v251, s[4:7], s53 offen offset:2048 sc1
v_accvgpr_read_b32 v0, a24
v_accvgpr_read_b32 v1, a25
v_accvgpr_read_b32 v2, a26
v_accvgpr_read_b32 v3, a27
v_accvgpr_read_b32 v4, a28
v_accvgpr_read_b32 v5, a29
v_accvgpr_read_b32 v6, a30
v_accvgpr_read_b32 v7, a31
v_mul_f32 v0, 0x3e0293ee, v0
v_mul_f32 v1, 0x3e0293ee, v1
v_mul_f32 v2, 0x3e0293ee, v2
v_mul_f32 v3, 0x3e0293ee, v3
v_mul_f32 v4, 0x3e0293ee, v4
v_mul_f32 v5, 0x3e0293ee, v5
v_mul_f32 v6, 0x3e0293ee, v6
v_mul_f32 v7, 0x3e0293ee, v7
v_cvt_pk_bf16_f32 v16, v0, v1
v_cvt_pk_bf16_f32 v17, v2, v3
v_cvt_pk_bf16_f32 v18, v4, v5
v_cvt_pk_bf16_f32 v19, v6, v7
buffer_store_dwordx4 v[16:19], v251, s[4:7], s53 offen offset:3072 sc1
s_add_u32 s53, s53, s2
v_accvgpr_read_b32 v20, a32
v_accvgpr_read_b32 v21, a33
v_accvgpr_read_b32 v22, a34
v_accvgpr_read_b32 v23, a35
v_accvgpr_read_b32 v24, a36
v_accvgpr_read_b32 v25, a37
v_accvgpr_read_b32 v26, a38
v_accvgpr_read_b32 v27, a39
v_mul_f32 v20, 0x3e0293ee, v20
v_mul_f32 v21, 0x3e0293ee, v21
v_mul_f32 v22, 0x3e0293ee, v22
v_mul_f32 v23, 0x3e0293ee, v23
v_mul_f32 v24, 0x3e0293ee, v24
v_mul_f32 v25, 0x3e0293ee, v25
v_mul_f32 v26, 0x3e0293ee, v26
v_mul_f32 v27, 0x3e0293ee, v27
v_cvt_pk_bf16_f32 v36, v20, v21
v_cvt_pk_bf16_f32 v37, v22, v23
v_cvt_pk_bf16_f32 v38, v24, v25
v_cvt_pk_bf16_f32 v39, v26, v27
buffer_store_dwordx4 v[36:39], v251, s[4:7], s53 offen offset:0 sc1
v_accvgpr_read_b32 v40, a40
v_accvgpr_read_b32 v41, a41
v_accvgpr_read_b32 v42, a42
v_accvgpr_read_b32 v43, a43
v_accvgpr_read_b32 v44, a44
v_accvgpr_read_b32 v45, a45
v_accvgpr_read_b32 v46, a46
v_accvgpr_read_b32 v47, a47
v_mul_f32 v40, 0x3e0293ee, v40
v_mul_f32 v41, 0x3e0293ee, v41
v_mul_f32 v42, 0x3e0293ee, v42
v_mul_f32 v43, 0x3e0293ee, v43
v_mul_f32 v44, 0x3e0293ee, v44
v_mul_f32 v45, 0x3e0293ee, v45
v_mul_f32 v46, 0x3e0293ee, v46
v_mul_f32 v47, 0x3e0293ee, v47
v_cvt_pk_bf16_f32 v56, v40, v41
v_cvt_pk_bf16_f32 v57, v42, v43
v_cvt_pk_bf16_f32 v58, v44, v45
v_cvt_pk_bf16_f32 v59, v46, v47
buffer_store_dwordx4 v[56:59], v251, s[4:7], s53 offen offset:1024 sc1
v_accvgpr_read_b32 v0, a48
v_accvgpr_read_b32 v1, a49
v_accvgpr_read_b32 v2, a50
v_accvgpr_read_b32 v3, a51
v_accvgpr_read_b32 v4, a52
v_accvgpr_read_b32 v5, a53
v_accvgpr_read_b32 v6, a54
v_accvgpr_read_b32 v7, a55
v_mul_f32 v0, 0x3e0293ee, v0
v_mul_f32 v1, 0x3e0293ee, v1
v_mul_f32 v2, 0x3e0293ee, v2
v_mul_f32 v3, 0x3e0293ee, v3
v_mul_f32 v4, 0x3e0293ee, v4
v_mul_f32 v5, 0x3e0293ee, v5
v_mul_f32 v6, 0x3e0293ee, v6
v_mul_f32 v7, 0x3e0293ee, v7
v_cvt_pk_bf16_f32 v16, v0, v1
v_cvt_pk_bf16_f32 v17, v2, v3
v_cvt_pk_bf16_f32 v18, v4, v5
v_cvt_pk_bf16_f32 v19, v6, v7
buffer_store_dwordx4 v[16:19], v251, s[4:7], s53 offen offset:2048 sc1
v_accvgpr_read_b32 v20, a56
v_accvgpr_read_b32 v21, a57
v_accvgpr_read_b32 v22, a58
v_accvgpr_read_b32 v23, a59
v_accvgpr_read_b32 v24, a60
v_accvgpr_read_b32 v25, a61
v_accvgpr_read_b32 v26, a62
v_accvgpr_read_b32 v27, a63
v_mul_f32 v20, 0x3e0293ee, v20
v_mul_f32 v21, 0x3e0293ee, v21
v_mul_f32 v22, 0x3e0293ee, v22
v_mul_f32 v23, 0x3e0293ee, v23
v_mul_f32 v24, 0x3e0293ee, v24
v_mul_f32 v25, 0x3e0293ee, v25
v_mul_f32 v26, 0x3e0293ee, v26
v_mul_f32 v27, 0x3e0293ee, v27
v_cvt_pk_bf16_f32 v36, v20, v21
v_cvt_pk_bf16_f32 v37, v22, v23
v_cvt_pk_bf16_f32 v38, v24, v25
v_cvt_pk_bf16_f32 v39, v26, v27
buffer_store_dwordx4 v[36:39], v251, s[4:7], s53 offen offset:3072 sc1
s_add_u32 s53, s53, s2
v_accvgpr_read_b32 v40, a64
v_accvgpr_read_b32 v41, a65
v_accvgpr_read_b32 v42, a66
v_accvgpr_read_b32 v43, a67
v_accvgpr_read_b32 v44, a68
v_accvgpr_read_b32 v45, a69
v_accvgpr_read_b32 v46, a70
v_accvgpr_read_b32 v47, a71
v_mul_f32 v40, 0x3e0293ee, v40
v_mul_f32 v41, 0x3e0293ee, v41
v_mul_f32 v42, 0x3e0293ee, v42
v_mul_f32 v43, 0x3e0293ee, v43
v_mul_f32 v44, 0x3e0293ee, v44
v_mul_f32 v45, 0x3e0293ee, v45
v_mul_f32 v46, 0x3e0293ee, v46
v_mul_f32 v47, 0x3e0293ee, v47
v_cvt_pk_bf16_f32 v56, v40, v41
v_cvt_pk_bf16_f32 v57, v42, v43
v_cvt_pk_bf16_f32 v58, v44, v45
v_cvt_pk_bf16_f32 v59, v46, v47
buffer_store_dwordx4 v[56:59], v251, s[4:7], s53 offen offset:0 sc1
v_accvgpr_read_b32 v0, a72
v_accvgpr_read_b32 v1, a73
v_accvgpr_read_b32 v2, a74
v_accvgpr_read_b32 v3, a75
v_accvgpr_read_b32 v4, a76
v_accvgpr_read_b32 v5, a77
v_accvgpr_read_b32 v6, a78
v_accvgpr_read_b32 v7, a79
v_mul_f32 v0, 0x3e0293ee, v0
v_mul_f32 v1, 0x3e0293ee, v1
v_mul_f32 v2, 0x3e0293ee, v2
v_mul_f32 v3, 0x3e0293ee, v3
v_mul_f32 v4, 0x3e0293ee, v4
v_mul_f32 v5, 0x3e0293ee, v5
v_mul_f32 v6, 0x3e0293ee, v6
v_mul_f32 v7, 0x3e0293ee, v7
v_cvt_pk_bf16_f32 v16, v0, v1
v_cvt_pk_bf16_f32 v17, v2, v3
v_cvt_pk_bf16_f32 v18, v4, v5
v_cvt_pk_bf16_f32 v19, v6, v7
buffer_store_dwordx4 v[16:19], v251, s[4:7], s53 offen offset:1024 sc1
v_accvgpr_read_b32 v20, a80
v_accvgpr_read_b32 v21, a81
v_accvgpr_read_b32 v22, a82
v_accvgpr_read_b32 v23, a83
v_accvgpr_read_b32 v24, a84
v_accvgpr_read_b32 v25, a85
v_accvgpr_read_b32 v26, a86
v_accvgpr_read_b32 v27, a87
v_mul_f32 v20, 0x3e0293ee, v20
v_mul_f32 v21, 0x3e0293ee, v21
v_mul_f32 v22, 0x3e0293ee, v22
v_mul_f32 v23, 0x3e0293ee, v23
v_mul_f32 v24, 0x3e0293ee, v24
v_mul_f32 v25, 0x3e0293ee, v25
v_mul_f32 v26, 0x3e0293ee, v26
v_mul_f32 v27, 0x3e0293ee, v27
v_cvt_pk_bf16_f32 v36, v20, v21
v_cvt_pk_bf16_f32 v37, v22, v23
v_cvt_pk_bf16_f32 v38, v24, v25
v_cvt_pk_bf16_f32 v39, v26, v27
buffer_store_dwordx4 v[36:39], v251, s[4:7], s53 offen offset:2048 sc1
v_accvgpr_read_b32 v40, a88
v_accvgpr_read_b32 v41, a89
v_accvgpr_read_b32 v42, a90
v_accvgpr_read_b32 v43, a91
v_accvgpr_read_b32 v44, a92
v_accvgpr_read_b32 v45, a93
v_accvgpr_read_b32 v46, a94
v_accvgpr_read_b32 v47, a95
v_mul_f32 v40, 0x3e0293ee, v40
v_mul_f32 v41, 0x3e0293ee, v41
v_mul_f32 v42, 0x3e0293ee, v42
v_mul_f32 v43, 0x3e0293ee, v43
v_mul_f32 v44, 0x3e0293ee, v44
v_mul_f32 v45, 0x3e0293ee, v45
v_mul_f32 v46, 0x3e0293ee, v46
v_mul_f32 v47, 0x3e0293ee, v47
v_cvt_pk_bf16_f32 v56, v40, v41
v_cvt_pk_bf16_f32 v57, v42, v43
v_cvt_pk_bf16_f32 v58, v44, v45
v_cvt_pk_bf16_f32 v59, v46, v47
buffer_store_dwordx4 v[56:59], v251, s[4:7], s53 offen offset:3072 sc1
s_add_u32 s53, s53, s2
v_accvgpr_read_b32 v0, a96
v_accvgpr_read_b32 v1, a97
v_accvgpr_read_b32 v2, a98
v_accvgpr_read_b32 v3, a99
v_accvgpr_read_b32 v4, a100
v_accvgpr_read_b32 v5, a101
v_accvgpr_read_b32 v6, a102
v_accvgpr_read_b32 v7, a103
v_mul_f32 v0, 0x3e0293ee, v0
v_mul_f32 v1, 0x3e0293ee, v1
v_mul_f32 v2, 0x3e0293ee, v2
v_mul_f32 v3, 0x3e0293ee, v3
v_mul_f32 v4, 0x3e0293ee, v4
v_mul_f32 v5, 0x3e0293ee, v5
v_mul_f32 v6, 0x3e0293ee, v6
v_mul_f32 v7, 0x3e0293ee, v7
v_cvt_pk_bf16_f32 v16, v0, v1
v_cvt_pk_bf16_f32 v17, v2, v3
v_cvt_pk_bf16_f32 v18, v4, v5
v_cvt_pk_bf16_f32 v19, v6, v7
buffer_store_dwordx4 v[16:19], v251, s[4:7], s53 offen offset:0 sc1
v_accvgpr_read_b32 v20, a104
v_accvgpr_read_b32 v21, a105
v_accvgpr_read_b32 v22, a106
v_accvgpr_read_b32 v23, a107
v_accvgpr_read_b32 v24, a108
v_accvgpr_read_b32 v25, a109
v_accvgpr_read_b32 v26, a110
v_accvgpr_read_b32 v27, a111
v_mul_f32 v20, 0x3e0293ee, v20
v_mul_f32 v21, 0x3e0293ee, v21
v_mul_f32 v22, 0x3e0293ee, v22
v_mul_f32 v23, 0x3e0293ee, v23
v_mul_f32 v24, 0x3e0293ee, v24
v_mul_f32 v25, 0x3e0293ee, v25
v_mul_f32 v26, 0x3e0293ee, v26
v_mul_f32 v27, 0x3e0293ee, v27
v_cvt_pk_bf16_f32 v36, v20, v21
v_cvt_pk_bf16_f32 v37, v22, v23
v_cvt_pk_bf16_f32 v38, v24, v25
v_cvt_pk_bf16_f32 v39, v26, v27
buffer_store_dwordx4 v[36:39], v251, s[4:7], s53 offen offset:1024 sc1
v_accvgpr_read_b32 v40, a112
v_accvgpr_read_b32 v41, a113
v_accvgpr_read_b32 v42, a114
v_accvgpr_read_b32 v43, a115
v_accvgpr_read_b32 v44, a116
v_accvgpr_read_b32 v45, a117
v_accvgpr_read_b32 v46, a118
v_accvgpr_read_b32 v47, a119
v_mul_f32 v40, 0x3e0293ee, v40
v_mul_f32 v41, 0x3e0293ee, v41
v_mul_f32 v42, 0x3e0293ee, v42
v_mul_f32 v43, 0x3e0293ee, v43
v_mul_f32 v44, 0x3e0293ee, v44
v_mul_f32 v45, 0x3e0293ee, v45
v_mul_f32 v46, 0x3e0293ee, v46
v_mul_f32 v47, 0x3e0293ee, v47
v_cvt_pk_bf16_f32 v56, v40, v41
v_cvt_pk_bf16_f32 v57, v42, v43
v_cvt_pk_bf16_f32 v58, v44, v45
v_cvt_pk_bf16_f32 v59, v46, v47
buffer_store_dwordx4 v[56:59], v251, s[4:7], s53 offen offset:2048 sc1
v_accvgpr_read_b32 v0, a120
v_accvgpr_read_b32 v1, a121
v_accvgpr_read_b32 v2, a122
v_accvgpr_read_b32 v3, a123
v_accvgpr_read_b32 v4, a124
v_accvgpr_read_b32 v5, a125
v_accvgpr_read_b32 v6, a126
v_accvgpr_read_b32 v7, a127
v_mul_f32 v0, 0x3e0293ee, v0
v_mul_f32 v1, 0x3e0293ee, v1
v_mul_f32 v2, 0x3e0293ee, v2
v_mul_f32 v3, 0x3e0293ee, v3
v_mul_f32 v4, 0x3e0293ee, v4
v_mul_f32 v5, 0x3e0293ee, v5
v_mul_f32 v6, 0x3e0293ee, v6
v_mul_f32 v7, 0x3e0293ee, v7
v_cvt_pk_bf16_f32 v16, v0, v1
v_cvt_pk_bf16_f32 v17, v2, v3
v_cvt_pk_bf16_f32 v18, v4, v5
v_cvt_pk_bf16_f32 v19, v6, v7
buffer_store_dwordx4 v[16:19], v251, s[4:7], s53 offen offset:3072 sc1
s_branch main_kernel_w_ee
main_kernel_w_e8:
s_mov_b32 s53, s1
v_accvgpr_read_b32 v0, a0
v_accvgpr_read_b32 v1, a1
v_accvgpr_read_b32 v2, a2
v_accvgpr_read_b32 v3, a3
v_accvgpr_read_b32 v4, a32
v_accvgpr_read_b32 v5, a33
v_accvgpr_read_b32 v6, a34
v_accvgpr_read_b32 v7, a35
v_cvt_pk_bf16_f32 v8, v0, v1
v_cvt_pk_bf16_f32 v9, v2, v3
v_cvt_pk_bf16_f32 v10, v4, v5
v_cvt_pk_bf16_f32 v11, v6, v7
buffer_store_dwordx4 v[8:11], v251, s[4:7], s53 offen offset:0 sc1
v_accvgpr_read_b32 v16, a4
v_accvgpr_read_b32 v17, a5
v_accvgpr_read_b32 v18, a6
v_accvgpr_read_b32 v19, a7
v_accvgpr_read_b32 v20, a36
v_accvgpr_read_b32 v21, a37
v_accvgpr_read_b32 v22, a38
v_accvgpr_read_b32 v23, a39
v_cvt_pk_bf16_f32 v24, v16, v17
v_cvt_pk_bf16_f32 v25, v18, v19
v_cvt_pk_bf16_f32 v26, v20, v21
v_cvt_pk_bf16_f32 v27, v22, v23
buffer_store_dwordx4 v[24:27], v251, s[4:7], s53 offen offset:1024 sc1
v_accvgpr_read_b32 v32, a8
v_accvgpr_read_b32 v33, a9
v_accvgpr_read_b32 v34, a10
v_accvgpr_read_b32 v35, a11
v_accvgpr_read_b32 v36, a40
v_accvgpr_read_b32 v37, a41
v_accvgpr_read_b32 v38, a42
v_accvgpr_read_b32 v39, a43
v_cvt_pk_bf16_f32 v40, v32, v33
v_cvt_pk_bf16_f32 v41, v34, v35
v_cvt_pk_bf16_f32 v42, v36, v37
v_cvt_pk_bf16_f32 v43, v38, v39
buffer_store_dwordx4 v[40:43], v251, s[4:7], s53 offen offset:2048 sc1
v_accvgpr_read_b32 v48, a12
v_accvgpr_read_b32 v49, a13
v_accvgpr_read_b32 v50, a14
v_accvgpr_read_b32 v51, a15
v_accvgpr_read_b32 v52, a44
v_accvgpr_read_b32 v53, a45
v_accvgpr_read_b32 v54, a46
v_accvgpr_read_b32 v55, a47
v_cvt_pk_bf16_f32 v56, v48, v49
v_cvt_pk_bf16_f32 v57, v50, v51
v_cvt_pk_bf16_f32 v58, v52, v53
v_cvt_pk_bf16_f32 v59, v54, v55
buffer_store_dwordx4 v[56:59], v251, s[4:7], s53 offen offset:3072 sc1
s_add_u32 s53, s53, 4096
v_accvgpr_read_b32 v0, a16
v_accvgpr_read_b32 v1, a17
v_accvgpr_read_b32 v2, a18
v_accvgpr_read_b32 v3, a19
v_accvgpr_read_b32 v4, a48
v_accvgpr_read_b32 v5, a49
v_accvgpr_read_b32 v6, a50
v_accvgpr_read_b32 v7, a51
v_cvt_pk_bf16_f32 v8, v0, v1
v_cvt_pk_bf16_f32 v9, v2, v3
v_cvt_pk_bf16_f32 v10, v4, v5
v_cvt_pk_bf16_f32 v11, v6, v7
buffer_store_dwordx4 v[8:11], v251, s[4:7], s53 offen offset:0 sc1
v_accvgpr_read_b32 v16, a20
v_accvgpr_read_b32 v17, a21
v_accvgpr_read_b32 v18, a22
v_accvgpr_read_b32 v19, a23
v_accvgpr_read_b32 v20, a52
v_accvgpr_read_b32 v21, a53
v_accvgpr_read_b32 v22, a54
v_accvgpr_read_b32 v23, a55
v_cvt_pk_bf16_f32 v24, v16, v17
v_cvt_pk_bf16_f32 v25, v18, v19
v_cvt_pk_bf16_f32 v26, v20, v21
v_cvt_pk_bf16_f32 v27, v22, v23
buffer_store_dwordx4 v[24:27], v251, s[4:7], s53 offen offset:1024 sc1
v_accvgpr_read_b32 v32, a24
v_accvgpr_read_b32 v33, a25
v_accvgpr_read_b32 v34, a26
v_accvgpr_read_b32 v35, a27
v_accvgpr_read_b32 v36, a56
v_accvgpr_read_b32 v37, a57
v_accvgpr_read_b32 v38, a58
v_accvgpr_read_b32 v39, a59
v_cvt_pk_bf16_f32 v40, v32, v33
v_cvt_pk_bf16_f32 v41, v34, v35
v_cvt_pk_bf16_f32 v42, v36, v37
v_cvt_pk_bf16_f32 v43, v38, v39
buffer_store_dwordx4 v[40:43], v251, s[4:7], s53 offen offset:2048 sc1
v_accvgpr_read_b32 v48, a28
v_accvgpr_read_b32 v49, a29
v_accvgpr_read_b32 v50, a30
v_accvgpr_read_b32 v51, a31
v_accvgpr_read_b32 v52, a60
v_accvgpr_read_b32 v53, a61
v_accvgpr_read_b32 v54, a62
v_accvgpr_read_b32 v55, a63
v_cvt_pk_bf16_f32 v56, v48, v49
v_cvt_pk_bf16_f32 v57, v50, v51
v_cvt_pk_bf16_f32 v58, v52, v53
v_cvt_pk_bf16_f32 v59, v54, v55
buffer_store_dwordx4 v[56:59], v251, s[4:7], s53 offen offset:3072 sc1
s_add_u32 s53, s53, 258048
v_accvgpr_read_b32 v0, a64
v_accvgpr_read_b32 v1, a65
v_accvgpr_read_b32 v2, a66
v_accvgpr_read_b32 v3, a67
v_accvgpr_read_b32 v4, a96
v_accvgpr_read_b32 v5, a97
v_accvgpr_read_b32 v6, a98
v_accvgpr_read_b32 v7, a99
v_cvt_pk_bf16_f32 v8, v0, v1
v_cvt_pk_bf16_f32 v9, v2, v3
v_cvt_pk_bf16_f32 v10, v4, v5
v_cvt_pk_bf16_f32 v11, v6, v7
buffer_store_dwordx4 v[8:11], v251, s[4:7], s53 offen offset:0 sc1
v_accvgpr_read_b32 v16, a68
v_accvgpr_read_b32 v17, a69
v_accvgpr_read_b32 v18, a70
v_accvgpr_read_b32 v19, a71
v_accvgpr_read_b32 v20, a100
v_accvgpr_read_b32 v21, a101
v_accvgpr_read_b32 v22, a102
v_accvgpr_read_b32 v23, a103
v_cvt_pk_bf16_f32 v24, v16, v17
v_cvt_pk_bf16_f32 v25, v18, v19
v_cvt_pk_bf16_f32 v26, v20, v21
v_cvt_pk_bf16_f32 v27, v22, v23
buffer_store_dwordx4 v[24:27], v251, s[4:7], s53 offen offset:1024 sc1
v_accvgpr_read_b32 v32, a72
v_accvgpr_read_b32 v33, a73
v_accvgpr_read_b32 v34, a74
v_accvgpr_read_b32 v35, a75
v_accvgpr_read_b32 v36, a104
v_accvgpr_read_b32 v37, a105
v_accvgpr_read_b32 v38, a106
v_accvgpr_read_b32 v39, a107
v_cvt_pk_bf16_f32 v40, v32, v33
v_cvt_pk_bf16_f32 v41, v34, v35
v_cvt_pk_bf16_f32 v42, v36, v37
v_cvt_pk_bf16_f32 v43, v38, v39
buffer_store_dwordx4 v[40:43], v251, s[4:7], s53 offen offset:2048 sc1
v_accvgpr_read_b32 v48, a76
v_accvgpr_read_b32 v49, a77
v_accvgpr_read_b32 v50, a78
v_accvgpr_read_b32 v51, a79
v_accvgpr_read_b32 v52, a108
v_accvgpr_read_b32 v53, a109
v_accvgpr_read_b32 v54, a110
v_accvgpr_read_b32 v55, a111
v_cvt_pk_bf16_f32 v56, v48, v49
v_cvt_pk_bf16_f32 v57, v50, v51
v_cvt_pk_bf16_f32 v58, v52, v53
v_cvt_pk_bf16_f32 v59, v54, v55
buffer_store_dwordx4 v[56:59], v251, s[4:7], s53 offen offset:3072 sc1
s_add_u32 s53, s53, 4096
v_accvgpr_read_b32 v0, a80
v_accvgpr_read_b32 v1, a81
v_accvgpr_read_b32 v2, a82
v_accvgpr_read_b32 v3, a83
v_accvgpr_read_b32 v4, a112
v_accvgpr_read_b32 v5, a113
v_accvgpr_read_b32 v6, a114
v_accvgpr_read_b32 v7, a115
v_cvt_pk_bf16_f32 v8, v0, v1
v_cvt_pk_bf16_f32 v9, v2, v3
v_cvt_pk_bf16_f32 v10, v4, v5
v_cvt_pk_bf16_f32 v11, v6, v7
buffer_store_dwordx4 v[8:11], v251, s[4:7], s53 offen offset:0 sc1
v_accvgpr_read_b32 v16, a84
v_accvgpr_read_b32 v17, a85
v_accvgpr_read_b32 v18, a86
v_accvgpr_read_b32 v19, a87
v_accvgpr_read_b32 v20, a116
v_accvgpr_read_b32 v21, a117
v_accvgpr_read_b32 v22, a118
v_accvgpr_read_b32 v23, a119
v_cvt_pk_bf16_f32 v24, v16, v17
v_cvt_pk_bf16_f32 v25, v18, v19
v_cvt_pk_bf16_f32 v26, v20, v21
v_cvt_pk_bf16_f32 v27, v22, v23
buffer_store_dwordx4 v[24:27], v251, s[4:7], s53 offen offset:1024 sc1
v_accvgpr_read_b32 v32, a88
v_accvgpr_read_b32 v33, a89
v_accvgpr_read_b32 v34, a90
v_accvgpr_read_b32 v35, a91
v_accvgpr_read_b32 v36, a120
v_accvgpr_read_b32 v37, a121
v_accvgpr_read_b32 v38, a122
v_accvgpr_read_b32 v39, a123
v_cvt_pk_bf16_f32 v40, v32, v33
v_cvt_pk_bf16_f32 v41, v34, v35
v_cvt_pk_bf16_f32 v42, v36, v37
v_cvt_pk_bf16_f32 v43, v38, v39
buffer_store_dwordx4 v[40:43], v251, s[4:7], s53 offen offset:2048 sc1
v_accvgpr_read_b32 v48, a92
v_accvgpr_read_b32 v49, a93
v_accvgpr_read_b32 v50, a94
v_accvgpr_read_b32 v51, a95
v_accvgpr_read_b32 v52, a124
v_accvgpr_read_b32 v53, a125
v_accvgpr_read_b32 v54, a126
v_accvgpr_read_b32 v55, a127
v_cvt_pk_bf16_f32 v56, v48, v49
v_cvt_pk_bf16_f32 v57, v50, v51
v_cvt_pk_bf16_f32 v58, v52, v53
v_cvt_pk_bf16_f32 v59, v54, v55
buffer_store_dwordx4 v[56:59], v251, s[4:7], s53 offen offset:3072 sc1
s_add_u32 s53, s53, 258048
s_branch main_kernel_w_ee
main_kernel_w_e9:
s_mov_b32 s53, s1
v_accvgpr_read_b32 v0, a0
v_accvgpr_read_b32 v1, a1
v_accvgpr_read_b32 v2, a2
v_accvgpr_read_b32 v3, a3
v_accvgpr_read_b32 v4, a4
v_accvgpr_read_b32 v5, a5
v_accvgpr_read_b32 v6, a6
v_accvgpr_read_b32 v7, a7
v_pk_mul_f32 v[8:9], v[0:1], v[0:1]
v_pk_mul_f32 v[10:11], v[2:3], v[2:3]
v_pk_mul_f32 v[12:13], v[4:5], v[4:5]
v_pk_mul_f32 v[14:15], v[6:7], v[6:7]
v_pk_fma_f32 v[8:9], v[8:9], v[242:243], v[240:241]
v_pk_fma_f32 v[10:11], v[10:11], v[242:243], v[240:241]
v_pk_fma_f32 v[12:13], v[12:13], v[242:243], v[240:241]
v_pk_fma_f32 v[14:15], v[14:15], v[242:243], v[240:241]
v_pk_mul_f32 v[8:9], v[8:9], v[0:1]
v_pk_mul_f32 v[10:11], v[10:11], v[2:3]
v_pk_mul_f32 v[12:13], v[12:13], v[4:5]
v_pk_mul_f32 v[14:15], v[14:15], v[6:7]
v_exp_f32 v8, v8
v_exp_f32 v9, v9
v_exp_f32 v10, v10
v_exp_f32 v11, v11
v_exp_f32 v12, v12
v_exp_f32 v13, v13
v_exp_f32 v14, v14
v_exp_f32 v15, v15
v_pk_add_f32 v[8:9], v[8:9], v[244:245]
v_pk_add_f32 v[10:11], v[10:11], v[244:245]
v_pk_add_f32 v[12:13], v[12:13], v[244:245]
v_pk_add_f32 v[14:15], v[14:15], v[244:245]
v_rcp_f32 v8, v8
v_rcp_f32 v9, v9
v_rcp_f32 v10, v10
v_rcp_f32 v11, v11
v_rcp_f32 v12, v12
v_rcp_f32 v13, v13
v_rcp_f32 v14, v14
v_rcp_f32 v15, v15
v_pk_mul_f32 v[0:1], v[8:9], v[0:1]
v_pk_mul_f32 v[2:3], v[10:11], v[2:3]
v_pk_mul_f32 v[4:5], v[12:13], v[4:5]
v_pk_mul_f32 v[6:7], v[14:15], v[6:7]
v_cvt_pk_bf16_f32 v16, v0, v1
v_cvt_pk_bf16_f32 v17, v2, v3
v_cvt_pk_bf16_f32 v18, v4, v5
v_cvt_pk_bf16_f32 v19, v6, v7
buffer_store_dwordx4 v[16:19], v145, s[4:7], s53 offen offset:0 sc1
v_accvgpr_read_b32 v20, a8
v_accvgpr_read_b32 v21, a9
v_accvgpr_read_b32 v22, a10
v_accvgpr_read_b32 v23, a11
v_accvgpr_read_b32 v24, a12
v_accvgpr_read_b32 v25, a13
v_accvgpr_read_b32 v26, a14
v_accvgpr_read_b32 v27, a15
v_pk_mul_f32 v[28:29], v[20:21], v[20:21]
v_pk_mul_f32 v[30:31], v[22:23], v[22:23]
v_pk_mul_f32 v[32:33], v[24:25], v[24:25]
v_pk_mul_f32 v[34:35], v[26:27], v[26:27]
v_pk_fma_f32 v[28:29], v[28:29], v[242:243], v[240:241]
v_pk_fma_f32 v[30:31], v[30:31], v[242:243], v[240:241]
v_pk_fma_f32 v[32:33], v[32:33], v[242:243], v[240:241]
v_pk_fma_f32 v[34:35], v[34:35], v[242:243], v[240:241]
v_pk_mul_f32 v[28:29], v[28:29], v[20:21]
v_pk_mul_f32 v[30:31], v[30:31], v[22:23]
v_pk_mul_f32 v[32:33], v[32:33], v[24:25]
v_pk_mul_f32 v[34:35], v[34:35], v[26:27]
v_exp_f32 v28, v28
v_exp_f32 v29, v29
v_exp_f32 v30, v30
v_exp_f32 v31, v31
v_exp_f32 v32, v32
v_exp_f32 v33, v33
v_exp_f32 v34, v34
v_exp_f32 v35, v35
v_pk_add_f32 v[28:29], v[28:29], v[244:245]
v_pk_add_f32 v[30:31], v[30:31], v[244:245]
v_pk_add_f32 v[32:33], v[32:33], v[244:245]
v_pk_add_f32 v[34:35], v[34:35], v[244:245]
v_rcp_f32 v28, v28
v_rcp_f32 v29, v29
v_rcp_f32 v30, v30
v_rcp_f32 v31, v31
v_rcp_f32 v32, v32
v_rcp_f32 v33, v33
v_rcp_f32 v34, v34
v_rcp_f32 v35, v35
v_pk_mul_f32 v[20:21], v[28:29], v[20:21]
v_pk_mul_f32 v[22:23], v[30:31], v[22:23]
v_pk_mul_f32 v[24:25], v[32:33], v[24:25]
v_pk_mul_f32 v[26:27], v[34:35], v[26:27]
v_cvt_pk_bf16_f32 v36, v20, v21
v_cvt_pk_bf16_f32 v37, v22, v23
v_cvt_pk_bf16_f32 v38, v24, v25
v_cvt_pk_bf16_f32 v39, v26, v27
buffer_store_dwordx4 v[36:39], v145, s[4:7], s53 offen offset:1024 sc1
v_accvgpr_read_b32 v40, a16
v_accvgpr_read_b32 v41, a17
v_accvgpr_read_b32 v42, a18
v_accvgpr_read_b32 v43, a19
v_accvgpr_read_b32 v44, a20
v_accvgpr_read_b32 v45, a21
v_accvgpr_read_b32 v46, a22
v_accvgpr_read_b32 v47, a23
v_pk_mul_f32 v[48:49], v[40:41], v[40:41]
v_pk_mul_f32 v[50:51], v[42:43], v[42:43]
v_pk_mul_f32 v[52:53], v[44:45], v[44:45]
v_pk_mul_f32 v[54:55], v[46:47], v[46:47]
v_pk_fma_f32 v[48:49], v[48:49], v[242:243], v[240:241]
v_pk_fma_f32 v[50:51], v[50:51], v[242:243], v[240:241]
v_pk_fma_f32 v[52:53], v[52:53], v[242:243], v[240:241]
v_pk_fma_f32 v[54:55], v[54:55], v[242:243], v[240:241]
v_pk_mul_f32 v[48:49], v[48:49], v[40:41]
v_pk_mul_f32 v[50:51], v[50:51], v[42:43]
v_pk_mul_f32 v[52:53], v[52:53], v[44:45]
v_pk_mul_f32 v[54:55], v[54:55], v[46:47]
v_exp_f32 v48, v48
v_exp_f32 v49, v49
v_exp_f32 v50, v50
v_exp_f32 v51, v51
v_exp_f32 v52, v52
v_exp_f32 v53, v53
v_exp_f32 v54, v54
v_exp_f32 v55, v55
v_pk_add_f32 v[48:49], v[48:49], v[244:245]
v_pk_add_f32 v[50:51], v[50:51], v[244:245]
v_pk_add_f32 v[52:53], v[52:53], v[244:245]
v_pk_add_f32 v[54:55], v[54:55], v[244:245]
v_rcp_f32 v48, v48
v_rcp_f32 v49, v49
v_rcp_f32 v50, v50
v_rcp_f32 v51, v51
v_rcp_f32 v52, v52
v_rcp_f32 v53, v53
v_rcp_f32 v54, v54
v_rcp_f32 v55, v55
v_pk_mul_f32 v[40:41], v[48:49], v[40:41]
v_pk_mul_f32 v[42:43], v[50:51], v[42:43]
v_pk_mul_f32 v[44:45], v[52:53], v[44:45]
v_pk_mul_f32 v[46:47], v[54:55], v[46:47]
v_cvt_pk_bf16_f32 v56, v40, v41
v_cvt_pk_bf16_f32 v57, v42, v43
v_cvt_pk_bf16_f32 v58, v44, v45
v_cvt_pk_bf16_f32 v59, v46, v47
buffer_store_dwordx4 v[56:59], v145, s[4:7], s53 offen offset:2048 sc1
v_accvgpr_read_b32 v0, a24
v_accvgpr_read_b32 v1, a25
v_accvgpr_read_b32 v2, a26
v_accvgpr_read_b32 v3, a27
v_accvgpr_read_b32 v4, a28
v_accvgpr_read_b32 v5, a29
v_accvgpr_read_b32 v6, a30
v_accvgpr_read_b32 v7, a31
v_pk_mul_f32 v[8:9], v[0:1], v[0:1]
v_pk_mul_f32 v[10:11], v[2:3], v[2:3]
v_pk_mul_f32 v[12:13], v[4:5], v[4:5]
v_pk_mul_f32 v[14:15], v[6:7], v[6:7]
v_pk_fma_f32 v[8:9], v[8:9], v[242:243], v[240:241]
v_pk_fma_f32 v[10:11], v[10:11], v[242:243], v[240:241]
v_pk_fma_f32 v[12:13], v[12:13], v[242:243], v[240:241]
v_pk_fma_f32 v[14:15], v[14:15], v[242:243], v[240:241]
v_pk_mul_f32 v[8:9], v[8:9], v[0:1]
v_pk_mul_f32 v[10:11], v[10:11], v[2:3]
v_pk_mul_f32 v[12:13], v[12:13], v[4:5]
v_pk_mul_f32 v[14:15], v[14:15], v[6:7]
v_exp_f32 v8, v8
v_exp_f32 v9, v9
v_exp_f32 v10, v10
v_exp_f32 v11, v11
v_exp_f32 v12, v12
v_exp_f32 v13, v13
v_exp_f32 v14, v14
v_exp_f32 v15, v15
v_pk_add_f32 v[8:9], v[8:9], v[244:245]
v_pk_add_f32 v[10:11], v[10:11], v[244:245]
v_pk_add_f32 v[12:13], v[12:13], v[244:245]
v_pk_add_f32 v[14:15], v[14:15], v[244:245]
v_rcp_f32 v8, v8
v_rcp_f32 v9, v9
v_rcp_f32 v10, v10
v_rcp_f32 v11, v11
v_rcp_f32 v12, v12
v_rcp_f32 v13, v13
v_rcp_f32 v14, v14
v_rcp_f32 v15, v15
v_pk_mul_f32 v[0:1], v[8:9], v[0:1]
v_pk_mul_f32 v[2:3], v[10:11], v[2:3]
v_pk_mul_f32 v[4:5], v[12:13], v[4:5]
v_pk_mul_f32 v[6:7], v[14:15], v[6:7]
v_cvt_pk_bf16_f32 v16, v0, v1
v_cvt_pk_bf16_f32 v17, v2, v3
v_cvt_pk_bf16_f32 v18, v4, v5
v_cvt_pk_bf16_f32 v19, v6, v7
buffer_store_dwordx4 v[16:19], v145, s[4:7], s53 offen offset:3072 sc1
s_add_u32 s53, s53, s2
v_accvgpr_read_b32 v20, a32
v_accvgpr_read_b32 v21, a33
v_accvgpr_read_b32 v22, a34
v_accvgpr_read_b32 v23, a35
v_accvgpr_read_b32 v24, a36
v_accvgpr_read_b32 v25, a37
v_accvgpr_read_b32 v26, a38
v_accvgpr_read_b32 v27, a39
v_pk_mul_f32 v[28:29], v[20:21], v[20:21]
v_pk_mul_f32 v[30:31], v[22:23], v[22:23]
v_pk_mul_f32 v[32:33], v[24:25], v[24:25]
v_pk_mul_f32 v[34:35], v[26:27], v[26:27]
v_pk_fma_f32 v[28:29], v[28:29], v[242:243], v[240:241]
v_pk_fma_f32 v[30:31], v[30:31], v[242:243], v[240:241]
v_pk_fma_f32 v[32:33], v[32:33], v[242:243], v[240:241]
v_pk_fma_f32 v[34:35], v[34:35], v[242:243], v[240:241]
v_pk_mul_f32 v[28:29], v[28:29], v[20:21]
v_pk_mul_f32 v[30:31], v[30:31], v[22:23]
v_pk_mul_f32 v[32:33], v[32:33], v[24:25]
v_pk_mul_f32 v[34:35], v[34:35], v[26:27]
v_exp_f32 v28, v28
v_exp_f32 v29, v29
v_exp_f32 v30, v30
v_exp_f32 v31, v31
v_exp_f32 v32, v32
v_exp_f32 v33, v33
v_exp_f32 v34, v34
v_exp_f32 v35, v35
v_pk_add_f32 v[28:29], v[28:29], v[244:245]
v_pk_add_f32 v[30:31], v[30:31], v[244:245]
v_pk_add_f32 v[32:33], v[32:33], v[244:245]
v_pk_add_f32 v[34:35], v[34:35], v[244:245]
v_rcp_f32 v28, v28
v_rcp_f32 v29, v29
v_rcp_f32 v30, v30
v_rcp_f32 v31, v31
v_rcp_f32 v32, v32
v_rcp_f32 v33, v33
v_rcp_f32 v34, v34
v_rcp_f32 v35, v35
v_pk_mul_f32 v[20:21], v[28:29], v[20:21]
v_pk_mul_f32 v[22:23], v[30:31], v[22:23]
v_pk_mul_f32 v[24:25], v[32:33], v[24:25]
v_pk_mul_f32 v[26:27], v[34:35], v[26:27]
v_cvt_pk_bf16_f32 v36, v20, v21
v_cvt_pk_bf16_f32 v37, v22, v23
v_cvt_pk_bf16_f32 v38, v24, v25
v_cvt_pk_bf16_f32 v39, v26, v27
buffer_store_dwordx4 v[36:39], v145, s[4:7], s53 offen offset:0 sc1
v_accvgpr_read_b32 v40, a40
v_accvgpr_read_b32 v41, a41
v_accvgpr_read_b32 v42, a42
v_accvgpr_read_b32 v43, a43
v_accvgpr_read_b32 v44, a44
v_accvgpr_read_b32 v45, a45
v_accvgpr_read_b32 v46, a46
v_accvgpr_read_b32 v47, a47
v_pk_mul_f32 v[48:49], v[40:41], v[40:41]
v_pk_mul_f32 v[50:51], v[42:43], v[42:43]
v_pk_mul_f32 v[52:53], v[44:45], v[44:45]
v_pk_mul_f32 v[54:55], v[46:47], v[46:47]
v_pk_fma_f32 v[48:49], v[48:49], v[242:243], v[240:241]
v_pk_fma_f32 v[50:51], v[50:51], v[242:243], v[240:241]
v_pk_fma_f32 v[52:53], v[52:53], v[242:243], v[240:241]
v_pk_fma_f32 v[54:55], v[54:55], v[242:243], v[240:241]
v_pk_mul_f32 v[48:49], v[48:49], v[40:41]
v_pk_mul_f32 v[50:51], v[50:51], v[42:43]
v_pk_mul_f32 v[52:53], v[52:53], v[44:45]
v_pk_mul_f32 v[54:55], v[54:55], v[46:47]
v_exp_f32 v48, v48
v_exp_f32 v49, v49
v_exp_f32 v50, v50
v_exp_f32 v51, v51
v_exp_f32 v52, v52
v_exp_f32 v53, v53
v_exp_f32 v54, v54
v_exp_f32 v55, v55
v_pk_add_f32 v[48:49], v[48:49], v[244:245]
v_pk_add_f32 v[50:51], v[50:51], v[244:245]
v_pk_add_f32 v[52:53], v[52:53], v[244:245]
v_pk_add_f32 v[54:55], v[54:55], v[244:245]
v_rcp_f32 v48, v48
v_rcp_f32 v49, v49
v_rcp_f32 v50, v50
v_rcp_f32 v51, v51
v_rcp_f32 v52, v52
v_rcp_f32 v53, v53
v_rcp_f32 v54, v54
v_rcp_f32 v55, v55
v_pk_mul_f32 v[40:41], v[48:49], v[40:41]
v_pk_mul_f32 v[42:43], v[50:51], v[42:43]
v_pk_mul_f32 v[44:45], v[52:53], v[44:45]
v_pk_mul_f32 v[46:47], v[54:55], v[46:47]
v_cvt_pk_bf16_f32 v56, v40, v41
v_cvt_pk_bf16_f32 v57, v42, v43
v_cvt_pk_bf16_f32 v58, v44, v45
v_cvt_pk_bf16_f32 v59, v46, v47
buffer_store_dwordx4 v[56:59], v145, s[4:7], s53 offen offset:1024 sc1
v_accvgpr_read_b32 v0, a48
v_accvgpr_read_b32 v1, a49
v_accvgpr_read_b32 v2, a50
v_accvgpr_read_b32 v3, a51
v_accvgpr_read_b32 v4, a52
v_accvgpr_read_b32 v5, a53
v_accvgpr_read_b32 v6, a54
v_accvgpr_read_b32 v7, a55
v_pk_mul_f32 v[8:9], v[0:1], v[0:1]
v_pk_mul_f32 v[10:11], v[2:3], v[2:3]
v_pk_mul_f32 v[12:13], v[4:5], v[4:5]
v_pk_mul_f32 v[14:15], v[6:7], v[6:7]
v_pk_fma_f32 v[8:9], v[8:9], v[242:243], v[240:241]
v_pk_fma_f32 v[10:11], v[10:11], v[242:243], v[240:241]
v_pk_fma_f32 v[12:13], v[12:13], v[242:243], v[240:241]
v_pk_fma_f32 v[14:15], v[14:15], v[242:243], v[240:241]
v_pk_mul_f32 v[8:9], v[8:9], v[0:1]
v_pk_mul_f32 v[10:11], v[10:11], v[2:3]
v_pk_mul_f32 v[12:13], v[12:13], v[4:5]
v_pk_mul_f32 v[14:15], v[14:15], v[6:7]
v_exp_f32 v8, v8
v_exp_f32 v9, v9
v_exp_f32 v10, v10
v_exp_f32 v11, v11
v_exp_f32 v12, v12
v_exp_f32 v13, v13
v_exp_f32 v14, v14
v_exp_f32 v15, v15
v_pk_add_f32 v[8:9], v[8:9], v[244:245]
v_pk_add_f32 v[10:11], v[10:11], v[244:245]
v_pk_add_f32 v[12:13], v[12:13], v[244:245]
v_pk_add_f32 v[14:15], v[14:15], v[244:245]
v_rcp_f32 v8, v8
v_rcp_f32 v9, v9
v_rcp_f32 v10, v10
v_rcp_f32 v11, v11
v_rcp_f32 v12, v12
v_rcp_f32 v13, v13
v_rcp_f32 v14, v14
v_rcp_f32 v15, v15
v_pk_mul_f32 v[0:1], v[8:9], v[0:1]
v_pk_mul_f32 v[2:3], v[10:11], v[2:3]
v_pk_mul_f32 v[4:5], v[12:13], v[4:5]
v_pk_mul_f32 v[6:7], v[14:15], v[6:7]
v_cvt_pk_bf16_f32 v16, v0, v1
v_cvt_pk_bf16_f32 v17, v2, v3
v_cvt_pk_bf16_f32 v18, v4, v5
v_cvt_pk_bf16_f32 v19, v6, v7
buffer_store_dwordx4 v[16:19], v145, s[4:7], s53 offen offset:2048 sc1
v_accvgpr_read_b32 v20, a56
v_accvgpr_read_b32 v21, a57
v_accvgpr_read_b32 v22, a58
v_accvgpr_read_b32 v23, a59
v_accvgpr_read_b32 v24, a60
v_accvgpr_read_b32 v25, a61
v_accvgpr_read_b32 v26, a62
v_accvgpr_read_b32 v27, a63
v_pk_mul_f32 v[28:29], v[20:21], v[20:21]
v_pk_mul_f32 v[30:31], v[22:23], v[22:23]
v_pk_mul_f32 v[32:33], v[24:25], v[24:25]
v_pk_mul_f32 v[34:35], v[26:27], v[26:27]
v_pk_fma_f32 v[28:29], v[28:29], v[242:243], v[240:241]
v_pk_fma_f32 v[30:31], v[30:31], v[242:243], v[240:241]
v_pk_fma_f32 v[32:33], v[32:33], v[242:243], v[240:241]
v_pk_fma_f32 v[34:35], v[34:35], v[242:243], v[240:241]
v_pk_mul_f32 v[28:29], v[28:29], v[20:21]
v_pk_mul_f32 v[30:31], v[30:31], v[22:23]
v_pk_mul_f32 v[32:33], v[32:33], v[24:25]
v_pk_mul_f32 v[34:35], v[34:35], v[26:27]
v_exp_f32 v28, v28
v_exp_f32 v29, v29
v_exp_f32 v30, v30
v_exp_f32 v31, v31
v_exp_f32 v32, v32
v_exp_f32 v33, v33
v_exp_f32 v34, v34
v_exp_f32 v35, v35
v_pk_add_f32 v[28:29], v[28:29], v[244:245]
v_pk_add_f32 v[30:31], v[30:31], v[244:245]
v_pk_add_f32 v[32:33], v[32:33], v[244:245]
v_pk_add_f32 v[34:35], v[34:35], v[244:245]
v_rcp_f32 v28, v28
v_rcp_f32 v29, v29
v_rcp_f32 v30, v30
v_rcp_f32 v31, v31
v_rcp_f32 v32, v32
v_rcp_f32 v33, v33
v_rcp_f32 v34, v34
v_rcp_f32 v35, v35
v_pk_mul_f32 v[20:21], v[28:29], v[20:21]
v_pk_mul_f32 v[22:23], v[30:31], v[22:23]
v_pk_mul_f32 v[24:25], v[32:33], v[24:25]
v_pk_mul_f32 v[26:27], v[34:35], v[26:27]
v_cvt_pk_bf16_f32 v36, v20, v21
v_cvt_pk_bf16_f32 v37, v22, v23
v_cvt_pk_bf16_f32 v38, v24, v25
v_cvt_pk_bf16_f32 v39, v26, v27
buffer_store_dwordx4 v[36:39], v145, s[4:7], s53 offen offset:3072 sc1
s_add_u32 s53, s53, s2
v_accvgpr_read_b32 v40, a64
v_accvgpr_read_b32 v41, a65
v_accvgpr_read_b32 v42, a66
v_accvgpr_read_b32 v43, a67
v_accvgpr_read_b32 v44, a68
v_accvgpr_read_b32 v45, a69
v_accvgpr_read_b32 v46, a70
v_accvgpr_read_b32 v47, a71
v_pk_mul_f32 v[48:49], v[40:41], v[40:41]
v_pk_mul_f32 v[50:51], v[42:43], v[42:43]
v_pk_mul_f32 v[52:53], v[44:45], v[44:45]
v_pk_mul_f32 v[54:55], v[46:47], v[46:47]
v_pk_fma_f32 v[48:49], v[48:49], v[242:243], v[240:241]
v_pk_fma_f32 v[50:51], v[50:51], v[242:243], v[240:241]
v_pk_fma_f32 v[52:53], v[52:53], v[242:243], v[240:241]
v_pk_fma_f32 v[54:55], v[54:55], v[242:243], v[240:241]
v_pk_mul_f32 v[48:49], v[48:49], v[40:41]
v_pk_mul_f32 v[50:51], v[50:51], v[42:43]
v_pk_mul_f32 v[52:53], v[52:53], v[44:45]
v_pk_mul_f32 v[54:55], v[54:55], v[46:47]
v_exp_f32 v48, v48
v_exp_f32 v49, v49
v_exp_f32 v50, v50
v_exp_f32 v51, v51
v_exp_f32 v52, v52
v_exp_f32 v53, v53
v_exp_f32 v54, v54
v_exp_f32 v55, v55
v_pk_add_f32 v[48:49], v[48:49], v[244:245]
v_pk_add_f32 v[50:51], v[50:51], v[244:245]
v_pk_add_f32 v[52:53], v[52:53], v[244:245]
v_pk_add_f32 v[54:55], v[54:55], v[244:245]
v_rcp_f32 v48, v48
v_rcp_f32 v49, v49
v_rcp_f32 v50, v50
v_rcp_f32 v51, v51
v_rcp_f32 v52, v52
v_rcp_f32 v53, v53
v_rcp_f32 v54, v54
v_rcp_f32 v55, v55
v_pk_mul_f32 v[40:41], v[48:49], v[40:41]
v_pk_mul_f32 v[42:43], v[50:51], v[42:43]
v_pk_mul_f32 v[44:45], v[52:53], v[44:45]
v_pk_mul_f32 v[46:47], v[54:55], v[46:47]
v_cvt_pk_bf16_f32 v56, v40, v41
v_cvt_pk_bf16_f32 v57, v42, v43
v_cvt_pk_bf16_f32 v58, v44, v45
v_cvt_pk_bf16_f32 v59, v46, v47
buffer_store_dwordx4 v[56:59], v145, s[4:7], s53 offen offset:0 sc1
v_accvgpr_read_b32 v0, a72
v_accvgpr_read_b32 v1, a73
v_accvgpr_read_b32 v2, a74
v_accvgpr_read_b32 v3, a75
v_accvgpr_read_b32 v4, a76
v_accvgpr_read_b32 v5, a77
v_accvgpr_read_b32 v6, a78
v_accvgpr_read_b32 v7, a79
v_pk_mul_f32 v[8:9], v[0:1], v[0:1]
v_pk_mul_f32 v[10:11], v[2:3], v[2:3]
v_pk_mul_f32 v[12:13], v[4:5], v[4:5]
v_pk_mul_f32 v[14:15], v[6:7], v[6:7]
v_pk_fma_f32 v[8:9], v[8:9], v[242:243], v[240:241]
v_pk_fma_f32 v[10:11], v[10:11], v[242:243], v[240:241]
v_pk_fma_f32 v[12:13], v[12:13], v[242:243], v[240:241]
v_pk_fma_f32 v[14:15], v[14:15], v[242:243], v[240:241]
v_pk_mul_f32 v[8:9], v[8:9], v[0:1]
v_pk_mul_f32 v[10:11], v[10:11], v[2:3]
v_pk_mul_f32 v[12:13], v[12:13], v[4:5]
v_pk_mul_f32 v[14:15], v[14:15], v[6:7]
v_exp_f32 v8, v8
v_exp_f32 v9, v9
v_exp_f32 v10, v10
v_exp_f32 v11, v11
v_exp_f32 v12, v12
v_exp_f32 v13, v13
v_exp_f32 v14, v14
v_exp_f32 v15, v15
v_pk_add_f32 v[8:9], v[8:9], v[244:245]
v_pk_add_f32 v[10:11], v[10:11], v[244:245]
v_pk_add_f32 v[12:13], v[12:13], v[244:245]
v_pk_add_f32 v[14:15], v[14:15], v[244:245]
v_rcp_f32 v8, v8
v_rcp_f32 v9, v9
v_rcp_f32 v10, v10
v_rcp_f32 v11, v11
v_rcp_f32 v12, v12
v_rcp_f32 v13, v13
v_rcp_f32 v14, v14
v_rcp_f32 v15, v15
v_pk_mul_f32 v[0:1], v[8:9], v[0:1]
v_pk_mul_f32 v[2:3], v[10:11], v[2:3]
v_pk_mul_f32 v[4:5], v[12:13], v[4:5]
v_pk_mul_f32 v[6:7], v[14:15], v[6:7]
v_cvt_pk_bf16_f32 v16, v0, v1
v_cvt_pk_bf16_f32 v17, v2, v3
v_cvt_pk_bf16_f32 v18, v4, v5
v_cvt_pk_bf16_f32 v19, v6, v7
buffer_store_dwordx4 v[16:19], v145, s[4:7], s53 offen offset:1024 sc1
v_accvgpr_read_b32 v20, a80
v_accvgpr_read_b32 v21, a81
v_accvgpr_read_b32 v22, a82
v_accvgpr_read_b32 v23, a83
v_accvgpr_read_b32 v24, a84
v_accvgpr_read_b32 v25, a85
v_accvgpr_read_b32 v26, a86
v_accvgpr_read_b32 v27, a87
v_pk_mul_f32 v[28:29], v[20:21], v[20:21]
v_pk_mul_f32 v[30:31], v[22:23], v[22:23]
v_pk_mul_f32 v[32:33], v[24:25], v[24:25]
v_pk_mul_f32 v[34:35], v[26:27], v[26:27]
v_pk_fma_f32 v[28:29], v[28:29], v[242:243], v[240:241]
v_pk_fma_f32 v[30:31], v[30:31], v[242:243], v[240:241]
v_pk_fma_f32 v[32:33], v[32:33], v[242:243], v[240:241]
v_pk_fma_f32 v[34:35], v[34:35], v[242:243], v[240:241]
v_pk_mul_f32 v[28:29], v[28:29], v[20:21]
v_pk_mul_f32 v[30:31], v[30:31], v[22:23]
v_pk_mul_f32 v[32:33], v[32:33], v[24:25]
v_pk_mul_f32 v[34:35], v[34:35], v[26:27]
v_exp_f32 v28, v28
v_exp_f32 v29, v29
v_exp_f32 v30, v30
v_exp_f32 v31, v31
v_exp_f32 v32, v32
v_exp_f32 v33, v33
v_exp_f32 v34, v34
v_exp_f32 v35, v35
v_pk_add_f32 v[28:29], v[28:29], v[244:245]
v_pk_add_f32 v[30:31], v[30:31], v[244:245]
v_pk_add_f32 v[32:33], v[32:33], v[244:245]
v_pk_add_f32 v[34:35], v[34:35], v[244:245]
v_rcp_f32 v28, v28
v_rcp_f32 v29, v29
v_rcp_f32 v30, v30
v_rcp_f32 v31, v31
v_rcp_f32 v32, v32
v_rcp_f32 v33, v33
v_rcp_f32 v34, v34
v_rcp_f32 v35, v35
v_pk_mul_f32 v[20:21], v[28:29], v[20:21]
v_pk_mul_f32 v[22:23], v[30:31], v[22:23]
v_pk_mul_f32 v[24:25], v[32:33], v[24:25]
v_pk_mul_f32 v[26:27], v[34:35], v[26:27]
v_cvt_pk_bf16_f32 v36, v20, v21
v_cvt_pk_bf16_f32 v37, v22, v23
v_cvt_pk_bf16_f32 v38, v24, v25
v_cvt_pk_bf16_f32 v39, v26, v27
buffer_store_dwordx4 v[36:39], v145, s[4:7], s53 offen offset:2048 sc1
v_accvgpr_read_b32 v40, a88
v_accvgpr_read_b32 v41, a89
v_accvgpr_read_b32 v42, a90
v_accvgpr_read_b32 v43, a91
v_accvgpr_read_b32 v44, a92
v_accvgpr_read_b32 v45, a93
v_accvgpr_read_b32 v46, a94
v_accvgpr_read_b32 v47, a95
v_pk_mul_f32 v[48:49], v[40:41], v[40:41]
v_pk_mul_f32 v[50:51], v[42:43], v[42:43]
v_pk_mul_f32 v[52:53], v[44:45], v[44:45]
v_pk_mul_f32 v[54:55], v[46:47], v[46:47]
v_pk_fma_f32 v[48:49], v[48:49], v[242:243], v[240:241]
v_pk_fma_f32 v[50:51], v[50:51], v[242:243], v[240:241]
v_pk_fma_f32 v[52:53], v[52:53], v[242:243], v[240:241]
v_pk_fma_f32 v[54:55], v[54:55], v[242:243], v[240:241]
v_pk_mul_f32 v[48:49], v[48:49], v[40:41]
v_pk_mul_f32 v[50:51], v[50:51], v[42:43]
v_pk_mul_f32 v[52:53], v[52:53], v[44:45]
v_pk_mul_f32 v[54:55], v[54:55], v[46:47]
v_exp_f32 v48, v48
v_exp_f32 v49, v49
v_exp_f32 v50, v50
v_exp_f32 v51, v51
v_exp_f32 v52, v52
v_exp_f32 v53, v53
v_exp_f32 v54, v54
v_exp_f32 v55, v55
v_pk_add_f32 v[48:49], v[48:49], v[244:245]
v_pk_add_f32 v[50:51], v[50:51], v[244:245]
v_pk_add_f32 v[52:53], v[52:53], v[244:245]
v_pk_add_f32 v[54:55], v[54:55], v[244:245]
v_rcp_f32 v48, v48
v_rcp_f32 v49, v49
v_rcp_f32 v50, v50
v_rcp_f32 v51, v51
v_rcp_f32 v52, v52
v_rcp_f32 v53, v53
v_rcp_f32 v54, v54
v_rcp_f32 v55, v55
v_pk_mul_f32 v[40:41], v[48:49], v[40:41]
v_pk_mul_f32 v[42:43], v[50:51], v[42:43]
v_pk_mul_f32 v[44:45], v[52:53], v[44:45]
v_pk_mul_f32 v[46:47], v[54:55], v[46:47]
v_cvt_pk_bf16_f32 v56, v40, v41
v_cvt_pk_bf16_f32 v57, v42, v43
v_cvt_pk_bf16_f32 v58, v44, v45
v_cvt_pk_bf16_f32 v59, v46, v47
buffer_store_dwordx4 v[56:59], v145, s[4:7], s53 offen offset:3072 sc1
s_add_u32 s53, s53, s2
v_accvgpr_read_b32 v0, a96
v_accvgpr_read_b32 v1, a97
v_accvgpr_read_b32 v2, a98
v_accvgpr_read_b32 v3, a99
v_accvgpr_read_b32 v4, a100
v_accvgpr_read_b32 v5, a101
v_accvgpr_read_b32 v6, a102
v_accvgpr_read_b32 v7, a103
v_pk_mul_f32 v[8:9], v[0:1], v[0:1]
v_pk_mul_f32 v[10:11], v[2:3], v[2:3]
v_pk_mul_f32 v[12:13], v[4:5], v[4:5]
v_pk_mul_f32 v[14:15], v[6:7], v[6:7]
v_pk_fma_f32 v[8:9], v[8:9], v[242:243], v[240:241]
v_pk_fma_f32 v[10:11], v[10:11], v[242:243], v[240:241]
v_pk_fma_f32 v[12:13], v[12:13], v[242:243], v[240:241]
v_pk_fma_f32 v[14:15], v[14:15], v[242:243], v[240:241]
v_pk_mul_f32 v[8:9], v[8:9], v[0:1]
v_pk_mul_f32 v[10:11], v[10:11], v[2:3]
v_pk_mul_f32 v[12:13], v[12:13], v[4:5]
v_pk_mul_f32 v[14:15], v[14:15], v[6:7]
v_exp_f32 v8, v8
v_exp_f32 v9, v9
v_exp_f32 v10, v10
v_exp_f32 v11, v11
v_exp_f32 v12, v12
v_exp_f32 v13, v13
v_exp_f32 v14, v14
v_exp_f32 v15, v15
v_pk_add_f32 v[8:9], v[8:9], v[244:245]
v_pk_add_f32 v[10:11], v[10:11], v[244:245]
v_pk_add_f32 v[12:13], v[12:13], v[244:245]
v_pk_add_f32 v[14:15], v[14:15], v[244:245]
v_rcp_f32 v8, v8
v_rcp_f32 v9, v9
v_rcp_f32 v10, v10
v_rcp_f32 v11, v11
v_rcp_f32 v12, v12
v_rcp_f32 v13, v13
v_rcp_f32 v14, v14
v_rcp_f32 v15, v15
v_pk_mul_f32 v[0:1], v[8:9], v[0:1]
v_pk_mul_f32 v[2:3], v[10:11], v[2:3]
v_pk_mul_f32 v[4:5], v[12:13], v[4:5]
v_pk_mul_f32 v[6:7], v[14:15], v[6:7]
v_cvt_pk_bf16_f32 v16, v0, v1
v_cvt_pk_bf16_f32 v17, v2, v3
v_cvt_pk_bf16_f32 v18, v4, v5
v_cvt_pk_bf16_f32 v19, v6, v7
buffer_store_dwordx4 v[16:19], v145, s[4:7], s53 offen offset:0 sc1
v_accvgpr_read_b32 v20, a104
v_accvgpr_read_b32 v21, a105
v_accvgpr_read_b32 v22, a106
v_accvgpr_read_b32 v23, a107
v_accvgpr_read_b32 v24, a108
v_accvgpr_read_b32 v25, a109
v_accvgpr_read_b32 v26, a110
v_accvgpr_read_b32 v27, a111
v_pk_mul_f32 v[28:29], v[20:21], v[20:21]
v_pk_mul_f32 v[30:31], v[22:23], v[22:23]
v_pk_mul_f32 v[32:33], v[24:25], v[24:25]
v_pk_mul_f32 v[34:35], v[26:27], v[26:27]
v_pk_fma_f32 v[28:29], v[28:29], v[242:243], v[240:241]
v_pk_fma_f32 v[30:31], v[30:31], v[242:243], v[240:241]
v_pk_fma_f32 v[32:33], v[32:33], v[242:243], v[240:241]
v_pk_fma_f32 v[34:35], v[34:35], v[242:243], v[240:241]
v_pk_mul_f32 v[28:29], v[28:29], v[20:21]
v_pk_mul_f32 v[30:31], v[30:31], v[22:23]
v_pk_mul_f32 v[32:33], v[32:33], v[24:25]
v_pk_mul_f32 v[34:35], v[34:35], v[26:27]
v_exp_f32 v28, v28
v_exp_f32 v29, v29
v_exp_f32 v30, v30
v_exp_f32 v31, v31
v_exp_f32 v32, v32
v_exp_f32 v33, v33
v_exp_f32 v34, v34
v_exp_f32 v35, v35
v_pk_add_f32 v[28:29], v[28:29], v[244:245]
v_pk_add_f32 v[30:31], v[30:31], v[244:245]
v_pk_add_f32 v[32:33], v[32:33], v[244:245]
v_pk_add_f32 v[34:35], v[34:35], v[244:245]
v_rcp_f32 v28, v28
v_rcp_f32 v29, v29
v_rcp_f32 v30, v30
v_rcp_f32 v31, v31
v_rcp_f32 v32, v32
v_rcp_f32 v33, v33
v_rcp_f32 v34, v34
v_rcp_f32 v35, v35
v_pk_mul_f32 v[20:21], v[28:29], v[20:21]
v_pk_mul_f32 v[22:23], v[30:31], v[22:23]
v_pk_mul_f32 v[24:25], v[32:33], v[24:25]
v_pk_mul_f32 v[26:27], v[34:35], v[26:27]
v_cvt_pk_bf16_f32 v36, v20, v21
v_cvt_pk_bf16_f32 v37, v22, v23
v_cvt_pk_bf16_f32 v38, v24, v25
v_cvt_pk_bf16_f32 v39, v26, v27
buffer_store_dwordx4 v[36:39], v145, s[4:7], s53 offen offset:1024 sc1
v_accvgpr_read_b32 v40, a112
v_accvgpr_read_b32 v41, a113
v_accvgpr_read_b32 v42, a114
v_accvgpr_read_b32 v43, a115
v_accvgpr_read_b32 v44, a116
v_accvgpr_read_b32 v45, a117
v_accvgpr_read_b32 v46, a118
v_accvgpr_read_b32 v47, a119
v_pk_mul_f32 v[48:49], v[40:41], v[40:41]
v_pk_mul_f32 v[50:51], v[42:43], v[42:43]
v_pk_mul_f32 v[52:53], v[44:45], v[44:45]
v_pk_mul_f32 v[54:55], v[46:47], v[46:47]
v_pk_fma_f32 v[48:49], v[48:49], v[242:243], v[240:241]
v_pk_fma_f32 v[50:51], v[50:51], v[242:243], v[240:241]
v_pk_fma_f32 v[52:53], v[52:53], v[242:243], v[240:241]
v_pk_fma_f32 v[54:55], v[54:55], v[242:243], v[240:241]
v_pk_mul_f32 v[48:49], v[48:49], v[40:41]
v_pk_mul_f32 v[50:51], v[50:51], v[42:43]
v_pk_mul_f32 v[52:53], v[52:53], v[44:45]
v_pk_mul_f32 v[54:55], v[54:55], v[46:47]
v_exp_f32 v48, v48
v_exp_f32 v49, v49
v_exp_f32 v50, v50
v_exp_f32 v51, v51
v_exp_f32 v52, v52
v_exp_f32 v53, v53
v_exp_f32 v54, v54
v_exp_f32 v55, v55
v_pk_add_f32 v[48:49], v[48:49], v[244:245]
v_pk_add_f32 v[50:51], v[50:51], v[244:245]
v_pk_add_f32 v[52:53], v[52:53], v[244:245]
v_pk_add_f32 v[54:55], v[54:55], v[244:245]
v_rcp_f32 v48, v48
v_rcp_f32 v49, v49
v_rcp_f32 v50, v50
v_rcp_f32 v51, v51
v_rcp_f32 v52, v52
v_rcp_f32 v53, v53
v_rcp_f32 v54, v54
v_rcp_f32 v55, v55
v_pk_mul_f32 v[40:41], v[48:49], v[40:41]
v_pk_mul_f32 v[42:43], v[50:51], v[42:43]
v_pk_mul_f32 v[44:45], v[52:53], v[44:45]
v_pk_mul_f32 v[46:47], v[54:55], v[46:47]
v_cvt_pk_bf16_f32 v56, v40, v41
v_cvt_pk_bf16_f32 v57, v42, v43
v_cvt_pk_bf16_f32 v58, v44, v45
v_cvt_pk_bf16_f32 v59, v46, v47
buffer_store_dwordx4 v[56:59], v145, s[4:7], s53 offen offset:2048 sc1
v_accvgpr_read_b32 v0, a120
v_accvgpr_read_b32 v1, a121
v_accvgpr_read_b32 v2, a122
v_accvgpr_read_b32 v3, a123
v_accvgpr_read_b32 v4, a124
v_accvgpr_read_b32 v5, a125
v_accvgpr_read_b32 v6, a126
v_accvgpr_read_b32 v7, a127
v_pk_mul_f32 v[8:9], v[0:1], v[0:1]
v_pk_mul_f32 v[10:11], v[2:3], v[2:3]
v_pk_mul_f32 v[12:13], v[4:5], v[4:5]
v_pk_mul_f32 v[14:15], v[6:7], v[6:7]
v_pk_fma_f32 v[8:9], v[8:9], v[242:243], v[240:241]
v_pk_fma_f32 v[10:11], v[10:11], v[242:243], v[240:241]
v_pk_fma_f32 v[12:13], v[12:13], v[242:243], v[240:241]
v_pk_fma_f32 v[14:15], v[14:15], v[242:243], v[240:241]
v_pk_mul_f32 v[8:9], v[8:9], v[0:1]
v_pk_mul_f32 v[10:11], v[10:11], v[2:3]
v_pk_mul_f32 v[12:13], v[12:13], v[4:5]
v_pk_mul_f32 v[14:15], v[14:15], v[6:7]
v_exp_f32 v8, v8
v_exp_f32 v9, v9
v_exp_f32 v10, v10
v_exp_f32 v11, v11
v_exp_f32 v12, v12
v_exp_f32 v13, v13
v_exp_f32 v14, v14
v_exp_f32 v15, v15
v_pk_add_f32 v[8:9], v[8:9], v[244:245]
v_pk_add_f32 v[10:11], v[10:11], v[244:245]
v_pk_add_f32 v[12:13], v[12:13], v[244:245]
v_pk_add_f32 v[14:15], v[14:15], v[244:245]
v_rcp_f32 v8, v8
v_rcp_f32 v9, v9
v_rcp_f32 v10, v10
v_rcp_f32 v11, v11
v_rcp_f32 v12, v12
v_rcp_f32 v13, v13
v_rcp_f32 v14, v14
v_rcp_f32 v15, v15
v_pk_mul_f32 v[0:1], v[8:9], v[0:1]
v_pk_mul_f32 v[2:3], v[10:11], v[2:3]
v_pk_mul_f32 v[4:5], v[12:13], v[4:5]
v_pk_mul_f32 v[6:7], v[14:15], v[6:7]
v_cvt_pk_bf16_f32 v16, v0, v1
v_cvt_pk_bf16_f32 v17, v2, v3
v_cvt_pk_bf16_f32 v18, v4, v5
v_cvt_pk_bf16_f32 v19, v6, v7
buffer_store_dwordx4 v[16:19], v145, s[4:7], s53 offen offset:3072 sc1
s_branch main_kernel_w_ee
main_kernel_w_e10:
s_mov_b32 s53, s1
v_accvgpr_read_b32 v0, a0
v_accvgpr_read_b32 v1, a1
v_accvgpr_read_b32 v2, a2
v_accvgpr_read_b32 v3, a3
v_accvgpr_read_b32 v4, a4
v_accvgpr_read_b32 v5, a5
v_accvgpr_read_b32 v6, a6
v_accvgpr_read_b32 v7, a7
v_pk_mul_f32 v[8:9], v[0:1], v[0:1]
v_pk_mul_f32 v[10:11], v[2:3], v[2:3]
v_pk_mul_f32 v[12:13], v[4:5], v[4:5]
v_pk_mul_f32 v[14:15], v[6:7], v[6:7]
v_pk_fma_f32 v[8:9], v[8:9], v[242:243], v[240:241]
v_pk_fma_f32 v[10:11], v[10:11], v[242:243], v[240:241]
v_pk_fma_f32 v[12:13], v[12:13], v[242:243], v[240:241]
v_pk_fma_f32 v[14:15], v[14:15], v[242:243], v[240:241]
v_pk_mul_f32 v[8:9], v[8:9], v[0:1]
v_pk_mul_f32 v[10:11], v[10:11], v[2:3]
v_pk_mul_f32 v[12:13], v[12:13], v[4:5]
v_pk_mul_f32 v[14:15], v[14:15], v[6:7]
v_exp_f32 v8, v8
v_exp_f32 v9, v9
v_exp_f32 v10, v10
v_exp_f32 v11, v11
v_exp_f32 v12, v12
v_exp_f32 v13, v13
v_exp_f32 v14, v14
v_exp_f32 v15, v15
v_pk_add_f32 v[8:9], v[8:9], v[244:245]
v_pk_add_f32 v[10:11], v[10:11], v[244:245]
v_pk_add_f32 v[12:13], v[12:13], v[244:245]
v_pk_add_f32 v[14:15], v[14:15], v[244:245]
v_rcp_f32 v8, v8
v_rcp_f32 v9, v9
v_rcp_f32 v10, v10
v_rcp_f32 v11, v11
v_rcp_f32 v12, v12
v_rcp_f32 v13, v13
v_rcp_f32 v14, v14
v_rcp_f32 v15, v15
v_pk_mul_f32 v[0:1], v[8:9], v[0:1]
v_pk_mul_f32 v[2:3], v[10:11], v[2:3]
v_pk_mul_f32 v[4:5], v[12:13], v[4:5]
v_pk_mul_f32 v[6:7], v[14:15], v[6:7]
v_cvt_pk_bf16_f32 v16, v0, v1
v_cvt_pk_bf16_f32 v17, v2, v3
v_cvt_pk_bf16_f32 v18, v4, v5
v_cvt_pk_bf16_f32 v19, v6, v7
buffer_store_dwordx4 v[16:19], v251, s[4:7], s53 offen offset:0 sc1
v_accvgpr_read_b32 v20, a8
v_accvgpr_read_b32 v21, a9
v_accvgpr_read_b32 v22, a10
v_accvgpr_read_b32 v23, a11
v_accvgpr_read_b32 v24, a12
v_accvgpr_read_b32 v25, a13
v_accvgpr_read_b32 v26, a14
v_accvgpr_read_b32 v27, a15
v_pk_mul_f32 v[28:29], v[20:21], v[20:21]
v_pk_mul_f32 v[30:31], v[22:23], v[22:23]
v_pk_mul_f32 v[32:33], v[24:25], v[24:25]
v_pk_mul_f32 v[34:35], v[26:27], v[26:27]
v_pk_fma_f32 v[28:29], v[28:29], v[242:243], v[240:241]
v_pk_fma_f32 v[30:31], v[30:31], v[242:243], v[240:241]
v_pk_fma_f32 v[32:33], v[32:33], v[242:243], v[240:241]
v_pk_fma_f32 v[34:35], v[34:35], v[242:243], v[240:241]
v_pk_mul_f32 v[28:29], v[28:29], v[20:21]
v_pk_mul_f32 v[30:31], v[30:31], v[22:23]
v_pk_mul_f32 v[32:33], v[32:33], v[24:25]
v_pk_mul_f32 v[34:35], v[34:35], v[26:27]
v_exp_f32 v28, v28
v_exp_f32 v29, v29
v_exp_f32 v30, v30
v_exp_f32 v31, v31
v_exp_f32 v32, v32
v_exp_f32 v33, v33
v_exp_f32 v34, v34
v_exp_f32 v35, v35
v_pk_add_f32 v[28:29], v[28:29], v[244:245]
v_pk_add_f32 v[30:31], v[30:31], v[244:245]
v_pk_add_f32 v[32:33], v[32:33], v[244:245]
v_pk_add_f32 v[34:35], v[34:35], v[244:245]
v_rcp_f32 v28, v28
v_rcp_f32 v29, v29
v_rcp_f32 v30, v30
v_rcp_f32 v31, v31
v_rcp_f32 v32, v32
v_rcp_f32 v33, v33
v_rcp_f32 v34, v34
v_rcp_f32 v35, v35
v_pk_mul_f32 v[20:21], v[28:29], v[20:21]
v_pk_mul_f32 v[22:23], v[30:31], v[22:23]
v_pk_mul_f32 v[24:25], v[32:33], v[24:25]
v_pk_mul_f32 v[26:27], v[34:35], v[26:27]
v_cvt_pk_bf16_f32 v36, v20, v21
v_cvt_pk_bf16_f32 v37, v22, v23
v_cvt_pk_bf16_f32 v38, v24, v25
v_cvt_pk_bf16_f32 v39, v26, v27
buffer_store_dwordx4 v[36:39], v251, s[4:7], s53 offen offset:1024 sc1
v_accvgpr_read_b32 v40, a16
v_accvgpr_read_b32 v41, a17
v_accvgpr_read_b32 v42, a18
v_accvgpr_read_b32 v43, a19
v_accvgpr_read_b32 v44, a20
v_accvgpr_read_b32 v45, a21
v_accvgpr_read_b32 v46, a22
v_accvgpr_read_b32 v47, a23
v_pk_mul_f32 v[48:49], v[40:41], v[40:41]
v_pk_mul_f32 v[50:51], v[42:43], v[42:43]
v_pk_mul_f32 v[52:53], v[44:45], v[44:45]
v_pk_mul_f32 v[54:55], v[46:47], v[46:47]
v_pk_fma_f32 v[48:49], v[48:49], v[242:243], v[240:241]
v_pk_fma_f32 v[50:51], v[50:51], v[242:243], v[240:241]
v_pk_fma_f32 v[52:53], v[52:53], v[242:243], v[240:241]
v_pk_fma_f32 v[54:55], v[54:55], v[242:243], v[240:241]
v_pk_mul_f32 v[48:49], v[48:49], v[40:41]
v_pk_mul_f32 v[50:51], v[50:51], v[42:43]
v_pk_mul_f32 v[52:53], v[52:53], v[44:45]
v_pk_mul_f32 v[54:55], v[54:55], v[46:47]
v_exp_f32 v48, v48
v_exp_f32 v49, v49
v_exp_f32 v50, v50
v_exp_f32 v51, v51
v_exp_f32 v52, v52
v_exp_f32 v53, v53
v_exp_f32 v54, v54
v_exp_f32 v55, v55
v_pk_add_f32 v[48:49], v[48:49], v[244:245]
v_pk_add_f32 v[50:51], v[50:51], v[244:245]
v_pk_add_f32 v[52:53], v[52:53], v[244:245]
v_pk_add_f32 v[54:55], v[54:55], v[244:245]
v_rcp_f32 v48, v48
v_rcp_f32 v49, v49
v_rcp_f32 v50, v50
v_rcp_f32 v51, v51
v_rcp_f32 v52, v52
v_rcp_f32 v53, v53
v_rcp_f32 v54, v54
v_rcp_f32 v55, v55
v_pk_mul_f32 v[40:41], v[48:49], v[40:41]
v_pk_mul_f32 v[42:43], v[50:51], v[42:43]
v_pk_mul_f32 v[44:45], v[52:53], v[44:45]
v_pk_mul_f32 v[46:47], v[54:55], v[46:47]
v_cvt_pk_bf16_f32 v56, v40, v41
v_cvt_pk_bf16_f32 v57, v42, v43
v_cvt_pk_bf16_f32 v58, v44, v45
v_cvt_pk_bf16_f32 v59, v46, v47
buffer_store_dwordx4 v[56:59], v251, s[4:7], s53 offen offset:2048 sc1
v_accvgpr_read_b32 v0, a24
v_accvgpr_read_b32 v1, a25
v_accvgpr_read_b32 v2, a26
v_accvgpr_read_b32 v3, a27
v_accvgpr_read_b32 v4, a28
v_accvgpr_read_b32 v5, a29
v_accvgpr_read_b32 v6, a30
v_accvgpr_read_b32 v7, a31
v_pk_mul_f32 v[8:9], v[0:1], v[0:1]
v_pk_mul_f32 v[10:11], v[2:3], v[2:3]
v_pk_mul_f32 v[12:13], v[4:5], v[4:5]
v_pk_mul_f32 v[14:15], v[6:7], v[6:7]
v_pk_fma_f32 v[8:9], v[8:9], v[242:243], v[240:241]
v_pk_fma_f32 v[10:11], v[10:11], v[242:243], v[240:241]
v_pk_fma_f32 v[12:13], v[12:13], v[242:243], v[240:241]
v_pk_fma_f32 v[14:15], v[14:15], v[242:243], v[240:241]
v_pk_mul_f32 v[8:9], v[8:9], v[0:1]
v_pk_mul_f32 v[10:11], v[10:11], v[2:3]
v_pk_mul_f32 v[12:13], v[12:13], v[4:5]
v_pk_mul_f32 v[14:15], v[14:15], v[6:7]
v_exp_f32 v8, v8
v_exp_f32 v9, v9
v_exp_f32 v10, v10
v_exp_f32 v11, v11
v_exp_f32 v12, v12
v_exp_f32 v13, v13
v_exp_f32 v14, v14
v_exp_f32 v15, v15
v_pk_add_f32 v[8:9], v[8:9], v[244:245]
v_pk_add_f32 v[10:11], v[10:11], v[244:245]
v_pk_add_f32 v[12:13], v[12:13], v[244:245]
v_pk_add_f32 v[14:15], v[14:15], v[244:245]
v_rcp_f32 v8, v8
v_rcp_f32 v9, v9
v_rcp_f32 v10, v10
v_rcp_f32 v11, v11
v_rcp_f32 v12, v12
v_rcp_f32 v13, v13
v_rcp_f32 v14, v14
v_rcp_f32 v15, v15
v_pk_mul_f32 v[0:1], v[8:9], v[0:1]
v_pk_mul_f32 v[2:3], v[10:11], v[2:3]
v_pk_mul_f32 v[4:5], v[12:13], v[4:5]
v_pk_mul_f32 v[6:7], v[14:15], v[6:7]
v_cvt_pk_bf16_f32 v16, v0, v1
v_cvt_pk_bf16_f32 v17, v2, v3
v_cvt_pk_bf16_f32 v18, v4, v5
v_cvt_pk_bf16_f32 v19, v6, v7
buffer_store_dwordx4 v[16:19], v251, s[4:7], s53 offen offset:3072 sc1
s_add_u32 s53, s53, s2
v_accvgpr_read_b32 v20, a32
v_accvgpr_read_b32 v21, a33
v_accvgpr_read_b32 v22, a34
v_accvgpr_read_b32 v23, a35
v_accvgpr_read_b32 v24, a36
v_accvgpr_read_b32 v25, a37
v_accvgpr_read_b32 v26, a38
v_accvgpr_read_b32 v27, a39
v_pk_mul_f32 v[28:29], v[20:21], v[20:21]
v_pk_mul_f32 v[30:31], v[22:23], v[22:23]
v_pk_mul_f32 v[32:33], v[24:25], v[24:25]
v_pk_mul_f32 v[34:35], v[26:27], v[26:27]
v_pk_fma_f32 v[28:29], v[28:29], v[242:243], v[240:241]
v_pk_fma_f32 v[30:31], v[30:31], v[242:243], v[240:241]
v_pk_fma_f32 v[32:33], v[32:33], v[242:243], v[240:241]
v_pk_fma_f32 v[34:35], v[34:35], v[242:243], v[240:241]
v_pk_mul_f32 v[28:29], v[28:29], v[20:21]
v_pk_mul_f32 v[30:31], v[30:31], v[22:23]
v_pk_mul_f32 v[32:33], v[32:33], v[24:25]
v_pk_mul_f32 v[34:35], v[34:35], v[26:27]
v_exp_f32 v28, v28
v_exp_f32 v29, v29
v_exp_f32 v30, v30
v_exp_f32 v31, v31
v_exp_f32 v32, v32
v_exp_f32 v33, v33
v_exp_f32 v34, v34
v_exp_f32 v35, v35
v_pk_add_f32 v[28:29], v[28:29], v[244:245]
v_pk_add_f32 v[30:31], v[30:31], v[244:245]
v_pk_add_f32 v[32:33], v[32:33], v[244:245]
v_pk_add_f32 v[34:35], v[34:35], v[244:245]
v_rcp_f32 v28, v28
v_rcp_f32 v29, v29
v_rcp_f32 v30, v30
v_rcp_f32 v31, v31
v_rcp_f32 v32, v32
v_rcp_f32 v33, v33
v_rcp_f32 v34, v34
v_rcp_f32 v35, v35
v_pk_mul_f32 v[20:21], v[28:29], v[20:21]
v_pk_mul_f32 v[22:23], v[30:31], v[22:23]
v_pk_mul_f32 v[24:25], v[32:33], v[24:25]
v_pk_mul_f32 v[26:27], v[34:35], v[26:27]
v_cvt_pk_bf16_f32 v36, v20, v21
v_cvt_pk_bf16_f32 v37, v22, v23
v_cvt_pk_bf16_f32 v38, v24, v25
v_cvt_pk_bf16_f32 v39, v26, v27
buffer_store_dwordx4 v[36:39], v251, s[4:7], s53 offen offset:0 sc1
v_accvgpr_read_b32 v40, a40
v_accvgpr_read_b32 v41, a41
v_accvgpr_read_b32 v42, a42
v_accvgpr_read_b32 v43, a43
v_accvgpr_read_b32 v44, a44
v_accvgpr_read_b32 v45, a45
v_accvgpr_read_b32 v46, a46
v_accvgpr_read_b32 v47, a47
v_pk_mul_f32 v[48:49], v[40:41], v[40:41]
v_pk_mul_f32 v[50:51], v[42:43], v[42:43]
v_pk_mul_f32 v[52:53], v[44:45], v[44:45]
v_pk_mul_f32 v[54:55], v[46:47], v[46:47]
v_pk_fma_f32 v[48:49], v[48:49], v[242:243], v[240:241]
v_pk_fma_f32 v[50:51], v[50:51], v[242:243], v[240:241]
v_pk_fma_f32 v[52:53], v[52:53], v[242:243], v[240:241]
v_pk_fma_f32 v[54:55], v[54:55], v[242:243], v[240:241]
v_pk_mul_f32 v[48:49], v[48:49], v[40:41]
v_pk_mul_f32 v[50:51], v[50:51], v[42:43]
v_pk_mul_f32 v[52:53], v[52:53], v[44:45]
v_pk_mul_f32 v[54:55], v[54:55], v[46:47]
v_exp_f32 v48, v48
v_exp_f32 v49, v49
v_exp_f32 v50, v50
v_exp_f32 v51, v51
v_exp_f32 v52, v52
v_exp_f32 v53, v53
v_exp_f32 v54, v54
v_exp_f32 v55, v55
v_pk_add_f32 v[48:49], v[48:49], v[244:245]
v_pk_add_f32 v[50:51], v[50:51], v[244:245]
v_pk_add_f32 v[52:53], v[52:53], v[244:245]
v_pk_add_f32 v[54:55], v[54:55], v[244:245]
v_rcp_f32 v48, v48
v_rcp_f32 v49, v49
v_rcp_f32 v50, v50
v_rcp_f32 v51, v51
v_rcp_f32 v52, v52
v_rcp_f32 v53, v53
v_rcp_f32 v54, v54
v_rcp_f32 v55, v55
v_pk_mul_f32 v[40:41], v[48:49], v[40:41]
v_pk_mul_f32 v[42:43], v[50:51], v[42:43]
v_pk_mul_f32 v[44:45], v[52:53], v[44:45]
v_pk_mul_f32 v[46:47], v[54:55], v[46:47]
v_cvt_pk_bf16_f32 v56, v40, v41
v_cvt_pk_bf16_f32 v57, v42, v43
v_cvt_pk_bf16_f32 v58, v44, v45
v_cvt_pk_bf16_f32 v59, v46, v47
buffer_store_dwordx4 v[56:59], v251, s[4:7], s53 offen offset:1024 sc1
v_accvgpr_read_b32 v0, a48
v_accvgpr_read_b32 v1, a49
v_accvgpr_read_b32 v2, a50
v_accvgpr_read_b32 v3, a51
v_accvgpr_read_b32 v4, a52
v_accvgpr_read_b32 v5, a53
v_accvgpr_read_b32 v6, a54
v_accvgpr_read_b32 v7, a55
v_pk_mul_f32 v[8:9], v[0:1], v[0:1]
v_pk_mul_f32 v[10:11], v[2:3], v[2:3]
v_pk_mul_f32 v[12:13], v[4:5], v[4:5]
v_pk_mul_f32 v[14:15], v[6:7], v[6:7]
v_pk_fma_f32 v[8:9], v[8:9], v[242:243], v[240:241]
v_pk_fma_f32 v[10:11], v[10:11], v[242:243], v[240:241]
v_pk_fma_f32 v[12:13], v[12:13], v[242:243], v[240:241]
v_pk_fma_f32 v[14:15], v[14:15], v[242:243], v[240:241]
v_pk_mul_f32 v[8:9], v[8:9], v[0:1]
v_pk_mul_f32 v[10:11], v[10:11], v[2:3]
v_pk_mul_f32 v[12:13], v[12:13], v[4:5]
v_pk_mul_f32 v[14:15], v[14:15], v[6:7]
v_exp_f32 v8, v8
v_exp_f32 v9, v9
v_exp_f32 v10, v10
v_exp_f32 v11, v11
v_exp_f32 v12, v12
v_exp_f32 v13, v13
v_exp_f32 v14, v14
v_exp_f32 v15, v15
v_pk_add_f32 v[8:9], v[8:9], v[244:245]
v_pk_add_f32 v[10:11], v[10:11], v[244:245]
v_pk_add_f32 v[12:13], v[12:13], v[244:245]
v_pk_add_f32 v[14:15], v[14:15], v[244:245]
v_rcp_f32 v8, v8
v_rcp_f32 v9, v9
v_rcp_f32 v10, v10
v_rcp_f32 v11, v11
v_rcp_f32 v12, v12
v_rcp_f32 v13, v13
v_rcp_f32 v14, v14
v_rcp_f32 v15, v15
v_pk_mul_f32 v[0:1], v[8:9], v[0:1]
v_pk_mul_f32 v[2:3], v[10:11], v[2:3]
v_pk_mul_f32 v[4:5], v[12:13], v[4:5]
v_pk_mul_f32 v[6:7], v[14:15], v[6:7]
v_cvt_pk_bf16_f32 v16, v0, v1
v_cvt_pk_bf16_f32 v17, v2, v3
v_cvt_pk_bf16_f32 v18, v4, v5
v_cvt_pk_bf16_f32 v19, v6, v7
buffer_store_dwordx4 v[16:19], v251, s[4:7], s53 offen offset:2048 sc1
v_accvgpr_read_b32 v20, a56
v_accvgpr_read_b32 v21, a57
v_accvgpr_read_b32 v22, a58
v_accvgpr_read_b32 v23, a59
v_accvgpr_read_b32 v24, a60
v_accvgpr_read_b32 v25, a61
v_accvgpr_read_b32 v26, a62
v_accvgpr_read_b32 v27, a63
v_pk_mul_f32 v[28:29], v[20:21], v[20:21]
v_pk_mul_f32 v[30:31], v[22:23], v[22:23]
v_pk_mul_f32 v[32:33], v[24:25], v[24:25]
v_pk_mul_f32 v[34:35], v[26:27], v[26:27]
v_pk_fma_f32 v[28:29], v[28:29], v[242:243], v[240:241]
v_pk_fma_f32 v[30:31], v[30:31], v[242:243], v[240:241]
v_pk_fma_f32 v[32:33], v[32:33], v[242:243], v[240:241]
v_pk_fma_f32 v[34:35], v[34:35], v[242:243], v[240:241]
v_pk_mul_f32 v[28:29], v[28:29], v[20:21]
v_pk_mul_f32 v[30:31], v[30:31], v[22:23]
v_pk_mul_f32 v[32:33], v[32:33], v[24:25]
v_pk_mul_f32 v[34:35], v[34:35], v[26:27]
v_exp_f32 v28, v28
v_exp_f32 v29, v29
v_exp_f32 v30, v30
v_exp_f32 v31, v31
v_exp_f32 v32, v32
v_exp_f32 v33, v33
v_exp_f32 v34, v34
v_exp_f32 v35, v35
v_pk_add_f32 v[28:29], v[28:29], v[244:245]
v_pk_add_f32 v[30:31], v[30:31], v[244:245]
v_pk_add_f32 v[32:33], v[32:33], v[244:245]
v_pk_add_f32 v[34:35], v[34:35], v[244:245]
v_rcp_f32 v28, v28
v_rcp_f32 v29, v29
v_rcp_f32 v30, v30
v_rcp_f32 v31, v31
v_rcp_f32 v32, v32
v_rcp_f32 v33, v33
v_rcp_f32 v34, v34
v_rcp_f32 v35, v35
v_pk_mul_f32 v[20:21], v[28:29], v[20:21]
v_pk_mul_f32 v[22:23], v[30:31], v[22:23]
v_pk_mul_f32 v[24:25], v[32:33], v[24:25]
v_pk_mul_f32 v[26:27], v[34:35], v[26:27]
v_cvt_pk_bf16_f32 v36, v20, v21
v_cvt_pk_bf16_f32 v37, v22, v23
v_cvt_pk_bf16_f32 v38, v24, v25
v_cvt_pk_bf16_f32 v39, v26, v27
buffer_store_dwordx4 v[36:39], v251, s[4:7], s53 offen offset:3072 sc1
s_add_u32 s53, s53, s2
v_accvgpr_read_b32 v40, a64
v_accvgpr_read_b32 v41, a65
v_accvgpr_read_b32 v42, a66
v_accvgpr_read_b32 v43, a67
v_accvgpr_read_b32 v44, a68
v_accvgpr_read_b32 v45, a69
v_accvgpr_read_b32 v46, a70
v_accvgpr_read_b32 v47, a71
v_pk_mul_f32 v[48:49], v[40:41], v[40:41]
v_pk_mul_f32 v[50:51], v[42:43], v[42:43]
v_pk_mul_f32 v[52:53], v[44:45], v[44:45]
v_pk_mul_f32 v[54:55], v[46:47], v[46:47]
v_pk_fma_f32 v[48:49], v[48:49], v[242:243], v[240:241]
v_pk_fma_f32 v[50:51], v[50:51], v[242:243], v[240:241]
v_pk_fma_f32 v[52:53], v[52:53], v[242:243], v[240:241]
v_pk_fma_f32 v[54:55], v[54:55], v[242:243], v[240:241]
v_pk_mul_f32 v[48:49], v[48:49], v[40:41]
v_pk_mul_f32 v[50:51], v[50:51], v[42:43]
v_pk_mul_f32 v[52:53], v[52:53], v[44:45]
v_pk_mul_f32 v[54:55], v[54:55], v[46:47]
v_exp_f32 v48, v48
v_exp_f32 v49, v49
v_exp_f32 v50, v50
v_exp_f32 v51, v51
v_exp_f32 v52, v52
v_exp_f32 v53, v53
v_exp_f32 v54, v54
v_exp_f32 v55, v55
v_pk_add_f32 v[48:49], v[48:49], v[244:245]
v_pk_add_f32 v[50:51], v[50:51], v[244:245]
v_pk_add_f32 v[52:53], v[52:53], v[244:245]
v_pk_add_f32 v[54:55], v[54:55], v[244:245]
v_rcp_f32 v48, v48
v_rcp_f32 v49, v49
v_rcp_f32 v50, v50
v_rcp_f32 v51, v51
v_rcp_f32 v52, v52
v_rcp_f32 v53, v53
v_rcp_f32 v54, v54
v_rcp_f32 v55, v55
v_pk_mul_f32 v[40:41], v[48:49], v[40:41]
v_pk_mul_f32 v[42:43], v[50:51], v[42:43]
v_pk_mul_f32 v[44:45], v[52:53], v[44:45]
v_pk_mul_f32 v[46:47], v[54:55], v[46:47]
v_cvt_pk_bf16_f32 v56, v40, v41
v_cvt_pk_bf16_f32 v57, v42, v43
v_cvt_pk_bf16_f32 v58, v44, v45
v_cvt_pk_bf16_f32 v59, v46, v47
buffer_store_dwordx4 v[56:59], v251, s[4:7], s53 offen offset:0 sc1
v_accvgpr_read_b32 v0, a72
v_accvgpr_read_b32 v1, a73
v_accvgpr_read_b32 v2, a74
v_accvgpr_read_b32 v3, a75
v_accvgpr_read_b32 v4, a76
v_accvgpr_read_b32 v5, a77
v_accvgpr_read_b32 v6, a78
v_accvgpr_read_b32 v7, a79
v_pk_mul_f32 v[8:9], v[0:1], v[0:1]
v_pk_mul_f32 v[10:11], v[2:3], v[2:3]
v_pk_mul_f32 v[12:13], v[4:5], v[4:5]
v_pk_mul_f32 v[14:15], v[6:7], v[6:7]
v_pk_fma_f32 v[8:9], v[8:9], v[242:243], v[240:241]
v_pk_fma_f32 v[10:11], v[10:11], v[242:243], v[240:241]
v_pk_fma_f32 v[12:13], v[12:13], v[242:243], v[240:241]
v_pk_fma_f32 v[14:15], v[14:15], v[242:243], v[240:241]
v_pk_mul_f32 v[8:9], v[8:9], v[0:1]
v_pk_mul_f32 v[10:11], v[10:11], v[2:3]
v_pk_mul_f32 v[12:13], v[12:13], v[4:5]
v_pk_mul_f32 v[14:15], v[14:15], v[6:7]
v_exp_f32 v8, v8
v_exp_f32 v9, v9
v_exp_f32 v10, v10
v_exp_f32 v11, v11
v_exp_f32 v12, v12
v_exp_f32 v13, v13
v_exp_f32 v14, v14
v_exp_f32 v15, v15
v_pk_add_f32 v[8:9], v[8:9], v[244:245]
v_pk_add_f32 v[10:11], v[10:11], v[244:245]
v_pk_add_f32 v[12:13], v[12:13], v[244:245]
v_pk_add_f32 v[14:15], v[14:15], v[244:245]
v_rcp_f32 v8, v8
v_rcp_f32 v9, v9
v_rcp_f32 v10, v10
v_rcp_f32 v11, v11
v_rcp_f32 v12, v12
v_rcp_f32 v13, v13
v_rcp_f32 v14, v14
v_rcp_f32 v15, v15
v_pk_mul_f32 v[0:1], v[8:9], v[0:1]
v_pk_mul_f32 v[2:3], v[10:11], v[2:3]
v_pk_mul_f32 v[4:5], v[12:13], v[4:5]
v_pk_mul_f32 v[6:7], v[14:15], v[6:7]
v_cvt_pk_bf16_f32 v16, v0, v1
v_cvt_pk_bf16_f32 v17, v2, v3
v_cvt_pk_bf16_f32 v18, v4, v5
v_cvt_pk_bf16_f32 v19, v6, v7
buffer_store_dwordx4 v[16:19], v251, s[4:7], s53 offen offset:1024 sc1
v_accvgpr_read_b32 v20, a80
v_accvgpr_read_b32 v21, a81
v_accvgpr_read_b32 v22, a82
v_accvgpr_read_b32 v23, a83
v_accvgpr_read_b32 v24, a84
v_accvgpr_read_b32 v25, a85
v_accvgpr_read_b32 v26, a86
v_accvgpr_read_b32 v27, a87
v_pk_mul_f32 v[28:29], v[20:21], v[20:21]
v_pk_mul_f32 v[30:31], v[22:23], v[22:23]
v_pk_mul_f32 v[32:33], v[24:25], v[24:25]
v_pk_mul_f32 v[34:35], v[26:27], v[26:27]
v_pk_fma_f32 v[28:29], v[28:29], v[242:243], v[240:241]
v_pk_fma_f32 v[30:31], v[30:31], v[242:243], v[240:241]
v_pk_fma_f32 v[32:33], v[32:33], v[242:243], v[240:241]
v_pk_fma_f32 v[34:35], v[34:35], v[242:243], v[240:241]
v_pk_mul_f32 v[28:29], v[28:29], v[20:21]
v_pk_mul_f32 v[30:31], v[30:31], v[22:23]
v_pk_mul_f32 v[32:33], v[32:33], v[24:25]
v_pk_mul_f32 v[34:35], v[34:35], v[26:27]
v_exp_f32 v28, v28
v_exp_f32 v29, v29
v_exp_f32 v30, v30
v_exp_f32 v31, v31
v_exp_f32 v32, v32
v_exp_f32 v33, v33
v_exp_f32 v34, v34
v_exp_f32 v35, v35
v_pk_add_f32 v[28:29], v[28:29], v[244:245]
v_pk_add_f32 v[30:31], v[30:31], v[244:245]
v_pk_add_f32 v[32:33], v[32:33], v[244:245]
v_pk_add_f32 v[34:35], v[34:35], v[244:245]
v_rcp_f32 v28, v28
v_rcp_f32 v29, v29
v_rcp_f32 v30, v30
v_rcp_f32 v31, v31
v_rcp_f32 v32, v32
v_rcp_f32 v33, v33
v_rcp_f32 v34, v34
v_rcp_f32 v35, v35
v_pk_mul_f32 v[20:21], v[28:29], v[20:21]
v_pk_mul_f32 v[22:23], v[30:31], v[22:23]
v_pk_mul_f32 v[24:25], v[32:33], v[24:25]
v_pk_mul_f32 v[26:27], v[34:35], v[26:27]
v_cvt_pk_bf16_f32 v36, v20, v21
v_cvt_pk_bf16_f32 v37, v22, v23
v_cvt_pk_bf16_f32 v38, v24, v25
v_cvt_pk_bf16_f32 v39, v26, v27
buffer_store_dwordx4 v[36:39], v251, s[4:7], s53 offen offset:2048 sc1
v_accvgpr_read_b32 v40, a88
v_accvgpr_read_b32 v41, a89
v_accvgpr_read_b32 v42, a90
v_accvgpr_read_b32 v43, a91
v_accvgpr_read_b32 v44, a92
v_accvgpr_read_b32 v45, a93
v_accvgpr_read_b32 v46, a94
v_accvgpr_read_b32 v47, a95
v_pk_mul_f32 v[48:49], v[40:41], v[40:41]
v_pk_mul_f32 v[50:51], v[42:43], v[42:43]
v_pk_mul_f32 v[52:53], v[44:45], v[44:45]
v_pk_mul_f32 v[54:55], v[46:47], v[46:47]
v_pk_fma_f32 v[48:49], v[48:49], v[242:243], v[240:241]
v_pk_fma_f32 v[50:51], v[50:51], v[242:243], v[240:241]
v_pk_fma_f32 v[52:53], v[52:53], v[242:243], v[240:241]
v_pk_fma_f32 v[54:55], v[54:55], v[242:243], v[240:241]
v_pk_mul_f32 v[48:49], v[48:49], v[40:41]
v_pk_mul_f32 v[50:51], v[50:51], v[42:43]
v_pk_mul_f32 v[52:53], v[52:53], v[44:45]
v_pk_mul_f32 v[54:55], v[54:55], v[46:47]
v_exp_f32 v48, v48
v_exp_f32 v49, v49
v_exp_f32 v50, v50
v_exp_f32 v51, v51
v_exp_f32 v52, v52
v_exp_f32 v53, v53
v_exp_f32 v54, v54
v_exp_f32 v55, v55
v_pk_add_f32 v[48:49], v[48:49], v[244:245]
v_pk_add_f32 v[50:51], v[50:51], v[244:245]
v_pk_add_f32 v[52:53], v[52:53], v[244:245]
v_pk_add_f32 v[54:55], v[54:55], v[244:245]
v_rcp_f32 v48, v48
v_rcp_f32 v49, v49
v_rcp_f32 v50, v50
v_rcp_f32 v51, v51
v_rcp_f32 v52, v52
v_rcp_f32 v53, v53
v_rcp_f32 v54, v54
v_rcp_f32 v55, v55
v_pk_mul_f32 v[40:41], v[48:49], v[40:41]
v_pk_mul_f32 v[42:43], v[50:51], v[42:43]
v_pk_mul_f32 v[44:45], v[52:53], v[44:45]
v_pk_mul_f32 v[46:47], v[54:55], v[46:47]
v_cvt_pk_bf16_f32 v56, v40, v41
v_cvt_pk_bf16_f32 v57, v42, v43
v_cvt_pk_bf16_f32 v58, v44, v45
v_cvt_pk_bf16_f32 v59, v46, v47
buffer_store_dwordx4 v[56:59], v251, s[4:7], s53 offen offset:3072 sc1
s_add_u32 s53, s53, s2
v_accvgpr_read_b32 v0, a96
v_accvgpr_read_b32 v1, a97
v_accvgpr_read_b32 v2, a98
v_accvgpr_read_b32 v3, a99
v_accvgpr_read_b32 v4, a100
v_accvgpr_read_b32 v5, a101
v_accvgpr_read_b32 v6, a102
v_accvgpr_read_b32 v7, a103
v_pk_mul_f32 v[8:9], v[0:1], v[0:1]
v_pk_mul_f32 v[10:11], v[2:3], v[2:3]
v_pk_mul_f32 v[12:13], v[4:5], v[4:5]
v_pk_mul_f32 v[14:15], v[6:7], v[6:7]
v_pk_fma_f32 v[8:9], v[8:9], v[242:243], v[240:241]
v_pk_fma_f32 v[10:11], v[10:11], v[242:243], v[240:241]
v_pk_fma_f32 v[12:13], v[12:13], v[242:243], v[240:241]
v_pk_fma_f32 v[14:15], v[14:15], v[242:243], v[240:241]
v_pk_mul_f32 v[8:9], v[8:9], v[0:1]
v_pk_mul_f32 v[10:11], v[10:11], v[2:3]
v_pk_mul_f32 v[12:13], v[12:13], v[4:5]
v_pk_mul_f32 v[14:15], v[14:15], v[6:7]
v_exp_f32 v8, v8
v_exp_f32 v9, v9
v_exp_f32 v10, v10
v_exp_f32 v11, v11
v_exp_f32 v12, v12
v_exp_f32 v13, v13
v_exp_f32 v14, v14
v_exp_f32 v15, v15
v_pk_add_f32 v[8:9], v[8:9], v[244:245]
v_pk_add_f32 v[10:11], v[10:11], v[244:245]
v_pk_add_f32 v[12:13], v[12:13], v[244:245]
v_pk_add_f32 v[14:15], v[14:15], v[244:245]
v_rcp_f32 v8, v8
v_rcp_f32 v9, v9
v_rcp_f32 v10, v10
v_rcp_f32 v11, v11
v_rcp_f32 v12, v12
v_rcp_f32 v13, v13
v_rcp_f32 v14, v14
v_rcp_f32 v15, v15
v_pk_mul_f32 v[0:1], v[8:9], v[0:1]
v_pk_mul_f32 v[2:3], v[10:11], v[2:3]
v_pk_mul_f32 v[4:5], v[12:13], v[4:5]
v_pk_mul_f32 v[6:7], v[14:15], v[6:7]
v_cvt_pk_bf16_f32 v16, v0, v1
v_cvt_pk_bf16_f32 v17, v2, v3
v_cvt_pk_bf16_f32 v18, v4, v5
v_cvt_pk_bf16_f32 v19, v6, v7
buffer_store_dwordx4 v[16:19], v251, s[4:7], s53 offen offset:0 sc1
v_accvgpr_read_b32 v20, a104
v_accvgpr_read_b32 v21, a105
v_accvgpr_read_b32 v22, a106
v_accvgpr_read_b32 v23, a107
v_accvgpr_read_b32 v24, a108
v_accvgpr_read_b32 v25, a109
v_accvgpr_read_b32 v26, a110
v_accvgpr_read_b32 v27, a111
v_pk_mul_f32 v[28:29], v[20:21], v[20:21]
v_pk_mul_f32 v[30:31], v[22:23], v[22:23]
v_pk_mul_f32 v[32:33], v[24:25], v[24:25]
v_pk_mul_f32 v[34:35], v[26:27], v[26:27]
v_pk_fma_f32 v[28:29], v[28:29], v[242:243], v[240:241]
v_pk_fma_f32 v[30:31], v[30:31], v[242:243], v[240:241]
v_pk_fma_f32 v[32:33], v[32:33], v[242:243], v[240:241]
v_pk_fma_f32 v[34:35], v[34:35], v[242:243], v[240:241]
v_pk_mul_f32 v[28:29], v[28:29], v[20:21]
v_pk_mul_f32 v[30:31], v[30:31], v[22:23]
v_pk_mul_f32 v[32:33], v[32:33], v[24:25]
v_pk_mul_f32 v[34:35], v[34:35], v[26:27]
v_exp_f32 v28, v28
v_exp_f32 v29, v29
v_exp_f32 v30, v30
v_exp_f32 v31, v31
v_exp_f32 v32, v32
v_exp_f32 v33, v33
v_exp_f32 v34, v34
v_exp_f32 v35, v35
v_pk_add_f32 v[28:29], v[28:29], v[244:245]
v_pk_add_f32 v[30:31], v[30:31], v[244:245]
v_pk_add_f32 v[32:33], v[32:33], v[244:245]
v_pk_add_f32 v[34:35], v[34:35], v[244:245]
v_rcp_f32 v28, v28
v_rcp_f32 v29, v29
v_rcp_f32 v30, v30
v_rcp_f32 v31, v31
v_rcp_f32 v32, v32
v_rcp_f32 v33, v33
v_rcp_f32 v34, v34
v_rcp_f32 v35, v35
v_pk_mul_f32 v[20:21], v[28:29], v[20:21]
v_pk_mul_f32 v[22:23], v[30:31], v[22:23]
v_pk_mul_f32 v[24:25], v[32:33], v[24:25]
v_pk_mul_f32 v[26:27], v[34:35], v[26:27]
v_cvt_pk_bf16_f32 v36, v20, v21
v_cvt_pk_bf16_f32 v37, v22, v23
v_cvt_pk_bf16_f32 v38, v24, v25
v_cvt_pk_bf16_f32 v39, v26, v27
buffer_store_dwordx4 v[36:39], v251, s[4:7], s53 offen offset:1024 sc1
v_accvgpr_read_b32 v40, a112
v_accvgpr_read_b32 v41, a113
v_accvgpr_read_b32 v42, a114
v_accvgpr_read_b32 v43, a115
v_accvgpr_read_b32 v44, a116
v_accvgpr_read_b32 v45, a117
v_accvgpr_read_b32 v46, a118
v_accvgpr_read_b32 v47, a119
v_pk_mul_f32 v[48:49], v[40:41], v[40:41]
v_pk_mul_f32 v[50:51], v[42:43], v[42:43]
v_pk_mul_f32 v[52:53], v[44:45], v[44:45]
v_pk_mul_f32 v[54:55], v[46:47], v[46:47]
v_pk_fma_f32 v[48:49], v[48:49], v[242:243], v[240:241]
v_pk_fma_f32 v[50:51], v[50:51], v[242:243], v[240:241]
v_pk_fma_f32 v[52:53], v[52:53], v[242:243], v[240:241]
v_pk_fma_f32 v[54:55], v[54:55], v[242:243], v[240:241]
v_pk_mul_f32 v[48:49], v[48:49], v[40:41]
v_pk_mul_f32 v[50:51], v[50:51], v[42:43]
v_pk_mul_f32 v[52:53], v[52:53], v[44:45]
v_pk_mul_f32 v[54:55], v[54:55], v[46:47]
v_exp_f32 v48, v48
v_exp_f32 v49, v49
v_exp_f32 v50, v50
v_exp_f32 v51, v51
v_exp_f32 v52, v52
v_exp_f32 v53, v53
v_exp_f32 v54, v54
v_exp_f32 v55, v55
v_pk_add_f32 v[48:49], v[48:49], v[244:245]
v_pk_add_f32 v[50:51], v[50:51], v[244:245]
v_pk_add_f32 v[52:53], v[52:53], v[244:245]
v_pk_add_f32 v[54:55], v[54:55], v[244:245]
v_rcp_f32 v48, v48
v_rcp_f32 v49, v49
v_rcp_f32 v50, v50
v_rcp_f32 v51, v51
v_rcp_f32 v52, v52
v_rcp_f32 v53, v53
v_rcp_f32 v54, v54
v_rcp_f32 v55, v55
v_pk_mul_f32 v[40:41], v[48:49], v[40:41]
v_pk_mul_f32 v[42:43], v[50:51], v[42:43]
v_pk_mul_f32 v[44:45], v[52:53], v[44:45]
v_pk_mul_f32 v[46:47], v[54:55], v[46:47]
v_cvt_pk_bf16_f32 v56, v40, v41
v_cvt_pk_bf16_f32 v57, v42, v43
v_cvt_pk_bf16_f32 v58, v44, v45
v_cvt_pk_bf16_f32 v59, v46, v47
buffer_store_dwordx4 v[56:59], v251, s[4:7], s53 offen offset:2048 sc1
v_accvgpr_read_b32 v0, a120
v_accvgpr_read_b32 v1, a121
v_accvgpr_read_b32 v2, a122
v_accvgpr_read_b32 v3, a123
v_accvgpr_read_b32 v4, a124
v_accvgpr_read_b32 v5, a125
v_accvgpr_read_b32 v6, a126
v_accvgpr_read_b32 v7, a127
v_pk_mul_f32 v[8:9], v[0:1], v[0:1]
v_pk_mul_f32 v[10:11], v[2:3], v[2:3]
v_pk_mul_f32 v[12:13], v[4:5], v[4:5]
v_pk_mul_f32 v[14:15], v[6:7], v[6:7]
v_pk_fma_f32 v[8:9], v[8:9], v[242:243], v[240:241]
v_pk_fma_f32 v[10:11], v[10:11], v[242:243], v[240:241]
v_pk_fma_f32 v[12:13], v[12:13], v[242:243], v[240:241]
v_pk_fma_f32 v[14:15], v[14:15], v[242:243], v[240:241]
v_pk_mul_f32 v[8:9], v[8:9], v[0:1]
v_pk_mul_f32 v[10:11], v[10:11], v[2:3]
v_pk_mul_f32 v[12:13], v[12:13], v[4:5]
v_pk_mul_f32 v[14:15], v[14:15], v[6:7]
v_exp_f32 v8, v8
v_exp_f32 v9, v9
v_exp_f32 v10, v10
v_exp_f32 v11, v11
v_exp_f32 v12, v12
v_exp_f32 v13, v13
v_exp_f32 v14, v14
v_exp_f32 v15, v15
v_pk_add_f32 v[8:9], v[8:9], v[244:245]
v_pk_add_f32 v[10:11], v[10:11], v[244:245]
v_pk_add_f32 v[12:13], v[12:13], v[244:245]
v_pk_add_f32 v[14:15], v[14:15], v[244:245]
v_rcp_f32 v8, v8
v_rcp_f32 v9, v9
v_rcp_f32 v10, v10
v_rcp_f32 v11, v11
v_rcp_f32 v12, v12
v_rcp_f32 v13, v13
v_rcp_f32 v14, v14
v_rcp_f32 v15, v15
v_pk_mul_f32 v[0:1], v[8:9], v[0:1]
v_pk_mul_f32 v[2:3], v[10:11], v[2:3]
v_pk_mul_f32 v[4:5], v[12:13], v[4:5]
v_pk_mul_f32 v[6:7], v[14:15], v[6:7]
v_cvt_pk_bf16_f32 v16, v0, v1
v_cvt_pk_bf16_f32 v17, v2, v3
v_cvt_pk_bf16_f32 v18, v4, v5
v_cvt_pk_bf16_f32 v19, v6, v7
buffer_store_dwordx4 v[16:19], v251, s[4:7], s53 offen offset:3072 sc1
main_kernel_w_ee:
s_cmp_eq_u32 s58, 0
s_cbranch_scc1 main_kernel_w_c0_n_ent
s_cmp_eq_u32 s58, 1
s_cbranch_scc1 main_kernel_w_c0_v_ent
s_cmp_eq_u32 s58, 2
s_cbranch_scc1 main_kernel_w_c1_n_ent
s_cmp_eq_u32 s58, 3
s_cbranch_scc1 main_kernel_w_c1_v_ent
s_branch main_kernel_w_drain
main_kernel_w_pref:
s_cmp_lg_u32 s24, 0
s_cbranch_scc1 main_kernel_w_pf0
s_mov_b32 s8, s64
s_and_b32 s9, s65, 0xffff
s_mov_b32 s10, 0x200000
s_mov_b32 s11, 0x20000
s_branch main_kernel_w_pfg
main_kernel_w_pf0:
s_cmp_lg_u32 s24, 1
s_cbranch_scc1 main_kernel_w_pf1
s_mov_b32 s8, s66
s_and_b32 s9, s67, 0xffff
s_mov_b32 s10, 0x200000
s_mov_b32 s11, 0x20000
s_branch main_kernel_w_pfg
main_kernel_w_pf1:
s_cmp_lg_u32 s24, 2
s_cbranch_scc1 main_kernel_w_pf2
s_mov_b32 s8, s68
s_and_b32 s9, s69, 0xffff
s_mov_b32 s10, 0x700000
s_mov_b32 s11, 0x20000
s_branch main_kernel_w_pfg
main_kernel_w_pf2:
s_mov_b32 s8, s70
s_and_b32 s9, s71, 0xffff
s_mov_b32 s10, 0x700000
s_mov_b32 s11, 0x20000
main_kernel_w_pfg:
s_lshl2_add_u32 s32, s25, s14
s_mul_i32 s32, s32, 131072
v_lshlrev_b32 v253, 7, v250
buffer_load_dword v0, v253, s[8:11], s32 offen
s_add_u32 s32, s32, 8192
buffer_load_dword v0, v253, s[8:11], s32 offen
s_add_u32 s32, s32, 8192
buffer_load_dword v0, v253, s[8:11], s32 offen
s_add_u32 s32, s32, 8192
buffer_load_dword v0, v253, s[8:11], s32 offen
s_add_u32 s32, s32, 8192
buffer_load_dword v0, v253, s[8:11], s32 offen
s_add_u32 s32, s32, 8192
buffer_load_dword v0, v253, s[8:11], s32 offen
s_add_u32 s32, s32, 8192
buffer_load_dword v0, v253, s[8:11], s32 offen
s_add_u32 s32, s32, 8192
buffer_load_dword v0, v253, s[8:11], s32 offen
s_add_u32 s32, s32, 8192
buffer_load_dword v0, v253, s[8:11], s32 offen
s_add_u32 s32, s32, 8192
buffer_load_dword v0, v253, s[8:11], s32 offen
s_add_u32 s32, s32, 8192
buffer_load_dword v0, v253, s[8:11], s32 offen
s_add_u32 s32, s32, 8192
buffer_load_dword v0, v253, s[8:11], s32 offen
s_add_u32 s32, s32, 8192
buffer_load_dword v0, v253, s[8:11], s32 offen
s_add_u32 s32, s32, 8192
buffer_load_dword v0, v253, s[8:11], s32 offen
s_add_u32 s32, s32, 8192
buffer_load_dword v0, v253, s[8:11], s32 offen
s_add_u32 s32, s32, 8192
buffer_load_dword v0, v253, s[8:11], s32 offen
s_add_u32 s32, s32, 8192
s_branch main_kernel_w_done
main_kernel_w_fill:
s_lshl_b32 s32, s24, 2
s_add_u32 s32, s32, s25
s_lshl_b32 s33, s32, 16
s_add_u32 s32, s33, 0x6e00000
s_add_u32 s35, s33, 0x8c00000
s_add_u32 s33, s33, 0x8000000
s_lshl_b32 s34, s14, 12
v_add_u32 v253, s34, v251
v_mov_b32 v0, -1
v_mov_b32 v1, -1
v_mov_b32 v2, -1
v_mov_b32 v3, -1
s_mov_b32 s18, 4
main_kernel_w_fl:
buffer_store_dwordx4 v[0:3], v253, s[4:7], s32 offen offset:0 sc1
buffer_store_dwordx4 v[0:3], v253, s[4:7], s32 offen offset:1024 sc1
buffer_store_dwordx4 v[0:3], v253, s[4:7], s32 offen offset:2048 sc1
buffer_store_dwordx4 v[0:3], v253, s[4:7], s32 offen offset:3072 sc1
s_add_u32 s32, s32, 16384
buffer_store_dwordx4 v[0:3], v253, s[4:7], s33 offen offset:0 sc1
buffer_store_dwordx4 v[0:3], v253, s[4:7], s33 offen offset:1024 sc1
buffer_store_dwordx4 v[0:3], v253, s[4:7], s33 offen offset:2048 sc1
buffer_store_dwordx4 v[0:3], v253, s[4:7], s33 offen offset:3072 sc1
s_add_u32 s33, s33, 16384
buffer_store_dwordx4 v[0:3], v253, s[4:7], s35 offen offset:0 sc1
buffer_store_dwordx4 v[0:3], v253, s[4:7], s35 offen offset:1024 sc1
buffer_store_dwordx4 v[0:3], v253, s[4:7], s35 offen offset:2048 sc1
buffer_store_dwordx4 v[0:3], v253, s[4:7], s35 offen offset:3072 sc1
s_add_u32 s35, s35, 16384
s_sub_u32 s18, s18, 1
s_cmp_lg_u32 s18, 0
s_cbranch_scc1 main_kernel_w_fl
s_branch main_kernel_w_done
main_kernel_w_ln2:
s_lshl_b32 s32, s24, 3
s_mul_i32 s33, s25, 2
s_add_u32 s32, s32, s33
s_lshl_b32 s32, s32, 15
s_lshl_b32 s33, s14, 13
s_add_u32 s32, s32, s33
s_add_u32 s21, s32, 0x6800000
s_add_u32 s32, s32, 0x5000000
buffer_load_dwordx4 v[0:3], v251, s[4:7], s32 offen offset:0 sc1
buffer_load_dwordx4 v[4:7], v251, s[4:7], s32 offen offset:1024 sc1
buffer_load_dwordx4 v[8:11], v251, s[4:7], s32 offen offset:2048 sc1
buffer_load_dwordx4 v[12:15], v251, s[4:7], s32 offen offset:3072 sc1
s_add_u32 s32, s32, 4096
buffer_load_dwordx4 v[16:19], v251, s[4:7], s32 offen offset:0 sc1
buffer_load_dwordx4 v[20:23], v251, s[4:7], s32 offen offset:1024 sc1
buffer_load_dwordx4 v[24:27], v251, s[4:7], s32 offen offset:2048 sc1
buffer_load_dwordx4 v[28:31], v251, s[4:7], s32 offen offset:3072 sc1
s_add_u32 s32, s32, 28672
buffer_load_dwordx4 v[32:35], v251, s[4:7], s32 offen offset:0 sc1
buffer_load_dwordx4 v[36:39], v251, s[4:7], s32 offen offset:1024 sc1
buffer_load_dwordx4 v[40:43], v251, s[4:7], s32 offen offset:2048 sc1
buffer_load_dwordx4 v[44:47], v251, s[4:7], s32 offen offset:3072 sc1
s_add_u32 s32, s32, 4096
buffer_load_dwordx4 v[48:51], v251, s[4:7], s32 offen offset:0 sc1
buffer_load_dwordx4 v[52:55], v251, s[4:7], s32 offen offset:1024 sc1
buffer_load_dwordx4 v[56:59], v251, s[4:7], s32 offen offset:2048 sc1
buffer_load_dwordx4 v[60:63], v251, s[4:7], s32 offen offset:3072 sc1
s_add_u32 s32, s32, 28672
v_and_b32 v255, 15, v250
v_lshlrev_b32 v254, 6, v255
v_add_u32 v254, 132096, v254
v_lshrrev_b32 v255, 4, v250
v_lshl_add_u32 v253, v255, 2, v254
v_lshl_add_u32 v253, s14, 4, v253
s_waitcnt vmcnt(8)
v_lshlrev_b32 v128, 16, v0
v_and_b32 v129, 0xffff0000, v0
v_lshlrev_b32 v130, 16, v1
v_and_b32 v131, 0xffff0000, v1
v_lshlrev_b32 v132, 16, v2
v_and_b32 v133, 0xffff0000, v2
v_lshlrev_b32 v134, 16, v3
v_and_b32 v135, 0xffff0000, v3
v_lshlrev_b32 v136, 16, v4
v_and_b32 v137, 0xffff0000, v4
v_lshlrev_b32 v138, 16, v5
v_and_b32 v139, 0xffff0000, v5
v_lshlrev_b32 v140, 16, v6
v_and_b32 v141, 0xffff0000, v6
v_lshlrev_b32 v142, 16, v7
v_and_b32 v143, 0xffff0000, v7
v_lshlrev_b32 v144, 16, v8
v_and_b32 v145, 0xffff0000, v8
v_lshlrev_b32 v146, 16, v9
v_and_b32 v147, 0xffff0000, v9
v_lshlrev_b32 v148, 16, v10
v_and_b32 v149, 0xffff0000, v10
v_lshlrev_b32 v150, 16, v11
v_and_b32 v151, 0xffff0000, v11
v_lshlrev_b32 v152, 16, v12
v_and_b32 v153, 0xffff0000, v12
v_lshlrev_b32 v154, 16, v13
v_and_b32 v155, 0xffff0000, v13
v_lshlrev_b32 v156, 16, v14
v_and_b32 v157, 0xffff0000, v14
v_lshlrev_b32 v158, 16, v15
v_and_b32 v159, 0xffff0000, v15
v_lshlrev_b32 v160, 16, v16
v_and_b32 v161, 0xffff0000, v16
v_lshlrev_b32 v162, 16, v17
v_and_b32 v163, 0xffff0000, v17
v_lshlrev_b32 v164, 16, v18
v_and_b32 v165, 0xffff0000, v18
v_lshlrev_b32 v166, 16, v19
v_and_b32 v167, 0xffff0000, v19
v_lshlrev_b32 v168, 16, v20
v_and_b32 v169, 0xffff0000, v20
v_lshlrev_b32 v170, 16, v21
v_and_b32 v171, 0xffff0000, v21
v_lshlrev_b32 v172, 16, v22
v_and_b32 v173, 0xffff0000, v22
v_lshlrev_b32 v174, 16, v23
v_and_b32 v175, 0xffff0000, v23
v_lshlrev_b32 v176, 16, v24
v_and_b32 v177, 0xffff0000, v24
v_lshlrev_b32 v178, 16, v25
v_and_b32 v179, 0xffff0000, v25
v_lshlrev_b32 v180, 16, v26
v_and_b32 v181, 0xffff0000, v26
v_lshlrev_b32 v182, 16, v27
v_and_b32 v183, 0xffff0000, v27
v_lshlrev_b32 v184, 16, v28
v_and_b32 v185, 0xffff0000, v28
v_lshlrev_b32 v186, 16, v29
v_and_b32 v187, 0xffff0000, v29
v_lshlrev_b32 v188, 16, v30
v_and_b32 v189, 0xffff0000, v30
v_lshlrev_b32 v190, 16, v31
v_and_b32 v191, 0xffff0000, v31
v_pk_add_f32 v[192:193], v[128:129], v[136:137]
v_pk_add_f32 v[194:195], v[130:131], v[138:139]
v_pk_add_f32 v[196:197], v[132:133], v[140:141]
v_pk_add_f32 v[198:199], v[134:135], v[142:143]
v_pk_add_f32 v[192:193], v[192:193], v[144:145]
v_pk_add_f32 v[194:195], v[194:195], v[146:147]
v_pk_add_f32 v[196:197], v[196:197], v[148:149]
v_pk_add_f32 v[198:199], v[198:199], v[150:151]
v_pk_add_f32 v[192:193], v[192:193], v[152:153]
v_pk_add_f32 v[194:195], v[194:195], v[154:155]
v_pk_add_f32 v[196:197], v[196:197], v[156:157]
v_pk_add_f32 v[198:199], v[198:199], v[158:159]
v_pk_add_f32 v[192:193], v[192:193], v[160:161]
v_pk_add_f32 v[194:195], v[194:195], v[162:163]
v_pk_add_f32 v[196:197], v[196:197], v[164:165]
v_pk_add_f32 v[198:199], v[198:199], v[166:167]
v_pk_add_f32 v[192:193], v[192:193], v[168:169]
v_pk_add_f32 v[194:195], v[194:195], v[170:171]
v_pk_add_f32 v[196:197], v[196:197], v[172:173]
v_pk_add_f32 v[198:199], v[198:199], v[174:175]
v_pk_add_f32 v[192:193], v[192:193], v[176:177]
v_pk_add_f32 v[194:195], v[194:195], v[178:179]
v_pk_add_f32 v[196:197], v[196:197], v[180:181]
v_pk_add_f32 v[198:199], v[198:199], v[182:183]
v_pk_add_f32 v[192:193], v[192:193], v[184:185]
v_pk_add_f32 v[194:195], v[194:195], v[186:187]
v_pk_add_f32 v[196:197], v[196:197], v[188:189]
v_pk_add_f32 v[198:199], v[198:199], v[190:191]
v_pk_add_f32 v[192:193], v[192:193], v[194:195]
v_pk_add_f32 v[196:197], v[196:197], v[198:199]
v_pk_add_f32 v[192:193], v[192:193], v[196:197]
v_add_f32 v192, v192, v193
ds_write_b32 v253, v192 offset:0
s_waitcnt lgkmcnt(0)
s_barrier
ds_read_b128 v[192:195], v254 offset:0
ds_read_b128 v[196:199], v254 offset:16
ds_read_b128 v[200:203], v254 offset:32
ds_read_b128 v[204:207], v254 offset:48
s_waitcnt lgkmcnt(2)
v_pk_add_f32 v[192:193], v[192:193], v[194:195]
v_pk_add_f32 v[196:197], v[196:197], v[198:199]
s_waitcnt lgkmcnt(0)
v_pk_add_f32 v[200:201], v[200:201], v[202:203]
v_pk_add_f32 v[204:205], v[204:205], v[206:207]
v_pk_add_f32 v[192:193], v[192:193], v[196:197]
v_pk_add_f32 v[200:201], v[200:201], v[204:205]
v_pk_add_f32 v[192:193], v[192:193], v[200:201]
v_add_f32 v192, v192, v193
v_mul_f32 v192, 0xba800000, v192
v_mov_b32 v193, v192
v_pk_add_f32 v[128:129], v[128:129], v[192:193]
v_pk_add_f32 v[130:131], v[130:131], v[192:193]
v_pk_add_f32 v[132:133], v[132:133], v[192:193]
v_pk_add_f32 v[134:135], v[134:135], v[192:193]
v_pk_add_f32 v[136:137], v[136:137], v[192:193]
v_pk_add_f32 v[138:139], v[138:139], v[192:193]
v_pk_add_f32 v[140:141], v[140:141], v[192:193]
v_pk_add_f32 v[142:143], v[142:143], v[192:193]
v_pk_add_f32 v[144:145], v[144:145], v[192:193]
v_pk_add_f32 v[146:147], v[146:147], v[192:193]
v_pk_add_f32 v[148:149], v[148:149], v[192:193]
v_pk_add_f32 v[150:151], v[150:151], v[192:193]
v_pk_add_f32 v[152:153], v[152:153], v[192:193]
v_pk_add_f32 v[154:155], v[154:155], v[192:193]
v_pk_add_f32 v[156:157], v[156:157], v[192:193]
v_pk_add_f32 v[158:159], v[158:159], v[192:193]
v_pk_add_f32 v[160:161], v[160:161], v[192:193]
v_pk_add_f32 v[162:163], v[162:163], v[192:193]
v_pk_add_f32 v[164:165], v[164:165], v[192:193]
v_pk_add_f32 v[166:167], v[166:167], v[192:193]
v_pk_add_f32 v[168:169], v[168:169], v[192:193]
v_pk_add_f32 v[170:171], v[170:171], v[192:193]
v_pk_add_f32 v[172:173], v[172:173], v[192:193]
v_pk_add_f32 v[174:175], v[174:175], v[192:193]
v_pk_add_f32 v[176:177], v[176:177], v[192:193]
v_pk_add_f32 v[178:179], v[178:179], v[192:193]
v_pk_add_f32 v[180:181], v[180:181], v[192:193]
v_pk_add_f32 v[182:183], v[182:183], v[192:193]
v_pk_add_f32 v[184:185], v[184:185], v[192:193]
v_pk_add_f32 v[186:187], v[186:187], v[192:193]
v_pk_add_f32 v[188:189], v[188:189], v[192:193]
v_pk_add_f32 v[190:191], v[190:191], v[192:193]
v_pk_mul_f32 v[192:193], v[128:129], v[128:129]
v_pk_mul_f32 v[194:195], v[130:131], v[130:131]
v_pk_mul_f32 v[196:197], v[132:133], v[132:133]
v_pk_mul_f32 v[198:199], v[134:135], v[134:135]
v_pk_fma_f32 v[192:193], v[136:137], v[136:137], v[192:193]
v_pk_fma_f32 v[194:195], v[138:139], v[138:139], v[194:195]
v_pk_fma_f32 v[196:197], v[140:141], v[140:141], v[196:197]
v_pk_fma_f32 v[198:199], v[142:143], v[142:143], v[198:199]
v_pk_fma_f32 v[192:193], v[144:145], v[144:145], v[192:193]
v_pk_fma_f32 v[194:195], v[146:147], v[146:147], v[194:195]
v_pk_fma_f32 v[196:197], v[148:149], v[148:149], v[196:197]
v_pk_fma_f32 v[198:199], v[150:151], v[150:151], v[198:199]
v_pk_fma_f32 v[192:193], v[152:153], v[152:153], v[192:193]
v_pk_fma_f32 v[194:195], v[154:155], v[154:155], v[194:195]
v_pk_fma_f32 v[196:197], v[156:157], v[156:157], v[196:197]
v_pk_fma_f32 v[198:199], v[158:159], v[158:159], v[198:199]
v_pk_fma_f32 v[192:193], v[160:161], v[160:161], v[192:193]
v_pk_fma_f32 v[194:195], v[162:163], v[162:163], v[194:195]
v_pk_fma_f32 v[196:197], v[164:165], v[164:165], v[196:197]
v_pk_fma_f32 v[198:199], v[166:167], v[166:167], v[198:199]
v_pk_fma_f32 v[192:193], v[168:169], v[168:169], v[192:193]
v_pk_fma_f32 v[194:195], v[170:171], v[170:171], v[194:195]
v_pk_fma_f32 v[196:197], v[172:173], v[172:173], v[196:197]
v_pk_fma_f32 v[198:199], v[174:175], v[174:175], v[198:199]
v_pk_fma_f32 v[192:193], v[176:177], v[176:177], v[192:193]
v_pk_fma_f32 v[194:195], v[178:179], v[178:179], v[194:195]
v_pk_fma_f32 v[196:197], v[180:181], v[180:181], v[196:197]
v_pk_fma_f32 v[198:199], v[182:183], v[182:183], v[198:199]
v_pk_fma_f32 v[192:193], v[184:185], v[184:185], v[192:193]
v_pk_fma_f32 v[194:195], v[186:187], v[186:187], v[194:195]
v_pk_fma_f32 v[196:197], v[188:189], v[188:189], v[196:197]
v_pk_fma_f32 v[198:199], v[190:191], v[190:191], v[198:199]
v_pk_add_f32 v[192:193], v[192:193], v[194:195]
v_pk_add_f32 v[196:197], v[196:197], v[198:199]
v_pk_add_f32 v[192:193], v[192:193], v[196:197]
v_add_f32 v192, v192, v193
ds_write_b32 v253, v192 offset:1024
s_waitcnt lgkmcnt(0)
s_barrier
ds_read_b128 v[192:195], v254 offset:1024
ds_read_b128 v[196:199], v254 offset:1040
ds_read_b128 v[200:203], v254 offset:1056
ds_read_b128 v[204:207], v254 offset:1072
s_waitcnt lgkmcnt(2)
v_pk_add_f32 v[192:193], v[192:193], v[194:195]
v_pk_add_f32 v[196:197], v[196:197], v[198:199]
s_waitcnt lgkmcnt(0)
v_pk_add_f32 v[200:201], v[200:201], v[202:203]
v_pk_add_f32 v[204:205], v[204:205], v[206:207]
v_pk_add_f32 v[192:193], v[192:193], v[196:197]
v_pk_add_f32 v[200:201], v[200:201], v[204:205]
v_pk_add_f32 v[192:193], v[192:193], v[200:201]
v_add_f32 v192, v192, v193
v_mov_b32 v193, 0x3727c5ac
v_fmac_f32 v193, 0x3a800000, v192
v_rsq_f32 v192, v193
s_nop 0
v_mov_b32 v193, v192
v_pk_mul_f32 v[128:129], v[128:129], v[192:193]
v_pk_mul_f32 v[130:131], v[130:131], v[192:193]
v_pk_mul_f32 v[132:133], v[132:133], v[192:193]
v_pk_mul_f32 v[134:135], v[134:135], v[192:193]
v_pk_mul_f32 v[136:137], v[136:137], v[192:193]
v_pk_mul_f32 v[138:139], v[138:139], v[192:193]
v_pk_mul_f32 v[140:141], v[140:141], v[192:193]
v_pk_mul_f32 v[142:143], v[142:143], v[192:193]
v_pk_mul_f32 v[144:145], v[144:145], v[192:193]
v_pk_mul_f32 v[146:147], v[146:147], v[192:193]
v_pk_mul_f32 v[148:149], v[148:149], v[192:193]
v_pk_mul_f32 v[150:151], v[150:151], v[192:193]
v_pk_mul_f32 v[152:153], v[152:153], v[192:193]
v_pk_mul_f32 v[154:155], v[154:155], v[192:193]
v_pk_mul_f32 v[156:157], v[156:157], v[192:193]
v_pk_mul_f32 v[158:159], v[158:159], v[192:193]
v_pk_mul_f32 v[160:161], v[160:161], v[192:193]
v_pk_mul_f32 v[162:163], v[162:163], v[192:193]
v_pk_mul_f32 v[164:165], v[164:165], v[192:193]
v_pk_mul_f32 v[166:167], v[166:167], v[192:193]
v_pk_mul_f32 v[168:169], v[168:169], v[192:193]
v_pk_mul_f32 v[170:171], v[170:171], v[192:193]
v_pk_mul_f32 v[172:173], v[172:173], v[192:193]
v_pk_mul_f32 v[174:175], v[174:175], v[192:193]
v_pk_mul_f32 v[176:177], v[176:177], v[192:193]
v_pk_mul_f32 v[178:179], v[178:179], v[192:193]
v_pk_mul_f32 v[180:181], v[180:181], v[192:193]
v_pk_mul_f32 v[182:183], v[182:183], v[192:193]
v_pk_mul_f32 v[184:185], v[184:185], v[192:193]
v_pk_mul_f32 v[186:187], v[186:187], v[192:193]
v_pk_mul_f32 v[188:189], v[188:189], v[192:193]
v_pk_mul_f32 v[190:191], v[190:191], v[192:193]
v_cvt_pk_bf16_f32 v0, v128, v129
v_cvt_pk_bf16_f32 v1, v130, v131
v_cvt_pk_bf16_f32 v2, v132, v133
v_cvt_pk_bf16_f32 v3, v134, v135
v_cvt_pk_bf16_f32 v4, v136, v137
v_cvt_pk_bf16_f32 v5, v138, v139
v_cvt_pk_bf16_f32 v6, v140, v141
v_cvt_pk_bf16_f32 v7, v142, v143
v_cvt_pk_bf16_f32 v8, v144, v145
v_cvt_pk_bf16_f32 v9, v146, v147
v_cvt_pk_bf16_f32 v10, v148, v149
v_cvt_pk_bf16_f32 v11, v150, v151
v_cvt_pk_bf16_f32 v12, v152, v153
v_cvt_pk_bf16_f32 v13, v154, v155
v_cvt_pk_bf16_f32 v14, v156, v157
v_cvt_pk_bf16_f32 v15, v158, v159
v_cvt_pk_bf16_f32 v16, v160, v161
v_cvt_pk_bf16_f32 v17, v162, v163
v_cvt_pk_bf16_f32 v18, v164, v165
v_cvt_pk_bf16_f32 v19, v166, v167
v_cvt_pk_bf16_f32 v20, v168, v169
v_cvt_pk_bf16_f32 v21, v170, v171
v_cvt_pk_bf16_f32 v22, v172, v173
v_cvt_pk_bf16_f32 v23, v174, v175
v_cvt_pk_bf16_f32 v24, v176, v177
v_cvt_pk_bf16_f32 v25, v178, v179
v_cvt_pk_bf16_f32 v26, v180, v181
v_cvt_pk_bf16_f32 v27, v182, v183
v_cvt_pk_bf16_f32 v28, v184, v185
v_cvt_pk_bf16_f32 v29, v186, v187
v_cvt_pk_bf16_f32 v30, v188, v189
v_cvt_pk_bf16_f32 v31, v190, v191
buffer_store_dwordx4 v[0:3], v251, s[4:7], s21 offen offset:0 sc1
buffer_store_dwordx4 v[4:7], v251, s[4:7], s21 offen offset:1024 sc1
buffer_store_dwordx4 v[8:11], v251, s[4:7], s21 offen offset:2048 sc1
buffer_store_dwordx4 v[12:15], v251, s[4:7], s21 offen offset:3072 sc1
s_add_u32 s21, s21, 4096
buffer_store_dwordx4 v[16:19], v251, s[4:7], s21 offen offset:0 sc1
buffer_store_dwordx4 v[20:23], v251, s[4:7], s21 offen offset:1024 sc1
buffer_store_dwordx4 v[24:27], v251, s[4:7], s21 offen offset:2048 sc1
buffer_store_dwordx4 v[28:31], v251, s[4:7], s21 offen offset:3072 sc1
s_add_u32 s21, s21, 28672
s_waitcnt vmcnt(8)
v_lshlrev_b32 v128, 16, v32
v_and_b32 v129, 0xffff0000, v32
v_lshlrev_b32 v130, 16, v33
v_and_b32 v131, 0xffff0000, v33
v_lshlrev_b32 v132, 16, v34
v_and_b32 v133, 0xffff0000, v34
v_lshlrev_b32 v134, 16, v35
v_and_b32 v135, 0xffff0000, v35
v_lshlrev_b32 v136, 16, v36
v_and_b32 v137, 0xffff0000, v36
v_lshlrev_b32 v138, 16, v37
v_and_b32 v139, 0xffff0000, v37
v_lshlrev_b32 v140, 16, v38
v_and_b32 v141, 0xffff0000, v38
v_lshlrev_b32 v142, 16, v39
v_and_b32 v143, 0xffff0000, v39
v_lshlrev_b32 v144, 16, v40
v_and_b32 v145, 0xffff0000, v40
v_lshlrev_b32 v146, 16, v41
v_and_b32 v147, 0xffff0000, v41
v_lshlrev_b32 v148, 16, v42
v_and_b32 v149, 0xffff0000, v42
v_lshlrev_b32 v150, 16, v43
v_and_b32 v151, 0xffff0000, v43
v_lshlrev_b32 v152, 16, v44
v_and_b32 v153, 0xffff0000, v44
v_lshlrev_b32 v154, 16, v45
v_and_b32 v155, 0xffff0000, v45
v_lshlrev_b32 v156, 16, v46
v_and_b32 v157, 0xffff0000, v46
v_lshlrev_b32 v158, 16, v47
v_and_b32 v159, 0xffff0000, v47
v_lshlrev_b32 v160, 16, v48
v_and_b32 v161, 0xffff0000, v48
v_lshlrev_b32 v162, 16, v49
v_and_b32 v163, 0xffff0000, v49
v_lshlrev_b32 v164, 16, v50
v_and_b32 v165, 0xffff0000, v50
v_lshlrev_b32 v166, 16, v51
v_and_b32 v167, 0xffff0000, v51
v_lshlrev_b32 v168, 16, v52
v_and_b32 v169, 0xffff0000, v52
v_lshlrev_b32 v170, 16, v53
v_and_b32 v171, 0xffff0000, v53
v_lshlrev_b32 v172, 16, v54
v_and_b32 v173, 0xffff0000, v54
v_lshlrev_b32 v174, 16, v55
v_and_b32 v175, 0xffff0000, v55
v_lshlrev_b32 v176, 16, v56
v_and_b32 v177, 0xffff0000, v56
v_lshlrev_b32 v178, 16, v57
v_and_b32 v179, 0xffff0000, v57
v_lshlrev_b32 v180, 16, v58
v_and_b32 v181, 0xffff0000, v58
v_lshlrev_b32 v182, 16, v59
v_and_b32 v183, 0xffff0000, v59
v_lshlrev_b32 v184, 16, v60
v_and_b32 v185, 0xffff0000, v60
v_lshlrev_b32 v186, 16, v61
v_and_b32 v187, 0xffff0000, v61
v_lshlrev_b32 v188, 16, v62
v_and_b32 v189, 0xffff0000, v62
v_lshlrev_b32 v190, 16, v63
v_and_b32 v191, 0xffff0000, v63
v_pk_add_f32 v[192:193], v[128:129], v[136:137]
v_pk_add_f32 v[194:195], v[130:131], v[138:139]
v_pk_add_f32 v[196:197], v[132:133], v[140:141]
v_pk_add_f32 v[198:199], v[134:135], v[142:143]
v_pk_add_f32 v[192:193], v[192:193], v[144:145]
v_pk_add_f32 v[194:195], v[194:195], v[146:147]
v_pk_add_f32 v[196:197], v[196:197], v[148:149]
v_pk_add_f32 v[198:199], v[198:199], v[150:151]
v_pk_add_f32 v[192:193], v[192:193], v[152:153]
v_pk_add_f32 v[194:195], v[194:195], v[154:155]
v_pk_add_f32 v[196:197], v[196:197], v[156:157]
v_pk_add_f32 v[198:199], v[198:199], v[158:159]
v_pk_add_f32 v[192:193], v[192:193], v[160:161]
v_pk_add_f32 v[194:195], v[194:195], v[162:163]
v_pk_add_f32 v[196:197], v[196:197], v[164:165]
v_pk_add_f32 v[198:199], v[198:199], v[166:167]
v_pk_add_f32 v[192:193], v[192:193], v[168:169]
v_pk_add_f32 v[194:195], v[194:195], v[170:171]
v_pk_add_f32 v[196:197], v[196:197], v[172:173]
v_pk_add_f32 v[198:199], v[198:199], v[174:175]
v_pk_add_f32 v[192:193], v[192:193], v[176:177]
v_pk_add_f32 v[194:195], v[194:195], v[178:179]
v_pk_add_f32 v[196:197], v[196:197], v[180:181]
v_pk_add_f32 v[198:199], v[198:199], v[182:183]
v_pk_add_f32 v[192:193], v[192:193], v[184:185]
v_pk_add_f32 v[194:195], v[194:195], v[186:187]
v_pk_add_f32 v[196:197], v[196:197], v[188:189]
v_pk_add_f32 v[198:199], v[198:199], v[190:191]
v_pk_add_f32 v[192:193], v[192:193], v[194:195]
v_pk_add_f32 v[196:197], v[196:197], v[198:199]
v_pk_add_f32 v[192:193], v[192:193], v[196:197]
v_add_f32 v192, v192, v193
ds_write_b32 v253, v192 offset:0
s_waitcnt lgkmcnt(0)
s_barrier
ds_read_b128 v[192:195], v254 offset:0
ds_read_b128 v[196:199], v254 offset:16
ds_read_b128 v[200:203], v254 offset:32
ds_read_b128 v[204:207], v254 offset:48
s_waitcnt lgkmcnt(2)
v_pk_add_f32 v[192:193], v[192:193], v[194:195]
v_pk_add_f32 v[196:197], v[196:197], v[198:199]
s_waitcnt lgkmcnt(0)
v_pk_add_f32 v[200:201], v[200:201], v[202:203]
v_pk_add_f32 v[204:205], v[204:205], v[206:207]
v_pk_add_f32 v[192:193], v[192:193], v[196:197]
v_pk_add_f32 v[200:201], v[200:201], v[204:205]
v_pk_add_f32 v[192:193], v[192:193], v[200:201]
v_add_f32 v192, v192, v193
v_mul_f32 v192, 0xba800000, v192
v_mov_b32 v193, v192
v_pk_add_f32 v[128:129], v[128:129], v[192:193]
v_pk_add_f32 v[130:131], v[130:131], v[192:193]
v_pk_add_f32 v[132:133], v[132:133], v[192:193]
v_pk_add_f32 v[134:135], v[134:135], v[192:193]
v_pk_add_f32 v[136:137], v[136:137], v[192:193]
v_pk_add_f32 v[138:139], v[138:139], v[192:193]
v_pk_add_f32 v[140:141], v[140:141], v[192:193]
v_pk_add_f32 v[142:143], v[142:143], v[192:193]
v_pk_add_f32 v[144:145], v[144:145], v[192:193]
v_pk_add_f32 v[146:147], v[146:147], v[192:193]
v_pk_add_f32 v[148:149], v[148:149], v[192:193]
v_pk_add_f32 v[150:151], v[150:151], v[192:193]
v_pk_add_f32 v[152:153], v[152:153], v[192:193]
v_pk_add_f32 v[154:155], v[154:155], v[192:193]
v_pk_add_f32 v[156:157], v[156:157], v[192:193]
v_pk_add_f32 v[158:159], v[158:159], v[192:193]
v_pk_add_f32 v[160:161], v[160:161], v[192:193]
v_pk_add_f32 v[162:163], v[162:163], v[192:193]
v_pk_add_f32 v[164:165], v[164:165], v[192:193]
v_pk_add_f32 v[166:167], v[166:167], v[192:193]
v_pk_add_f32 v[168:169], v[168:169], v[192:193]
v_pk_add_f32 v[170:171], v[170:171], v[192:193]
v_pk_add_f32 v[172:173], v[172:173], v[192:193]
v_pk_add_f32 v[174:175], v[174:175], v[192:193]
v_pk_add_f32 v[176:177], v[176:177], v[192:193]
v_pk_add_f32 v[178:179], v[178:179], v[192:193]
v_pk_add_f32 v[180:181], v[180:181], v[192:193]
v_pk_add_f32 v[182:183], v[182:183], v[192:193]
v_pk_add_f32 v[184:185], v[184:185], v[192:193]
v_pk_add_f32 v[186:187], v[186:187], v[192:193]
v_pk_add_f32 v[188:189], v[188:189], v[192:193]
v_pk_add_f32 v[190:191], v[190:191], v[192:193]
v_pk_mul_f32 v[192:193], v[128:129], v[128:129]
v_pk_mul_f32 v[194:195], v[130:131], v[130:131]
v_pk_mul_f32 v[196:197], v[132:133], v[132:133]
v_pk_mul_f32 v[198:199], v[134:135], v[134:135]
v_pk_fma_f32 v[192:193], v[136:137], v[136:137], v[192:193]
v_pk_fma_f32 v[194:195], v[138:139], v[138:139], v[194:195]
v_pk_fma_f32 v[196:197], v[140:141], v[140:141], v[196:197]
v_pk_fma_f32 v[198:199], v[142:143], v[142:143], v[198:199]
v_pk_fma_f32 v[192:193], v[144:145], v[144:145], v[192:193]
v_pk_fma_f32 v[194:195], v[146:147], v[146:147], v[194:195]
v_pk_fma_f32 v[196:197], v[148:149], v[148:149], v[196:197]
v_pk_fma_f32 v[198:199], v[150:151], v[150:151], v[198:199]
v_pk_fma_f32 v[192:193], v[152:153], v[152:153], v[192:193]
v_pk_fma_f32 v[194:195], v[154:155], v[154:155], v[194:195]
v_pk_fma_f32 v[196:197], v[156:157], v[156:157], v[196:197]
v_pk_fma_f32 v[198:199], v[158:159], v[158:159], v[198:199]
v_pk_fma_f32 v[192:193], v[160:161], v[160:161], v[192:193]
v_pk_fma_f32 v[194:195], v[162:163], v[162:163], v[194:195]
v_pk_fma_f32 v[196:197], v[164:165], v[164:165], v[196:197]
v_pk_fma_f32 v[198:199], v[166:167], v[166:167], v[198:199]
v_pk_fma_f32 v[192:193], v[168:169], v[168:169], v[192:193]
v_pk_fma_f32 v[194:195], v[170:171], v[170:171], v[194:195]
v_pk_fma_f32 v[196:197], v[172:173], v[172:173], v[196:197]
v_pk_fma_f32 v[198:199], v[174:175], v[174:175], v[198:199]
v_pk_fma_f32 v[192:193], v[176:177], v[176:177], v[192:193]
v_pk_fma_f32 v[194:195], v[178:179], v[178:179], v[194:195]
v_pk_fma_f32 v[196:197], v[180:181], v[180:181], v[196:197]
v_pk_fma_f32 v[198:199], v[182:183], v[182:183], v[198:199]
v_pk_fma_f32 v[192:193], v[184:185], v[184:185], v[192:193]
v_pk_fma_f32 v[194:195], v[186:187], v[186:187], v[194:195]
v_pk_fma_f32 v[196:197], v[188:189], v[188:189], v[196:197]
v_pk_fma_f32 v[198:199], v[190:191], v[190:191], v[198:199]
v_pk_add_f32 v[192:193], v[192:193], v[194:195]
v_pk_add_f32 v[196:197], v[196:197], v[198:199]
v_pk_add_f32 v[192:193], v[192:193], v[196:197]
v_add_f32 v192, v192, v193
ds_write_b32 v253, v192 offset:1024
s_waitcnt lgkmcnt(0)
s_barrier
ds_read_b128 v[192:195], v254 offset:1024
ds_read_b128 v[196:199], v254 offset:1040
ds_read_b128 v[200:203], v254 offset:1056
ds_read_b128 v[204:207], v254 offset:1072
s_waitcnt lgkmcnt(2)
v_pk_add_f32 v[192:193], v[192:193], v[194:195]
v_pk_add_f32 v[196:197], v[196:197], v[198:199]
s_waitcnt lgkmcnt(0)
v_pk_add_f32 v[200:201], v[200:201], v[202:203]
v_pk_add_f32 v[204:205], v[204:205], v[206:207]
v_pk_add_f32 v[192:193], v[192:193], v[196:197]
v_pk_add_f32 v[200:201], v[200:201], v[204:205]
v_pk_add_f32 v[192:193], v[192:193], v[200:201]
v_add_f32 v192, v192, v193
v_mov_b32 v193, 0x3727c5ac
v_fmac_f32 v193, 0x3a800000, v192
v_rsq_f32 v192, v193
s_nop 0
v_mov_b32 v193, v192
v_pk_mul_f32 v[128:129], v[128:129], v[192:193]
v_pk_mul_f32 v[130:131], v[130:131], v[192:193]
v_pk_mul_f32 v[132:133], v[132:133], v[192:193]
v_pk_mul_f32 v[134:135], v[134:135], v[192:193]
v_pk_mul_f32 v[136:137], v[136:137], v[192:193]
v_pk_mul_f32 v[138:139], v[138:139], v[192:193]
v_pk_mul_f32 v[140:141], v[140:141], v[192:193]
v_pk_mul_f32 v[142:143], v[142:143], v[192:193]
v_pk_mul_f32 v[144:145], v[144:145], v[192:193]
v_pk_mul_f32 v[146:147], v[146:147], v[192:193]
v_pk_mul_f32 v[148:149], v[148:149], v[192:193]
v_pk_mul_f32 v[150:151], v[150:151], v[192:193]
v_pk_mul_f32 v[152:153], v[152:153], v[192:193]
v_pk_mul_f32 v[154:155], v[154:155], v[192:193]
v_pk_mul_f32 v[156:157], v[156:157], v[192:193]
v_pk_mul_f32 v[158:159], v[158:159], v[192:193]
v_pk_mul_f32 v[160:161], v[160:161], v[192:193]
v_pk_mul_f32 v[162:163], v[162:163], v[192:193]
v_pk_mul_f32 v[164:165], v[164:165], v[192:193]
v_pk_mul_f32 v[166:167], v[166:167], v[192:193]
v_pk_mul_f32 v[168:169], v[168:169], v[192:193]
v_pk_mul_f32 v[170:171], v[170:171], v[192:193]
v_pk_mul_f32 v[172:173], v[172:173], v[192:193]
v_pk_mul_f32 v[174:175], v[174:175], v[192:193]
v_pk_mul_f32 v[176:177], v[176:177], v[192:193]
v_pk_mul_f32 v[178:179], v[178:179], v[192:193]
v_pk_mul_f32 v[180:181], v[180:181], v[192:193]
v_pk_mul_f32 v[182:183], v[182:183], v[192:193]
v_pk_mul_f32 v[184:185], v[184:185], v[192:193]
v_pk_mul_f32 v[186:187], v[186:187], v[192:193]
v_pk_mul_f32 v[188:189], v[188:189], v[192:193]
v_pk_mul_f32 v[190:191], v[190:191], v[192:193]
v_cvt_pk_bf16_f32 v32, v128, v129
v_cvt_pk_bf16_f32 v33, v130, v131
v_cvt_pk_bf16_f32 v34, v132, v133
v_cvt_pk_bf16_f32 v35, v134, v135
v_cvt_pk_bf16_f32 v36, v136, v137
v_cvt_pk_bf16_f32 v37, v138, v139
v_cvt_pk_bf16_f32 v38, v140, v141
v_cvt_pk_bf16_f32 v39, v142, v143
v_cvt_pk_bf16_f32 v40, v144, v145
v_cvt_pk_bf16_f32 v41, v146, v147
v_cvt_pk_bf16_f32 v42, v148, v149
v_cvt_pk_bf16_f32 v43, v150, v151
v_cvt_pk_bf16_f32 v44, v152, v153
v_cvt_pk_bf16_f32 v45, v154, v155
v_cvt_pk_bf16_f32 v46, v156, v157
v_cvt_pk_bf16_f32 v47, v158, v159
v_cvt_pk_bf16_f32 v48, v160, v161
v_cvt_pk_bf16_f32 v49, v162, v163
v_cvt_pk_bf16_f32 v50, v164, v165
v_cvt_pk_bf16_f32 v51, v166, v167
v_cvt_pk_bf16_f32 v52, v168, v169
v_cvt_pk_bf16_f32 v53, v170, v171
v_cvt_pk_bf16_f32 v54, v172, v173
v_cvt_pk_bf16_f32 v55, v174, v175
v_cvt_pk_bf16_f32 v56, v176, v177
v_cvt_pk_bf16_f32 v57, v178, v179
v_cvt_pk_bf16_f32 v58, v180, v181
v_cvt_pk_bf16_f32 v59, v182, v183
v_cvt_pk_bf16_f32 v60, v184, v185
v_cvt_pk_bf16_f32 v61, v186, v187
v_cvt_pk_bf16_f32 v62, v188, v189
v_cvt_pk_bf16_f32 v63, v190, v191
buffer_store_dwordx4 v[32:35], v251, s[4:7], s21 offen offset:0 sc1
buffer_store_dwordx4 v[36:39], v251, s[4:7], s21 offen offset:1024 sc1
buffer_store_dwordx4 v[40:43], v251, s[4:7], s21 offen offset:2048 sc1
buffer_store_dwordx4 v[44:47], v251, s[4:7], s21 offen offset:3072 sc1
s_add_u32 s21, s21, 4096
buffer_store_dwordx4 v[48:51], v251, s[4:7], s21 offen offset:0 sc1
buffer_store_dwordx4 v[52:55], v251, s[4:7], s21 offen offset:1024 sc1
buffer_store_dwordx4 v[56:59], v251, s[4:7], s21 offen offset:2048 sc1
buffer_store_dwordx4 v[60:63], v251, s[4:7], s21 offen offset:3072 sc1
s_add_u32 s21, s21, 28672
s_mov_b32 s54, 0
main_kernel_w_done:
s_add_u32 s32, s23, 1
s_bitcmp0_b32 s32, 2
s_cselect_b32 s34, 7, 2
s_cselect_b32 s35, 2, 4
s_lshl_b32 s59, s23, 13
s_add_u32 s59, s59, 0x8404000
v_lshrrev_b32 v253, 3, v250
v_add_lshl_u32 v253, s24, v253, 9
v_and_b32 v254, 3, v250
v_lshl_add_u32 v253, v254, s34, v253
v_bfe_u32 v254, v250, 2, 1
v_add_u32 v254, s25, v254
v_lshl_add_u32 v248, v254, s35, v253
s_lshl_b32 s0, 4, s54
main_kernel_w_drain:
s_waitcnt vmcnt(0)
s_barrier
s_cmp_lg_u32 s14, 0
s_cbranch_scc1 main_kernel_w_bar
s_bfm_b64 exec, s0, 0
buffer_store_dword v244, v248, s[4:7], s59 offen sc1
s_mov_b64 exec, -1
s_cmp_eq_u32 s58, -1
s_cbranch_scc1 main_kernel_w_chk
s_lshl_b32 s32, s27, 8
s_add_u32 s32, s32, 0x841e000
s_mov_b64 exec, 1
v_mov_b32 v249, 1
buffer_atomic_add v249, off, s[4:7], s32 sc0 sc1
s_mov_b64 exec, -1
s_branch main_kernel_w_dec
.section .rodata,"a"
.p2align 6
.amdhsa_kernel main_kernel
  .amdhsa_next_free_vgpr 512
  .amdhsa_next_free_sgpr 102
  .amdhsa_accum_offset 256
  .amdhsa_group_segment_fixed_size 0
  .amdhsa_kernarg_size 120
  .amdhsa_user_sgpr_count 2
  .amdhsa_user_sgpr_kernarg_segment_ptr 1
  .amdhsa_system_sgpr_workgroup_id_x 1
.end_amdhsa_kernel
```
